```python
import torch

def _softmax(x, axis=-1):
    return torch.softmax(x, dim=axis)
def _gelu(x):
    return torch.nn.functional.gelu(x, approximate="tanh")
def _silu(x):
    return torch.nn.functional.silu(x)
def _sigmoid(x):
    return torch.sigmoid(x)
def _layernorm(x, axis=-1, eps=1e-5):
    m = x.mean(dim=axis, keepdim=True)
    v = x.var(dim=axis, keepdim=True, unbiased=False)
    return (x - m) / torch.sqrt(v + eps)
def _scatter_add(tgt, idx, src, axis=0):
    return tgt.clone().index_add_(axis, idx, src)
def _segment_sum(src, seg, n):
    out = torch.zeros((n,) + src.shape[1:], dtype=src.dtype)
    return out.index_add_(0, seg, src)
def _pad(x, pw):
    flat = tuple(v for pair in reversed(pw) for v in pair)
    return torch.nn.functional.pad(x, flat)

kernel_name = 'standalone__gqa_softmax__near_ridge'

def setup_inputs():

    _w = (lambda a: (lambda t: t.to(torch.bfloat16) if t.is_floating_point() else t)(torch.as_tensor(a)))
    B, Hq, Hkv, Sq, Sk, D = 16, 32, 32, 848, 512, 128
    return {
        "q": _w((lambda *s: torch.randn(*s, dtype=torch.bfloat16) * 0.8)(B, Hq, Sq, D)),
        "k": _w((lambda *s: torch.randn(*s, dtype=torch.bfloat16) * 0.8)(B, Hkv, Sk, D)),
        "v": _w((lambda *s: torch.randn(*s, dtype=torch.bfloat16) * 0.05)(B, Hkv, Sk, D)),
    }

def reference(q, k, v):
    B, Hq, Sq, D = q.shape
    Hkv = k.shape[1]
    rep = Hq // Hkv
    k = (lambda x, n, axis: torch.repeat_interleave(x, n, dim=axis))(k, rep, axis=1)
    v = (lambda x, n, axis: torch.repeat_interleave(x, n, dim=axis))(v, rep, axis=1)
    scale = D ** -0.5
    scores = torch.einsum("bhqd,bhkd->bhqk", q, k) * scale
    p = _softmax(scores, axis=-1)
    return torch.einsum("bhqk,bhkd->bhqd", p, v)
```

```asm
; @launch grid=(256,1,1) block=(256,1,1) lds=154112
.amdgcn_target "amdgcn-amd-amdhsa--gfx950"
.text
.globl standalone__gqa_softmax__near_ridge_kernel
.p2align 8
.type standalone__gqa_softmax__near_ridge_kernel,@function
standalone__gqa_softmax__near_ridge_kernel:
  s_cmp_ge_u32 s2, 256
  s_cbranch_scc1 L_out
  s_load_dwordx2 s[12:13], s[0:1], 0
  s_load_dwordx2 s[4:5], s[0:1], 8
  s_load_dwordx2 s[8:9], s[0:1], 16
  s_load_dwordx2 s[16:17], s[0:1], 24
  v_lshrrev_b32 v245, 6, v0
  v_and_b32 v242, 63, v0
  v_readfirstlane_b32 s28, v245
  v_lshrrev_b32 v243, 4, v242
  v_and_b32 v244, 15, v242
  s_getpc_b64 s[60:61]
L_pc:
  s_lshr_b32 s50, s2, 3
  s_lshl_b32 s50, s50, 12
  v_lshl_add_u32 v246, v0, 4, s50
  v_min_u32 v246, L_end-L_pc, v246
  v_mov_b32 v253, s61
  v_add_co_u32 v252, vcc, s60, v246
  s_lshr_b32 s50, s2, 4
  s_lshl_b32 s50, s50, 3
  s_and_b32 s51, s2, 7
  v_addc_co_u32 v253, vcc, 0, v253, vcc
  global_load_dword a120, v[252:253], off
  s_add_u32 s55, s50, s51
  s_bfe_u32 s56, s2, 0x10003
  s_lshr_b32 s3, s55, 3
  s_lshl_b32 s50, s55, 1
  s_xor_b32 s3, s3, s50
  s_and_b32 s3, s3, 15
  s_lshl_b32 s3, s3, 13
  s_mul_i32 s32, s28, 2112
  s_mul_i32 s49, s28, 24576
  s_add_u32 s49, s49, 50688
  s_lshl_b32 s96, s28, 5
  s_sub_u32 s96, 8448, s96
  s_sub_u32 s50, 7, s56
  s_mul_i32 s50, s50, s28
  s_mul_i32 s51, s56, 28
  s_add_u32 s50, s50, s51
  s_lshl_b32 s50, s50, 12
  s_mul_i32 s47, s55, 868352
  s_add_u32 s41, s47, s50
  s_mov_b32 s39, s41
  v_lshlrev_b32 v233, 4, v242
  v_lshl_add_u32 v221, v245, 11, v233
  v_lshlrev_b32 v246, 5, v243
  v_xor_b32 v222, v246, v233
  v_xor_b32 v223, 128, v222
  s_mov_b32 s14, 111149056
  s_mov_b32 s15, 0x20000
  s_mov_b32 s6, 524288
  s_mov_b32 s7, 0x20000
  s_mov_b32 s10, 524288
  s_mov_b32 s11, 0x20000
  s_lshl_b32 s52, s55, 19
  s_getreg_b32 s58, hwreg(HW_REG_XCC_ID, 0, 1)
  s_lshl1_add_u32 s58, s58, s56
  s_lshl_b32 s58, s58, 2
  s_lshr_b32 s58, 135, s58
  s_and_b32 s58, s58, 15
  s_add_u32 m0, s49, 0
  s_add_u32 s50, s39, 0
  s_waitcnt lgkmcnt(0)
  buffer_load_dwordx4 v222, s[12:15], s50 offen nt lds
  buffer_load_dwordx4 v223, s[12:15], s50 offen offset:1024 nt lds
  buffer_load_dwordx4 v222, s[12:15], s50 offen offset:2048 nt lds
  buffer_load_dwordx4 v223, s[12:15], s50 offen offset:3072 nt lds
  s_add_u32 s4, s4, s52
  s_addc_u32 s5, s5, 0
  s_add_u32 s8, s8, s52
  s_addc_u32 s9, s9, 0
  s_cmp_lt_u32 s58, 1
  s_cbranch_scc1 L_y1
  s_waitcnt vmcnt(0)
L_y1:
  s_add_u32 m0, s32, 33792
  s_xor_b32 s50, 0, s3
  buffer_load_dwordx4 v221, s[4:7], s50 offen lds
  s_add_u32 m0, s32, 33824
  s_add_u32 s51, s32, s96
  buffer_load_dwordx4 v221, s[4:7], s50 offen offset:1024 lds
  s_add_u32 m0, s51, 33792
  s_nop 0
  buffer_load_dwordx4 v221, s[8:11], s50 offen lds
  s_add_u32 m0, s51, 33808
  s_nop 0
  buffer_load_dwordx4 v221, s[8:11], s50 offen offset:1024 lds
  s_cmp_lt_u32 s58, 2
  s_cbranch_scc1 L_y2
  s_waitcnt vmcnt(0)
L_y2:
  s_add_u32 m0, s49, 4096
  s_add_u32 s50, s39, 4096
  buffer_load_dwordx4 v222, s[12:15], s50 offen nt lds
  buffer_load_dwordx4 v223, s[12:15], s50 offen offset:1024 nt lds
  buffer_load_dwordx4 v222, s[12:15], s50 offen offset:2048 nt lds
  buffer_load_dwordx4 v223, s[12:15], s50 offen offset:3072 nt lds
  s_mov_b32 s18, 111149056
  s_mov_b32 s19, 0x20000
  s_add_u32 s31, s32, 33792
  v_add_u32 v234, s49, v233
  v_lshlrev_b32 v246, 4, v243
  v_lshl_add_u32 v255, v244, 8, v246
  s_lshl_b32 s50, s28, 12
  s_sub_u32 s43, 331776, s50
  s_add_u32 s45, 102400, s50
  s_mul_i32 s50, s50, 7
  s_sub_u32 s44, 405504, s50
  s_add_u32 s46, 28672, s50
  s_add_u32 s50, s50, 24576
  s_cmp_eq_u32 s56, 0
  s_cselect_b32 s43, s43, s45
  s_cselect_b32 s44, s44, s46
  s_cselect_b32 s50, s50, 212992
  s_add_u32 s42, s47, s50
  s_mov_b32 s40, s42
  s_add_u32 s41, s41, s43
  s_add_u32 s42, s42, s44
  s_sub_u32 s43, 434176, s43
  s_sub_u32 s44, 434176, s44
  v_and_b32 v246, 7, v244
  v_lshlrev_b32 v247, 8, v244
  v_add_u32 v247, s49, v247
  v_lshlrev_b32 v245, 1, v246
  v_xor_b32 v245, v245, v243
  v_lshl_add_u32 v224, v245, 4, v247
  v_lshlrev_b32 v247, 4, v244
  v_lshl_add_u32 v245, v243, 10, v247
  v_add_u32 v232, s49, v245
  s_lshl_b32 s50, s28, 8
  s_add_u32 s51, s50, 50688
  v_lshl_add_u32 v245, v243, 11, v247
  v_add_u32 v236, s51, v245
  v_add_u32 v237, 49152, v236
  v_lshlrev_b32 v245, 2, v242
  v_add_u32 v239, 148992, v245
  v_add_u32 v238, s50, v239
  s_lshl_b32 s50, s28, 10
  s_add_u32 s50, s50, 150016
  v_lshl_add_u32 v245, v243, 2, v247
  v_add_u32 v240, s50, v245
  v_bfe_u32 v245, v242, 1, 1
  v_lshlrev_b32 v245, 7, v245
  v_and_b32 v247, 1, v242
  v_lshl_add_u32 v247, v247, 3, v245
  v_bfe_u32 v245, v242, 2, 2
  v_lshl_add_u32 v245, v245, 4, v247
  v_lshl_add_u32 v245, v243, 8, v245
  v_add_u32 v235, s49, v245
  v_add_u32 v241, s50, v245
  v_mul_u32_u24 v245, 1056, v246
  v_lshrrev_b32 v246, 3, v244
  v_lshl_add_u32 v245, v246, 8, v245
  v_lshl_add_u32 v245, v243, 4, v245
  v_subrev_u32 v218, s32, v245
  v_bfe_u32 v245, v242, 2, 3
  v_mul_u32_u24 v245, 1040, v245
  v_lshrrev_b32 v246, 5, v242
  v_lshl_add_u32 v245, v246, 8, v245
  v_add_u32 v245, v245, v247
  v_subrev_u32 v219, s32, v245
  s_add_u32 s97, s96, 16
  s_sub_u32 s98, s28, 1
  s_and_b32 s98, s98, 3
  s_lshl_b32 s98, s98, 11
  v_cmp_gt_u32 vcc, 16, v242
  v_mov_b32 v245, 1.0
  s_nop 0
  v_cndmask_b32 v245, 0, v245, vcc
  v_accvgpr_write_b32 a121, v245
  v_accvgpr_write_b32 a122, v218
  v_accvgpr_write_b32 a123, v219
  v_accvgpr_write_b32 a208, v255
  v_add_u32 v216, s32, v218
  v_add_u32 v217, s32, v219
  v_and_b32 v247, 1, v242
  v_mul_u32_u24 v247, 0xaaaa, v247
  v_add_u32 v254, 0x4444, v247
  v_lshrrev_b32 v247, 4, v242
  v_xor_b32 v246, v247, v242
  v_and_b32 v246, 2, v246
  v_mov_b32 v245, 0x3f803f80
  v_cmp_eq_u32 vcc, 0, v246
  s_nop 1
  v_cndmask_b32 v245, 0, v245, vcc
  v_accvgpr_write_b32 a220, v245
  v_accvgpr_write_b32 a221, v245
  v_accvgpr_write_b32 a222, v245
  v_accvgpr_write_b32 a223, v245
  v_accvgpr_write_b32 a124, 0
  v_accvgpr_write_b32 a125, 0
  v_accvgpr_write_b32 a126, 0
  v_accvgpr_write_b32 a127, 0
  s_mov_b32 s29, 0x3e0293ee
  s_mov_b32 s30, s32
  s_mov_b32 s34, s41
  s_mov_b32 s35, 0
  s_mov_b32 s36, s49
  s_mov_b32 s38, 4
  s_mov_b32 s48, 0
  s_mov_b32 s53, 0x2b800000
  s_mov_b32 s54, 0x52800000
  v_subrev_u32 v220, s98, v235
  v_xor_b32 v225, 64, v224
  v_xor_b32 v226, 128, v224
  v_xor_b32 v227, 192, v224
  v_mov_b32 v228, 0xc2d3bc5b
  v_mov_b32 v229, 0xc2d3bc5b
  v_mov_b32 v230, 0xc2d3bc5b
  v_mov_b32 v231, 0xc2d3bc5b
  v_mfma_f32_16x16x32_bf16 a[224:227], a[124:127], a[124:127], 0
  v_mfma_f32_16x16x32_bf16 a[228:231], a[124:127], a[124:127], 0
  v_mfma_f32_16x16x32_bf16 a[232:235], a[124:127], a[124:127], 0
  v_mfma_f32_16x16x32_bf16 a[236:239], a[124:127], a[124:127], 0
  v_mfma_f32_16x16x32_bf16 a[240:243], a[124:127], a[124:127], 0
  v_mfma_f32_16x16x32_bf16 a[244:247], a[124:127], a[124:127], 0
  v_mfma_f32_16x16x32_bf16 a[248:251], a[124:127], a[124:127], 0
  v_mfma_f32_16x16x32_bf16 a[252:255], a[124:127], a[124:127], 0
  v_mfma_f32_16x16x32_bf16 a[204:207], a[124:127], a[124:127], 0
  v_mfma_f32_16x16x32_bf16 a[192:195], a[124:127], a[124:127], 0
  v_mfma_f32_16x16x32_bf16 a[196:199], a[124:127], a[124:127], 0
  v_mfma_f32_16x16x32_bf16 a[200:203], a[124:127], a[124:127], 0
  s_mov_b32 s59, 40960
  s_xor_b32 s33, s59, s3
  s_mov_b32 s37, 13
  s_add_u32 s50, s28, 1
  s_mov_b32 s99, 0x2a9444
  s_bitcmp1_b32 s50, 1
  s_cselect_b32 s99, 0xaa511, s99
  s_cmp_lt_u32 s58, 3
  s_cbranch_scc1 L_y3
  s_waitcnt vmcnt(0)
L_y3:
  s_add_u32 m0, s32, 16896
  s_xor_b32 s50, 8192, s3
  buffer_load_dwordx4 v221, s[4:7], s50 offen lds
  s_add_u32 m0, s32, 16928
  s_add_u32 s51, s32, s96
  buffer_load_dwordx4 v221, s[4:7], s50 offen offset:1024 lds
  s_add_u32 m0, s51, 16896
  s_nop 0
  buffer_load_dwordx4 v221, s[8:11], s50 offen lds
  s_add_u32 m0, s51, 16912
  s_nop 0
  buffer_load_dwordx4 v221, s[8:11], s50 offen offset:1024 lds
  s_waitcnt vmcnt(8)
  s_barrier
  s_cmp_eq_u32 s56, 0
  s_cbranch_scc1 L_startA
  s_cmp_eq_u32 s28, 0
  s_cbranch_scc1 L_startB0
  s_cmp_eq_u32 s28, 3
  s_cbranch_scc1 L_startB3
  ds_read_b128 a[128:131], v216 offset:33792
  ds_read_b128 a[132:135], v216 offset:33856
  ds_read_b128 a[136:139], v216 offset:33920
  ds_read_b128 a[140:143], v216 offset:33984
  ds_read_b128 a[144:147], v216 offset:34496
  ds_read_b128 a[148:151], v216 offset:34432
  ds_read_b128 a[152:155], v216 offset:34368
  ds_read_b128 a[156:159], v216 offset:34304
  ds_read_b128 a[0:3], v224 offset:0
  ds_read_b128 a[4:7], v225 offset:0
  ds_read_b128 a[8:11], v226 offset:0
  ds_read_b128 a[12:15], v227 offset:0
  s_cmp_lt_u32 s58, 4
  s_cbranch_scc1 L_y19
  s_waitcnt vmcnt(0)
L_y19:
  s_add_u32 m0, s49, 8192
  s_add_u32 s50, s39, 8192
  buffer_load_dwordx4 v222, s[12:15], s50 offen nt lds
  buffer_load_dwordx4 v223, s[12:15], s50 offen offset:1024 nt lds
  buffer_load_dwordx4 v222, s[12:15], s50 offen offset:2048 nt lds
  buffer_load_dwordx4 v223, s[12:15], s50 offen offset:3072 nt lds
  s_waitcnt lgkmcnt(3)
  v_mfma_f32_16x16x32_bf16 v[192:195], a[128:131], a[0:3], v[228:231]
  ds_read_b64_tr_b16 a[160:161], v217 offset:42240
  ds_read_b64_tr_b16 a[162:163], v217 offset:42752
  s_waitcnt lgkmcnt(4)
  v_mfma_f32_16x16x32_bf16 v[192:195], a[132:135], a[4:7], v[192:195]
  ds_read_b64_tr_b16 a[164:165], v217 offset:42256
  ds_read_b64_tr_b16 a[166:167], v217 offset:42768
  s_waitcnt lgkmcnt(5)
  v_mfma_f32_16x16x32_bf16 v[192:195], a[136:139], a[8:11], v[192:195]
  ds_read_b64_tr_b16 a[168:169], v217 offset:42272
  ds_read_b64_tr_b16 a[170:171], v217 offset:42784
  s_waitcnt lgkmcnt(6)
  v_mfma_f32_16x16x32_bf16 v[192:195], a[140:143], a[12:15], v[192:195]
  ds_read_b64_tr_b16 a[172:173], v217 offset:42288
  ds_read_b64_tr_b16 a[174:175], v217 offset:42800
  v_mfma_f32_16x16x32_bf16 v[196:199], a[144:147], a[12:15], v[228:231]
  ds_read_b64_tr_b16 a[176:177], v217 offset:42304
  ds_read_b64_tr_b16 a[178:179], v217 offset:42816
  v_mfma_f32_16x16x32_bf16 v[196:199], a[148:151], a[8:11], v[196:199]
  ds_read_b64_tr_b16 a[180:181], v217 offset:42320
  ds_read_b64_tr_b16 a[182:183], v217 offset:42832
  v_mfma_f32_16x16x32_bf16 v[196:199], a[152:155], a[4:7], v[196:199]
  v_mul_f32 v200, s29, v192
  v_mul_f32_e64 v203, s29, v195
  v_mfma_f32_16x16x32_bf16 v[196:199], a[156:159], a[0:3], v[196:199]
  v_mul_f32 v201, s29, v193
  v_mul_f32_e64 v202, s29, v194
  s_waitcnt vmcnt(4)
  s_barrier
  ds_read_b128 a[16:19], v224 offset:4096
  ds_read_b128 a[20:23], v225 offset:4096
  ds_read_b128 a[24:27], v226 offset:4096
  ds_read_b128 a[28:31], v227 offset:4096
  s_cmp_lt_u32 s58, 5
  s_cbranch_scc1 L_y20
  s_waitcnt vmcnt(0)
L_y20:
  s_add_u32 m0, s49, 12288
  s_add_u32 s50, s39, 12288
  buffer_load_dwordx4 v222, s[12:15], s50 offen nt lds
  buffer_load_dwordx4 v223, s[12:15], s50 offen offset:1024 nt lds
  buffer_load_dwordx4 v222, s[12:15], s50 offen offset:2048 nt lds
  buffer_load_dwordx4 v223, s[12:15], s50 offen offset:3072 nt lds
  s_cmp_lt_u32 s58, 6
  s_cbranch_scc1 L_y21
  s_waitcnt vmcnt(0)
L_y21:
  s_add_u32 m0, s49, 16384
  s_add_u32 s50, s39, 16384
  buffer_load_dwordx4 v222, s[12:15], s50 offen nt lds
  buffer_load_dwordx4 v223, s[12:15], s50 offen offset:1024 nt lds
  buffer_load_dwordx4 v222, s[12:15], s50 offen offset:2048 nt lds
  buffer_load_dwordx4 v223, s[12:15], s50 offen offset:3072 nt lds
  s_waitcnt lgkmcnt(3)
  v_mfma_f32_16x16x32_bf16 v[192:195], a[128:131], a[16:19], v[228:231]
  s_waitcnt lgkmcnt(2)
  v_exp_f32 v202, v202
  v_mfma_f32_16x16x32_bf16 v[192:195], a[132:135], a[20:23], v[192:195]
  s_waitcnt lgkmcnt(1)
  v_exp_f32 v200, v200
  v_mfma_f32_16x16x32_bf16 v[192:195], a[136:139], a[24:27], v[192:195]
  s_waitcnt lgkmcnt(0)
  v_mul_f32 v205, s29, v197
  v_mul_f32_e64 v206, s29, v198
  v_mfma_f32_16x16x32_bf16 v[192:195], a[140:143], a[28:31], v[192:195]
  v_mul_f32 v204, s29, v196
  v_mul_f32 v207, s29, v199
  v_mfma_f32_16x16x32_bf16 v[196:199], a[144:147], a[28:31], v[228:231]
  v_exp_f32_e64 v207, v207
  v_mfma_f32_16x16x32_bf16 v[196:199], a[148:151], a[24:27], v[196:199]
  v_exp_f32 v201, v201
  v_exp_f32 v203, v203
  v_exp_f32 v204, v204
  v_exp_f32 v205, v205
  v_exp_f32_e64 v206, v206
  v_mfma_f32_16x16x32_bf16 v[196:199], a[152:155], a[20:23], v[196:199]
  v_cvt_pk_bf16_f32 v208, v200, v201
  v_cvt_pk_bf16_f32 v209, v202, v203
  v_cvt_pk_bf16_f32 v210, v204, v205
  v_cvt_pk_bf16_f32 v211, v206, v207
  v_mfma_f32_16x16x32_bf16 v[196:199], a[156:159], a[16:19], v[196:199]
  ds_read_b64_tr_b16 a[184:185], v217 offset:42336
  ds_read_b64_tr_b16 a[186:187], v217 offset:42848
  v_mfma_f32_16x16x32_bf16 v[0:3], v[208:211], a[160:163], 0
  ds_read_b64_tr_b16 a[188:189], v217 offset:42352
  ds_read_b64_tr_b16 a[190:191], v217 offset:42864
  v_mfma_f32_16x16x32_bf16 v[4:7], v[208:211], a[164:167], 0
  ds_read_b128 a[128:131], v216 offset:16896
  ds_read_b128 a[132:135], v216 offset:16960
  v_mfma_f32_16x16x32_bf16 v[8:11], v[208:211], a[168:171], 0
  ds_read_b128 a[136:139], v216 offset:17024
  ds_read_b128 a[140:143], v216 offset:17088
  v_mfma_f32_16x16x32_bf16 v[12:15], v[208:211], a[172:175], 0
  ds_read_b128 a[144:147], v216 offset:17600
  ds_read_b128 a[148:151], v216 offset:17536
  v_mfma_f32_16x16x32_bf16 v[16:19], v[208:211], a[176:179], 0
  s_waitcnt lgkmcnt(8)
  v_mul_f32 v200, s29, v192
  v_mul_f32_e64 v202, s29, v194
  v_mfma_f32_16x16x32_bf16 v[20:23], v[208:211], a[180:183], 0
  ds_read_b128 a[152:155], v216 offset:17472
  v_mul_f32_e64 v203, s29, v195
  v_mfma_f32_16x16x32_bf16 v[24:27], v[208:211], a[184:187], 0
  ds_read_b128 a[156:159], v216 offset:17408
  v_mul_f32 v201, s29, v193
  s_waitcnt lgkmcnt(8)
  v_mfma_f32_16x16x32_bf16 v[28:31], v[208:211], a[188:191], 0
  s_waitcnt lgkmcnt(7)
  v_mul_f32 v205, s29, v197
  v_mul_f32_e64 v207, s29, v199
  v_mfma_f32_16x16x32_bf16 v[192:195], a[128:131], a[0:3], v[228:231]
  s_waitcnt lgkmcnt(6)
  v_mul_f32 v204, s29, v196
  v_mul_f32_e64 v206, s29, v198
  v_mfma_f32_16x16x32_bf16 v[192:195], a[132:135], a[4:7], v[192:195]
  s_waitcnt lgkmcnt(5)
  v_exp_f32 v207, v207
  v_mfma_f32_16x16x32_bf16 v[192:195], a[136:139], a[8:11], v[192:195]
  s_waitcnt lgkmcnt(4)
  v_exp_f32 v201, v201
  v_mfma_f32_16x16x32_bf16 v[192:195], a[140:143], a[12:15], v[192:195]
  s_waitcnt lgkmcnt(3)
  v_exp_f32 v204, v204
  v_mfma_f32_16x16x32_bf16 v[196:199], a[144:147], a[12:15], v[228:231]
  s_waitcnt lgkmcnt(2)
  v_exp_f32 v206, v206
  v_mfma_f32_16x16x32_bf16 v[196:199], a[148:151], a[8:11], v[196:199]
  s_waitcnt lgkmcnt(1)
  v_exp_f32 v200, v200
  v_exp_f32 v202, v202
  v_exp_f32 v203, v203
  v_exp_f32_e64 v205, v205
  v_mfma_f32_16x16x32_bf16 v[196:199], a[152:155], a[4:7], v[196:199]
  s_waitcnt lgkmcnt(0)
  v_cvt_pk_bf16_f32 v212, v200, v201
  v_cvt_pk_bf16_f32 v213, v202, v203
  v_cvt_pk_bf16_f32 v214, v204, v205
  v_cvt_pk_bf16_f32 v215, v206, v207
  v_mfma_f32_16x16x32_bf16 v[196:199], a[156:159], a[0:3], v[196:199]
  v_mul_f32 v202, s29, v194
  v_mul_f32_e64 v203, s29, v195
  v_mfma_f32_16x16x32_bf16 v[32:35], v[212:215], a[160:163], 0
  v_mul_f32 v200, s29, v192
  v_mul_f32 v201, s29, v193
  v_mfma_f32_16x16x32_bf16 v[36:39], v[212:215], a[164:167], 0
  ds_read_b64_tr_b16 a[160:161], v217 offset:25344
  ds_read_b64_tr_b16 a[162:163], v217 offset:25856
  v_mfma_f32_16x16x32_bf16 v[40:43], v[212:215], a[168:171], 0
  ds_read_b64_tr_b16 a[164:165], v217 offset:25360
  ds_read_b64_tr_b16 a[166:167], v217 offset:25872
  v_mfma_f32_16x16x32_bf16 v[44:47], v[212:215], a[172:175], 0
  ds_read_b64_tr_b16 a[168:169], v217 offset:25376
  v_mul_f32_e64 v206, s29, v198
  v_mfma_f32_16x16x32_bf16 v[48:51], v[212:215], a[176:179], 0
  v_mul_f32 v205, s29, v197
  v_mul_f32 v207, s29, v199
  v_mfma_f32_16x16x32_bf16 v[52:55], v[212:215], a[180:183], 0
  ds_read_b64_tr_b16 a[170:171], v217 offset:25888
  v_mul_f32_e64 v204, s29, v196
  v_mfma_f32_16x16x32_bf16 v[56:59], v[212:215], a[184:187], 0
  ds_read_b64_tr_b16 a[172:173], v217 offset:25392
  ds_read_b64_tr_b16 a[174:175], v217 offset:25904
  v_mfma_f32_16x16x32_bf16 v[60:63], v[212:215], a[188:191], 0
  v_exp_f32_e64 v206, v206
  v_smfmac_f32_16x16x64_bf16 a[192:195], a[220:223], v[208:215], v254
  ds_read_b64_tr_b16 a[176:177], v217 offset:25408
  ds_read_b64_tr_b16 a[178:179], v217 offset:25920
  v_mfma_f32_16x16x32_bf16 v[192:195], a[128:131], a[16:19], v[228:231]
  v_exp_f32_e64 v200, v200
  v_mfma_f32_16x16x32_bf16 v[192:195], a[132:135], a[20:23], v[192:195]
  v_exp_f32_e64 v203, v203
  v_mfma_f32_16x16x32_bf16 v[192:195], a[136:139], a[24:27], v[192:195]
  v_exp_f32_e64 v201, v201
  v_mfma_f32_16x16x32_bf16 v[192:195], a[140:143], a[28:31], v[192:195]
  v_exp_f32_e64 v207, v207
  v_mfma_f32_16x16x32_bf16 v[196:199], a[144:147], a[28:31], v[228:231]
  v_exp_f32_e64 v202, v202
  v_mfma_f32_16x16x32_bf16 v[196:199], a[148:151], a[24:27], v[196:199]
  v_exp_f32 v204, v204
  v_exp_f32 v205, v205
  v_mfma_f32_16x16x32_bf16 v[196:199], a[152:155], a[20:23], v[196:199]
  ds_read_b64_tr_b16 a[180:181], v217 offset:25424
  ds_read_b64_tr_b16 a[182:183], v217 offset:25936
  v_cvt_pk_bf16_f32 v208, v200, v201
  v_cvt_pk_bf16_f32 v209, v202, v203
  v_cvt_pk_bf16_f32 v210, v204, v205
  v_cvt_pk_bf16_f32 v211, v206, v207
  v_mfma_f32_16x16x32_bf16 v[196:199], a[156:159], a[16:19], v[196:199]
  ds_read_b64_tr_b16 a[184:185], v217 offset:25440
  ds_read_b64_tr_b16 a[186:187], v217 offset:25952
  s_waitcnt lgkmcnt(12)
  v_mfma_f32_16x16x32_bf16 v[0:3], v[208:211], a[160:163], v[0:3]
  ds_read_b64_tr_b16 a[188:189], v217 offset:25456
  ds_read_b64_tr_b16 a[190:191], v217 offset:25968
  s_waitcnt lgkmcnt(12)
  v_mfma_f32_16x16x32_bf16 v[4:7], v[208:211], a[164:167], v[4:7]
  s_waitcnt lgkmcnt(10)
  v_mul_f32 v200, s29, v192
  v_mul_f32_e64 v202, s29, v194
  v_mfma_f32_16x16x32_bf16 v[8:11], v[208:211], a[168:171], v[8:11]
  s_waitcnt lgkmcnt(8)
  v_mul_f32 v201, s29, v193
  v_mul_f32_e64 v203, s29, v195
  v_mfma_f32_16x16x32_bf16 v[12:15], v[208:211], a[172:175], v[12:15]
  v_mul_f32 v206, s29, v198
  v_mul_f32_e64 v207, s29, v199
  s_waitcnt vmcnt(8)
  ds_read_b128 a[32:35], v224 offset:8192
  ds_read_b128 a[36:39], v225 offset:8192
  ds_read_b128 a[40:43], v226 offset:8192
  ds_read_b128 a[44:47], v227 offset:8192
  s_cmp_lt_u32 s58, 7
  s_cbranch_scc1 L_y22
  s_waitcnt vmcnt(0)
L_y22:
  s_add_u32 m0, s49, 20480
  s_add_u32 s50, s39, 20480
  buffer_load_dwordx4 v222, s[12:15], s50 offen nt lds
  buffer_load_dwordx4 v223, s[12:15], s50 offen offset:1024 nt lds
  buffer_load_dwordx4 v222, s[12:15], s50 offen offset:2048 nt lds
  buffer_load_dwordx4 v223, s[12:15], s50 offen offset:3072 nt lds
  s_waitcnt lgkmcnt(10)
  v_mfma_f32_16x16x32_bf16 v[16:19], v[208:211], a[176:179], v[16:19]
  s_waitcnt lgkmcnt(8)
  v_mul_f32 v204, s29, v196
  v_mul_f32_e64 v205, s29, v197
  v_mfma_f32_16x16x32_bf16 v[20:23], v[208:211], a[180:183], v[20:23]
  s_waitcnt lgkmcnt(6)
  v_exp_f32 v203, v203
  v_mfma_f32_16x16x32_bf16 v[24:27], v[208:211], a[184:187], v[24:27]
  s_waitcnt lgkmcnt(4)
  v_exp_f32 v207, v207
  v_mfma_f32_16x16x32_bf16 v[28:31], v[208:211], a[188:191], v[28:31]
  s_waitcnt lgkmcnt(3)
  v_exp_f32 v201, v201
  v_mfma_f32_16x16x32_bf16 v[192:195], a[128:131], a[32:35], v[228:231]
  s_waitcnt lgkmcnt(2)
  v_exp_f32 v200, v200
  v_mfma_f32_16x16x32_bf16 v[192:195], a[132:135], a[36:39], v[192:195]
  s_waitcnt lgkmcnt(1)
  v_exp_f32 v204, v204
  v_mfma_f32_16x16x32_bf16 v[192:195], a[136:139], a[40:43], v[192:195]
  s_waitcnt lgkmcnt(0)
  v_exp_f32 v202, v202
  v_mfma_f32_16x16x32_bf16 v[192:195], a[140:143], a[44:47], v[192:195]
  v_exp_f32_e64 v206, v206
  v_mfma_f32_16x16x32_bf16 v[196:199], a[144:147], a[44:47], v[228:231]
  v_exp_f32_e64 v205, v205
  v_mfma_f32_16x16x32_bf16 v[196:199], a[148:151], a[40:43], v[196:199]
  v_cvt_pk_bf16_f32 v213, v202, v203
  v_cvt_pk_bf16_f32 v215, v206, v207
  v_mfma_f32_16x16x32_bf16 v[196:199], a[152:155], a[36:39], v[196:199]
  v_cvt_pk_bf16_f32 v212, v200, v201
  v_cvt_pk_bf16_f32 v214, v204, v205
  v_mfma_f32_16x16x32_bf16 v[196:199], a[156:159], a[32:35], v[196:199]
  v_mul_f32 v200, s29, v192
  v_mul_f32 v201, s29, v193
  v_smfmac_f32_16x16x64_bf16 a[192:195], a[220:223], v[208:215], v254
  v_mul_f32_e64 v203, s29, v195
  v_mfma_f32_16x16x32_bf16 v[32:35], v[212:215], a[160:163], v[32:35]
  v_exp_f32_e64 v200, v200
  v_mfma_f32_16x16x32_bf16 v[36:39], v[212:215], a[164:167], v[36:39]
  v_mul_f32 v202, s29, v194
  v_mul_f32 v205, s29, v197
  v_mfma_f32_16x16x32_bf16 v[40:43], v[212:215], a[168:171], v[40:43]
  v_mul_f32 v204, s29, v196
  v_mul_f32 v207, s29, v199
  v_mfma_f32_16x16x32_bf16 v[44:47], v[212:215], a[172:175], v[44:47]
  v_exp_f32 v207, v207
  s_waitcnt vmcnt(8)
  ds_read_b128 a[48:51], v224 offset:12288
  ds_read_b128 a[52:55], v225 offset:12288
  ds_read_b128 a[56:59], v226 offset:12288
  ds_read_b128 a[60:63], v227 offset:12288
  s_cmp_lt_u32 s58, 8
  s_cbranch_scc1 L_y23
  s_waitcnt vmcnt(0)
L_y23:
  s_add_u32 m0, s32, 0
  s_xor_b32 s50, 16384, s3
  buffer_load_dwordx4 v221, s[4:7], s50 offen lds
  s_add_u32 m0, s32, 32
  s_add_u32 s51, s32, s96
  buffer_load_dwordx4 v221, s[4:7], s50 offen offset:1024 lds
  s_add_u32 m0, s51, 0
  s_nop 0
  buffer_load_dwordx4 v221, s[8:11], s50 offen lds
  s_add_u32 m0, s51, 16
  s_nop 0
  buffer_load_dwordx4 v221, s[8:11], s50 offen offset:1024 lds
  v_mfma_f32_16x16x32_bf16 v[48:51], v[212:215], a[176:179], v[48:51]
  v_exp_f32_e64 v203, v203
  v_mfma_f32_16x16x32_bf16 v[52:55], v[212:215], a[180:183], v[52:55]
  v_exp_f32_e64 v204, v204
  v_mfma_f32_16x16x32_bf16 v[56:59], v[212:215], a[184:187], v[56:59]
  v_exp_f32_e64 v202, v202
  v_mfma_f32_16x16x32_bf16 v[60:63], v[212:215], a[188:191], v[60:63]
  s_waitcnt lgkmcnt(3)
  v_mul_f32 v206, s29, v198
  v_cvt_pk_bf16_f32 v209, v202, v203
  v_mfma_f32_16x16x32_bf16 v[192:195], a[128:131], a[48:51], v[228:231]
  s_waitcnt lgkmcnt(2)
  v_exp_f32 v206, v206
  v_mfma_f32_16x16x32_bf16 v[192:195], a[132:135], a[52:55], v[192:195]
  s_waitcnt lgkmcnt(1)
  v_exp_f32 v205, v205
  v_mfma_f32_16x16x32_bf16 v[192:195], a[136:139], a[56:59], v[192:195]
  s_waitcnt lgkmcnt(0)
  v_exp_f32 v201, v201
  v_mfma_f32_16x16x32_bf16 v[192:195], a[140:143], a[60:63], v[192:195]
  v_cvt_pk_bf16_f32 v210, v204, v205
  v_cvt_pk_bf16_f32 v211, v206, v207
  v_mfma_f32_16x16x32_bf16 v[196:199], a[144:147], a[60:63], v[228:231]
  ds_read_b128 a[128:131], v216 offset:33792
  v_cvt_pk_bf16_f32 v208, v200, v201
  v_mfma_f32_16x16x32_bf16 v[196:199], a[148:151], a[56:59], v[196:199]
  ds_read_b128 a[132:135], v216 offset:33856
  ds_read_b128 a[136:139], v216 offset:33920
  v_mfma_f32_16x16x32_bf16 v[196:199], a[152:155], a[52:55], v[196:199]
  ds_read_b128 a[140:143], v216 offset:33984
  ds_read_b128 a[144:147], v216 offset:34496
  v_mfma_f32_16x16x32_bf16 v[196:199], a[156:159], a[48:51], v[196:199]
  ds_read_b128 a[148:151], v216 offset:34432
  v_mul_f32_e64 v201, s29, v193
  v_mfma_f32_16x16x32_bf16 v[64:67], v[208:211], a[160:163], 0
  v_mul_f32 v200, s29, v192
  v_mul_f32 v202, s29, v194
  v_mfma_f32_16x16x32_bf16 v[68:71], v[208:211], a[164:167], 0
  ds_read_b128 a[152:155], v216 offset:34368
  v_mul_f32_e64 v203, s29, v195
  v_mfma_f32_16x16x32_bf16 v[72:75], v[208:211], a[168:171], 0
  ds_read_b128 a[156:159], v216 offset:34304
  v_mul_f32_e64 v205, s29, v197
  v_mfma_f32_16x16x32_bf16 v[76:79], v[208:211], a[172:175], 0
  v_mul_f32 v204, s29, v196
  v_mul_f32 v207, s29, v199
  v_mfma_f32_16x16x32_bf16 v[80:83], v[208:211], a[176:179], 0
  v_exp_f32_e64 v203, v203
  v_mfma_f32_16x16x32_bf16 v[84:87], v[208:211], a[180:183], 0
  v_exp_f32_e64 v201, v201
  v_mfma_f32_16x16x32_bf16 v[88:91], v[208:211], a[184:187], 0
  v_exp_f32_e64 v205, v205
  v_mfma_f32_16x16x32_bf16 v[92:95], v[208:211], a[188:191], 0
  s_waitcnt lgkmcnt(7)
  v_exp_f32 v204, v204
  v_mfma_f32_16x16x32_bf16 v[192:195], a[128:131], a[32:35], v[228:231]
  s_waitcnt lgkmcnt(6)
  v_mul_f32 v206, s29, v198
  v_cvt_pk_bf16_f32 v214, v204, v205
  v_mfma_f32_16x16x32_bf16 v[192:195], a[132:135], a[36:39], v[192:195]
  s_waitcnt lgkmcnt(5)
  v_exp_f32 v207, v207
  v_mfma_f32_16x16x32_bf16 v[192:195], a[136:139], a[40:43], v[192:195]
  s_waitcnt lgkmcnt(4)
  v_exp_f32 v202, v202
  v_mfma_f32_16x16x32_bf16 v[192:195], a[140:143], a[44:47], v[192:195]
  s_waitcnt lgkmcnt(3)
  v_exp_f32 v200, v200
  v_mfma_f32_16x16x32_bf16 v[196:199], a[144:147], a[44:47], v[228:231]
  s_waitcnt lgkmcnt(2)
  v_exp_f32 v206, v206
  v_mfma_f32_16x16x32_bf16 v[196:199], a[148:151], a[40:43], v[196:199]
  s_waitcnt lgkmcnt(1)
  v_cvt_pk_bf16_f32 v213, v202, v203
  v_cvt_pk_bf16_f32 v215, v206, v207
  v_mfma_f32_16x16x32_bf16 v[196:199], a[152:155], a[36:39], v[196:199]
  s_waitcnt lgkmcnt(0)
  v_cvt_pk_bf16_f32 v212, v200, v201
  v_mul_f32_e64 v201, s29, v193
  v_mfma_f32_16x16x32_bf16 v[196:199], a[156:159], a[32:35], v[196:199]
  v_mul_f32 v200, s29, v192
  v_mul_f32 v203, s29, v195
  v_mfma_f32_16x16x32_bf16 v[96:99], v[212:215], a[160:163], 0
  ds_read_b64_tr_b16 a[162:163], v217 offset:42752
  v_mul_f32_e64 v202, s29, v194
  v_mfma_f32_16x16x32_bf16 v[100:103], v[212:215], a[164:167], 0
  ds_read_b64_tr_b16 a[160:161], v217 offset:42240
  ds_read_b64_tr_b16 a[166:167], v217 offset:42768
  v_mfma_f32_16x16x32_bf16 v[104:107], v[212:215], a[168:171], 0
  ds_read_b64_tr_b16 a[164:165], v217 offset:42256
  v_mul_f32_e64 v205, s29, v197
  v_mfma_f32_16x16x32_bf16 v[108:111], v[212:215], a[172:175], 0
  ds_read_b64_tr_b16 a[170:171], v217 offset:42784
  v_mul_f32_e64 v206, s29, v198
  v_mfma_f32_16x16x32_bf16 v[112:115], v[212:215], a[176:179], 0
  ds_read_b64_tr_b16 a[168:169], v217 offset:42272
  v_mul_f32_e64 v204, s29, v196
  v_mfma_f32_16x16x32_bf16 v[116:119], v[212:215], a[180:183], 0
  ds_read_b64_tr_b16 a[174:175], v217 offset:42800
  v_mul_f32_e64 v207, s29, v199
  v_mfma_f32_16x16x32_bf16 v[120:123], v[212:215], a[184:187], 0
  ds_read_b64_tr_b16 a[172:173], v217 offset:42288
  ds_read_b64_tr_b16 a[178:179], v217 offset:42816
  v_mfma_f32_16x16x32_bf16 v[124:127], v[212:215], a[188:191], 0
  v_exp_f32_e64 v201, v201
  v_smfmac_f32_16x16x64_bf16 a[196:199], a[220:223], v[208:215], v254
  ds_read_b64_tr_b16 a[176:177], v217 offset:42304
  ds_read_b64_tr_b16 a[180:181], v217 offset:42320
  s_mov_b32 m0, s49
  s_nop 0
  buffer_load_dwordx4 v222, s[12:15], s40 offen nt lds
  buffer_load_dwordx4 v223, s[12:15], s40 offen offset:1024 nt lds
  buffer_load_dwordx4 v222, s[12:15], s40 offen offset:2048 nt lds
  buffer_load_dwordx4 v223, s[12:15], s40 offen offset:3072 nt lds
  v_mfma_f32_16x16x32_bf16 v[192:195], a[128:131], a[48:51], v[228:231]
  v_exp_f32_e64 v202, v202
  v_mfma_f32_16x16x32_bf16 v[192:195], a[132:135], a[52:55], v[192:195]
  v_exp_f32_e64 v205, v205
  v_mfma_f32_16x16x32_bf16 v[192:195], a[136:139], a[56:59], v[192:195]
  v_exp_f32_e64 v207, v207
  v_mfma_f32_16x16x32_bf16 v[192:195], a[140:143], a[60:63], v[192:195]
  v_exp_f32_e64 v200, v200
  v_mfma_f32_16x16x32_bf16 v[196:199], a[144:147], a[60:63], v[228:231]
  v_exp_f32_e64 v203, v203
  v_mfma_f32_16x16x32_bf16 v[196:199], a[148:151], a[56:59], v[196:199]
  s_waitcnt lgkmcnt(9)
  v_exp_f32 v204, v204
  v_exp_f32_e64 v206, v206
  v_mfma_f32_16x16x32_bf16 v[196:199], a[152:155], a[52:55], v[196:199]
  ds_read_b64_tr_b16 a[182:183], v217 offset:42832
  v_cvt_pk_bf16_f32 v208, v200, v201
  v_cvt_pk_bf16_f32 v209, v202, v203
  v_cvt_pk_bf16_f32 v210, v204, v205
  v_cvt_pk_bf16_f32 v211, v206, v207
  v_mfma_f32_16x16x32_bf16 v[196:199], a[156:159], a[48:51], v[196:199]
  ds_read_b64_tr_b16 a[184:185], v217 offset:42336
  ds_read_b64_tr_b16 a[186:187], v217 offset:42848
  v_mfma_f32_16x16x32_bf16 v[64:67], v[208:211], a[160:163], v[64:67]
  ds_read_b64_tr_b16 a[188:189], v217 offset:42352
  ds_read_b64_tr_b16 a[190:191], v217 offset:42864
  s_waitcnt lgkmcnt(12)
  v_mfma_f32_16x16x32_bf16 v[68:71], v[208:211], a[164:167], v[68:71]
  s_waitcnt lgkmcnt(10)
  v_mul_f32 v200, s29, v192
  v_mul_f32 v201, s29, v193
  v_mfma_f32_16x16x32_bf16 v[72:75], v[208:211], a[168:171], v[72:75]
  s_waitcnt lgkmcnt(8)
  v_mul_f32 v202, s29, v194
  v_mul_f32_e64 v203, s29, v195
  v_mfma_f32_16x16x32_bf16 v[76:79], v[208:211], a[172:175], v[76:79]
  s_waitcnt lgkmcnt(6)
  v_mul_f32 v205, s29, v197
  v_mul_f32 v207, s29, v199
  s_waitcnt vmcnt(12)
  ds_read_b128 a[64:67], v224 offset:16384
  ds_read_b128 a[68:71], v225 offset:16384
  ds_read_b128 a[72:75], v226 offset:16384
  ds_read_b128 a[76:79], v227 offset:16384
  v_mfma_f32_16x16x32_bf16 v[80:83], v[208:211], a[176:179], v[80:83]
  s_waitcnt lgkmcnt(8)
  v_mul_f32 v204, s29, v196
  v_mul_f32_e64 v206, s29, v198
  v_mfma_f32_16x16x32_bf16 v[84:87], v[208:211], a[180:183], v[84:87]
  s_waitcnt lgkmcnt(6)
  v_exp_f32 v205, v205
  v_mfma_f32_16x16x32_bf16 v[88:91], v[208:211], a[184:187], v[88:91]
  s_waitcnt lgkmcnt(4)
  v_exp_f32 v206, v206
  v_mfma_f32_16x16x32_bf16 v[92:95], v[208:211], a[188:191], v[92:95]
  v_exp_f32 v200, v200
  s_barrier
  s_add_u32 m0, s32, 33792
  s_xor_b32 s50, 24576, s3
  buffer_load_dwordx4 v221, s[4:7], s50 offen lds
  s_add_u32 m0, s32, 33824
  s_add_u32 s51, s32, s96
  buffer_load_dwordx4 v221, s[4:7], s50 offen offset:1024 lds
  s_add_u32 m0, s51, 33792
  s_nop 0
  buffer_load_dwordx4 v221, s[8:11], s50 offen lds
  s_add_u32 m0, s51, 33808
  s_nop 0
  buffer_load_dwordx4 v221, s[8:11], s50 offen offset:1024 lds
  s_waitcnt lgkmcnt(3)
  v_mfma_f32_16x16x32_bf16 v[192:195], a[128:131], a[64:67], v[228:231]
  s_waitcnt lgkmcnt(2)
  v_exp_f32 v202, v202
  v_mfma_f32_16x16x32_bf16 v[192:195], a[132:135], a[68:71], v[192:195]
  s_waitcnt lgkmcnt(1)
  v_exp_f32 v203, v203
  v_mfma_f32_16x16x32_bf16 v[192:195], a[136:139], a[72:75], v[192:195]
  s_waitcnt lgkmcnt(0)
  v_exp_f32 v201, v201
  v_mfma_f32_16x16x32_bf16 v[192:195], a[140:143], a[76:79], v[192:195]
  v_exp_f32_e64 v204, v204
  v_mfma_f32_16x16x32_bf16 v[196:199], a[144:147], a[76:79], v[228:231]
  v_exp_f32_e64 v207, v207
  v_mfma_f32_16x16x32_bf16 v[196:199], a[148:151], a[72:75], v[196:199]
  v_cvt_pk_bf16_f32 v212, v200, v201
  v_cvt_pk_bf16_f32 v214, v204, v205
  v_mfma_f32_16x16x32_bf16 v[196:199], a[152:155], a[68:71], v[196:199]
  v_cvt_pk_bf16_f32 v213, v202, v203
  v_cvt_pk_bf16_f32 v215, v206, v207
  v_mfma_f32_16x16x32_bf16 v[196:199], a[156:159], a[64:67], v[196:199]
  v_mul_f32 v200, s29, v192
  v_mul_f32 v201, s29, v193
  v_smfmac_f32_16x16x64_bf16 a[196:199], a[220:223], v[208:215], v254
  v_mul_f32_e64 v202, s29, v194
  v_mfma_f32_16x16x32_bf16 v[96:99], v[212:215], a[160:163], v[96:99]
  v_exp_f32_e64 v200, v200
  v_mfma_f32_16x16x32_bf16 v[100:103], v[212:215], a[164:167], v[100:103]
  v_mul_f32 v203, s29, v195
  v_mul_f32 v206, s29, v198
  v_mfma_f32_16x16x32_bf16 v[104:107], v[212:215], a[168:171], v[104:107]
  v_mul_f32 v204, s29, v196
  v_mul_f32 v207, s29, v199
  v_mfma_f32_16x16x32_bf16 v[108:111], v[212:215], a[172:175], v[108:111]
  v_exp_f32 v203, v203
  s_waitcnt vmcnt(12)
  ds_read_b128 a[80:83], v224 offset:20480
  ds_read_b128 a[84:87], v225 offset:20480
  ds_read_b128 a[88:91], v226 offset:20480
  ds_read_b128 a[92:95], v227 offset:20480
  v_mfma_f32_16x16x32_bf16 v[112:115], v[212:215], a[176:179], v[112:115]
  v_exp_f32_e64 v206, v206
  v_mfma_f32_16x16x32_bf16 v[116:119], v[212:215], a[180:183], v[116:119]
  v_exp_f32_e64 v207, v207
  v_mfma_f32_16x16x32_bf16 v[120:123], v[212:215], a[184:187], v[120:123]
  v_mul_f32_e64 v205, s29, v197
  v_cvt_pk_bf16_f32 v211, v206, v207
  v_mfma_f32_16x16x32_bf16 v[124:127], v[212:215], a[188:191], v[124:127]
  s_waitcnt lgkmcnt(3)
  v_exp_f32 v205, v205
  v_mfma_f32_16x16x32_bf16 v[192:195], a[128:131], a[80:83], v[228:231]
  s_waitcnt lgkmcnt(2)
  v_exp_f32 v204, v204
  v_mfma_f32_16x16x32_bf16 v[192:195], a[132:135], a[84:87], v[192:195]
  s_waitcnt lgkmcnt(1)
  v_exp_f32 v201, v201
  v_mfma_f32_16x16x32_bf16 v[192:195], a[136:139], a[88:91], v[192:195]
  s_waitcnt lgkmcnt(0)
  v_exp_f32 v202, v202
  v_mfma_f32_16x16x32_bf16 v[192:195], a[140:143], a[92:95], v[192:195]
  v_cvt_pk_bf16_f32 v209, v202, v203
  v_cvt_pk_bf16_f32 v210, v204, v205
  v_mfma_f32_16x16x32_bf16 v[196:199], a[144:147], a[92:95], v[228:231]
  ds_read_b128 a[128:131], v216 offset:16896
  v_cvt_pk_bf16_f32 v208, v200, v201
  v_mfma_f32_16x16x32_bf16 v[196:199], a[148:151], a[88:91], v[196:199]
  ds_read_b128 a[132:135], v216 offset:16960
  ds_read_b128 a[136:139], v216 offset:17024
  v_mfma_f32_16x16x32_bf16 v[196:199], a[152:155], a[84:87], v[196:199]
  ds_read_b128 a[140:143], v216 offset:17088
  ds_read_b128 a[144:147], v216 offset:17600
  v_mfma_f32_16x16x32_bf16 v[196:199], a[156:159], a[80:83], v[196:199]
  ds_read_b128 a[148:151], v216 offset:17536
  v_mul_f32_e64 v201, s29, v193
  v_mfma_f32_16x16x32_bf16 v[128:131], v[208:211], a[160:163], 0
  v_mul_f32 v200, s29, v192
  v_mul_f32 v202, s29, v194
  v_mfma_f32_16x16x32_bf16 v[132:135], v[208:211], a[164:167], 0
  ds_read_b128 a[152:155], v216 offset:17472
  v_mul_f32_e64 v203, s29, v195
  v_mfma_f32_16x16x32_bf16 v[136:139], v[208:211], a[168:171], 0
  ds_read_b128 a[156:159], v216 offset:17408
  v_mul_f32_e64 v206, s29, v198
  v_mfma_f32_16x16x32_bf16 v[140:143], v[208:211], a[172:175], 0
  v_mul_f32 v204, s29, v196
  v_mul_f32 v207, s29, v199
  v_mfma_f32_16x16x32_bf16 v[144:147], v[208:211], a[176:179], 0
  v_exp_f32_e64 v204, v204
  v_mfma_f32_16x16x32_bf16 v[148:151], v[208:211], a[180:183], 0
  v_exp_f32_e64 v206, v206
  v_mfma_f32_16x16x32_bf16 v[152:155], v[208:211], a[184:187], 0
  v_exp_f32_e64 v200, v200
  v_mfma_f32_16x16x32_bf16 v[156:159], v[208:211], a[188:191], 0
  s_waitcnt lgkmcnt(7)
  v_exp_f32 v202, v202
  v_mfma_f32_16x16x32_bf16 v[192:195], a[128:131], a[64:67], v[228:231]
  s_waitcnt lgkmcnt(6)
  v_exp_f32 v203, v203
  v_mfma_f32_16x16x32_bf16 v[192:195], a[132:135], a[68:71], v[192:195]
  s_waitcnt lgkmcnt(5)
  v_mul_f32 v205, s29, v197
  v_cvt_pk_bf16_f32 v213, v202, v203
  v_mfma_f32_16x16x32_bf16 v[192:195], a[136:139], a[72:75], v[192:195]
  s_waitcnt lgkmcnt(4)
  v_exp_f32 v205, v205
  v_mfma_f32_16x16x32_bf16 v[192:195], a[140:143], a[76:79], v[192:195]
  s_waitcnt lgkmcnt(3)
  v_exp_f32 v201, v201
  v_mfma_f32_16x16x32_bf16 v[196:199], a[144:147], a[76:79], v[228:231]
  s_waitcnt lgkmcnt(2)
  v_exp_f32 v207, v207
  v_mfma_f32_16x16x32_bf16 v[196:199], a[148:151], a[72:75], v[196:199]
  s_waitcnt lgkmcnt(1)
  v_cvt_pk_bf16_f32 v214, v204, v205
  v_cvt_pk_bf16_f32 v215, v206, v207
  v_mfma_f32_16x16x32_bf16 v[196:199], a[152:155], a[68:71], v[196:199]
  s_waitcnt lgkmcnt(0)
  v_cvt_pk_bf16_f32 v212, v200, v201
  v_mul_f32_e64 v203, s29, v195
  v_mfma_f32_16x16x32_bf16 v[196:199], a[156:159], a[64:67], v[196:199]
  v_mul_f32 v200, s29, v192
  v_mul_f32 v201, s29, v193
  v_mfma_f32_16x16x32_bf16 v[160:163], v[212:215], a[160:163], 0
  ds_read_b64_tr_b16 a[160:161], v217 offset:25344
  v_mul_f32_e64 v202, s29, v194
  v_mfma_f32_16x16x32_bf16 v[164:167], v[212:215], a[164:167], 0
  ds_read_b64_tr_b16 a[162:163], v217 offset:25856
  ds_read_b64_tr_b16 a[166:167], v217 offset:25872
  v_mfma_f32_16x16x32_bf16 v[168:171], v[212:215], a[168:171], 0
  ds_read_b64_tr_b16 a[164:165], v217 offset:25360
  v_mul_f32_e64 v205, s29, v197
  v_mfma_f32_16x16x32_bf16 v[172:175], v[212:215], a[172:175], 0
  ds_read_b64_tr_b16 a[170:171], v217 offset:25888
  v_mul_f32_e64 v207, s29, v199
  v_mfma_f32_16x16x32_bf16 v[176:179], v[212:215], a[176:179], 0
  ds_read_b64_tr_b16 a[168:169], v217 offset:25376
  v_mul_f32_e64 v206, s29, v198
  v_mfma_f32_16x16x32_bf16 v[180:183], v[212:215], a[180:183], 0
  ds_read_b64_tr_b16 a[174:175], v217 offset:25904
  v_mul_f32_e64 v204, s29, v196
  v_mfma_f32_16x16x32_bf16 v[184:187], v[212:215], a[184:187], 0
  ds_read_b64_tr_b16 a[172:173], v217 offset:25392
  ds_read_b64_tr_b16 a[176:177], v217 offset:25408
  v_mfma_f32_16x16x32_bf16 v[188:191], v[212:215], a[188:191], 0
  v_exp_f32_e64 v202, v202
  v_smfmac_f32_16x16x64_bf16 a[200:203], a[220:223], v[208:215], v254
  ds_read_b64_tr_b16 a[178:179], v217 offset:25920
  ds_read_b64_tr_b16 a[180:181], v217 offset:25424
  s_waitcnt vmcnt(8)
  s_barrier
  v_mfma_f32_16x16x32_bf16 v[192:195], a[128:131], a[80:83], v[228:231]
  v_exp_f32_e64 v204, v204
  v_mfma_f32_16x16x32_bf16 v[192:195], a[132:135], a[84:87], v[192:195]
  v_exp_f32_e64 v201, v201
  v_mfma_f32_16x16x32_bf16 v[192:195], a[136:139], a[88:91], v[192:195]
  v_exp_f32_e64 v206, v206
  v_mfma_f32_16x16x32_bf16 v[192:195], a[140:143], a[92:95], v[192:195]
  v_exp_f32_e64 v207, v207
  v_mfma_f32_16x16x32_bf16 v[196:199], a[144:147], a[92:95], v[228:231]
  v_exp_f32_e64 v200, v200
  v_mfma_f32_16x16x32_bf16 v[196:199], a[148:151], a[88:91], v[196:199]
  s_waitcnt lgkmcnt(9)
  v_exp_f32 v203, v203
  v_exp_f32_e64 v205, v205
  v_mfma_f32_16x16x32_bf16 v[196:199], a[152:155], a[84:87], v[196:199]
  ds_read_b64_tr_b16 a[182:183], v217 offset:25936
  v_cvt_pk_bf16_f32 v208, v200, v201
  v_cvt_pk_bf16_f32 v209, v202, v203
  v_cvt_pk_bf16_f32 v210, v204, v205
  v_cvt_pk_bf16_f32 v211, v206, v207
  v_mfma_f32_16x16x32_bf16 v[196:199], a[156:159], a[80:83], v[196:199]
  ds_read_b64_tr_b16 a[184:185], v217 offset:25440
  ds_read_b64_tr_b16 a[186:187], v217 offset:25952
  v_mfma_f32_16x16x32_bf16 v[128:131], v[208:211], a[160:163], v[128:131]
  ds_read_b64_tr_b16 a[188:189], v217 offset:25456
  ds_read_b64_tr_b16 a[190:191], v217 offset:25968
  s_waitcnt lgkmcnt(12)
  v_mfma_f32_16x16x32_bf16 v[132:135], v[208:211], a[164:167], v[132:135]
  ds_read_b128 a[128:131], v216 offset:0
  ds_read_b128 a[132:135], v216 offset:64
  s_waitcnt lgkmcnt(12)
  v_mfma_f32_16x16x32_bf16 v[136:139], v[208:211], a[168:171], v[136:139]
  ds_read_b128 a[136:139], v216 offset:128
  ds_read_b128 a[140:143], v216 offset:192
  s_waitcnt lgkmcnt(12)
  v_mfma_f32_16x16x32_bf16 v[140:143], v[208:211], a[172:175], v[140:143]
  ds_read_b128 a[144:147], v216 offset:704
  ds_read_b128 a[148:151], v216 offset:640
  s_waitcnt lgkmcnt(12)
  v_mfma_f32_16x16x32_bf16 v[144:147], v[208:211], a[176:179], v[144:147]
  ds_read_b128 a[152:155], v216 offset:576
  v_mul_f32 v202, s29, v194
  s_waitcnt lgkmcnt(11)
  v_mfma_f32_16x16x32_bf16 v[148:151], v[208:211], a[180:183], v[148:151]
  s_waitcnt lgkmcnt(9)
  v_mul_f32 v200, s29, v192
  v_mul_f32_e64 v201, s29, v193
  v_mfma_f32_16x16x32_bf16 v[152:155], v[208:211], a[184:187], v[152:155]
  ds_read_b128 a[156:159], v216 offset:512
  v_mul_f32 v203, s29, v195
  s_waitcnt lgkmcnt(8)
  v_mfma_f32_16x16x32_bf16 v[156:159], v[208:211], a[188:191], v[156:159]
  v_mul_f32 v206, s29, v198
  v_mul_f32 v207, s29, v199
  s_barrier
  s_add_u32 m0, s32, 16896
  s_xor_b32 s50, 32768, s3
  buffer_load_dwordx4 v221, s[4:7], s50 offen lds
  s_add_u32 m0, s32, 16928
  s_add_u32 s51, s32, s96
  buffer_load_dwordx4 v221, s[4:7], s50 offen offset:1024 lds
  s_add_u32 m0, s51, 16896
  s_nop 0
  buffer_load_dwordx4 v221, s[8:11], s50 offen lds
  s_add_u32 m0, s51, 16912
  s_nop 0
  buffer_load_dwordx4 v221, s[8:11], s50 offen offset:1024 lds
  s_waitcnt vmcnt(4)
  ds_read_b128 a[96:99], v224 offset:0
  ds_read_b128 a[100:103], v225 offset:0
  ds_read_b128 a[104:107], v226 offset:0
  ds_read_b128 a[108:111], v227 offset:0
  s_waitcnt lgkmcnt(11)
  v_mfma_f32_16x16x32_bf16 v[192:195], a[128:131], a[0:3], v[228:231]
  s_waitcnt lgkmcnt(10)
  v_mul_f32 v204, s29, v196
  v_mul_f32_e64 v205, s29, v197
  v_mfma_f32_16x16x32_bf16 v[192:195], a[132:135], a[4:7], v[192:195]
  s_waitcnt lgkmcnt(9)
  v_exp_f32 v204, v204
  v_mfma_f32_16x16x32_bf16 v[192:195], a[136:139], a[8:11], v[192:195]
  s_waitcnt lgkmcnt(8)
  v_exp_f32 v203, v203
  v_mfma_f32_16x16x32_bf16 v[192:195], a[140:143], a[12:15], v[192:195]
  s_waitcnt lgkmcnt(7)
  v_exp_f32 v207, v207
  v_mfma_f32_16x16x32_bf16 v[196:199], a[144:147], a[12:15], v[228:231]
  s_waitcnt lgkmcnt(6)
  v_exp_f32 v202, v202
  v_mfma_f32_16x16x32_bf16 v[196:199], a[148:151], a[8:11], v[196:199]
  s_waitcnt lgkmcnt(5)
  v_exp_f32 v200, v200
  v_exp_f32 v201, v201
  v_exp_f32 v205, v205
  v_exp_f32_e64 v206, v206
  v_mfma_f32_16x16x32_bf16 v[196:199], a[152:155], a[4:7], v[196:199]
  s_waitcnt lgkmcnt(4)
  v_cvt_pk_bf16_f32 v212, v200, v201
  v_cvt_pk_bf16_f32 v213, v202, v203
  v_cvt_pk_bf16_f32 v214, v204, v205
  v_cvt_pk_bf16_f32 v215, v206, v207
  v_mfma_f32_16x16x32_bf16 v[196:199], a[156:159], a[0:3], v[196:199]
  v_mul_f32 v201, s29, v193
  v_mul_f32_e64 v202, s29, v194
  v_mfma_f32_16x16x32_bf16 v[160:163], v[212:215], a[160:163], v[160:163]
  v_mul_f32 v200, s29, v192
  v_mul_f32 v203, s29, v195
  v_mfma_f32_16x16x32_bf16 v[164:167], v[212:215], a[164:167], v[164:167]
  v_exp_f32_e64 v201, v201
  v_mfma_f32_16x16x32_bf16 v[168:171], v[212:215], a[168:171], v[168:171]
  v_mul_f32 v205, s29, v197
  v_mul_f32 v206, s29, v198
  v_mfma_f32_16x16x32_bf16 v[172:175], v[212:215], a[172:175], v[172:175]
  ds_read_b64_tr_b16 a[172:173], v217 offset:8496
  v_mul_f32_e64 v207, s29, v199
  v_mfma_f32_16x16x32_bf16 v[176:179], v[212:215], a[176:179], v[176:179]
  v_exp_f32_e64 v202, v202
  v_mfma_f32_16x16x32_bf16 v[180:183], v[212:215], a[180:183], v[180:183]
  v_exp_f32_e64 v200, v200
  v_mfma_f32_16x16x32_bf16 v[184:187], v[212:215], a[184:187], v[184:187]
  ds_read_b64_tr_b16 a[170:171], v217 offset:8992
  ds_read_b64_tr_b16 a[174:175], v217 offset:9008
  v_mfma_f32_16x16x32_bf16 v[188:191], v[212:215], a[188:191], v[188:191]
  ds_read_b64_tr_b16 a[162:163], v217 offset:8960
  ds_read_b64_tr_b16 a[168:169], v217 offset:8480
  v_smfmac_f32_16x16x64_bf16 a[200:203], a[220:223], v[208:215], v254
  ds_read_b64_tr_b16 a[160:161], v217 offset:8448
  ds_read_b64_tr_b16 a[164:165], v217 offset:8464
  ds_read_b64_tr_b16 a[166:167], v217 offset:8976
  v_mul_f32 v204, s29, v196
  v_exp_f32_e64 v203, v203
  s_cmp_eq_u32 s28, 1
  s_cbranch_scc1 L_pG3
  s_branch L_pG0
L_startB0:
  ds_read_b128 a[128:131], v216 offset:33792
  ds_read_b128 a[132:135], v216 offset:33856
  ds_read_b128 a[136:139], v216 offset:33920
  ds_read_b128 a[140:143], v216 offset:33984
  ds_read_b128 a[144:147], v216 offset:34496
  ds_read_b128 a[148:151], v216 offset:34432
  ds_read_b128 a[152:155], v216 offset:34368
  ds_read_b128 a[156:159], v216 offset:34304
  ds_read_b128 a[0:3], v224 offset:0
  ds_read_b128 a[4:7], v225 offset:0
  ds_read_b128 a[8:11], v226 offset:0
  ds_read_b128 a[12:15], v227 offset:0
  s_cmp_lt_u32 s58, 4
  s_cbranch_scc1 L_y9
  s_waitcnt vmcnt(0)
L_y9:
  s_add_u32 m0, s49, 8192
  s_add_u32 s50, s39, 8192
  buffer_load_dwordx4 v222, s[12:15], s50 offen nt lds
  buffer_load_dwordx4 v223, s[12:15], s50 offen offset:1024 nt lds
  buffer_load_dwordx4 v222, s[12:15], s50 offen offset:2048 nt lds
  buffer_load_dwordx4 v223, s[12:15], s50 offen offset:3072 nt lds
  s_waitcnt lgkmcnt(3)
  v_mfma_f32_16x16x32_bf16 v[192:195], a[128:131], a[0:3], v[228:231]
  ds_read_b64_tr_b16 a[160:161], v217 offset:42240
  ds_read_b64_tr_b16 a[162:163], v217 offset:42752
  s_waitcnt lgkmcnt(4)
  v_mfma_f32_16x16x32_bf16 v[192:195], a[132:135], a[4:7], v[192:195]
  ds_read_b64_tr_b16 a[164:165], v217 offset:42256
  ds_read_b64_tr_b16 a[166:167], v217 offset:42768
  s_waitcnt lgkmcnt(5)
  v_mfma_f32_16x16x32_bf16 v[192:195], a[136:139], a[8:11], v[192:195]
  ds_read_b64_tr_b16 a[168:169], v217 offset:42272
  ds_read_b64_tr_b16 a[170:171], v217 offset:42784
  s_waitcnt lgkmcnt(6)
  v_mfma_f32_16x16x32_bf16 v[192:195], a[140:143], a[12:15], v[192:195]
  ds_read_b64_tr_b16 a[172:173], v217 offset:42288
  ds_read_b64_tr_b16 a[174:175], v217 offset:42800
  v_mfma_f32_16x16x32_bf16 v[196:199], a[144:147], a[12:15], v[228:231]
  ds_read_b64_tr_b16 a[176:177], v217 offset:42304
  ds_read_b64_tr_b16 a[178:179], v217 offset:42816
  v_mfma_f32_16x16x32_bf16 v[196:199], a[148:151], a[8:11], v[196:199]
  ds_read_b64_tr_b16 a[180:181], v217 offset:42320
  ds_read_b64_tr_b16 a[182:183], v217 offset:42832
  v_mfma_f32_16x16x32_bf16 v[196:199], a[152:155], a[4:7], v[196:199]
  v_mul_f32 v200, s29, v192
  v_mul_f32_e64 v203, s29, v195
  v_mfma_f32_16x16x32_bf16 v[196:199], a[156:159], a[0:3], v[196:199]
  v_mul_f32 v201, s29, v193
  v_mul_f32_e64 v202, s29, v194
  s_waitcnt vmcnt(4)
  s_barrier
  ds_read_b128 a[16:19], v224 offset:4096
  ds_read_b128 a[20:23], v225 offset:4096
  ds_read_b128 a[24:27], v226 offset:4096
  ds_read_b128 a[28:31], v227 offset:4096
  s_cmp_lt_u32 s58, 5
  s_cbranch_scc1 L_y10
  s_waitcnt vmcnt(0)
L_y10:
  s_add_u32 m0, s49, 12288
  s_add_u32 s50, s39, 12288
  buffer_load_dwordx4 v222, s[12:15], s50 offen nt lds
  buffer_load_dwordx4 v223, s[12:15], s50 offen offset:1024 nt lds
  buffer_load_dwordx4 v222, s[12:15], s50 offen offset:2048 nt lds
  buffer_load_dwordx4 v223, s[12:15], s50 offen offset:3072 nt lds
  s_cmp_lt_u32 s58, 6
  s_cbranch_scc1 L_y11
  s_waitcnt vmcnt(0)
L_y11:
  s_mov_b32 m0, s49
  s_nop 0
  buffer_load_dwordx4 v222, s[12:15], s40 offen nt lds
  buffer_load_dwordx4 v223, s[12:15], s40 offen offset:1024 nt lds
  buffer_load_dwordx4 v222, s[12:15], s40 offen offset:2048 nt lds
  buffer_load_dwordx4 v223, s[12:15], s40 offen offset:3072 nt lds
  s_waitcnt lgkmcnt(3)
  v_mfma_f32_16x16x32_bf16 v[192:195], a[128:131], a[16:19], v[228:231]
  s_waitcnt lgkmcnt(2)
  v_exp_f32 v202, v202
  v_mfma_f32_16x16x32_bf16 v[192:195], a[132:135], a[20:23], v[192:195]
  s_waitcnt lgkmcnt(1)
  v_exp_f32 v200, v200
  v_mfma_f32_16x16x32_bf16 v[192:195], a[136:139], a[24:27], v[192:195]
  s_waitcnt lgkmcnt(0)
  v_mul_f32 v205, s29, v197
  v_mul_f32_e64 v206, s29, v198
  v_mfma_f32_16x16x32_bf16 v[192:195], a[140:143], a[28:31], v[192:195]
  v_mul_f32 v204, s29, v196
  v_mul_f32 v207, s29, v199
  v_mfma_f32_16x16x32_bf16 v[196:199], a[144:147], a[28:31], v[228:231]
  v_exp_f32_e64 v206, v206
  v_mfma_f32_16x16x32_bf16 v[196:199], a[148:151], a[24:27], v[196:199]
  v_exp_f32 v201, v201
  v_exp_f32 v203, v203
  v_exp_f32 v204, v204
  v_exp_f32 v205, v205
  v_exp_f32_e64 v207, v207
  v_mfma_f32_16x16x32_bf16 v[196:199], a[152:155], a[20:23], v[196:199]
  v_cvt_pk_bf16_f32 v208, v200, v201
  v_cvt_pk_bf16_f32 v209, v202, v203
  v_cvt_pk_bf16_f32 v210, v204, v205
  v_cvt_pk_bf16_f32 v211, v206, v207
  v_mfma_f32_16x16x32_bf16 v[196:199], a[156:159], a[16:19], v[196:199]
  ds_read_b64_tr_b16 a[184:185], v217 offset:42336
  ds_read_b64_tr_b16 a[186:187], v217 offset:42848
  v_mfma_f32_16x16x32_bf16 v[0:3], v[208:211], a[160:163], 0
  ds_read_b64_tr_b16 a[188:189], v217 offset:42352
  ds_read_b64_tr_b16 a[190:191], v217 offset:42864
  v_mfma_f32_16x16x32_bf16 v[4:7], v[208:211], a[164:167], 0
  ds_read_b128 a[128:131], v216 offset:16896
  ds_read_b128 a[132:135], v216 offset:16960
  v_mfma_f32_16x16x32_bf16 v[8:11], v[208:211], a[168:171], 0
  ds_read_b128 a[136:139], v216 offset:17024
  ds_read_b128 a[140:143], v216 offset:17088
  v_mfma_f32_16x16x32_bf16 v[12:15], v[208:211], a[172:175], 0
  ds_read_b128 a[144:147], v216 offset:17600
  ds_read_b128 a[148:151], v216 offset:17536
  v_mfma_f32_16x16x32_bf16 v[16:19], v[208:211], a[176:179], 0
  s_waitcnt lgkmcnt(8)
  v_mul_f32 v202, s29, v194
  v_mul_f32_e64 v203, s29, v195
  v_mfma_f32_16x16x32_bf16 v[20:23], v[208:211], a[180:183], 0
  ds_read_b128 a[152:155], v216 offset:17472
  v_mul_f32_e64 v200, s29, v192
  v_mfma_f32_16x16x32_bf16 v[24:27], v[208:211], a[184:187], 0
  ds_read_b128 a[156:159], v216 offset:17408
  v_mul_f32 v201, s29, v193
  s_waitcnt lgkmcnt(8)
  v_mfma_f32_16x16x32_bf16 v[28:31], v[208:211], a[188:191], 0
  s_waitcnt lgkmcnt(7)
  v_mul_f32 v204, s29, v196
  v_mul_f32_e64 v206, s29, v198
  v_mfma_f32_16x16x32_bf16 v[192:195], a[128:131], a[0:3], v[228:231]
  s_waitcnt lgkmcnt(6)
  v_mul_f32 v205, s29, v197
  v_mul_f32_e64 v207, s29, v199
  v_mfma_f32_16x16x32_bf16 v[192:195], a[132:135], a[4:7], v[192:195]
  s_waitcnt lgkmcnt(5)
  v_exp_f32 v207, v207
  v_mfma_f32_16x16x32_bf16 v[192:195], a[136:139], a[8:11], v[192:195]
  s_waitcnt lgkmcnt(4)
  v_exp_f32 v202, v202
  v_mfma_f32_16x16x32_bf16 v[192:195], a[140:143], a[12:15], v[192:195]
  s_waitcnt lgkmcnt(3)
  v_exp_f32 v205, v205
  v_mfma_f32_16x16x32_bf16 v[196:199], a[144:147], a[12:15], v[228:231]
  s_waitcnt lgkmcnt(2)
  v_exp_f32 v204, v204
  v_mfma_f32_16x16x32_bf16 v[196:199], a[148:151], a[8:11], v[196:199]
  s_waitcnt lgkmcnt(1)
  v_exp_f32 v200, v200
  v_exp_f32 v201, v201
  v_exp_f32 v203, v203
  v_exp_f32_e64 v206, v206
  v_mfma_f32_16x16x32_bf16 v[196:199], a[152:155], a[4:7], v[196:199]
  s_waitcnt lgkmcnt(0)
  v_cvt_pk_bf16_f32 v212, v200, v201
  v_cvt_pk_bf16_f32 v213, v202, v203
  v_cvt_pk_bf16_f32 v214, v204, v205
  v_cvt_pk_bf16_f32 v215, v206, v207
  v_mfma_f32_16x16x32_bf16 v[196:199], a[156:159], a[0:3], v[196:199]
  v_mul_f32 v201, s29, v193
  v_mul_f32_e64 v202, s29, v194
  v_mfma_f32_16x16x32_bf16 v[32:35], v[212:215], a[160:163], 0
  v_mul_f32 v200, s29, v192
  v_mul_f32 v203, s29, v195
  v_mfma_f32_16x16x32_bf16 v[36:39], v[212:215], a[164:167], 0
  ds_read_b64_tr_b16 a[160:161], v217 offset:25344
  ds_read_b64_tr_b16 a[162:163], v217 offset:25856
  v_mfma_f32_16x16x32_bf16 v[40:43], v[212:215], a[168:171], 0
  ds_read_b64_tr_b16 a[164:165], v217 offset:25360
  ds_read_b64_tr_b16 a[166:167], v217 offset:25872
  v_mfma_f32_16x16x32_bf16 v[44:47], v[212:215], a[172:175], 0
  v_mul_f32 v204, s29, v196
  v_mul_f32 v205, s29, v197
  v_mfma_f32_16x16x32_bf16 v[48:51], v[212:215], a[176:179], 0
  ds_read_b64_tr_b16 a[168:169], v217 offset:25376
  ds_read_b64_tr_b16 a[170:171], v217 offset:25888
  v_mfma_f32_16x16x32_bf16 v[52:55], v[212:215], a[180:183], 0
  v_mul_f32 v206, s29, v198
  v_mul_f32 v207, s29, v199
  v_mfma_f32_16x16x32_bf16 v[56:59], v[212:215], a[184:187], 0
  ds_read_b64_tr_b16 a[172:173], v217 offset:25392
  ds_read_b64_tr_b16 a[174:175], v217 offset:25904
  v_mfma_f32_16x16x32_bf16 v[60:63], v[212:215], a[188:191], 0
  v_exp_f32_e64 v204, v204
  v_smfmac_f32_16x16x64_bf16 a[192:195], a[220:223], v[208:215], v254
  ds_read_b64_tr_b16 a[176:177], v217 offset:25408
  ds_read_b64_tr_b16 a[178:179], v217 offset:25920
  v_mfma_f32_16x16x32_bf16 v[192:195], a[128:131], a[16:19], v[228:231]
  v_exp_f32_e64 v203, v203
  v_mfma_f32_16x16x32_bf16 v[192:195], a[132:135], a[20:23], v[192:195]
  v_exp_f32_e64 v207, v207
  v_mfma_f32_16x16x32_bf16 v[192:195], a[136:139], a[24:27], v[192:195]
  v_exp_f32_e64 v206, v206
  v_mfma_f32_16x16x32_bf16 v[192:195], a[140:143], a[28:31], v[192:195]
  v_exp_f32_e64 v202, v202
  v_mfma_f32_16x16x32_bf16 v[196:199], a[144:147], a[28:31], v[228:231]
  v_exp_f32_e64 v205, v205
  v_mfma_f32_16x16x32_bf16 v[196:199], a[148:151], a[24:27], v[196:199]
  v_exp_f32 v200, v200
  v_exp_f32 v201, v201
  v_mfma_f32_16x16x32_bf16 v[196:199], a[152:155], a[20:23], v[196:199]
  ds_read_b64_tr_b16 a[180:181], v217 offset:25424
  ds_read_b64_tr_b16 a[182:183], v217 offset:25936
  v_cvt_pk_bf16_f32 v208, v200, v201
  v_cvt_pk_bf16_f32 v209, v202, v203
  v_cvt_pk_bf16_f32 v210, v204, v205
  v_cvt_pk_bf16_f32 v211, v206, v207
  v_mfma_f32_16x16x32_bf16 v[196:199], a[156:159], a[16:19], v[196:199]
  ds_read_b64_tr_b16 a[184:185], v217 offset:25440
  ds_read_b64_tr_b16 a[186:187], v217 offset:25952
  s_waitcnt lgkmcnt(12)
  v_mfma_f32_16x16x32_bf16 v[0:3], v[208:211], a[160:163], v[0:3]
  ds_read_b64_tr_b16 a[188:189], v217 offset:25456
  ds_read_b64_tr_b16 a[190:191], v217 offset:25968
  s_waitcnt lgkmcnt(12)
  v_mfma_f32_16x16x32_bf16 v[4:7], v[208:211], a[164:167], v[4:7]
  s_waitcnt lgkmcnt(10)
  v_mul_f32 v201, s29, v193
  v_mul_f32_e64 v203, s29, v195
  v_mfma_f32_16x16x32_bf16 v[8:11], v[208:211], a[168:171], v[8:11]
  s_waitcnt lgkmcnt(8)
  v_mul_f32 v200, s29, v192
  v_mul_f32_e64 v202, s29, v194
  v_mfma_f32_16x16x32_bf16 v[12:15], v[208:211], a[172:175], v[12:15]
  v_mul_f32 v204, s29, v196
  v_mul_f32_e64 v207, s29, v199
  s_waitcnt vmcnt(8)
  ds_read_b128 a[32:35], v224 offset:8192
  ds_read_b128 a[36:39], v225 offset:8192
  ds_read_b128 a[40:43], v226 offset:8192
  ds_read_b128 a[44:47], v227 offset:8192
  s_cmp_lt_u32 s58, 7
  s_cbranch_scc1 L_y12
  s_waitcnt vmcnt(0)
L_y12:
  s_add_u32 m0, s49, 16384
  s_add_u32 s50, s39, 16384
  buffer_load_dwordx4 v222, s[12:15], s50 offen nt lds
  buffer_load_dwordx4 v223, s[12:15], s50 offen offset:1024 nt lds
  buffer_load_dwordx4 v222, s[12:15], s50 offen offset:2048 nt lds
  buffer_load_dwordx4 v223, s[12:15], s50 offen offset:3072 nt lds
  s_waitcnt lgkmcnt(10)
  v_mfma_f32_16x16x32_bf16 v[16:19], v[208:211], a[176:179], v[16:19]
  s_waitcnt lgkmcnt(8)
  v_mul_f32 v205, s29, v197
  v_mul_f32_e64 v206, s29, v198
  v_mfma_f32_16x16x32_bf16 v[20:23], v[208:211], a[180:183], v[20:23]
  s_waitcnt lgkmcnt(6)
  v_exp_f32 v203, v203
  v_mfma_f32_16x16x32_bf16 v[24:27], v[208:211], a[184:187], v[24:27]
  s_waitcnt lgkmcnt(4)
  v_exp_f32 v202, v202
  v_mfma_f32_16x16x32_bf16 v[28:31], v[208:211], a[188:191], v[28:31]
  s_waitcnt lgkmcnt(3)
  v_exp_f32 v206, v206
  v_mfma_f32_16x16x32_bf16 v[192:195], a[128:131], a[32:35], v[228:231]
  s_waitcnt lgkmcnt(2)
  v_exp_f32 v207, v207
  v_mfma_f32_16x16x32_bf16 v[192:195], a[132:135], a[36:39], v[192:195]
  s_waitcnt lgkmcnt(1)
  v_exp_f32 v205, v205
  v_mfma_f32_16x16x32_bf16 v[192:195], a[136:139], a[40:43], v[192:195]
  s_waitcnt lgkmcnt(0)
  v_exp_f32 v201, v201
  v_mfma_f32_16x16x32_bf16 v[192:195], a[140:143], a[44:47], v[192:195]
  v_exp_f32_e64 v200, v200
  v_mfma_f32_16x16x32_bf16 v[196:199], a[144:147], a[44:47], v[228:231]
  v_exp_f32_e64 v204, v204
  v_mfma_f32_16x16x32_bf16 v[196:199], a[148:151], a[40:43], v[196:199]
  v_cvt_pk_bf16_f32 v213, v202, v203
  v_cvt_pk_bf16_f32 v214, v204, v205
  v_mfma_f32_16x16x32_bf16 v[196:199], a[152:155], a[36:39], v[196:199]
  v_cvt_pk_bf16_f32 v212, v200, v201
  v_cvt_pk_bf16_f32 v215, v206, v207
  v_mfma_f32_16x16x32_bf16 v[196:199], a[156:159], a[32:35], v[196:199]
  v_mul_f32 v200, s29, v192
  v_mul_f32 v203, s29, v195
  v_smfmac_f32_16x16x64_bf16 a[192:195], a[220:223], v[208:215], v254
  v_mul_f32_e64 v202, s29, v194
  v_mfma_f32_16x16x32_bf16 v[32:35], v[212:215], a[160:163], v[32:35]
  v_exp_f32_e64 v200, v200
  v_mfma_f32_16x16x32_bf16 v[36:39], v[212:215], a[164:167], v[36:39]
  v_mul_f32 v201, s29, v193
  v_mul_f32 v207, s29, v199
  v_mfma_f32_16x16x32_bf16 v[40:43], v[212:215], a[168:171], v[40:43]
  v_mul_f32 v205, s29, v197
  v_mul_f32 v206, s29, v198
  v_mfma_f32_16x16x32_bf16 v[44:47], v[212:215], a[172:175], v[44:47]
  v_exp_f32_e64 v205, v205
  s_waitcnt vmcnt(8)
  ds_read_b128 a[48:51], v224 offset:12288
  ds_read_b128 a[52:55], v225 offset:12288
  ds_read_b128 a[56:59], v226 offset:12288
  ds_read_b128 a[60:63], v227 offset:12288
  s_cmp_lt_u32 s58, 8
  s_cbranch_scc1 L_y13
  s_waitcnt vmcnt(0)
L_y13:
  s_add_u32 m0, s49, 20480
  s_add_u32 s50, s39, 20480
  buffer_load_dwordx4 v222, s[12:15], s50 offen nt lds
  buffer_load_dwordx4 v223, s[12:15], s50 offen offset:1024 nt lds
  buffer_load_dwordx4 v222, s[12:15], s50 offen offset:2048 nt lds
  buffer_load_dwordx4 v223, s[12:15], s50 offen offset:3072 nt lds
  v_mfma_f32_16x16x32_bf16 v[48:51], v[212:215], a[176:179], v[48:51]
  v_exp_f32_e64 v202, v202
  v_mfma_f32_16x16x32_bf16 v[52:55], v[212:215], a[180:183], v[52:55]
  v_exp_f32_e64 v201, v201
  v_mfma_f32_16x16x32_bf16 v[56:59], v[212:215], a[184:187], v[56:59]
  v_mul_f32_e64 v204, s29, v196
  v_cvt_pk_bf16_f32 v208, v200, v201
  v_mfma_f32_16x16x32_bf16 v[60:63], v[212:215], a[188:191], v[60:63]
  s_waitcnt lgkmcnt(3)
  v_exp_f32 v204, v204
  v_mfma_f32_16x16x32_bf16 v[192:195], a[128:131], a[48:51], v[228:231]
  s_waitcnt lgkmcnt(2)
  v_exp_f32 v203, v203
  v_mfma_f32_16x16x32_bf16 v[192:195], a[132:135], a[52:55], v[192:195]
  s_waitcnt lgkmcnt(1)
  v_exp_f32 v207, v207
  v_mfma_f32_16x16x32_bf16 v[192:195], a[136:139], a[56:59], v[192:195]
  s_waitcnt lgkmcnt(0)
  v_exp_f32 v206, v206
  v_mfma_f32_16x16x32_bf16 v[192:195], a[140:143], a[60:63], v[192:195]
  v_cvt_pk_bf16_f32 v209, v202, v203
  v_cvt_pk_bf16_f32 v210, v204, v205
  v_mfma_f32_16x16x32_bf16 v[196:199], a[144:147], a[60:63], v[228:231]
  ds_read_b128 a[128:131], v216 offset:33792
  v_cvt_pk_bf16_f32 v211, v206, v207
  v_mfma_f32_16x16x32_bf16 v[196:199], a[148:151], a[56:59], v[196:199]
  ds_read_b128 a[132:135], v216 offset:33856
  ds_read_b128 a[136:139], v216 offset:33920
  v_mfma_f32_16x16x32_bf16 v[196:199], a[152:155], a[52:55], v[196:199]
  ds_read_b128 a[140:143], v216 offset:33984
  ds_read_b128 a[144:147], v216 offset:34496
  v_mfma_f32_16x16x32_bf16 v[196:199], a[156:159], a[48:51], v[196:199]
  ds_read_b128 a[148:151], v216 offset:34432
  v_mul_f32_e64 v203, s29, v195
  v_mfma_f32_16x16x32_bf16 v[64:67], v[208:211], a[160:163], 0
  ds_read_b128 a[152:155], v216 offset:34368
  v_mul_f32_e64 v200, s29, v192
  v_mfma_f32_16x16x32_bf16 v[68:71], v[208:211], a[164:167], 0
  v_mul_f32 v201, s29, v193
  v_mul_f32 v202, s29, v194
  v_mfma_f32_16x16x32_bf16 v[72:75], v[208:211], a[168:171], 0
  ds_read_b128 a[156:159], v216 offset:34304
  v_mul_f32_e64 v206, s29, v198
  v_mfma_f32_16x16x32_bf16 v[76:79], v[208:211], a[172:175], 0
  v_mul_f32 v205, s29, v197
  v_mul_f32 v207, s29, v199
  v_mfma_f32_16x16x32_bf16 v[80:83], v[208:211], a[176:179], 0
  v_exp_f32_e64 v202, v202
  v_mfma_f32_16x16x32_bf16 v[84:87], v[208:211], a[180:183], 0
  v_exp_f32_e64 v203, v203
  v_mfma_f32_16x16x32_bf16 v[88:91], v[208:211], a[184:187], 0
  v_mul_f32_e64 v204, s29, v196
  v_cvt_pk_bf16_f32 v213, v202, v203
  v_mfma_f32_16x16x32_bf16 v[92:95], v[208:211], a[188:191], 0
  s_waitcnt lgkmcnt(7)
  v_exp_f32 v205, v205
  v_mfma_f32_16x16x32_bf16 v[192:195], a[128:131], a[32:35], v[228:231]
  s_waitcnt lgkmcnt(6)
  v_exp_f32 v200, v200
  v_mfma_f32_16x16x32_bf16 v[192:195], a[132:135], a[36:39], v[192:195]
  s_waitcnt lgkmcnt(5)
  v_exp_f32 v204, v204
  v_mfma_f32_16x16x32_bf16 v[192:195], a[136:139], a[40:43], v[192:195]
  s_waitcnt lgkmcnt(4)
  v_exp_f32 v206, v206
  v_mfma_f32_16x16x32_bf16 v[192:195], a[140:143], a[44:47], v[192:195]
  s_waitcnt lgkmcnt(3)
  v_exp_f32 v201, v201
  v_mfma_f32_16x16x32_bf16 v[196:199], a[144:147], a[44:47], v[228:231]
  s_waitcnt lgkmcnt(2)
  v_exp_f32 v207, v207
  v_mfma_f32_16x16x32_bf16 v[196:199], a[148:151], a[40:43], v[196:199]
  s_waitcnt lgkmcnt(1)
  v_cvt_pk_bf16_f32 v214, v204, v205
  v_cvt_pk_bf16_f32 v215, v206, v207
  v_mfma_f32_16x16x32_bf16 v[196:199], a[152:155], a[36:39], v[196:199]
  s_waitcnt lgkmcnt(0)
  v_cvt_pk_bf16_f32 v212, v200, v201
  v_mul_f32_e64 v203, s29, v195
  v_mfma_f32_16x16x32_bf16 v[196:199], a[156:159], a[32:35], v[196:199]
  v_mul_f32 v200, s29, v192
  v_mul_f32 v202, s29, v194
  v_mfma_f32_16x16x32_bf16 v[96:99], v[212:215], a[160:163], 0
  ds_read_b64_tr_b16 a[160:161], v217 offset:42240
  v_mul_f32_e64 v201, s29, v193
  v_mfma_f32_16x16x32_bf16 v[100:103], v[212:215], a[164:167], 0
  ds_read_b64_tr_b16 a[162:163], v217 offset:42752
  ds_read_b64_tr_b16 a[166:167], v217 offset:42768
  v_mfma_f32_16x16x32_bf16 v[104:107], v[212:215], a[168:171], 0
  ds_read_b64_tr_b16 a[164:165], v217 offset:42256
  v_mul_f32_e64 v206, s29, v198
  v_mfma_f32_16x16x32_bf16 v[108:111], v[212:215], a[172:175], 0
  ds_read_b64_tr_b16 a[168:169], v217 offset:42272
  ds_read_b64_tr_b16 a[170:171], v217 offset:42784
  v_mfma_f32_16x16x32_bf16 v[112:115], v[212:215], a[176:179], 0
  v_mul_f32 v204, s29, v196
  v_mul_f32 v207, s29, v199
  v_mfma_f32_16x16x32_bf16 v[116:119], v[212:215], a[180:183], 0
  ds_read_b64_tr_b16 a[174:175], v217 offset:42800
  v_mul_f32_e64 v205, s29, v197
  v_mfma_f32_16x16x32_bf16 v[120:123], v[212:215], a[184:187], 0
  ds_read_b64_tr_b16 a[172:173], v217 offset:42288
  ds_read_b64_tr_b16 a[176:177], v217 offset:42304
  v_mfma_f32_16x16x32_bf16 v[124:127], v[212:215], a[188:191], 0
  v_exp_f32_e64 v202, v202
  v_smfmac_f32_16x16x64_bf16 a[196:199], a[220:223], v[208:215], v254
  ds_read_b64_tr_b16 a[178:179], v217 offset:42816
  ds_read_b64_tr_b16 a[182:183], v217 offset:42832
  s_add_u32 m0, s32, 0
  s_xor_b32 s50, 16384, s3
  buffer_load_dwordx4 v221, s[4:7], s50 offen lds
  s_add_u32 m0, s32, 32
  s_add_u32 s51, s32, s96
  buffer_load_dwordx4 v221, s[4:7], s50 offen offset:1024 lds
  s_add_u32 m0, s51, 0
  s_nop 0
  buffer_load_dwordx4 v221, s[8:11], s50 offen lds
  s_add_u32 m0, s51, 16
  s_nop 0
  buffer_load_dwordx4 v221, s[8:11], s50 offen offset:1024 lds
  v_mfma_f32_16x16x32_bf16 v[192:195], a[128:131], a[48:51], v[228:231]
  v_exp_f32 v207, v207
  v_mfma_f32_16x16x32_bf16 v[192:195], a[132:135], a[52:55], v[192:195]
  v_exp_f32_e64 v205, v205
  v_mfma_f32_16x16x32_bf16 v[192:195], a[136:139], a[56:59], v[192:195]
  v_exp_f32_e64 v204, v204
  v_mfma_f32_16x16x32_bf16 v[192:195], a[140:143], a[60:63], v[192:195]
  v_exp_f32_e64 v203, v203
  v_mfma_f32_16x16x32_bf16 v[196:199], a[144:147], a[60:63], v[228:231]
  v_exp_f32_e64 v206, v206
  v_mfma_f32_16x16x32_bf16 v[196:199], a[148:151], a[56:59], v[196:199]
  s_waitcnt lgkmcnt(9)
  v_exp_f32 v200, v200
  v_exp_f32_e64 v201, v201
  v_mfma_f32_16x16x32_bf16 v[196:199], a[152:155], a[52:55], v[196:199]
  ds_read_b64_tr_b16 a[180:181], v217 offset:42320
  v_cvt_pk_bf16_f32 v208, v200, v201
  v_cvt_pk_bf16_f32 v209, v202, v203
  v_cvt_pk_bf16_f32 v210, v204, v205
  v_cvt_pk_bf16_f32 v211, v206, v207
  v_mfma_f32_16x16x32_bf16 v[196:199], a[156:159], a[48:51], v[196:199]
  ds_read_b64_tr_b16 a[184:185], v217 offset:42336
  ds_read_b64_tr_b16 a[186:187], v217 offset:42848
  v_mfma_f32_16x16x32_bf16 v[64:67], v[208:211], a[160:163], v[64:67]
  ds_read_b64_tr_b16 a[188:189], v217 offset:42352
  ds_read_b64_tr_b16 a[190:191], v217 offset:42864
  s_waitcnt lgkmcnt(12)
  v_mfma_f32_16x16x32_bf16 v[68:71], v[208:211], a[164:167], v[68:71]
  s_waitcnt lgkmcnt(10)
  v_mul_f32 v201, s29, v193
  v_mul_f32 v203, s29, v195
  v_mfma_f32_16x16x32_bf16 v[72:75], v[208:211], a[168:171], v[72:75]
  s_waitcnt lgkmcnt(8)
  v_mul_f32 v200, s29, v192
  v_mul_f32_e64 v202, s29, v194
  v_mfma_f32_16x16x32_bf16 v[76:79], v[208:211], a[172:175], v[76:79]
  s_waitcnt lgkmcnt(6)
  v_mul_f32 v204, s29, v196
  v_mul_f32 v205, s29, v197
  s_waitcnt vmcnt(12)
  ds_read_b128 a[96:99], v224 offset:0
  ds_read_b128 a[100:103], v225 offset:0
  ds_read_b128 a[104:107], v226 offset:0
  ds_read_b128 a[108:111], v227 offset:0
  v_mfma_f32_16x16x32_bf16 v[80:83], v[208:211], a[176:179], v[80:83]
  s_waitcnt lgkmcnt(8)
  v_mul_f32 v206, s29, v198
  v_mul_f32_e64 v207, s29, v199
  v_mfma_f32_16x16x32_bf16 v[84:87], v[208:211], a[180:183], v[84:87]
  s_waitcnt lgkmcnt(6)
  v_exp_f32 v207, v207
  v_mfma_f32_16x16x32_bf16 v[88:91], v[208:211], a[184:187], v[88:91]
  s_waitcnt lgkmcnt(4)
  v_exp_f32 v203, v203
  v_mfma_f32_16x16x32_bf16 v[92:95], v[208:211], a[188:191], v[92:95]
  v_exp_f32 v205, v205
  s_barrier
  s_add_u32 m0, s32, 33792
  s_xor_b32 s50, 24576, s3
  buffer_load_dwordx4 v221, s[4:7], s50 offen lds
  s_add_u32 m0, s32, 33824
  s_add_u32 s51, s32, s96
  buffer_load_dwordx4 v221, s[4:7], s50 offen offset:1024 lds
  s_add_u32 m0, s51, 33792
  s_nop 0
  buffer_load_dwordx4 v221, s[8:11], s50 offen lds
  s_add_u32 m0, s51, 33808
  s_nop 0
  buffer_load_dwordx4 v221, s[8:11], s50 offen offset:1024 lds
  s_waitcnt lgkmcnt(3)
  v_mfma_f32_16x16x32_bf16 v[192:195], a[128:131], a[96:99], v[228:231]
  s_waitcnt lgkmcnt(2)
  v_exp_f32 v204, v204
  v_mfma_f32_16x16x32_bf16 v[192:195], a[132:135], a[100:103], v[192:195]
  s_waitcnt lgkmcnt(1)
  v_exp_f32 v202, v202
  v_mfma_f32_16x16x32_bf16 v[192:195], a[136:139], a[104:107], v[192:195]
  s_waitcnt lgkmcnt(0)
  v_exp_f32 v200, v200
  v_mfma_f32_16x16x32_bf16 v[192:195], a[140:143], a[108:111], v[192:195]
  v_exp_f32_e64 v201, v201
  v_mfma_f32_16x16x32_bf16 v[196:199], a[144:147], a[108:111], v[228:231]
  v_exp_f32_e64 v206, v206
  v_mfma_f32_16x16x32_bf16 v[196:199], a[148:151], a[104:107], v[196:199]
  v_cvt_pk_bf16_f32 v213, v202, v203
  v_cvt_pk_bf16_f32 v215, v206, v207
  v_mfma_f32_16x16x32_bf16 v[196:199], a[152:155], a[100:103], v[196:199]
  v_cvt_pk_bf16_f32 v212, v200, v201
  v_cvt_pk_bf16_f32 v214, v204, v205
  v_mfma_f32_16x16x32_bf16 v[196:199], a[156:159], a[96:99], v[196:199]
  v_mul_f32 v200, s29, v192
  v_mul_f32 v202, s29, v194
  v_smfmac_f32_16x16x64_bf16 a[196:199], a[220:223], v[208:215], v254
  v_mul_f32_e64 v201, s29, v193
  v_mfma_f32_16x16x32_bf16 v[96:99], v[212:215], a[160:163], v[96:99]
  v_exp_f32_e64 v202, v202
  v_mfma_f32_16x16x32_bf16 v[100:103], v[212:215], a[164:167], v[100:103]
  v_mul_f32 v203, s29, v195
  v_mul_f32 v205, s29, v197
  v_mfma_f32_16x16x32_bf16 v[104:107], v[212:215], a[168:171], v[104:107]
  v_mul_f32 v206, s29, v198
  v_mul_f32 v207, s29, v199
  v_mfma_f32_16x16x32_bf16 v[108:111], v[212:215], a[172:175], v[108:111]
  v_exp_f32 v207, v207
  s_waitcnt vmcnt(12)
  ds_read_b128 a[64:67], v224 offset:16384
  ds_read_b128 a[68:71], v225 offset:16384
  ds_read_b128 a[72:75], v226 offset:16384
  ds_read_b128 a[76:79], v227 offset:16384
  v_mfma_f32_16x16x32_bf16 v[112:115], v[212:215], a[176:179], v[112:115]
  v_exp_f32_e64 v205, v205
  v_mfma_f32_16x16x32_bf16 v[116:119], v[212:215], a[180:183], v[116:119]
  v_exp_f32_e64 v206, v206
  v_mfma_f32_16x16x32_bf16 v[120:123], v[212:215], a[184:187], v[120:123]
  v_mul_f32_e64 v204, s29, v196
  v_cvt_pk_bf16_f32 v211, v206, v207
  v_mfma_f32_16x16x32_bf16 v[124:127], v[212:215], a[188:191], v[124:127]
  s_waitcnt lgkmcnt(3)
  v_exp_f32 v204, v204
  v_mfma_f32_16x16x32_bf16 v[192:195], a[128:131], a[64:67], v[228:231]
  s_waitcnt lgkmcnt(2)
  v_exp_f32 v200, v200
  v_mfma_f32_16x16x32_bf16 v[192:195], a[132:135], a[68:71], v[192:195]
  s_waitcnt lgkmcnt(1)
  v_exp_f32 v201, v201
  v_mfma_f32_16x16x32_bf16 v[192:195], a[136:139], a[72:75], v[192:195]
  s_waitcnt lgkmcnt(0)
  v_exp_f32 v203, v203
  v_mfma_f32_16x16x32_bf16 v[192:195], a[140:143], a[76:79], v[192:195]
  v_cvt_pk_bf16_f32 v208, v200, v201
  v_cvt_pk_bf16_f32 v209, v202, v203
  v_mfma_f32_16x16x32_bf16 v[196:199], a[144:147], a[76:79], v[228:231]
  v_cvt_pk_bf16_f32 v210, v204, v205
  v_mfma_f32_16x16x32_bf16 v[196:199], a[148:151], a[72:75], v[196:199]
  v_mfma_f32_16x16x32_bf16 v[196:199], a[152:155], a[68:71], v[196:199]
  v_mul_f32 v202, s29, v194
  v_mul_f32 v203, s29, v195
  v_mfma_f32_16x16x32_bf16 v[196:199], a[156:159], a[64:67], v[196:199]
  v_mul_f32 v200, s29, v192
  v_mul_f32 v201, s29, v193
  v_mfma_f32_16x16x32_bf16 a[204:207], a[220:223], v[208:211], a[204:207]
  v_exp_f32_e64 v202, v202
  v_mfma_f32_16x16x32_bf16 a[224:227], v[208:211], a[160:163], a[224:227]
  v_exp_f32_e64 v201, v201
  v_mfma_f32_16x16x32_bf16 a[228:231], v[208:211], a[164:167], a[228:231]
  v_mul_f32 v204, s29, v196
  v_mul_f32 v205, s29, v197
  v_mfma_f32_16x16x32_bf16 a[232:235], v[208:211], a[168:171], a[232:235]
  v_mul_f32 v206, s29, v198
  v_mul_f32 v207, s29, v199
  v_mfma_f32_16x16x32_bf16 a[236:239], v[208:211], a[172:175], a[236:239]
  v_exp_f32 v204, v204
  s_waitcnt vmcnt(8)
  ds_read_b128 a[80:83], v224 offset:20480
  ds_read_b128 a[84:87], v225 offset:20480
  ds_read_b128 a[88:91], v226 offset:20480
  ds_read_b128 a[92:95], v227 offset:20480
  v_mfma_f32_16x16x32_bf16 a[240:243], v[208:211], a[176:179], a[240:243]
  v_exp_f32_e64 v200, v200
  v_mfma_f32_16x16x32_bf16 a[244:247], v[208:211], a[180:183], a[244:247]
  v_exp_f32_e64 v207, v207
  v_mfma_f32_16x16x32_bf16 a[248:251], v[208:211], a[184:187], a[248:251]
  v_exp_f32_e64 v203, v203
  v_mfma_f32_16x16x32_bf16 a[252:255], v[208:211], a[188:191], a[252:255]
  s_waitcnt lgkmcnt(3)
  v_exp_f32 v206, v206
  v_mfma_f32_16x16x32_bf16 v[192:195], a[128:131], a[80:83], v[228:231]
  s_waitcnt lgkmcnt(2)
  v_exp_f32 v205, v205
  v_mfma_f32_16x16x32_bf16 v[192:195], a[132:135], a[84:87], v[192:195]
  s_waitcnt lgkmcnt(1)
  v_cvt_pk_bf16_f32 v208, v200, v201
  v_cvt_pk_bf16_f32 v211, v206, v207
  v_mfma_f32_16x16x32_bf16 v[192:195], a[136:139], a[88:91], v[192:195]
  s_waitcnt lgkmcnt(0)
  v_cvt_pk_bf16_f32 v209, v202, v203
  v_cvt_pk_bf16_f32 v210, v204, v205
  v_mfma_f32_16x16x32_bf16 v[192:195], a[140:143], a[92:95], v[192:195]
  ds_read_b128 a[128:131], v216 offset:16896
  ds_read_b128 a[132:135], v216 offset:16960
  v_mfma_f32_16x16x32_bf16 v[196:199], a[144:147], a[92:95], v[228:231]
  ds_read_b128 a[136:139], v216 offset:17024
  ds_read_b128 a[140:143], v216 offset:17088
  v_mfma_f32_16x16x32_bf16 v[196:199], a[148:151], a[88:91], v[196:199]
  ds_read_b128 a[144:147], v216 offset:17600
  ds_read_b128 a[148:151], v216 offset:17536
  v_mfma_f32_16x16x32_bf16 v[196:199], a[152:155], a[84:87], v[196:199]
  ds_read_b128 a[152:155], v216 offset:17472
  v_mul_f32_e64 v201, s29, v193
  v_mfma_f32_16x16x32_bf16 v[196:199], a[156:159], a[80:83], v[196:199]
  v_mul_f32 v202, s29, v194
  v_mul_f32 v203, s29, v195
  v_mfma_f32_16x16x32_bf16 v[128:131], v[208:211], a[160:163], 0
  ds_read_b128 a[156:159], v216 offset:17408
  v_mul_f32_e64 v200, s29, v192
  v_mfma_f32_16x16x32_bf16 v[132:135], v[208:211], a[164:167], 0
  v_exp_f32_e64 v202, v202
  v_mfma_f32_16x16x32_bf16 v[136:139], v[208:211], a[168:171], 0
  v_mul_f32 v205, s29, v197
  v_mul_f32 v206, s29, v198
  v_mfma_f32_16x16x32_bf16 v[140:143], v[208:211], a[172:175], 0
  v_mul_f32 v204, s29, v196
  v_mul_f32 v207, s29, v199
  v_mfma_f32_16x16x32_bf16 v[144:147], v[208:211], a[176:179], 0
  v_exp_f32_e64 v206, v206
  v_mfma_f32_16x16x32_bf16 v[148:151], v[208:211], a[180:183], 0
  v_exp_f32_e64 v204, v204
  v_mfma_f32_16x16x32_bf16 v[152:155], v[208:211], a[184:187], 0
  v_exp_f32_e64 v200, v200
  v_mfma_f32_16x16x32_bf16 v[156:159], v[208:211], a[188:191], 0
  s_waitcnt lgkmcnt(7)
  v_exp_f32 v201, v201
  v_mfma_f32_16x16x32_bf16 v[192:195], a[128:131], a[64:67], v[228:231]
  s_waitcnt lgkmcnt(6)
  v_exp_f32 v203, v203
  v_mfma_f32_16x16x32_bf16 v[192:195], a[132:135], a[68:71], v[192:195]
  s_waitcnt lgkmcnt(5)
  v_exp_f32 v205, v205
  v_mfma_f32_16x16x32_bf16 v[192:195], a[136:139], a[72:75], v[192:195]
  s_waitcnt lgkmcnt(4)
  v_exp_f32 v207, v207
  v_mfma_f32_16x16x32_bf16 v[192:195], a[140:143], a[76:79], v[192:195]
  s_waitcnt lgkmcnt(3)
  v_cvt_pk_bf16_f32 v214, v204, v205
  v_cvt_pk_bf16_f32 v215, v206, v207
  v_mfma_f32_16x16x32_bf16 v[196:199], a[144:147], a[76:79], v[228:231]
  s_waitcnt lgkmcnt(2)
  v_cvt_pk_bf16_f32 v212, v200, v201
  v_cvt_pk_bf16_f32 v213, v202, v203
  v_mfma_f32_16x16x32_bf16 v[196:199], a[148:151], a[72:75], v[196:199]
  s_waitcnt lgkmcnt(1)
  v_mfma_f32_16x16x32_bf16 v[196:199], a[152:155], a[68:71], v[196:199]
  s_waitcnt lgkmcnt(0)
  v_mul_f32 v200, s29, v192
  v_mul_f32 v203, s29, v195
  v_mfma_f32_16x16x32_bf16 v[196:199], a[156:159], a[64:67], v[196:199]
  v_mul_f32 v201, s29, v193
  v_mul_f32 v202, s29, v194
  v_mfma_f32_16x16x32_bf16 v[160:163], v[212:215], a[160:163], 0
  ds_read_b64_tr_b16 a[160:161], v217 offset:25344
  ds_read_b64_tr_b16 a[162:163], v217 offset:25856
  v_mfma_f32_16x16x32_bf16 v[164:167], v[212:215], a[164:167], 0
  ds_read_b64_tr_b16 a[164:165], v217 offset:25360
  ds_read_b64_tr_b16 a[166:167], v217 offset:25872
  v_mfma_f32_16x16x32_bf16 v[168:171], v[212:215], a[168:171], 0
  ds_read_b64_tr_b16 a[170:171], v217 offset:25888
  v_mul_f32_e64 v206, s29, v198
  v_mfma_f32_16x16x32_bf16 v[172:175], v[212:215], a[172:175], 0
  v_mul_f32 v204, s29, v196
  v_mul_f32 v207, s29, v199
  v_mfma_f32_16x16x32_bf16 v[176:179], v[212:215], a[176:179], 0
  ds_read_b64_tr_b16 a[168:169], v217 offset:25376
  v_mul_f32_e64 v205, s29, v197
  v_mfma_f32_16x16x32_bf16 v[180:183], v[212:215], a[180:183], 0
  ds_read_b64_tr_b16 a[172:173], v217 offset:25392
  ds_read_b64_tr_b16 a[174:175], v217 offset:25904
  v_mfma_f32_16x16x32_bf16 v[184:187], v[212:215], a[184:187], 0
  v_exp_f32_e64 v206, v206
  v_mfma_f32_16x16x32_bf16 v[188:191], v[212:215], a[188:191], 0
  v_exp_f32_e64 v203, v203
  v_smfmac_f32_16x16x64_bf16 a[200:203], a[220:223], v[208:215], v254
  ds_read_b64_tr_b16 a[176:177], v217 offset:25408
  ds_read_b64_tr_b16 a[178:179], v217 offset:25920
  s_waitcnt vmcnt(4)
  s_barrier
  v_mfma_f32_16x16x32_bf16 v[192:195], a[128:131], a[80:83], v[228:231]
  v_exp_f32_e64 v204, v204
  v_mfma_f32_16x16x32_bf16 v[192:195], a[132:135], a[84:87], v[192:195]
  v_exp_f32_e64 v201, v201
  v_mfma_f32_16x16x32_bf16 v[192:195], a[136:139], a[88:91], v[192:195]
  v_exp_f32_e64 v205, v205
  v_mfma_f32_16x16x32_bf16 v[192:195], a[140:143], a[92:95], v[192:195]
  v_exp_f32_e64 v202, v202
  v_mfma_f32_16x16x32_bf16 v[196:199], a[144:147], a[92:95], v[228:231]
  v_exp_f32_e64 v207, v207
  v_mfma_f32_16x16x32_bf16 v[196:199], a[148:151], a[88:91], v[196:199]
  s_waitcnt lgkmcnt(8)
  v_exp_f32 v200, v200
  v_mfma_f32_16x16x32_bf16 v[196:199], a[152:155], a[84:87], v[196:199]
  ds_read_b64_tr_b16 a[180:181], v217 offset:25424
  ds_read_b64_tr_b16 a[182:183], v217 offset:25936
  v_cvt_pk_bf16_f32 v208, v200, v201
  v_cvt_pk_bf16_f32 v209, v202, v203
  v_cvt_pk_bf16_f32 v210, v204, v205
  v_cvt_pk_bf16_f32 v211, v206, v207
  v_mfma_f32_16x16x32_bf16 v[196:199], a[156:159], a[80:83], v[196:199]
  ds_read_b64_tr_b16 a[184:185], v217 offset:25440
  ds_read_b64_tr_b16 a[186:187], v217 offset:25952
  v_mfma_f32_16x16x32_bf16 v[128:131], v[208:211], a[160:163], v[128:131]
  ds_read_b64_tr_b16 a[188:189], v217 offset:25456
  ds_read_b64_tr_b16 a[190:191], v217 offset:25968
  s_waitcnt lgkmcnt(12)
  v_mfma_f32_16x16x32_bf16 v[132:135], v[208:211], a[164:167], v[132:135]
  ds_read_b128 a[128:131], v216 offset:0
  ds_read_b128 a[132:135], v216 offset:64
  s_waitcnt lgkmcnt(12)
  v_mfma_f32_16x16x32_bf16 v[136:139], v[208:211], a[168:171], v[136:139]
  ds_read_b128 a[136:139], v216 offset:128
  ds_read_b128 a[140:143], v216 offset:192
  s_waitcnt lgkmcnt(12)
  v_mfma_f32_16x16x32_bf16 v[140:143], v[208:211], a[172:175], v[140:143]
  ds_read_b128 a[144:147], v216 offset:704
  ds_read_b128 a[148:151], v216 offset:640
  s_waitcnt lgkmcnt(12)
  v_mfma_f32_16x16x32_bf16 v[144:147], v[208:211], a[176:179], v[144:147]
  s_waitcnt lgkmcnt(10)
  v_mul_f32 v200, s29, v192
  v_mul_f32_e64 v201, s29, v193
  v_mfma_f32_16x16x32_bf16 v[148:151], v[208:211], a[180:183], v[148:151]
  ds_read_b128 a[152:155], v216 offset:576
  v_mul_f32 v202, s29, v194
  s_waitcnt lgkmcnt(9)
  v_mfma_f32_16x16x32_bf16 v[152:155], v[208:211], a[184:187], v[152:155]
  ds_read_b128 a[156:159], v216 offset:512
  v_mul_f32 v203, s29, v195
  s_waitcnt lgkmcnt(8)
  v_mfma_f32_16x16x32_bf16 v[156:159], v[208:211], a[188:191], v[156:159]
  v_mul_f32 v204, s29, v196
  v_mul_f32 v207, s29, v199
  s_barrier
  s_add_u32 m0, s32, 16896
  s_xor_b32 s50, 32768, s3
  buffer_load_dwordx4 v221, s[4:7], s50 offen lds
  s_add_u32 m0, s32, 16928
  s_add_u32 s51, s32, s96
  buffer_load_dwordx4 v221, s[4:7], s50 offen offset:1024 lds
  s_add_u32 m0, s51, 16896
  s_nop 0
  buffer_load_dwordx4 v221, s[8:11], s50 offen lds
  s_add_u32 m0, s51, 16912
  s_nop 0
  buffer_load_dwordx4 v221, s[8:11], s50 offen offset:1024 lds
  s_waitcnt vmcnt(4)
  s_waitcnt lgkmcnt(7)
  v_mfma_f32_16x16x32_bf16 v[192:195], a[128:131], a[0:3], v[228:231]
  s_waitcnt lgkmcnt(6)
  v_mul_f32 v205, s29, v197
  v_mul_f32_e64 v206, s29, v198
  v_mfma_f32_16x16x32_bf16 v[192:195], a[132:135], a[4:7], v[192:195]
  s_waitcnt lgkmcnt(5)
  v_exp_f32 v206, v206
  v_mfma_f32_16x16x32_bf16 v[192:195], a[136:139], a[8:11], v[192:195]
  s_waitcnt lgkmcnt(4)
  v_exp_f32 v203, v203
  v_mfma_f32_16x16x32_bf16 v[192:195], a[140:143], a[12:15], v[192:195]
  s_waitcnt lgkmcnt(3)
  v_exp_f32 v201, v201
  v_mfma_f32_16x16x32_bf16 v[196:199], a[144:147], a[12:15], v[228:231]
  s_waitcnt lgkmcnt(2)
  v_exp_f32 v202, v202
  v_mfma_f32_16x16x32_bf16 v[196:199], a[148:151], a[8:11], v[196:199]
  s_waitcnt lgkmcnt(1)
  v_exp_f32 v200, v200
  v_exp_f32 v204, v204
  v_exp_f32 v205, v205
  v_exp_f32_e64 v207, v207
  v_mfma_f32_16x16x32_bf16 v[196:199], a[152:155], a[4:7], v[196:199]
  s_waitcnt lgkmcnt(0)
  v_cvt_pk_bf16_f32 v212, v200, v201
  v_cvt_pk_bf16_f32 v213, v202, v203
  v_cvt_pk_bf16_f32 v214, v204, v205
  v_cvt_pk_bf16_f32 v215, v206, v207
  v_mfma_f32_16x16x32_bf16 v[196:199], a[156:159], a[0:3], v[196:199]
  v_mul_f32 v200, s29, v192
  v_mul_f32_e64 v203, s29, v195
  v_mfma_f32_16x16x32_bf16 v[160:163], v[212:215], a[160:163], v[160:163]
  v_mul_f32 v201, s29, v193
  v_mul_f32 v202, s29, v194
  v_mfma_f32_16x16x32_bf16 v[164:167], v[212:215], a[164:167], v[164:167]
  v_exp_f32_e64 v200, v200
  v_mfma_f32_16x16x32_bf16 v[168:171], v[212:215], a[168:171], v[168:171]
  v_exp_f32_e64 v203, v203
  v_mfma_f32_16x16x32_bf16 v[172:175], v[212:215], a[172:175], v[172:175]
  ds_read_b64_tr_b16 a[162:163], v217 offset:8960
  ds_read_b64_tr_b16 a[166:167], v217 offset:8976
  v_mfma_f32_16x16x32_bf16 v[176:179], v[212:215], a[176:179], v[176:179]
  ds_read_b64_tr_b16 a[170:171], v217 offset:8992
  v_mul_f32_e64 v205, s29, v197
  v_mfma_f32_16x16x32_bf16 v[180:183], v[212:215], a[180:183], v[180:183]
  ds_read_b64_tr_b16 a[164:165], v217 offset:8464
  ds_read_b64_tr_b16 a[172:173], v217 offset:8496
  v_mfma_f32_16x16x32_bf16 v[184:187], v[212:215], a[184:187], v[184:187]
  v_exp_f32_e64 v202, v202
  v_mfma_f32_16x16x32_bf16 v[188:191], v[212:215], a[188:191], v[188:191]
  ds_read_b64_tr_b16 a[168:169], v217 offset:8480
  v_mul_f32_e64 v204, s29, v196
  v_smfmac_f32_16x16x64_bf16 a[200:203], a[220:223], v[208:215], v254
  ds_read_b64_tr_b16 a[160:161], v217 offset:8448
  ds_read_b64_tr_b16 a[174:175], v217 offset:9008
  v_exp_f32 v201, v201
  v_mul_f32 v206, s29, v198
  v_mul_f32 v207, s29, v199
  s_branch L_pG2
L_startB3:
  ds_read_b128 a[128:131], v216 offset:33792
  ds_read_b128 a[132:135], v216 offset:33856
  ds_read_b128 a[136:139], v216 offset:33920
  ds_read_b128 a[140:143], v216 offset:33984
  ds_read_b128 a[144:147], v216 offset:34496
  ds_read_b128 a[148:151], v216 offset:34432
  ds_read_b128 a[152:155], v216 offset:34368
  ds_read_b128 a[156:159], v216 offset:34304
  ds_read_b128 a[0:3], v224 offset:0
  ds_read_b128 a[4:7], v225 offset:0
  ds_read_b128 a[8:11], v226 offset:0
  ds_read_b128 a[12:15], v227 offset:0
  s_cmp_lt_u32 s58, 4
  s_cbranch_scc1 L_y14
  s_waitcnt vmcnt(0)
L_y14:
  s_add_u32 m0, s49, 8192
  s_add_u32 s50, s39, 8192
  buffer_load_dwordx4 v222, s[12:15], s50 offen nt lds
  buffer_load_dwordx4 v223, s[12:15], s50 offen offset:1024 nt lds
  buffer_load_dwordx4 v222, s[12:15], s50 offen offset:2048 nt lds
  buffer_load_dwordx4 v223, s[12:15], s50 offen offset:3072 nt lds
  s_waitcnt lgkmcnt(3)
  v_mfma_f32_16x16x32_bf16 v[192:195], a[128:131], a[0:3], v[228:231]
  ds_read_b64_tr_b16 a[160:161], v217 offset:42240
  ds_read_b64_tr_b16 a[162:163], v217 offset:42752
  s_waitcnt lgkmcnt(4)
  v_mfma_f32_16x16x32_bf16 v[192:195], a[132:135], a[4:7], v[192:195]
  ds_read_b64_tr_b16 a[164:165], v217 offset:42256
  ds_read_b64_tr_b16 a[166:167], v217 offset:42768
  s_waitcnt lgkmcnt(5)
  v_mfma_f32_16x16x32_bf16 v[192:195], a[136:139], a[8:11], v[192:195]
  ds_read_b64_tr_b16 a[168:169], v217 offset:42272
  ds_read_b64_tr_b16 a[170:171], v217 offset:42784
  s_waitcnt lgkmcnt(6)
  v_mfma_f32_16x16x32_bf16 v[192:195], a[140:143], a[12:15], v[192:195]
  ds_read_b64_tr_b16 a[172:173], v217 offset:42288
  ds_read_b64_tr_b16 a[174:175], v217 offset:42800
  v_mfma_f32_16x16x32_bf16 v[196:199], a[144:147], a[12:15], v[228:231]
  ds_read_b64_tr_b16 a[176:177], v217 offset:42304
  ds_read_b64_tr_b16 a[178:179], v217 offset:42816
  v_mfma_f32_16x16x32_bf16 v[196:199], a[148:151], a[8:11], v[196:199]
  ds_read_b64_tr_b16 a[180:181], v217 offset:42320
  ds_read_b64_tr_b16 a[182:183], v217 offset:42832
  v_mfma_f32_16x16x32_bf16 v[196:199], a[152:155], a[4:7], v[196:199]
  v_mul_f32 v200, s29, v192
  v_mul_f32_e64 v203, s29, v195
  v_mfma_f32_16x16x32_bf16 v[196:199], a[156:159], a[0:3], v[196:199]
  v_mul_f32 v201, s29, v193
  v_mul_f32_e64 v202, s29, v194
  s_waitcnt vmcnt(4)
  s_barrier
  ds_read_b128 a[16:19], v224 offset:4096
  ds_read_b128 a[20:23], v225 offset:4096
  ds_read_b128 a[24:27], v226 offset:4096
  ds_read_b128 a[28:31], v227 offset:4096
  s_cmp_lt_u32 s58, 5
  s_cbranch_scc1 L_y15
  s_waitcnt vmcnt(0)
L_y15:
  s_add_u32 m0, s49, 12288
  s_add_u32 s50, s39, 12288
  buffer_load_dwordx4 v222, s[12:15], s50 offen nt lds
  buffer_load_dwordx4 v223, s[12:15], s50 offen offset:1024 nt lds
  buffer_load_dwordx4 v222, s[12:15], s50 offen offset:2048 nt lds
  buffer_load_dwordx4 v223, s[12:15], s50 offen offset:3072 nt lds
  s_cmp_lt_u32 s58, 6
  s_cbranch_scc1 L_y16
  s_waitcnt vmcnt(0)
L_y16:
  s_add_u32 m0, s49, 16384
  s_add_u32 s50, s39, 16384
  buffer_load_dwordx4 v222, s[12:15], s50 offen nt lds
  buffer_load_dwordx4 v223, s[12:15], s50 offen offset:1024 nt lds
  buffer_load_dwordx4 v222, s[12:15], s50 offen offset:2048 nt lds
  buffer_load_dwordx4 v223, s[12:15], s50 offen offset:3072 nt lds
  s_waitcnt lgkmcnt(3)
  v_mfma_f32_16x16x32_bf16 v[192:195], a[128:131], a[16:19], v[228:231]
  s_waitcnt lgkmcnt(2)
  v_exp_f32 v202, v202
  v_mfma_f32_16x16x32_bf16 v[192:195], a[132:135], a[20:23], v[192:195]
  s_waitcnt lgkmcnt(1)
  v_exp_f32 v200, v200
  v_mfma_f32_16x16x32_bf16 v[192:195], a[136:139], a[24:27], v[192:195]
  s_waitcnt lgkmcnt(0)
  v_mul_f32 v205, s29, v197
  v_mul_f32_e64 v206, s29, v198
  v_mfma_f32_16x16x32_bf16 v[192:195], a[140:143], a[28:31], v[192:195]
  v_mul_f32 v204, s29, v196
  v_mul_f32 v207, s29, v199
  v_mfma_f32_16x16x32_bf16 v[196:199], a[144:147], a[28:31], v[228:231]
  v_exp_f32_e64 v206, v206
  v_mfma_f32_16x16x32_bf16 v[196:199], a[148:151], a[24:27], v[196:199]
  v_exp_f32 v201, v201
  v_exp_f32 v203, v203
  v_exp_f32 v204, v204
  v_exp_f32 v205, v205
  v_exp_f32_e64 v207, v207
  v_mfma_f32_16x16x32_bf16 v[196:199], a[152:155], a[20:23], v[196:199]
  v_cvt_pk_bf16_f32 v208, v200, v201
  v_cvt_pk_bf16_f32 v209, v202, v203
  v_cvt_pk_bf16_f32 v210, v204, v205
  v_cvt_pk_bf16_f32 v211, v206, v207
  v_mfma_f32_16x16x32_bf16 v[196:199], a[156:159], a[16:19], v[196:199]
  ds_read_b64_tr_b16 a[184:185], v217 offset:42336
  ds_read_b64_tr_b16 a[186:187], v217 offset:42848
  v_mfma_f32_16x16x32_bf16 v[0:3], v[208:211], a[160:163], 0
  ds_read_b64_tr_b16 a[188:189], v217 offset:42352
  ds_read_b64_tr_b16 a[190:191], v217 offset:42864
  v_mfma_f32_16x16x32_bf16 v[4:7], v[208:211], a[164:167], 0
  ds_read_b128 a[128:131], v216 offset:16896
  ds_read_b128 a[132:135], v216 offset:16960
  v_mfma_f32_16x16x32_bf16 v[8:11], v[208:211], a[168:171], 0
  ds_read_b128 a[136:139], v216 offset:17024
  ds_read_b128 a[140:143], v216 offset:17088
  v_mfma_f32_16x16x32_bf16 v[12:15], v[208:211], a[172:175], 0
  ds_read_b128 a[144:147], v216 offset:17600
  ds_read_b128 a[148:151], v216 offset:17536
  v_mfma_f32_16x16x32_bf16 v[16:19], v[208:211], a[176:179], 0
  s_waitcnt lgkmcnt(8)
  v_mul_f32 v202, s29, v194
  v_mul_f32_e64 v203, s29, v195
  v_mfma_f32_16x16x32_bf16 v[20:23], v[208:211], a[180:183], 0
  ds_read_b128 a[152:155], v216 offset:17472
  v_mul_f32_e64 v200, s29, v192
  v_mfma_f32_16x16x32_bf16 v[24:27], v[208:211], a[184:187], 0
  ds_read_b128 a[156:159], v216 offset:17408
  v_mul_f32 v201, s29, v193
  s_waitcnt lgkmcnt(8)
  v_mfma_f32_16x16x32_bf16 v[28:31], v[208:211], a[188:191], 0
  s_waitcnt lgkmcnt(7)
  v_mul_f32 v204, s29, v196
  v_mul_f32_e64 v206, s29, v198
  v_mfma_f32_16x16x32_bf16 v[192:195], a[128:131], a[0:3], v[228:231]
  s_waitcnt lgkmcnt(6)
  v_mul_f32 v205, s29, v197
  v_mul_f32_e64 v207, s29, v199
  v_mfma_f32_16x16x32_bf16 v[192:195], a[132:135], a[4:7], v[192:195]
  s_waitcnt lgkmcnt(5)
  v_exp_f32 v207, v207
  v_mfma_f32_16x16x32_bf16 v[192:195], a[136:139], a[8:11], v[192:195]
  s_waitcnt lgkmcnt(4)
  v_exp_f32 v202, v202
  v_mfma_f32_16x16x32_bf16 v[192:195], a[140:143], a[12:15], v[192:195]
  s_waitcnt lgkmcnt(3)
  v_exp_f32 v205, v205
  v_mfma_f32_16x16x32_bf16 v[196:199], a[144:147], a[12:15], v[228:231]
  s_waitcnt lgkmcnt(2)
  v_exp_f32 v204, v204
  v_mfma_f32_16x16x32_bf16 v[196:199], a[148:151], a[8:11], v[196:199]
  s_waitcnt lgkmcnt(1)
  v_exp_f32 v200, v200
  v_exp_f32 v201, v201
  v_exp_f32 v203, v203
  v_exp_f32_e64 v206, v206
  v_mfma_f32_16x16x32_bf16 v[196:199], a[152:155], a[4:7], v[196:199]
  s_waitcnt lgkmcnt(0)
  v_cvt_pk_bf16_f32 v212, v200, v201
  v_cvt_pk_bf16_f32 v213, v202, v203
  v_cvt_pk_bf16_f32 v214, v204, v205
  v_cvt_pk_bf16_f32 v215, v206, v207
  v_mfma_f32_16x16x32_bf16 v[196:199], a[156:159], a[0:3], v[196:199]
  v_mul_f32 v201, s29, v193
  v_mul_f32_e64 v202, s29, v194
  v_mfma_f32_16x16x32_bf16 v[32:35], v[212:215], a[160:163], 0
  v_mul_f32 v200, s29, v192
  v_mul_f32 v203, s29, v195
  v_mfma_f32_16x16x32_bf16 v[36:39], v[212:215], a[164:167], 0
  ds_read_b64_tr_b16 a[160:161], v217 offset:25344
  ds_read_b64_tr_b16 a[162:163], v217 offset:25856
  v_mfma_f32_16x16x32_bf16 v[40:43], v[212:215], a[168:171], 0
  ds_read_b64_tr_b16 a[164:165], v217 offset:25360
  ds_read_b64_tr_b16 a[166:167], v217 offset:25872
  v_mfma_f32_16x16x32_bf16 v[44:47], v[212:215], a[172:175], 0
  v_mul_f32 v204, s29, v196
  v_mul_f32 v205, s29, v197
  v_mfma_f32_16x16x32_bf16 v[48:51], v[212:215], a[176:179], 0
  ds_read_b64_tr_b16 a[168:169], v217 offset:25376
  ds_read_b64_tr_b16 a[170:171], v217 offset:25888
  v_mfma_f32_16x16x32_bf16 v[52:55], v[212:215], a[180:183], 0
  v_mul_f32 v206, s29, v198
  v_mul_f32 v207, s29, v199
  v_mfma_f32_16x16x32_bf16 v[56:59], v[212:215], a[184:187], 0
  ds_read_b64_tr_b16 a[172:173], v217 offset:25392
  ds_read_b64_tr_b16 a[174:175], v217 offset:25904
  v_mfma_f32_16x16x32_bf16 v[60:63], v[212:215], a[188:191], 0
  v_exp_f32_e64 v204, v204
  v_smfmac_f32_16x16x64_bf16 a[192:195], a[220:223], v[208:215], v254
  ds_read_b64_tr_b16 a[176:177], v217 offset:25408
  ds_read_b64_tr_b16 a[178:179], v217 offset:25920
  v_mfma_f32_16x16x32_bf16 v[192:195], a[128:131], a[16:19], v[228:231]
  v_exp_f32_e64 v203, v203
  v_mfma_f32_16x16x32_bf16 v[192:195], a[132:135], a[20:23], v[192:195]
  v_exp_f32_e64 v207, v207
  v_mfma_f32_16x16x32_bf16 v[192:195], a[136:139], a[24:27], v[192:195]
  v_exp_f32_e64 v206, v206
  v_mfma_f32_16x16x32_bf16 v[192:195], a[140:143], a[28:31], v[192:195]
  v_exp_f32_e64 v202, v202
  v_mfma_f32_16x16x32_bf16 v[196:199], a[144:147], a[28:31], v[228:231]
  v_exp_f32_e64 v205, v205
  v_mfma_f32_16x16x32_bf16 v[196:199], a[148:151], a[24:27], v[196:199]
  v_exp_f32 v200, v200
  v_exp_f32 v201, v201
  v_mfma_f32_16x16x32_bf16 v[196:199], a[152:155], a[20:23], v[196:199]
  ds_read_b64_tr_b16 a[180:181], v217 offset:25424
  ds_read_b64_tr_b16 a[182:183], v217 offset:25936
  v_cvt_pk_bf16_f32 v208, v200, v201
  v_cvt_pk_bf16_f32 v209, v202, v203
  v_cvt_pk_bf16_f32 v210, v204, v205
  v_cvt_pk_bf16_f32 v211, v206, v207
  v_mfma_f32_16x16x32_bf16 v[196:199], a[156:159], a[16:19], v[196:199]
  ds_read_b64_tr_b16 a[184:185], v217 offset:25440
  ds_read_b64_tr_b16 a[186:187], v217 offset:25952
  s_waitcnt lgkmcnt(12)
  v_mfma_f32_16x16x32_bf16 v[0:3], v[208:211], a[160:163], v[0:3]
  ds_read_b64_tr_b16 a[188:189], v217 offset:25456
  ds_read_b64_tr_b16 a[190:191], v217 offset:25968
  s_waitcnt lgkmcnt(12)
  v_mfma_f32_16x16x32_bf16 v[4:7], v[208:211], a[164:167], v[4:7]
  s_waitcnt lgkmcnt(10)
  v_mul_f32 v201, s29, v193
  v_mul_f32_e64 v203, s29, v195
  v_mfma_f32_16x16x32_bf16 v[8:11], v[208:211], a[168:171], v[8:11]
  s_waitcnt lgkmcnt(8)
  v_mul_f32 v200, s29, v192
  v_mul_f32_e64 v202, s29, v194
  v_mfma_f32_16x16x32_bf16 v[12:15], v[208:211], a[172:175], v[12:15]
  v_mul_f32 v204, s29, v196
  v_mul_f32_e64 v207, s29, v199
  s_waitcnt vmcnt(8)
  ds_read_b128 a[32:35], v224 offset:8192
  ds_read_b128 a[36:39], v225 offset:8192
  ds_read_b128 a[40:43], v226 offset:8192
  ds_read_b128 a[44:47], v227 offset:8192
  s_cmp_lt_u32 s58, 7
  s_cbranch_scc1 L_y17
  s_waitcnt vmcnt(0)
L_y17:
  s_add_u32 m0, s49, 20480
  s_add_u32 s50, s39, 20480
  buffer_load_dwordx4 v222, s[12:15], s50 offen nt lds
  buffer_load_dwordx4 v223, s[12:15], s50 offen offset:1024 nt lds
  buffer_load_dwordx4 v222, s[12:15], s50 offen offset:2048 nt lds
  buffer_load_dwordx4 v223, s[12:15], s50 offen offset:3072 nt lds
  s_waitcnt lgkmcnt(10)
  v_mfma_f32_16x16x32_bf16 v[16:19], v[208:211], a[176:179], v[16:19]
  s_waitcnt lgkmcnt(8)
  v_mul_f32 v205, s29, v197
  v_mul_f32_e64 v206, s29, v198
  v_mfma_f32_16x16x32_bf16 v[20:23], v[208:211], a[180:183], v[20:23]
  s_waitcnt lgkmcnt(6)
  v_exp_f32 v203, v203
  v_mfma_f32_16x16x32_bf16 v[24:27], v[208:211], a[184:187], v[24:27]
  s_waitcnt lgkmcnt(4)
  v_exp_f32 v202, v202
  v_mfma_f32_16x16x32_bf16 v[28:31], v[208:211], a[188:191], v[28:31]
  s_waitcnt lgkmcnt(3)
  v_exp_f32 v206, v206
  v_mfma_f32_16x16x32_bf16 v[192:195], a[128:131], a[32:35], v[228:231]
  s_waitcnt lgkmcnt(2)
  v_exp_f32 v207, v207
  v_mfma_f32_16x16x32_bf16 v[192:195], a[132:135], a[36:39], v[192:195]
  s_waitcnt lgkmcnt(1)
  v_exp_f32 v205, v205
  v_mfma_f32_16x16x32_bf16 v[192:195], a[136:139], a[40:43], v[192:195]
  s_waitcnt lgkmcnt(0)
  v_exp_f32 v201, v201
  v_mfma_f32_16x16x32_bf16 v[192:195], a[140:143], a[44:47], v[192:195]
  v_exp_f32_e64 v200, v200
  v_mfma_f32_16x16x32_bf16 v[196:199], a[144:147], a[44:47], v[228:231]
  v_exp_f32_e64 v204, v204
  v_mfma_f32_16x16x32_bf16 v[196:199], a[148:151], a[40:43], v[196:199]
  v_cvt_pk_bf16_f32 v213, v202, v203
  v_cvt_pk_bf16_f32 v214, v204, v205
  v_mfma_f32_16x16x32_bf16 v[196:199], a[152:155], a[36:39], v[196:199]
  v_cvt_pk_bf16_f32 v212, v200, v201
  v_cvt_pk_bf16_f32 v215, v206, v207
  v_mfma_f32_16x16x32_bf16 v[196:199], a[156:159], a[32:35], v[196:199]
  v_mul_f32 v200, s29, v192
  v_mul_f32 v203, s29, v195
  v_smfmac_f32_16x16x64_bf16 a[192:195], a[220:223], v[208:215], v254
  v_mul_f32_e64 v202, s29, v194
  v_mfma_f32_16x16x32_bf16 v[32:35], v[212:215], a[160:163], v[32:35]
  v_exp_f32_e64 v200, v200
  v_mfma_f32_16x16x32_bf16 v[36:39], v[212:215], a[164:167], v[36:39]
  v_mul_f32 v201, s29, v193
  v_mul_f32 v207, s29, v199
  v_mfma_f32_16x16x32_bf16 v[40:43], v[212:215], a[168:171], v[40:43]
  v_mul_f32 v205, s29, v197
  v_mul_f32 v206, s29, v198
  v_mfma_f32_16x16x32_bf16 v[44:47], v[212:215], a[172:175], v[44:47]
  v_exp_f32_e64 v205, v205
  s_waitcnt vmcnt(8)
  ds_read_b128 a[48:51], v224 offset:12288
  ds_read_b128 a[52:55], v225 offset:12288
  ds_read_b128 a[56:59], v226 offset:12288
  ds_read_b128 a[60:63], v227 offset:12288
  s_cmp_lt_u32 s58, 8
  s_cbranch_scc1 L_y18
  s_waitcnt vmcnt(0)
L_y18:
  s_mov_b32 m0, s49
  s_nop 0
  buffer_load_dwordx4 v222, s[12:15], s40 offen nt lds
  buffer_load_dwordx4 v223, s[12:15], s40 offen offset:1024 nt lds
  buffer_load_dwordx4 v222, s[12:15], s40 offen offset:2048 nt lds
  buffer_load_dwordx4 v223, s[12:15], s40 offen offset:3072 nt lds
  v_mfma_f32_16x16x32_bf16 v[48:51], v[212:215], a[176:179], v[48:51]
  v_exp_f32_e64 v202, v202
  v_mfma_f32_16x16x32_bf16 v[52:55], v[212:215], a[180:183], v[52:55]
  v_exp_f32_e64 v201, v201
  v_mfma_f32_16x16x32_bf16 v[56:59], v[212:215], a[184:187], v[56:59]
  v_mul_f32_e64 v204, s29, v196
  v_cvt_pk_bf16_f32 v208, v200, v201
  v_mfma_f32_16x16x32_bf16 v[60:63], v[212:215], a[188:191], v[60:63]
  s_waitcnt lgkmcnt(3)
  v_exp_f32 v204, v204
  v_mfma_f32_16x16x32_bf16 v[192:195], a[128:131], a[48:51], v[228:231]
  s_waitcnt lgkmcnt(2)
  v_exp_f32 v203, v203
  v_mfma_f32_16x16x32_bf16 v[192:195], a[132:135], a[52:55], v[192:195]
  s_waitcnt lgkmcnt(1)
  v_exp_f32 v207, v207
  v_mfma_f32_16x16x32_bf16 v[192:195], a[136:139], a[56:59], v[192:195]
  s_waitcnt lgkmcnt(0)
  v_exp_f32 v206, v206
  v_mfma_f32_16x16x32_bf16 v[192:195], a[140:143], a[60:63], v[192:195]
  v_cvt_pk_bf16_f32 v209, v202, v203
  v_cvt_pk_bf16_f32 v210, v204, v205
  v_mfma_f32_16x16x32_bf16 v[196:199], a[144:147], a[60:63], v[228:231]
  ds_read_b128 a[128:131], v216 offset:33792
  v_cvt_pk_bf16_f32 v211, v206, v207
  v_mfma_f32_16x16x32_bf16 v[196:199], a[148:151], a[56:59], v[196:199]
  ds_read_b128 a[132:135], v216 offset:33856
  ds_read_b128 a[136:139], v216 offset:33920
  v_mfma_f32_16x16x32_bf16 v[196:199], a[152:155], a[52:55], v[196:199]
  ds_read_b128 a[140:143], v216 offset:33984
  ds_read_b128 a[144:147], v216 offset:34496
  v_mfma_f32_16x16x32_bf16 v[196:199], a[156:159], a[48:51], v[196:199]
  ds_read_b128 a[148:151], v216 offset:34432
  v_mul_f32_e64 v203, s29, v195
  v_mfma_f32_16x16x32_bf16 v[64:67], v[208:211], a[160:163], 0
  ds_read_b128 a[152:155], v216 offset:34368
  v_mul_f32_e64 v200, s29, v192
  v_mfma_f32_16x16x32_bf16 v[68:71], v[208:211], a[164:167], 0
  v_mul_f32 v201, s29, v193
  v_mul_f32 v202, s29, v194
  v_mfma_f32_16x16x32_bf16 v[72:75], v[208:211], a[168:171], 0
  ds_read_b128 a[156:159], v216 offset:34304
  v_mul_f32_e64 v206, s29, v198
  v_mfma_f32_16x16x32_bf16 v[76:79], v[208:211], a[172:175], 0
  v_mul_f32 v205, s29, v197
  v_mul_f32 v207, s29, v199
  v_mfma_f32_16x16x32_bf16 v[80:83], v[208:211], a[176:179], 0
  v_exp_f32_e64 v202, v202
  v_mfma_f32_16x16x32_bf16 v[84:87], v[208:211], a[180:183], 0
  v_exp_f32_e64 v203, v203
  v_mfma_f32_16x16x32_bf16 v[88:91], v[208:211], a[184:187], 0
  v_mul_f32_e64 v204, s29, v196
  v_cvt_pk_bf16_f32 v213, v202, v203
  v_mfma_f32_16x16x32_bf16 v[92:95], v[208:211], a[188:191], 0
  s_waitcnt lgkmcnt(7)
  v_exp_f32 v205, v205
  v_mfma_f32_16x16x32_bf16 v[192:195], a[128:131], a[32:35], v[228:231]
  s_waitcnt lgkmcnt(6)
  v_exp_f32 v200, v200
  v_mfma_f32_16x16x32_bf16 v[192:195], a[132:135], a[36:39], v[192:195]
  s_waitcnt lgkmcnt(5)
  v_exp_f32 v204, v204
  v_mfma_f32_16x16x32_bf16 v[192:195], a[136:139], a[40:43], v[192:195]
  s_waitcnt lgkmcnt(4)
  v_exp_f32 v206, v206
  v_mfma_f32_16x16x32_bf16 v[192:195], a[140:143], a[44:47], v[192:195]
  s_waitcnt lgkmcnt(3)
  v_exp_f32 v201, v201
  v_mfma_f32_16x16x32_bf16 v[196:199], a[144:147], a[44:47], v[228:231]
  s_waitcnt lgkmcnt(2)
  v_exp_f32 v207, v207
  v_mfma_f32_16x16x32_bf16 v[196:199], a[148:151], a[40:43], v[196:199]
  s_waitcnt lgkmcnt(1)
  v_cvt_pk_bf16_f32 v214, v204, v205
  v_cvt_pk_bf16_f32 v215, v206, v207
  v_mfma_f32_16x16x32_bf16 v[196:199], a[152:155], a[36:39], v[196:199]
  s_waitcnt lgkmcnt(0)
  v_cvt_pk_bf16_f32 v212, v200, v201
  v_mul_f32_e64 v203, s29, v195
  v_mfma_f32_16x16x32_bf16 v[196:199], a[156:159], a[32:35], v[196:199]
  v_mul_f32 v200, s29, v192
  v_mul_f32 v202, s29, v194
  v_mfma_f32_16x16x32_bf16 v[96:99], v[212:215], a[160:163], 0
  ds_read_b64_tr_b16 a[160:161], v217 offset:42240
  v_mul_f32_e64 v201, s29, v193
  v_mfma_f32_16x16x32_bf16 v[100:103], v[212:215], a[164:167], 0
  ds_read_b64_tr_b16 a[162:163], v217 offset:42752
  ds_read_b64_tr_b16 a[166:167], v217 offset:42768
  v_mfma_f32_16x16x32_bf16 v[104:107], v[212:215], a[168:171], 0
  ds_read_b64_tr_b16 a[164:165], v217 offset:42256
  v_mul_f32_e64 v206, s29, v198
  v_mfma_f32_16x16x32_bf16 v[108:111], v[212:215], a[172:175], 0
  ds_read_b64_tr_b16 a[168:169], v217 offset:42272
  ds_read_b64_tr_b16 a[170:171], v217 offset:42784
  v_mfma_f32_16x16x32_bf16 v[112:115], v[212:215], a[176:179], 0
  v_mul_f32 v204, s29, v196
  v_mul_f32 v207, s29, v199
  v_mfma_f32_16x16x32_bf16 v[116:119], v[212:215], a[180:183], 0
  ds_read_b64_tr_b16 a[174:175], v217 offset:42800
  v_mul_f32_e64 v205, s29, v197
  v_mfma_f32_16x16x32_bf16 v[120:123], v[212:215], a[184:187], 0
  ds_read_b64_tr_b16 a[172:173], v217 offset:42288
  ds_read_b64_tr_b16 a[176:177], v217 offset:42304
  v_mfma_f32_16x16x32_bf16 v[124:127], v[212:215], a[188:191], 0
  v_exp_f32_e64 v202, v202
  v_smfmac_f32_16x16x64_bf16 a[196:199], a[220:223], v[208:215], v254
  ds_read_b64_tr_b16 a[178:179], v217 offset:42816
  ds_read_b64_tr_b16 a[182:183], v217 offset:42832
  s_add_u32 m0, s32, 0
  s_xor_b32 s50, 16384, s3
  buffer_load_dwordx4 v221, s[4:7], s50 offen lds
  s_add_u32 m0, s32, 32
  s_add_u32 s51, s32, s96
  buffer_load_dwordx4 v221, s[4:7], s50 offen offset:1024 lds
  s_add_u32 m0, s51, 0
  s_nop 0
  buffer_load_dwordx4 v221, s[8:11], s50 offen lds
  s_add_u32 m0, s51, 16
  s_nop 0
  buffer_load_dwordx4 v221, s[8:11], s50 offen offset:1024 lds
  v_mfma_f32_16x16x32_bf16 v[192:195], a[128:131], a[48:51], v[228:231]
  v_exp_f32 v207, v207
  v_mfma_f32_16x16x32_bf16 v[192:195], a[132:135], a[52:55], v[192:195]
  v_exp_f32_e64 v205, v205
  v_mfma_f32_16x16x32_bf16 v[192:195], a[136:139], a[56:59], v[192:195]
  v_exp_f32_e64 v204, v204
  v_mfma_f32_16x16x32_bf16 v[192:195], a[140:143], a[60:63], v[192:195]
  v_exp_f32_e64 v203, v203
  v_mfma_f32_16x16x32_bf16 v[196:199], a[144:147], a[60:63], v[228:231]
  v_exp_f32_e64 v206, v206
  v_mfma_f32_16x16x32_bf16 v[196:199], a[148:151], a[56:59], v[196:199]
  s_waitcnt lgkmcnt(9)
  v_exp_f32 v200, v200
  v_exp_f32_e64 v201, v201
  v_mfma_f32_16x16x32_bf16 v[196:199], a[152:155], a[52:55], v[196:199]
  ds_read_b64_tr_b16 a[180:181], v217 offset:42320
  v_cvt_pk_bf16_f32 v208, v200, v201
  v_cvt_pk_bf16_f32 v209, v202, v203
  v_cvt_pk_bf16_f32 v210, v204, v205
  v_cvt_pk_bf16_f32 v211, v206, v207
  v_mfma_f32_16x16x32_bf16 v[196:199], a[156:159], a[48:51], v[196:199]
  ds_read_b64_tr_b16 a[184:185], v217 offset:42336
  ds_read_b64_tr_b16 a[186:187], v217 offset:42848
  v_mfma_f32_16x16x32_bf16 v[64:67], v[208:211], a[160:163], v[64:67]
  ds_read_b64_tr_b16 a[188:189], v217 offset:42352
  ds_read_b64_tr_b16 a[190:191], v217 offset:42864
  s_waitcnt lgkmcnt(12)
  v_mfma_f32_16x16x32_bf16 v[68:71], v[208:211], a[164:167], v[68:71]
  s_waitcnt lgkmcnt(10)
  v_mul_f32 v201, s29, v193
  v_mul_f32 v203, s29, v195
  v_mfma_f32_16x16x32_bf16 v[72:75], v[208:211], a[168:171], v[72:75]
  s_waitcnt lgkmcnt(8)
  v_mul_f32 v200, s29, v192
  v_mul_f32_e64 v202, s29, v194
  v_mfma_f32_16x16x32_bf16 v[76:79], v[208:211], a[172:175], v[76:79]
  s_waitcnt lgkmcnt(6)
  v_mul_f32 v204, s29, v196
  v_mul_f32 v205, s29, v197
  s_waitcnt vmcnt(12)
  ds_read_b128 a[64:67], v224 offset:16384
  ds_read_b128 a[68:71], v225 offset:16384
  ds_read_b128 a[72:75], v226 offset:16384
  ds_read_b128 a[76:79], v227 offset:16384
  v_mfma_f32_16x16x32_bf16 v[80:83], v[208:211], a[176:179], v[80:83]
  s_waitcnt lgkmcnt(8)
  v_mul_f32 v206, s29, v198
  v_mul_f32_e64 v207, s29, v199
  v_mfma_f32_16x16x32_bf16 v[84:87], v[208:211], a[180:183], v[84:87]
  s_waitcnt lgkmcnt(6)
  v_exp_f32 v207, v207
  v_mfma_f32_16x16x32_bf16 v[88:91], v[208:211], a[184:187], v[88:91]
  s_waitcnt lgkmcnt(4)
  v_exp_f32 v203, v203
  v_mfma_f32_16x16x32_bf16 v[92:95], v[208:211], a[188:191], v[92:95]
  v_exp_f32 v205, v205
  s_barrier
  s_add_u32 m0, s32, 33792
  s_xor_b32 s50, 24576, s3
  buffer_load_dwordx4 v221, s[4:7], s50 offen lds
  s_add_u32 m0, s32, 33824
  s_add_u32 s51, s32, s96
  buffer_load_dwordx4 v221, s[4:7], s50 offen offset:1024 lds
  s_add_u32 m0, s51, 33792
  s_nop 0
  buffer_load_dwordx4 v221, s[8:11], s50 offen lds
  s_add_u32 m0, s51, 33808
  s_nop 0
  buffer_load_dwordx4 v221, s[8:11], s50 offen offset:1024 lds
  s_waitcnt lgkmcnt(3)
  v_mfma_f32_16x16x32_bf16 v[192:195], a[128:131], a[64:67], v[228:231]
  s_waitcnt lgkmcnt(2)
  v_exp_f32 v204, v204
  v_mfma_f32_16x16x32_bf16 v[192:195], a[132:135], a[68:71], v[192:195]
  s_waitcnt lgkmcnt(1)
  v_exp_f32 v202, v202
  v_mfma_f32_16x16x32_bf16 v[192:195], a[136:139], a[72:75], v[192:195]
  s_waitcnt lgkmcnt(0)
  v_exp_f32 v200, v200
  v_mfma_f32_16x16x32_bf16 v[192:195], a[140:143], a[76:79], v[192:195]
  v_exp_f32_e64 v201, v201
  v_mfma_f32_16x16x32_bf16 v[196:199], a[144:147], a[76:79], v[228:231]
  v_exp_f32_e64 v206, v206
  v_mfma_f32_16x16x32_bf16 v[196:199], a[148:151], a[72:75], v[196:199]
  v_cvt_pk_bf16_f32 v213, v202, v203
  v_cvt_pk_bf16_f32 v215, v206, v207
  v_mfma_f32_16x16x32_bf16 v[196:199], a[152:155], a[68:71], v[196:199]
  v_cvt_pk_bf16_f32 v212, v200, v201
  v_cvt_pk_bf16_f32 v214, v204, v205
  v_mfma_f32_16x16x32_bf16 v[196:199], a[156:159], a[64:67], v[196:199]
  v_mul_f32 v200, s29, v192
  v_mul_f32 v202, s29, v194
  v_smfmac_f32_16x16x64_bf16 a[196:199], a[220:223], v[208:215], v254
  v_mul_f32_e64 v201, s29, v193
  v_mfma_f32_16x16x32_bf16 v[96:99], v[212:215], a[160:163], v[96:99]
  v_exp_f32_e64 v202, v202
  v_mfma_f32_16x16x32_bf16 v[100:103], v[212:215], a[164:167], v[100:103]
  v_mul_f32 v203, s29, v195
  v_mul_f32 v205, s29, v197
  v_mfma_f32_16x16x32_bf16 v[104:107], v[212:215], a[168:171], v[104:107]
  v_mul_f32 v206, s29, v198
  v_mul_f32 v207, s29, v199
  v_mfma_f32_16x16x32_bf16 v[108:111], v[212:215], a[172:175], v[108:111]
  v_exp_f32 v207, v207
  s_waitcnt vmcnt(12)
  ds_read_b128 a[80:83], v224 offset:20480
  ds_read_b128 a[84:87], v225 offset:20480
  ds_read_b128 a[88:91], v226 offset:20480
  ds_read_b128 a[92:95], v227 offset:20480
  v_mfma_f32_16x16x32_bf16 v[112:115], v[212:215], a[176:179], v[112:115]
  v_exp_f32_e64 v205, v205
  v_mfma_f32_16x16x32_bf16 v[116:119], v[212:215], a[180:183], v[116:119]
  v_exp_f32_e64 v206, v206
  v_mfma_f32_16x16x32_bf16 v[120:123], v[212:215], a[184:187], v[120:123]
  v_mul_f32_e64 v204, s29, v196
  v_cvt_pk_bf16_f32 v211, v206, v207
  v_mfma_f32_16x16x32_bf16 v[124:127], v[212:215], a[188:191], v[124:127]
  s_waitcnt lgkmcnt(3)
  v_exp_f32 v204, v204
  v_mfma_f32_16x16x32_bf16 v[192:195], a[128:131], a[80:83], v[228:231]
  s_waitcnt lgkmcnt(2)
  v_exp_f32 v200, v200
  v_mfma_f32_16x16x32_bf16 v[192:195], a[132:135], a[84:87], v[192:195]
  s_waitcnt lgkmcnt(1)
  v_exp_f32 v201, v201
  v_mfma_f32_16x16x32_bf16 v[192:195], a[136:139], a[88:91], v[192:195]
  s_waitcnt lgkmcnt(0)
  v_exp_f32 v203, v203
  v_mfma_f32_16x16x32_bf16 v[192:195], a[140:143], a[92:95], v[192:195]
  v_cvt_pk_bf16_f32 v208, v200, v201
  v_cvt_pk_bf16_f32 v209, v202, v203
  v_mfma_f32_16x16x32_bf16 v[196:199], a[144:147], a[92:95], v[228:231]
  ds_read_b128 a[128:131], v216 offset:16896
  v_cvt_pk_bf16_f32 v210, v204, v205
  v_mfma_f32_16x16x32_bf16 v[196:199], a[148:151], a[88:91], v[196:199]
  ds_read_b128 a[132:135], v216 offset:16960
  ds_read_b128 a[136:139], v216 offset:17024
  v_mfma_f32_16x16x32_bf16 v[196:199], a[152:155], a[84:87], v[196:199]
  ds_read_b128 a[140:143], v216 offset:17088
  ds_read_b128 a[144:147], v216 offset:17600
  v_mfma_f32_16x16x32_bf16 v[196:199], a[156:159], a[80:83], v[196:199]
  ds_read_b128 a[148:151], v216 offset:17536
  ds_read_b128 a[152:155], v216 offset:17472
  v_mfma_f32_16x16x32_bf16 v[128:131], v[208:211], a[160:163], 0
  v_mul_f32 v202, s29, v194
  v_mul_f32 v203, s29, v195
  v_mfma_f32_16x16x32_bf16 v[132:135], v[208:211], a[164:167], 0
  v_mul_f32 v200, s29, v192
  v_mul_f32 v201, s29, v193
  v_mfma_f32_16x16x32_bf16 v[136:139], v[208:211], a[168:171], 0
  ds_read_b128 a[156:159], v216 offset:17408
  v_mul_f32_e64 v205, s29, v197
  v_mfma_f32_16x16x32_bf16 v[140:143], v[208:211], a[172:175], 0
  v_mul_f32 v204, s29, v196
  v_mul_f32_e64 v207, s29, v199
  s_waitcnt vmcnt(8)
  ds_read_b128 a[96:99], v224 offset:0
  ds_read_b128 a[100:103], v225 offset:0
  ds_read_b128 a[104:107], v226 offset:0
  ds_read_b128 a[108:111], v227 offset:0
  v_mfma_f32_16x16x32_bf16 v[144:147], v[208:211], a[176:179], 0
  v_exp_f32_e64 v204, v204
  v_mfma_f32_16x16x32_bf16 v[148:151], v[208:211], a[180:183], 0
  v_exp_f32_e64 v202, v202
  v_mfma_f32_16x16x32_bf16 v[152:155], v[208:211], a[184:187], 0
  v_exp_f32_e64 v201, v201
  v_mfma_f32_16x16x32_bf16 v[156:159], v[208:211], a[188:191], 0
  s_waitcnt lgkmcnt(3)
  v_exp_f32 v200, v200
  v_mfma_f32_16x16x32_bf16 v[192:195], a[128:131], a[96:99], v[228:231]
  s_waitcnt lgkmcnt(2)
  v_mul_f32 v206, s29, v198
  v_cvt_pk_bf16_f32 v212, v200, v201
  v_mfma_f32_16x16x32_bf16 v[192:195], a[132:135], a[100:103], v[192:195]
  s_waitcnt lgkmcnt(1)
  v_exp_f32 v207, v207
  v_mfma_f32_16x16x32_bf16 v[192:195], a[136:139], a[104:107], v[192:195]
  s_waitcnt lgkmcnt(0)
  v_exp_f32 v203, v203
  v_mfma_f32_16x16x32_bf16 v[192:195], a[140:143], a[108:111], v[192:195]
  v_exp_f32_e64 v206, v206
  v_mfma_f32_16x16x32_bf16 v[196:199], a[144:147], a[108:111], v[228:231]
  v_exp_f32_e64 v205, v205
  v_mfma_f32_16x16x32_bf16 v[196:199], a[148:151], a[104:107], v[196:199]
  v_cvt_pk_bf16_f32 v214, v204, v205
  v_cvt_pk_bf16_f32 v215, v206, v207
  v_mfma_f32_16x16x32_bf16 v[196:199], a[152:155], a[100:103], v[196:199]
  v_cvt_pk_bf16_f32 v213, v202, v203
  v_mul_f32_e64 v202, s29, v194
  v_mfma_f32_16x16x32_bf16 v[196:199], a[156:159], a[96:99], v[196:199]
  v_mul_f32 v200, s29, v192
  v_mul_f32 v201, s29, v193
  v_mfma_f32_16x16x32_bf16 v[160:163], v[212:215], a[160:163], 0
  ds_read_b64_tr_b16 a[160:161], v217 offset:25344
  v_mul_f32_e64 v203, s29, v195
  v_mfma_f32_16x16x32_bf16 v[164:167], v[212:215], a[164:167], 0
  ds_read_b64_tr_b16 a[162:163], v217 offset:25856
  ds_read_b64_tr_b16 a[166:167], v217 offset:25872
  v_mfma_f32_16x16x32_bf16 v[168:171], v[212:215], a[168:171], 0
  v_mul_f32 v205, s29, v197
  v_mul_f32 v207, s29, v199
  v_mfma_f32_16x16x32_bf16 v[172:175], v[212:215], a[172:175], 0
  ds_read_b64_tr_b16 a[164:165], v217 offset:25360
  v_mul_f32_e64 v206, s29, v198
  v_mfma_f32_16x16x32_bf16 v[176:179], v[212:215], a[176:179], 0
  ds_read_b64_tr_b16 a[170:171], v217 offset:25888
  v_mul_f32_e64 v204, s29, v196
  v_mfma_f32_16x16x32_bf16 v[180:183], v[212:215], a[180:183], 0
  ds_read_b64_tr_b16 a[168:169], v217 offset:25376
  ds_read_b64_tr_b16 a[172:173], v217 offset:25392
  v_mfma_f32_16x16x32_bf16 v[184:187], v[212:215], a[184:187], 0
  v_exp_f32_e64 v200, v200
  v_mfma_f32_16x16x32_bf16 v[188:191], v[212:215], a[188:191], 0
  v_exp_f32_e64 v204, v204
  v_smfmac_f32_16x16x64_bf16 a[200:203], a[220:223], v[208:215], v254
  ds_read_b64_tr_b16 a[174:175], v217 offset:25904
  ds_read_b64_tr_b16 a[178:179], v217 offset:25920
  v_mfma_f32_16x16x32_bf16 v[192:195], a[128:131], a[64:67], v[228:231]
  v_exp_f32_e64 v205, v205
  v_mfma_f32_16x16x32_bf16 v[192:195], a[132:135], a[68:71], v[192:195]
  v_exp_f32_e64 v201, v201
  v_mfma_f32_16x16x32_bf16 v[192:195], a[136:139], a[72:75], v[192:195]
  v_exp_f32_e64 v207, v207
  v_mfma_f32_16x16x32_bf16 v[192:195], a[140:143], a[76:79], v[192:195]
  v_exp_f32_e64 v203, v203
  v_mfma_f32_16x16x32_bf16 v[196:199], a[144:147], a[76:79], v[228:231]
  v_exp_f32_e64 v206, v206
  v_mfma_f32_16x16x32_bf16 v[196:199], a[148:151], a[72:75], v[196:199]
  v_exp_f32_e64 v202, v202
  v_mfma_f32_16x16x32_bf16 v[196:199], a[152:155], a[68:71], v[196:199]
  ds_read_b64_tr_b16 a[176:177], v217 offset:25408
  v_cvt_pk_bf16_f32 v208, v200, v201
  v_cvt_pk_bf16_f32 v209, v202, v203
  v_cvt_pk_bf16_f32 v210, v204, v205
  v_cvt_pk_bf16_f32 v211, v206, v207
  v_mfma_f32_16x16x32_bf16 v[196:199], a[156:159], a[64:67], v[196:199]
  ds_read_b64_tr_b16 a[180:181], v217 offset:25424
  ds_read_b64_tr_b16 a[182:183], v217 offset:25936
  v_mfma_f32_16x16x32_bf16 a[204:207], a[220:223], v[208:211], a[204:207]
  ds_read_b64_tr_b16 a[184:185], v217 offset:25440
  ds_read_b64_tr_b16 a[186:187], v217 offset:25952
  s_waitcnt lgkmcnt(12)
  v_mfma_f32_16x16x32_bf16 a[224:227], v[208:211], a[160:163], a[224:227]
  ds_read_b64_tr_b16 a[188:189], v217 offset:25456
  ds_read_b64_tr_b16 a[190:191], v217 offset:25968
  s_waitcnt lgkmcnt(12)
  v_mfma_f32_16x16x32_bf16 a[228:231], v[208:211], a[164:167], a[228:231]
  s_waitcnt lgkmcnt(10)
  v_mul_f32 v200, s29, v192
  v_mul_f32_e64 v201, s29, v193
  v_mfma_f32_16x16x32_bf16 a[232:235], v[208:211], a[168:171], a[232:235]
  s_waitcnt lgkmcnt(8)
  v_mul_f32 v202, s29, v194
  v_mul_f32_e64 v203, s29, v195
  v_mfma_f32_16x16x32_bf16 a[236:239], v[208:211], a[172:175], a[236:239]
  s_waitcnt lgkmcnt(6)
  v_mul_f32 v206, s29, v198
  v_mul_f32_e64 v207, s29, v199
  v_mfma_f32_16x16x32_bf16 a[240:243], v[208:211], a[176:179], a[240:243]
  s_waitcnt lgkmcnt(4)
  v_mul_f32 v204, s29, v196
  v_mul_f32_e64 v205, s29, v197
  v_mfma_f32_16x16x32_bf16 a[244:247], v[208:211], a[180:183], a[244:247]
  s_waitcnt lgkmcnt(2)
  v_exp_f32 v202, v202
  v_mfma_f32_16x16x32_bf16 a[248:251], v[208:211], a[184:187], a[248:251]
  s_waitcnt lgkmcnt(0)
  v_exp_f32 v207, v207
  v_mfma_f32_16x16x32_bf16 a[252:255], v[208:211], a[188:191], a[252:255]
  v_exp_f32_e64 v206, v206
  s_waitcnt vmcnt(4)
  s_barrier
  v_mfma_f32_16x16x32_bf16 v[192:195], a[128:131], a[80:83], v[228:231]
  v_exp_f32_e64 v205, v205
  v_mfma_f32_16x16x32_bf16 v[192:195], a[132:135], a[84:87], v[192:195]
  v_exp_f32_e64 v203, v203
  v_mfma_f32_16x16x32_bf16 v[192:195], a[136:139], a[88:91], v[192:195]
  v_exp_f32_e64 v201, v201
  v_mfma_f32_16x16x32_bf16 v[192:195], a[140:143], a[92:95], v[192:195]
  v_exp_f32_e64 v200, v200
  v_mfma_f32_16x16x32_bf16 v[196:199], a[144:147], a[92:95], v[228:231]
  v_exp_f32_e64 v204, v204
  v_mfma_f32_16x16x32_bf16 v[196:199], a[148:151], a[88:91], v[196:199]
  v_cvt_pk_bf16_f32 v208, v200, v201
  v_cvt_pk_bf16_f32 v210, v204, v205
  v_mfma_f32_16x16x32_bf16 v[196:199], a[152:155], a[84:87], v[196:199]
  v_cvt_pk_bf16_f32 v209, v202, v203
  v_cvt_pk_bf16_f32 v211, v206, v207
  v_mfma_f32_16x16x32_bf16 v[196:199], a[156:159], a[80:83], v[196:199]
  ds_read_b128 a[128:131], v216 offset:0
  ds_read_b128 a[132:135], v216 offset:64
  v_mfma_f32_16x16x32_bf16 v[128:131], v[208:211], a[160:163], v[128:131]
  ds_read_b128 a[136:139], v216 offset:128
  ds_read_b128 a[140:143], v216 offset:192
  v_mfma_f32_16x16x32_bf16 v[132:135], v[208:211], a[164:167], v[132:135]
  ds_read_b128 a[144:147], v216 offset:704
  ds_read_b128 a[148:151], v216 offset:640
  v_mfma_f32_16x16x32_bf16 v[136:139], v[208:211], a[168:171], v[136:139]
  v_mul_f32 v200, s29, v192
  v_mul_f32 v201, s29, v193
  v_mfma_f32_16x16x32_bf16 v[140:143], v[208:211], a[172:175], v[140:143]
  ds_read_b128 a[152:155], v216 offset:576
  v_mul_f32_e64 v202, s29, v194
  v_mfma_f32_16x16x32_bf16 v[144:147], v[208:211], a[176:179], v[144:147]
  ds_read_b128 a[156:159], v216 offset:512
  v_mul_f32_e64 v203, s29, v195
  v_mfma_f32_16x16x32_bf16 v[148:151], v[208:211], a[180:183], v[148:151]
  v_mul_f32 v204, s29, v196
  v_mul_f32 v207, s29, v199
  v_mfma_f32_16x16x32_bf16 v[152:155], v[208:211], a[184:187], v[152:155]
  v_mul_f32 v205, s29, v197
  v_mul_f32 v206, s29, v198
  v_mfma_f32_16x16x32_bf16 v[156:159], v[208:211], a[188:191], v[156:159]
  v_exp_f32_e64 v206, v206
  s_barrier
  s_add_u32 m0, s32, 16896
  s_xor_b32 s50, 32768, s3
  buffer_load_dwordx4 v221, s[4:7], s50 offen lds
  s_add_u32 m0, s32, 16928
  s_add_u32 s51, s32, s96
  buffer_load_dwordx4 v221, s[4:7], s50 offen offset:1024 lds
  s_add_u32 m0, s51, 16896
  s_nop 0
  buffer_load_dwordx4 v221, s[8:11], s50 offen lds
  s_add_u32 m0, s51, 16912
  s_nop 0
  buffer_load_dwordx4 v221, s[8:11], s50 offen offset:1024 lds
  s_waitcnt vmcnt(4)
  s_waitcnt lgkmcnt(7)
  v_mfma_f32_16x16x32_bf16 v[192:195], a[128:131], a[0:3], v[228:231]
  s_waitcnt lgkmcnt(6)
  v_exp_f32 v203, v203
  v_mfma_f32_16x16x32_bf16 v[192:195], a[132:135], a[4:7], v[192:195]
  s_waitcnt lgkmcnt(5)
  v_exp_f32 v201, v201
  v_mfma_f32_16x16x32_bf16 v[192:195], a[136:139], a[8:11], v[192:195]
  s_waitcnt lgkmcnt(4)
  v_exp_f32 v202, v202
  v_mfma_f32_16x16x32_bf16 v[192:195], a[140:143], a[12:15], v[192:195]
  s_waitcnt lgkmcnt(3)
  v_exp_f32 v207, v207
  v_mfma_f32_16x16x32_bf16 v[196:199], a[144:147], a[12:15], v[228:231]
  s_waitcnt lgkmcnt(2)
  v_exp_f32 v205, v205
  v_mfma_f32_16x16x32_bf16 v[196:199], a[148:151], a[8:11], v[196:199]
  s_waitcnt lgkmcnt(1)
  v_exp_f32 v200, v200
  v_exp_f32_e64 v204, v204
  v_mfma_f32_16x16x32_bf16 v[196:199], a[152:155], a[4:7], v[196:199]
  s_waitcnt lgkmcnt(0)
  v_cvt_pk_bf16_f32 v212, v200, v201
  v_cvt_pk_bf16_f32 v213, v202, v203
  v_cvt_pk_bf16_f32 v214, v204, v205
  v_cvt_pk_bf16_f32 v215, v206, v207
  v_mfma_f32_16x16x32_bf16 v[196:199], a[156:159], a[0:3], v[196:199]
  v_mul_f32 v200, s29, v192
  v_mul_f32_e64 v203, s29, v195
  v_mfma_f32_16x16x32_bf16 v[160:163], v[212:215], a[160:163], v[160:163]
  v_mul_f32 v201, s29, v193
  v_mul_f32 v202, s29, v194
  v_mfma_f32_16x16x32_bf16 v[164:167], v[212:215], a[164:167], v[164:167]
  v_exp_f32_e64 v200, v200
  v_mfma_f32_16x16x32_bf16 v[168:171], v[212:215], a[168:171], v[168:171]
  v_exp_f32_e64 v203, v203
  v_mfma_f32_16x16x32_bf16 v[172:175], v[212:215], a[172:175], v[172:175]
  ds_read_b64_tr_b16 a[162:163], v217 offset:8960
  ds_read_b64_tr_b16 a[166:167], v217 offset:8976
  v_mfma_f32_16x16x32_bf16 v[176:179], v[212:215], a[176:179], v[176:179]
  ds_read_b64_tr_b16 a[170:171], v217 offset:8992
  v_mul_f32_e64 v205, s29, v197
  v_mfma_f32_16x16x32_bf16 v[180:183], v[212:215], a[180:183], v[180:183]
  ds_read_b64_tr_b16 a[164:165], v217 offset:8464
  ds_read_b64_tr_b16 a[172:173], v217 offset:8496
  v_mfma_f32_16x16x32_bf16 v[184:187], v[212:215], a[184:187], v[184:187]
  v_exp_f32_e64 v202, v202
  v_mfma_f32_16x16x32_bf16 v[188:191], v[212:215], a[188:191], v[188:191]
  ds_read_b64_tr_b16 a[168:169], v217 offset:8480
  v_mul_f32_e64 v204, s29, v196
  v_smfmac_f32_16x16x64_bf16 a[200:203], a[220:223], v[208:215], v254
  ds_read_b64_tr_b16 a[160:161], v217 offset:8448
  ds_read_b64_tr_b16 a[174:175], v217 offset:9008
  v_exp_f32 v201, v201
  v_mul_f32 v206, s29, v198
  v_mul_f32 v207, s29, v199
  s_branch L_pG1
L_startA:
  ds_read_b128 a[128:131], v216 offset:33792
  ds_read_b128 a[132:135], v216 offset:33856
  ds_read_b128 a[136:139], v216 offset:33920
  ds_read_b128 a[140:143], v216 offset:33984
  ds_read_b128 a[144:147], v216 offset:34496
  ds_read_b128 a[148:151], v216 offset:34432
  ds_read_b128 a[152:155], v216 offset:34368
  ds_read_b128 a[156:159], v216 offset:34304
  ds_read_b128 a[0:3], v224 offset:0
  ds_read_b128 a[4:7], v225 offset:0
  ds_read_b128 a[8:11], v226 offset:0
  ds_read_b128 a[12:15], v227 offset:0
  s_cmp_lt_u32 s58, 4
  s_cbranch_scc1 L_y4
  s_waitcnt vmcnt(0)
L_y4:
  s_add_u32 m0, s49, 8192
  s_add_u32 s50, s39, 8192
  buffer_load_dwordx4 v222, s[12:15], s50 offen nt lds
  buffer_load_dwordx4 v223, s[12:15], s50 offen offset:1024 nt lds
  buffer_load_dwordx4 v222, s[12:15], s50 offen offset:2048 nt lds
  buffer_load_dwordx4 v223, s[12:15], s50 offen offset:3072 nt lds
  s_waitcnt lgkmcnt(3)
  v_mfma_f32_16x16x32_bf16 v[192:195], a[128:131], a[0:3], v[228:231]
  ds_read_b64_tr_b16 a[160:161], v217 offset:42240
  ds_read_b64_tr_b16 a[162:163], v217 offset:42752
  s_waitcnt lgkmcnt(4)
  v_mfma_f32_16x16x32_bf16 v[192:195], a[132:135], a[4:7], v[192:195]
  ds_read_b64_tr_b16 a[164:165], v217 offset:42256
  ds_read_b64_tr_b16 a[166:167], v217 offset:42768
  s_waitcnt lgkmcnt(5)
  v_mfma_f32_16x16x32_bf16 v[192:195], a[136:139], a[8:11], v[192:195]
  ds_read_b64_tr_b16 a[168:169], v217 offset:42272
  ds_read_b64_tr_b16 a[170:171], v217 offset:42784
  s_waitcnt lgkmcnt(6)
  v_mfma_f32_16x16x32_bf16 v[192:195], a[140:143], a[12:15], v[192:195]
  ds_read_b64_tr_b16 a[172:173], v217 offset:42288
  ds_read_b64_tr_b16 a[174:175], v217 offset:42800
  v_mfma_f32_16x16x32_bf16 v[196:199], a[144:147], a[12:15], v[228:231]
  ds_read_b64_tr_b16 a[176:177], v217 offset:42304
  ds_read_b64_tr_b16 a[178:179], v217 offset:42816
  v_mfma_f32_16x16x32_bf16 v[196:199], a[148:151], a[8:11], v[196:199]
  ds_read_b64_tr_b16 a[180:181], v217 offset:42320
  ds_read_b64_tr_b16 a[182:183], v217 offset:42832
  v_mfma_f32_16x16x32_bf16 v[196:199], a[152:155], a[4:7], v[196:199]
  v_mul_f32 v200, s29, v192
  v_mul_f32_e64 v203, s29, v195
  v_mfma_f32_16x16x32_bf16 v[196:199], a[156:159], a[0:3], v[196:199]
  v_mul_f32 v201, s29, v193
  v_mul_f32_e64 v202, s29, v194
  s_waitcnt vmcnt(4)
  s_barrier
  ds_read_b128 a[16:19], v224 offset:4096
  ds_read_b128 a[20:23], v225 offset:4096
  ds_read_b128 a[24:27], v226 offset:4096
  ds_read_b128 a[28:31], v227 offset:4096
  s_cmp_lt_u32 s58, 5
  s_cbranch_scc1 L_y5
  s_waitcnt vmcnt(0)
L_y5:
  s_add_u32 m0, s49, 12288
  s_add_u32 s50, s39, 12288
  buffer_load_dwordx4 v222, s[12:15], s50 offen nt lds
  buffer_load_dwordx4 v223, s[12:15], s50 offen offset:1024 nt lds
  buffer_load_dwordx4 v222, s[12:15], s50 offen offset:2048 nt lds
  buffer_load_dwordx4 v223, s[12:15], s50 offen offset:3072 nt lds
  s_cmp_lt_u32 s58, 6
  s_cbranch_scc1 L_y6
  s_waitcnt vmcnt(0)
L_y6:
  s_mov_b32 m0, s49
  s_nop 0
  buffer_load_dwordx4 v222, s[12:15], s40 offen nt lds
  buffer_load_dwordx4 v223, s[12:15], s40 offen offset:1024 nt lds
  buffer_load_dwordx4 v222, s[12:15], s40 offen offset:2048 nt lds
  buffer_load_dwordx4 v223, s[12:15], s40 offen offset:3072 nt lds
  s_waitcnt lgkmcnt(3)
  v_mfma_f32_16x16x32_bf16 v[192:195], a[128:131], a[16:19], v[228:231]
  s_waitcnt lgkmcnt(2)
  v_exp_f32 v202, v202
  v_mfma_f32_16x16x32_bf16 v[192:195], a[132:135], a[20:23], v[192:195]
  s_waitcnt lgkmcnt(1)
  v_exp_f32 v200, v200
  v_mfma_f32_16x16x32_bf16 v[192:195], a[136:139], a[24:27], v[192:195]
  s_waitcnt lgkmcnt(0)
  v_mul_f32 v205, s29, v197
  v_mul_f32_e64 v206, s29, v198
  v_mfma_f32_16x16x32_bf16 v[192:195], a[140:143], a[28:31], v[192:195]
  v_mul_f32 v204, s29, v196
  v_mul_f32 v207, s29, v199
  v_mfma_f32_16x16x32_bf16 v[196:199], a[144:147], a[28:31], v[228:231]
  v_exp_f32_e64 v207, v207
  v_mfma_f32_16x16x32_bf16 v[196:199], a[148:151], a[24:27], v[196:199]
  v_exp_f32 v201, v201
  v_exp_f32 v203, v203
  v_exp_f32 v204, v204
  v_exp_f32 v205, v205
  v_exp_f32_e64 v206, v206
  v_mfma_f32_16x16x32_bf16 v[196:199], a[152:155], a[20:23], v[196:199]
  v_cvt_pk_bf16_f32 v208, v200, v201
  v_cvt_pk_bf16_f32 v209, v202, v203
  v_cvt_pk_bf16_f32 v210, v204, v205
  v_cvt_pk_bf16_f32 v211, v206, v207
  v_mfma_f32_16x16x32_bf16 v[196:199], a[156:159], a[16:19], v[196:199]
  ds_read_b64_tr_b16 a[184:185], v217 offset:42336
  ds_read_b64_tr_b16 a[186:187], v217 offset:42848
  v_mfma_f32_16x16x32_bf16 v[0:3], v[208:211], a[160:163], 0
  ds_read_b64_tr_b16 a[188:189], v217 offset:42352
  ds_read_b64_tr_b16 a[190:191], v217 offset:42864
  v_mfma_f32_16x16x32_bf16 v[4:7], v[208:211], a[164:167], 0
  ds_read_b128 a[128:131], v216 offset:16896
  ds_read_b128 a[132:135], v216 offset:16960
  v_mfma_f32_16x16x32_bf16 v[8:11], v[208:211], a[168:171], 0
  ds_read_b128 a[136:139], v216 offset:17024
  ds_read_b128 a[140:143], v216 offset:17088
  v_mfma_f32_16x16x32_bf16 v[12:15], v[208:211], a[172:175], 0
  ds_read_b128 a[144:147], v216 offset:17600
  ds_read_b128 a[148:151], v216 offset:17536
  v_mfma_f32_16x16x32_bf16 v[16:19], v[208:211], a[176:179], 0
  s_waitcnt lgkmcnt(8)
  v_mul_f32 v200, s29, v192
  v_mul_f32_e64 v202, s29, v194
  v_mfma_f32_16x16x32_bf16 v[20:23], v[208:211], a[180:183], 0
  ds_read_b128 a[152:155], v216 offset:17472
  v_mul_f32_e64 v203, s29, v195
  v_mfma_f32_16x16x32_bf16 v[24:27], v[208:211], a[184:187], 0
  ds_read_b128 a[156:159], v216 offset:17408
  v_mul_f32 v201, s29, v193
  s_waitcnt lgkmcnt(8)
  v_mfma_f32_16x16x32_bf16 v[28:31], v[208:211], a[188:191], 0
  s_waitcnt lgkmcnt(7)
  v_mul_f32 v205, s29, v197
  v_mul_f32_e64 v207, s29, v199
  v_mfma_f32_16x16x32_bf16 v[192:195], a[128:131], a[0:3], v[228:231]
  s_waitcnt lgkmcnt(6)
  v_mul_f32 v204, s29, v196
  v_mul_f32_e64 v206, s29, v198
  v_mfma_f32_16x16x32_bf16 v[192:195], a[132:135], a[4:7], v[192:195]
  s_waitcnt lgkmcnt(5)
  v_exp_f32 v207, v207
  v_mfma_f32_16x16x32_bf16 v[192:195], a[136:139], a[8:11], v[192:195]
  s_waitcnt lgkmcnt(4)
  v_exp_f32 v201, v201
  v_mfma_f32_16x16x32_bf16 v[192:195], a[140:143], a[12:15], v[192:195]
  s_waitcnt lgkmcnt(3)
  v_exp_f32 v204, v204
  v_mfma_f32_16x16x32_bf16 v[196:199], a[144:147], a[12:15], v[228:231]
  s_waitcnt lgkmcnt(2)
  v_exp_f32 v206, v206
  v_mfma_f32_16x16x32_bf16 v[196:199], a[148:151], a[8:11], v[196:199]
  s_waitcnt lgkmcnt(1)
  v_exp_f32 v200, v200
  v_exp_f32 v202, v202
  v_exp_f32 v203, v203
  v_exp_f32_e64 v205, v205
  v_mfma_f32_16x16x32_bf16 v[196:199], a[152:155], a[4:7], v[196:199]
  s_waitcnt lgkmcnt(0)
  v_cvt_pk_bf16_f32 v212, v200, v201
  v_cvt_pk_bf16_f32 v213, v202, v203
  v_cvt_pk_bf16_f32 v214, v204, v205
  v_cvt_pk_bf16_f32 v215, v206, v207
  v_mfma_f32_16x16x32_bf16 v[196:199], a[156:159], a[0:3], v[196:199]
  v_mul_f32 v202, s29, v194
  v_mul_f32_e64 v203, s29, v195
  v_mfma_f32_16x16x32_bf16 v[32:35], v[212:215], a[160:163], 0
  v_mul_f32 v200, s29, v192
  v_mul_f32 v201, s29, v193
  v_mfma_f32_16x16x32_bf16 v[36:39], v[212:215], a[164:167], 0
  ds_read_b64_tr_b16 a[160:161], v217 offset:25344
  ds_read_b64_tr_b16 a[162:163], v217 offset:25856
  v_mfma_f32_16x16x32_bf16 v[40:43], v[212:215], a[168:171], 0
  ds_read_b64_tr_b16 a[164:165], v217 offset:25360
  ds_read_b64_tr_b16 a[166:167], v217 offset:25872
  v_mfma_f32_16x16x32_bf16 v[44:47], v[212:215], a[172:175], 0
  ds_read_b64_tr_b16 a[168:169], v217 offset:25376
  v_mul_f32_e64 v206, s29, v198
  v_mfma_f32_16x16x32_bf16 v[48:51], v[212:215], a[176:179], 0
  v_mul_f32 v205, s29, v197
  v_mul_f32 v207, s29, v199
  v_mfma_f32_16x16x32_bf16 v[52:55], v[212:215], a[180:183], 0
  ds_read_b64_tr_b16 a[170:171], v217 offset:25888
  v_mul_f32_e64 v204, s29, v196
  v_mfma_f32_16x16x32_bf16 v[56:59], v[212:215], a[184:187], 0
  ds_read_b64_tr_b16 a[172:173], v217 offset:25392
  ds_read_b64_tr_b16 a[174:175], v217 offset:25904
  v_mfma_f32_16x16x32_bf16 v[60:63], v[212:215], a[188:191], 0
  v_exp_f32_e64 v206, v206
  v_smfmac_f32_16x16x64_bf16 a[192:195], a[220:223], v[208:215], v254
  ds_read_b64_tr_b16 a[176:177], v217 offset:25408
  ds_read_b64_tr_b16 a[178:179], v217 offset:25920
  v_mfma_f32_16x16x32_bf16 v[192:195], a[128:131], a[16:19], v[228:231]
  v_exp_f32_e64 v200, v200
  v_mfma_f32_16x16x32_bf16 v[192:195], a[132:135], a[20:23], v[192:195]
  v_exp_f32_e64 v203, v203
  v_mfma_f32_16x16x32_bf16 v[192:195], a[136:139], a[24:27], v[192:195]
  v_exp_f32_e64 v201, v201
  v_mfma_f32_16x16x32_bf16 v[192:195], a[140:143], a[28:31], v[192:195]
  v_exp_f32_e64 v207, v207
  v_mfma_f32_16x16x32_bf16 v[196:199], a[144:147], a[28:31], v[228:231]
  v_exp_f32_e64 v202, v202
  v_mfma_f32_16x16x32_bf16 v[196:199], a[148:151], a[24:27], v[196:199]
  v_exp_f32 v204, v204
  v_exp_f32 v205, v205
  v_mfma_f32_16x16x32_bf16 v[196:199], a[152:155], a[20:23], v[196:199]
  ds_read_b64_tr_b16 a[180:181], v217 offset:25424
  ds_read_b64_tr_b16 a[182:183], v217 offset:25936
  v_cvt_pk_bf16_f32 v208, v200, v201
  v_cvt_pk_bf16_f32 v209, v202, v203
  v_cvt_pk_bf16_f32 v210, v204, v205
  v_cvt_pk_bf16_f32 v211, v206, v207
  v_mfma_f32_16x16x32_bf16 v[196:199], a[156:159], a[16:19], v[196:199]
  ds_read_b64_tr_b16 a[184:185], v217 offset:25440
  ds_read_b64_tr_b16 a[186:187], v217 offset:25952
  s_waitcnt lgkmcnt(12)
  v_mfma_f32_16x16x32_bf16 v[0:3], v[208:211], a[160:163], v[0:3]
  ds_read_b64_tr_b16 a[188:189], v217 offset:25456
  ds_read_b64_tr_b16 a[190:191], v217 offset:25968
  s_waitcnt lgkmcnt(12)
  v_mfma_f32_16x16x32_bf16 v[4:7], v[208:211], a[164:167], v[4:7]
  s_waitcnt lgkmcnt(10)
  v_mul_f32 v200, s29, v192
  v_mul_f32_e64 v202, s29, v194
  v_mfma_f32_16x16x32_bf16 v[8:11], v[208:211], a[168:171], v[8:11]
  s_waitcnt lgkmcnt(8)
  v_mul_f32 v201, s29, v193
  v_mul_f32_e64 v203, s29, v195
  v_mfma_f32_16x16x32_bf16 v[12:15], v[208:211], a[172:175], v[12:15]
  v_mul_f32 v206, s29, v198
  v_mul_f32_e64 v207, s29, v199
  s_waitcnt vmcnt(8)
  ds_read_b128 a[32:35], v224 offset:8192
  ds_read_b128 a[36:39], v225 offset:8192
  ds_read_b128 a[40:43], v226 offset:8192
  ds_read_b128 a[44:47], v227 offset:8192
  s_cmp_lt_u32 s58, 7
  s_cbranch_scc1 L_y7
  s_waitcnt vmcnt(0)
L_y7:
  s_add_u32 m0, s49, 16384
  s_add_u32 s50, s39, 16384
  buffer_load_dwordx4 v222, s[12:15], s50 offen nt lds
  buffer_load_dwordx4 v223, s[12:15], s50 offen offset:1024 nt lds
  buffer_load_dwordx4 v222, s[12:15], s50 offen offset:2048 nt lds
  buffer_load_dwordx4 v223, s[12:15], s50 offen offset:3072 nt lds
  s_waitcnt lgkmcnt(10)
  v_mfma_f32_16x16x32_bf16 v[16:19], v[208:211], a[176:179], v[16:19]
  s_waitcnt lgkmcnt(8)
  v_mul_f32 v204, s29, v196
  v_mul_f32_e64 v205, s29, v197
  v_mfma_f32_16x16x32_bf16 v[20:23], v[208:211], a[180:183], v[20:23]
  s_waitcnt lgkmcnt(6)
  v_exp_f32 v203, v203
  v_mfma_f32_16x16x32_bf16 v[24:27], v[208:211], a[184:187], v[24:27]
  s_waitcnt lgkmcnt(4)
  v_exp_f32 v207, v207
  v_mfma_f32_16x16x32_bf16 v[28:31], v[208:211], a[188:191], v[28:31]
  s_waitcnt lgkmcnt(3)
  v_exp_f32 v201, v201
  v_mfma_f32_16x16x32_bf16 v[192:195], a[128:131], a[32:35], v[228:231]
  s_waitcnt lgkmcnt(2)
  v_exp_f32 v200, v200
  v_mfma_f32_16x16x32_bf16 v[192:195], a[132:135], a[36:39], v[192:195]
  s_waitcnt lgkmcnt(1)
  v_exp_f32 v204, v204
  v_mfma_f32_16x16x32_bf16 v[192:195], a[136:139], a[40:43], v[192:195]
  s_waitcnt lgkmcnt(0)
  v_exp_f32 v202, v202
  v_mfma_f32_16x16x32_bf16 v[192:195], a[140:143], a[44:47], v[192:195]
  v_exp_f32_e64 v206, v206
  v_mfma_f32_16x16x32_bf16 v[196:199], a[144:147], a[44:47], v[228:231]
  v_exp_f32_e64 v205, v205
  v_mfma_f32_16x16x32_bf16 v[196:199], a[148:151], a[40:43], v[196:199]
  v_cvt_pk_bf16_f32 v213, v202, v203
  v_cvt_pk_bf16_f32 v215, v206, v207
  v_mfma_f32_16x16x32_bf16 v[196:199], a[152:155], a[36:39], v[196:199]
  v_cvt_pk_bf16_f32 v212, v200, v201
  v_cvt_pk_bf16_f32 v214, v204, v205
  v_mfma_f32_16x16x32_bf16 v[196:199], a[156:159], a[32:35], v[196:199]
  v_mul_f32 v200, s29, v192
  v_mul_f32 v201, s29, v193
  v_smfmac_f32_16x16x64_bf16 a[192:195], a[220:223], v[208:215], v254
  v_mul_f32_e64 v203, s29, v195
  v_mfma_f32_16x16x32_bf16 v[32:35], v[212:215], a[160:163], v[32:35]
  v_exp_f32_e64 v200, v200
  v_mfma_f32_16x16x32_bf16 v[36:39], v[212:215], a[164:167], v[36:39]
  v_mul_f32 v202, s29, v194
  v_mul_f32 v205, s29, v197
  v_mfma_f32_16x16x32_bf16 v[40:43], v[212:215], a[168:171], v[40:43]
  v_mul_f32 v204, s29, v196
  v_mul_f32 v207, s29, v199
  v_mfma_f32_16x16x32_bf16 v[44:47], v[212:215], a[172:175], v[44:47]
  v_exp_f32_e64 v207, v207
  s_waitcnt vmcnt(8)
  ds_read_b128 a[48:51], v224 offset:12288
  ds_read_b128 a[52:55], v225 offset:12288
  ds_read_b128 a[56:59], v226 offset:12288
  ds_read_b128 a[60:63], v227 offset:12288
  s_cmp_lt_u32 s58, 8
  s_cbranch_scc1 L_y8
  s_waitcnt vmcnt(0)
L_y8:
  s_add_u32 m0, s49, 20480
  s_add_u32 s50, s39, 20480
  buffer_load_dwordx4 v222, s[12:15], s50 offen nt lds
  buffer_load_dwordx4 v223, s[12:15], s50 offen offset:1024 nt lds
  buffer_load_dwordx4 v222, s[12:15], s50 offen offset:2048 nt lds
  buffer_load_dwordx4 v223, s[12:15], s50 offen offset:3072 nt lds
  v_mfma_f32_16x16x32_bf16 v[48:51], v[212:215], a[176:179], v[48:51]
  v_exp_f32_e64 v203, v203
  v_mfma_f32_16x16x32_bf16 v[52:55], v[212:215], a[180:183], v[52:55]
  v_exp_f32_e64 v204, v204
  v_mfma_f32_16x16x32_bf16 v[56:59], v[212:215], a[184:187], v[56:59]
  v_exp_f32_e64 v202, v202
  v_mfma_f32_16x16x32_bf16 v[60:63], v[212:215], a[188:191], v[60:63]
  s_waitcnt lgkmcnt(3)
  v_mul_f32 v206, s29, v198
  v_cvt_pk_bf16_f32 v209, v202, v203
  v_mfma_f32_16x16x32_bf16 v[192:195], a[128:131], a[48:51], v[228:231]
  s_waitcnt lgkmcnt(2)
  v_exp_f32 v206, v206
  v_mfma_f32_16x16x32_bf16 v[192:195], a[132:135], a[52:55], v[192:195]
  s_waitcnt lgkmcnt(1)
  v_exp_f32 v205, v205
  v_mfma_f32_16x16x32_bf16 v[192:195], a[136:139], a[56:59], v[192:195]
  s_waitcnt lgkmcnt(0)
  v_exp_f32 v201, v201
  v_mfma_f32_16x16x32_bf16 v[192:195], a[140:143], a[60:63], v[192:195]
  v_cvt_pk_bf16_f32 v210, v204, v205
  v_cvt_pk_bf16_f32 v211, v206, v207
  v_mfma_f32_16x16x32_bf16 v[196:199], a[144:147], a[60:63], v[228:231]
  ds_read_b128 a[128:131], v216 offset:33792
  v_cvt_pk_bf16_f32 v208, v200, v201
  v_mfma_f32_16x16x32_bf16 v[196:199], a[148:151], a[56:59], v[196:199]
  ds_read_b128 a[132:135], v216 offset:33856
  ds_read_b128 a[136:139], v216 offset:33920
  v_mfma_f32_16x16x32_bf16 v[196:199], a[152:155], a[52:55], v[196:199]
  ds_read_b128 a[140:143], v216 offset:33984
  ds_read_b128 a[144:147], v216 offset:34496
  v_mfma_f32_16x16x32_bf16 v[196:199], a[156:159], a[48:51], v[196:199]
  ds_read_b128 a[148:151], v216 offset:34432
  v_mul_f32_e64 v201, s29, v193
  v_mfma_f32_16x16x32_bf16 v[64:67], v[208:211], a[160:163], 0
  v_mul_f32 v200, s29, v192
  v_mul_f32 v202, s29, v194
  v_mfma_f32_16x16x32_bf16 v[68:71], v[208:211], a[164:167], 0
  ds_read_b128 a[152:155], v216 offset:34368
  v_mul_f32_e64 v203, s29, v195
  v_mfma_f32_16x16x32_bf16 v[72:75], v[208:211], a[168:171], 0
  ds_read_b128 a[156:159], v216 offset:34304
  v_mul_f32_e64 v205, s29, v197
  v_mfma_f32_16x16x32_bf16 v[76:79], v[208:211], a[172:175], 0
  v_mul_f32 v204, s29, v196
  v_mul_f32 v207, s29, v199
  v_mfma_f32_16x16x32_bf16 v[80:83], v[208:211], a[176:179], 0
  v_exp_f32_e64 v203, v203
  v_mfma_f32_16x16x32_bf16 v[84:87], v[208:211], a[180:183], 0
  v_exp_f32_e64 v201, v201
  v_mfma_f32_16x16x32_bf16 v[88:91], v[208:211], a[184:187], 0
  v_exp_f32_e64 v205, v205
  v_mfma_f32_16x16x32_bf16 v[92:95], v[208:211], a[188:191], 0
  s_waitcnt lgkmcnt(7)
  v_exp_f32 v204, v204
  v_mfma_f32_16x16x32_bf16 v[192:195], a[128:131], a[32:35], v[228:231]
  s_waitcnt lgkmcnt(6)
  v_mul_f32 v206, s29, v198
  v_cvt_pk_bf16_f32 v214, v204, v205
  v_mfma_f32_16x16x32_bf16 v[192:195], a[132:135], a[36:39], v[192:195]
  s_waitcnt lgkmcnt(5)
  v_exp_f32 v207, v207
  v_mfma_f32_16x16x32_bf16 v[192:195], a[136:139], a[40:43], v[192:195]
  s_waitcnt lgkmcnt(4)
  v_exp_f32 v202, v202
  v_mfma_f32_16x16x32_bf16 v[192:195], a[140:143], a[44:47], v[192:195]
  s_waitcnt lgkmcnt(3)
  v_exp_f32 v200, v200
  v_mfma_f32_16x16x32_bf16 v[196:199], a[144:147], a[44:47], v[228:231]
  s_waitcnt lgkmcnt(2)
  v_exp_f32 v206, v206
  v_mfma_f32_16x16x32_bf16 v[196:199], a[148:151], a[40:43], v[196:199]
  s_waitcnt lgkmcnt(1)
  v_cvt_pk_bf16_f32 v213, v202, v203
  v_cvt_pk_bf16_f32 v215, v206, v207
  v_mfma_f32_16x16x32_bf16 v[196:199], a[152:155], a[36:39], v[196:199]
  s_waitcnt lgkmcnt(0)
  v_cvt_pk_bf16_f32 v212, v200, v201
  v_mul_f32_e64 v201, s29, v193
  v_mfma_f32_16x16x32_bf16 v[196:199], a[156:159], a[32:35], v[196:199]
  v_mul_f32 v200, s29, v192
  v_mul_f32 v203, s29, v195
  v_mfma_f32_16x16x32_bf16 v[96:99], v[212:215], a[160:163], 0
  ds_read_b64_tr_b16 a[162:163], v217 offset:42752
  v_mul_f32_e64 v202, s29, v194
  v_mfma_f32_16x16x32_bf16 v[100:103], v[212:215], a[164:167], 0
  ds_read_b64_tr_b16 a[160:161], v217 offset:42240
  ds_read_b64_tr_b16 a[166:167], v217 offset:42768
  v_mfma_f32_16x16x32_bf16 v[104:107], v[212:215], a[168:171], 0
  ds_read_b64_tr_b16 a[164:165], v217 offset:42256
  v_mul_f32_e64 v205, s29, v197
  v_mfma_f32_16x16x32_bf16 v[108:111], v[212:215], a[172:175], 0
  ds_read_b64_tr_b16 a[170:171], v217 offset:42784
  v_mul_f32_e64 v206, s29, v198
  v_mfma_f32_16x16x32_bf16 v[112:115], v[212:215], a[176:179], 0
  ds_read_b64_tr_b16 a[168:169], v217 offset:42272
  v_mul_f32_e64 v204, s29, v196
  v_mfma_f32_16x16x32_bf16 v[116:119], v[212:215], a[180:183], 0
  ds_read_b64_tr_b16 a[174:175], v217 offset:42800
  v_mul_f32_e64 v207, s29, v199
  v_mfma_f32_16x16x32_bf16 v[120:123], v[212:215], a[184:187], 0
  ds_read_b64_tr_b16 a[172:173], v217 offset:42288
  ds_read_b64_tr_b16 a[178:179], v217 offset:42816
  v_mfma_f32_16x16x32_bf16 v[124:127], v[212:215], a[188:191], 0
  v_exp_f32_e64 v201, v201
  v_smfmac_f32_16x16x64_bf16 a[196:199], a[220:223], v[208:215], v254
  ds_read_b64_tr_b16 a[176:177], v217 offset:42304
  ds_read_b64_tr_b16 a[180:181], v217 offset:42320
  s_add_u32 m0, s32, 0
  s_xor_b32 s50, 16384, s3
  buffer_load_dwordx4 v221, s[4:7], s50 offen lds
  s_add_u32 m0, s32, 32
  s_add_u32 s51, s32, s96
  buffer_load_dwordx4 v221, s[4:7], s50 offen offset:1024 lds
  s_add_u32 m0, s51, 0
  s_nop 0
  buffer_load_dwordx4 v221, s[8:11], s50 offen lds
  s_add_u32 m0, s51, 16
  s_nop 0
  buffer_load_dwordx4 v221, s[8:11], s50 offen offset:1024 lds
  v_mfma_f32_16x16x32_bf16 v[192:195], a[128:131], a[48:51], v[228:231]
  v_exp_f32 v202, v202
  v_mfma_f32_16x16x32_bf16 v[192:195], a[132:135], a[52:55], v[192:195]
  v_exp_f32_e64 v205, v205
  v_mfma_f32_16x16x32_bf16 v[192:195], a[136:139], a[56:59], v[192:195]
  v_exp_f32_e64 v207, v207
  v_mfma_f32_16x16x32_bf16 v[192:195], a[140:143], a[60:63], v[192:195]
  v_exp_f32_e64 v200, v200
  v_mfma_f32_16x16x32_bf16 v[196:199], a[144:147], a[60:63], v[228:231]
  v_exp_f32_e64 v203, v203
  v_mfma_f32_16x16x32_bf16 v[196:199], a[148:151], a[56:59], v[196:199]
  s_waitcnt lgkmcnt(9)
  v_exp_f32 v204, v204
  v_exp_f32_e64 v206, v206
  v_mfma_f32_16x16x32_bf16 v[196:199], a[152:155], a[52:55], v[196:199]
  ds_read_b64_tr_b16 a[182:183], v217 offset:42832
  v_cvt_pk_bf16_f32 v208, v200, v201
  v_cvt_pk_bf16_f32 v209, v202, v203
  v_cvt_pk_bf16_f32 v210, v204, v205
  v_cvt_pk_bf16_f32 v211, v206, v207
  v_mfma_f32_16x16x32_bf16 v[196:199], a[156:159], a[48:51], v[196:199]
  ds_read_b64_tr_b16 a[184:185], v217 offset:42336
  ds_read_b64_tr_b16 a[186:187], v217 offset:42848
  v_mfma_f32_16x16x32_bf16 v[64:67], v[208:211], a[160:163], v[64:67]
  ds_read_b64_tr_b16 a[188:189], v217 offset:42352
  ds_read_b64_tr_b16 a[190:191], v217 offset:42864
  s_waitcnt lgkmcnt(12)
  v_mfma_f32_16x16x32_bf16 v[68:71], v[208:211], a[164:167], v[68:71]
  s_waitcnt lgkmcnt(10)
  v_mul_f32 v200, s29, v192
  v_mul_f32 v201, s29, v193
  v_mfma_f32_16x16x32_bf16 v[72:75], v[208:211], a[168:171], v[72:75]
  s_waitcnt lgkmcnt(8)
  v_mul_f32 v202, s29, v194
  v_mul_f32_e64 v203, s29, v195
  v_mfma_f32_16x16x32_bf16 v[76:79], v[208:211], a[172:175], v[76:79]
  s_waitcnt lgkmcnt(6)
  v_mul_f32 v205, s29, v197
  v_mul_f32 v207, s29, v199
  s_waitcnt vmcnt(12)
  ds_read_b128 a[96:99], v224 offset:0
  ds_read_b128 a[100:103], v225 offset:0
  ds_read_b128 a[104:107], v226 offset:0
  ds_read_b128 a[108:111], v227 offset:0
  v_mfma_f32_16x16x32_bf16 v[80:83], v[208:211], a[176:179], v[80:83]
  s_waitcnt lgkmcnt(8)
  v_mul_f32 v204, s29, v196
  v_mul_f32_e64 v206, s29, v198
  v_mfma_f32_16x16x32_bf16 v[84:87], v[208:211], a[180:183], v[84:87]
  s_waitcnt lgkmcnt(6)
  v_exp_f32 v205, v205
  v_mfma_f32_16x16x32_bf16 v[88:91], v[208:211], a[184:187], v[88:91]
  s_waitcnt lgkmcnt(4)
  v_exp_f32 v206, v206
  v_mfma_f32_16x16x32_bf16 v[92:95], v[208:211], a[188:191], v[92:95]
  v_exp_f32 v200, v200
  s_barrier
  s_add_u32 m0, s32, 33792
  s_xor_b32 s50, 24576, s3
  buffer_load_dwordx4 v221, s[4:7], s50 offen lds
  s_add_u32 m0, s32, 33824
  s_add_u32 s51, s32, s96
  buffer_load_dwordx4 v221, s[4:7], s50 offen offset:1024 lds
  s_add_u32 m0, s51, 33792
  s_nop 0
  buffer_load_dwordx4 v221, s[8:11], s50 offen lds
  s_add_u32 m0, s51, 33808
  s_nop 0
  buffer_load_dwordx4 v221, s[8:11], s50 offen offset:1024 lds
  s_waitcnt lgkmcnt(3)
  v_mfma_f32_16x16x32_bf16 v[192:195], a[128:131], a[96:99], v[228:231]
  s_waitcnt lgkmcnt(2)
  v_exp_f32 v202, v202
  v_mfma_f32_16x16x32_bf16 v[192:195], a[132:135], a[100:103], v[192:195]
  s_waitcnt lgkmcnt(1)
  v_exp_f32 v203, v203
  v_mfma_f32_16x16x32_bf16 v[192:195], a[136:139], a[104:107], v[192:195]
  s_waitcnt lgkmcnt(0)
  v_exp_f32 v201, v201
  v_mfma_f32_16x16x32_bf16 v[192:195], a[140:143], a[108:111], v[192:195]
  v_exp_f32_e64 v204, v204
  v_mfma_f32_16x16x32_bf16 v[196:199], a[144:147], a[108:111], v[228:231]
  v_exp_f32_e64 v207, v207
  v_mfma_f32_16x16x32_bf16 v[196:199], a[148:151], a[104:107], v[196:199]
  v_cvt_pk_bf16_f32 v212, v200, v201
  v_cvt_pk_bf16_f32 v214, v204, v205
  v_mfma_f32_16x16x32_bf16 v[196:199], a[152:155], a[100:103], v[196:199]
  v_cvt_pk_bf16_f32 v213, v202, v203
  v_cvt_pk_bf16_f32 v215, v206, v207
  v_mfma_f32_16x16x32_bf16 v[196:199], a[156:159], a[96:99], v[196:199]
  v_mul_f32 v200, s29, v192
  v_mul_f32 v201, s29, v193
  v_smfmac_f32_16x16x64_bf16 a[196:199], a[220:223], v[208:215], v254
  v_mul_f32_e64 v202, s29, v194
  v_mfma_f32_16x16x32_bf16 v[96:99], v[212:215], a[160:163], v[96:99]
  v_exp_f32_e64 v200, v200
  v_mfma_f32_16x16x32_bf16 v[100:103], v[212:215], a[164:167], v[100:103]
  v_mul_f32 v203, s29, v195
  v_mul_f32 v206, s29, v198
  v_mfma_f32_16x16x32_bf16 v[104:107], v[212:215], a[168:171], v[104:107]
  v_mul_f32 v204, s29, v196
  v_mul_f32 v207, s29, v199
  v_mfma_f32_16x16x32_bf16 v[108:111], v[212:215], a[172:175], v[108:111]
  v_exp_f32 v203, v203
  s_waitcnt vmcnt(12)
  ds_read_b128 a[64:67], v224 offset:16384
  ds_read_b128 a[68:71], v225 offset:16384
  ds_read_b128 a[72:75], v226 offset:16384
  ds_read_b128 a[76:79], v227 offset:16384
  v_mfma_f32_16x16x32_bf16 v[112:115], v[212:215], a[176:179], v[112:115]
  v_exp_f32_e64 v206, v206
  v_mfma_f32_16x16x32_bf16 v[116:119], v[212:215], a[180:183], v[116:119]
  v_exp_f32_e64 v207, v207
  v_mfma_f32_16x16x32_bf16 v[120:123], v[212:215], a[184:187], v[120:123]
  v_mul_f32_e64 v205, s29, v197
  v_cvt_pk_bf16_f32 v211, v206, v207
  v_mfma_f32_16x16x32_bf16 v[124:127], v[212:215], a[188:191], v[124:127]
  s_waitcnt lgkmcnt(3)
  v_exp_f32 v205, v205
  v_mfma_f32_16x16x32_bf16 v[192:195], a[128:131], a[64:67], v[228:231]
  s_waitcnt lgkmcnt(2)
  v_exp_f32 v204, v204
  v_mfma_f32_16x16x32_bf16 v[192:195], a[132:135], a[68:71], v[192:195]
  s_waitcnt lgkmcnt(1)
  v_exp_f32 v201, v201
  v_mfma_f32_16x16x32_bf16 v[192:195], a[136:139], a[72:75], v[192:195]
  s_waitcnt lgkmcnt(0)
  v_exp_f32 v202, v202
  v_mfma_f32_16x16x32_bf16 v[192:195], a[140:143], a[76:79], v[192:195]
  v_cvt_pk_bf16_f32 v209, v202, v203
  v_cvt_pk_bf16_f32 v210, v204, v205
  v_mfma_f32_16x16x32_bf16 v[196:199], a[144:147], a[76:79], v[228:231]
  v_cvt_pk_bf16_f32 v208, v200, v201
  v_mfma_f32_16x16x32_bf16 v[196:199], a[148:151], a[72:75], v[196:199]
  v_mfma_f32_16x16x32_bf16 v[196:199], a[152:155], a[68:71], v[196:199]
  v_mul_f32 v200, s29, v192
  v_mul_f32 v201, s29, v193
  v_mfma_f32_16x16x32_bf16 v[196:199], a[156:159], a[64:67], v[196:199]
  v_mul_f32 v202, s29, v194
  v_mul_f32 v203, s29, v195
  v_mfma_f32_16x16x32_bf16 a[204:207], a[220:223], v[208:211], 0
  v_exp_f32_e64 v200, v200
  v_mfma_f32_16x16x32_bf16 a[224:227], v[208:211], a[160:163], 0
  v_exp_f32_e64 v202, v202
  v_mfma_f32_16x16x32_bf16 a[228:231], v[208:211], a[164:167], 0
  v_mul_f32 v204, s29, v196
  v_mul_f32 v206, s29, v198
  v_mfma_f32_16x16x32_bf16 a[232:235], v[208:211], a[168:171], 0
  v_mul_f32 v205, s29, v197
  v_mul_f32 v207, s29, v199
  v_mfma_f32_16x16x32_bf16 a[236:239], v[208:211], a[172:175], 0
  v_exp_f32 v204, v204
  s_waitcnt vmcnt(8)
  ds_read_b128 a[80:83], v224 offset:20480
  ds_read_b128 a[84:87], v225 offset:20480
  ds_read_b128 a[88:91], v226 offset:20480
  ds_read_b128 a[92:95], v227 offset:20480
  v_mfma_f32_16x16x32_bf16 a[240:243], v[208:211], a[176:179], 0
  v_exp_f32_e64 v205, v205
  v_mfma_f32_16x16x32_bf16 a[244:247], v[208:211], a[180:183], 0
  v_exp_f32_e64 v206, v206
  v_mfma_f32_16x16x32_bf16 a[248:251], v[208:211], a[184:187], 0
  v_exp_f32_e64 v203, v203
  v_mfma_f32_16x16x32_bf16 a[252:255], v[208:211], a[188:191], 0
  s_waitcnt lgkmcnt(3)
  v_exp_f32 v201, v201
  v_mfma_f32_16x16x32_bf16 v[192:195], a[128:131], a[80:83], v[228:231]
  s_waitcnt lgkmcnt(2)
  v_exp_f32 v207, v207
  v_mfma_f32_16x16x32_bf16 v[192:195], a[132:135], a[84:87], v[192:195]
  s_waitcnt lgkmcnt(1)
  v_cvt_pk_bf16_f32 v209, v202, v203
  v_cvt_pk_bf16_f32 v211, v206, v207
  v_mfma_f32_16x16x32_bf16 v[192:195], a[136:139], a[88:91], v[192:195]
  s_waitcnt lgkmcnt(0)
  v_cvt_pk_bf16_f32 v208, v200, v201
  v_cvt_pk_bf16_f32 v210, v204, v205
  v_mfma_f32_16x16x32_bf16 v[192:195], a[140:143], a[92:95], v[192:195]
  ds_read_b128 a[128:131], v216 offset:16896
  ds_read_b128 a[132:135], v216 offset:16960
  v_mfma_f32_16x16x32_bf16 v[196:199], a[144:147], a[92:95], v[228:231]
  ds_read_b128 a[136:139], v216 offset:17024
  ds_read_b128 a[140:143], v216 offset:17088
  v_mfma_f32_16x16x32_bf16 v[196:199], a[148:151], a[88:91], v[196:199]
  ds_read_b128 a[144:147], v216 offset:17600
  ds_read_b128 a[148:151], v216 offset:17536
  v_mfma_f32_16x16x32_bf16 v[196:199], a[152:155], a[84:87], v[196:199]
  v_mul_f32 v200, s29, v192
  v_mul_f32 v201, s29, v193
  v_mfma_f32_16x16x32_bf16 v[196:199], a[156:159], a[80:83], v[196:199]
  ds_read_b128 a[152:155], v216 offset:17472
  v_mul_f32_e64 v203, s29, v195
  v_mfma_f32_16x16x32_bf16 v[128:131], v[208:211], a[160:163], 0
  ds_read_b128 a[156:159], v216 offset:17408
  v_mul_f32_e64 v202, s29, v194
  v_mfma_f32_16x16x32_bf16 v[132:135], v[208:211], a[164:167], 0
  v_exp_f32_e64 v201, v201
  v_mfma_f32_16x16x32_bf16 v[136:139], v[208:211], a[168:171], 0
  v_mul_f32 v205, s29, v197
  v_mul_f32 v207, s29, v199
  v_mfma_f32_16x16x32_bf16 v[140:143], v[208:211], a[172:175], 0
  v_mul_f32 v204, s29, v196
  v_mul_f32 v206, s29, v198
  v_mfma_f32_16x16x32_bf16 v[144:147], v[208:211], a[176:179], 0
  v_exp_f32_e64 v205, v205
  v_mfma_f32_16x16x32_bf16 v[148:151], v[208:211], a[180:183], 0
  v_exp_f32_e64 v203, v203
  v_mfma_f32_16x16x32_bf16 v[152:155], v[208:211], a[184:187], 0
  v_exp_f32_e64 v206, v206
  v_mfma_f32_16x16x32_bf16 v[156:159], v[208:211], a[188:191], 0
  s_waitcnt lgkmcnt(7)
  v_exp_f32 v207, v207
  v_mfma_f32_16x16x32_bf16 v[192:195], a[128:131], a[96:99], v[228:231]
  s_waitcnt lgkmcnt(6)
  v_exp_f32 v204, v204
  v_mfma_f32_16x16x32_bf16 v[192:195], a[132:135], a[100:103], v[192:195]
  s_waitcnt lgkmcnt(5)
  v_exp_f32 v200, v200
  v_mfma_f32_16x16x32_bf16 v[192:195], a[136:139], a[104:107], v[192:195]
  s_waitcnt lgkmcnt(4)
  v_exp_f32 v202, v202
  v_mfma_f32_16x16x32_bf16 v[192:195], a[140:143], a[108:111], v[192:195]
  s_waitcnt lgkmcnt(3)
  v_cvt_pk_bf16_f32 v212, v200, v201
  v_cvt_pk_bf16_f32 v215, v206, v207
  v_mfma_f32_16x16x32_bf16 v[196:199], a[144:147], a[108:111], v[228:231]
  s_waitcnt lgkmcnt(2)
  v_cvt_pk_bf16_f32 v213, v202, v203
  v_cvt_pk_bf16_f32 v214, v204, v205
  v_mfma_f32_16x16x32_bf16 v[196:199], a[148:151], a[104:107], v[196:199]
  s_waitcnt lgkmcnt(1)
  v_mfma_f32_16x16x32_bf16 v[196:199], a[152:155], a[100:103], v[196:199]
  s_waitcnt lgkmcnt(0)
  v_mul_f32 v202, s29, v194
  v_mul_f32 v203, s29, v195
  v_mfma_f32_16x16x32_bf16 v[196:199], a[156:159], a[96:99], v[196:199]
  v_mul_f32 v200, s29, v192
  v_mul_f32 v201, s29, v193
  v_mfma_f32_16x16x32_bf16 v[160:163], v[212:215], a[160:163], 0
  ds_read_b64_tr_b16 a[160:161], v217 offset:25344
  ds_read_b64_tr_b16 a[162:163], v217 offset:25856
  v_mfma_f32_16x16x32_bf16 v[164:167], v[212:215], a[164:167], 0
  ds_read_b64_tr_b16 a[164:165], v217 offset:25360
  ds_read_b64_tr_b16 a[166:167], v217 offset:25872
  v_mfma_f32_16x16x32_bf16 v[168:171], v[212:215], a[168:171], 0
  v_mul_f32 v204, s29, v196
  v_mul_f32 v205, s29, v197
  v_mfma_f32_16x16x32_bf16 v[172:175], v[212:215], a[172:175], 0
  v_mul_f32 v206, s29, v198
  v_mul_f32 v207, s29, v199
  v_mfma_f32_16x16x32_bf16 v[176:179], v[212:215], a[176:179], 0
  ds_read_b64_tr_b16 a[168:169], v217 offset:25376
  ds_read_b64_tr_b16 a[170:171], v217 offset:25888
  v_mfma_f32_16x16x32_bf16 v[180:183], v[212:215], a[180:183], 0
  ds_read_b64_tr_b16 a[172:173], v217 offset:25392
  ds_read_b64_tr_b16 a[174:175], v217 offset:25904
  v_mfma_f32_16x16x32_bf16 v[184:187], v[212:215], a[184:187], 0
  v_exp_f32_e64 v202, v202
  v_mfma_f32_16x16x32_bf16 v[188:191], v[212:215], a[188:191], 0
  v_exp_f32_e64 v201, v201
  v_smfmac_f32_16x16x64_bf16 a[200:203], a[220:223], v[208:215], v254
  ds_read_b64_tr_b16 a[176:177], v217 offset:25408
  ds_read_b64_tr_b16 a[178:179], v217 offset:25920
  v_mfma_f32_16x16x32_bf16 v[192:195], a[128:131], a[64:67], v[228:231]
  v_exp_f32_e64 v207, v207
  v_mfma_f32_16x16x32_bf16 v[192:195], a[132:135], a[68:71], v[192:195]
  v_exp_f32_e64 v206, v206
  v_mfma_f32_16x16x32_bf16 v[192:195], a[136:139], a[72:75], v[192:195]
  v_exp_f32_e64 v204, v204
  v_mfma_f32_16x16x32_bf16 v[192:195], a[140:143], a[76:79], v[192:195]
  v_exp_f32_e64 v200, v200
  v_mfma_f32_16x16x32_bf16 v[196:199], a[144:147], a[76:79], v[228:231]
  v_exp_f32_e64 v205, v205
  v_mfma_f32_16x16x32_bf16 v[196:199], a[148:151], a[72:75], v[196:199]
  v_exp_f32_e64 v203, v203
  v_mfma_f32_16x16x32_bf16 v[196:199], a[152:155], a[68:71], v[196:199]
  s_waitcnt lgkmcnt(8)
  v_cvt_pk_bf16_f32 v208, v200, v201
  v_cvt_pk_bf16_f32 v209, v202, v203
  v_cvt_pk_bf16_f32 v210, v204, v205
  v_cvt_pk_bf16_f32 v211, v206, v207
  v_mfma_f32_16x16x32_bf16 v[196:199], a[156:159], a[64:67], v[196:199]
  ds_read_b64_tr_b16 a[180:181], v217 offset:25424
  ds_read_b64_tr_b16 a[182:183], v217 offset:25936
  v_mfma_f32_16x16x32_bf16 a[204:207], a[220:223], v[208:211], a[204:207]
  ds_read_b64_tr_b16 a[184:185], v217 offset:25440
  ds_read_b64_tr_b16 a[186:187], v217 offset:25952
  v_mfma_f32_16x16x32_bf16 a[224:227], v[208:211], a[160:163], a[224:227]
  ds_read_b64_tr_b16 a[188:189], v217 offset:25456
  ds_read_b64_tr_b16 a[190:191], v217 offset:25968
  s_waitcnt lgkmcnt(12)
  v_mfma_f32_16x16x32_bf16 a[228:231], v[208:211], a[164:167], a[228:231]
  s_waitcnt lgkmcnt(10)
  v_mul_f32 v201, s29, v193
  v_mul_f32_e64 v202, s29, v194
  v_mfma_f32_16x16x32_bf16 a[232:235], v[208:211], a[168:171], a[232:235]
  s_waitcnt lgkmcnt(8)
  v_mul_f32 v200, s29, v192
  v_mul_f32_e64 v203, s29, v195
  v_mfma_f32_16x16x32_bf16 a[236:239], v[208:211], a[172:175], a[236:239]
  s_waitcnt lgkmcnt(6)
  v_mul_f32 v206, s29, v198
  v_mul_f32_e64 v207, s29, v199
  v_mfma_f32_16x16x32_bf16 a[240:243], v[208:211], a[176:179], a[240:243]
  s_waitcnt lgkmcnt(4)
  v_mul_f32 v204, s29, v196
  v_mul_f32_e64 v205, s29, v197
  v_mfma_f32_16x16x32_bf16 a[244:247], v[208:211], a[180:183], a[244:247]
  s_waitcnt lgkmcnt(2)
  v_exp_f32 v206, v206
  v_mfma_f32_16x16x32_bf16 a[248:251], v[208:211], a[184:187], a[248:251]
  s_waitcnt lgkmcnt(0)
  v_exp_f32 v202, v202
  v_mfma_f32_16x16x32_bf16 a[252:255], v[208:211], a[188:191], a[252:255]
  v_exp_f32_e64 v200, v200
  s_waitcnt vmcnt(4)
  s_barrier
  v_mfma_f32_16x16x32_bf16 v[192:195], a[128:131], a[80:83], v[228:231]
  v_exp_f32_e64 v204, v204
  v_mfma_f32_16x16x32_bf16 v[192:195], a[132:135], a[84:87], v[192:195]
  v_exp_f32_e64 v201, v201
  v_mfma_f32_16x16x32_bf16 v[192:195], a[136:139], a[88:91], v[192:195]
  v_exp_f32_e64 v203, v203
  v_mfma_f32_16x16x32_bf16 v[192:195], a[140:143], a[92:95], v[192:195]
  v_exp_f32_e64 v207, v207
  v_mfma_f32_16x16x32_bf16 v[196:199], a[144:147], a[92:95], v[228:231]
  v_exp_f32_e64 v205, v205
  v_mfma_f32_16x16x32_bf16 v[196:199], a[148:151], a[88:91], v[196:199]
  v_cvt_pk_bf16_f32 v208, v200, v201
  v_cvt_pk_bf16_f32 v210, v204, v205
  v_mfma_f32_16x16x32_bf16 v[196:199], a[152:155], a[84:87], v[196:199]
  v_cvt_pk_bf16_f32 v209, v202, v203
  v_cvt_pk_bf16_f32 v211, v206, v207
  v_mfma_f32_16x16x32_bf16 v[196:199], a[156:159], a[80:83], v[196:199]
  ds_read_b128 a[128:131], v216 offset:0
  ds_read_b128 a[132:135], v216 offset:64
  v_mfma_f32_16x16x32_bf16 v[128:131], v[208:211], a[160:163], v[128:131]
  ds_read_b128 a[136:139], v216 offset:128
  ds_read_b128 a[140:143], v216 offset:192
  v_mfma_f32_16x16x32_bf16 v[132:135], v[208:211], a[164:167], v[132:135]
  ds_read_b128 a[144:147], v216 offset:704
  ds_read_b128 a[148:151], v216 offset:640
  v_mfma_f32_16x16x32_bf16 v[136:139], v[208:211], a[168:171], v[136:139]
  ds_read_b128 a[152:155], v216 offset:576
  v_mul_f32_e64 v203, s29, v195
  v_mfma_f32_16x16x32_bf16 v[140:143], v[208:211], a[172:175], v[140:143]
  v_mul_f32 v201, s29, v193
  v_mul_f32 v202, s29, v194
  v_mfma_f32_16x16x32_bf16 v[144:147], v[208:211], a[176:179], v[144:147]
  ds_read_b128 a[156:159], v216 offset:512
  v_mul_f32_e64 v200, s29, v192
  v_mfma_f32_16x16x32_bf16 v[148:151], v[208:211], a[180:183], v[148:151]
  v_mul_f32 v205, s29, v197
  v_mul_f32 v207, s29, v199
  v_mfma_f32_16x16x32_bf16 v[152:155], v[208:211], a[184:187], v[152:155]
  v_mul_f32 v204, s29, v196
  v_mul_f32 v206, s29, v198
  v_mfma_f32_16x16x32_bf16 v[156:159], v[208:211], a[188:191], v[156:159]
  v_exp_f32_e64 v204, v204
  s_barrier
  s_add_u32 m0, s32, 16896
  s_xor_b32 s50, 32768, s3
  buffer_load_dwordx4 v221, s[4:7], s50 offen lds
  s_add_u32 m0, s32, 16928
  s_add_u32 s51, s32, s96
  buffer_load_dwordx4 v221, s[4:7], s50 offen offset:1024 lds
  s_add_u32 m0, s51, 16896
  s_nop 0
  buffer_load_dwordx4 v221, s[8:11], s50 offen lds
  s_add_u32 m0, s51, 16912
  s_nop 0
  buffer_load_dwordx4 v221, s[8:11], s50 offen offset:1024 lds
  s_waitcnt vmcnt(4)
  s_waitcnt lgkmcnt(7)
  v_mfma_f32_16x16x32_bf16 v[192:195], a[128:131], a[0:3], v[228:231]
  s_waitcnt lgkmcnt(6)
  v_exp_f32 v202, v202
  v_mfma_f32_16x16x32_bf16 v[192:195], a[132:135], a[4:7], v[192:195]
  s_waitcnt lgkmcnt(5)
  v_exp_f32 v206, v206
  v_mfma_f32_16x16x32_bf16 v[192:195], a[136:139], a[8:11], v[192:195]
  s_waitcnt lgkmcnt(4)
  v_exp_f32 v203, v203
  v_mfma_f32_16x16x32_bf16 v[192:195], a[140:143], a[12:15], v[192:195]
  s_waitcnt lgkmcnt(3)
  v_exp_f32 v201, v201
  v_mfma_f32_16x16x32_bf16 v[196:199], a[144:147], a[12:15], v[228:231]
  s_waitcnt lgkmcnt(2)
  v_exp_f32 v207, v207
  v_mfma_f32_16x16x32_bf16 v[196:199], a[148:151], a[8:11], v[196:199]
  s_waitcnt lgkmcnt(1)
  v_exp_f32 v200, v200
  v_exp_f32_e64 v205, v205
  v_mfma_f32_16x16x32_bf16 v[196:199], a[152:155], a[4:7], v[196:199]
  s_waitcnt lgkmcnt(0)
  v_cvt_pk_bf16_f32 v212, v200, v201
  v_cvt_pk_bf16_f32 v213, v202, v203
  v_cvt_pk_bf16_f32 v214, v204, v205
  v_cvt_pk_bf16_f32 v215, v206, v207
  v_mfma_f32_16x16x32_bf16 v[196:199], a[156:159], a[0:3], v[196:199]
  v_mul_f32 v200, s29, v192
  v_mul_f32_e64 v201, s29, v193
  v_mfma_f32_16x16x32_bf16 v[160:163], v[212:215], a[160:163], v[160:163]
  v_mul_f32 v202, s29, v194
  v_mul_f32 v203, s29, v195
  v_mfma_f32_16x16x32_bf16 v[164:167], v[212:215], a[164:167], v[164:167]
  ds_read_b64_tr_b16 a[160:161], v217 offset:8448
  ds_read_b64_tr_b16 a[166:167], v217 offset:8976
  v_mfma_f32_16x16x32_bf16 v[168:171], v[212:215], a[168:171], v[168:171]
  v_mul_f32 v204, s29, v196
  v_mul_f32 v205, s29, v197
  v_mfma_f32_16x16x32_bf16 v[172:175], v[212:215], a[172:175], v[172:175]
  ds_read_b64_tr_b16 a[172:173], v217 offset:8496
  ds_read_b64_tr_b16 a[174:175], v217 offset:9008
  v_mfma_f32_16x16x32_bf16 v[176:179], v[212:215], a[176:179], v[176:179]
  v_exp_f32_e64 v200, v200
  v_mfma_f32_16x16x32_bf16 v[180:183], v[212:215], a[180:183], v[180:183]
  ds_read_b64_tr_b16 a[168:169], v217 offset:8480
  ds_read_b64_tr_b16 a[170:171], v217 offset:8992
  v_mfma_f32_16x16x32_bf16 v[184:187], v[212:215], a[184:187], v[184:187]
  v_mul_f32 v206, s29, v198
  v_mul_f32 v207, s29, v199
  v_mfma_f32_16x16x32_bf16 v[188:191], v[212:215], a[188:191], v[188:191]
  v_exp_f32_e64 v203, v203
  v_smfmac_f32_16x16x64_bf16 a[200:203], a[220:223], v[208:215], v254
  ds_read_b64_tr_b16 a[162:163], v217 offset:8960
  ds_read_b64_tr_b16 a[164:165], v217 offset:8464
  v_exp_f32 v201, v201
  v_exp_f32 v202, v202
  s_cmp_eq_u32 s28, 0
  s_cbranch_scc1 L_pE2
  s_cmp_eq_u32 s28, 1
  s_cbranch_scc1 L_pE3
  s_cmp_eq_u32 s28, 2
  s_cbranch_scc1 L_pE0
  s_branch L_pE1
L_out:
  s_endpgm
L_exitB:
  buffer_load_dwordx4 a[96:99], v255, s[12:15], s42 offen nt
  ds_read_b128 a[16:19], v224 offset:4096
  ds_read_b128 a[20:23], v225 offset:4096
  ds_read_b128 a[24:27], v226 offset:4096
  ds_read_b128 a[28:31], v227 offset:4096
  ds_read_b128 a[32:35], v224 offset:8192
  ds_read_b128 a[36:39], v225 offset:8192
  ds_read_b128 a[40:43], v226 offset:8192
  ds_read_b128 a[44:47], v227 offset:8192
  ds_read_b128 a[0:3], v224 offset:0
  ds_read_b128 a[4:7], v225 offset:0
  ds_read_b128 a[8:11], v226 offset:0
  ds_read_b128 a[12:15], v227 offset:0
  v_mul_f32 v206, s29, v198
  v_mul_f32 v207, s29, v199
  v_exp_f32 v204, v204
  v_exp_f32 v205, v205
  v_cvt_pk_bf16_f32 v212, v200, v201
  v_cvt_pk_bf16_f32 v213, v202, v203
  v_exp_f32 v206, v206
  v_exp_f32 v207, v207
  v_cvt_pk_bf16_f32 v214, v204, v205
  v_cvt_pk_bf16_f32 v215, v206, v207
  v_accvgpr_read_b32 v245, a198
  v_accvgpr_read_b32 v251, a199
  v_smfmac_f32_16x16x64_bf16 a[200:203], a[220:223], v[208:215], v254
  s_mov_b32 s35, s39
  v_add_f32 v245, v245, v251
  v_mfma_f32_16x16x32_bf16 v[160:163], v[212:215], a[160:163], v[160:163]
  s_mov_b32 s51, s40
  v_rcp_f32 v245, v245
  v_mfma_f32_16x16x32_bf16 v[164:167], v[212:215], a[164:167], v[164:167]
  s_mov_b32 s39, s41
  v_accvgpr_read_b32 v244, a196
  v_accvgpr_read_b32 v250, a197
  v_mfma_f32_16x16x32_bf16 v[168:171], v[212:215], a[168:171], v[168:171]
  s_mov_b32 s40, s42
  v_add_f32_e64 v244, v244, v250
  v_accvgpr_read_b32 v243, a194
  v_mfma_f32_16x16x32_bf16 v[172:175], v[212:215], a[172:175], v[172:175]
  s_add_u32 s41, s41, s43
  v_accvgpr_read_b32 v251, a195
  v_add_f32 v243, v243, v251
  v_mfma_f32_16x16x4_f32 v[208:211], v245, a121, 0
  s_add_u32 s42, s42, s44
  v_accvgpr_read_b32 v242, a192
  v_accvgpr_read_b32 v250, a193
  v_mfma_f32_16x16x32_bf16 v[176:179], v[212:215], a[176:179], v[176:179]
  s_sub_u32 s43, 434176, s43
  v_add_f32 v242, v242, v250
  v_mfma_f32_16x16x32_bf16 v[180:183], v[212:215], a[180:183], v[180:183]
  s_sub_u32 s44, 434176, s44
  v_rcp_f32_e64 v244, v244
  v_mfma_f32_16x16x32_bf16 v[184:187], v[212:215], a[184:187], v[184:187]
  s_mov_b32 s34, s41
  v_rcp_f32 v243, v243
  v_mfma_f32_16x16x32_bf16 v[188:191], v[212:215], a[188:191], v[188:191]
  s_mov_b32 s36, s49
  v_rcp_f32 v242, v242
  ds_read_b128 a[48:51], v224 offset:12288
  ds_read_b128 a[52:55], v225 offset:12288
  ds_read_b128 a[56:59], v226 offset:12288
  ds_read_b128 a[60:63], v227 offset:12288
  v_accvgpr_read_b32 v248, a204
  v_accvgpr_read_b32 v250, a206
  v_add_f32 v248, v248, v250
  ds_write_b32 v238, v248 offset:0
  s_waitcnt lgkmcnt(5)
  buffer_load_dwordx4 a[100:103], v255, s[12:15], s40 offen offset:64 nt
  ds_write_b128 v234, a[224:227] offset:4096
  ds_write_b128 v234, a[228:231] offset:5120
  v_accvgpr_read_b32 v246, a200
  v_accvgpr_read_b32 v250, a201
  v_add_f32 v246, v246, v250
  v_accvgpr_read_b32 v247, a202
  v_accvgpr_read_b32 v251, a203
  v_add_f32 v247, v247, v251
  v_rcp_f32 v246, v246
  v_rcp_f32_e64 v247, v247
  v_subrev_u32 v220, s98, v235
  ds_write_b128 v234, a[232:235] offset:6144
  ds_write_b128 v234, a[236:239] offset:7168
  v_pk_mul_f32 v[96:97], v[96:97], v[208:209]
  v_pk_mul_f32 v[100:101], v[100:101], v[208:209]
  v_pk_mul_f32 v[104:105], v[104:105], v[208:209]
  v_pk_mul_f32 v[108:109], v[108:109], v[208:209]
  v_pk_mul_f32 v[112:113], v[112:113], v[208:209]
  v_pk_mul_f32 v[116:117], v[116:117], v[208:209]
  v_pk_mul_f32 v[120:121], v[120:121], v[208:209]
  v_pk_mul_f32 v[124:125], v[124:125], v[208:209]
  v_cvt_pk_bf16_f32 v200, v96, v100
  v_cvt_pk_bf16_f32 v201, v104, v108
  v_cvt_pk_bf16_f32 v202, v112, v116
  v_cvt_pk_bf16_f32 v203, v120, v124
  v_cvt_pk_bf16_f32 v204, v97, v101
  v_cvt_pk_bf16_f32 v205, v105, v109
  v_cvt_pk_bf16_f32 v206, v113, v117
  v_cvt_pk_bf16_f32 v207, v121, v125
  v_mfma_f32_16x16x4_f32 v[212:215], v246, a121, 0
  s_waitcnt vmcnt(10)
  ds_read_b128 a[64:67], v224 offset:16384
  ds_read_b128 a[68:71], v225 offset:16384
  ds_write_b128 v232, v[200:203] offset:12288
  ds_write_b128 v232, v[204:207] offset:12544
  ds_write_b128 v234, a[240:243] offset:8192
  v_pk_mul_f32 v[98:99], v[98:99], v[210:211]
  v_pk_mul_f32 v[102:103], v[102:103], v[210:211]
  v_pk_mul_f32 v[106:107], v[106:107], v[210:211]
  v_pk_mul_f32 v[110:111], v[110:111], v[210:211]
  v_pk_mul_f32 v[114:115], v[114:115], v[210:211]
  v_pk_mul_f32 v[118:119], v[118:119], v[210:211]
  v_pk_mul_f32 v[122:123], v[122:123], v[210:211]
  v_pk_mul_f32 v[126:127], v[126:127], v[210:211]
  v_cvt_pk_bf16_f32 v200, v98, v102
  v_cvt_pk_bf16_f32 v201, v106, v110
  v_cvt_pk_bf16_f32 v202, v114, v118
  v_cvt_pk_bf16_f32 v203, v122, v126
  v_cvt_pk_bf16_f32 v204, v99, v103
  v_cvt_pk_bf16_f32 v205, v107, v111
  v_cvt_pk_bf16_f32 v206, v115, v119
  v_cvt_pk_bf16_f32 v207, v123, v127
  v_mfma_f32_16x16x32_bf16 v[192:195], a[128:131], a[0:3], v[228:231]
  ds_read_b128 a[72:75], v226 offset:16384
  ds_read_b128 a[76:79], v227 offset:16384
  ds_write_b128 v232, v[200:203] offset:12800
  v_mfma_f32_16x16x32_bf16 v[192:195], a[132:135], a[4:7], v[192:195]
  ds_write_b128 v232, v[204:207] offset:13056
  ds_write_b128 v234, a[244:247] offset:9216
  buffer_load_dwordx4 a[104:107], v255, s[12:15], s40 offen offset:128 nt
  v_pk_mul_f32 v[128:129], v[128:129], v[212:213]
  v_pk_mul_f32 v[132:133], v[132:133], v[212:213]
  v_pk_mul_f32 v[136:137], v[136:137], v[212:213]
  v_pk_mul_f32 v[140:141], v[140:141], v[212:213]
  v_pk_mul_f32 v[144:145], v[144:145], v[212:213]
  v_pk_mul_f32 v[148:149], v[148:149], v[212:213]
  v_pk_mul_f32 v[152:153], v[152:153], v[212:213]
  v_pk_mul_f32 v[156:157], v[156:157], v[212:213]
  v_cvt_pk_bf16_f32 v200, v128, v132
  v_cvt_pk_bf16_f32 v201, v136, v140
  v_cvt_pk_bf16_f32 v202, v144, v148
  v_cvt_pk_bf16_f32 v203, v152, v156
  v_cvt_pk_bf16_f32 v204, v129, v133
  v_cvt_pk_bf16_f32 v205, v137, v141
  v_cvt_pk_bf16_f32 v206, v145, v149
  v_cvt_pk_bf16_f32 v207, v153, v157
  v_mfma_f32_16x16x4_f32 v[208:211], v244, a121, 0
  ds_write_b128 v232, v[200:203] offset:16384
  ds_write_b128 v232, v[204:207] offset:16640
  ds_write_b128 v234, a[248:251] offset:10240
  v_pk_mul_f32 v[130:131], v[130:131], v[214:215]
  v_pk_mul_f32 v[134:135], v[134:135], v[214:215]
  v_pk_mul_f32 v[138:139], v[138:139], v[214:215]
  v_pk_mul_f32 v[142:143], v[142:143], v[214:215]
  v_pk_mul_f32 v[146:147], v[146:147], v[214:215]
  v_pk_mul_f32 v[150:151], v[150:151], v[214:215]
  v_pk_mul_f32 v[154:155], v[154:155], v[214:215]
  v_pk_mul_f32 v[158:159], v[158:159], v[214:215]
  v_cvt_pk_bf16_f32 v200, v130, v134
  v_cvt_pk_bf16_f32 v201, v138, v142
  v_cvt_pk_bf16_f32 v202, v146, v150
  v_cvt_pk_bf16_f32 v203, v154, v158
  v_cvt_pk_bf16_f32 v204, v131, v135
  v_cvt_pk_bf16_f32 v205, v139, v143
  v_cvt_pk_bf16_f32 v206, v147, v151
  v_cvt_pk_bf16_f32 v207, v155, v159
  v_mfma_f32_16x16x32_bf16 v[192:195], a[136:139], a[8:11], v[192:195]
  ds_write_b128 v232, v[200:203] offset:16896
  v_mfma_f32_16x16x32_bf16 v[192:195], a[140:143], a[12:15], v[192:195]
  ds_write_b128 v232, v[204:207] offset:17152
  ds_write_b128 v234, a[252:255] offset:11264
  buffer_load_dwordx4 a[108:111], v255, s[12:15], s40 offen offset:192 nt
  s_sub_u32 s38, s38, 1
  s_cmp_eq_u32 s38, 1
  s_cselect_b32 s14, 0, s14
  v_pk_mul_f32 v[64:65], v[64:65], v[208:209]
  v_pk_mul_f32 v[68:69], v[68:69], v[208:209]
  v_pk_mul_f32 v[72:73], v[72:73], v[208:209]
  v_pk_mul_f32 v[76:77], v[76:77], v[208:209]
  v_pk_mul_f32 v[80:81], v[80:81], v[208:209]
  v_pk_mul_f32 v[84:85], v[84:85], v[208:209]
  v_pk_mul_f32 v[88:89], v[88:89], v[208:209]
  v_pk_mul_f32 v[92:93], v[92:93], v[208:209]
  v_mfma_f32_16x16x4_f32 v[212:215], v243, a121, 0
  s_waitcnt lgkmcnt(0)
  s_barrier
  ds_read_b128 v[96:99], v236 offset:4096
  ds_read_b128 v[100:103], v236 offset:5120
  ds_read_b128 v[104:107], v236 offset:28672
  ds_read_b128 v[108:111], v236 offset:29696
  v_cvt_pk_bf16_f32 v128, v64, v68
  v_cvt_pk_bf16_f32 v129, v72, v76
  v_cvt_pk_bf16_f32 v130, v80, v84
  v_cvt_pk_bf16_f32 v131, v88, v92
  v_cvt_pk_bf16_f32 v132, v65, v69
  v_cvt_pk_bf16_f32 v133, v73, v77
  v_cvt_pk_bf16_f32 v134, v81, v85
  v_cvt_pk_bf16_f32 v135, v89, v93
  v_pk_mul_f32 v[66:67], v[66:67], v[210:211]
  v_pk_mul_f32 v[70:71], v[70:71], v[210:211]
  v_pk_mul_f32 v[74:75], v[74:75], v[210:211]
  v_pk_mul_f32 v[78:79], v[78:79], v[210:211]
  v_pk_mul_f32 v[82:83], v[82:83], v[210:211]
  v_pk_mul_f32 v[86:87], v[86:87], v[210:211]
  v_pk_mul_f32 v[90:91], v[90:91], v[210:211]
  v_pk_mul_f32 v[94:95], v[94:95], v[210:211]
  v_mfma_f32_16x16x32_bf16 v[196:199], a[144:147], a[12:15], v[228:231]
  ds_read_b128 v[112:115], v237 offset:4096
  ds_read_b128 v[116:119], v237 offset:5120
  ds_read_b128 v[120:123], v237 offset:28672
  ds_read_b128 v[124:127], v237 offset:29696
  v_cvt_pk_bf16_f32 v136, v66, v70
  v_cvt_pk_bf16_f32 v137, v74, v78
  v_cvt_pk_bf16_f32 v138, v82, v86
  v_cvt_pk_bf16_f32 v139, v90, v94
  v_cvt_pk_bf16_f32 v140, v67, v71
  v_cvt_pk_bf16_f32 v141, v75, v79
  v_cvt_pk_bf16_f32 v142, v83, v87
  v_cvt_pk_bf16_f32 v143, v91, v95
  v_pk_mul_f32 v[32:33], v[32:33], v[212:213]
  v_pk_mul_f32 v[36:37], v[36:37], v[212:213]
  v_pk_mul_f32 v[40:41], v[40:41], v[212:213]
  v_pk_mul_f32 v[44:45], v[44:45], v[212:213]
  v_pk_mul_f32 v[48:49], v[48:49], v[212:213]
  v_pk_mul_f32 v[52:53], v[52:53], v[212:213]
  v_pk_mul_f32 v[56:57], v[56:57], v[212:213]
  v_pk_mul_f32 v[60:61], v[60:61], v[212:213]
  v_mfma_f32_16x16x4_f32 v[208:211], v242, a121, 0
  ds_read_b32 v64, v239 offset:0
  ds_read_b32 v65, v239 offset:256
  ds_read_b32 v66, v239 offset:512
  ds_read_b32 v67, v239 offset:768
  v_cvt_pk_bf16_f32 v144, v32, v36
  v_cvt_pk_bf16_f32 v145, v40, v44
  v_cvt_pk_bf16_f32 v146, v48, v52
  v_cvt_pk_bf16_f32 v147, v56, v60
  v_cvt_pk_bf16_f32 v148, v33, v37
  v_cvt_pk_bf16_f32 v149, v41, v45
  v_cvt_pk_bf16_f32 v150, v49, v53
  v_cvt_pk_bf16_f32 v151, v57, v61
  v_pk_mul_f32 v[34:35], v[34:35], v[214:215]
  v_pk_mul_f32 v[38:39], v[38:39], v[214:215]
  v_pk_mul_f32 v[42:43], v[42:43], v[214:215]
  v_pk_mul_f32 v[46:47], v[46:47], v[214:215]
  v_pk_mul_f32 v[50:51], v[50:51], v[214:215]
  v_pk_mul_f32 v[54:55], v[54:55], v[214:215]
  v_pk_mul_f32 v[58:59], v[58:59], v[214:215]
  v_pk_mul_f32 v[62:63], v[62:63], v[214:215]
  v_mfma_f32_16x16x32_bf16 v[196:199], a[148:151], a[8:11], v[196:199]
  ds_read_b64_tr_b16 a[160:161], v217 offset:8448
  ds_read_b64_tr_b16 a[162:163], v217 offset:8960
  ds_read_b64_tr_b16 a[164:165], v217 offset:8464
  ds_read_b64_tr_b16 a[166:167], v217 offset:8976
  ds_read_b64_tr_b16 a[168:169], v217 offset:8480
  ds_read_b64_tr_b16 a[170:171], v217 offset:8992
  ds_read_b64_tr_b16 a[172:173], v217 offset:8496
  ds_read_b64_tr_b16 a[174:175], v217 offset:9008
  v_cvt_pk_bf16_f32 v152, v34, v38
  v_cvt_pk_bf16_f32 v153, v42, v46
  v_cvt_pk_bf16_f32 v154, v50, v54
  v_cvt_pk_bf16_f32 v155, v58, v62
  v_cvt_pk_bf16_f32 v156, v35, v39
  v_cvt_pk_bf16_f32 v157, v43, v47
  v_cvt_pk_bf16_f32 v158, v51, v55
  v_cvt_pk_bf16_f32 v159, v59, v63
  s_waitcnt lgkmcnt(8)
  v_add_f32 v64, v64, v65
  v_add_f32 v66, v66, v67
  v_add_f32 v248, v64, v66
  v_rcp_f32_e64 v248, v248
  s_lshl_b32 s24, s28, 2
  s_add_u32 s25, s24, 1
  s_add_u32 s26, s24, 2
  s_add_u32 s27, s24, 3
  v_readlane_b32 s20, v248, s24
  v_readlane_b32 s21, v248, s25
  v_readlane_b32 s22, v248, s26
  v_readlane_b32 s23, v248, s27
  v_pk_add_f32 v[96:97], v[96:97], v[104:105]
  v_pk_add_f32 v[98:99], v[98:99], v[106:107]
  v_pk_add_f32 v[100:101], v[100:101], v[108:109]
  v_pk_add_f32 v[102:103], v[102:103], v[110:111]
  v_pk_add_f32 v[112:113], v[112:113], v[120:121]
  v_pk_add_f32 v[114:115], v[114:115], v[122:123]
  v_pk_add_f32 v[116:117], v[116:117], v[124:125]
  v_pk_add_f32 v[118:119], v[118:119], v[126:127]
  v_pk_add_f32 v[96:97], v[96:97], v[112:113]
  v_pk_add_f32 v[98:99], v[98:99], v[114:115]
  v_pk_add_f32 v[100:101], v[100:101], v[116:117]
  v_pk_add_f32 v[102:103], v[102:103], v[118:119]
  v_pk_mul_f32 v[96:97], v[96:97], s[20:21]
  v_pk_mul_f32 v[98:99], v[98:99], s[22:23]
  v_pk_mul_f32 v[100:101], v[100:101], s[20:21]
  v_pk_mul_f32 v[102:103], v[102:103], s[22:23]
  v_cvt_pk_bf16_f32 v96, v96, v100
  v_cvt_pk_bf16_f32 v97, v97, v101
  v_cvt_pk_bf16_f32 v98, v98, v102
  v_cvt_pk_bf16_f32 v99, v99, v103
  ds_write2st64_b32 v240, v96, v97 offset0:0 offset1:1
  ds_write2st64_b32 v240, v98, v99 offset0:2 offset1:3
  v_pk_mul_f32 v[0:1], v[0:1], v[208:209]
  v_pk_mul_f32 v[4:5], v[4:5], v[208:209]
  v_pk_mul_f32 v[8:9], v[8:9], v[208:209]
  v_pk_mul_f32 v[12:13], v[12:13], v[208:209]
  v_pk_mul_f32 v[16:17], v[16:17], v[208:209]
  v_pk_mul_f32 v[20:21], v[20:21], v[208:209]
  v_pk_mul_f32 v[24:25], v[24:25], v[208:209]
  v_pk_mul_f32 v[28:29], v[28:29], v[208:209]
  v_cvt_pk_bf16_f32 v200, v0, v4
  v_cvt_pk_bf16_f32 v201, v8, v12
  v_cvt_pk_bf16_f32 v202, v16, v20
  v_cvt_pk_bf16_f32 v203, v24, v28
  v_cvt_pk_bf16_f32 v204, v1, v5
  v_cvt_pk_bf16_f32 v205, v9, v13
  v_cvt_pk_bf16_f32 v206, v17, v21
  v_cvt_pk_bf16_f32 v207, v25, v29
  v_mfma_f32_16x16x4_f32 v[212:215], v247, a121, 0
  ds_read_b64_tr_b16 v[104:105], v241 offset:0
  ds_read_b64_tr_b16 v[106:107], v241 offset:64
  ds_write_b128 v232, v[200:203] offset:0
  ds_write_b128 v232, v[204:207] offset:256
  v_max3_u32 v250, v242, v243, v244
  v_min3_u32 v251, v242, v243, v244
  v_max3_u32 v250, v250, v245, v246
  v_min3_u32 v251, v251, v245, v246
  v_max_u32 v250, v250, v247
  v_min_u32 v251, v251, v247
  v_cmp_lt_u32 s[20:21], s54, v250
  v_cmp_gt_u32 s[22:23], s53, v251
  v_cmp_lt_u32 s[24:25], s54, v248
  v_cmp_gt_u32 s[26:27], s53, v248
  v_pk_mul_f32 v[2:3], v[2:3], v[210:211]
  v_pk_mul_f32 v[6:7], v[6:7], v[210:211]
  v_pk_mul_f32 v[10:11], v[10:11], v[210:211]
  v_pk_mul_f32 v[14:15], v[14:15], v[210:211]
  v_pk_mul_f32 v[18:19], v[18:19], v[210:211]
  v_pk_mul_f32 v[22:23], v[22:23], v[210:211]
  v_pk_mul_f32 v[26:27], v[26:27], v[210:211]
  v_pk_mul_f32 v[30:31], v[30:31], v[210:211]
  v_cvt_pk_bf16_f32 v200, v2, v6
  v_cvt_pk_bf16_f32 v201, v10, v14
  v_cvt_pk_bf16_f32 v202, v18, v22
  v_cvt_pk_bf16_f32 v203, v26, v30
  v_cvt_pk_bf16_f32 v204, v3, v7
  v_cvt_pk_bf16_f32 v205, v11, v15
  v_cvt_pk_bf16_f32 v206, v19, v23
  v_cvt_pk_bf16_f32 v207, v27, v31
  v_mfma_f32_16x16x32_bf16 v[196:199], a[152:155], a[4:7], v[196:199]
  s_waitcnt vmcnt(4)
  ds_read_b128 a[80:83], v224 offset:20480
  ds_read_b128 a[84:87], v225 offset:20480
  ds_write_b128 v232, v[200:203] offset:512
  ds_write_b128 v232, v[204:207] offset:768
  s_waitcnt lgkmcnt(6)
  s_lshl_b32 s52, s28, 10
  s_add_u32 s52, s52, s51
  buffer_store_dwordx4 v[104:107], v233, s[16:19], s52 offen
  v_pk_mul_f32 v[160:161], v[160:161], v[212:213]
  v_pk_mul_f32 v[164:165], v[164:165], v[212:213]
  v_pk_mul_f32 v[168:169], v[168:169], v[212:213]
  v_pk_mul_f32 v[172:173], v[172:173], v[212:213]
  v_pk_mul_f32 v[176:177], v[176:177], v[212:213]
  v_pk_mul_f32 v[180:181], v[180:181], v[212:213]
  v_pk_mul_f32 v[184:185], v[184:185], v[212:213]
  v_pk_mul_f32 v[188:189], v[188:189], v[212:213]
  v_cvt_pk_bf16_f32 v200, v160, v164
  v_cvt_pk_bf16_f32 v201, v168, v172
  v_cvt_pk_bf16_f32 v202, v176, v180
  v_cvt_pk_bf16_f32 v203, v184, v188
  v_cvt_pk_bf16_f32 v204, v161, v165
  v_cvt_pk_bf16_f32 v205, v169, v173
  v_cvt_pk_bf16_f32 v206, v177, v181
  v_cvt_pk_bf16_f32 v207, v185, v189
  v_mfma_f32_16x16x32_bf16 v[196:199], a[156:159], a[0:3], v[196:199]
  ds_read_b128 a[88:91], v226 offset:20480
  ds_read_b128 a[92:95], v227 offset:20480
  ds_write_b128 v232, v[200:203] offset:20480
  ds_write_b128 v232, v[204:207] offset:20736
  v_pk_mul_f32 v[162:163], v[162:163], v[214:215]
  v_pk_mul_f32 v[166:167], v[166:167], v[214:215]
  v_pk_mul_f32 v[170:171], v[170:171], v[214:215]
  v_pk_mul_f32 v[174:175], v[174:175], v[214:215]
  v_pk_mul_f32 v[178:179], v[178:179], v[214:215]
  v_pk_mul_f32 v[182:183], v[182:183], v[214:215]
  v_pk_mul_f32 v[186:187], v[186:187], v[214:215]
  v_pk_mul_f32 v[190:191], v[190:191], v[214:215]
  v_cvt_pk_bf16_f32 v200, v162, v166
  v_cvt_pk_bf16_f32 v201, v170, v174
  v_cvt_pk_bf16_f32 v202, v178, v182
  v_cvt_pk_bf16_f32 v203, v186, v190
  v_cvt_pk_bf16_f32 v204, v163, v167
  v_cvt_pk_bf16_f32 v205, v171, v175
  v_cvt_pk_bf16_f32 v206, v179, v183
  v_cvt_pk_bf16_f32 v207, v187, v191
  ds_write_b128 v232, v[200:203] offset:20992
  ds_write_b128 v232, v[204:207] offset:21248
  s_or_b64 s[20:21], s[20:21], s[22:23]
  s_addc_u32 s48, s48, s48
  s_or_b64 s[24:25], s[24:25], s[26:27]
  s_addc_u32 s48, s48, s48
L_headA:
  v_mfma_f32_16x16x32_bf16 a[192:195], a[124:127], a[124:127], 0
  s_mov_b32 s37, 14
  v_mul_f32 v200, s29, v192
  v_mul_f32_e64 v201, s29, v193
  v_mfma_f32_16x16x32_bf16 a[196:199], a[124:127], a[124:127], 0
  v_exp_f32_e64 v200, v200
  v_mfma_f32_16x16x32_bf16 a[200:203], a[124:127], a[124:127], 0
  v_exp_f32 v201, v201
  v_mul_f32 v202, s29, v194
  v_mul_f32 v203, s29, v195
  v_exp_f32 v202, v202
  v_mul_f32 v204, s29, v196
  v_mul_f32 v205, s29, v197
  v_exp_f32 v203, v203
  v_mul_f32 v206, s29, v198
  v_mul_f32_e64 v207, s29, v199
  s_cmp_lg_u32 s28, 0
  s_cbranch_scc1 L_selA
  v_mfma_f32_16x16x32_bf16 v[192:195], a[128:131], a[16:19], v[228:231]
  ds_read_b64_tr_b16 a[176:177], v217 offset:8512
  ds_read_b64_tr_b16 a[178:179], v217 offset:9024
  v_mfma_f32_16x16x32_bf16 v[192:195], a[132:135], a[20:23], v[192:195]
  v_exp_f32_e64 v205, v205
  v_mfma_f32_16x16x32_bf16 v[192:195], a[136:139], a[24:27], v[192:195]
  ds_read_b64_tr_b16 a[180:181], v217 offset:8528
  ds_read_b64_tr_b16 a[182:183], v217 offset:9040
  v_mfma_f32_16x16x32_bf16 v[192:195], a[140:143], a[28:31], v[192:195]
  v_exp_f32_e64 v204, v204
  v_mfma_f32_16x16x32_bf16 v[196:199], a[144:147], a[28:31], v[228:231]
  ds_read_b64_tr_b16 a[184:185], v217 offset:8544
  ds_read_b64_tr_b16 a[186:187], v217 offset:9056
  v_mfma_f32_16x16x32_bf16 v[196:199], a[148:151], a[24:27], v[196:199]
  v_exp_f32 v206, v206
  v_exp_f32 v207, v207
  v_mfma_f32_16x16x32_bf16 v[196:199], a[152:155], a[20:23], v[196:199]
  s_waitcnt lgkmcnt(6)
  v_cvt_pk_bf16_f32 v208, v200, v201
  v_cvt_pk_bf16_f32 v209, v202, v203
  v_cvt_pk_bf16_f32 v210, v204, v205
  v_cvt_pk_bf16_f32 v211, v206, v207
  v_mfma_f32_16x16x32_bf16 v[196:199], a[156:159], a[16:19], v[196:199]
  ds_read_b64_tr_b16 a[188:189], v217 offset:8560
  ds_read_b64_tr_b16 a[190:191], v217 offset:9072
  v_mfma_f32_16x16x32_bf16 v[0:3], v[208:211], a[160:163], 0
  v_mul_f32 v201, s29, v193
  v_mul_f32_e64 v203, s29, v195
  v_mfma_f32_16x16x32_bf16 v[4:7], v[208:211], a[164:167], 0
  v_mul_f32 v200, s29, v192
  v_mul_f32 v202, s29, v194
  v_mfma_f32_16x16x32_bf16 v[8:11], v[208:211], a[168:171], 0
  v_mul_f32 v205, s29, v197
  v_mul_f32 v207, s29, v199
  v_mfma_f32_16x16x32_bf16 v[12:15], v[208:211], a[172:175], 0
  s_waitcnt lgkmcnt(4)
  v_mul_f32 v204, s29, v196
  v_mul_f32_e64 v206, s29, v198
  v_mfma_f32_16x16x32_bf16 v[16:19], v[208:211], a[176:179], 0
  v_exp_f32_e64 v201, v201
  v_mfma_f32_16x16x32_bf16 v[20:23], v[208:211], a[180:183], 0
  s_waitcnt lgkmcnt(2)
  v_exp_f32 v202, v202
  v_mfma_f32_16x16x32_bf16 v[24:27], v[208:211], a[184:187], 0
  s_waitcnt lgkmcnt(0)
  v_exp_f32 v203, v203
  v_mfma_f32_16x16x32_bf16 v[28:31], v[208:211], a[188:191], 0
  v_exp_f32_e64 v205, v205
  v_mfma_f32_16x16x32_bf16 v[192:195], a[128:131], a[32:35], v[228:231]
  v_exp_f32_e64 v207, v207
  v_mfma_f32_16x16x32_bf16 v[192:195], a[132:135], a[36:39], v[192:195]
  v_exp_f32_e64 v206, v206
  v_mfma_f32_16x16x32_bf16 v[192:195], a[136:139], a[40:43], v[192:195]
  v_exp_f32_e64 v204, v204
  v_mfma_f32_16x16x32_bf16 v[192:195], a[140:143], a[44:47], v[192:195]
  v_exp_f32_e64 v200, v200
  v_mfma_f32_16x16x32_bf16 v[196:199], a[144:147], a[44:47], v[228:231]
  v_cvt_pk_bf16_f32 v212, v200, v201
  v_cvt_pk_bf16_f32 v213, v202, v203
  v_mfma_f32_16x16x32_bf16 v[196:199], a[148:151], a[40:43], v[196:199]
  v_cvt_pk_bf16_f32 v214, v204, v205
  v_cvt_pk_bf16_f32 v215, v206, v207
  v_mfma_f32_16x16x32_bf16 v[196:199], a[152:155], a[36:39], v[196:199]
  v_mul_f32 v201, s29, v193
  v_mul_f32 v202, s29, v194
  v_mfma_f32_16x16x32_bf16 v[196:199], a[156:159], a[32:35], v[196:199]
  v_mul_f32 v200, s29, v192
  v_mul_f32 v203, s29, v195
  v_smfmac_f32_16x16x64_bf16 a[192:195], a[220:223], v[208:215], v254
  s_barrier
  v_add_u32 v220, 6144, v220
  v_mfma_f32_16x16x32_bf16 v[32:35], v[212:215], a[160:163], 0
  v_exp_f32 v202, v202
  v_mfma_f32_16x16x32_bf16 v[36:39], v[212:215], a[164:167], 0
  v_mul_f32 v205, s29, v197
  v_mul_f32 v207, s29, v199
  v_mfma_f32_16x16x32_bf16 v[40:43], v[212:215], a[168:171], 0
  s_mov_b32 m0, s30
  v_mul_f32 v204, s29, v196
  v_mul_f32_e64 v206, s29, v198
  v_mfma_f32_16x16x32_bf16 v[44:47], v[212:215], a[172:175], 0
  buffer_load_dwordx4 v221, s[4:7], s33 offen lds
  v_mfma_f32_16x16x32_bf16 v[48:51], v[212:215], a[176:179], 0
  v_exp_f32_e64 v204, v204
  v_mfma_f32_16x16x32_bf16 v[52:55], v[212:215], a[180:183], 0
  v_exp_f32_e64 v206, v206
  v_mfma_f32_16x16x32_bf16 v[56:59], v[212:215], a[184:187], 0
  s_add_u32 m0, s30, 32
  v_exp_f32 v203, v203
  v_mfma_f32_16x16x32_bf16 v[60:63], v[212:215], a[188:191], 0
  buffer_load_dwordx4 v221, s[4:7], s33 offen offset:1024 lds
  v_mfma_f32_16x16x32_bf16 v[192:195], a[128:131], a[48:51], v[228:231]
  v_exp_f32_e64 v205, v205
  v_mfma_f32_16x16x32_bf16 v[192:195], a[132:135], a[52:55], v[192:195]
  v_exp_f32_e64 v201, v201
  v_mfma_f32_16x16x32_bf16 v[192:195], a[136:139], a[56:59], v[192:195]
  s_add_u32 m0, s30, s96
  v_exp_f32 v200, v200
  v_mfma_f32_16x16x32_bf16 v[192:195], a[140:143], a[60:63], v[192:195]
  buffer_load_dwordx4 v221, s[8:11], s33 offen lds
  v_mfma_f32_16x16x32_bf16 v[196:199], a[144:147], a[60:63], v[228:231]
  v_exp_f32_e64 v207, v207
  v_mfma_f32_16x16x32_bf16 v[196:199], a[148:151], a[56:59], v[196:199]
  v_cvt_pk_bf16_f32 v208, v200, v201
  v_cvt_pk_bf16_f32 v211, v206, v207
  v_mfma_f32_16x16x32_bf16 v[196:199], a[152:155], a[52:55], v[196:199]
  s_add_u32 m0, s30, s97
  v_cvt_pk_bf16_f32 v209, v202, v203
  v_cvt_pk_bf16_f32 v210, v204, v205
  v_mfma_f32_16x16x32_bf16 v[196:199], a[156:159], a[48:51], v[196:199]
  buffer_load_dwordx4 v221, s[8:11], s33 offen offset:1024 lds
  v_mfma_f32_16x16x32_bf16 v[64:67], v[208:211], a[160:163], 0
  s_sub_u32 s30, s30, 16896
  v_mul_f32 v200, s29, v192
  v_mul_f32_e64 v201, s29, v193
  v_mfma_f32_16x16x32_bf16 v[68:71], v[208:211], a[164:167], 0
  s_cselect_b32 s30, s31, s30
  v_mul_f32 v202, s29, v194
  v_mul_f32_e64 v203, s29, v195
  v_mfma_f32_16x16x32_bf16 v[72:75], v[208:211], a[168:171], 0
  s_add_u32 s59, s59, 8192
  v_mul_f32 v204, s29, v196
  v_mul_f32 v206, s29, v198
  v_mfma_f32_16x16x32_bf16 v[76:79], v[208:211], a[172:175], 0
  ds_write_b128 v232, v[144:147] offset:4096
  v_mul_f32 v205, s29, v197
  v_mul_f32 v207, s29, v199
  v_mfma_f32_16x16x32_bf16 v[80:83], v[208:211], a[176:179], 0
  s_xor_b32 s33, s59, s3
  v_exp_f32 v207, v207
  v_mfma_f32_16x16x32_bf16 v[84:87], v[208:211], a[180:183], 0
  v_exp_f32_e64 v201, v201
  v_mfma_f32_16x16x32_bf16 v[88:91], v[208:211], a[184:187], 0
  s_waitcnt vmcnt(5)
  v_exp_f32 v204, v204
  v_mfma_f32_16x16x32_bf16 v[92:95], v[208:211], a[188:191], 0
  ds_write_b128 v232, v[148:151] offset:4352
  v_exp_f32_e64 v206, v206
  v_mfma_f32_16x16x32_bf16 v[192:195], a[128:131], a[96:99], v[228:231]
  v_exp_f32_e64 v202, v202
  v_mfma_f32_16x16x32_bf16 v[192:195], a[132:135], a[100:103], v[192:195]
  v_exp_f32_e64 v200, v200
  v_mfma_f32_16x16x32_bf16 v[192:195], a[136:139], a[104:107], v[192:195]
  v_exp_f32_e64 v203, v203
  v_mfma_f32_16x16x32_bf16 v[192:195], a[140:143], a[108:111], v[192:195]
  ds_write_b128 v232, v[152:155] offset:4608
  v_exp_f32_e64 v205, v205
  v_mfma_f32_16x16x32_bf16 v[196:199], a[144:147], a[108:111], v[228:231]
  v_cvt_pk_bf16_f32 v212, v200, v201
  v_cvt_pk_bf16_f32 v213, v202, v203
  v_mfma_f32_16x16x32_bf16 v[196:199], a[148:151], a[104:107], v[196:199]
  v_cvt_pk_bf16_f32 v214, v204, v205
  v_cvt_pk_bf16_f32 v215, v206, v207
  v_mfma_f32_16x16x32_bf16 v[196:199], a[152:155], a[100:103], v[196:199]
  v_mul_f32 v202, s29, v194
  v_mul_f32 v203, s29, v195
  v_mfma_f32_16x16x32_bf16 v[196:199], a[156:159], a[96:99], v[196:199]
  ds_write_b128 v232, v[156:159] offset:4864
  global_load_dword a120, v[252:253], off
  v_smfmac_f32_16x16x64_bf16 a[196:199], a[220:223], v[208:215], v254
  v_mul_f32_e64 v201, s29, v193
  v_mfma_f32_16x16x32_bf16 v[96:99], v[212:215], a[160:163], 0
  v_mul_f32 v200, s29, v192
  v_add_u32 v216, s30, v218
  v_mfma_f32_16x16x32_bf16 v[100:103], v[212:215], a[164:167], 0
  v_mul_f32 v205, s29, v197
  v_mul_f32 v206, s29, v198
  v_mfma_f32_16x16x32_bf16 v[104:107], v[212:215], a[168:171], 0
  ds_write_b128 v232, v[128:131] offset:8192
  v_mul_f32 v204, s29, v196
  v_mul_f32 v207, s29, v199
  v_mfma_f32_16x16x32_bf16 v[108:111], v[212:215], a[172:175], 0
  v_exp_f32_e64 v204, v204
  v_mfma_f32_16x16x32_bf16 v[112:115], v[212:215], a[176:179], 0
  v_exp_f32_e64 v203, v203
  v_mfma_f32_16x16x32_bf16 v[116:119], v[212:215], a[180:183], 0
  v_exp_f32_e64 v201, v201
  v_mfma_f32_16x16x32_bf16 v[120:123], v[212:215], a[184:187], 0
  ds_write_b128 v232, v[132:135] offset:8448
  v_exp_f32_e64 v200, v200
  v_mfma_f32_16x16x32_bf16 v[124:127], v[212:215], a[188:191], 0
  v_exp_f32_e64 v205, v205
  v_mfma_f32_16x16x32_bf16 v[192:195], a[128:131], a[64:67], v[228:231]
  v_exp_f32_e64 v206, v206
  v_mfma_f32_16x16x32_bf16 v[192:195], a[132:135], a[68:71], v[192:195]
  v_exp_f32_e64 v202, v202
  v_mfma_f32_16x16x32_bf16 v[192:195], a[136:139], a[72:75], v[192:195]
  ds_write_b128 v232, v[136:139] offset:8704
  v_exp_f32_e64 v207, v207
  v_mfma_f32_16x16x32_bf16 v[192:195], a[140:143], a[76:79], v[192:195]
  v_cvt_pk_bf16_f32 v210, v204, v205
  v_cvt_pk_bf16_f32 v211, v206, v207
  v_mfma_f32_16x16x32_bf16 v[196:199], a[144:147], a[76:79], v[228:231]
  v_cvt_pk_bf16_f32 v208, v200, v201
  v_cvt_pk_bf16_f32 v209, v202, v203
  v_mfma_f32_16x16x32_bf16 v[196:199], a[148:151], a[72:75], v[196:199]
  v_add_u32_e64 v217, s30, v219
  v_mfma_f32_16x16x32_bf16 v[196:199], a[152:155], a[68:71], v[196:199]
  ds_write_b128 v232, v[140:143] offset:8960
  v_mul_f32 v201, s29, v193
  v_mul_f32 v203, s29, v195
  v_mfma_f32_16x16x32_bf16 v[196:199], a[156:159], a[64:67], v[196:199]
  v_mul_f32 v200, s29, v192
  v_mul_f32 v202, s29, v194
  v_mfma_f32_16x16x32_bf16 a[204:207], a[220:223], v[208:211], 0
  v_exp_f32_e64 v200, v200
  v_mfma_f32_16x16x32_bf16 a[224:227], v[208:211], a[160:163], 0
  v_exp_f32_e64 v203, v203
  v_mfma_f32_16x16x32_bf16 a[228:231], v[208:211], a[164:167], 0
  v_mul_f32 v204, s29, v196
  v_mul_f32 v206, s29, v198
  v_mfma_f32_16x16x32_bf16 a[232:235], v[208:211], a[168:171], 0
  v_mul_f32 v205, s29, v197
  v_mul_f32 v207, s29, v199
  v_mfma_f32_16x16x32_bf16 a[236:239], v[208:211], a[172:175], 0
  v_exp_f32_e64 v205, v205
  v_mfma_f32_16x16x32_bf16 a[240:243], v[208:211], a[176:179], 0
  v_exp_f32_e64 v206, v206
  v_mfma_f32_16x16x32_bf16 a[244:247], v[208:211], a[180:183], 0
  v_exp_f32_e64 v207, v207
  v_mfma_f32_16x16x32_bf16 a[248:251], v[208:211], a[184:187], 0
  v_exp_f32_e64 v202, v202
  v_mfma_f32_16x16x32_bf16 a[252:255], v[208:211], a[188:191], 0
  v_exp_f32_e64 v201, v201
  v_mfma_f32_16x16x32_bf16 v[192:195], a[128:131], a[80:83], v[228:231]
  v_exp_f32_e64 v204, v204
  v_mfma_f32_16x16x32_bf16 v[192:195], a[132:135], a[84:87], v[192:195]
  ds_read_b128 a[128:131], v216 offset:0
  ds_read_b128 a[132:135], v216 offset:64
  v_mfma_f32_16x16x32_bf16 v[192:195], a[136:139], a[88:91], v[192:195]
  v_cvt_pk_bf16_f32 v208, v200, v201
  v_cvt_pk_bf16_f32 v209, v202, v203
  v_mfma_f32_16x16x32_bf16 v[192:195], a[140:143], a[92:95], v[192:195]
  ds_read_b128 a[136:139], v216 offset:128
  ds_read_b128 a[140:143], v216 offset:192
  v_mfma_f32_16x16x32_bf16 v[196:199], a[144:147], a[92:95], v[228:231]
  v_cvt_pk_bf16_f32 v210, v204, v205
  v_cvt_pk_bf16_f32 v211, v206, v207
  v_mfma_f32_16x16x32_bf16 v[196:199], a[148:151], a[88:91], v[196:199]
  ds_read_b128 a[144:147], v216 offset:704
  ds_read_b128 a[148:151], v216 offset:640
  v_mfma_f32_16x16x32_bf16 v[196:199], a[152:155], a[84:87], v[196:199]
  v_mul_f32 v200, s29, v192
  v_mul_f32 v202, s29, v194
  v_mfma_f32_16x16x32_bf16 v[196:199], a[156:159], a[80:83], v[196:199]
  ds_read_b128 a[152:155], v216 offset:576
  ds_read_b128 a[156:159], v216 offset:512
  v_mfma_f32_16x16x32_bf16 v[128:131], v[208:211], a[160:163], 0
  v_mul_f32 v201, s29, v193
  v_mul_f32 v203, s29, v195
  v_mfma_f32_16x16x32_bf16 v[132:135], v[208:211], a[164:167], 0
  v_exp_f32_e64 v200, v200
  v_mfma_f32_16x16x32_bf16 v[136:139], v[208:211], a[168:171], 0
  v_mul_f32 v204, s29, v196
  v_mul_f32 v205, s29, v197
  v_mfma_f32_16x16x32_bf16 v[140:143], v[208:211], a[172:175], 0
  v_exp_f32_e64 v202, v202
  v_mfma_f32_16x16x32_bf16 v[144:147], v[208:211], a[176:179], 0
  v_exp_f32_e64 v201, v201
  v_mfma_f32_16x16x32_bf16 v[148:151], v[208:211], a[180:183], 0
  v_exp_f32_e64 v203, v203
  v_mfma_f32_16x16x32_bf16 v[152:155], v[208:211], a[184:187], 0
  v_mfma_f32_16x16x32_bf16 v[156:159], v[208:211], a[188:191], 0
  s_waitcnt lgkmcnt(0)
  v_mul_f32 v206, s29, v198
  v_mul_f32_e64 v207, s29, v199
  v_mfma_f32_16x16x32_bf16 v[192:195], a[128:131], a[0:3], v[228:231]
  v_exp_f32_e64 v204, v204
  v_mfma_f32_16x16x32_bf16 v[192:195], a[132:135], a[4:7], v[192:195]
  v_exp_f32_e64 v207, v207
  v_mfma_f32_16x16x32_bf16 v[192:195], a[136:139], a[8:11], v[192:195]
  v_exp_f32_e64 v206, v206
  v_mfma_f32_16x16x32_bf16 v[192:195], a[140:143], a[12:15], v[192:195]
  v_exp_f32_e64 v205, v205
  v_mfma_f32_16x16x32_bf16 v[196:199], a[144:147], a[12:15], v[228:231]
  v_cvt_pk_bf16_f32 v214, v204, v205
  v_cvt_pk_bf16_f32 v215, v206, v207
  v_mfma_f32_16x16x32_bf16 v[196:199], a[148:151], a[8:11], v[196:199]
  v_cvt_pk_bf16_f32 v212, v200, v201
  v_cvt_pk_bf16_f32 v213, v202, v203
  v_mfma_f32_16x16x32_bf16 v[196:199], a[152:155], a[4:7], v[196:199]
  v_mul_f32 v201, s29, v193
  v_mul_f32 v202, s29, v194
  v_mfma_f32_16x16x32_bf16 v[196:199], a[156:159], a[0:3], v[196:199]
  v_mul_f32 v200, s29, v192
  v_mul_f32 v203, s29, v195
  v_mfma_f32_16x16x32_bf16 v[160:163], v[212:215], a[160:163], 0
  v_exp_f32_e64 v203, v203
  v_mfma_f32_16x16x32_bf16 v[164:167], v[212:215], a[164:167], 0
  ds_read_b64_tr_b16 a[162:163], v217 offset:8960
  ds_read_b64_tr_b16 a[164:165], v217 offset:8464
  v_mfma_f32_16x16x32_bf16 v[168:171], v[212:215], a[168:171], 0
  v_mul_f32 v205, s29, v197
  v_mul_f32 v207, s29, v199
  v_mfma_f32_16x16x32_bf16 v[172:175], v[212:215], a[172:175], 0
  ds_read_b64_tr_b16 a[166:167], v217 offset:8976
  ds_read_b64_tr_b16 a[172:173], v217 offset:8496
  v_mfma_f32_16x16x32_bf16 v[176:179], v[212:215], a[176:179], 0
  v_exp_f32_e64 v201, v201
  v_mfma_f32_16x16x32_bf16 v[180:183], v[212:215], a[180:183], 0
  ds_read_b64_tr_b16 a[160:161], v217 offset:8448
  ds_read_b64_tr_b16 a[174:175], v217 offset:9008
  v_mfma_f32_16x16x32_bf16 v[184:187], v[212:215], a[184:187], 0
  v_exp_f32_e64 v200, v200
  v_mfma_f32_16x16x32_bf16 v[188:191], v[212:215], a[188:191], 0
  ds_read_b64_tr_b16 a[168:169], v217 offset:8480
  ds_read_b64_tr_b16 a[170:171], v217 offset:8992
  v_smfmac_f32_16x16x64_bf16 a[200:203], a[220:223], v[208:215], v254
  v_exp_f32 v202, v202
  v_mul_f32 v204, s29, v196
  v_mul_f32 v206, s29, v198
  s_cmp_eq_u32 s38, 1
  s_cselect_b32 s37, 12, 14
  s_cbranch_scc1 L_pC1
  s_branch L_pA1
  .p2align 6
L_pA1:
  v_mfma_f32_16x16x32_bf16 v[192:195], a[128:131], a[16:19], v[228:231]
  v_exp_f32_e64 v205, v205
  v_mfma_f32_16x16x32_bf16 v[192:195], a[132:135], a[20:23], v[192:195]
  ds_read_b64_tr_b16 a[176:177], v217 offset:8512
  ds_read_b64_tr_b16 a[178:179], v217 offset:9024
  v_mfma_f32_16x16x32_bf16 v[192:195], a[136:139], a[24:27], v[192:195]
  v_exp_f32_e64 v206, v206
  v_mfma_f32_16x16x32_bf16 v[192:195], a[140:143], a[28:31], v[192:195]
  ds_read_b64_tr_b16 a[180:181], v217 offset:8528
  ds_read_b64_tr_b16 a[182:183], v217 offset:9040
  v_mfma_f32_16x16x32_bf16 v[196:199], a[144:147], a[28:31], v[228:231]
  v_exp_f32_e64 v207, v207
  v_mfma_f32_16x16x32_bf16 v[196:199], a[148:151], a[24:27], v[196:199]
  s_waitcnt lgkmcnt(4)
  v_exp_f32 v204, v204
  v_mfma_f32_16x16x32_bf16 v[196:199], a[152:155], a[20:23], v[196:199]
  ds_read_b64_tr_b16 a[184:185], v217 offset:8544
  ds_read_b64_tr_b16 a[186:187], v217 offset:9056
  v_cvt_pk_bf16_f32 v208, v200, v201
  v_cvt_pk_bf16_f32 v209, v202, v203
  v_cvt_pk_bf16_f32 v210, v204, v205
  v_cvt_pk_bf16_f32 v211, v206, v207
  v_mfma_f32_16x16x32_bf16 v[196:199], a[156:159], a[16:19], v[196:199]
  ds_read_b64_tr_b16 a[188:189], v217 offset:8560
  ds_read_b64_tr_b16 a[190:191], v217 offset:9072
  v_mfma_f32_16x16x32_bf16 v[0:3], v[208:211], a[160:163], v[0:3]
  v_mul_f32 v200, s29, v192
  v_mul_f32 v203, s29, v195
  v_mfma_f32_16x16x32_bf16 v[4:7], v[208:211], a[164:167], v[4:7]
  v_mul_f32 v201, s29, v193
  v_mul_f32 v202, s29, v194
  v_mfma_f32_16x16x32_bf16 v[8:11], v[208:211], a[168:171], v[8:11]
  v_mul_f32 v204, s29, v196
  v_mul_f32 v205, s29, v197
  v_mfma_f32_16x16x32_bf16 v[12:15], v[208:211], a[172:175], v[12:15]
  s_waitcnt lgkmcnt(4)
  v_mul_f32 v206, s29, v198
  v_mul_f32_e64 v207, s29, v199
  v_mfma_f32_16x16x32_bf16 v[16:19], v[208:211], a[176:179], v[16:19]
  v_exp_f32_e64 v204, v204
  v_mfma_f32_16x16x32_bf16 v[20:23], v[208:211], a[180:183], v[20:23]
  s_waitcnt lgkmcnt(2)
  v_exp_f32 v203, v203
  v_mfma_f32_16x16x32_bf16 v[24:27], v[208:211], a[184:187], v[24:27]
  s_waitcnt lgkmcnt(0)
  v_exp_f32 v200, v200
  v_mfma_f32_16x16x32_bf16 v[28:31], v[208:211], a[188:191], v[28:31]
  v_exp_f32_e64 v202, v202
  v_mfma_f32_16x16x32_bf16 v[192:195], a[128:131], a[32:35], v[228:231]
  v_exp_f32_e64 v201, v201
  v_mfma_f32_16x16x32_bf16 v[192:195], a[132:135], a[36:39], v[192:195]
  v_exp_f32_e64 v205, v205
  v_mfma_f32_16x16x32_bf16 v[192:195], a[136:139], a[40:43], v[192:195]
  v_exp_f32_e64 v207, v207
  v_mfma_f32_16x16x32_bf16 v[192:195], a[140:143], a[44:47], v[192:195]
  v_exp_f32_e64 v206, v206
  v_mfma_f32_16x16x32_bf16 v[196:199], a[144:147], a[44:47], v[228:231]
  v_cvt_pk_bf16_f32 v213, v202, v203
  v_cvt_pk_bf16_f32 v214, v204, v205
  v_mfma_f32_16x16x32_bf16 v[196:199], a[148:151], a[40:43], v[196:199]
  v_cvt_pk_bf16_f32 v212, v200, v201
  v_cvt_pk_bf16_f32 v215, v206, v207
  v_mfma_f32_16x16x32_bf16 v[196:199], a[152:155], a[36:39], v[196:199]
  s_mov_b32 m0, s30
  v_mul_f32 v202, s29, v194
  v_mul_f32_e64 v203, s29, v195
  v_mfma_f32_16x16x32_bf16 v[196:199], a[156:159], a[32:35], v[196:199]
  s_waitcnt vmcnt(9)
  v_mul_f32 v200, s29, v192
  v_mul_f32_e64 v201, s29, v193
  v_smfmac_f32_16x16x64_bf16 a[192:195], a[220:223], v[208:215], v254
  s_barrier
  v_mfma_f32_16x16x32_bf16 v[32:35], v[212:215], a[160:163], v[32:35]
  buffer_load_dwordx4 v221, s[4:7], s33 offen lds
  v_mfma_f32_16x16x32_bf16 v[36:39], v[212:215], a[164:167], v[36:39]
  v_mul_f32 v205, s29, v197
  v_mul_f32_e64 v207, s29, v199
  v_mfma_f32_16x16x32_bf16 v[40:43], v[212:215], a[168:171], v[40:43]
  v_mul_f32 v204, s29, v196
  v_mul_f32 v206, s29, v198
  v_mfma_f32_16x16x32_bf16 v[44:47], v[212:215], a[172:175], v[44:47]
  s_add_u32 m0, s30, 32
  v_exp_f32 v205, v205
  v_mfma_f32_16x16x32_bf16 v[48:51], v[212:215], a[176:179], v[48:51]
  buffer_load_dwordx4 v221, s[4:7], s33 offen offset:1024 lds
  v_mfma_f32_16x16x32_bf16 v[52:55], v[212:215], a[180:183], v[52:55]
  v_exp_f32_e64 v200, v200
  v_mfma_f32_16x16x32_bf16 v[56:59], v[212:215], a[184:187], v[56:59]
  v_exp_f32_e64 v204, v204
  v_mfma_f32_16x16x32_bf16 v[60:63], v[212:215], a[188:191], v[60:63]
  s_add_u32 m0, s30, s96
  v_exp_f32 v201, v201
  v_mfma_f32_16x16x32_bf16 v[192:195], a[128:131], a[48:51], v[228:231]
  buffer_load_dwordx4 v221, s[8:11], s33 offen lds
  v_mfma_f32_16x16x32_bf16 v[192:195], a[132:135], a[52:55], v[192:195]
  v_exp_f32_e64 v206, v206
  v_mfma_f32_16x16x32_bf16 v[192:195], a[136:139], a[56:59], v[192:195]
  v_exp_f32_e64 v207, v207
  v_mfma_f32_16x16x32_bf16 v[192:195], a[140:143], a[60:63], v[192:195]
  v_exp_f32_e64 v202, v202
  v_mfma_f32_16x16x32_bf16 v[196:199], a[144:147], a[60:63], v[228:231]
  v_exp_f32_e64 v203, v203
  v_mfma_f32_16x16x32_bf16 v[196:199], a[148:151], a[56:59], v[196:199]
  v_cvt_pk_bf16_f32 v209, v202, v203
  v_cvt_pk_bf16_f32 v210, v204, v205
  v_mfma_f32_16x16x32_bf16 v[196:199], a[152:155], a[52:55], v[196:199]
  v_cvt_pk_bf16_f32 v208, v200, v201
  v_cvt_pk_bf16_f32 v211, v206, v207
  v_mfma_f32_16x16x32_bf16 v[196:199], a[156:159], a[48:51], v[196:199]
  s_add_u32 m0, s30, s97
  v_mul_f32 v200, s29, v192
  v_mul_f32_e64 v201, s29, v193
  v_mfma_f32_16x16x32_bf16 v[64:67], v[208:211], a[160:163], v[64:67]
  buffer_load_dwordx4 v221, s[8:11], s33 offen offset:1024 lds
  v_mfma_f32_16x16x32_bf16 v[68:71], v[208:211], a[164:167], v[68:71]
  s_sub_u32 s30, s30, 16896
  v_mul_f32 v202, s29, v194
  v_mul_f32 v203, s29, v195
  v_mfma_f32_16x16x32_bf16 v[72:75], v[208:211], a[168:171], v[72:75]
  s_cselect_b32 s30, s31, s30
  v_mul_f32 v205, s29, v197
  v_mul_f32_e64 v207, s29, v199
  v_mfma_f32_16x16x32_bf16 v[76:79], v[208:211], a[172:175], v[76:79]
  s_add_u32 s59, s59, 8192
  v_mul_f32 v204, s29, v196
  v_mul_f32 v206, s29, v198
  v_mfma_f32_16x16x32_bf16 v[80:83], v[208:211], a[176:179], v[80:83]
  s_xor_b32 s33, s59, s3
  v_exp_f32 v207, v207
  v_mfma_f32_16x16x32_bf16 v[84:87], v[208:211], a[180:183], v[84:87]
  v_exp_f32_e64 v200, v200
  v_mfma_f32_16x16x32_bf16 v[88:91], v[208:211], a[184:187], v[88:91]
  v_exp_f32_e64 v205, v205
  v_mfma_f32_16x16x32_bf16 v[92:95], v[208:211], a[188:191], v[92:95]
  v_exp_f32_e64 v206, v206
  v_mfma_f32_16x16x32_bf16 v[192:195], a[128:131], a[96:99], v[228:231]
  v_exp_f32_e64 v204, v204
  v_mfma_f32_16x16x32_bf16 v[192:195], a[132:135], a[100:103], v[192:195]
  v_exp_f32_e64 v201, v201
  v_mfma_f32_16x16x32_bf16 v[192:195], a[136:139], a[104:107], v[192:195]
  v_exp_f32_e64 v203, v203
  v_mfma_f32_16x16x32_bf16 v[192:195], a[140:143], a[108:111], v[192:195]
  v_exp_f32_e64 v202, v202
  v_mfma_f32_16x16x32_bf16 v[196:199], a[144:147], a[108:111], v[228:231]
  v_cvt_pk_bf16_f32 v214, v204, v205
  v_cvt_pk_bf16_f32 v215, v206, v207
  v_mfma_f32_16x16x32_bf16 v[196:199], a[148:151], a[104:107], v[196:199]
  v_cvt_pk_bf16_f32 v212, v200, v201
  v_cvt_pk_bf16_f32 v213, v202, v203
  v_mfma_f32_16x16x32_bf16 v[196:199], a[152:155], a[100:103], v[196:199]
  ds_read_b64_tr_b16 a[112:113], v220 offset:0
  ds_read_b64_tr_b16 a[114:115], v220 offset:64
  v_mfma_f32_16x16x32_bf16 v[196:199], a[156:159], a[96:99], v[196:199]
  v_mul_f32 v200, s29, v192
  v_mul_f32 v201, s29, v193
  v_smfmac_f32_16x16x64_bf16 a[196:199], a[220:223], v[208:215], v254
  ds_read_b64_tr_b16 a[116:117], v220 offset:1024
  ds_read_b64_tr_b16 a[118:119], v220 offset:1088
  v_mfma_f32_16x16x32_bf16 v[96:99], v[212:215], a[160:163], v[96:99]
  v_mul_f32 v202, s29, v194
  v_mul_f32 v203, s29, v195
  v_mfma_f32_16x16x32_bf16 v[100:103], v[212:215], a[164:167], v[100:103]
  v_mul_f32 v204, s29, v196
  v_mul_f32 v206, s29, v198
  v_mfma_f32_16x16x32_bf16 v[104:107], v[212:215], a[168:171], v[104:107]
  v_mul_f32 v205, s29, v197
  v_mul_f32 v207, s29, v199
  v_mfma_f32_16x16x32_bf16 v[108:111], v[212:215], a[172:175], v[108:111]
  v_exp_f32_e64 v205, v205
  v_mfma_f32_16x16x32_bf16 v[112:115], v[212:215], a[176:179], v[112:115]
  v_exp_f32_e64 v202, v202
  v_mfma_f32_16x16x32_bf16 v[116:119], v[212:215], a[180:183], v[116:119]
  v_exp_f32_e64 v206, v206
  v_mfma_f32_16x16x32_bf16 v[120:123], v[212:215], a[184:187], v[120:123]
  v_exp_f32_e64 v207, v207
  v_mfma_f32_16x16x32_bf16 v[124:127], v[212:215], a[188:191], v[124:127]
  v_exp_f32_e64 v203, v203
  v_mfma_f32_16x16x32_bf16 v[192:195], a[128:131], a[64:67], v[228:231]
  v_exp_f32_e64 v200, v200
  v_mfma_f32_16x16x32_bf16 v[192:195], a[132:135], a[68:71], v[192:195]
  v_exp_f32_e64 v201, v201
  v_mfma_f32_16x16x32_bf16 v[192:195], a[136:139], a[72:75], v[192:195]
  s_waitcnt lgkmcnt(0)
  v_exp_f32 v204, v204
  v_mfma_f32_16x16x32_bf16 v[192:195], a[140:143], a[76:79], v[192:195]
  buffer_store_dwordx4 a[116:119], v233, s[16:19], s35 offen offset:1024
  v_cvt_pk_bf16_f32 v208, v200, v201
  v_cvt_pk_bf16_f32 v209, v202, v203
  v_mfma_f32_16x16x32_bf16 v[196:199], a[144:147], a[76:79], v[228:231]
  v_cvt_pk_bf16_f32 v210, v204, v205
  v_cvt_pk_bf16_f32 v211, v206, v207
  v_mfma_f32_16x16x32_bf16 v[196:199], a[148:151], a[72:75], v[196:199]
  v_add_u32 v216, s30, v218
  v_add_u32 v217, s30, v219
  v_mfma_f32_16x16x32_bf16 v[196:199], a[152:155], a[68:71], v[196:199]
  s_mov_b32 m0, s36
  v_mul_f32 v202, s29, v194
  v_mul_f32_e64 v203, s29, v195
  v_mfma_f32_16x16x32_bf16 v[196:199], a[156:159], a[64:67], v[196:199]
  buffer_load_dwordx4 v222, s[12:15], s34 offen nt lds
  v_mfma_f32_16x16x32_bf16 a[204:207], a[220:223], v[208:211], a[204:207]
  s_add_u32 s36, s36, 2048
  v_mul_f32 v200, s29, v192
  v_mul_f32 v201, s29, v193
  v_mfma_f32_16x16x32_bf16 a[224:227], v[208:211], a[160:163], a[224:227]
  v_exp_f32_e64 v201, v201
  v_mfma_f32_16x16x32_bf16 a[228:231], v[208:211], a[164:167], a[228:231]
  v_mul_f32 v205, s29, v197
  v_mul_f32 v206, s29, v198
  v_mfma_f32_16x16x32_bf16 a[232:235], v[208:211], a[168:171], a[232:235]
  buffer_load_dwordx4 v223, s[12:15], s34 offen offset:1024 nt lds
  v_mfma_f32_16x16x32_bf16 a[236:239], v[208:211], a[172:175], a[236:239]
  s_add_u32 s34, s34, 2048
  v_mul_f32 v204, s29, v196
  v_mul_f32 v207, s29, v199
  v_mfma_f32_16x16x32_bf16 a[240:243], v[208:211], a[176:179], a[240:243]
  v_exp_f32_e64 v207, v207
  v_mfma_f32_16x16x32_bf16 a[244:247], v[208:211], a[180:183], a[244:247]
  v_exp_f32_e64 v200, v200
  v_mfma_f32_16x16x32_bf16 a[248:251], v[208:211], a[184:187], a[248:251]
  buffer_store_dwordx4 a[112:115], v233, s[16:19], s35 offen
  v_exp_f32_e64 v202, v202
  v_mfma_f32_16x16x32_bf16 a[252:255], v[208:211], a[188:191], a[252:255]
  s_add_u32 s35, s35, 2048
  v_exp_f32_e64 v206, v206
  v_mfma_f32_16x16x32_bf16 v[192:195], a[128:131], a[80:83], v[228:231]
  ds_read_b128 a[128:131], v216 offset:0
  v_cvt_pk_bf16_f32 v211, v206, v207
  v_mfma_f32_16x16x32_bf16 v[192:195], a[132:135], a[84:87], v[192:195]
  v_exp_f32_e64 v204, v204
  v_mfma_f32_16x16x32_bf16 v[192:195], a[136:139], a[88:91], v[192:195]
  ds_read_b128 a[132:135], v216 offset:64
  ds_read_b128 a[136:139], v216 offset:128
  v_mfma_f32_16x16x32_bf16 v[192:195], a[140:143], a[92:95], v[192:195]
  v_exp_f32_e64 v205, v205
  v_mfma_f32_16x16x32_bf16 v[196:199], a[144:147], a[92:95], v[228:231]
  ds_read_b128 a[140:143], v216 offset:192
  ds_read_b128 a[144:147], v216 offset:704
  v_mfma_f32_16x16x32_bf16 v[196:199], a[148:151], a[88:91], v[196:199]
  v_exp_f32_e64 v203, v203
  v_mfma_f32_16x16x32_bf16 v[196:199], a[152:155], a[84:87], v[196:199]
  v_cvt_pk_bf16_f32 v208, v200, v201
  v_cvt_pk_bf16_f32 v209, v202, v203
  v_cvt_pk_bf16_f32 v210, v204, v205
  v_mfma_f32_16x16x32_bf16 v[196:199], a[156:159], a[80:83], v[196:199]
  v_mul_f32 v200, s29, v192
  v_mul_f32 v202, s29, v194
  v_mfma_f32_16x16x32_bf16 v[128:131], v[208:211], a[160:163], v[128:131]
  ds_read_b128 a[148:151], v216 offset:640
  ds_read_b128 a[152:155], v216 offset:576
  v_mfma_f32_16x16x32_bf16 v[132:135], v[208:211], a[164:167], v[132:135]
  v_mul_f32 v201, s29, v193
  v_mul_f32 v203, s29, v195
  v_mfma_f32_16x16x32_bf16 v[136:139], v[208:211], a[168:171], v[136:139]
  ds_read_b128 a[156:159], v216 offset:512
  v_mul_f32_e64 v205, s29, v197
  v_mfma_f32_16x16x32_bf16 v[140:143], v[208:211], a[172:175], v[140:143]
  v_exp_f32_e64 v202, v202
  v_mfma_f32_16x16x32_bf16 v[144:147], v[208:211], a[176:179], v[144:147]
  v_exp_f32_e64 v201, v201
  v_mfma_f32_16x16x32_bf16 v[148:151], v[208:211], a[180:183], v[148:151]
  s_sub_u32 s37, s37, 1
  v_exp_f32 v203, v203
  v_mfma_f32_16x16x32_bf16 v[152:155], v[208:211], a[184:187], v[152:155]
  s_waitcnt lgkmcnt(3)
  v_exp_f32 v200, v200
  v_mul_f32_e64 v204, s29, v196
  v_mfma_f32_16x16x32_bf16 v[156:159], v[208:211], a[188:191], v[156:159]
  s_cbranch_scc1 L_exitA
  v_mul_f32 v206, s29, v198
  v_mul_f32_e64 v207, s29, v199
  v_mfma_f32_16x16x32_bf16 v[192:195], a[128:131], a[0:3], v[228:231]
  v_exp_f32_e64 v206, v206
  v_mfma_f32_16x16x32_bf16 v[192:195], a[132:135], a[4:7], v[192:195]
  v_exp_f32_e64 v204, v204
  v_mfma_f32_16x16x32_bf16 v[192:195], a[136:139], a[8:11], v[192:195]
  v_exp_f32_e64 v205, v205
  v_mfma_f32_16x16x32_bf16 v[192:195], a[140:143], a[12:15], v[192:195]
  v_exp_f32_e64 v207, v207
  v_mfma_f32_16x16x32_bf16 v[196:199], a[144:147], a[12:15], v[228:231]
  s_waitcnt lgkmcnt(0)
  v_cvt_pk_bf16_f32 v214, v204, v205
  v_cvt_pk_bf16_f32 v215, v206, v207
  v_mfma_f32_16x16x32_bf16 v[196:199], a[148:151], a[8:11], v[196:199]
  v_cvt_pk_bf16_f32 v212, v200, v201
  v_cvt_pk_bf16_f32 v213, v202, v203
  v_mfma_f32_16x16x32_bf16 v[196:199], a[152:155], a[4:7], v[196:199]
  v_mul_f32 v200, s29, v192
  v_mul_f32_e64 v203, s29, v195
  v_mfma_f32_16x16x32_bf16 v[196:199], a[156:159], a[0:3], v[196:199]
  v_mul_f32 v201, s29, v193
  v_mul_f32 v202, s29, v194
  v_mfma_f32_16x16x32_bf16 v[160:163], v[212:215], a[160:163], v[160:163]
  ds_read_b64_tr_b16 a[160:161], v217 offset:8448
  ds_read_b64_tr_b16 a[162:163], v217 offset:8960
  v_mfma_f32_16x16x32_bf16 v[164:167], v[212:215], a[164:167], v[164:167]
  v_exp_f32_e64 v201, v201
  v_mfma_f32_16x16x32_bf16 v[168:171], v[212:215], a[168:171], v[168:171]
  ds_read_b64_tr_b16 a[166:167], v217 offset:8976
  ds_read_b64_tr_b16 a[168:169], v217 offset:8480
  v_mfma_f32_16x16x32_bf16 v[172:175], v[212:215], a[172:175], v[172:175]
  v_mul_f32 v204, s29, v196
  v_mul_f32 v205, s29, v197
  v_mfma_f32_16x16x32_bf16 v[176:179], v[212:215], a[176:179], v[176:179]
  ds_read_b64_tr_b16 a[164:165], v217 offset:8464
  ds_read_b64_tr_b16 a[172:173], v217 offset:8496
  v_mfma_f32_16x16x32_bf16 v[180:183], v[212:215], a[180:183], v[180:183]
  v_exp_f32_e64 v202, v202
  v_mfma_f32_16x16x32_bf16 v[184:187], v[212:215], a[184:187], v[184:187]
  ds_read_b64_tr_b16 a[170:171], v217 offset:8992
  ds_read_b64_tr_b16 a[174:175], v217 offset:9008
  v_mfma_f32_16x16x32_bf16 v[188:191], v[212:215], a[188:191], v[188:191]
  v_exp_f32_e64 v203, v203
  v_smfmac_f32_16x16x64_bf16 a[200:203], a[220:223], v[208:215], v254
  v_exp_f32 v200, v200
  v_mul_f32 v206, s29, v198
  v_mul_f32_e64 v207, s29, v199
L_pA2:
  v_mfma_f32_16x16x32_bf16 v[192:195], a[128:131], a[16:19], v[228:231]
  ds_read_b64_tr_b16 a[176:177], v217 offset:8512
  ds_read_b64_tr_b16 a[188:189], v217 offset:8560
  v_mfma_f32_16x16x32_bf16 v[192:195], a[132:135], a[20:23], v[192:195]
  v_exp_f32_e64 v206, v206
  v_mfma_f32_16x16x32_bf16 v[192:195], a[136:139], a[24:27], v[192:195]
  ds_read_b64_tr_b16 a[178:179], v217 offset:9024
  ds_read_b64_tr_b16 a[190:191], v217 offset:9072
  v_mfma_f32_16x16x32_bf16 v[192:195], a[140:143], a[28:31], v[192:195]
  v_cvt_pk_bf16_f32 v208, v200, v201
  v_cvt_pk_bf16_f32 v209, v202, v203
  v_mfma_f32_16x16x32_bf16 v[196:199], a[144:147], a[28:31], v[228:231]
  ds_read_b64_tr_b16 a[180:181], v217 offset:8528
  ds_read_b64_tr_b16 a[182:183], v217 offset:9040
  v_mfma_f32_16x16x32_bf16 v[196:199], a[148:151], a[24:27], v[196:199]
  v_exp_f32 v204, v204
  v_exp_f32 v205, v205
  v_exp_f32_e64 v207, v207
  v_mfma_f32_16x16x32_bf16 v[196:199], a[152:155], a[20:23], v[196:199]
  ds_read_b64_tr_b16 a[184:185], v217 offset:8544
  ds_read_b64_tr_b16 a[186:187], v217 offset:9056
  v_cvt_pk_bf16_f32 v210, v204, v205
  v_cvt_pk_bf16_f32 v211, v206, v207
  v_mfma_f32_16x16x32_bf16 v[196:199], a[156:159], a[16:19], v[196:199]
  s_waitcnt lgkmcnt(8)
  v_mul_f32 v201, s29, v193
  v_mul_f32_e64 v202, s29, v194
  v_mfma_f32_16x16x32_bf16 v[0:3], v[208:211], a[160:163], v[0:3]
  v_mul_f32 v200, s29, v192
  v_mul_f32 v203, s29, v195
  v_mfma_f32_16x16x32_bf16 v[4:7], v[208:211], a[164:167], v[4:7]
  v_exp_f32_e64 v202, v202
  v_mfma_f32_16x16x32_bf16 v[8:11], v[208:211], a[168:171], v[8:11]
  v_mul_f32 v205, s29, v197
  v_mul_f32 v207, s29, v199
  v_mfma_f32_16x16x32_bf16 v[12:15], v[208:211], a[172:175], v[12:15]
  s_waitcnt lgkmcnt(4)
  v_mul_f32 v204, s29, v196
  v_mul_f32_e64 v206, s29, v198
  v_mfma_f32_16x16x32_bf16 v[16:19], v[208:211], a[176:179], v[16:19]
  s_waitcnt lgkmcnt(2)
  v_exp_f32 v205, v205
  v_mfma_f32_16x16x32_bf16 v[20:23], v[208:211], a[180:183], v[20:23]
  s_waitcnt lgkmcnt(0)
  v_exp_f32 v203, v203
  v_mfma_f32_16x16x32_bf16 v[24:27], v[208:211], a[184:187], v[24:27]
  ds_read_b64_tr_b16 a[112:113], v220 offset:2048
  v_cvt_pk_bf16_f32 v213, v202, v203
  v_mfma_f32_16x16x32_bf16 v[28:31], v[208:211], a[188:191], v[28:31]
  v_exp_f32_e64 v206, v206
  v_mfma_f32_16x16x32_bf16 v[192:195], a[128:131], a[32:35], v[228:231]
  v_exp_f32_e64 v201, v201
  v_mfma_f32_16x16x32_bf16 v[192:195], a[132:135], a[36:39], v[192:195]
  v_exp_f32_e64 v204, v204
  v_mfma_f32_16x16x32_bf16 v[192:195], a[136:139], a[40:43], v[192:195]
  ds_read_b64_tr_b16 a[114:115], v220 offset:2112
  v_cvt_pk_bf16_f32 v214, v204, v205
  v_mfma_f32_16x16x32_bf16 v[192:195], a[140:143], a[44:47], v[192:195]
  v_exp_f32_e64 v207, v207
  v_mfma_f32_16x16x32_bf16 v[196:199], a[144:147], a[44:47], v[228:231]
  ds_read_b64_tr_b16 a[116:117], v220 offset:3072
  v_cvt_pk_bf16_f32 v215, v206, v207
  v_mfma_f32_16x16x32_bf16 v[196:199], a[148:151], a[40:43], v[196:199]
  v_exp_f32_e64 v200, v200
  v_mfma_f32_16x16x32_bf16 v[196:199], a[152:155], a[36:39], v[196:199]
  v_cvt_pk_bf16_f32 v212, v200, v201
  v_mul_f32_e64 v201, s29, v193
  v_mfma_f32_16x16x32_bf16 v[196:199], a[156:159], a[32:35], v[196:199]
  s_waitcnt vmcnt(9)
  v_mul_f32 v202, s29, v194
  v_mul_f32_e64 v203, s29, v195
  v_smfmac_f32_16x16x64_bf16 a[192:195], a[220:223], v[208:215], v254
  s_barrier
  v_mul_f32 v200, s29, v192
  v_mfma_f32_16x16x32_bf16 v[32:35], v[212:215], a[160:163], v[32:35]
  s_mov_b32 m0, s30
  v_exp_f32 v200, v200
  v_mfma_f32_16x16x32_bf16 v[36:39], v[212:215], a[164:167], v[36:39]
  buffer_load_dwordx4 v221, s[4:7], s33 offen lds
  v_mfma_f32_16x16x32_bf16 v[40:43], v[212:215], a[168:171], v[40:43]
  v_mul_f32 v206, s29, v198
  v_mul_f32 v207, s29, v199
  v_mfma_f32_16x16x32_bf16 v[44:47], v[212:215], a[172:175], v[44:47]
  v_mul_f32 v204, s29, v196
  v_mul_f32 v205, s29, v197
  v_mfma_f32_16x16x32_bf16 v[48:51], v[212:215], a[176:179], v[48:51]
  s_add_u32 m0, s30, 32
  v_exp_f32 v205, v205
  v_mfma_f32_16x16x32_bf16 v[52:55], v[212:215], a[180:183], v[52:55]
  buffer_load_dwordx4 v221, s[4:7], s33 offen offset:1024 lds
  v_mfma_f32_16x16x32_bf16 v[56:59], v[212:215], a[184:187], v[56:59]
  v_exp_f32_e64 v207, v207
  v_mfma_f32_16x16x32_bf16 v[60:63], v[212:215], a[188:191], v[60:63]
  v_exp_f32_e64 v206, v206
  v_mfma_f32_16x16x32_bf16 v[192:195], a[128:131], a[48:51], v[228:231]
  s_add_u32 m0, s30, s96
  v_exp_f32 v204, v204
  v_mfma_f32_16x16x32_bf16 v[192:195], a[132:135], a[52:55], v[192:195]
  buffer_load_dwordx4 v221, s[8:11], s33 offen lds
  v_mfma_f32_16x16x32_bf16 v[192:195], a[136:139], a[56:59], v[192:195]
  v_cvt_pk_bf16_f32 v210, v204, v205
  v_cvt_pk_bf16_f32 v211, v206, v207
  v_mfma_f32_16x16x32_bf16 v[192:195], a[140:143], a[60:63], v[192:195]
  v_exp_f32_e64 v202, v202
  v_mfma_f32_16x16x32_bf16 v[196:199], a[144:147], a[60:63], v[228:231]
  v_exp_f32_e64 v201, v201
  v_mfma_f32_16x16x32_bf16 v[196:199], a[148:151], a[56:59], v[196:199]
  v_exp_f32_e64 v203, v203
  v_mfma_f32_16x16x32_bf16 v[196:199], a[152:155], a[52:55], v[196:199]
  v_cvt_pk_bf16_f32 v208, v200, v201
  v_cvt_pk_bf16_f32 v209, v202, v203
  v_mfma_f32_16x16x32_bf16 v[196:199], a[156:159], a[48:51], v[196:199]
  ds_read_b64_tr_b16 a[118:119], v220 offset:3136
  v_mul_f32_e64 v203, s29, v195
  v_mfma_f32_16x16x32_bf16 v[64:67], v[208:211], a[160:163], v[64:67]
  s_add_u32 m0, s30, s97
  v_mul_f32 v200, s29, v192
  v_mul_f32_e64 v201, s29, v193
  v_mfma_f32_16x16x32_bf16 v[68:71], v[208:211], a[164:167], v[68:71]
  buffer_load_dwordx4 v221, s[8:11], s33 offen offset:1024 lds
  v_mfma_f32_16x16x32_bf16 v[72:75], v[208:211], a[168:171], v[72:75]
  s_sub_u32 s30, s30, 16896
  v_mul_f32 v204, s29, v196
  v_mul_f32 v205, s29, v197
  v_mfma_f32_16x16x32_bf16 v[76:79], v[208:211], a[172:175], v[76:79]
  s_cselect_b32 s30, s31, s30
  v_exp_f32 v203, v203
  v_mfma_f32_16x16x32_bf16 v[80:83], v[208:211], a[176:179], v[80:83]
  s_add_u32 s59, s59, 8192
  v_exp_f32_e64 v204, v204
  v_mfma_f32_16x16x32_bf16 v[84:87], v[208:211], a[180:183], v[84:87]
  s_xor_b32 s33, s59, s3
  v_mul_f32 v202, s29, v194
  v_mul_f32_e64 v207, s29, v199
  v_mfma_f32_16x16x32_bf16 v[88:91], v[208:211], a[184:187], v[88:91]
  v_exp_f32_e64 v207, v207
  v_mfma_f32_16x16x32_bf16 v[92:95], v[208:211], a[188:191], v[92:95]
  v_exp_f32_e64 v205, v205
  v_mfma_f32_16x16x32_bf16 v[192:195], a[128:131], a[96:99], v[228:231]
  s_waitcnt lgkmcnt(0)
  v_mul_f32 v206, s29, v198
  v_cvt_pk_bf16_f32 v214, v204, v205
  v_mfma_f32_16x16x32_bf16 v[192:195], a[132:135], a[100:103], v[192:195]
  buffer_store_dwordx4 a[116:119], v233, s[16:19], s35 offen offset:1024
  v_exp_f32_e64 v200, v200
  v_mfma_f32_16x16x32_bf16 v[192:195], a[136:139], a[104:107], v[192:195]
  v_exp_f32_e64 v201, v201
  v_mfma_f32_16x16x32_bf16 v[192:195], a[140:143], a[108:111], v[192:195]
  v_cvt_pk_bf16_f32 v212, v200, v201
  v_add_u32_e64 v216, s30, v218
  v_mfma_f32_16x16x32_bf16 v[196:199], a[144:147], a[108:111], v[228:231]
  v_exp_f32_e64 v202, v202
  v_mfma_f32_16x16x32_bf16 v[196:199], a[148:151], a[104:107], v[196:199]
  v_exp_f32_e64 v206, v206
  v_mfma_f32_16x16x32_bf16 v[196:199], a[152:155], a[100:103], v[196:199]
  v_cvt_pk_bf16_f32 v213, v202, v203
  v_cvt_pk_bf16_f32 v215, v206, v207
  v_mfma_f32_16x16x32_bf16 v[196:199], a[156:159], a[96:99], v[196:199]
  v_mul_f32 v202, s29, v194
  v_mul_f32 v203, s29, v195
  v_smfmac_f32_16x16x64_bf16 a[196:199], a[220:223], v[208:215], v254
  s_mov_b32 m0, s36
  v_mul_f32 v200, s29, v192
  v_mfma_f32_16x16x32_bf16 v[96:99], v[212:215], a[160:163], v[96:99]
  buffer_load_dwordx4 v222, s[12:15], s34 offen nt lds
  v_mfma_f32_16x16x32_bf16 v[100:103], v[212:215], a[164:167], v[100:103]
  s_add_u32 s36, s36, 2048
  v_mul_f32 v201, s29, v193
  v_mul_f32 v204, s29, v196
  v_mfma_f32_16x16x32_bf16 v[104:107], v[212:215], a[168:171], v[104:107]
  v_exp_f32_e64 v201, v201
  v_mfma_f32_16x16x32_bf16 v[108:111], v[212:215], a[172:175], v[108:111]
  v_mul_f32 v205, s29, v197
  v_mul_f32 v207, s29, v199
  v_mfma_f32_16x16x32_bf16 v[112:115], v[212:215], a[176:179], v[112:115]
  buffer_store_dwordx4 a[112:115], v233, s[16:19], s35 offen
  buffer_load_dwordx4 v223, s[12:15], s34 offen offset:1024 nt lds
  v_mfma_f32_16x16x32_bf16 v[116:119], v[212:215], a[180:183], v[116:119]
  s_add_u32 s35, s35, 2048
  v_exp_f32_e64 v207, v207
  v_mfma_f32_16x16x32_bf16 v[120:123], v[212:215], a[184:187], v[120:123]
  s_add_u32 s34, s34, 2048
  v_exp_f32_e64 v204, v204
  v_mfma_f32_16x16x32_bf16 v[124:127], v[212:215], a[188:191], v[124:127]
  v_exp_f32_e64 v200, v200
  v_mfma_f32_16x16x32_bf16 v[192:195], a[128:131], a[64:67], v[228:231]
  v_mul_f32_e64 v206, s29, v198
  v_cvt_pk_bf16_f32 v208, v200, v201
  v_mfma_f32_16x16x32_bf16 v[192:195], a[132:135], a[68:71], v[192:195]
  v_exp_f32_e64 v206, v206
  v_mfma_f32_16x16x32_bf16 v[192:195], a[136:139], a[72:75], v[192:195]
  v_exp_f32_e64 v205, v205
  v_mfma_f32_16x16x32_bf16 v[192:195], a[140:143], a[76:79], v[192:195]
  v_cvt_pk_bf16_f32 v210, v204, v205
  v_cvt_pk_bf16_f32 v211, v206, v207
  v_mfma_f32_16x16x32_bf16 v[196:199], a[144:147], a[76:79], v[228:231]
  v_exp_f32_e64 v203, v203
  v_mfma_f32_16x16x32_bf16 v[196:199], a[148:151], a[72:75], v[196:199]
  v_exp_f32_e64 v202, v202
  v_mfma_f32_16x16x32_bf16 v[196:199], a[152:155], a[68:71], v[196:199]
  v_cvt_pk_bf16_f32 v209, v202, v203
  v_mul_f32_e64 v201, s29, v193
  v_mfma_f32_16x16x32_bf16 v[196:199], a[156:159], a[64:67], v[196:199]
  v_mul_f32 v202, s29, v194
  v_mul_f32 v203, s29, v195
  v_mfma_f32_16x16x32_bf16 a[204:207], a[220:223], v[208:211], a[204:207]
  v_mul_f32 v200, s29, v192
  v_add_u32 v217, s30, v219
  v_mfma_f32_16x16x32_bf16 a[224:227], v[208:211], a[160:163], a[224:227]
  v_exp_f32_e64 v201, v201
  v_mfma_f32_16x16x32_bf16 a[228:231], v[208:211], a[164:167], a[228:231]
  v_mul_f32 v205, s29, v197
  v_mul_f32 v206, s29, v198
  v_mfma_f32_16x16x32_bf16 a[232:235], v[208:211], a[168:171], a[232:235]
  v_exp_f32_e64 v205, v205
  v_mfma_f32_16x16x32_bf16 a[236:239], v[208:211], a[172:175], a[236:239]
  v_mul_f32 v204, s29, v196
  v_mul_f32 v207, s29, v199
  v_mfma_f32_16x16x32_bf16 a[240:243], v[208:211], a[176:179], a[240:243]
  v_exp_f32_e64 v204, v204
  v_mfma_f32_16x16x32_bf16 a[244:247], v[208:211], a[180:183], a[244:247]
  v_exp_f32_e64 v203, v203
  v_mfma_f32_16x16x32_bf16 a[248:251], v[208:211], a[184:187], a[248:251]
  v_exp_f32_e64 v207, v207
  v_mfma_f32_16x16x32_bf16 a[252:255], v[208:211], a[188:191], a[252:255]
  v_exp_f32_e64 v202, v202
  v_mfma_f32_16x16x32_bf16 v[192:195], a[128:131], a[80:83], v[228:231]
  v_cvt_pk_bf16_f32 v209, v202, v203
  v_cvt_pk_bf16_f32 v210, v204, v205
  v_mfma_f32_16x16x32_bf16 v[192:195], a[132:135], a[84:87], v[192:195]
  ds_read_b128 a[128:131], v216 offset:0
  ds_read_b128 a[132:135], v216 offset:64
  v_mfma_f32_16x16x32_bf16 v[192:195], a[136:139], a[88:91], v[192:195]
  v_exp_f32_e64 v200, v200
  v_mfma_f32_16x16x32_bf16 v[192:195], a[140:143], a[92:95], v[192:195]
  ds_read_b128 a[136:139], v216 offset:128
  ds_read_b128 a[140:143], v216 offset:192
  v_mfma_f32_16x16x32_bf16 v[196:199], a[144:147], a[92:95], v[228:231]
  v_exp_f32_e64 v206, v206
  v_mfma_f32_16x16x32_bf16 v[196:199], a[148:151], a[88:91], v[196:199]
  ds_read_b128 a[144:147], v216 offset:704
  ds_read_b128 a[148:151], v216 offset:640
  v_mfma_f32_16x16x32_bf16 v[196:199], a[152:155], a[84:87], v[196:199]
  v_cvt_pk_bf16_f32 v208, v200, v201
  v_cvt_pk_bf16_f32 v211, v206, v207
  v_mfma_f32_16x16x32_bf16 v[196:199], a[156:159], a[80:83], v[196:199]
  ds_read_b128 a[152:155], v216 offset:576
  ds_read_b128 a[156:159], v216 offset:512
  v_mfma_f32_16x16x32_bf16 v[128:131], v[208:211], a[160:163], v[128:131]
  v_mul_f32 v201, s29, v193
  v_mul_f32 v203, s29, v195
  v_mfma_f32_16x16x32_bf16 v[132:135], v[208:211], a[164:167], v[132:135]
  v_mul_f32 v200, s29, v192
  v_mul_f32 v202, s29, v194
  v_mfma_f32_16x16x32_bf16 v[136:139], v[208:211], a[168:171], v[136:139]
  v_exp_f32_e64 v203, v203
  v_mfma_f32_16x16x32_bf16 v[140:143], v[208:211], a[172:175], v[140:143]
  v_exp_f32_e64 v200, v200
  v_mfma_f32_16x16x32_bf16 v[144:147], v[208:211], a[176:179], v[144:147]
  v_exp_f32_e64 v202, v202
  v_mfma_f32_16x16x32_bf16 v[148:151], v[208:211], a[180:183], v[148:151]
  s_sub_u32 s37, s37, 1
  v_mul_f32 v204, s29, v196
  v_mul_f32_e64 v205, s29, v197
  v_mfma_f32_16x16x32_bf16 v[152:155], v[208:211], a[184:187], v[152:155]
  s_waitcnt lgkmcnt(2)
  v_exp_f32 v201, v201
  v_mfma_f32_16x16x32_bf16 v[156:159], v[208:211], a[188:191], v[156:159]
  s_cbranch_scc1 L_exitA
  v_mul_f32 v207, s29, v199
  v_cvt_pk_bf16_f32 v213, v202, v203
  v_mfma_f32_16x16x32_bf16 v[192:195], a[128:131], a[0:3], v[228:231]
  v_mul_f32_e64 v206, s29, v198
  v_cvt_pk_bf16_f32 v212, v200, v201
  v_mfma_f32_16x16x32_bf16 v[192:195], a[132:135], a[4:7], v[192:195]
  v_exp_f32_e64 v206, v206
  v_mfma_f32_16x16x32_bf16 v[192:195], a[136:139], a[8:11], v[192:195]
  v_exp_f32_e64 v205, v205
  v_mfma_f32_16x16x32_bf16 v[192:195], a[140:143], a[12:15], v[192:195]
  v_exp_f32_e64 v207, v207
  v_mfma_f32_16x16x32_bf16 v[196:199], a[144:147], a[12:15], v[228:231]
  v_exp_f32_e64 v204, v204
  v_mfma_f32_16x16x32_bf16 v[196:199], a[148:151], a[8:11], v[196:199]
  s_waitcnt lgkmcnt(0)
  v_cvt_pk_bf16_f32 v214, v204, v205
  v_cvt_pk_bf16_f32 v215, v206, v207
  v_mfma_f32_16x16x32_bf16 v[196:199], a[152:155], a[4:7], v[196:199]
  v_mul_f32 v200, s29, v192
  v_mul_f32_e64 v201, s29, v193
  v_mfma_f32_16x16x32_bf16 v[196:199], a[156:159], a[0:3], v[196:199]
  v_exp_f32_e64 v201, v201
  v_mfma_f32_16x16x32_bf16 v[160:163], v[212:215], a[160:163], v[160:163]
  v_exp_f32_e64 v200, v200
  v_mfma_f32_16x16x32_bf16 v[164:167], v[212:215], a[164:167], v[164:167]
  ds_read_b64_tr_b16 a[160:161], v217 offset:8448
  ds_read_b64_tr_b16 a[166:167], v217 offset:8976
  v_mfma_f32_16x16x32_bf16 v[168:171], v[212:215], a[168:171], v[168:171]
  v_mul_f32 v204, s29, v196
  v_mul_f32 v205, s29, v197
  v_mfma_f32_16x16x32_bf16 v[172:175], v[212:215], a[172:175], v[172:175]
  ds_read_b64_tr_b16 a[170:171], v217 offset:8992
  ds_read_b64_tr_b16 a[174:175], v217 offset:9008
  v_mfma_f32_16x16x32_bf16 v[176:179], v[212:215], a[176:179], v[176:179]
  v_mul_f32 v203, s29, v195
  v_mul_f32 v207, s29, v199
  v_mfma_f32_16x16x32_bf16 v[180:183], v[212:215], a[180:183], v[180:183]
  ds_read_b64_tr_b16 a[162:163], v217 offset:8960
  ds_read_b64_tr_b16 a[172:173], v217 offset:8496
  v_mfma_f32_16x16x32_bf16 v[184:187], v[212:215], a[184:187], v[184:187]
  v_exp_f32_e64 v203, v203
  v_mfma_f32_16x16x32_bf16 v[188:191], v[212:215], a[188:191], v[188:191]
  ds_read_b64_tr_b16 a[164:165], v217 offset:8464
  v_mul_f32_e64 v202, s29, v194
  v_smfmac_f32_16x16x64_bf16 a[200:203], a[220:223], v[208:215], v254
  ds_read_b64_tr_b16 a[168:169], v217 offset:8480
  v_exp_f32 v202, v202
  v_mul_f32 v206, s29, v198
L_pA3:
  v_mfma_f32_16x16x32_bf16 v[192:195], a[128:131], a[16:19], v[228:231]
  v_exp_f32_e64 v207, v207
  v_mfma_f32_16x16x32_bf16 v[192:195], a[132:135], a[20:23], v[192:195]
  ds_read_b64_tr_b16 a[176:177], v217 offset:8512
  ds_read_b64_tr_b16 a[180:181], v217 offset:8528
  v_mfma_f32_16x16x32_bf16 v[192:195], a[136:139], a[24:27], v[192:195]
  v_exp_f32_e64 v206, v206
  v_mfma_f32_16x16x32_bf16 v[192:195], a[140:143], a[28:31], v[192:195]
  ds_read_b64_tr_b16 a[178:179], v217 offset:9024
  ds_read_b64_tr_b16 a[182:183], v217 offset:9040
  v_mfma_f32_16x16x32_bf16 v[196:199], a[144:147], a[28:31], v[228:231]
  v_cvt_pk_bf16_f32 v208, v200, v201
  v_cvt_pk_bf16_f32 v211, v206, v207
  v_mfma_f32_16x16x32_bf16 v[196:199], a[148:151], a[24:27], v[196:199]
  s_waitcnt lgkmcnt(4)
  v_exp_f32 v204, v204
  v_exp_f32_e64 v205, v205
  v_mfma_f32_16x16x32_bf16 v[196:199], a[152:155], a[20:23], v[196:199]
  ds_read_b64_tr_b16 a[184:185], v217 offset:8544
  ds_read_b64_tr_b16 a[186:187], v217 offset:9056
  v_cvt_pk_bf16_f32 v209, v202, v203
  v_cvt_pk_bf16_f32 v210, v204, v205
  v_mfma_f32_16x16x32_bf16 v[196:199], a[156:159], a[16:19], v[196:199]
  ds_read_b64_tr_b16 a[188:189], v217 offset:8560
  ds_read_b64_tr_b16 a[190:191], v217 offset:9072
  v_mfma_f32_16x16x32_bf16 v[0:3], v[208:211], a[160:163], v[0:3]
  v_mul_f32 v200, s29, v192
  v_mul_f32 v202, s29, v194
  v_mfma_f32_16x16x32_bf16 v[4:7], v[208:211], a[164:167], v[4:7]
  v_mul_f32 v201, s29, v193
  v_mul_f32 v203, s29, v195
  v_mfma_f32_16x16x32_bf16 v[8:11], v[208:211], a[168:171], v[8:11]
  v_mul_f32 v205, s29, v197
  v_mul_f32 v207, s29, v199
  v_mfma_f32_16x16x32_bf16 v[12:15], v[208:211], a[172:175], v[12:15]
  s_waitcnt lgkmcnt(4)
  v_mul_f32 v204, s29, v196
  v_mul_f32_e64 v206, s29, v198
  v_mfma_f32_16x16x32_bf16 v[16:19], v[208:211], a[176:179], v[16:19]
  v_exp_f32_e64 v204, v204
  v_mfma_f32_16x16x32_bf16 v[20:23], v[208:211], a[180:183], v[20:23]
  s_waitcnt lgkmcnt(2)
  v_exp_f32 v203, v203
  v_mfma_f32_16x16x32_bf16 v[24:27], v[208:211], a[184:187], v[24:27]
  s_waitcnt lgkmcnt(0)
  v_exp_f32 v207, v207
  v_mfma_f32_16x16x32_bf16 v[28:31], v[208:211], a[188:191], v[28:31]
  v_exp_f32_e64 v202, v202
  v_mfma_f32_16x16x32_bf16 v[192:195], a[128:131], a[32:35], v[228:231]
  v_exp_f32_e64 v201, v201
  v_mfma_f32_16x16x32_bf16 v[192:195], a[132:135], a[36:39], v[192:195]
  ds_read_b64_tr_b16 a[112:113], v220 offset:4096
  v_cvt_pk_bf16_f32 v213, v202, v203
  v_mfma_f32_16x16x32_bf16 v[192:195], a[136:139], a[40:43], v[192:195]
  v_exp_f32_e64 v200, v200
  v_mfma_f32_16x16x32_bf16 v[192:195], a[140:143], a[44:47], v[192:195]
  v_exp_f32_e64 v206, v206
  v_mfma_f32_16x16x32_bf16 v[196:199], a[144:147], a[44:47], v[228:231]
  v_cvt_pk_bf16_f32 v212, v200, v201
  v_cvt_pk_bf16_f32 v215, v206, v207
  v_mfma_f32_16x16x32_bf16 v[196:199], a[148:151], a[40:43], v[196:199]
  v_exp_f32_e64 v205, v205
  v_mfma_f32_16x16x32_bf16 v[196:199], a[152:155], a[36:39], v[196:199]
  v_cvt_pk_bf16_f32 v214, v204, v205
  v_mul_f32_e64 v201, s29, v193
  v_mfma_f32_16x16x32_bf16 v[196:199], a[156:159], a[32:35], v[196:199]
  s_waitcnt vmcnt(12)
  v_mul_f32 v200, s29, v192
  v_mul_f32_e64 v203, s29, v195
  v_smfmac_f32_16x16x64_bf16 a[192:195], a[220:223], v[208:215], v254
  s_barrier
  v_mul_f32 v202, s29, v194
  v_mfma_f32_16x16x32_bf16 v[32:35], v[212:215], a[160:163], v[32:35]
  v_exp_f32_e64 v201, v201
  v_mfma_f32_16x16x32_bf16 v[36:39], v[212:215], a[164:167], v[36:39]
  s_mov_b32 m0, s30
  v_mul_f32 v206, s29, v198
  v_mul_f32_e64 v207, s29, v199
  v_mfma_f32_16x16x32_bf16 v[40:43], v[212:215], a[168:171], v[40:43]
  buffer_load_dwordx4 v221, s[4:7], s33 offen lds
  v_mfma_f32_16x16x32_bf16 v[44:47], v[212:215], a[172:175], v[44:47]
  v_mul_f32 v204, s29, v196
  v_mul_f32 v205, s29, v197
  v_mfma_f32_16x16x32_bf16 v[48:51], v[212:215], a[176:179], v[48:51]
  v_exp_f32_e64 v204, v204
  v_mfma_f32_16x16x32_bf16 v[52:55], v[212:215], a[180:183], v[52:55]
  s_add_u32 m0, s30, 32
  v_exp_f32 v207, v207
  v_mfma_f32_16x16x32_bf16 v[56:59], v[212:215], a[184:187], v[56:59]
  buffer_load_dwordx4 v221, s[4:7], s33 offen offset:1024 lds
  v_mfma_f32_16x16x32_bf16 v[60:63], v[212:215], a[188:191], v[60:63]
  v_exp_f32_e64 v205, v205
  v_mfma_f32_16x16x32_bf16 v[192:195], a[128:131], a[48:51], v[228:231]
  ds_read_b64_tr_b16 a[114:115], v220 offset:4160
  v_cvt_pk_bf16_f32 v210, v204, v205
  v_mfma_f32_16x16x32_bf16 v[192:195], a[132:135], a[52:55], v[192:195]
  s_add_u32 m0, s30, s96
  v_exp_f32 v206, v206
  v_mfma_f32_16x16x32_bf16 v[192:195], a[136:139], a[56:59], v[192:195]
  buffer_load_dwordx4 v221, s[8:11], s33 offen lds
  v_mfma_f32_16x16x32_bf16 v[192:195], a[140:143], a[60:63], v[192:195]
  v_exp_f32_e64 v200, v200
  v_mfma_f32_16x16x32_bf16 v[196:199], a[144:147], a[60:63], v[228:231]
  v_cvt_pk_bf16_f32 v208, v200, v201
  v_cvt_pk_bf16_f32 v211, v206, v207
  v_mfma_f32_16x16x32_bf16 v[196:199], a[148:151], a[56:59], v[196:199]
  v_exp_f32 v202, v202
  v_exp_f32 v203, v203
  v_mfma_f32_16x16x32_bf16 v[196:199], a[152:155], a[52:55], v[196:199]
  v_cvt_pk_bf16_f32 v209, v202, v203
  v_mul_f32_e64 v203, s29, v195
  v_mfma_f32_16x16x32_bf16 v[196:199], a[156:159], a[48:51], v[196:199]
  v_mul_f32 v201, s29, v193
  v_mul_f32 v202, s29, v194
  v_mfma_f32_16x16x32_bf16 v[64:67], v[208:211], a[160:163], v[64:67]
  ds_read_b64_tr_b16 a[116:117], v220 offset:5120
  v_mul_f32_e64 v200, s29, v192
  v_mfma_f32_16x16x32_bf16 v[68:71], v[208:211], a[164:167], v[68:71]
  s_add_u32 m0, s30, s97
  v_exp_f32 v203, v203
  v_mfma_f32_16x16x32_bf16 v[72:75], v[208:211], a[168:171], v[72:75]
  buffer_load_dwordx4 v221, s[8:11], s33 offen offset:1024 lds
  v_mfma_f32_16x16x32_bf16 v[76:79], v[208:211], a[172:175], v[76:79]
  s_sub_u32 s30, s30, 16896
  v_mul_f32 v206, s29, v198
  v_mul_f32 v207, s29, v199
  v_mfma_f32_16x16x32_bf16 v[80:83], v[208:211], a[176:179], v[80:83]
  s_cselect_b32 s30, s31, s30
  v_mul_f32 v204, s29, v196
  v_mul_f32_e64 v205, s29, v197
  v_mfma_f32_16x16x32_bf16 v[84:87], v[208:211], a[180:183], v[84:87]
  s_add_u32 s59, s59, 8192
  v_exp_f32_e64 v205, v205
  v_mfma_f32_16x16x32_bf16 v[88:91], v[208:211], a[184:187], v[88:91]
  s_xor_b32 s33, s59, s3
  v_exp_f32 v204, v204
  v_mfma_f32_16x16x32_bf16 v[92:95], v[208:211], a[188:191], v[92:95]
  v_exp_f32_e64 v206, v206
  v_mfma_f32_16x16x32_bf16 v[192:195], a[128:131], a[96:99], v[228:231]
  v_exp_f32_e64 v201, v201
  v_mfma_f32_16x16x32_bf16 v[192:195], a[132:135], a[100:103], v[192:195]
  v_exp_f32_e64 v200, v200
  v_mfma_f32_16x16x32_bf16 v[192:195], a[136:139], a[104:107], v[192:195]
  v_cvt_pk_bf16_f32 v212, v200, v201
  v_cvt_pk_bf16_f32 v214, v204, v205
  v_mfma_f32_16x16x32_bf16 v[192:195], a[140:143], a[108:111], v[192:195]
  v_exp_f32_e64 v207, v207
  v_mfma_f32_16x16x32_bf16 v[196:199], a[144:147], a[108:111], v[228:231]
  ds_read_b64_tr_b16 a[118:119], v220 offset:5184
  v_cvt_pk_bf16_f32 v215, v206, v207
  v_mfma_f32_16x16x32_bf16 v[196:199], a[148:151], a[104:107], v[196:199]
  v_exp_f32_e64 v202, v202
  v_mfma_f32_16x16x32_bf16 v[196:199], a[152:155], a[100:103], v[196:199]
  v_cvt_pk_bf16_f32 v213, v202, v203
  v_mul_f32_e64 v200, s29, v192
  v_mfma_f32_16x16x32_bf16 v[196:199], a[156:159], a[96:99], v[196:199]
  v_mul_f32 v202, s29, v194
  v_mul_f32 v203, s29, v195
  v_smfmac_f32_16x16x64_bf16 a[196:199], a[220:223], v[208:215], v254
  v_mul_f32_e64 v201, s29, v193
  v_mfma_f32_16x16x32_bf16 v[96:99], v[212:215], a[160:163], v[96:99]
  v_exp_f32_e64 v202, v202
  v_mfma_f32_16x16x32_bf16 v[100:103], v[212:215], a[164:167], v[100:103]
  v_mul_f32 v206, s29, v198
  v_mul_f32 v207, s29, v199
  v_mfma_f32_16x16x32_bf16 v[104:107], v[212:215], a[168:171], v[104:107]
  v_mul_f32 v204, s29, v196
  v_mul_f32 v205, s29, v197
  v_mfma_f32_16x16x32_bf16 v[108:111], v[212:215], a[172:175], v[108:111]
  v_exp_f32_e64 v203, v203
  v_mfma_f32_16x16x32_bf16 v[112:115], v[212:215], a[176:179], v[112:115]
  s_waitcnt lgkmcnt(0)
  v_exp_f32 v204, v204
  v_mfma_f32_16x16x32_bf16 v[116:119], v[212:215], a[180:183], v[116:119]
  buffer_store_dwordx4 a[116:119], v233, s[16:19], s35 offen offset:1024
  v_exp_f32_e64 v207, v207
  v_mfma_f32_16x16x32_bf16 v[120:123], v[212:215], a[184:187], v[120:123]
  v_exp_f32_e64 v205, v205
  v_mfma_f32_16x16x32_bf16 v[124:127], v[212:215], a[188:191], v[124:127]
  v_cvt_pk_bf16_f32 v209, v202, v203
  v_cvt_pk_bf16_f32 v210, v204, v205
  v_mfma_f32_16x16x32_bf16 v[192:195], a[128:131], a[64:67], v[228:231]
  v_exp_f32_e64 v206, v206
  v_mfma_f32_16x16x32_bf16 v[192:195], a[132:135], a[68:71], v[192:195]
  v_exp_f32_e64 v200, v200
  v_mfma_f32_16x16x32_bf16 v[192:195], a[136:139], a[72:75], v[192:195]
  v_exp_f32_e64 v201, v201
  v_mfma_f32_16x16x32_bf16 v[192:195], a[140:143], a[76:79], v[192:195]
  v_cvt_pk_bf16_f32 v208, v200, v201
  v_cvt_pk_bf16_f32 v211, v206, v207
  v_mfma_f32_16x16x32_bf16 v[196:199], a[144:147], a[76:79], v[228:231]
  s_mov_b32 m0, s36
  v_add_u32 v216, s30, v218
  v_add_u32_e64 v217, s30, v219
  v_mfma_f32_16x16x32_bf16 v[196:199], a[148:151], a[72:75], v[196:199]
  buffer_load_dwordx4 v222, s[12:15], s34 offen nt lds
  v_mfma_f32_16x16x32_bf16 v[196:199], a[152:155], a[68:71], v[196:199]
  s_add_u32 s36, s36, 2048
  v_mul_f32 v201, s29, v193
  v_mul_f32 v202, s29, v194
  v_mfma_f32_16x16x32_bf16 v[196:199], a[156:159], a[64:67], v[196:199]
  v_mul_f32 v200, s29, v192
  v_mul_f32 v203, s29, v195
  v_mfma_f32_16x16x32_bf16 a[204:207], a[220:223], v[208:211], a[204:207]
  v_exp_f32_e64 v202, v202
  v_mfma_f32_16x16x32_bf16 a[224:227], v[208:211], a[160:163], a[224:227]
  buffer_store_dwordx4 a[112:115], v233, s[16:19], s35 offen
  buffer_load_dwordx4 v223, s[12:15], s34 offen offset:1024 nt lds
  v_mfma_f32_16x16x32_bf16 a[228:231], v[208:211], a[164:167], a[228:231]
  s_add_u32 s35, s35, 2048
  v_mul_f32 v205, s29, v197
  v_mul_f32 v207, s29, v199
  v_mfma_f32_16x16x32_bf16 a[232:235], v[208:211], a[168:171], a[232:235]
  s_add_u32 s34, s34, 2048
  v_mul_f32 v204, s29, v196
  v_mul_f32 v206, s29, v198
  v_mfma_f32_16x16x32_bf16 a[236:239], v[208:211], a[172:175], a[236:239]
  v_exp_f32_e64 v204, v204
  v_mfma_f32_16x16x32_bf16 a[240:243], v[208:211], a[176:179], a[240:243]
  v_exp_f32_e64 v207, v207
  v_mfma_f32_16x16x32_bf16 a[244:247], v[208:211], a[180:183], a[244:247]
  v_exp_f32_e64 v203, v203
  v_mfma_f32_16x16x32_bf16 a[248:251], v[208:211], a[184:187], a[248:251]
  v_exp_f32_e64 v201, v201
  v_mfma_f32_16x16x32_bf16 a[252:255], v[208:211], a[188:191], a[252:255]
  v_exp_f32_e64 v200, v200
  v_mfma_f32_16x16x32_bf16 v[192:195], a[128:131], a[80:83], v[228:231]
  ds_read_b128 a[128:131], v216 offset:0
  v_cvt_pk_bf16_f32 v208, v200, v201
  v_mfma_f32_16x16x32_bf16 v[192:195], a[132:135], a[84:87], v[192:195]
  v_exp_f32_e64 v205, v205
  v_mfma_f32_16x16x32_bf16 v[192:195], a[136:139], a[88:91], v[192:195]
  ds_read_b128 a[132:135], v216 offset:64
  ds_read_b128 a[136:139], v216 offset:128
  v_mfma_f32_16x16x32_bf16 v[192:195], a[140:143], a[92:95], v[192:195]
  v_cvt_pk_bf16_f32 v209, v202, v203
  v_cvt_pk_bf16_f32 v210, v204, v205
  v_mfma_f32_16x16x32_bf16 v[196:199], a[144:147], a[92:95], v[228:231]
  ds_read_b128 a[140:143], v216 offset:192
  ds_read_b128 a[144:147], v216 offset:704
  v_mfma_f32_16x16x32_bf16 v[196:199], a[148:151], a[88:91], v[196:199]
  v_exp_f32_e64 v206, v206
  v_mfma_f32_16x16x32_bf16 v[196:199], a[152:155], a[84:87], v[196:199]
  ds_read_b128 a[148:151], v216 offset:640
  v_cvt_pk_bf16_f32 v211, v206, v207
  v_mfma_f32_16x16x32_bf16 v[196:199], a[156:159], a[80:83], v[196:199]
  v_mul_f32 v200, s29, v192
  v_mul_f32 v201, s29, v193
  v_mfma_f32_16x16x32_bf16 v[128:131], v[208:211], a[160:163], v[128:131]
  ds_read_b128 a[152:155], v216 offset:576
  ds_read_b128 a[156:159], v216 offset:512
  v_mfma_f32_16x16x32_bf16 v[132:135], v[208:211], a[164:167], v[132:135]
  v_exp_f32_e64 v201, v201
  v_mfma_f32_16x16x32_bf16 v[136:139], v[208:211], a[168:171], v[136:139]
  v_mul_f32 v202, s29, v194
  v_mul_f32 v204, s29, v196
  v_mfma_f32_16x16x32_bf16 v[140:143], v[208:211], a[172:175], v[140:143]
  v_mul_f32 v203, s29, v195
  v_mul_f32 v205, s29, v197
  v_mfma_f32_16x16x32_bf16 v[144:147], v[208:211], a[176:179], v[144:147]
  v_exp_f32_e64 v200, v200
  v_mfma_f32_16x16x32_bf16 v[148:151], v[208:211], a[180:183], v[148:151]
  s_sub_u32 s37, s37, 1
  v_exp_f32 v202, v202
  v_mfma_f32_16x16x32_bf16 v[152:155], v[208:211], a[184:187], v[152:155]
  s_waitcnt lgkmcnt(2)
  v_exp_f32 v203, v203
  v_mfma_f32_16x16x32_bf16 v[156:159], v[208:211], a[188:191], v[156:159]
  s_cbranch_scc1 L_exitA
  v_mul_f32 v206, s29, v198
  v_mul_f32_e64 v207, s29, v199
  v_mfma_f32_16x16x32_bf16 v[192:195], a[128:131], a[0:3], v[228:231]
  v_exp_f32_e64 v206, v206
  v_mfma_f32_16x16x32_bf16 v[192:195], a[132:135], a[4:7], v[192:195]
  v_exp_f32_e64 v205, v205
  v_mfma_f32_16x16x32_bf16 v[192:195], a[136:139], a[8:11], v[192:195]
  v_exp_f32_e64 v204, v204
  v_mfma_f32_16x16x32_bf16 v[192:195], a[140:143], a[12:15], v[192:195]
  v_cvt_pk_bf16_f32 v212, v200, v201
  v_cvt_pk_bf16_f32 v213, v202, v203
  v_mfma_f32_16x16x32_bf16 v[196:199], a[144:147], a[12:15], v[228:231]
  v_exp_f32_e64 v207, v207
  v_mfma_f32_16x16x32_bf16 v[196:199], a[148:151], a[8:11], v[196:199]
  s_waitcnt lgkmcnt(0)
  v_cvt_pk_bf16_f32 v214, v204, v205
  v_cvt_pk_bf16_f32 v215, v206, v207
  v_mfma_f32_16x16x32_bf16 v[196:199], a[152:155], a[4:7], v[196:199]
  v_mul_f32 v200, s29, v192
  v_mul_f32_e64 v201, s29, v193
  v_mfma_f32_16x16x32_bf16 v[196:199], a[156:159], a[0:3], v[196:199]
  v_mul_f32 v202, s29, v194
  v_mul_f32 v203, s29, v195
  v_mfma_f32_16x16x32_bf16 v[160:163], v[212:215], a[160:163], v[160:163]
  ds_read_b64_tr_b16 a[160:161], v217 offset:8448
  ds_read_b64_tr_b16 a[162:163], v217 offset:8960
  v_mfma_f32_16x16x32_bf16 v[164:167], v[212:215], a[164:167], v[164:167]
  v_exp_f32_e64 v202, v202
  v_mfma_f32_16x16x32_bf16 v[168:171], v[212:215], a[168:171], v[168:171]
  ds_read_b64_tr_b16 a[164:165], v217 offset:8464
  ds_read_b64_tr_b16 a[166:167], v217 offset:8976
  v_mfma_f32_16x16x32_bf16 v[172:175], v[212:215], a[172:175], v[172:175]
  v_mul_f32 v204, s29, v196
  v_mul_f32 v207, s29, v199
  v_mfma_f32_16x16x32_bf16 v[176:179], v[212:215], a[176:179], v[176:179]
  ds_read_b64_tr_b16 a[168:169], v217 offset:8480
  ds_read_b64_tr_b16 a[174:175], v217 offset:9008
  v_mfma_f32_16x16x32_bf16 v[180:183], v[212:215], a[180:183], v[180:183]
  v_exp_f32_e64 v203, v203
  v_mfma_f32_16x16x32_bf16 v[184:187], v[212:215], a[184:187], v[184:187]
  ds_read_b64_tr_b16 a[170:171], v217 offset:8992
  ds_read_b64_tr_b16 a[172:173], v217 offset:8496
  v_mfma_f32_16x16x32_bf16 v[188:191], v[212:215], a[188:191], v[188:191]
  v_mul_f32 v205, s29, v197
  v_mul_f32 v206, s29, v198
  v_smfmac_f32_16x16x64_bf16 a[200:203], a[220:223], v[208:215], v254
  v_exp_f32 v200, v200
  v_exp_f32 v201, v201
L_pA0:
  v_mfma_f32_16x16x32_bf16 v[192:195], a[128:131], a[16:19], v[228:231]
  ds_read_b64_tr_b16 a[176:177], v217 offset:8512
  ds_read_b64_tr_b16 a[178:179], v217 offset:9024
  v_mfma_f32_16x16x32_bf16 v[192:195], a[132:135], a[20:23], v[192:195]
  v_exp_f32_e64 v205, v205
  v_mfma_f32_16x16x32_bf16 v[192:195], a[136:139], a[24:27], v[192:195]
  ds_read_b64_tr_b16 a[180:181], v217 offset:8528
  ds_read_b64_tr_b16 a[182:183], v217 offset:9040
  v_mfma_f32_16x16x32_bf16 v[192:195], a[140:143], a[28:31], v[192:195]
  v_exp_f32_e64 v204, v204
  v_mfma_f32_16x16x32_bf16 v[196:199], a[144:147], a[28:31], v[228:231]
  ds_read_b64_tr_b16 a[184:185], v217 offset:8544
  ds_read_b64_tr_b16 a[186:187], v217 offset:9056
  v_mfma_f32_16x16x32_bf16 v[196:199], a[148:151], a[24:27], v[196:199]
  v_exp_f32 v206, v206
  v_exp_f32 v207, v207
  v_mfma_f32_16x16x32_bf16 v[196:199], a[152:155], a[20:23], v[196:199]
  s_waitcnt lgkmcnt(6)
  v_cvt_pk_bf16_f32 v208, v200, v201
  v_cvt_pk_bf16_f32 v209, v202, v203
  v_cvt_pk_bf16_f32 v210, v204, v205
  v_cvt_pk_bf16_f32 v211, v206, v207
  v_mfma_f32_16x16x32_bf16 v[196:199], a[156:159], a[16:19], v[196:199]
  ds_read_b64_tr_b16 a[188:189], v217 offset:8560
  ds_read_b64_tr_b16 a[190:191], v217 offset:9072
  v_mfma_f32_16x16x32_bf16 v[0:3], v[208:211], a[160:163], v[0:3]
  v_mul_f32 v201, s29, v193
  v_mul_f32_e64 v203, s29, v195
  v_mfma_f32_16x16x32_bf16 v[4:7], v[208:211], a[164:167], v[4:7]
  v_mul_f32 v200, s29, v192
  v_mul_f32 v202, s29, v194
  v_mfma_f32_16x16x32_bf16 v[8:11], v[208:211], a[168:171], v[8:11]
  v_mul_f32 v205, s29, v197
  v_mul_f32 v207, s29, v199
  v_mfma_f32_16x16x32_bf16 v[12:15], v[208:211], a[172:175], v[12:15]
  s_waitcnt lgkmcnt(4)
  v_mul_f32 v204, s29, v196
  v_mul_f32_e64 v206, s29, v198
  v_mfma_f32_16x16x32_bf16 v[16:19], v[208:211], a[176:179], v[16:19]
  v_exp_f32_e64 v201, v201
  v_mfma_f32_16x16x32_bf16 v[20:23], v[208:211], a[180:183], v[20:23]
  s_waitcnt lgkmcnt(2)
  v_exp_f32 v202, v202
  v_mfma_f32_16x16x32_bf16 v[24:27], v[208:211], a[184:187], v[24:27]
  s_waitcnt lgkmcnt(0)
  v_exp_f32 v203, v203
  v_mfma_f32_16x16x32_bf16 v[28:31], v[208:211], a[188:191], v[28:31]
  v_exp_f32_e64 v205, v205
  v_mfma_f32_16x16x32_bf16 v[192:195], a[128:131], a[32:35], v[228:231]
  v_exp_f32_e64 v207, v207
  v_mfma_f32_16x16x32_bf16 v[192:195], a[132:135], a[36:39], v[192:195]
  v_exp_f32_e64 v206, v206
  v_mfma_f32_16x16x32_bf16 v[192:195], a[136:139], a[40:43], v[192:195]
  v_exp_f32_e64 v204, v204
  v_mfma_f32_16x16x32_bf16 v[192:195], a[140:143], a[44:47], v[192:195]
  v_exp_f32_e64 v200, v200
  v_mfma_f32_16x16x32_bf16 v[196:199], a[144:147], a[44:47], v[228:231]
  v_cvt_pk_bf16_f32 v212, v200, v201
  v_cvt_pk_bf16_f32 v213, v202, v203
  v_mfma_f32_16x16x32_bf16 v[196:199], a[148:151], a[40:43], v[196:199]
  v_cvt_pk_bf16_f32 v214, v204, v205
  v_cvt_pk_bf16_f32 v215, v206, v207
  v_mfma_f32_16x16x32_bf16 v[196:199], a[152:155], a[36:39], v[196:199]
  v_mul_f32 v201, s29, v193
  v_mul_f32 v202, s29, v194
  v_mfma_f32_16x16x32_bf16 v[196:199], a[156:159], a[32:35], v[196:199]
  s_waitcnt vmcnt(12)
  v_mul_f32 v200, s29, v192
  v_mul_f32_e64 v203, s29, v195
  v_smfmac_f32_16x16x64_bf16 a[192:195], a[220:223], v[208:215], v254
  s_barrier
  v_add_u32 v220, 6144, v220
  v_mfma_f32_16x16x32_bf16 v[32:35], v[212:215], a[160:163], v[32:35]
  v_exp_f32 v202, v202
  v_mfma_f32_16x16x32_bf16 v[36:39], v[212:215], a[164:167], v[36:39]
  v_mul_f32 v205, s29, v197
  v_mul_f32 v207, s29, v199
  v_mfma_f32_16x16x32_bf16 v[40:43], v[212:215], a[168:171], v[40:43]
  s_mov_b32 m0, s30
  v_mul_f32 v204, s29, v196
  v_mul_f32_e64 v206, s29, v198
  v_mfma_f32_16x16x32_bf16 v[44:47], v[212:215], a[172:175], v[44:47]
  buffer_load_dwordx4 v221, s[4:7], s33 offen lds
  v_mfma_f32_16x16x32_bf16 v[48:51], v[212:215], a[176:179], v[48:51]
  v_exp_f32_e64 v204, v204
  v_mfma_f32_16x16x32_bf16 v[52:55], v[212:215], a[180:183], v[52:55]
  v_exp_f32_e64 v206, v206
  v_mfma_f32_16x16x32_bf16 v[56:59], v[212:215], a[184:187], v[56:59]
  s_add_u32 m0, s30, 32
  v_exp_f32 v203, v203
  v_mfma_f32_16x16x32_bf16 v[60:63], v[212:215], a[188:191], v[60:63]
  buffer_load_dwordx4 v221, s[4:7], s33 offen offset:1024 lds
  v_mfma_f32_16x16x32_bf16 v[192:195], a[128:131], a[48:51], v[228:231]
  v_exp_f32_e64 v205, v205
  v_mfma_f32_16x16x32_bf16 v[192:195], a[132:135], a[52:55], v[192:195]
  v_exp_f32_e64 v201, v201
  v_mfma_f32_16x16x32_bf16 v[192:195], a[136:139], a[56:59], v[192:195]
  s_add_u32 m0, s30, s96
  v_exp_f32 v200, v200
  v_mfma_f32_16x16x32_bf16 v[192:195], a[140:143], a[60:63], v[192:195]
  buffer_load_dwordx4 v221, s[8:11], s33 offen lds
  v_mfma_f32_16x16x32_bf16 v[196:199], a[144:147], a[60:63], v[228:231]
  v_exp_f32_e64 v207, v207
  v_mfma_f32_16x16x32_bf16 v[196:199], a[148:151], a[56:59], v[196:199]
  v_cvt_pk_bf16_f32 v208, v200, v201
  v_cvt_pk_bf16_f32 v211, v206, v207
  v_mfma_f32_16x16x32_bf16 v[196:199], a[152:155], a[52:55], v[196:199]
  s_add_u32 m0, s30, s97
  v_cvt_pk_bf16_f32 v209, v202, v203
  v_cvt_pk_bf16_f32 v210, v204, v205
  v_mfma_f32_16x16x32_bf16 v[196:199], a[156:159], a[48:51], v[196:199]
  buffer_load_dwordx4 v221, s[8:11], s33 offen offset:1024 lds
  v_mfma_f32_16x16x32_bf16 v[64:67], v[208:211], a[160:163], v[64:67]
  s_sub_u32 s30, s30, 16896
  v_mul_f32 v200, s29, v192
  v_mul_f32_e64 v201, s29, v193
  v_mfma_f32_16x16x32_bf16 v[68:71], v[208:211], a[164:167], v[68:71]
  s_cselect_b32 s30, s31, s30
  v_mul_f32 v202, s29, v194
  v_mul_f32_e64 v203, s29, v195
  v_mfma_f32_16x16x32_bf16 v[72:75], v[208:211], a[168:171], v[72:75]
  s_add_u32 s59, s59, 8192
  v_mul_f32 v204, s29, v196
  v_mul_f32 v206, s29, v198
  v_mfma_f32_16x16x32_bf16 v[76:79], v[208:211], a[172:175], v[76:79]
  s_xor_b32 s33, s59, s3
  v_mul_f32 v205, s29, v197
  v_mul_f32_e64 v207, s29, v199
  v_mfma_f32_16x16x32_bf16 v[80:83], v[208:211], a[176:179], v[80:83]
  v_exp_f32_e64 v207, v207
  v_mfma_f32_16x16x32_bf16 v[84:87], v[208:211], a[180:183], v[84:87]
  v_exp_f32_e64 v201, v201
  v_mfma_f32_16x16x32_bf16 v[88:91], v[208:211], a[184:187], v[88:91]
  v_exp_f32_e64 v204, v204
  v_mfma_f32_16x16x32_bf16 v[92:95], v[208:211], a[188:191], v[92:95]
  v_exp_f32_e64 v206, v206
  v_mfma_f32_16x16x32_bf16 v[192:195], a[128:131], a[96:99], v[228:231]
  v_exp_f32_e64 v202, v202
  v_mfma_f32_16x16x32_bf16 v[192:195], a[132:135], a[100:103], v[192:195]
  v_exp_f32_e64 v200, v200
  v_mfma_f32_16x16x32_bf16 v[192:195], a[136:139], a[104:107], v[192:195]
  v_exp_f32_e64 v203, v203
  v_mfma_f32_16x16x32_bf16 v[192:195], a[140:143], a[108:111], v[192:195]
  v_exp_f32_e64 v205, v205
  v_mfma_f32_16x16x32_bf16 v[196:199], a[144:147], a[108:111], v[228:231]
  v_cvt_pk_bf16_f32 v212, v200, v201
  v_cvt_pk_bf16_f32 v213, v202, v203
  v_mfma_f32_16x16x32_bf16 v[196:199], a[148:151], a[104:107], v[196:199]
  v_cvt_pk_bf16_f32 v214, v204, v205
  v_cvt_pk_bf16_f32 v215, v206, v207
  v_mfma_f32_16x16x32_bf16 v[196:199], a[152:155], a[100:103], v[196:199]
  v_mul_f32 v202, s29, v194
  v_mul_f32 v203, s29, v195
  v_mfma_f32_16x16x32_bf16 v[196:199], a[156:159], a[96:99], v[196:199]
  global_load_dword a120, v[252:253], off
  v_smfmac_f32_16x16x64_bf16 a[196:199], a[220:223], v[208:215], v254
  v_mul_f32_e64 v201, s29, v193
  v_mfma_f32_16x16x32_bf16 v[96:99], v[212:215], a[160:163], v[96:99]
  v_mul_f32 v200, s29, v192
  v_add_u32 v216, s30, v218
  v_mfma_f32_16x16x32_bf16 v[100:103], v[212:215], a[164:167], v[100:103]
  v_mul_f32 v205, s29, v197
  v_mul_f32 v206, s29, v198
  v_mfma_f32_16x16x32_bf16 v[104:107], v[212:215], a[168:171], v[104:107]
  v_mul_f32 v204, s29, v196
  v_mul_f32 v207, s29, v199
  v_mfma_f32_16x16x32_bf16 v[108:111], v[212:215], a[172:175], v[108:111]
  v_exp_f32_e64 v204, v204
  v_mfma_f32_16x16x32_bf16 v[112:115], v[212:215], a[176:179], v[112:115]
  v_exp_f32_e64 v203, v203
  v_mfma_f32_16x16x32_bf16 v[116:119], v[212:215], a[180:183], v[116:119]
  v_exp_f32_e64 v201, v201
  v_mfma_f32_16x16x32_bf16 v[120:123], v[212:215], a[184:187], v[120:123]
  v_exp_f32_e64 v200, v200
  v_mfma_f32_16x16x32_bf16 v[124:127], v[212:215], a[188:191], v[124:127]
  v_exp_f32_e64 v205, v205
  v_mfma_f32_16x16x32_bf16 v[192:195], a[128:131], a[64:67], v[228:231]
  v_exp_f32_e64 v206, v206
  v_mfma_f32_16x16x32_bf16 v[192:195], a[132:135], a[68:71], v[192:195]
  v_exp_f32_e64 v202, v202
  v_mfma_f32_16x16x32_bf16 v[192:195], a[136:139], a[72:75], v[192:195]
  v_exp_f32_e64 v207, v207
  v_mfma_f32_16x16x32_bf16 v[192:195], a[140:143], a[76:79], v[192:195]
  v_cvt_pk_bf16_f32 v210, v204, v205
  v_cvt_pk_bf16_f32 v211, v206, v207
  v_mfma_f32_16x16x32_bf16 v[196:199], a[144:147], a[76:79], v[228:231]
  v_cvt_pk_bf16_f32 v208, v200, v201
  v_cvt_pk_bf16_f32 v209, v202, v203
  v_mfma_f32_16x16x32_bf16 v[196:199], a[148:151], a[72:75], v[196:199]
  v_add_u32_e64 v217, s30, v219
  v_mfma_f32_16x16x32_bf16 v[196:199], a[152:155], a[68:71], v[196:199]
  v_mul_f32 v201, s29, v193
  v_mul_f32 v203, s29, v195
  v_mfma_f32_16x16x32_bf16 v[196:199], a[156:159], a[64:67], v[196:199]
  v_mul_f32 v200, s29, v192
  v_mul_f32 v202, s29, v194
  v_mfma_f32_16x16x32_bf16 a[204:207], a[220:223], v[208:211], a[204:207]
  v_exp_f32_e64 v200, v200
  v_mfma_f32_16x16x32_bf16 a[224:227], v[208:211], a[160:163], a[224:227]
  v_exp_f32_e64 v203, v203
  v_mfma_f32_16x16x32_bf16 a[228:231], v[208:211], a[164:167], a[228:231]
  v_mul_f32 v204, s29, v196
  v_mul_f32 v206, s29, v198
  v_mfma_f32_16x16x32_bf16 a[232:235], v[208:211], a[168:171], a[232:235]
  v_mul_f32 v205, s29, v197
  v_mul_f32 v207, s29, v199
  v_mfma_f32_16x16x32_bf16 a[236:239], v[208:211], a[172:175], a[236:239]
  v_exp_f32_e64 v205, v205
  v_mfma_f32_16x16x32_bf16 a[240:243], v[208:211], a[176:179], a[240:243]
  v_exp_f32_e64 v206, v206
  v_mfma_f32_16x16x32_bf16 a[244:247], v[208:211], a[180:183], a[244:247]
  v_exp_f32_e64 v207, v207
  v_mfma_f32_16x16x32_bf16 a[248:251], v[208:211], a[184:187], a[248:251]
  v_exp_f32_e64 v202, v202
  v_mfma_f32_16x16x32_bf16 a[252:255], v[208:211], a[188:191], a[252:255]
  v_exp_f32_e64 v201, v201
  v_mfma_f32_16x16x32_bf16 v[192:195], a[128:131], a[80:83], v[228:231]
  v_exp_f32_e64 v204, v204
  v_mfma_f32_16x16x32_bf16 v[192:195], a[132:135], a[84:87], v[192:195]
  ds_read_b128 a[128:131], v216 offset:0
  ds_read_b128 a[132:135], v216 offset:64
  v_mfma_f32_16x16x32_bf16 v[192:195], a[136:139], a[88:91], v[192:195]
  v_cvt_pk_bf16_f32 v208, v200, v201
  v_cvt_pk_bf16_f32 v209, v202, v203
  v_mfma_f32_16x16x32_bf16 v[192:195], a[140:143], a[92:95], v[192:195]
  ds_read_b128 a[136:139], v216 offset:128
  ds_read_b128 a[140:143], v216 offset:192
  v_mfma_f32_16x16x32_bf16 v[196:199], a[144:147], a[92:95], v[228:231]
  v_cvt_pk_bf16_f32 v210, v204, v205
  v_cvt_pk_bf16_f32 v211, v206, v207
  v_mfma_f32_16x16x32_bf16 v[196:199], a[148:151], a[88:91], v[196:199]
  ds_read_b128 a[144:147], v216 offset:704
  ds_read_b128 a[148:151], v216 offset:640
  v_mfma_f32_16x16x32_bf16 v[196:199], a[152:155], a[84:87], v[196:199]
  v_mul_f32 v200, s29, v192
  v_mul_f32 v202, s29, v194
  v_mfma_f32_16x16x32_bf16 v[196:199], a[156:159], a[80:83], v[196:199]
  ds_read_b128 a[152:155], v216 offset:576
  ds_read_b128 a[156:159], v216 offset:512
  v_mfma_f32_16x16x32_bf16 v[128:131], v[208:211], a[160:163], v[128:131]
  v_mul_f32 v201, s29, v193
  v_mul_f32 v203, s29, v195
  v_mfma_f32_16x16x32_bf16 v[132:135], v[208:211], a[164:167], v[132:135]
  v_exp_f32_e64 v200, v200
  v_mfma_f32_16x16x32_bf16 v[136:139], v[208:211], a[168:171], v[136:139]
  v_mul_f32 v204, s29, v196
  v_mul_f32 v205, s29, v197
  v_mfma_f32_16x16x32_bf16 v[140:143], v[208:211], a[172:175], v[140:143]
  v_exp_f32_e64 v202, v202
  v_mfma_f32_16x16x32_bf16 v[144:147], v[208:211], a[176:179], v[144:147]
  v_exp_f32_e64 v201, v201
  v_mfma_f32_16x16x32_bf16 v[148:151], v[208:211], a[180:183], v[148:151]
  s_sub_u32 s37, s37, 1
  v_exp_f32 v203, v203
  v_mfma_f32_16x16x32_bf16 v[152:155], v[208:211], a[184:187], v[152:155]
  s_waitcnt lgkmcnt(2)
  v_mfma_f32_16x16x32_bf16 v[156:159], v[208:211], a[188:191], v[156:159]
  s_cbranch_scc1 L_exitA
  v_mul_f32 v206, s29, v198
  v_mul_f32 v207, s29, v199
  v_mfma_f32_16x16x32_bf16 v[192:195], a[128:131], a[0:3], v[228:231]
  v_exp_f32_e64 v204, v204
  v_mfma_f32_16x16x32_bf16 v[192:195], a[132:135], a[4:7], v[192:195]
  v_exp_f32_e64 v207, v207
  v_mfma_f32_16x16x32_bf16 v[192:195], a[136:139], a[8:11], v[192:195]
  v_exp_f32_e64 v206, v206
  v_mfma_f32_16x16x32_bf16 v[192:195], a[140:143], a[12:15], v[192:195]
  v_exp_f32_e64 v205, v205
  v_mfma_f32_16x16x32_bf16 v[196:199], a[144:147], a[12:15], v[228:231]
  v_cvt_pk_bf16_f32 v214, v204, v205
  v_cvt_pk_bf16_f32 v215, v206, v207
  v_mfma_f32_16x16x32_bf16 v[196:199], a[148:151], a[8:11], v[196:199]
  s_waitcnt lgkmcnt(0)
  v_cvt_pk_bf16_f32 v212, v200, v201
  v_cvt_pk_bf16_f32 v213, v202, v203
  v_mfma_f32_16x16x32_bf16 v[196:199], a[152:155], a[4:7], v[196:199]
  v_mul_f32 v201, s29, v193
  v_mul_f32_e64 v202, s29, v194
  v_mfma_f32_16x16x32_bf16 v[196:199], a[156:159], a[0:3], v[196:199]
  v_mul_f32 v200, s29, v192
  v_mul_f32 v203, s29, v195
  v_mfma_f32_16x16x32_bf16 v[160:163], v[212:215], a[160:163], v[160:163]
  v_exp_f32_e64 v203, v203
  v_mfma_f32_16x16x32_bf16 v[164:167], v[212:215], a[164:167], v[164:167]
  ds_read_b64_tr_b16 a[162:163], v217 offset:8960
  ds_read_b64_tr_b16 a[164:165], v217 offset:8464
  v_mfma_f32_16x16x32_bf16 v[168:171], v[212:215], a[168:171], v[168:171]
  v_mul_f32 v205, s29, v197
  v_mul_f32 v207, s29, v199
  v_mfma_f32_16x16x32_bf16 v[172:175], v[212:215], a[172:175], v[172:175]
  ds_read_b64_tr_b16 a[166:167], v217 offset:8976
  ds_read_b64_tr_b16 a[172:173], v217 offset:8496
  v_mfma_f32_16x16x32_bf16 v[176:179], v[212:215], a[176:179], v[176:179]
  v_exp_f32_e64 v201, v201
  v_mfma_f32_16x16x32_bf16 v[180:183], v[212:215], a[180:183], v[180:183]
  ds_read_b64_tr_b16 a[160:161], v217 offset:8448
  ds_read_b64_tr_b16 a[174:175], v217 offset:9008
  v_mfma_f32_16x16x32_bf16 v[184:187], v[212:215], a[184:187], v[184:187]
  v_exp_f32_e64 v200, v200
  v_mfma_f32_16x16x32_bf16 v[188:191], v[212:215], a[188:191], v[188:191]
  ds_read_b64_tr_b16 a[168:169], v217 offset:8480
  ds_read_b64_tr_b16 a[170:171], v217 offset:8992
  v_smfmac_f32_16x16x64_bf16 a[200:203], a[220:223], v[208:215], v254
  v_exp_f32 v202, v202
  v_mul_f32 v204, s29, v196
  v_mul_f32 v206, s29, v198
  s_branch L_pA1
L_selA:
  s_cmp_eq_u32 s28, 3
  s_cbranch_scc1 L_fA3
  s_cmp_eq_u32 s28, 2
  s_cbranch_scc1 L_fA2
L_fA1:
  v_mfma_f32_16x16x32_bf16 v[192:195], a[128:131], a[16:19], v[228:231]
  v_exp_f32_e64 v205, v205
  v_mfma_f32_16x16x32_bf16 v[192:195], a[132:135], a[20:23], v[192:195]
  ds_read_b64_tr_b16 a[178:179], v217 offset:9024
  ds_read_b64_tr_b16 a[180:181], v217 offset:8528
  v_mfma_f32_16x16x32_bf16 v[192:195], a[136:139], a[24:27], v[192:195]
  v_cvt_pk_bf16_f32 v208, v200, v201
  v_cvt_pk_bf16_f32 v209, v202, v203
  v_mfma_f32_16x16x32_bf16 v[192:195], a[140:143], a[28:31], v[192:195]
  ds_read_b64_tr_b16 a[176:177], v217 offset:8512
  ds_read_b64_tr_b16 a[186:187], v217 offset:9056
  v_mfma_f32_16x16x32_bf16 v[196:199], a[144:147], a[28:31], v[228:231]
  s_waitcnt lgkmcnt(4)
  v_exp_f32 v207, v207
  v_mfma_f32_16x16x32_bf16 v[196:199], a[148:151], a[24:27], v[196:199]
  ds_read_b64_tr_b16 a[182:183], v217 offset:9040
  v_exp_f32 v204, v204
  v_exp_f32 v206, v206
  v_mfma_f32_16x16x32_bf16 v[196:199], a[152:155], a[20:23], v[196:199]
  ds_read_b64_tr_b16 a[184:185], v217 offset:8544
  v_cvt_pk_bf16_f32 v210, v204, v205
  v_cvt_pk_bf16_f32 v211, v206, v207
  v_mfma_f32_16x16x32_bf16 v[196:199], a[156:159], a[16:19], v[196:199]
  ds_read_b64_tr_b16 a[188:189], v217 offset:8560
  ds_read_b64_tr_b16 a[190:191], v217 offset:9072
  v_mfma_f32_16x16x32_bf16 v[0:3], v[208:211], a[160:163], 0
  v_mul_f32 v201, s29, v193
  v_mul_f32 v203, s29, v195
  v_mfma_f32_16x16x32_bf16 v[4:7], v[208:211], a[164:167], 0
  v_mul_f32 v200, s29, v192
  v_mul_f32 v202, s29, v194
  v_mfma_f32_16x16x32_bf16 v[8:11], v[208:211], a[168:171], 0
  v_mul_f32 v204, s29, v196
  v_mul_f32 v206, s29, v198
  v_mfma_f32_16x16x32_bf16 v[12:15], v[208:211], a[172:175], 0
  s_waitcnt lgkmcnt(4)
  v_mul_f32 v205, s29, v197
  v_mul_f32_e64 v207, s29, v199
  v_mfma_f32_16x16x32_bf16 v[16:19], v[208:211], a[176:179], 0
  s_waitcnt lgkmcnt(3)
  v_exp_f32 v201, v201
  v_mfma_f32_16x16x32_bf16 v[20:23], v[208:211], a[180:183], 0
  s_waitcnt lgkmcnt(2)
  v_exp_f32 v200, v200
  v_mfma_f32_16x16x32_bf16 v[24:27], v[208:211], a[184:187], 0
  s_waitcnt lgkmcnt(0)
  v_exp_f32 v206, v206
  v_mfma_f32_16x16x32_bf16 v[28:31], v[208:211], a[188:191], 0
  v_exp_f32_e64 v203, v203
  v_mfma_f32_16x16x32_bf16 v[192:195], a[128:131], a[32:35], v[228:231]
  v_exp_f32_e64 v205, v205
  v_mfma_f32_16x16x32_bf16 v[192:195], a[132:135], a[36:39], v[192:195]
  v_exp_f32_e64 v207, v207
  v_mfma_f32_16x16x32_bf16 v[192:195], a[136:139], a[40:43], v[192:195]
  v_cvt_pk_bf16_f32 v212, v200, v201
  v_cvt_pk_bf16_f32 v215, v206, v207
  v_mfma_f32_16x16x32_bf16 v[192:195], a[140:143], a[44:47], v[192:195]
  v_exp_f32_e64 v204, v204
  v_mfma_f32_16x16x32_bf16 v[196:199], a[144:147], a[44:47], v[228:231]
  v_exp_f32_e64 v202, v202
  v_mfma_f32_16x16x32_bf16 v[196:199], a[148:151], a[40:43], v[196:199]
  v_cvt_pk_bf16_f32 v213, v202, v203
  v_cvt_pk_bf16_f32 v214, v204, v205
  v_mfma_f32_16x16x32_bf16 v[196:199], a[152:155], a[36:39], v[196:199]
  s_mov_b32 m0, s30
  v_mul_f32 v200, s29, v192
  v_mul_f32_e64 v203, s29, v195
  v_mfma_f32_16x16x32_bf16 v[196:199], a[156:159], a[32:35], v[196:199]
  v_mul_f32 v201, s29, v193
  v_mul_f32 v202, s29, v194
  v_smfmac_f32_16x16x64_bf16 a[192:195], a[220:223], v[208:215], v254
  s_barrier
  v_mfma_f32_16x16x32_bf16 v[32:35], v[212:215], a[160:163], 0
  buffer_load_dwordx4 v221, s[4:7], s33 offen lds
  v_mfma_f32_16x16x32_bf16 v[36:39], v[212:215], a[164:167], 0
  v_mul_f32 v204, s29, v196
  v_mul_f32_e64 v206, s29, v198
  v_mfma_f32_16x16x32_bf16 v[40:43], v[212:215], a[168:171], 0
  v_exp_f32_e64 v206, v206
  v_mfma_f32_16x16x32_bf16 v[44:47], v[212:215], a[172:175], 0
  s_add_u32 m0, s30, 32
  v_exp_f32 v204, v204
  v_mfma_f32_16x16x32_bf16 v[48:51], v[212:215], a[176:179], 0
  buffer_load_dwordx4 v221, s[4:7], s33 offen offset:1024 lds
  v_mfma_f32_16x16x32_bf16 v[52:55], v[212:215], a[180:183], 0
  v_mul_f32 v205, s29, v197
  v_mul_f32 v207, s29, v199
  v_mfma_f32_16x16x32_bf16 v[56:59], v[212:215], a[184:187], 0
  v_exp_f32_e64 v203, v203
  v_mfma_f32_16x16x32_bf16 v[60:63], v[212:215], a[188:191], 0
  v_exp_f32_e64 v202, v202
  v_mfma_f32_16x16x32_bf16 v[192:195], a[128:131], a[48:51], v[228:231]
  v_exp_f32_e64 v207, v207
  v_mfma_f32_16x16x32_bf16 v[192:195], a[132:135], a[52:55], v[192:195]
  v_exp_f32_e64 v205, v205
  v_mfma_f32_16x16x32_bf16 v[192:195], a[136:139], a[56:59], v[192:195]
  v_exp_f32_e64 v201, v201
  v_mfma_f32_16x16x32_bf16 v[192:195], a[140:143], a[60:63], v[192:195]
  s_add_u32 m0, s30, s96
  v_cvt_pk_bf16_f32 v210, v204, v205
  v_cvt_pk_bf16_f32 v211, v206, v207
  v_mfma_f32_16x16x32_bf16 v[196:199], a[144:147], a[60:63], v[228:231]
  buffer_load_dwordx4 v221, s[8:11], s33 offen lds
  v_mfma_f32_16x16x32_bf16 v[196:199], a[148:151], a[56:59], v[196:199]
  v_exp_f32 v200, v200
  v_mfma_f32_16x16x32_bf16 v[196:199], a[152:155], a[52:55], v[196:199]
  v_cvt_pk_bf16_f32 v208, v200, v201
  v_cvt_pk_bf16_f32 v209, v202, v203
  v_mfma_f32_16x16x32_bf16 v[196:199], a[156:159], a[48:51], v[196:199]
  s_add_u32 m0, s30, s97
  v_mul_f32 v200, s29, v192
  v_mul_f32_e64 v203, s29, v195
  v_mfma_f32_16x16x32_bf16 v[64:67], v[208:211], a[160:163], 0
  ds_write_b128 v232, v[144:147] offset:4096
  buffer_load_dwordx4 v221, s[8:11], s33 offen offset:1024 lds
  v_mfma_f32_16x16x32_bf16 v[68:71], v[208:211], a[164:167], 0
  s_sub_u32 s30, s30, 16896
  v_mul_f32 v201, s29, v193
  v_mul_f32 v202, s29, v194
  v_mfma_f32_16x16x32_bf16 v[72:75], v[208:211], a[168:171], 0
  s_cselect_b32 s30, s31, s30
  v_mul_f32 v204, s29, v196
  v_mul_f32_e64 v206, s29, v198
  v_mfma_f32_16x16x32_bf16 v[76:79], v[208:211], a[172:175], 0
  s_add_u32 s59, s59, 8192
  v_mul_f32 v205, s29, v197
  v_mul_f32 v207, s29, v199
  v_mfma_f32_16x16x32_bf16 v[80:83], v[208:211], a[176:179], 0
  ds_write_b128 v232, v[148:151] offset:4352
  v_exp_f32_e64 v207, v207
  v_mfma_f32_16x16x32_bf16 v[84:87], v[208:211], a[180:183], 0
  s_xor_b32 s33, s59, s3
  v_exp_f32 v204, v204
  v_mfma_f32_16x16x32_bf16 v[88:91], v[208:211], a[184:187], 0
  v_exp_f32_e64 v200, v200
  v_mfma_f32_16x16x32_bf16 v[92:95], v[208:211], a[188:191], 0
  s_waitcnt vmcnt(5)
  v_exp_f32 v205, v205
  v_mfma_f32_16x16x32_bf16 v[192:195], a[128:131], a[96:99], v[228:231]
  ds_write_b128 v232, v[152:155] offset:4608
  v_exp_f32_e64 v201, v201
  v_mfma_f32_16x16x32_bf16 v[192:195], a[132:135], a[100:103], v[192:195]
  v_cvt_pk_bf16_f32 v212, v200, v201
  v_cvt_pk_bf16_f32 v214, v204, v205
  v_mfma_f32_16x16x32_bf16 v[192:195], a[136:139], a[104:107], v[192:195]
  v_exp_f32_e64 v206, v206
  v_mfma_f32_16x16x32_bf16 v[192:195], a[140:143], a[108:111], v[192:195]
  v_exp_f32_e64 v202, v202
  v_mfma_f32_16x16x32_bf16 v[196:199], a[144:147], a[108:111], v[228:231]
  v_exp_f32_e64 v203, v203
  v_mfma_f32_16x16x32_bf16 v[196:199], a[148:151], a[104:107], v[196:199]
  v_cvt_pk_bf16_f32 v213, v202, v203
  v_cvt_pk_bf16_f32 v215, v206, v207
  v_mfma_f32_16x16x32_bf16 v[196:199], a[152:155], a[100:103], v[196:199]
  ds_read_b64_tr_b16 a[112:113], v220 offset:0
  ds_read_b64_tr_b16 a[114:115], v220 offset:64
  v_mfma_f32_16x16x32_bf16 v[196:199], a[156:159], a[96:99], v[196:199]
  v_mul_f32 v200, s29, v192
  v_mul_f32 v201, s29, v193
  v_smfmac_f32_16x16x64_bf16 a[196:199], a[220:223], v[208:215], v254
  ds_write_b128 v232, v[156:159] offset:4864
  ds_read_b64_tr_b16 a[116:117], v220 offset:1024
  ds_read_b64_tr_b16 a[118:119], v220 offset:1088
  v_mfma_f32_16x16x32_bf16 v[96:99], v[212:215], a[160:163], 0
  v_mul_f32 v202, s29, v194
  v_mul_f32 v203, s29, v195
  v_mfma_f32_16x16x32_bf16 v[100:103], v[212:215], a[164:167], 0
  v_mul_f32 v204, s29, v196
  v_mul_f32 v206, s29, v198
  v_mfma_f32_16x16x32_bf16 v[104:107], v[212:215], a[168:171], 0
  v_exp_f32_e64 v200, v200
  v_mfma_f32_16x16x32_bf16 v[108:111], v[212:215], a[172:175], 0
  ds_write_b128 v232, v[128:131] offset:8192
  v_exp_f32_e64 v206, v206
  v_mfma_f32_16x16x32_bf16 v[112:115], v[212:215], a[176:179], 0
  v_mul_f32 v205, s29, v197
  v_mul_f32 v207, s29, v199
  v_mfma_f32_16x16x32_bf16 v[116:119], v[212:215], a[180:183], 0
  v_exp_f32_e64 v205, v205
  v_mfma_f32_16x16x32_bf16 v[120:123], v[212:215], a[184:187], 0
  v_exp_f32_e64 v207, v207
  v_mfma_f32_16x16x32_bf16 v[124:127], v[212:215], a[188:191], 0
  ds_write_b128 v232, v[132:135] offset:8448
  v_exp_f32_e64 v204, v204
  v_mfma_f32_16x16x32_bf16 v[192:195], a[128:131], a[64:67], v[228:231]
  v_exp_f32_e64 v202, v202
  v_mfma_f32_16x16x32_bf16 v[192:195], a[132:135], a[68:71], v[192:195]
  v_cvt_pk_bf16_f32 v210, v204, v205
  v_cvt_pk_bf16_f32 v211, v206, v207
  v_mfma_f32_16x16x32_bf16 v[192:195], a[136:139], a[72:75], v[192:195]
  v_exp_f32_e64 v201, v201
  v_mfma_f32_16x16x32_bf16 v[192:195], a[140:143], a[76:79], v[192:195]
  ds_write_b128 v232, v[136:139] offset:8704
  v_exp_f32_e64 v203, v203
  v_mfma_f32_16x16x32_bf16 v[196:199], a[144:147], a[76:79], v[228:231]
  v_cvt_pk_bf16_f32 v208, v200, v201
  v_cvt_pk_bf16_f32 v209, v202, v203
  v_mfma_f32_16x16x32_bf16 v[196:199], a[148:151], a[72:75], v[196:199]
  v_add_u32 v216, s30, v218
  v_add_u32 v217, s30, v219
  v_mfma_f32_16x16x32_bf16 v[196:199], a[152:155], a[68:71], v[196:199]
  s_waitcnt lgkmcnt(2)
  v_mul_f32 v202, s29, v194
  v_mul_f32_e64 v203, s29, v195
  v_mfma_f32_16x16x32_bf16 v[196:199], a[156:159], a[64:67], v[196:199]
  buffer_store_dwordx4 a[116:119], v233, s[16:19], s35 offen offset:1024
  v_mul_f32 v200, s29, v192
  v_mul_f32 v201, s29, v193
  v_mfma_f32_16x16x32_bf16 a[204:207], a[220:223], v[208:211], 0
  v_exp_f32_e64 v202, v202
  v_mfma_f32_16x16x32_bf16 a[224:227], v[208:211], a[160:163], 0
  v_exp_f32_e64 v200, v200
  v_mfma_f32_16x16x32_bf16 a[228:231], v[208:211], a[164:167], 0
  s_mov_b32 m0, s36
  v_mul_f32 v206, s29, v198
  v_mul_f32_e64 v207, s29, v199
  v_mfma_f32_16x16x32_bf16 a[232:235], v[208:211], a[168:171], 0
  buffer_load_dwordx4 v222, s[12:15], s34 offen nt lds
  v_mfma_f32_16x16x32_bf16 a[236:239], v[208:211], a[172:175], 0
  s_add_u32 s36, s36, 2048
  v_mul_f32 v204, s29, v196
  v_mul_f32 v205, s29, v197
  v_mfma_f32_16x16x32_bf16 a[240:243], v[208:211], a[176:179], 0
  v_exp_f32_e64 v204, v204
  v_mfma_f32_16x16x32_bf16 a[244:247], v[208:211], a[180:183], 0
  v_exp_f32_e64 v205, v205
  v_mfma_f32_16x16x32_bf16 a[248:251], v[208:211], a[184:187], 0
  ds_write_b128 v232, v[140:143] offset:8960
  buffer_load_dwordx4 v223, s[12:15], s34 offen offset:1024 nt lds
  v_mfma_f32_16x16x32_bf16 a[252:255], v[208:211], a[188:191], 0
  s_add_u32 s34, s34, 2048
  v_exp_f32_e64 v206, v206
  v_mfma_f32_16x16x32_bf16 v[192:195], a[128:131], a[80:83], v[228:231]
  ds_read_b128 a[128:131], v216 offset:0
  v_cvt_pk_bf16_f32 v210, v204, v205
  v_mfma_f32_16x16x32_bf16 v[192:195], a[132:135], a[84:87], v[192:195]
  buffer_store_dwordx4 a[112:115], v233, s[16:19], s35 offen
  v_exp_f32_e64 v203, v203
  v_mfma_f32_16x16x32_bf16 v[192:195], a[136:139], a[88:91], v[192:195]
  ds_read_b128 a[132:135], v216 offset:64
  ds_read_b128 a[136:139], v216 offset:128
  v_mfma_f32_16x16x32_bf16 v[192:195], a[140:143], a[92:95], v[192:195]
  s_add_u32 s35, s35, 2048
  v_exp_f32_e64 v207, v207
  v_mfma_f32_16x16x32_bf16 v[196:199], a[144:147], a[92:95], v[228:231]
  ds_read_b128 a[140:143], v216 offset:192
  ds_read_b128 a[144:147], v216 offset:704
  v_mfma_f32_16x16x32_bf16 v[196:199], a[148:151], a[88:91], v[196:199]
  v_exp_f32_e64 v201, v201
  v_mfma_f32_16x16x32_bf16 v[196:199], a[152:155], a[84:87], v[196:199]
  v_cvt_pk_bf16_f32 v208, v200, v201
  v_cvt_pk_bf16_f32 v209, v202, v203
  v_cvt_pk_bf16_f32 v211, v206, v207
  v_mfma_f32_16x16x32_bf16 v[196:199], a[156:159], a[80:83], v[196:199]
  v_mul_f32 v201, s29, v193
  v_mul_f32 v203, s29, v195
  v_mfma_f32_16x16x32_bf16 v[128:131], v[208:211], a[160:163], 0
  ds_read_b128 a[148:151], v216 offset:640
  ds_read_b128 a[152:155], v216 offset:576
  v_mfma_f32_16x16x32_bf16 v[132:135], v[208:211], a[164:167], 0
  v_mul_f32 v200, s29, v192
  v_mul_f32 v202, s29, v194
  v_mfma_f32_16x16x32_bf16 v[136:139], v[208:211], a[168:171], 0
  ds_read_b128 a[156:159], v216 offset:512
  v_mul_f32_e64 v205, s29, v197
  v_mfma_f32_16x16x32_bf16 v[140:143], v[208:211], a[172:175], 0
  v_exp_f32_e64 v200, v200
  v_mfma_f32_16x16x32_bf16 v[144:147], v[208:211], a[176:179], 0
  v_exp_f32_e64 v201, v201
  v_mfma_f32_16x16x32_bf16 v[148:151], v[208:211], a[180:183], 0
  v_exp_f32_e64 v202, v202
  v_mfma_f32_16x16x32_bf16 v[152:155], v[208:211], a[184:187], 0
  v_mul_f32 v204, s29, v196
  v_exp_f32 v203, v203
  v_mfma_f32_16x16x32_bf16 v[156:159], v[208:211], a[188:191], 0
  s_waitcnt lgkmcnt(3)
  v_mul_f32 v206, s29, v198
  v_mul_f32_e64 v207, s29, v199
  v_mfma_f32_16x16x32_bf16 v[192:195], a[128:131], a[0:3], v[228:231]
  v_exp_f32_e64 v205, v205
  v_mfma_f32_16x16x32_bf16 v[192:195], a[132:135], a[4:7], v[192:195]
  v_exp_f32_e64 v206, v206
  v_mfma_f32_16x16x32_bf16 v[192:195], a[136:139], a[8:11], v[192:195]
  v_cvt_pk_bf16_f32 v212, v200, v201
  v_cvt_pk_bf16_f32 v213, v202, v203
  v_mfma_f32_16x16x32_bf16 v[192:195], a[140:143], a[12:15], v[192:195]
  v_exp_f32_e64 v204, v204
  v_mfma_f32_16x16x32_bf16 v[196:199], a[144:147], a[12:15], v[228:231]
  s_waitcnt lgkmcnt(0)
  v_exp_f32 v207, v207
  v_mfma_f32_16x16x32_bf16 v[196:199], a[148:151], a[8:11], v[196:199]
  v_cvt_pk_bf16_f32 v214, v204, v205
  v_cvt_pk_bf16_f32 v215, v206, v207
  v_mfma_f32_16x16x32_bf16 v[196:199], a[152:155], a[4:7], v[196:199]
  v_mul_f32 v200, s29, v192
  v_mul_f32 v203, s29, v195
  v_mfma_f32_16x16x32_bf16 v[196:199], a[156:159], a[0:3], v[196:199]
  v_mul_f32 v201, s29, v193
  v_mul_f32 v202, s29, v194
  v_mfma_f32_16x16x32_bf16 v[160:163], v[212:215], a[160:163], 0
  ds_read_b64_tr_b16 a[160:161], v217 offset:8448
  ds_read_b64_tr_b16 a[162:163], v217 offset:8960
  v_mfma_f32_16x16x32_bf16 v[164:167], v[212:215], a[164:167], 0
  v_exp_f32_e64 v203, v203
  v_mfma_f32_16x16x32_bf16 v[168:171], v[212:215], a[168:171], 0
  ds_read_b64_tr_b16 a[166:167], v217 offset:8976
  ds_read_b64_tr_b16 a[170:171], v217 offset:8992
  v_mfma_f32_16x16x32_bf16 v[172:175], v[212:215], a[172:175], 0
  v_mul_f32 v204, s29, v196
  v_mul_f32 v207, s29, v199
  v_mfma_f32_16x16x32_bf16 v[176:179], v[212:215], a[176:179], 0
  ds_read_b64_tr_b16 a[168:169], v217 offset:8480
  ds_read_b64_tr_b16 a[172:173], v217 offset:8496
  v_mfma_f32_16x16x32_bf16 v[180:183], v[212:215], a[180:183], 0
  v_exp_f32_e64 v201, v201
  v_mfma_f32_16x16x32_bf16 v[184:187], v[212:215], a[184:187], 0
  ds_read_b64_tr_b16 a[164:165], v217 offset:8464
  ds_read_b64_tr_b16 a[174:175], v217 offset:9008
  v_mfma_f32_16x16x32_bf16 v[188:191], v[212:215], a[188:191], 0
  v_mul_f32 v205, s29, v197
  v_mul_f32 v206, s29, v198
  v_smfmac_f32_16x16x64_bf16 a[200:203], a[220:223], v[208:215], v254
  v_exp_f32 v200, v200
  v_exp_f32 v202, v202
  s_cmp_eq_u32 s38, 1
  s_cselect_b32 s37, 12, 14
  s_cbranch_scc1 L_pC2
  s_branch L_pA2
L_fA2:
  v_mfma_f32_16x16x32_bf16 v[192:195], a[128:131], a[16:19], v[228:231]
  ds_read_b64_tr_b16 a[178:179], v217 offset:9024
  v_cvt_pk_bf16_f32 v209, v202, v203
  v_mfma_f32_16x16x32_bf16 v[192:195], a[132:135], a[20:23], v[192:195]
  v_exp_f32_e64 v206, v206
  v_mfma_f32_16x16x32_bf16 v[192:195], a[136:139], a[24:27], v[192:195]
  ds_read_b64_tr_b16 a[182:183], v217 offset:9040
  v_cvt_pk_bf16_f32 v208, v200, v201
  v_mfma_f32_16x16x32_bf16 v[192:195], a[140:143], a[28:31], v[192:195]
  s_waitcnt lgkmcnt(2)
  v_exp_f32 v204, v204
  v_mfma_f32_16x16x32_bf16 v[196:199], a[144:147], a[28:31], v[228:231]
  ds_read_b64_tr_b16 a[176:177], v217 offset:8512
  ds_read_b64_tr_b16 a[186:187], v217 offset:9056
  v_mfma_f32_16x16x32_bf16 v[196:199], a[148:151], a[24:27], v[196:199]
  ds_read_b64_tr_b16 a[180:181], v217 offset:8528
  v_exp_f32 v205, v205
  v_exp_f32 v207, v207
  v_mfma_f32_16x16x32_bf16 v[196:199], a[152:155], a[20:23], v[196:199]
  ds_read_b64_tr_b16 a[184:185], v217 offset:8544
  v_cvt_pk_bf16_f32 v210, v204, v205
  v_cvt_pk_bf16_f32 v211, v206, v207
  v_mfma_f32_16x16x32_bf16 v[196:199], a[156:159], a[16:19], v[196:199]
  ds_read_b64_tr_b16 a[188:189], v217 offset:8560
  ds_read_b64_tr_b16 a[190:191], v217 offset:9072
  v_mfma_f32_16x16x32_bf16 v[0:3], v[208:211], a[160:163], 0
  v_mul_f32 v200, s29, v192
  v_mul_f32 v203, s29, v195
  v_mfma_f32_16x16x32_bf16 v[4:7], v[208:211], a[164:167], 0
  v_mul_f32 v201, s29, v193
  v_mul_f32 v202, s29, v194
  v_mfma_f32_16x16x32_bf16 v[8:11], v[208:211], a[168:171], 0
  v_mul_f32 v204, s29, v196
  v_mul_f32 v205, s29, v197
  v_mfma_f32_16x16x32_bf16 v[12:15], v[208:211], a[172:175], 0
  s_waitcnt lgkmcnt(5)
  v_mul_f32 v206, s29, v198
  v_mul_f32_e64 v207, s29, v199
  v_mfma_f32_16x16x32_bf16 v[16:19], v[208:211], a[176:179], 0
  s_waitcnt lgkmcnt(3)
  v_exp_f32 v202, v202
  v_mfma_f32_16x16x32_bf16 v[20:23], v[208:211], a[180:183], 0
  s_waitcnt lgkmcnt(2)
  v_exp_f32 v203, v203
  v_mfma_f32_16x16x32_bf16 v[24:27], v[208:211], a[184:187], 0
  s_waitcnt lgkmcnt(0)
  v_exp_f32 v206, v206
  v_mfma_f32_16x16x32_bf16 v[28:31], v[208:211], a[188:191], 0
  v_exp_f32_e64 v204, v204
  v_mfma_f32_16x16x32_bf16 v[192:195], a[128:131], a[32:35], v[228:231]
  v_exp_f32_e64 v201, v201
  v_mfma_f32_16x16x32_bf16 v[192:195], a[132:135], a[36:39], v[192:195]
  v_exp_f32_e64 v205, v205
  v_mfma_f32_16x16x32_bf16 v[192:195], a[136:139], a[40:43], v[192:195]
  v_cvt_pk_bf16_f32 v213, v202, v203
  v_cvt_pk_bf16_f32 v214, v204, v205
  v_mfma_f32_16x16x32_bf16 v[192:195], a[140:143], a[44:47], v[192:195]
  v_exp_f32_e64 v200, v200
  v_mfma_f32_16x16x32_bf16 v[196:199], a[144:147], a[44:47], v[228:231]
  ds_read_b64_tr_b16 a[112:113], v220 offset:2048
  v_cvt_pk_bf16_f32 v212, v200, v201
  v_mfma_f32_16x16x32_bf16 v[196:199], a[148:151], a[40:43], v[196:199]
  v_exp_f32_e64 v207, v207
  v_mfma_f32_16x16x32_bf16 v[196:199], a[152:155], a[36:39], v[196:199]
  v_cvt_pk_bf16_f32 v215, v206, v207
  v_mul_f32_e64 v202, s29, v194
  v_mfma_f32_16x16x32_bf16 v[196:199], a[156:159], a[32:35], v[196:199]
  v_mul_f32 v201, s29, v193
  v_mul_f32 v203, s29, v195
  v_smfmac_f32_16x16x64_bf16 a[192:195], a[220:223], v[208:215], v254
  s_barrier
  v_mul_f32 v200, s29, v192
  v_mfma_f32_16x16x32_bf16 v[32:35], v[212:215], a[160:163], 0
  v_exp_f32_e64 v200, v200
  v_mfma_f32_16x16x32_bf16 v[36:39], v[212:215], a[164:167], 0
  v_mul_f32 v205, s29, v197
  v_mul_f32 v206, s29, v198
  v_mfma_f32_16x16x32_bf16 v[40:43], v[212:215], a[168:171], 0
  v_mul_f32 v204, s29, v196
  v_mul_f32 v207, s29, v199
  v_mfma_f32_16x16x32_bf16 v[44:47], v[212:215], a[172:175], 0
  v_exp_f32_e64 v205, v205
  v_mfma_f32_16x16x32_bf16 v[48:51], v[212:215], a[176:179], 0
  s_mov_b32 m0, s30
  v_exp_f32 v207, v207
  v_mfma_f32_16x16x32_bf16 v[52:55], v[212:215], a[180:183], 0
  buffer_load_dwordx4 v221, s[4:7], s33 offen lds
  v_mfma_f32_16x16x32_bf16 v[56:59], v[212:215], a[184:187], 0
  v_exp_f32_e64 v202, v202
  v_mfma_f32_16x16x32_bf16 v[60:63], v[212:215], a[188:191], 0
  v_exp_f32_e64 v204, v204
  v_mfma_f32_16x16x32_bf16 v[192:195], a[128:131], a[48:51], v[228:231]
  v_exp_f32_e64 v203, v203
  v_mfma_f32_16x16x32_bf16 v[192:195], a[132:135], a[52:55], v[192:195]
  v_cvt_pk_bf16_f32 v209, v202, v203
  v_cvt_pk_bf16_f32 v210, v204, v205
  v_mfma_f32_16x16x32_bf16 v[192:195], a[136:139], a[56:59], v[192:195]
  v_exp_f32_e64 v201, v201
  v_mfma_f32_16x16x32_bf16 v[192:195], a[140:143], a[60:63], v[192:195]
  ds_read_b64_tr_b16 a[114:115], v220 offset:2112
  v_cvt_pk_bf16_f32 v208, v200, v201
  v_mfma_f32_16x16x32_bf16 v[196:199], a[144:147], a[60:63], v[228:231]
  s_add_u32 m0, s30, 32
  v_exp_f32 v206, v206
  v_mfma_f32_16x16x32_bf16 v[196:199], a[148:151], a[56:59], v[196:199]
  buffer_load_dwordx4 v221, s[4:7], s33 offen offset:1024 lds
  v_mfma_f32_16x16x32_bf16 v[196:199], a[152:155], a[52:55], v[196:199]
  v_cvt_pk_bf16_f32 v211, v206, v207
  v_mul_f32_e64 v203, s29, v195
  v_mfma_f32_16x16x32_bf16 v[196:199], a[156:159], a[48:51], v[196:199]
  v_mul_f32 v200, s29, v192
  v_mul_f32 v201, s29, v193
  v_mfma_f32_16x16x32_bf16 v[64:67], v[208:211], a[160:163], 0
  s_add_u32 m0, s30, s96
  v_exp_f32 v200, v200
  v_mfma_f32_16x16x32_bf16 v[68:71], v[208:211], a[164:167], 0
  buffer_load_dwordx4 v221, s[8:11], s33 offen lds
  v_mfma_f32_16x16x32_bf16 v[72:75], v[208:211], a[168:171], 0
  v_mul_f32 v204, s29, v196
  v_mul_f32 v206, s29, v198
  v_mfma_f32_16x16x32_bf16 v[76:79], v[208:211], a[172:175], 0
  v_exp_f32_e64 v203, v203
  v_mfma_f32_16x16x32_bf16 v[80:83], v[208:211], a[176:179], 0
  v_mul_f32 v202, s29, v194
  v_mul_f32 v207, s29, v199
  v_mfma_f32_16x16x32_bf16 v[84:87], v[208:211], a[180:183], 0
  v_exp_f32_e64 v202, v202
  v_mfma_f32_16x16x32_bf16 v[88:91], v[208:211], a[184:187], 0
  v_exp_f32_e64 v201, v201
  v_mfma_f32_16x16x32_bf16 v[92:95], v[208:211], a[188:191], 0
  s_waitcnt vmcnt(4)
  v_mul_f32 v205, s29, v197
  v_cvt_pk_bf16_f32 v212, v200, v201
  v_mfma_f32_16x16x32_bf16 v[192:195], a[128:131], a[96:99], v[228:231]
  v_exp_f32_e64 v204, v204
  v_mfma_f32_16x16x32_bf16 v[192:195], a[132:135], a[100:103], v[192:195]
  ds_write_b128 v232, v[144:147] offset:4096
  v_exp_f32_e64 v206, v206
  v_mfma_f32_16x16x32_bf16 v[192:195], a[136:139], a[104:107], v[192:195]
  v_exp_f32_e64 v207, v207
  v_mfma_f32_16x16x32_bf16 v[192:195], a[140:143], a[108:111], v[192:195]
  v_exp_f32_e64 v205, v205
  v_mfma_f32_16x16x32_bf16 v[196:199], a[144:147], a[108:111], v[228:231]
  s_add_u32 m0, s30, s97
  v_cvt_pk_bf16_f32 v214, v204, v205
  v_cvt_pk_bf16_f32 v215, v206, v207
  v_mfma_f32_16x16x32_bf16 v[196:199], a[148:151], a[104:107], v[196:199]
  buffer_load_dwordx4 v221, s[8:11], s33 offen offset:1024 lds
  v_mfma_f32_16x16x32_bf16 v[196:199], a[152:155], a[100:103], v[196:199]
  s_sub_u32 s30, s30, 16896
  v_cvt_pk_bf16_f32 v213, v202, v203
  v_mul_f32 v202, s29, v194
  v_mfma_f32_16x16x32_bf16 v[196:199], a[156:159], a[96:99], v[196:199]
  s_cselect_b32 s30, s31, s30
  v_mul_f32 v200, s29, v192
  v_mul_f32_e64 v203, s29, v195
  v_smfmac_f32_16x16x64_bf16 a[196:199], a[220:223], v[208:215], v254
  s_add_u32 s59, s59, 8192
  v_mul_f32_e64 v201, s29, v193
  v_mfma_f32_16x16x32_bf16 v[96:99], v[212:215], a[160:163], 0
  ds_write_b128 v232, v[148:151] offset:4352
  v_exp_f32_e64 v200, v200
  v_mfma_f32_16x16x32_bf16 v[100:103], v[212:215], a[164:167], 0
  s_xor_b32 s33, s59, s3
  v_mul_f32 v205, s29, v197
  v_mul_f32_e64 v207, s29, v199
  v_mfma_f32_16x16x32_bf16 v[104:107], v[212:215], a[168:171], 0
  v_exp_f32_e64 v205, v205
  v_mfma_f32_16x16x32_bf16 v[108:111], v[212:215], a[172:175], 0
  v_exp_f32_e64 v207, v207
  v_mfma_f32_16x16x32_bf16 v[112:115], v[212:215], a[176:179], 0
  ds_write_b128 v232, v[152:155] offset:4608
  v_exp_f32_e64 v201, v201
  v_mfma_f32_16x16x32_bf16 v[116:119], v[212:215], a[180:183], 0
  v_mul_f32 v204, s29, v196
  v_mul_f32 v206, s29, v198
  v_mfma_f32_16x16x32_bf16 v[120:123], v[212:215], a[184:187], 0
  ds_read_b64_tr_b16 a[116:117], v220 offset:3072
  ds_read_b64_tr_b16 a[118:119], v220 offset:3136
  v_mfma_f32_16x16x32_bf16 v[124:127], v[212:215], a[188:191], 0
  v_exp_f32_e64 v202, v202
  v_mfma_f32_16x16x32_bf16 v[192:195], a[128:131], a[64:67], v[228:231]
  ds_write_b128 v232, v[156:159] offset:4864
  v_exp_f32_e64 v203, v203
  v_mfma_f32_16x16x32_bf16 v[192:195], a[132:135], a[68:71], v[192:195]
  v_cvt_pk_bf16_f32 v208, v200, v201
  v_cvt_pk_bf16_f32 v209, v202, v203
  v_mfma_f32_16x16x32_bf16 v[192:195], a[136:139], a[72:75], v[192:195]
  v_exp_f32_e64 v204, v204
  v_mfma_f32_16x16x32_bf16 v[192:195], a[140:143], a[76:79], v[192:195]
  v_cvt_pk_bf16_f32 v210, v204, v205
  v_add_u32_e64 v216, s30, v218
  v_mfma_f32_16x16x32_bf16 v[196:199], a[144:147], a[76:79], v[228:231]
  ds_write_b128 v232, v[128:131] offset:8192
  v_exp_f32_e64 v206, v206
  v_mfma_f32_16x16x32_bf16 v[196:199], a[148:151], a[72:75], v[196:199]
  v_cvt_pk_bf16_f32 v211, v206, v207
  v_add_u32_e64 v217, s30, v219
  v_mfma_f32_16x16x32_bf16 v[196:199], a[152:155], a[68:71], v[196:199]
  v_mul_f32 v200, s29, v192
  v_mul_f32 v202, s29, v194
  v_mfma_f32_16x16x32_bf16 v[196:199], a[156:159], a[64:67], v[196:199]
  v_mul_f32 v201, s29, v193
  v_mul_f32 v203, s29, v195
  v_mfma_f32_16x16x32_bf16 a[204:207], a[220:223], v[208:211], 0
  ds_write_b128 v232, v[132:135] offset:8448
  v_exp_f32_e64 v203, v203
  v_mfma_f32_16x16x32_bf16 a[224:227], v[208:211], a[160:163], 0
  v_exp_f32_e64 v200, v200
  v_mfma_f32_16x16x32_bf16 a[228:231], v[208:211], a[164:167], 0
  v_mul_f32 v206, s29, v198
  v_mul_f32 v207, s29, v199
  v_mfma_f32_16x16x32_bf16 a[232:235], v[208:211], a[168:171], 0
  v_exp_f32_e64 v206, v206
  v_mfma_f32_16x16x32_bf16 a[236:239], v[208:211], a[172:175], 0
  ds_write_b128 v232, v[136:139] offset:8704
  v_exp_f32_e64 v202, v202
  v_mfma_f32_16x16x32_bf16 a[240:243], v[208:211], a[176:179], 0
  s_waitcnt lgkmcnt(2)
  v_exp_f32 v201, v201
  v_mfma_f32_16x16x32_bf16 a[244:247], v[208:211], a[180:183], 0
  buffer_store_dwordx4 a[116:119], v233, s[16:19], s35 offen offset:1024
  v_mul_f32 v204, s29, v196
  v_mul_f32 v205, s29, v197
  v_mfma_f32_16x16x32_bf16 a[248:251], v[208:211], a[184:187], 0
  s_mov_b32 m0, s36
  v_exp_f32 v205, v205
  v_mfma_f32_16x16x32_bf16 a[252:255], v[208:211], a[188:191], 0
  ds_write_b128 v232, v[140:143] offset:8960
  buffer_load_dwordx4 v222, s[12:15], s34 offen nt lds
  v_mfma_f32_16x16x32_bf16 v[192:195], a[128:131], a[80:83], v[228:231]
  s_add_u32 s36, s36, 2048
  v_exp_f32_e64 v204, v204
  v_mfma_f32_16x16x32_bf16 v[192:195], a[132:135], a[84:87], v[192:195]
  buffer_store_dwordx4 a[112:115], v233, s[16:19], s35 offen
  buffer_load_dwordx4 v223, s[12:15], s34 offen offset:1024 nt lds
  v_mfma_f32_16x16x32_bf16 v[192:195], a[136:139], a[88:91], v[192:195]
  s_add_u32 s35, s35, 2048
  v_cvt_pk_bf16_f32 v209, v202, v203
  v_cvt_pk_bf16_f32 v210, v204, v205
  v_mfma_f32_16x16x32_bf16 v[192:195], a[140:143], a[92:95], v[192:195]
  ds_read_b128 a[128:131], v216 offset:0
  v_cvt_pk_bf16_f32 v208, v200, v201
  v_mfma_f32_16x16x32_bf16 v[196:199], a[144:147], a[92:95], v[228:231]
  s_add_u32 s34, s34, 2048
  v_exp_f32_e64 v207, v207
  v_mfma_f32_16x16x32_bf16 v[196:199], a[148:151], a[88:91], v[196:199]
  ds_read_b128 a[136:139], v216 offset:128
  v_cvt_pk_bf16_f32 v211, v206, v207
  v_mfma_f32_16x16x32_bf16 v[196:199], a[152:155], a[84:87], v[196:199]
  v_mul_f32 v201, s29, v193
  v_mul_f32 v202, s29, v194
  v_mfma_f32_16x16x32_bf16 v[196:199], a[156:159], a[80:83], v[196:199]
  ds_read_b128 a[132:135], v216 offset:64
  ds_read_b128 a[140:143], v216 offset:192
  v_mfma_f32_16x16x32_bf16 v[128:131], v[208:211], a[160:163], 0
  v_mul_f32 v200, s29, v192
  v_mul_f32 v203, s29, v195
  v_mfma_f32_16x16x32_bf16 v[132:135], v[208:211], a[164:167], 0
  v_exp_f32_e64 v203, v203
  v_mfma_f32_16x16x32_bf16 v[136:139], v[208:211], a[168:171], 0
  v_mul_f32 v204, s29, v196
  v_mul_f32 v205, s29, v197
  v_mfma_f32_16x16x32_bf16 v[140:143], v[208:211], a[172:175], 0
  ds_read_b128 a[144:147], v216 offset:704
  ds_read_b128 a[148:151], v216 offset:640
  v_mfma_f32_16x16x32_bf16 v[144:147], v[208:211], a[176:179], 0
  v_exp_f32_e64 v202, v202
  v_mfma_f32_16x16x32_bf16 v[148:151], v[208:211], a[180:183], 0
  ds_read_b128 a[152:155], v216 offset:576
  ds_read_b128 a[156:159], v216 offset:512
  v_mfma_f32_16x16x32_bf16 v[152:155], v[208:211], a[184:187], 0
  v_exp_f32 v200, v200
  v_exp_f32 v201, v201
  v_mfma_f32_16x16x32_bf16 v[156:159], v[208:211], a[188:191], 0
  s_waitcnt lgkmcnt(4)
  v_mul_f32 v206, s29, v198
  v_cvt_pk_bf16_f32 v213, v202, v203
  v_mfma_f32_16x16x32_bf16 v[192:195], a[128:131], a[0:3], v[228:231]
  v_exp_f32_e64 v205, v205
  v_mfma_f32_16x16x32_bf16 v[192:195], a[132:135], a[4:7], v[192:195]
  v_exp_f32_e64 v206, v206
  v_mfma_f32_16x16x32_bf16 v[192:195], a[136:139], a[8:11], v[192:195]
  v_mul_f32_e64 v207, s29, v199
  v_cvt_pk_bf16_f32 v212, v200, v201
  v_mfma_f32_16x16x32_bf16 v[192:195], a[140:143], a[12:15], v[192:195]
  s_waitcnt lgkmcnt(2)
  v_exp_f32 v207, v207
  v_mfma_f32_16x16x32_bf16 v[196:199], a[144:147], a[12:15], v[228:231]
  v_exp_f32_e64 v204, v204
  v_mfma_f32_16x16x32_bf16 v[196:199], a[148:151], a[8:11], v[196:199]
  s_waitcnt lgkmcnt(0)
  v_cvt_pk_bf16_f32 v214, v204, v205
  v_cvt_pk_bf16_f32 v215, v206, v207
  v_mfma_f32_16x16x32_bf16 v[196:199], a[152:155], a[4:7], v[196:199]
  v_mul_f32 v201, s29, v193
  v_mul_f32_e64 v202, s29, v194
  v_mfma_f32_16x16x32_bf16 v[196:199], a[156:159], a[0:3], v[196:199]
  v_mul_f32 v200, s29, v192
  v_mul_f32 v203, s29, v195
  v_mfma_f32_16x16x32_bf16 v[160:163], v[212:215], a[160:163], 0
  v_exp_f32_e64 v200, v200
  v_mfma_f32_16x16x32_bf16 v[164:167], v[212:215], a[164:167], 0
  ds_read_b64_tr_b16 a[160:161], v217 offset:8448
  ds_read_b64_tr_b16 a[164:165], v217 offset:8464
  v_mfma_f32_16x16x32_bf16 v[168:171], v[212:215], a[168:171], 0
  v_mul_f32 v205, s29, v197
  v_mul_f32 v207, s29, v199
  v_mfma_f32_16x16x32_bf16 v[172:175], v[212:215], a[172:175], 0
  ds_read_b64_tr_b16 a[168:169], v217 offset:8480
  ds_read_b64_tr_b16 a[172:173], v217 offset:8496
  v_mfma_f32_16x16x32_bf16 v[176:179], v[212:215], a[176:179], 0
  v_mul_f32 v204, s29, v196
  v_mul_f32 v206, s29, v198
  v_mfma_f32_16x16x32_bf16 v[180:183], v[212:215], a[180:183], 0
  ds_read_b64_tr_b16 a[162:163], v217 offset:8960
  ds_read_b64_tr_b16 a[170:171], v217 offset:8992
  v_mfma_f32_16x16x32_bf16 v[184:187], v[212:215], a[184:187], 0
  v_exp_f32_e64 v202, v202
  v_mfma_f32_16x16x32_bf16 v[188:191], v[212:215], a[188:191], 0
  ds_read_b64_tr_b16 a[166:167], v217 offset:8976
  ds_read_b64_tr_b16 a[174:175], v217 offset:9008
  v_smfmac_f32_16x16x64_bf16 a[200:203], a[220:223], v[208:215], v254
  v_exp_f32 v201, v201
  v_exp_f32 v203, v203
  s_cmp_eq_u32 s38, 1
  s_cselect_b32 s37, 12, 14
  s_cbranch_scc1 L_pC3
  s_branch L_pA3
L_fA3:
  v_mfma_f32_16x16x32_bf16 v[192:195], a[128:131], a[16:19], v[228:231]
  v_exp_f32_e64 v205, v205
  v_mfma_f32_16x16x32_bf16 v[192:195], a[132:135], a[20:23], v[192:195]
  ds_read_b64_tr_b16 a[178:179], v217 offset:9024
  ds_read_b64_tr_b16 a[180:181], v217 offset:8528
  v_mfma_f32_16x16x32_bf16 v[192:195], a[136:139], a[24:27], v[192:195]
  v_cvt_pk_bf16_f32 v208, v200, v201
  v_cvt_pk_bf16_f32 v209, v202, v203
  v_mfma_f32_16x16x32_bf16 v[192:195], a[140:143], a[28:31], v[192:195]
  ds_read_b64_tr_b16 a[176:177], v217 offset:8512
  ds_read_b64_tr_b16 a[186:187], v217 offset:9056
  v_mfma_f32_16x16x32_bf16 v[196:199], a[144:147], a[28:31], v[228:231]
  s_waitcnt lgkmcnt(4)
  v_exp_f32 v207, v207
  v_mfma_f32_16x16x32_bf16 v[196:199], a[148:151], a[24:27], v[196:199]
  ds_read_b64_tr_b16 a[182:183], v217 offset:9040
  v_exp_f32 v204, v204
  v_exp_f32 v206, v206
  v_mfma_f32_16x16x32_bf16 v[196:199], a[152:155], a[20:23], v[196:199]
  ds_read_b64_tr_b16 a[184:185], v217 offset:8544
  v_cvt_pk_bf16_f32 v210, v204, v205
  v_cvt_pk_bf16_f32 v211, v206, v207
  v_mfma_f32_16x16x32_bf16 v[196:199], a[156:159], a[16:19], v[196:199]
  ds_read_b64_tr_b16 a[188:189], v217 offset:8560
  ds_read_b64_tr_b16 a[190:191], v217 offset:9072
  v_mfma_f32_16x16x32_bf16 v[0:3], v[208:211], a[160:163], 0
  v_mul_f32 v201, s29, v193
  v_mul_f32 v203, s29, v195
  v_mfma_f32_16x16x32_bf16 v[4:7], v[208:211], a[164:167], 0
  v_mul_f32 v200, s29, v192
  v_mul_f32 v202, s29, v194
  v_mfma_f32_16x16x32_bf16 v[8:11], v[208:211], a[168:171], 0
  v_mul_f32 v204, s29, v196
  v_mul_f32 v206, s29, v198
  v_mfma_f32_16x16x32_bf16 v[12:15], v[208:211], a[172:175], 0
  s_waitcnt lgkmcnt(4)
  v_mul_f32 v205, s29, v197
  v_mul_f32_e64 v207, s29, v199
  v_mfma_f32_16x16x32_bf16 v[16:19], v[208:211], a[176:179], 0
  s_waitcnt lgkmcnt(3)
  v_exp_f32 v201, v201
  v_mfma_f32_16x16x32_bf16 v[20:23], v[208:211], a[180:183], 0
  s_waitcnt lgkmcnt(2)
  v_exp_f32 v200, v200
  v_mfma_f32_16x16x32_bf16 v[24:27], v[208:211], a[184:187], 0
  s_waitcnt lgkmcnt(0)
  v_exp_f32 v206, v206
  v_mfma_f32_16x16x32_bf16 v[28:31], v[208:211], a[188:191], 0
  v_exp_f32_e64 v203, v203
  v_mfma_f32_16x16x32_bf16 v[192:195], a[128:131], a[32:35], v[228:231]
  v_exp_f32_e64 v205, v205
  v_mfma_f32_16x16x32_bf16 v[192:195], a[132:135], a[36:39], v[192:195]
  v_exp_f32_e64 v207, v207
  v_mfma_f32_16x16x32_bf16 v[192:195], a[136:139], a[40:43], v[192:195]
  v_cvt_pk_bf16_f32 v212, v200, v201
  v_cvt_pk_bf16_f32 v215, v206, v207
  v_mfma_f32_16x16x32_bf16 v[192:195], a[140:143], a[44:47], v[192:195]
  v_exp_f32_e64 v204, v204
  v_mfma_f32_16x16x32_bf16 v[196:199], a[144:147], a[44:47], v[228:231]
  v_exp_f32_e64 v202, v202
  v_mfma_f32_16x16x32_bf16 v[196:199], a[148:151], a[40:43], v[196:199]
  v_cvt_pk_bf16_f32 v213, v202, v203
  v_cvt_pk_bf16_f32 v214, v204, v205
  v_mfma_f32_16x16x32_bf16 v[196:199], a[152:155], a[36:39], v[196:199]
  v_mul_f32 v200, s29, v192
  v_mul_f32 v203, s29, v195
  v_mfma_f32_16x16x32_bf16 v[196:199], a[156:159], a[32:35], v[196:199]
  v_mul_f32 v201, s29, v193
  v_mul_f32 v202, s29, v194
  v_smfmac_f32_16x16x64_bf16 a[192:195], a[220:223], v[208:215], v254
  s_barrier
  v_mfma_f32_16x16x32_bf16 v[32:35], v[212:215], a[160:163], 0
  v_exp_f32 v203, v203
  v_mfma_f32_16x16x32_bf16 v[36:39], v[212:215], a[164:167], 0
  s_mov_b32 m0, s30
  v_mul_f32 v204, s29, v196
  v_mul_f32_e64 v206, s29, v198
  v_mfma_f32_16x16x32_bf16 v[40:43], v[212:215], a[168:171], 0
  buffer_load_dwordx4 v221, s[4:7], s33 offen lds
  v_mfma_f32_16x16x32_bf16 v[44:47], v[212:215], a[172:175], 0
  v_exp_f32_e64 v206, v206
  v_mfma_f32_16x16x32_bf16 v[48:51], v[212:215], a[176:179], 0
  v_exp_f32_e64 v204, v204
  v_mfma_f32_16x16x32_bf16 v[52:55], v[212:215], a[180:183], 0
  s_add_u32 m0, s30, 32
  v_mul_f32 v205, s29, v197
  v_mul_f32_e64 v207, s29, v199
  v_mfma_f32_16x16x32_bf16 v[56:59], v[212:215], a[184:187], 0
  buffer_load_dwordx4 v221, s[4:7], s33 offen offset:1024 lds
  v_mfma_f32_16x16x32_bf16 v[60:63], v[212:215], a[188:191], 0
  v_exp_f32_e64 v202, v202
  v_mfma_f32_16x16x32_bf16 v[192:195], a[128:131], a[48:51], v[228:231]
  v_exp_f32_e64 v207, v207
  v_mfma_f32_16x16x32_bf16 v[192:195], a[132:135], a[52:55], v[192:195]
  s_add_u32 m0, s30, s96
  v_exp_f32 v205, v205
  v_mfma_f32_16x16x32_bf16 v[192:195], a[136:139], a[56:59], v[192:195]
  buffer_load_dwordx4 v221, s[8:11], s33 offen lds
  v_mfma_f32_16x16x32_bf16 v[192:195], a[140:143], a[60:63], v[192:195]
  v_exp_f32_e64 v201, v201
  v_mfma_f32_16x16x32_bf16 v[196:199], a[144:147], a[60:63], v[228:231]
  v_cvt_pk_bf16_f32 v210, v204, v205
  v_cvt_pk_bf16_f32 v211, v206, v207
  v_mfma_f32_16x16x32_bf16 v[196:199], a[148:151], a[56:59], v[196:199]
  v_exp_f32_e64 v200, v200
  v_mfma_f32_16x16x32_bf16 v[196:199], a[152:155], a[52:55], v[196:199]
  v_cvt_pk_bf16_f32 v208, v200, v201
  v_cvt_pk_bf16_f32 v209, v202, v203
  v_mfma_f32_16x16x32_bf16 v[196:199], a[156:159], a[48:51], v[196:199]
  v_mul_f32 v200, s29, v192
  v_mul_f32 v203, s29, v195
  v_mfma_f32_16x16x32_bf16 v[64:67], v[208:211], a[160:163], 0
  s_waitcnt vmcnt(4)
  v_mul_f32 v201, s29, v193
  v_mul_f32_e64 v202, s29, v194
  v_mfma_f32_16x16x32_bf16 v[68:71], v[208:211], a[164:167], 0
  s_add_u32 m0, s30, s97
  v_exp_f32 v200, v200
  v_mfma_f32_16x16x32_bf16 v[72:75], v[208:211], a[168:171], 0
  ds_write_b128 v232, v[144:147] offset:4096
  buffer_load_dwordx4 v221, s[8:11], s33 offen offset:1024 lds
  v_mfma_f32_16x16x32_bf16 v[76:79], v[208:211], a[172:175], 0
  s_sub_u32 s30, s30, 16896
  v_mul_f32 v204, s29, v196
  v_mul_f32 v206, s29, v198
  v_mfma_f32_16x16x32_bf16 v[80:83], v[208:211], a[176:179], 0
  s_cselect_b32 s30, s31, s30
  v_mul_f32 v205, s29, v197
  v_mul_f32_e64 v207, s29, v199
  v_mfma_f32_16x16x32_bf16 v[84:87], v[208:211], a[180:183], 0
  s_add_u32 s59, s59, 8192
  v_exp_f32_e64 v207, v207
  v_mfma_f32_16x16x32_bf16 v[88:91], v[208:211], a[184:187], 0
  ds_write_b128 v232, v[148:151] offset:4352
  v_exp_f32_e64 v204, v204
  v_mfma_f32_16x16x32_bf16 v[92:95], v[208:211], a[188:191], 0
  s_xor_b32 s33, s59, s3
  v_exp_f32 v205, v205
  v_mfma_f32_16x16x32_bf16 v[192:195], a[128:131], a[96:99], v[228:231]
  v_exp_f32_e64 v201, v201
  v_mfma_f32_16x16x32_bf16 v[192:195], a[132:135], a[100:103], v[192:195]
  v_cvt_pk_bf16_f32 v212, v200, v201
  v_cvt_pk_bf16_f32 v214, v204, v205
  v_mfma_f32_16x16x32_bf16 v[192:195], a[136:139], a[104:107], v[192:195]
  ds_write_b128 v232, v[152:155] offset:4608
  v_exp_f32_e64 v206, v206
  v_mfma_f32_16x16x32_bf16 v[192:195], a[140:143], a[108:111], v[192:195]
  v_exp_f32_e64 v202, v202
  v_mfma_f32_16x16x32_bf16 v[196:199], a[144:147], a[108:111], v[228:231]
  v_exp_f32_e64 v203, v203
  v_mfma_f32_16x16x32_bf16 v[196:199], a[148:151], a[104:107], v[196:199]
  v_cvt_pk_bf16_f32 v213, v202, v203
  v_cvt_pk_bf16_f32 v215, v206, v207
  v_mfma_f32_16x16x32_bf16 v[196:199], a[152:155], a[100:103], v[196:199]
  ds_write_b128 v232, v[156:159] offset:4864
  ds_read_b64_tr_b16 a[112:113], v220 offset:4096
  ds_read_b64_tr_b16 a[114:115], v220 offset:4160
  v_mfma_f32_16x16x32_bf16 v[196:199], a[156:159], a[96:99], v[196:199]
  v_mul_f32 v200, s29, v192
  v_mul_f32 v201, s29, v193
  v_smfmac_f32_16x16x64_bf16 a[196:199], a[220:223], v[208:215], v254
  ds_read_b64_tr_b16 a[116:117], v220 offset:5120
  ds_read_b64_tr_b16 a[118:119], v220 offset:5184
  v_mfma_f32_16x16x32_bf16 v[96:99], v[212:215], a[160:163], 0
  v_mul_f32 v202, s29, v194
  v_mul_f32 v203, s29, v195
  v_mfma_f32_16x16x32_bf16 v[100:103], v[212:215], a[164:167], 0
  ds_write_b128 v232, v[128:131] offset:8192
  v_mul_f32 v204, s29, v196
  v_mul_f32 v206, s29, v198
  v_mfma_f32_16x16x32_bf16 v[104:107], v[212:215], a[168:171], 0
  v_exp_f32_e64 v200, v200
  v_mfma_f32_16x16x32_bf16 v[108:111], v[212:215], a[172:175], 0
  v_exp_f32_e64 v206, v206
  v_mfma_f32_16x16x32_bf16 v[112:115], v[212:215], a[176:179], 0
  v_mul_f32 v205, s29, v197
  v_mul_f32 v207, s29, v199
  v_mfma_f32_16x16x32_bf16 v[116:119], v[212:215], a[180:183], 0
  ds_write_b128 v232, v[132:135] offset:8448
  v_exp_f32_e64 v205, v205
  v_mfma_f32_16x16x32_bf16 v[120:123], v[212:215], a[184:187], 0
  v_exp_f32_e64 v207, v207
  v_mfma_f32_16x16x32_bf16 v[124:127], v[212:215], a[188:191], 0
  v_exp_f32_e64 v204, v204
  v_mfma_f32_16x16x32_bf16 v[192:195], a[128:131], a[64:67], v[228:231]
  v_exp_f32_e64 v202, v202
  v_mfma_f32_16x16x32_bf16 v[192:195], a[132:135], a[68:71], v[192:195]
  ds_write_b128 v232, v[136:139] offset:8704
  v_cvt_pk_bf16_f32 v210, v204, v205
  v_cvt_pk_bf16_f32 v211, v206, v207
  v_mfma_f32_16x16x32_bf16 v[192:195], a[136:139], a[72:75], v[192:195]
  v_exp_f32_e64 v201, v201
  v_mfma_f32_16x16x32_bf16 v[192:195], a[140:143], a[76:79], v[192:195]
  v_exp_f32_e64 v203, v203
  v_mfma_f32_16x16x32_bf16 v[196:199], a[144:147], a[76:79], v[228:231]
  s_waitcnt lgkmcnt(2)
  v_cvt_pk_bf16_f32 v208, v200, v201
  v_cvt_pk_bf16_f32 v209, v202, v203
  v_mfma_f32_16x16x32_bf16 v[196:199], a[148:151], a[72:75], v[196:199]
  buffer_store_dwordx4 a[116:119], v233, s[16:19], s35 offen offset:1024
  v_add_u32 v216, s30, v218
  v_add_u32_e64 v217, s30, v219
  v_mfma_f32_16x16x32_bf16 v[196:199], a[152:155], a[68:71], v[196:199]
  v_mul_f32 v202, s29, v194
  v_mul_f32 v203, s29, v195
  v_mfma_f32_16x16x32_bf16 v[196:199], a[156:159], a[64:67], v[196:199]
  v_mul_f32 v200, s29, v192
  v_mul_f32 v201, s29, v193
  v_mfma_f32_16x16x32_bf16 a[204:207], a[220:223], v[208:211], 0
  s_mov_b32 m0, s36
  v_exp_f32 v202, v202
  v_mfma_f32_16x16x32_bf16 a[224:227], v[208:211], a[160:163], 0
  buffer_load_dwordx4 v222, s[12:15], s34 offen nt lds
  v_mfma_f32_16x16x32_bf16 a[228:231], v[208:211], a[164:167], 0
  s_add_u32 s36, s36, 2048
  v_mul_f32 v206, s29, v198
  v_mul_f32 v207, s29, v199
  v_mfma_f32_16x16x32_bf16 a[232:235], v[208:211], a[168:171], 0
  v_mul_f32 v204, s29, v196
  v_mul_f32 v205, s29, v197
  v_mfma_f32_16x16x32_bf16 a[236:239], v[208:211], a[172:175], 0
  v_exp_f32_e64 v204, v204
  v_mfma_f32_16x16x32_bf16 a[240:243], v[208:211], a[176:179], 0
  ds_write_b128 v232, v[140:143] offset:8960
  buffer_load_dwordx4 v223, s[12:15], s34 offen offset:1024 nt lds
  v_mfma_f32_16x16x32_bf16 a[244:247], v[208:211], a[180:183], 0
  s_add_u32 s34, s34, 2048
  v_exp_f32_e64 v205, v205
  v_mfma_f32_16x16x32_bf16 a[248:251], v[208:211], a[184:187], 0
  v_exp_f32_e64 v200, v200
  v_mfma_f32_16x16x32_bf16 a[252:255], v[208:211], a[188:191], 0
  v_exp_f32_e64 v206, v206
  v_mfma_f32_16x16x32_bf16 v[192:195], a[128:131], a[80:83], v[228:231]
  buffer_store_dwordx4 a[112:115], v233, s[16:19], s35 offen
  ds_read_b128 a[128:131], v216 offset:0
  v_cvt_pk_bf16_f32 v210, v204, v205
  v_mfma_f32_16x16x32_bf16 v[192:195], a[132:135], a[84:87], v[192:195]
  s_add_u32 s35, s35, 2048
  v_exp_f32_e64 v203, v203
  v_mfma_f32_16x16x32_bf16 v[192:195], a[136:139], a[88:91], v[192:195]
  ds_read_b128 a[132:135], v216 offset:64
  ds_read_b128 a[136:139], v216 offset:128
  v_mfma_f32_16x16x32_bf16 v[192:195], a[140:143], a[92:95], v[192:195]
  v_exp_f32_e64 v207, v207
  v_mfma_f32_16x16x32_bf16 v[196:199], a[144:147], a[92:95], v[228:231]
  ds_read_b128 a[140:143], v216 offset:192
  ds_read_b128 a[144:147], v216 offset:704
  v_mfma_f32_16x16x32_bf16 v[196:199], a[148:151], a[88:91], v[196:199]
  v_exp_f32_e64 v201, v201
  v_mfma_f32_16x16x32_bf16 v[196:199], a[152:155], a[84:87], v[196:199]
  v_cvt_pk_bf16_f32 v208, v200, v201
  v_cvt_pk_bf16_f32 v209, v202, v203
  v_cvt_pk_bf16_f32 v211, v206, v207
  v_mfma_f32_16x16x32_bf16 v[196:199], a[156:159], a[80:83], v[196:199]
  v_mul_f32 v201, s29, v193
  v_mul_f32 v203, s29, v195
  v_mfma_f32_16x16x32_bf16 v[128:131], v[208:211], a[160:163], 0
  ds_read_b128 a[148:151], v216 offset:640
  ds_read_b128 a[152:155], v216 offset:576
  v_mfma_f32_16x16x32_bf16 v[132:135], v[208:211], a[164:167], 0
  v_mul_f32 v200, s29, v192
  v_mul_f32 v202, s29, v194
  v_mfma_f32_16x16x32_bf16 v[136:139], v[208:211], a[168:171], 0
  ds_read_b128 a[156:159], v216 offset:512
  v_mul_f32_e64 v205, s29, v197
  v_mfma_f32_16x16x32_bf16 v[140:143], v[208:211], a[172:175], 0
  v_exp_f32_e64 v200, v200
  v_mfma_f32_16x16x32_bf16 v[144:147], v[208:211], a[176:179], 0
  v_exp_f32_e64 v201, v201
  v_mfma_f32_16x16x32_bf16 v[148:151], v[208:211], a[180:183], 0
  v_exp_f32_e64 v202, v202
  v_mfma_f32_16x16x32_bf16 v[152:155], v[208:211], a[184:187], 0
  v_mul_f32 v204, s29, v196
  v_exp_f32 v203, v203
  v_mfma_f32_16x16x32_bf16 v[156:159], v[208:211], a[188:191], 0
  s_waitcnt lgkmcnt(3)
  v_mul_f32 v206, s29, v198
  v_mul_f32_e64 v207, s29, v199
  v_mfma_f32_16x16x32_bf16 v[192:195], a[128:131], a[0:3], v[228:231]
  v_exp_f32_e64 v205, v205
  v_mfma_f32_16x16x32_bf16 v[192:195], a[132:135], a[4:7], v[192:195]
  v_exp_f32_e64 v206, v206
  v_mfma_f32_16x16x32_bf16 v[192:195], a[136:139], a[8:11], v[192:195]
  v_cvt_pk_bf16_f32 v212, v200, v201
  v_cvt_pk_bf16_f32 v213, v202, v203
  v_mfma_f32_16x16x32_bf16 v[192:195], a[140:143], a[12:15], v[192:195]
  v_exp_f32_e64 v204, v204
  v_mfma_f32_16x16x32_bf16 v[196:199], a[144:147], a[12:15], v[228:231]
  s_waitcnt lgkmcnt(0)
  v_exp_f32 v207, v207
  v_mfma_f32_16x16x32_bf16 v[196:199], a[148:151], a[8:11], v[196:199]
  v_cvt_pk_bf16_f32 v214, v204, v205
  v_cvt_pk_bf16_f32 v215, v206, v207
  v_mfma_f32_16x16x32_bf16 v[196:199], a[152:155], a[4:7], v[196:199]
  v_mul_f32 v200, s29, v192
  v_mul_f32 v203, s29, v195
  v_mfma_f32_16x16x32_bf16 v[196:199], a[156:159], a[0:3], v[196:199]
  v_mul_f32 v201, s29, v193
  v_mul_f32 v202, s29, v194
  v_mfma_f32_16x16x32_bf16 v[160:163], v[212:215], a[160:163], 0
  ds_read_b64_tr_b16 a[160:161], v217 offset:8448
  ds_read_b64_tr_b16 a[162:163], v217 offset:8960
  v_mfma_f32_16x16x32_bf16 v[164:167], v[212:215], a[164:167], 0
  v_exp_f32_e64 v203, v203
  v_mfma_f32_16x16x32_bf16 v[168:171], v[212:215], a[168:171], 0
  ds_read_b64_tr_b16 a[166:167], v217 offset:8976
  ds_read_b64_tr_b16 a[170:171], v217 offset:8992
  v_mfma_f32_16x16x32_bf16 v[172:175], v[212:215], a[172:175], 0
  v_mul_f32 v204, s29, v196
  v_mul_f32 v207, s29, v199
  v_mfma_f32_16x16x32_bf16 v[176:179], v[212:215], a[176:179], 0
  ds_read_b64_tr_b16 a[168:169], v217 offset:8480
  ds_read_b64_tr_b16 a[172:173], v217 offset:8496
  v_mfma_f32_16x16x32_bf16 v[180:183], v[212:215], a[180:183], 0
  v_exp_f32_e64 v201, v201
  v_mfma_f32_16x16x32_bf16 v[184:187], v[212:215], a[184:187], 0
  ds_read_b64_tr_b16 a[164:165], v217 offset:8464
  ds_read_b64_tr_b16 a[174:175], v217 offset:9008
  v_mfma_f32_16x16x32_bf16 v[188:191], v[212:215], a[188:191], 0
  v_mul_f32 v205, s29, v197
  v_mul_f32 v206, s29, v198
  v_smfmac_f32_16x16x64_bf16 a[200:203], a[220:223], v[208:215], v254
  v_exp_f32 v200, v200
  v_exp_f32 v202, v202
  s_cmp_eq_u32 s38, 1
  s_cselect_b32 s37, 12, 14
  s_cbranch_scc1 L_pC0
  s_branch L_pA0
L_exitA:
  buffer_load_dwordx4 a[96:99], v255, s[12:15], s42 offen nt
  ds_read_b128 a[0:3], v224 offset:0
  ds_read_b128 a[4:7], v225 offset:0
  ds_read_b128 a[8:11], v226 offset:0
  ds_read_b128 a[12:15], v227 offset:0
  ds_read_b128 a[16:19], v224 offset:4096
  ds_read_b128 a[20:23], v225 offset:4096
  ds_read_b128 a[24:27], v226 offset:4096
  ds_read_b128 a[28:31], v227 offset:4096
  v_mul_f32 v206, s29, v198
  v_mul_f32 v207, s29, v199
  v_exp_f32 v204, v204
  v_exp_f32 v205, v205
  v_cvt_pk_bf16_f32 v212, v200, v201
  v_cvt_pk_bf16_f32 v213, v202, v203
  v_exp_f32 v206, v206
  v_exp_f32 v207, v207
  v_cvt_pk_bf16_f32 v214, v204, v205
  v_cvt_pk_bf16_f32 v215, v206, v207
  v_accvgpr_read_b32 v243, a194
  v_accvgpr_read_b32 v251, a195
  v_smfmac_f32_16x16x64_bf16 a[200:203], a[220:223], v[208:215], v254
  s_mov_b32 s35, s39
  v_add_f32 v243, v243, v251
  v_mfma_f32_16x16x32_bf16 v[160:163], v[212:215], a[160:163], v[160:163]
  s_mov_b32 s51, s40
  v_rcp_f32 v243, v243
  v_mfma_f32_16x16x32_bf16 v[164:167], v[212:215], a[164:167], v[164:167]
  s_mov_b32 s39, s41
  v_accvgpr_read_b32 v248, a204
  v_accvgpr_read_b32 v250, a206
  v_mfma_f32_16x16x32_bf16 v[168:171], v[212:215], a[168:171], v[168:171]
  s_mov_b32 s40, s42
  v_add_f32_e64 v248, v248, v250
  v_accvgpr_read_b32 v244, a196
  v_mfma_f32_16x16x32_bf16 v[172:175], v[212:215], a[172:175], v[172:175]
  s_add_u32 s41, s41, s43
  v_accvgpr_read_b32 v250, a197
  v_add_f32 v244, v244, v250
  v_mfma_f32_16x16x4_f32 v[208:211], v243, a121, 0
  s_add_u32 s42, s42, s44
  v_accvgpr_read_b32 v242, a192
  v_accvgpr_read_b32 v250, a193
  v_mfma_f32_16x16x32_bf16 v[176:179], v[212:215], a[176:179], v[176:179]
  s_sub_u32 s43, 434176, s43
  v_add_f32 v242, v242, v250
  v_accvgpr_read_b32 v245, a198
  v_mfma_f32_16x16x32_bf16 v[180:183], v[212:215], a[180:183], v[180:183]
  s_sub_u32 s44, 434176, s44
  v_accvgpr_read_b32 v251, a199
  v_add_f32_e64 v245, v245, v251
  v_mfma_f32_16x16x32_bf16 v[184:187], v[212:215], a[184:187], v[184:187]
  s_mov_b32 s34, s41
  v_rcp_f32 v248, v248
  v_mfma_f32_16x16x32_bf16 v[188:191], v[212:215], a[188:191], v[188:191]
  s_mov_b32 s36, s49
  v_rcp_f32 v244, v244
  v_rcp_f32 v242, v242
  v_rcp_f32_e64 v245, v245
  s_waitcnt lgkmcnt(4)
  buffer_load_dwordx4 a[100:103], v255, s[12:15], s40 offen offset:64 nt
  v_pk_mul_f32 v[32:33], v[32:33], v[208:209]
  v_pk_mul_f32 v[36:37], v[36:37], v[208:209]
  v_pk_mul_f32 v[40:41], v[40:41], v[208:209]
  v_pk_mul_f32 v[44:45], v[44:45], v[208:209]
  v_pk_mul_f32 v[48:49], v[48:49], v[208:209]
  v_pk_mul_f32 v[52:53], v[52:53], v[208:209]
  v_pk_mul_f32 v[56:57], v[56:57], v[208:209]
  v_pk_mul_f32 v[60:61], v[60:61], v[208:209]
  v_cvt_pk_bf16_f32 v200, v32, v36
  v_cvt_pk_bf16_f32 v201, v40, v44
  v_cvt_pk_bf16_f32 v202, v48, v52
  v_cvt_pk_bf16_f32 v203, v56, v60
  v_cvt_pk_bf16_f32 v204, v33, v37
  v_cvt_pk_bf16_f32 v205, v41, v45
  v_cvt_pk_bf16_f32 v206, v49, v53
  v_cvt_pk_bf16_f32 v207, v57, v61
  v_mfma_f32_16x16x4_f32 v[212:215], v248, a121, 0
  ds_read_b128 a[32:35], v224 offset:8192
  ds_read_b128 a[36:39], v225 offset:8192
  ds_write_b128 v232, v[200:203] offset:4096
  ds_write_b128 v232, v[204:207] offset:4352
  v_pk_mul_f32 v[34:35], v[34:35], v[210:211]
  v_pk_mul_f32 v[38:39], v[38:39], v[210:211]
  v_pk_mul_f32 v[42:43], v[42:43], v[210:211]
  v_pk_mul_f32 v[46:47], v[46:47], v[210:211]
  v_pk_mul_f32 v[50:51], v[50:51], v[210:211]
  v_pk_mul_f32 v[54:55], v[54:55], v[210:211]
  v_pk_mul_f32 v[58:59], v[58:59], v[210:211]
  v_pk_mul_f32 v[62:63], v[62:63], v[210:211]
  v_cvt_pk_bf16_f32 v200, v34, v38
  v_cvt_pk_bf16_f32 v201, v42, v46
  v_cvt_pk_bf16_f32 v202, v50, v54
  v_cvt_pk_bf16_f32 v203, v58, v62
  v_cvt_pk_bf16_f32 v204, v35, v39
  v_cvt_pk_bf16_f32 v205, v43, v47
  v_cvt_pk_bf16_f32 v206, v51, v55
  v_cvt_pk_bf16_f32 v207, v59, v63
  v_mfma_f32_16x16x32_bf16 v[192:195], a[128:131], a[0:3], v[228:231]
  ds_read_b128 a[40:43], v226 offset:8192
  ds_read_b128 a[44:47], v227 offset:8192
  ds_write_b128 v232, v[200:203] offset:4608
  v_mfma_f32_16x16x32_bf16 v[192:195], a[132:135], a[4:7], v[192:195]
  ds_write_b128 v232, v[204:207] offset:4864
  buffer_load_dwordx4 a[104:107], v255, s[12:15], s40 offen offset:128 nt
  v_accvgpr_read_b32 v32, a224
  v_accvgpr_read_b32 v33, a225
  v_accvgpr_read_b32 v34, a228
  v_accvgpr_read_b32 v35, a229
  v_accvgpr_read_b32 v36, a232
  v_accvgpr_read_b32 v37, a233
  v_accvgpr_read_b32 v38, a236
  v_accvgpr_read_b32 v39, a237
  v_accvgpr_read_b32 v40, a240
  v_accvgpr_read_b32 v41, a241
  v_accvgpr_read_b32 v42, a244
  v_accvgpr_read_b32 v43, a245
  v_accvgpr_read_b32 v44, a248
  v_accvgpr_read_b32 v45, a249
  v_accvgpr_read_b32 v46, a252
  v_accvgpr_read_b32 v47, a253
  v_pk_mul_f32 v[32:33], v[32:33], v[212:213]
  v_pk_mul_f32 v[34:35], v[34:35], v[212:213]
  v_pk_mul_f32 v[36:37], v[36:37], v[212:213]
  v_pk_mul_f32 v[38:39], v[38:39], v[212:213]
  v_pk_mul_f32 v[40:41], v[40:41], v[212:213]
  v_pk_mul_f32 v[42:43], v[42:43], v[212:213]
  v_pk_mul_f32 v[44:45], v[44:45], v[212:213]
  v_pk_mul_f32 v[46:47], v[46:47], v[212:213]
  v_cvt_pk_bf16_f32 v200, v32, v34
  v_cvt_pk_bf16_f32 v201, v36, v38
  v_cvt_pk_bf16_f32 v202, v40, v42
  v_cvt_pk_bf16_f32 v203, v44, v46
  v_cvt_pk_bf16_f32 v204, v33, v35
  v_cvt_pk_bf16_f32 v205, v37, v39
  v_cvt_pk_bf16_f32 v206, v41, v43
  v_cvt_pk_bf16_f32 v207, v45, v47
  v_mfma_f32_16x16x4_f32 v[208:211], v244, a121, 0
  ds_read_b64_tr_b16 a[160:161], v217 offset:8448
  ds_read_b64_tr_b16 a[162:163], v217 offset:8960
  ds_read_b64_tr_b16 a[164:165], v217 offset:8464
  ds_read_b64_tr_b16 a[166:167], v217 offset:8976
  ds_write_b128 v232, v[200:203] offset:0
  ds_write_b128 v232, v[204:207] offset:256
  v_accvgpr_read_b32 v48, a226
  v_accvgpr_read_b32 v49, a227
  v_accvgpr_read_b32 v50, a230
  v_accvgpr_read_b32 v51, a231
  v_accvgpr_read_b32 v52, a234
  v_accvgpr_read_b32 v53, a235
  v_accvgpr_read_b32 v54, a238
  v_accvgpr_read_b32 v55, a239
  v_accvgpr_read_b32 v56, a242
  v_accvgpr_read_b32 v57, a243
  v_accvgpr_read_b32 v58, a246
  v_accvgpr_read_b32 v59, a247
  v_accvgpr_read_b32 v60, a250
  v_accvgpr_read_b32 v61, a251
  v_accvgpr_read_b32 v62, a254
  v_accvgpr_read_b32 v63, a255
  v_pk_mul_f32 v[48:49], v[48:49], v[214:215]
  v_pk_mul_f32 v[50:51], v[50:51], v[214:215]
  v_pk_mul_f32 v[52:53], v[52:53], v[214:215]
  v_pk_mul_f32 v[54:55], v[54:55], v[214:215]
  v_pk_mul_f32 v[56:57], v[56:57], v[214:215]
  v_pk_mul_f32 v[58:59], v[58:59], v[214:215]
  v_pk_mul_f32 v[60:61], v[60:61], v[214:215]
  v_pk_mul_f32 v[62:63], v[62:63], v[214:215]
  v_cvt_pk_bf16_f32 v200, v48, v50
  v_cvt_pk_bf16_f32 v201, v52, v54
  v_cvt_pk_bf16_f32 v202, v56, v58
  v_cvt_pk_bf16_f32 v203, v60, v62
  v_cvt_pk_bf16_f32 v204, v49, v51
  v_cvt_pk_bf16_f32 v205, v53, v55
  v_cvt_pk_bf16_f32 v206, v57, v59
  v_cvt_pk_bf16_f32 v207, v61, v63
  v_mfma_f32_16x16x32_bf16 v[192:195], a[136:139], a[8:11], v[192:195]
  ds_read_b64_tr_b16 a[168:169], v217 offset:8480
  ds_read_b64_tr_b16 a[170:171], v217 offset:8992
  ds_read_b64_tr_b16 a[172:173], v217 offset:8496
  ds_read_b64_tr_b16 a[174:175], v217 offset:9008
  ds_write_b128 v232, v[200:203] offset:512
  ds_write_b128 v232, v[204:207] offset:768
  buffer_load_dwordx4 a[108:111], v255, s[12:15], s40 offen offset:192 nt
  s_sub_u32 s38, s38, 1
  s_cmp_eq_u32 s38, 1
  s_cselect_b32 s14, 0, s14
  v_pk_mul_f32 v[64:65], v[64:65], v[208:209]
  v_pk_mul_f32 v[68:69], v[68:69], v[208:209]
  v_pk_mul_f32 v[72:73], v[72:73], v[208:209]
  v_pk_mul_f32 v[76:77], v[76:77], v[208:209]
  v_pk_mul_f32 v[80:81], v[80:81], v[208:209]
  v_pk_mul_f32 v[84:85], v[84:85], v[208:209]
  v_pk_mul_f32 v[88:89], v[88:89], v[208:209]
  v_pk_mul_f32 v[92:93], v[92:93], v[208:209]
  v_cvt_pk_bf16_f32 v200, v64, v68
  v_cvt_pk_bf16_f32 v201, v72, v76
  v_cvt_pk_bf16_f32 v202, v80, v84
  v_cvt_pk_bf16_f32 v203, v88, v92
  v_cvt_pk_bf16_f32 v204, v65, v69
  v_cvt_pk_bf16_f32 v205, v73, v77
  v_cvt_pk_bf16_f32 v206, v81, v85
  v_cvt_pk_bf16_f32 v207, v89, v93
  v_mfma_f32_16x16x4_f32 v[212:215], v242, a121, 0
  ds_read_b64_tr_b16 v[32:33], v235 offset:0
  ds_read_b64_tr_b16 v[34:35], v235 offset:64
  ds_read_b64_tr_b16 v[36:37], v235 offset:1024
  ds_read_b64_tr_b16 v[38:39], v235 offset:1088
  ds_write_b128 v232, v[200:203] offset:8192
  ds_write_b128 v232, v[204:207] offset:8448
  v_pk_mul_f32 v[66:67], v[66:67], v[210:211]
  v_pk_mul_f32 v[70:71], v[70:71], v[210:211]
  v_pk_mul_f32 v[74:75], v[74:75], v[210:211]
  v_pk_mul_f32 v[78:79], v[78:79], v[210:211]
  v_pk_mul_f32 v[82:83], v[82:83], v[210:211]
  v_pk_mul_f32 v[86:87], v[86:87], v[210:211]
  v_pk_mul_f32 v[90:91], v[90:91], v[210:211]
  v_pk_mul_f32 v[94:95], v[94:95], v[210:211]
  v_cvt_pk_bf16_f32 v200, v66, v70
  v_cvt_pk_bf16_f32 v201, v74, v78
  v_cvt_pk_bf16_f32 v202, v82, v86
  v_cvt_pk_bf16_f32 v203, v90, v94
  v_cvt_pk_bf16_f32 v204, v67, v71
  v_cvt_pk_bf16_f32 v205, v75, v79
  v_cvt_pk_bf16_f32 v206, v83, v87
  v_cvt_pk_bf16_f32 v207, v91, v95
  v_mfma_f32_16x16x32_bf16 v[192:195], a[140:143], a[12:15], v[192:195]
  ds_read_b64_tr_b16 v[40:41], v235 offset:2048
  ds_read_b64_tr_b16 v[42:43], v235 offset:2112
  ds_read_b64_tr_b16 v[44:45], v235 offset:3072
  ds_read_b64_tr_b16 v[46:47], v235 offset:3136
  ds_write_b128 v232, v[200:203] offset:8704
  ds_write_b128 v232, v[204:207] offset:8960
  v_accvgpr_read_b32 v246, a200
  v_accvgpr_read_b32 v250, a201
  v_add_f32 v246, v246, v250
  v_accvgpr_read_b32 v247, a202
  v_accvgpr_read_b32 v251, a203
  v_add_f32 v247, v247, v251
  v_rcp_f32 v246, v246
  v_rcp_f32 v247, v247
  v_subrev_u32 v220, s98, v235
  v_pk_mul_f32 v[0:1], v[0:1], v[212:213]
  v_pk_mul_f32 v[4:5], v[4:5], v[212:213]
  v_pk_mul_f32 v[8:9], v[8:9], v[212:213]
  v_pk_mul_f32 v[12:13], v[12:13], v[212:213]
  v_pk_mul_f32 v[16:17], v[16:17], v[212:213]
  v_pk_mul_f32 v[20:21], v[20:21], v[212:213]
  v_pk_mul_f32 v[24:25], v[24:25], v[212:213]
  v_pk_mul_f32 v[28:29], v[28:29], v[212:213]
  v_cvt_pk_bf16_f32 v200, v0, v4
  v_cvt_pk_bf16_f32 v201, v8, v12
  v_cvt_pk_bf16_f32 v202, v16, v20
  v_cvt_pk_bf16_f32 v203, v24, v28
  v_cvt_pk_bf16_f32 v204, v1, v5
  v_cvt_pk_bf16_f32 v205, v9, v13
  v_cvt_pk_bf16_f32 v206, v17, v21
  v_cvt_pk_bf16_f32 v207, v25, v29
  v_mfma_f32_16x16x4_f32 v[208:211], v245, a121, 0
  ds_read_b128 a[48:51], v224 offset:12288
  ds_read_b128 a[52:55], v225 offset:12288
  ds_write_b128 v232, v[200:203] offset:0
  ds_write_b128 v232, v[204:207] offset:256
  s_waitcnt lgkmcnt(6)
  buffer_store_dwordx4 v[32:35], v233, s[16:19], s51 offen
  v_pk_mul_f32 v[2:3], v[2:3], v[214:215]
  v_pk_mul_f32 v[6:7], v[6:7], v[214:215]
  v_pk_mul_f32 v[10:11], v[10:11], v[214:215]
  v_pk_mul_f32 v[14:15], v[14:15], v[214:215]
  v_pk_mul_f32 v[18:19], v[18:19], v[214:215]
  v_pk_mul_f32 v[22:23], v[22:23], v[214:215]
  v_pk_mul_f32 v[26:27], v[26:27], v[214:215]
  v_pk_mul_f32 v[30:31], v[30:31], v[214:215]
  v_cvt_pk_bf16_f32 v200, v2, v6
  v_cvt_pk_bf16_f32 v201, v10, v14
  v_cvt_pk_bf16_f32 v202, v18, v22
  v_cvt_pk_bf16_f32 v203, v26, v30
  v_cvt_pk_bf16_f32 v204, v3, v7
  v_cvt_pk_bf16_f32 v205, v11, v15
  v_cvt_pk_bf16_f32 v206, v19, v23
  v_cvt_pk_bf16_f32 v207, v27, v31
  v_mfma_f32_16x16x32_bf16 v[196:199], a[144:147], a[12:15], v[228:231]
  ds_read_b128 a[56:59], v226 offset:12288
  ds_read_b128 a[60:63], v227 offset:12288
  ds_write_b128 v232, v[200:203] offset:512
  ds_write_b128 v232, v[204:207] offset:768
  buffer_store_dwordx4 v[36:39], v233, s[16:19], s51 offen offset:1024
  v_pk_mul_f32 v[96:97], v[96:97], v[208:209]
  v_pk_mul_f32 v[100:101], v[100:101], v[208:209]
  v_pk_mul_f32 v[104:105], v[104:105], v[208:209]
  v_pk_mul_f32 v[108:109], v[108:109], v[208:209]
  v_pk_mul_f32 v[112:113], v[112:113], v[208:209]
  v_pk_mul_f32 v[116:117], v[116:117], v[208:209]
  v_pk_mul_f32 v[120:121], v[120:121], v[208:209]
  v_pk_mul_f32 v[124:125], v[124:125], v[208:209]
  v_cvt_pk_bf16_f32 v200, v96, v100
  v_cvt_pk_bf16_f32 v201, v104, v108
  v_cvt_pk_bf16_f32 v202, v112, v116
  v_cvt_pk_bf16_f32 v203, v120, v124
  v_cvt_pk_bf16_f32 v204, v97, v101
  v_cvt_pk_bf16_f32 v205, v105, v109
  v_cvt_pk_bf16_f32 v206, v113, v117
  v_cvt_pk_bf16_f32 v207, v121, v125
  v_mfma_f32_16x16x4_f32 v[212:215], v246, a121, 0
  s_waitcnt vmcnt(14)
  ds_read_b128 a[64:67], v224 offset:16384
  ds_read_b128 a[68:71], v225 offset:16384
  ds_write_b128 v232, v[200:203] offset:12288
  ds_write_b128 v232, v[204:207] offset:12544
  buffer_store_dwordx4 v[40:43], v233, s[16:19], s51 offen offset:2048
  v_pk_mul_f32 v[98:99], v[98:99], v[210:211]
  v_pk_mul_f32 v[102:103], v[102:103], v[210:211]
  v_pk_mul_f32 v[106:107], v[106:107], v[210:211]
  v_pk_mul_f32 v[110:111], v[110:111], v[210:211]
  v_pk_mul_f32 v[114:115], v[114:115], v[210:211]
  v_pk_mul_f32 v[118:119], v[118:119], v[210:211]
  v_pk_mul_f32 v[122:123], v[122:123], v[210:211]
  v_pk_mul_f32 v[126:127], v[126:127], v[210:211]
  v_cvt_pk_bf16_f32 v200, v98, v102
  v_cvt_pk_bf16_f32 v201, v106, v110
  v_cvt_pk_bf16_f32 v202, v114, v118
  v_cvt_pk_bf16_f32 v203, v122, v126
  v_cvt_pk_bf16_f32 v204, v99, v103
  v_cvt_pk_bf16_f32 v205, v107, v111
  v_cvt_pk_bf16_f32 v206, v115, v119
  v_cvt_pk_bf16_f32 v207, v123, v127
  v_mfma_f32_16x16x32_bf16 v[196:199], a[148:151], a[8:11], v[196:199]
  ds_read_b128 a[72:75], v226 offset:16384
  ds_read_b128 a[76:79], v227 offset:16384
  ds_write_b128 v232, v[200:203] offset:12800
  ds_write_b128 v232, v[204:207] offset:13056
  buffer_store_dwordx4 v[44:47], v233, s[16:19], s51 offen offset:3072
  v_mfma_f32_16x16x32_bf16 a[224:227], a[124:127], a[124:127], 0
  v_max3_u32 v250, v242, v243, v244
  v_min3_u32 v251, v242, v243, v244
  v_mfma_f32_16x16x32_bf16 a[228:231], a[124:127], a[124:127], 0
  v_max3_u32 v250, v250, v245, v246
  v_min3_u32 v251, v251, v245, v246
  v_mfma_f32_16x16x32_bf16 a[232:235], a[124:127], a[124:127], 0
  v_max_u32 v250, v250, v247
  v_min_u32 v251, v251, v247
  v_mfma_f32_16x16x32_bf16 a[236:239], a[124:127], a[124:127], 0
  v_cmp_lt_u32 s[20:21], s54, v250
  v_cmp_gt_u32 s[22:23], s53, v251
  v_cmp_lt_u32 s[24:25], s54, v248
  v_cmp_gt_u32 s[26:27], s53, v248
  v_pk_mul_f32 v[128:129], v[128:129], v[212:213]
  v_pk_mul_f32 v[132:133], v[132:133], v[212:213]
  v_pk_mul_f32 v[136:137], v[136:137], v[212:213]
  v_pk_mul_f32 v[140:141], v[140:141], v[212:213]
  v_pk_mul_f32 v[144:145], v[144:145], v[212:213]
  v_pk_mul_f32 v[148:149], v[148:149], v[212:213]
  v_pk_mul_f32 v[152:153], v[152:153], v[212:213]
  v_pk_mul_f32 v[156:157], v[156:157], v[212:213]
  v_cvt_pk_bf16_f32 v200, v128, v132
  v_cvt_pk_bf16_f32 v201, v136, v140
  v_cvt_pk_bf16_f32 v202, v144, v148
  v_cvt_pk_bf16_f32 v203, v152, v156
  v_cvt_pk_bf16_f32 v204, v129, v133
  v_cvt_pk_bf16_f32 v205, v137, v141
  v_cvt_pk_bf16_f32 v206, v145, v149
  v_cvt_pk_bf16_f32 v207, v153, v157
  v_mfma_f32_16x16x4_f32 v[208:211], v247, a121, 0
  ds_write_b128 v232, v[200:203] offset:16384
  ds_write_b128 v232, v[204:207] offset:16640
  v_pk_mul_f32 v[130:131], v[130:131], v[214:215]
  v_pk_mul_f32 v[134:135], v[134:135], v[214:215]
  v_pk_mul_f32 v[138:139], v[138:139], v[214:215]
  v_pk_mul_f32 v[142:143], v[142:143], v[214:215]
  v_pk_mul_f32 v[146:147], v[146:147], v[214:215]
  v_pk_mul_f32 v[150:151], v[150:151], v[214:215]
  v_pk_mul_f32 v[154:155], v[154:155], v[214:215]
  v_pk_mul_f32 v[158:159], v[158:159], v[214:215]
  v_cvt_pk_bf16_f32 v200, v130, v134
  v_cvt_pk_bf16_f32 v201, v138, v142
  v_cvt_pk_bf16_f32 v202, v146, v150
  v_cvt_pk_bf16_f32 v203, v154, v158
  v_cvt_pk_bf16_f32 v204, v131, v135
  v_cvt_pk_bf16_f32 v205, v139, v143
  v_cvt_pk_bf16_f32 v206, v147, v151
  v_cvt_pk_bf16_f32 v207, v155, v159
  v_mfma_f32_16x16x32_bf16 v[196:199], a[152:155], a[4:7], v[196:199]
  s_waitcnt vmcnt(8)
  ds_read_b128 a[80:83], v224 offset:20480
  ds_read_b128 a[84:87], v225 offset:20480
  ds_write_b128 v232, v[200:203] offset:16896
  ds_write_b128 v232, v[204:207] offset:17152
  v_pk_mul_f32 v[160:161], v[160:161], v[208:209]
  v_pk_mul_f32 v[164:165], v[164:165], v[208:209]
  v_pk_mul_f32 v[168:169], v[168:169], v[208:209]
  v_pk_mul_f32 v[172:173], v[172:173], v[208:209]
  v_pk_mul_f32 v[176:177], v[176:177], v[208:209]
  v_pk_mul_f32 v[180:181], v[180:181], v[208:209]
  v_pk_mul_f32 v[184:185], v[184:185], v[208:209]
  v_pk_mul_f32 v[188:189], v[188:189], v[208:209]
  v_cvt_pk_bf16_f32 v200, v160, v164
  v_cvt_pk_bf16_f32 v201, v168, v172
  v_cvt_pk_bf16_f32 v202, v176, v180
  v_cvt_pk_bf16_f32 v203, v184, v188
  v_cvt_pk_bf16_f32 v204, v161, v165
  v_cvt_pk_bf16_f32 v205, v169, v173
  v_cvt_pk_bf16_f32 v206, v177, v181
  v_cvt_pk_bf16_f32 v207, v185, v189
  v_mfma_f32_16x16x32_bf16 v[196:199], a[156:159], a[0:3], v[196:199]
  ds_read_b128 a[88:91], v226 offset:20480
  ds_read_b128 a[92:95], v227 offset:20480
  ds_write_b128 v232, v[200:203] offset:20480
  ds_write_b128 v232, v[204:207] offset:20736
  v_pk_mul_f32 v[162:163], v[162:163], v[210:211]
  v_pk_mul_f32 v[166:167], v[166:167], v[210:211]
  v_pk_mul_f32 v[170:171], v[170:171], v[210:211]
  v_pk_mul_f32 v[174:175], v[174:175], v[210:211]
  v_pk_mul_f32 v[178:179], v[178:179], v[210:211]
  v_pk_mul_f32 v[182:183], v[182:183], v[210:211]
  v_pk_mul_f32 v[186:187], v[186:187], v[210:211]
  v_pk_mul_f32 v[190:191], v[190:191], v[210:211]
  v_cvt_pk_bf16_f32 v200, v162, v166
  v_cvt_pk_bf16_f32 v201, v170, v174
  v_cvt_pk_bf16_f32 v202, v178, v182
  v_cvt_pk_bf16_f32 v203, v186, v190
  v_cvt_pk_bf16_f32 v204, v163, v167
  v_cvt_pk_bf16_f32 v205, v171, v175
  v_cvt_pk_bf16_f32 v206, v179, v183
  v_cvt_pk_bf16_f32 v207, v187, v191
  ds_write_b128 v232, v[200:203] offset:20992
  ds_write_b128 v232, v[204:207] offset:21248
  s_or_b64 s[20:21], s[20:21], s[22:23]
  s_addc_u32 s48, s48, s48
  s_or_b64 s[24:25], s[24:25], s[26:27]
  s_addc_u32 s48, s48, s48
L_headB:
  v_mfma_f32_16x16x32_bf16 a[240:243], a[124:127], a[124:127], 0
  s_mov_b32 s37, 14
  v_mul_f32 v200, s29, v192
  v_mul_f32 v201, s29, v193
  v_mfma_f32_16x16x32_bf16 a[244:247], a[124:127], a[124:127], 0
  v_exp_f32_e64 v200, v200
  v_mfma_f32_16x16x32_bf16 a[248:251], a[124:127], a[124:127], 0
  v_exp_f32_e64 v201, v201
  v_mfma_f32_16x16x32_bf16 a[252:255], a[124:127], a[124:127], 0
  v_mul_f32 v202, s29, v194
  v_mul_f32 v203, s29, v195
  v_mfma_f32_16x16x32_bf16 a[204:207], a[124:127], a[124:127], 0
  v_exp_f32_e64 v202, v202
  v_mfma_f32_16x16x32_bf16 a[192:195], a[124:127], a[124:127], 0
  v_mul_f32 v204, s29, v196
  v_mul_f32 v205, s29, v197
  v_mfma_f32_16x16x32_bf16 a[196:199], a[124:127], a[124:127], 0
  v_exp_f32_e64 v203, v203
  v_mfma_f32_16x16x32_bf16 a[200:203], a[124:127], a[124:127], 0
  v_mul_f32 v206, s29, v198
  v_mul_f32 v207, s29, v199
  s_cmp_lg_u32 s28, 0
  s_cbranch_scc1 L_selB
  v_mfma_f32_16x16x32_bf16 v[192:195], a[128:131], a[16:19], v[228:231]
  v_exp_f32_e64 v204, v204
  v_mfma_f32_16x16x32_bf16 v[192:195], a[132:135], a[20:23], v[192:195]
  ds_read_b64_tr_b16 a[176:177], v217 offset:8512
  ds_read_b64_tr_b16 a[178:179], v217 offset:9024
  v_mfma_f32_16x16x32_bf16 v[192:195], a[136:139], a[24:27], v[192:195]
  v_exp_f32_e64 v206, v206
  v_mfma_f32_16x16x32_bf16 v[192:195], a[140:143], a[28:31], v[192:195]
  v_exp_f32_e64 v207, v207
  v_mfma_f32_16x16x32_bf16 v[196:199], a[144:147], a[28:31], v[228:231]
  s_waitcnt lgkmcnt(2)
  v_exp_f32 v205, v205
  v_mfma_f32_16x16x32_bf16 v[196:199], a[148:151], a[24:27], v[196:199]
  ds_read_b64_tr_b16 a[182:183], v217 offset:9040
  v_cvt_pk_bf16_f32 v210, v204, v205
  v_mfma_f32_16x16x32_bf16 v[196:199], a[152:155], a[20:23], v[196:199]
  ds_read_b64_tr_b16 a[180:181], v217 offset:8528
  v_cvt_pk_bf16_f32 v208, v200, v201
  v_cvt_pk_bf16_f32 v209, v202, v203
  v_cvt_pk_bf16_f32 v211, v206, v207
  v_mfma_f32_16x16x32_bf16 v[196:199], a[156:159], a[16:19], v[196:199]
  ds_read_b64_tr_b16 a[184:185], v217 offset:8544
  ds_read_b64_tr_b16 a[186:187], v217 offset:9056
  v_mfma_f32_16x16x32_bf16 v[0:3], v[208:211], a[160:163], 0
  ds_read_b64_tr_b16 a[188:189], v217 offset:8560
  ds_read_b64_tr_b16 a[190:191], v217 offset:9072
  v_mfma_f32_16x16x32_bf16 v[4:7], v[208:211], a[164:167], 0
  v_mul_f32 v200, s29, v192
  v_mul_f32 v201, s29, v193
  v_mfma_f32_16x16x32_bf16 v[8:11], v[208:211], a[168:171], 0
  v_mul_f32 v202, s29, v194
  v_mul_f32 v203, s29, v195
  v_mfma_f32_16x16x32_bf16 v[12:15], v[208:211], a[172:175], 0
  s_waitcnt lgkmcnt(6)
  v_mul_f32 v206, s29, v198
  v_mul_f32_e64 v207, s29, v199
  v_mfma_f32_16x16x32_bf16 v[16:19], v[208:211], a[176:179], 0
  s_waitcnt lgkmcnt(4)
  v_mul_f32 v204, s29, v196
  v_mul_f32_e64 v205, s29, v197
  v_mfma_f32_16x16x32_bf16 v[20:23], v[208:211], a[180:183], 0
  s_waitcnt lgkmcnt(2)
  v_exp_f32 v202, v202
  v_mfma_f32_16x16x32_bf16 v[24:27], v[208:211], a[184:187], 0
  s_waitcnt lgkmcnt(0)
  v_exp_f32 v206, v206
  v_mfma_f32_16x16x32_bf16 v[28:31], v[208:211], a[188:191], 0
  v_exp_f32_e64 v201, v201
  v_mfma_f32_16x16x32_bf16 v[192:195], a[128:131], a[32:35], v[228:231]
  v_exp_f32_e64 v200, v200
  v_mfma_f32_16x16x32_bf16 v[192:195], a[132:135], a[36:39], v[192:195]
  v_exp_f32_e64 v205, v205
  v_mfma_f32_16x16x32_bf16 v[192:195], a[136:139], a[40:43], v[192:195]
  v_exp_f32_e64 v203, v203
  v_mfma_f32_16x16x32_bf16 v[192:195], a[140:143], a[44:47], v[192:195]
  v_exp_f32_e64 v204, v204
  v_mfma_f32_16x16x32_bf16 v[196:199], a[144:147], a[44:47], v[228:231]
  v_exp_f32_e64 v207, v207
  v_mfma_f32_16x16x32_bf16 v[196:199], a[148:151], a[40:43], v[196:199]
  v_cvt_pk_bf16_f32 v212, v200, v201
  v_cvt_pk_bf16_f32 v214, v204, v205
  v_mfma_f32_16x16x32_bf16 v[196:199], a[152:155], a[36:39], v[196:199]
  v_cvt_pk_bf16_f32 v213, v202, v203
  v_cvt_pk_bf16_f32 v215, v206, v207
  v_mfma_f32_16x16x32_bf16 v[196:199], a[156:159], a[32:35], v[196:199]
  v_mul_f32 v201, s29, v193
  v_mul_f32 v203, s29, v195
  v_smfmac_f32_16x16x64_bf16 a[192:195], a[220:223], v[208:215], v254
  v_mul_f32_e64 v202, s29, v194
  v_mfma_f32_16x16x32_bf16 v[32:35], v[212:215], a[160:163], 0
  v_mul_f32_e64 v200, s29, v192
  v_add_u32 v220, 6144, v220
  v_mfma_f32_16x16x32_bf16 v[36:39], v[212:215], a[164:167], 0
  v_mul_f32 v206, s29, v198
  v_mul_f32 v207, s29, v199
  v_mfma_f32_16x16x32_bf16 v[40:43], v[212:215], a[168:171], 0
  v_mul_f32 v204, s29, v196
  v_mul_f32 v205, s29, v197
  v_mfma_f32_16x16x32_bf16 v[44:47], v[212:215], a[172:175], 0
  v_exp_f32_e64 v204, v204
  v_mfma_f32_16x16x32_bf16 v[48:51], v[212:215], a[176:179], 0
  v_exp_f32_e64 v201, v201
  v_mfma_f32_16x16x32_bf16 v[52:55], v[212:215], a[180:183], 0
  v_exp_f32_e64 v206, v206
  v_mfma_f32_16x16x32_bf16 v[56:59], v[212:215], a[184:187], 0
  s_barrier
  v_mfma_f32_16x16x32_bf16 v[60:63], v[212:215], a[188:191], 0
  v_exp_f32 v203, v203
  v_mfma_f32_16x16x32_bf16 v[192:195], a[128:131], a[48:51], v[228:231]
  v_exp_f32_e64 v207, v207
  v_mfma_f32_16x16x32_bf16 v[192:195], a[132:135], a[52:55], v[192:195]
  v_exp_f32_e64 v202, v202
  v_mfma_f32_16x16x32_bf16 v[192:195], a[136:139], a[56:59], v[192:195]
  v_exp_f32_e64 v205, v205
  v_mfma_f32_16x16x32_bf16 v[192:195], a[140:143], a[60:63], v[192:195]
  v_exp_f32_e64 v200, v200
  v_mfma_f32_16x16x32_bf16 v[196:199], a[144:147], a[60:63], v[228:231]
  v_cvt_pk_bf16_f32 v208, v200, v201
  v_cvt_pk_bf16_f32 v211, v206, v207
  v_mfma_f32_16x16x32_bf16 v[196:199], a[148:151], a[56:59], v[196:199]
  s_mov_b32 m0, s30
  v_cvt_pk_bf16_f32 v209, v202, v203
  v_cvt_pk_bf16_f32 v210, v204, v205
  v_mfma_f32_16x16x32_bf16 v[196:199], a[152:155], a[52:55], v[196:199]
  buffer_load_dwordx4 v221, s[4:7], s33 offen lds
  v_mfma_f32_16x16x32_bf16 v[196:199], a[156:159], a[48:51], v[196:199]
  v_mul_f32 v200, s29, v192
  v_mul_f32_e64 v202, s29, v194
  v_mfma_f32_16x16x32_bf16 v[64:67], v[208:211], a[160:163], 0
  s_add_u32 m0, s30, 32
  v_mul_f32 v201, s29, v193
  v_mul_f32_e64 v203, s29, v195
  v_mfma_f32_16x16x32_bf16 v[68:71], v[208:211], a[164:167], 0
  buffer_load_dwordx4 v221, s[4:7], s33 offen offset:1024 lds
  v_mfma_f32_16x16x32_bf16 v[72:75], v[208:211], a[168:171], 0
  v_mul_f32 v205, s29, v197
  v_mul_f32 v207, s29, v199
  v_mfma_f32_16x16x32_bf16 v[76:79], v[208:211], a[172:175], 0
  v_mul_f32 v204, s29, v196
  v_mul_f32 v206, s29, v198
  v_mfma_f32_16x16x32_bf16 v[80:83], v[208:211], a[176:179], 0
  v_exp_f32_e64 v207, v207
  v_mfma_f32_16x16x32_bf16 v[84:87], v[208:211], a[180:183], 0
  v_exp_f32_e64 v204, v204
  v_mfma_f32_16x16x32_bf16 v[88:91], v[208:211], a[184:187], 0
  v_exp_f32_e64 v205, v205
  v_mfma_f32_16x16x32_bf16 v[92:95], v[208:211], a[188:191], 0
  s_waitcnt vmcnt(6)
  v_exp_f32 v206, v206
  v_mfma_f32_16x16x32_bf16 v[192:195], a[128:131], a[96:99], v[228:231]
  v_exp_f32_e64 v202, v202
  v_mfma_f32_16x16x32_bf16 v[192:195], a[132:135], a[100:103], v[192:195]
  v_exp_f32_e64 v203, v203
  v_mfma_f32_16x16x32_bf16 v[192:195], a[136:139], a[104:107], v[192:195]
  v_exp_f32_e64 v201, v201
  v_mfma_f32_16x16x32_bf16 v[192:195], a[140:143], a[108:111], v[192:195]
  v_exp_f32_e64 v200, v200
  v_mfma_f32_16x16x32_bf16 v[196:199], a[144:147], a[108:111], v[228:231]
  s_add_u32 m0, s30, s96
  v_cvt_pk_bf16_f32 v212, v200, v201
  v_cvt_pk_bf16_f32 v214, v204, v205
  v_mfma_f32_16x16x32_bf16 v[196:199], a[148:151], a[104:107], v[196:199]
  buffer_load_dwordx4 v221, s[8:11], s33 offen lds
  v_mfma_f32_16x16x32_bf16 v[196:199], a[152:155], a[100:103], v[196:199]
  v_cvt_pk_bf16_f32 v213, v202, v203
  v_cvt_pk_bf16_f32 v215, v206, v207
  v_mfma_f32_16x16x32_bf16 v[196:199], a[156:159], a[96:99], v[196:199]
  s_add_u32 m0, s30, s97
  v_mul_f32 v200, s29, v192
  v_mul_f32 v202, s29, v194
  v_smfmac_f32_16x16x64_bf16 a[196:199], a[220:223], v[208:215], v254
  buffer_load_dwordx4 v221, s[8:11], s33 offen offset:1024 lds
  v_mfma_f32_16x16x32_bf16 v[96:99], v[212:215], a[160:163], 0
  s_sub_u32 s30, s30, 16896
  v_mul_f32 v201, s29, v193
  v_mul_f32 v203, s29, v195
  v_mfma_f32_16x16x32_bf16 v[100:103], v[212:215], a[164:167], 0
  s_cselect_b32 s30, s31, s30
  v_mul_f32 v205, s29, v197
  v_mul_f32_e64 v207, s29, v199
  v_mfma_f32_16x16x32_bf16 v[104:107], v[212:215], a[168:171], 0
  s_add_u32 s59, s59, 8192
  v_mul_f32 v204, s29, v196
  v_mul_f32 v206, s29, v198
  v_mfma_f32_16x16x32_bf16 v[108:111], v[212:215], a[172:175], 0
  s_xor_b32 s33, s59, s3
  v_exp_f32 v200, v200
  v_mfma_f32_16x16x32_bf16 v[112:115], v[212:215], a[176:179], 0
  v_exp_f32_e64 v204, v204
  v_mfma_f32_16x16x32_bf16 v[116:119], v[212:215], a[180:183], 0
  v_exp_f32_e64 v201, v201
  v_mfma_f32_16x16x32_bf16 v[120:123], v[212:215], a[184:187], 0
  v_exp_f32_e64 v203, v203
  v_mfma_f32_16x16x32_bf16 v[124:127], v[212:215], a[188:191], 0
  v_exp_f32_e64 v202, v202
  v_mfma_f32_16x16x32_bf16 v[192:195], a[128:131], a[64:67], v[228:231]
  v_exp_f32_e64 v205, v205
  v_mfma_f32_16x16x32_bf16 v[192:195], a[132:135], a[68:71], v[192:195]
  v_exp_f32_e64 v206, v206
  v_mfma_f32_16x16x32_bf16 v[192:195], a[136:139], a[72:75], v[192:195]
  v_exp_f32_e64 v207, v207
  v_mfma_f32_16x16x32_bf16 v[192:195], a[140:143], a[76:79], v[192:195]
  v_cvt_pk_bf16_f32 v208, v200, v201
  v_cvt_pk_bf16_f32 v209, v202, v203
  v_mfma_f32_16x16x32_bf16 v[196:199], a[144:147], a[76:79], v[228:231]
  v_cvt_pk_bf16_f32 v210, v204, v205
  v_cvt_pk_bf16_f32 v211, v206, v207
  v_mfma_f32_16x16x32_bf16 v[196:199], a[148:151], a[72:75], v[196:199]
  global_load_dword a120, v[252:253], off
  v_mfma_f32_16x16x32_bf16 v[196:199], a[152:155], a[68:71], v[196:199]
  v_mul_f32 v200, s29, v192
  v_mul_f32 v203, s29, v195
  v_mfma_f32_16x16x32_bf16 v[196:199], a[156:159], a[64:67], v[196:199]
  v_mul_f32 v201, s29, v193
  v_mul_f32 v202, s29, v194
  v_mfma_f32_16x16x32_bf16 a[204:207], a[220:223], v[208:211], a[204:207]
  v_exp_f32_e64 v202, v202
  v_mfma_f32_16x16x32_bf16 a[224:227], v[208:211], a[160:163], a[224:227]
  v_exp_f32_e64 v203, v203
  v_mfma_f32_16x16x32_bf16 a[228:231], v[208:211], a[164:167], a[228:231]
  v_mul_f32 v205, s29, v197
  v_mul_f32 v206, s29, v198
  v_mfma_f32_16x16x32_bf16 a[232:235], v[208:211], a[168:171], a[232:235]
  v_mul_f32 v204, s29, v196
  v_mul_f32 v207, s29, v199
  v_mfma_f32_16x16x32_bf16 a[236:239], v[208:211], a[172:175], a[236:239]
  v_exp_f32_e64 v205, v205
  v_mfma_f32_16x16x32_bf16 a[240:243], v[208:211], a[176:179], a[240:243]
  v_exp_f32_e64 v204, v204
  v_mfma_f32_16x16x32_bf16 a[244:247], v[208:211], a[180:183], a[244:247]
  v_exp_f32_e64 v200, v200
  v_mfma_f32_16x16x32_bf16 a[248:251], v[208:211], a[184:187], a[248:251]
  v_exp_f32_e64 v206, v206
  v_mfma_f32_16x16x32_bf16 a[252:255], v[208:211], a[188:191], a[252:255]
  v_exp_f32_e64 v207, v207
  v_mfma_f32_16x16x32_bf16 v[192:195], a[128:131], a[80:83], v[228:231]
  v_exp_f32_e64 v201, v201
  v_mfma_f32_16x16x32_bf16 v[192:195], a[132:135], a[84:87], v[192:195]
  v_cvt_pk_bf16_f32 v210, v204, v205
  v_cvt_pk_bf16_f32 v211, v206, v207
  v_mfma_f32_16x16x32_bf16 v[192:195], a[136:139], a[88:91], v[192:195]
  v_cvt_pk_bf16_f32 v208, v200, v201
  v_cvt_pk_bf16_f32 v209, v202, v203
  v_mfma_f32_16x16x32_bf16 v[192:195], a[140:143], a[92:95], v[192:195]
  v_add_u32 v216, s30, v218
  v_add_u32 v217, s30, v219
  v_mfma_f32_16x16x32_bf16 v[196:199], a[144:147], a[92:95], v[228:231]
  ds_read_b128 a[128:131], v216 offset:0
  ds_read_b128 a[132:135], v216 offset:64
  v_mfma_f32_16x16x32_bf16 v[196:199], a[148:151], a[88:91], v[196:199]
  ds_read_b128 a[136:139], v216 offset:128
  ds_read_b128 a[140:143], v216 offset:192
  v_mfma_f32_16x16x32_bf16 v[196:199], a[152:155], a[84:87], v[196:199]
  v_mul_f32 v201, s29, v193
  v_mul_f32 v202, s29, v194
  v_mfma_f32_16x16x32_bf16 v[196:199], a[156:159], a[80:83], v[196:199]
  ds_read_b128 a[144:147], v216 offset:704
  v_mul_f32_e64 v203, s29, v195
  v_mfma_f32_16x16x32_bf16 v[128:131], v[208:211], a[160:163], 0
  ds_read_b128 a[152:155], v216 offset:576
  v_mul_f32_e64 v200, s29, v192
  v_mfma_f32_16x16x32_bf16 v[132:135], v[208:211], a[164:167], 0
  ds_read_b128 a[148:151], v216 offset:640
  ds_read_b128 a[156:159], v216 offset:512
  v_mfma_f32_16x16x32_bf16 v[136:139], v[208:211], a[168:171], 0
  v_exp_f32_e64 v203, v203
  v_mfma_f32_16x16x32_bf16 v[140:143], v[208:211], a[172:175], 0
  v_exp_f32_e64 v202, v202
  v_mfma_f32_16x16x32_bf16 v[144:147], v[208:211], a[176:179], 0
  v_exp_f32_e64 v201, v201
  v_mfma_f32_16x16x32_bf16 v[148:151], v[208:211], a[180:183], 0
  v_mul_f32 v204, s29, v196
  v_mul_f32 v205, s29, v197
  v_mfma_f32_16x16x32_bf16 v[152:155], v[208:211], a[184:187], 0
  v_exp_f32_e64 v200, v200
  v_mfma_f32_16x16x32_bf16 v[156:159], v[208:211], a[188:191], 0
  s_waitcnt lgkmcnt(2)
  v_mul_f32 v206, s29, v198
  v_mul_f32_e64 v207, s29, v199
  v_mfma_f32_16x16x32_bf16 v[192:195], a[128:131], a[0:3], v[228:231]
  v_exp_f32_e64 v206, v206
  v_mfma_f32_16x16x32_bf16 v[192:195], a[132:135], a[4:7], v[192:195]
  v_exp_f32_e64 v207, v207
  v_mfma_f32_16x16x32_bf16 v[192:195], a[136:139], a[8:11], v[192:195]
  v_exp_f32_e64 v204, v204
  v_mfma_f32_16x16x32_bf16 v[192:195], a[140:143], a[12:15], v[192:195]
  v_exp_f32_e64 v205, v205
  v_mfma_f32_16x16x32_bf16 v[196:199], a[144:147], a[12:15], v[228:231]
  s_waitcnt lgkmcnt(0)
  v_cvt_pk_bf16_f32 v214, v204, v205
  v_cvt_pk_bf16_f32 v215, v206, v207
  v_mfma_f32_16x16x32_bf16 v[196:199], a[148:151], a[8:11], v[196:199]
  v_cvt_pk_bf16_f32 v212, v200, v201
  v_cvt_pk_bf16_f32 v213, v202, v203
  v_mfma_f32_16x16x32_bf16 v[196:199], a[152:155], a[4:7], v[196:199]
  v_mul_f32 v200, s29, v192
  v_mul_f32_e64 v203, s29, v195
  v_mfma_f32_16x16x32_bf16 v[196:199], a[156:159], a[0:3], v[196:199]
  v_mul_f32 v201, s29, v193
  v_mul_f32 v202, s29, v194
  v_mfma_f32_16x16x32_bf16 v[160:163], v[212:215], a[160:163], 0
  ds_read_b64_tr_b16 a[160:161], v217 offset:8448
  ds_read_b64_tr_b16 a[162:163], v217 offset:8960
  v_mfma_f32_16x16x32_bf16 v[164:167], v[212:215], a[164:167], 0
  v_exp_f32_e64 v201, v201
  v_mfma_f32_16x16x32_bf16 v[168:171], v[212:215], a[168:171], 0
  ds_read_b64_tr_b16 a[168:169], v217 offset:8480
  v_mul_f32_e64 v205, s29, v197
  v_mfma_f32_16x16x32_bf16 v[172:175], v[212:215], a[172:175], 0
  v_exp_f32_e64 v200, v200
  v_mfma_f32_16x16x32_bf16 v[176:179], v[212:215], a[176:179], 0
  ds_read_b64_tr_b16 a[166:167], v217 offset:8976
  v_mul_f32_e64 v206, s29, v198
  v_mfma_f32_16x16x32_bf16 v[180:183], v[212:215], a[180:183], 0
  ds_read_b64_tr_b16 a[164:165], v217 offset:8464
  v_mul_f32_e64 v204, s29, v196
  v_mfma_f32_16x16x32_bf16 v[184:187], v[212:215], a[184:187], 0
  v_exp_f32_e64 v202, v202
  v_mfma_f32_16x16x32_bf16 v[188:191], v[212:215], a[188:191], 0
  ds_read_b64_tr_b16 a[172:173], v217 offset:8496
  ds_read_b64_tr_b16 a[174:175], v217 offset:9008
  v_smfmac_f32_16x16x64_bf16 a[200:203], a[220:223], v[208:215], v254
  ds_read_b64_tr_b16 a[170:171], v217 offset:8992
  v_exp_f32 v203, v203
  v_mul_f32 v207, s29, v199
  s_cmp_eq_u32 s38, 1
  s_cselect_b32 s37, 12, 14
  s_cbranch_scc1 L_pD1
  s_branch L_pB1
  .p2align 6
L_pB1:
  v_mfma_f32_16x16x32_bf16 v[192:195], a[128:131], a[16:19], v[228:231]
  ds_read_b64_tr_b16 a[176:177], v217 offset:8512
  ds_read_b64_tr_b16 a[178:179], v217 offset:9024
  v_mfma_f32_16x16x32_bf16 v[192:195], a[132:135], a[20:23], v[192:195]
  v_exp_f32_e64 v204, v204
  v_mfma_f32_16x16x32_bf16 v[192:195], a[136:139], a[24:27], v[192:195]
  v_exp_f32_e64 v206, v206
  v_mfma_f32_16x16x32_bf16 v[192:195], a[140:143], a[28:31], v[192:195]
  v_exp_f32_e64 v207, v207
  v_mfma_f32_16x16x32_bf16 v[196:199], a[144:147], a[28:31], v[228:231]
  s_waitcnt lgkmcnt(2)
  v_exp_f32 v205, v205
  v_mfma_f32_16x16x32_bf16 v[196:199], a[148:151], a[24:27], v[196:199]
  ds_read_b64_tr_b16 a[180:181], v217 offset:8528
  v_cvt_pk_bf16_f32 v210, v204, v205
  v_mfma_f32_16x16x32_bf16 v[196:199], a[152:155], a[20:23], v[196:199]
  ds_read_b64_tr_b16 a[182:183], v217 offset:9040
  v_cvt_pk_bf16_f32 v208, v200, v201
  v_cvt_pk_bf16_f32 v209, v202, v203
  v_cvt_pk_bf16_f32 v211, v206, v207
  v_mfma_f32_16x16x32_bf16 v[196:199], a[156:159], a[16:19], v[196:199]
  ds_read_b64_tr_b16 a[184:185], v217 offset:8544
  ds_read_b64_tr_b16 a[186:187], v217 offset:9056
  v_mfma_f32_16x16x32_bf16 v[0:3], v[208:211], a[160:163], v[0:3]
  ds_read_b64_tr_b16 a[188:189], v217 offset:8560
  ds_read_b64_tr_b16 a[190:191], v217 offset:9072
  v_mfma_f32_16x16x32_bf16 v[4:7], v[208:211], a[164:167], v[4:7]
  v_mul_f32 v200, s29, v192
  v_mul_f32 v201, s29, v193
  v_mfma_f32_16x16x32_bf16 v[8:11], v[208:211], a[168:171], v[8:11]
  v_mul_f32 v202, s29, v194
  v_mul_f32 v203, s29, v195
  v_mfma_f32_16x16x32_bf16 v[12:15], v[208:211], a[172:175], v[12:15]
  s_waitcnt lgkmcnt(6)
  v_mul_f32 v206, s29, v198
  v_mul_f32_e64 v207, s29, v199
  v_mfma_f32_16x16x32_bf16 v[16:19], v[208:211], a[176:179], v[16:19]
  s_waitcnt lgkmcnt(4)
  v_mul_f32 v204, s29, v196
  v_mul_f32_e64 v205, s29, v197
  v_mfma_f32_16x16x32_bf16 v[20:23], v[208:211], a[180:183], v[20:23]
  s_waitcnt lgkmcnt(2)
  v_exp_f32 v202, v202
  v_mfma_f32_16x16x32_bf16 v[24:27], v[208:211], a[184:187], v[24:27]
  s_waitcnt lgkmcnt(0)
  v_exp_f32 v206, v206
  v_mfma_f32_16x16x32_bf16 v[28:31], v[208:211], a[188:191], v[28:31]
  v_exp_f32_e64 v201, v201
  v_mfma_f32_16x16x32_bf16 v[192:195], a[128:131], a[32:35], v[228:231]
  v_exp_f32_e64 v200, v200
  v_mfma_f32_16x16x32_bf16 v[192:195], a[132:135], a[36:39], v[192:195]
  v_exp_f32_e64 v205, v205
  v_mfma_f32_16x16x32_bf16 v[192:195], a[136:139], a[40:43], v[192:195]
  v_exp_f32_e64 v203, v203
  v_mfma_f32_16x16x32_bf16 v[192:195], a[140:143], a[44:47], v[192:195]
  s_waitcnt vmcnt(8)
  v_exp_f32 v204, v204
  v_mfma_f32_16x16x32_bf16 v[196:199], a[144:147], a[44:47], v[228:231]
  s_barrier
  v_cvt_pk_bf16_f32 v214, v204, v205
  v_mfma_f32_16x16x32_bf16 v[196:199], a[148:151], a[40:43], v[196:199]
  v_exp_f32 v207, v207
  v_mfma_f32_16x16x32_bf16 v[196:199], a[152:155], a[36:39], v[196:199]
  s_mov_b32 m0, s30
  v_cvt_pk_bf16_f32 v212, v200, v201
  v_cvt_pk_bf16_f32 v213, v202, v203
  v_cvt_pk_bf16_f32 v215, v206, v207
  v_mfma_f32_16x16x32_bf16 v[196:199], a[156:159], a[32:35], v[196:199]
  buffer_load_dwordx4 v221, s[4:7], s33 offen lds
  v_smfmac_f32_16x16x64_bf16 a[192:195], a[220:223], v[208:215], v254
  ds_read_b64_tr_b16 a[112:113], v220 offset:0
  v_mul_f32 v201, s29, v193
  v_mfma_f32_16x16x32_bf16 v[32:35], v[212:215], a[160:163], v[32:35]
  v_mul_f32 v202, s29, v194
  v_mul_f32 v203, s29, v195
  v_mfma_f32_16x16x32_bf16 v[36:39], v[212:215], a[164:167], v[36:39]
  ds_read_b64_tr_b16 a[114:115], v220 offset:64
  v_mul_f32_e64 v200, s29, v192
  v_mfma_f32_16x16x32_bf16 v[40:43], v[212:215], a[168:171], v[40:43]
  ds_read_b64_tr_b16 a[116:117], v220 offset:1024
  ds_read_b64_tr_b16 a[118:119], v220 offset:1088
  v_mfma_f32_16x16x32_bf16 v[44:47], v[212:215], a[172:175], v[44:47]
  v_mul_f32 v206, s29, v198
  v_mul_f32 v207, s29, v199
  v_mfma_f32_16x16x32_bf16 v[48:51], v[212:215], a[176:179], v[48:51]
  v_mul_f32 v204, s29, v196
  v_mul_f32 v205, s29, v197
  v_mfma_f32_16x16x32_bf16 v[52:55], v[212:215], a[180:183], v[52:55]
  v_exp_f32_e64 v204, v204
  v_mfma_f32_16x16x32_bf16 v[56:59], v[212:215], a[184:187], v[56:59]
  v_exp_f32_e64 v201, v201
  v_mfma_f32_16x16x32_bf16 v[60:63], v[212:215], a[188:191], v[60:63]
  v_exp_f32_e64 v206, v206
  v_mfma_f32_16x16x32_bf16 v[192:195], a[128:131], a[48:51], v[228:231]
  s_add_u32 m0, s30, 32
  v_exp_f32 v203, v203
  v_mfma_f32_16x16x32_bf16 v[192:195], a[132:135], a[52:55], v[192:195]
  buffer_load_dwordx4 v221, s[4:7], s33 offen offset:1024 lds
  v_mfma_f32_16x16x32_bf16 v[192:195], a[136:139], a[56:59], v[192:195]
  v_exp_f32_e64 v207, v207
  v_mfma_f32_16x16x32_bf16 v[192:195], a[140:143], a[60:63], v[192:195]
  v_exp_f32_e64 v202, v202
  v_mfma_f32_16x16x32_bf16 v[196:199], a[144:147], a[60:63], v[228:231]
  v_exp_f32_e64 v205, v205
  v_mfma_f32_16x16x32_bf16 v[196:199], a[148:151], a[56:59], v[196:199]
  s_add_u32 m0, s30, s96
  v_exp_f32 v200, v200
  v_mfma_f32_16x16x32_bf16 v[196:199], a[152:155], a[52:55], v[196:199]
  s_waitcnt lgkmcnt(0)
  v_cvt_pk_bf16_f32 v208, v200, v201
  v_cvt_pk_bf16_f32 v209, v202, v203
  v_cvt_pk_bf16_f32 v210, v204, v205
  v_cvt_pk_bf16_f32 v211, v206, v207
  v_mfma_f32_16x16x32_bf16 v[196:199], a[156:159], a[48:51], v[196:199]
  buffer_store_dwordx4 a[116:119], v233, s[16:19], s35 offen offset:1024
  buffer_load_dwordx4 v221, s[8:11], s33 offen lds
  v_pk_mul_f32 v[200:201], v[192:193], s[28:29] op_sel:[0,1] op_sel_hi:[1,1]
  v_pk_mul_f32 v[202:203], v[194:195], s[28:29] op_sel:[0,1] op_sel_hi:[1,1]
  v_mfma_f32_16x16x32_bf16 v[64:67], v[208:211], a[160:163], v[64:67]
  v_exp_f32 v203, v203
  v_mfma_f32_16x16x32_bf16 v[68:71], v[208:211], a[164:167], v[68:71]
  s_add_u32 m0, s30, s97
  v_exp_f32 v202, v202
  v_mfma_f32_16x16x32_bf16 v[72:75], v[208:211], a[168:171], v[72:75]
  buffer_load_dwordx4 v221, s[8:11], s33 offen offset:1024 lds
  v_mfma_f32_16x16x32_bf16 v[76:79], v[208:211], a[172:175], v[76:79]
  s_sub_u32 s30, s30, 16896
  v_mul_f32 v204, s29, v196
  v_mul_f32 v207, s29, v199
  v_mfma_f32_16x16x32_bf16 v[80:83], v[208:211], a[176:179], v[80:83]
  s_cselect_b32 s30, s31, s30
  v_mul_f32 v205, s29, v197
  v_mul_f32_e64 v206, s29, v198
  v_mfma_f32_16x16x32_bf16 v[84:87], v[208:211], a[180:183], v[84:87]
  s_add_u32 s59, s59, 8192
  v_exp_f32_e64 v207, v207
  v_mfma_f32_16x16x32_bf16 v[88:91], v[208:211], a[184:187], v[88:91]
  s_xor_b32 s33, s59, s3
  v_exp_f32 v206, v206
  v_mfma_f32_16x16x32_bf16 v[92:95], v[208:211], a[188:191], v[92:95]
  v_exp_f32_e64 v205, v205
  v_mfma_f32_16x16x32_bf16 v[192:195], a[128:131], a[64:67], v[228:231]
  v_exp_f32_e64 v204, v204
  v_mfma_f32_16x16x32_bf16 v[192:195], a[132:135], a[68:71], v[192:195]
  v_exp_f32_e64 v201, v201
  v_mfma_f32_16x16x32_bf16 v[192:195], a[136:139], a[72:75], v[192:195]
  v_exp_f32_e64 v200, v200
  v_mfma_f32_16x16x32_bf16 v[192:195], a[140:143], a[76:79], v[192:195]
  v_cvt_pk_bf16_f32 v212, v200, v201
  v_cvt_pk_bf16_f32 v213, v202, v203
  v_mfma_f32_16x16x32_bf16 v[196:199], a[144:147], a[76:79], v[228:231]
  s_mov_b32 m0, s36
  v_cvt_pk_bf16_f32 v214, v204, v205
  v_cvt_pk_bf16_f32 v215, v206, v207
  v_mfma_f32_16x16x32_bf16 v[196:199], a[148:151], a[72:75], v[196:199]
  buffer_load_dwordx4 v222, s[12:15], s34 offen nt lds
  v_mfma_f32_16x16x32_bf16 v[196:199], a[152:155], a[68:71], v[196:199]
  s_add_u32 s36, s36, 2048
  v_mul_f32 v200, s29, v192
  v_mul_f32_e64 v203, s29, v195
  v_mfma_f32_16x16x32_bf16 v[196:199], a[156:159], a[64:67], v[196:199]
  v_mul_f32 v201, s29, v193
  v_mul_f32 v202, s29, v194
  v_smfmac_f32_16x16x64_bf16 a[196:199], a[220:223], v[208:215], v254
  buffer_load_dwordx4 v223, s[12:15], s34 offen offset:1024 nt lds
  v_mfma_f32_16x16x32_bf16 v[96:99], v[212:215], a[160:163], v[96:99]
  buffer_store_dwordx4 a[112:115], v233, s[16:19], s35 offen
  v_exp_f32_e64 v202, v202
  v_mfma_f32_16x16x32_bf16 v[100:103], v[212:215], a[164:167], v[100:103]
  s_add_u32 s35, s35, 2048
  v_mul_f32 v204, s29, v196
  v_mul_f32 v207, s29, v199
  v_mfma_f32_16x16x32_bf16 v[104:107], v[212:215], a[168:171], v[104:107]
  s_add_u32 s34, s34, 2048
  v_mul_f32 v205, s29, v197
  v_mul_f32 v206, s29, v198
  v_mfma_f32_16x16x32_bf16 v[108:111], v[212:215], a[172:175], v[108:111]
  v_exp_f32_e64 v204, v204
  v_mfma_f32_16x16x32_bf16 v[112:115], v[212:215], a[176:179], v[112:115]
  v_exp_f32_e64 v203, v203
  v_mfma_f32_16x16x32_bf16 v[116:119], v[212:215], a[180:183], v[116:119]
  v_exp_f32_e64 v207, v207
  v_mfma_f32_16x16x32_bf16 v[120:123], v[212:215], a[184:187], v[120:123]
  v_exp_f32_e64 v201, v201
  v_mfma_f32_16x16x32_bf16 v[124:127], v[212:215], a[188:191], v[124:127]
  v_exp_f32_e64 v200, v200
  v_mfma_f32_16x16x32_bf16 v[192:195], a[128:131], a[80:83], v[228:231]
  v_exp_f32_e64 v206, v206
  v_mfma_f32_16x16x32_bf16 v[192:195], a[132:135], a[84:87], v[192:195]
  v_exp_f32_e64 v205, v205
  v_mfma_f32_16x16x32_bf16 v[192:195], a[136:139], a[88:91], v[192:195]
  v_cvt_pk_bf16_f32 v208, v200, v201
  v_cvt_pk_bf16_f32 v209, v202, v203
  v_mfma_f32_16x16x32_bf16 v[192:195], a[140:143], a[92:95], v[192:195]
  v_cvt_pk_bf16_f32 v210, v204, v205
  v_cvt_pk_bf16_f32 v211, v206, v207
  v_mfma_f32_16x16x32_bf16 v[196:199], a[144:147], a[92:95], v[228:231]
  v_add_u32 v216, s30, v218
  v_add_u32 v217, s30, v219
  v_mfma_f32_16x16x32_bf16 v[196:199], a[148:151], a[88:91], v[196:199]
  ds_read_b128 a[128:131], v216 offset:0
  ds_read_b128 a[132:135], v216 offset:64
  v_mfma_f32_16x16x32_bf16 v[196:199], a[152:155], a[84:87], v[196:199]
  ds_read_b128 a[136:139], v216 offset:128
  ds_read_b128 a[140:143], v216 offset:192
  v_mfma_f32_16x16x32_bf16 v[196:199], a[156:159], a[80:83], v[196:199]
  v_mul_f32 v202, s29, v194
  v_mul_f32 v203, s29, v195
  v_mfma_f32_16x16x32_bf16 v[128:131], v[208:211], a[160:163], v[128:131]
  ds_read_b128 a[144:147], v216 offset:704
  v_mul_f32_e64 v201, s29, v193
  v_mfma_f32_16x16x32_bf16 v[132:135], v[208:211], a[164:167], v[132:135]
  ds_read_b128 a[156:159], v216 offset:512
  v_mul_f32_e64 v200, s29, v192
  v_mfma_f32_16x16x32_bf16 v[136:139], v[208:211], a[168:171], v[136:139]
  v_exp_f32_e64 v203, v203
  v_mfma_f32_16x16x32_bf16 v[140:143], v[208:211], a[172:175], v[140:143]
  ds_read_b128 a[152:155], v216 offset:576
  v_mul_f32_e64 v205, s29, v197
  v_mfma_f32_16x16x32_bf16 v[144:147], v[208:211], a[176:179], v[144:147]
  s_sub_u32 s37, s37, 1
  v_exp_f32 v201, v201
  v_mfma_f32_16x16x32_bf16 v[148:151], v[208:211], a[180:183], v[148:151]
  ds_read_b128 a[148:151], v216 offset:640
  v_mul_f32_e64 v204, s29, v196
  v_mfma_f32_16x16x32_bf16 v[152:155], v[208:211], a[184:187], v[152:155]
  s_waitcnt lgkmcnt(4)
  v_exp_f32 v200, v200
  v_exp_f32_e64 v202, v202
  v_mfma_f32_16x16x32_bf16 v[156:159], v[208:211], a[188:191], v[156:159]
  s_cbranch_scc1 L_exitB
  v_mul_f32 v206, s29, v198
  v_mul_f32_e64 v207, s29, v199
  v_mfma_f32_16x16x32_bf16 v[192:195], a[128:131], a[0:3], v[228:231]
  v_exp_f32_e64 v205, v205
  v_mfma_f32_16x16x32_bf16 v[192:195], a[132:135], a[4:7], v[192:195]
  v_exp_f32_e64 v206, v206
  v_mfma_f32_16x16x32_bf16 v[192:195], a[136:139], a[8:11], v[192:195]
  v_exp_f32_e64 v204, v204
  v_mfma_f32_16x16x32_bf16 v[192:195], a[140:143], a[12:15], v[192:195]
  s_waitcnt lgkmcnt(1)
  v_exp_f32 v207, v207
  v_mfma_f32_16x16x32_bf16 v[196:199], a[144:147], a[12:15], v[228:231]
  s_waitcnt lgkmcnt(0)
  v_cvt_pk_bf16_f32 v212, v200, v201
  v_cvt_pk_bf16_f32 v213, v202, v203
  v_mfma_f32_16x16x32_bf16 v[196:199], a[148:151], a[8:11], v[196:199]
  v_cvt_pk_bf16_f32 v214, v204, v205
  v_cvt_pk_bf16_f32 v215, v206, v207
  v_mfma_f32_16x16x32_bf16 v[196:199], a[152:155], a[4:7], v[196:199]
  v_mul_f32 v200, s29, v192
  v_mul_f32_e64 v203, s29, v195
  v_mfma_f32_16x16x32_bf16 v[196:199], a[156:159], a[0:3], v[196:199]
  v_mul_f32 v201, s29, v193
  v_mul_f32 v202, s29, v194
  v_mfma_f32_16x16x32_bf16 v[160:163], v[212:215], a[160:163], v[160:163]
  v_exp_f32_e64 v201, v201
  v_mfma_f32_16x16x32_bf16 v[164:167], v[212:215], a[164:167], v[164:167]
  v_exp_f32_e64 v200, v200
  v_mfma_f32_16x16x32_bf16 v[168:171], v[212:215], a[168:171], v[168:171]
  ds_read_b64_tr_b16 a[168:169], v217 offset:8480
  v_mul_f32_e64 v205, s29, v197
  v_mfma_f32_16x16x32_bf16 v[172:175], v[212:215], a[172:175], v[172:175]
  ds_read_b64_tr_b16 a[170:171], v217 offset:8992
  ds_read_b64_tr_b16 a[172:173], v217 offset:8496
  v_mfma_f32_16x16x32_bf16 v[176:179], v[212:215], a[176:179], v[176:179]
  v_mul_f32 v204, s29, v196
  v_mul_f32 v206, s29, v198
  v_mfma_f32_16x16x32_bf16 v[180:183], v[212:215], a[180:183], v[180:183]
  ds_read_b64_tr_b16 a[162:163], v217 offset:8960
  ds_read_b64_tr_b16 a[166:167], v217 offset:8976
  v_mfma_f32_16x16x32_bf16 v[184:187], v[212:215], a[184:187], v[184:187]
  v_exp_f32_e64 v202, v202
  v_mfma_f32_16x16x32_bf16 v[188:191], v[212:215], a[188:191], v[188:191]
  ds_read_b64_tr_b16 a[160:161], v217 offset:8448
  ds_read_b64_tr_b16 a[174:175], v217 offset:9008
  v_smfmac_f32_16x16x64_bf16 a[200:203], a[220:223], v[208:215], v254
  ds_read_b64_tr_b16 a[164:165], v217 offset:8464
  v_exp_f32 v203, v203
  v_mul_f32 v207, s29, v199
L_pB2:
  v_mfma_f32_16x16x32_bf16 v[192:195], a[128:131], a[16:19], v[228:231]
  v_exp_f32_e64 v206, v206
  v_mfma_f32_16x16x32_bf16 v[192:195], a[132:135], a[20:23], v[192:195]
  ds_read_b64_tr_b16 a[176:177], v217 offset:8512
  ds_read_b64_tr_b16 a[178:179], v217 offset:9024
  v_mfma_f32_16x16x32_bf16 v[192:195], a[136:139], a[24:27], v[192:195]
  v_exp_f32_e64 v205, v205
  v_mfma_f32_16x16x32_bf16 v[192:195], a[140:143], a[28:31], v[192:195]
  ds_read_b64_tr_b16 a[182:183], v217 offset:9040
  v_cvt_pk_bf16_f32 v209, v202, v203
  v_mfma_f32_16x16x32_bf16 v[196:199], a[144:147], a[28:31], v[228:231]
  v_exp_f32_e64 v207, v207
  v_mfma_f32_16x16x32_bf16 v[196:199], a[148:151], a[24:27], v[196:199]
  s_waitcnt lgkmcnt(3)
  v_exp_f32 v204, v204
  v_mfma_f32_16x16x32_bf16 v[196:199], a[152:155], a[20:23], v[196:199]
  ds_read_b64_tr_b16 a[180:181], v217 offset:8528
  v_cvt_pk_bf16_f32 v208, v200, v201
  v_cvt_pk_bf16_f32 v210, v204, v205
  v_cvt_pk_bf16_f32 v211, v206, v207
  v_mfma_f32_16x16x32_bf16 v[196:199], a[156:159], a[16:19], v[196:199]
  ds_read_b64_tr_b16 a[184:185], v217 offset:8544
  ds_read_b64_tr_b16 a[186:187], v217 offset:9056
  v_mfma_f32_16x16x32_bf16 v[0:3], v[208:211], a[160:163], v[0:3]
  ds_read_b64_tr_b16 a[188:189], v217 offset:8560
  ds_read_b64_tr_b16 a[190:191], v217 offset:9072
  v_mfma_f32_16x16x32_bf16 v[4:7], v[208:211], a[164:167], v[4:7]
  v_mul_f32 v201, s29, v193
  v_mul_f32 v203, s29, v195
  v_mfma_f32_16x16x32_bf16 v[8:11], v[208:211], a[168:171], v[8:11]
  v_mul_f32 v200, s29, v192
  v_mul_f32 v202, s29, v194
  v_mfma_f32_16x16x32_bf16 v[12:15], v[208:211], a[172:175], v[12:15]
  s_waitcnt lgkmcnt(5)
  v_mul_f32 v204, s29, v196
  v_mul_f32_e64 v206, s29, v198
  v_mfma_f32_16x16x32_bf16 v[16:19], v[208:211], a[176:179], v[16:19]
  s_waitcnt lgkmcnt(4)
  v_mul_f32 v205, s29, v197
  v_mul_f32_e64 v207, s29, v199
  v_mfma_f32_16x16x32_bf16 v[20:23], v[208:211], a[180:183], v[20:23]
  s_waitcnt lgkmcnt(2)
  v_exp_f32 v205, v205
  v_mfma_f32_16x16x32_bf16 v[24:27], v[208:211], a[184:187], v[24:27]
  s_waitcnt lgkmcnt(0)
  v_exp_f32 v200, v200
  v_mfma_f32_16x16x32_bf16 v[28:31], v[208:211], a[188:191], v[28:31]
  v_exp_f32_e64 v202, v202
  v_mfma_f32_16x16x32_bf16 v[192:195], a[128:131], a[32:35], v[228:231]
  v_exp_f32_e64 v206, v206
  v_mfma_f32_16x16x32_bf16 v[192:195], a[132:135], a[36:39], v[192:195]
  v_exp_f32_e64 v207, v207
  v_mfma_f32_16x16x32_bf16 v[192:195], a[136:139], a[40:43], v[192:195]
  v_exp_f32_e64 v204, v204
  v_mfma_f32_16x16x32_bf16 v[192:195], a[140:143], a[44:47], v[192:195]
  v_cvt_pk_bf16_f32 v214, v204, v205
  v_cvt_pk_bf16_f32 v215, v206, v207
  v_mfma_f32_16x16x32_bf16 v[196:199], a[144:147], a[44:47], v[228:231]
  v_exp_f32_e64 v201, v201
  v_mfma_f32_16x16x32_bf16 v[196:199], a[148:151], a[40:43], v[196:199]
  v_exp_f32_e64 v203, v203
  v_mfma_f32_16x16x32_bf16 v[196:199], a[152:155], a[36:39], v[196:199]
  v_cvt_pk_bf16_f32 v212, v200, v201
  v_cvt_pk_bf16_f32 v213, v202, v203
  v_mfma_f32_16x16x32_bf16 v[196:199], a[156:159], a[32:35], v[196:199]
  s_waitcnt vmcnt(9)
  v_mul_f32 v200, s29, v192
  v_mul_f32_e64 v203, s29, v195
  v_smfmac_f32_16x16x64_bf16 a[192:195], a[220:223], v[208:215], v254
  s_barrier
  v_mul_f32 v202, s29, v194
  v_mfma_f32_16x16x32_bf16 v[32:35], v[212:215], a[160:163], v[32:35]
  ds_read_b64_tr_b16 a[112:113], v220 offset:2048
  ds_read_b64_tr_b16 a[114:115], v220 offset:2112
  v_mfma_f32_16x16x32_bf16 v[36:39], v[212:215], a[164:167], v[36:39]
  ds_read_b64_tr_b16 a[116:117], v220 offset:3072
  ds_read_b64_tr_b16 a[118:119], v220 offset:3136
  v_mfma_f32_16x16x32_bf16 v[40:43], v[212:215], a[168:171], v[40:43]
  s_mov_b32 m0, s30
  v_mul_f32 v201, s29, v193
  v_mul_f32_e64 v205, s29, v197
  v_mfma_f32_16x16x32_bf16 v[44:47], v[212:215], a[172:175], v[44:47]
  buffer_load_dwordx4 v221, s[4:7], s33 offen lds
  v_mfma_f32_16x16x32_bf16 v[48:51], v[212:215], a[176:179], v[48:51]
  v_mul_f32 v204, s29, v196
  v_mul_f32 v206, s29, v198
  v_mfma_f32_16x16x32_bf16 v[52:55], v[212:215], a[180:183], v[52:55]
  v_exp_f32_e64 v202, v202
  v_mfma_f32_16x16x32_bf16 v[56:59], v[212:215], a[184:187], v[56:59]
  v_exp_f32_e64 v204, v204
  v_mfma_f32_16x16x32_bf16 v[60:63], v[212:215], a[188:191], v[60:63]
  v_exp_f32_e64 v200, v200
  v_mfma_f32_16x16x32_bf16 v[192:195], a[128:131], a[48:51], v[228:231]
  v_exp_f32_e64 v203, v203
  v_mfma_f32_16x16x32_bf16 v[192:195], a[132:135], a[52:55], v[192:195]
  v_mul_f32_e64 v207, s29, v199
  v_cvt_pk_bf16_f32 v209, v202, v203
  v_mfma_f32_16x16x32_bf16 v[192:195], a[136:139], a[56:59], v[192:195]
  v_exp_f32_e64 v207, v207
  v_mfma_f32_16x16x32_bf16 v[192:195], a[140:143], a[60:63], v[192:195]
  v_exp_f32_e64 v201, v201
  v_mfma_f32_16x16x32_bf16 v[196:199], a[144:147], a[60:63], v[228:231]
  v_exp_f32_e64 v205, v205
  v_mfma_f32_16x16x32_bf16 v[196:199], a[148:151], a[56:59], v[196:199]
  s_add_u32 m0, s30, 32
  v_exp_f32 v206, v206
  v_mfma_f32_16x16x32_bf16 v[196:199], a[152:155], a[52:55], v[196:199]
  s_waitcnt lgkmcnt(0)
  v_cvt_pk_bf16_f32 v208, v200, v201
  v_cvt_pk_bf16_f32 v210, v204, v205
  v_cvt_pk_bf16_f32 v211, v206, v207
  v_mfma_f32_16x16x32_bf16 v[196:199], a[156:159], a[48:51], v[196:199]
  buffer_store_dwordx4 a[116:119], v233, s[16:19], s35 offen offset:1024
  buffer_load_dwordx4 v221, s[4:7], s33 offen offset:1024 lds
  v_pk_mul_f32 v[200:201], v[192:193], s[28:29] op_sel:[0,1] op_sel_hi:[1,1]
  v_pk_mul_f32 v[202:203], v[194:195], s[28:29] op_sel:[0,1] op_sel_hi:[1,1]
  v_mfma_f32_16x16x32_bf16 v[64:67], v[208:211], a[160:163], v[64:67]
  v_exp_f32 v201, v201
  v_mfma_f32_16x16x32_bf16 v[68:71], v[208:211], a[164:167], v[68:71]
  s_add_u32 m0, s30, s96
  v_exp_f32 v202, v202
  v_mfma_f32_16x16x32_bf16 v[72:75], v[208:211], a[168:171], v[72:75]
  buffer_load_dwordx4 v221, s[8:11], s33 offen lds
  v_mfma_f32_16x16x32_bf16 v[76:79], v[208:211], a[172:175], v[76:79]
  v_mul_f32 v206, s29, v198
  v_mul_f32 v207, s29, v199
  v_mfma_f32_16x16x32_bf16 v[80:83], v[208:211], a[176:179], v[80:83]
  v_mul_f32 v204, s29, v196
  v_mul_f32 v205, s29, v197
  v_mfma_f32_16x16x32_bf16 v[84:87], v[208:211], a[180:183], v[84:87]
  v_exp_f32_e64 v205, v205
  v_mfma_f32_16x16x32_bf16 v[88:91], v[208:211], a[184:187], v[88:91]
  v_exp_f32_e64 v200, v200
  v_mfma_f32_16x16x32_bf16 v[92:95], v[208:211], a[188:191], v[92:95]
  v_exp_f32_e64 v203, v203
  v_mfma_f32_16x16x32_bf16 v[192:195], a[128:131], a[64:67], v[228:231]
  v_exp_f32_e64 v206, v206
  v_mfma_f32_16x16x32_bf16 v[192:195], a[132:135], a[68:71], v[192:195]
  v_exp_f32_e64 v204, v204
  v_mfma_f32_16x16x32_bf16 v[192:195], a[136:139], a[72:75], v[192:195]
  v_cvt_pk_bf16_f32 v213, v202, v203
  v_cvt_pk_bf16_f32 v214, v204, v205
  v_mfma_f32_16x16x32_bf16 v[192:195], a[140:143], a[76:79], v[192:195]
  v_exp_f32_e64 v207, v207
  v_mfma_f32_16x16x32_bf16 v[196:199], a[144:147], a[76:79], v[228:231]
  s_add_u32 m0, s30, s97
  v_cvt_pk_bf16_f32 v212, v200, v201
  v_cvt_pk_bf16_f32 v215, v206, v207
  v_mfma_f32_16x16x32_bf16 v[196:199], a[148:151], a[72:75], v[196:199]
  buffer_load_dwordx4 v221, s[8:11], s33 offen offset:1024 lds
  v_mfma_f32_16x16x32_bf16 v[196:199], a[152:155], a[68:71], v[196:199]
  s_sub_u32 s30, s30, 16896
  v_mul_f32 v200, s29, v192
  v_mul_f32_e64 v201, s29, v193
  v_mfma_f32_16x16x32_bf16 v[196:199], a[156:159], a[64:67], v[196:199]
  s_mov_b32 m0, s36
  v_mul_f32 v202, s29, v194
  v_mul_f32_e64 v203, s29, v195
  v_smfmac_f32_16x16x64_bf16 a[196:199], a[220:223], v[208:215], v254
  buffer_load_dwordx4 v222, s[12:15], s34 offen nt lds
  v_mfma_f32_16x16x32_bf16 v[96:99], v[212:215], a[160:163], v[96:99]
  buffer_store_dwordx4 a[112:115], v233, s[16:19], s35 offen
  v_exp_f32_e64 v201, v201
  v_mfma_f32_16x16x32_bf16 v[100:103], v[212:215], a[164:167], v[100:103]
  buffer_load_dwordx4 v223, s[12:15], s34 offen offset:1024 nt lds
  v_mfma_f32_16x16x32_bf16 v[104:107], v[212:215], a[168:171], v[104:107]
  s_cselect_b32 s30, s31, s30
  v_mul_f32 v205, s29, v197
  v_mul_f32_e64 v206, s29, v198
  v_mfma_f32_16x16x32_bf16 v[108:111], v[212:215], a[172:175], v[108:111]
  s_add_u32 s59, s59, 8192
  v_mul_f32 v204, s29, v196
  v_mul_f32 v207, s29, v199
  v_mfma_f32_16x16x32_bf16 v[112:115], v[212:215], a[176:179], v[112:115]
  s_xor_b32 s33, s59, s3
  v_exp_f32 v206, v206
  v_mfma_f32_16x16x32_bf16 v[116:119], v[212:215], a[180:183], v[116:119]
  s_add_u32 s35, s35, 2048
  v_exp_f32_e64 v202, v202
  v_mfma_f32_16x16x32_bf16 v[120:123], v[212:215], a[184:187], v[120:123]
  s_add_u32 s34, s34, 2048
  v_exp_f32_e64 v204, v204
  v_mfma_f32_16x16x32_bf16 v[124:127], v[212:215], a[188:191], v[124:127]
  s_add_u32 s36, s36, 2048
  v_exp_f32_e64 v203, v203
  v_mfma_f32_16x16x32_bf16 v[192:195], a[128:131], a[80:83], v[228:231]
  v_exp_f32_e64 v207, v207
  v_mfma_f32_16x16x32_bf16 v[192:195], a[132:135], a[84:87], v[192:195]
  v_exp_f32_e64 v205, v205
  v_mfma_f32_16x16x32_bf16 v[192:195], a[136:139], a[88:91], v[192:195]
  v_cvt_pk_bf16_f32 v210, v204, v205
  v_cvt_pk_bf16_f32 v211, v206, v207
  v_mfma_f32_16x16x32_bf16 v[192:195], a[140:143], a[92:95], v[192:195]
  v_exp_f32_e64 v200, v200
  v_mfma_f32_16x16x32_bf16 v[196:199], a[144:147], a[92:95], v[228:231]
  v_cvt_pk_bf16_f32 v208, v200, v201
  v_cvt_pk_bf16_f32 v209, v202, v203
  v_mfma_f32_16x16x32_bf16 v[196:199], a[148:151], a[88:91], v[196:199]
  v_add_u32 v216, s30, v218
  v_add_u32 v217, s30, v219
  v_mfma_f32_16x16x32_bf16 v[196:199], a[152:155], a[84:87], v[196:199]
  ds_read_b128 a[128:131], v216 offset:0
  ds_read_b128 a[132:135], v216 offset:64
  v_mfma_f32_16x16x32_bf16 v[196:199], a[156:159], a[80:83], v[196:199]
  ds_read_b128 a[136:139], v216 offset:128
  v_mul_f32_e64 v201, s29, v193
  v_mfma_f32_16x16x32_bf16 v[128:131], v[208:211], a[160:163], v[128:131]
  ds_read_b128 a[140:143], v216 offset:192
  ds_read_b128 a[156:159], v216 offset:512
  v_mfma_f32_16x16x32_bf16 v[132:135], v[208:211], a[164:167], v[132:135]
  ds_read_b128 a[144:147], v216 offset:704
  ds_read_b128 a[148:151], v216 offset:640
  v_mfma_f32_16x16x32_bf16 v[136:139], v[208:211], a[168:171], v[136:139]
  v_mul_f32 v203, s29, v195
  v_mul_f32 v204, s29, v196
  v_mfma_f32_16x16x32_bf16 v[140:143], v[208:211], a[172:175], v[140:143]
  v_mul_f32 v200, s29, v192
  v_mul_f32 v202, s29, v194
  v_mfma_f32_16x16x32_bf16 v[144:147], v[208:211], a[176:179], v[144:147]
  s_sub_u32 s37, s37, 1
  v_exp_f32 v202, v202
  v_mfma_f32_16x16x32_bf16 v[148:151], v[208:211], a[180:183], v[148:151]
  ds_read_b128 a[152:155], v216 offset:576
  v_mul_f32_e64 v205, s29, v197
  v_mfma_f32_16x16x32_bf16 v[152:155], v[208:211], a[184:187], v[152:155]
  s_waitcnt lgkmcnt(5)
  v_exp_f32 v200, v200
  v_exp_f32 v201, v201
  v_exp_f32 v203, v203
  v_mfma_f32_16x16x32_bf16 v[156:159], v[208:211], a[188:191], v[156:159]
  s_cbranch_scc1 L_exitB
  v_mul_f32 v206, s29, v198
  v_mul_f32_e64 v207, s29, v199
  v_mfma_f32_16x16x32_bf16 v[192:195], a[128:131], a[0:3], v[228:231]
  v_exp_f32_e64 v204, v204
  v_mfma_f32_16x16x32_bf16 v[192:195], a[132:135], a[4:7], v[192:195]
  v_exp_f32_e64 v205, v205
  v_mfma_f32_16x16x32_bf16 v[192:195], a[136:139], a[8:11], v[192:195]
  s_waitcnt lgkmcnt(1)
  v_cvt_pk_bf16_f32 v213, v202, v203
  v_cvt_pk_bf16_f32 v214, v204, v205
  v_mfma_f32_16x16x32_bf16 v[192:195], a[140:143], a[12:15], v[192:195]
  v_exp_f32 v206, v206
  v_mfma_f32_16x16x32_bf16 v[196:199], a[144:147], a[12:15], v[228:231]
  v_exp_f32_e64 v207, v207
  v_mfma_f32_16x16x32_bf16 v[196:199], a[148:151], a[8:11], v[196:199]
  s_waitcnt lgkmcnt(0)
  v_cvt_pk_bf16_f32 v212, v200, v201
  v_cvt_pk_bf16_f32 v215, v206, v207
  v_mfma_f32_16x16x32_bf16 v[196:199], a[152:155], a[4:7], v[196:199]
  v_mul_f32 v201, s29, v193
  v_mul_f32_e64 v202, s29, v194
  v_mfma_f32_16x16x32_bf16 v[196:199], a[156:159], a[0:3], v[196:199]
  v_mul_f32 v200, s29, v192
  v_mul_f32 v203, s29, v195
  v_mfma_f32_16x16x32_bf16 v[160:163], v[212:215], a[160:163], v[160:163]
  v_exp_f32_e64 v202, v202
  v_mfma_f32_16x16x32_bf16 v[164:167], v[212:215], a[164:167], v[164:167]
  v_exp_f32_e64 v203, v203
  v_mfma_f32_16x16x32_bf16 v[168:171], v[212:215], a[168:171], v[168:171]
  v_mul_f32 v205, s29, v197
  v_mul_f32 v206, s29, v198
  v_mfma_f32_16x16x32_bf16 v[172:175], v[212:215], a[172:175], v[172:175]
  v_exp_f32_e64 v201, v201
  v_mfma_f32_16x16x32_bf16 v[176:179], v[212:215], a[176:179], v[176:179]
  ds_read_b64_tr_b16 a[172:173], v217 offset:8496
  ds_read_b64_tr_b16 a[174:175], v217 offset:9008
  v_mfma_f32_16x16x32_bf16 v[180:183], v[212:215], a[180:183], v[180:183]
  ds_read_b64_tr_b16 a[162:163], v217 offset:8960
  ds_read_b64_tr_b16 a[164:165], v217 offset:8464
  v_mfma_f32_16x16x32_bf16 v[184:187], v[212:215], a[184:187], v[184:187]
  v_exp_f32_e64 v200, v200
  v_mfma_f32_16x16x32_bf16 v[188:191], v[212:215], a[188:191], v[188:191]
  ds_read_b64_tr_b16 a[170:171], v217 offset:8992
  v_mul_f32_e64 v204, s29, v196
  v_smfmac_f32_16x16x64_bf16 a[200:203], a[220:223], v[208:215], v254
  ds_read_b64_tr_b16 a[160:161], v217 offset:8448
  ds_read_b64_tr_b16 a[166:167], v217 offset:8976
  ds_read_b64_tr_b16 a[168:169], v217 offset:8480
  v_mul_f32_e64 v207, s29, v199
L_pB3:
  v_mfma_f32_16x16x32_bf16 v[192:195], a[128:131], a[16:19], v[228:231]
  ds_read_b64_tr_b16 a[176:177], v217 offset:8512
  v_cvt_pk_bf16_f32 v208, v200, v201
  v_mfma_f32_16x16x32_bf16 v[192:195], a[132:135], a[20:23], v[192:195]
  v_exp_f32_e64 v205, v205
  v_mfma_f32_16x16x32_bf16 v[192:195], a[136:139], a[24:27], v[192:195]
  ds_read_b64_tr_b16 a[178:179], v217 offset:9024
  v_cvt_pk_bf16_f32 v209, v202, v203
  v_mfma_f32_16x16x32_bf16 v[192:195], a[140:143], a[28:31], v[192:195]
  v_exp_f32_e64 v204, v204
  v_mfma_f32_16x16x32_bf16 v[196:199], a[144:147], a[28:31], v[228:231]
  ds_read_b64_tr_b16 a[180:181], v217 offset:8528
  ds_read_b64_tr_b16 a[186:187], v217 offset:9056
  v_mfma_f32_16x16x32_bf16 v[196:199], a[148:151], a[24:27], v[196:199]
  s_waitcnt lgkmcnt(4)
  v_exp_f32 v206, v206
  v_exp_f32_e64 v207, v207
  v_mfma_f32_16x16x32_bf16 v[196:199], a[152:155], a[20:23], v[196:199]
  ds_read_b64_tr_b16 a[182:183], v217 offset:9040
  v_cvt_pk_bf16_f32 v210, v204, v205
  v_cvt_pk_bf16_f32 v211, v206, v207
  v_mfma_f32_16x16x32_bf16 v[196:199], a[156:159], a[16:19], v[196:199]
  ds_read_b64_tr_b16 a[184:185], v217 offset:8544
  ds_read_b64_tr_b16 a[190:191], v217 offset:9072
  v_mfma_f32_16x16x32_bf16 v[0:3], v[208:211], a[160:163], v[0:3]
  ds_read_b64_tr_b16 a[188:189], v217 offset:8560
  v_mul_f32_e64 v200, s29, v192
  v_mfma_f32_16x16x32_bf16 v[4:7], v[208:211], a[164:167], v[4:7]
  v_mul_f32 v202, s29, v194
  v_mul_f32 v203, s29, v195
  v_mfma_f32_16x16x32_bf16 v[8:11], v[208:211], a[168:171], v[8:11]
  v_mul_f32 v205, s29, v197
  v_mul_f32 v207, s29, v199
  v_mfma_f32_16x16x32_bf16 v[12:15], v[208:211], a[172:175], v[12:15]
  s_waitcnt lgkmcnt(4)
  v_mul_f32 v201, s29, v193
  v_mul_f32_e64 v206, s29, v198
  v_mfma_f32_16x16x32_bf16 v[16:19], v[208:211], a[176:179], v[16:19]
  s_waitcnt lgkmcnt(3)
  v_exp_f32 v200, v200
  v_mfma_f32_16x16x32_bf16 v[20:23], v[208:211], a[180:183], v[20:23]
  s_waitcnt lgkmcnt(2)
  v_exp_f32 v201, v201
  v_mfma_f32_16x16x32_bf16 v[24:27], v[208:211], a[184:187], v[24:27]
  s_waitcnt lgkmcnt(0)
  v_mul_f32 v204, s29, v196
  v_cvt_pk_bf16_f32 v212, v200, v201
  v_mfma_f32_16x16x32_bf16 v[28:31], v[208:211], a[188:191], v[28:31]
  v_exp_f32_e64 v202, v202
  v_mfma_f32_16x16x32_bf16 v[192:195], a[128:131], a[32:35], v[228:231]
  v_exp_f32_e64 v206, v206
  v_mfma_f32_16x16x32_bf16 v[192:195], a[132:135], a[36:39], v[192:195]
  v_exp_f32_e64 v204, v204
  v_mfma_f32_16x16x32_bf16 v[192:195], a[136:139], a[40:43], v[192:195]
  v_exp_f32_e64 v207, v207
  v_mfma_f32_16x16x32_bf16 v[192:195], a[140:143], a[44:47], v[192:195]
  ds_read_b64_tr_b16 a[112:113], v220 offset:4096
  v_cvt_pk_bf16_f32 v215, v206, v207
  v_mfma_f32_16x16x32_bf16 v[196:199], a[144:147], a[44:47], v[228:231]
  v_exp_f32_e64 v203, v203
  v_mfma_f32_16x16x32_bf16 v[196:199], a[148:151], a[40:43], v[196:199]
  v_exp_f32_e64 v205, v205
  v_mfma_f32_16x16x32_bf16 v[196:199], a[152:155], a[36:39], v[196:199]
  v_cvt_pk_bf16_f32 v213, v202, v203
  v_cvt_pk_bf16_f32 v214, v204, v205
  v_mfma_f32_16x16x32_bf16 v[196:199], a[156:159], a[32:35], v[196:199]
  ds_read_b64_tr_b16 a[114:115], v220 offset:4160
  v_mul_f32_e64 v203, s29, v195
  v_smfmac_f32_16x16x64_bf16 a[192:195], a[220:223], v[208:215], v254
  ds_read_b64_tr_b16 a[116:117], v220 offset:5120
  v_mul_f32_e64 v200, s29, v192
  v_mfma_f32_16x16x32_bf16 v[32:35], v[212:215], a[160:163], v[32:35]
  ds_read_b64_tr_b16 a[118:119], v220 offset:5184
  v_mul_f32_e64 v201, s29, v193
  v_mfma_f32_16x16x32_bf16 v[36:39], v[212:215], a[164:167], v[36:39]
  v_mul_f32 v202, s29, v194
  v_mul_f32 v207, s29, v199
  v_mfma_f32_16x16x32_bf16 v[40:43], v[212:215], a[168:171], v[40:43]
  s_waitcnt vmcnt(11)
  v_exp_f32 v201, v201
  v_mfma_f32_16x16x32_bf16 v[44:47], v[212:215], a[172:175], v[44:47]
  s_barrier
  v_mul_f32 v204, s29, v196
  v_mfma_f32_16x16x32_bf16 v[48:51], v[212:215], a[176:179], v[48:51]
  v_exp_f32_e64 v203, v203
  v_mfma_f32_16x16x32_bf16 v[52:55], v[212:215], a[180:183], v[52:55]
  v_mul_f32 v205, s29, v197
  v_mul_f32 v206, s29, v198
  v_mfma_f32_16x16x32_bf16 v[56:59], v[212:215], a[184:187], v[56:59]
  v_exp_f32_e64 v206, v206
  v_mfma_f32_16x16x32_bf16 v[60:63], v[212:215], a[188:191], v[60:63]
  s_mov_b32 m0, s30
  v_exp_f32 v205, v205
  v_mfma_f32_16x16x32_bf16 v[192:195], a[128:131], a[48:51], v[228:231]
  buffer_load_dwordx4 v221, s[4:7], s33 offen lds
  v_mfma_f32_16x16x32_bf16 v[192:195], a[132:135], a[52:55], v[192:195]
  v_exp_f32_e64 v202, v202
  v_mfma_f32_16x16x32_bf16 v[192:195], a[136:139], a[56:59], v[192:195]
  v_exp_f32_e64 v204, v204
  v_mfma_f32_16x16x32_bf16 v[192:195], a[140:143], a[60:63], v[192:195]
  v_cvt_pk_bf16_f32 v209, v202, v203
  v_cvt_pk_bf16_f32 v210, v204, v205
  v_mfma_f32_16x16x32_bf16 v[196:199], a[144:147], a[60:63], v[228:231]
  v_exp_f32_e64 v207, v207
  v_mfma_f32_16x16x32_bf16 v[196:199], a[148:151], a[56:59], v[196:199]
  s_add_u32 m0, s30, 32
  v_exp_f32 v200, v200
  v_mfma_f32_16x16x32_bf16 v[196:199], a[152:155], a[52:55], v[196:199]
  s_waitcnt lgkmcnt(0)
  v_cvt_pk_bf16_f32 v208, v200, v201
  v_cvt_pk_bf16_f32 v211, v206, v207
  v_mfma_f32_16x16x32_bf16 v[196:199], a[156:159], a[48:51], v[196:199]
  buffer_store_dwordx4 a[116:119], v233, s[16:19], s35 offen offset:1024
  buffer_load_dwordx4 v221, s[4:7], s33 offen offset:1024 lds
  v_pk_mul_f32 v[200:201], v[192:193], s[28:29] op_sel:[0,1] op_sel_hi:[1,1]
  v_pk_mul_f32 v[202:203], v[194:195], s[28:29] op_sel:[0,1] op_sel_hi:[1,1]
  v_mfma_f32_16x16x32_bf16 v[64:67], v[208:211], a[160:163], v[64:67]
  v_exp_f32 v201, v201
  v_mfma_f32_16x16x32_bf16 v[68:71], v[208:211], a[164:167], v[68:71]
  v_exp_f32_e64 v203, v203
  v_mfma_f32_16x16x32_bf16 v[72:75], v[208:211], a[168:171], v[72:75]
  v_mul_f32 v204, s29, v196
  v_mul_f32 v205, s29, v197
  v_mfma_f32_16x16x32_bf16 v[76:79], v[208:211], a[172:175], v[76:79]
  s_add_u32 m0, s30, s96
  v_mul_f32 v206, s29, v198
  v_mul_f32_e64 v207, s29, v199
  v_mfma_f32_16x16x32_bf16 v[80:83], v[208:211], a[176:179], v[80:83]
  buffer_load_dwordx4 v221, s[8:11], s33 offen lds
  v_mfma_f32_16x16x32_bf16 v[84:87], v[208:211], a[180:183], v[84:87]
  v_exp_f32_e64 v205, v205
  v_mfma_f32_16x16x32_bf16 v[88:91], v[208:211], a[184:187], v[88:91]
  v_exp_f32_e64 v204, v204
  v_mfma_f32_16x16x32_bf16 v[92:95], v[208:211], a[188:191], v[92:95]
  v_exp_f32_e64 v200, v200
  v_mfma_f32_16x16x32_bf16 v[192:195], a[128:131], a[64:67], v[228:231]
  v_cvt_pk_bf16_f32 v212, v200, v201
  v_cvt_pk_bf16_f32 v214, v204, v205
  v_mfma_f32_16x16x32_bf16 v[192:195], a[132:135], a[68:71], v[192:195]
  v_exp_f32_e64 v207, v207
  v_mfma_f32_16x16x32_bf16 v[192:195], a[136:139], a[72:75], v[192:195]
  v_exp_f32_e64 v206, v206
  v_mfma_f32_16x16x32_bf16 v[192:195], a[140:143], a[76:79], v[192:195]
  v_exp_f32_e64 v202, v202
  v_mfma_f32_16x16x32_bf16 v[196:199], a[144:147], a[76:79], v[228:231]
  s_add_u32 m0, s30, s97
  v_cvt_pk_bf16_f32 v213, v202, v203
  v_cvt_pk_bf16_f32 v215, v206, v207
  v_mfma_f32_16x16x32_bf16 v[196:199], a[148:151], a[72:75], v[196:199]
  buffer_load_dwordx4 v221, s[8:11], s33 offen offset:1024 lds
  v_mfma_f32_16x16x32_bf16 v[196:199], a[152:155], a[68:71], v[196:199]
  s_sub_u32 s30, s30, 16896
  v_mul_f32 v201, s29, v193
  v_mul_f32_e64 v202, s29, v194
  v_mfma_f32_16x16x32_bf16 v[196:199], a[156:159], a[64:67], v[196:199]
  s_mov_b32 m0, s36
  v_mul_f32 v200, s29, v192
  v_mul_f32_e64 v203, s29, v195
  v_smfmac_f32_16x16x64_bf16 a[196:199], a[220:223], v[208:215], v254
  buffer_load_dwordx4 v222, s[12:15], s34 offen nt lds
  v_mfma_f32_16x16x32_bf16 v[96:99], v[212:215], a[160:163], v[96:99]
  s_cselect_b32 s30, s31, s30
  v_exp_f32 v200, v200
  v_mfma_f32_16x16x32_bf16 v[100:103], v[212:215], a[164:167], v[100:103]
  buffer_load_dwordx4 v223, s[12:15], s34 offen offset:1024 nt lds
  v_mfma_f32_16x16x32_bf16 v[104:107], v[212:215], a[168:171], v[104:107]
  s_add_u32 s59, s59, 8192
  v_mul_f32 v204, s29, v196
  v_mul_f32 v207, s29, v199
  v_mfma_f32_16x16x32_bf16 v[108:111], v[212:215], a[172:175], v[108:111]
  s_xor_b32 s33, s59, s3
  v_exp_f32 v204, v204
  v_mfma_f32_16x16x32_bf16 v[112:115], v[212:215], a[176:179], v[112:115]
  s_add_u32 s34, s34, 2048
  v_exp_f32_e64 v207, v207
  v_mfma_f32_16x16x32_bf16 v[116:119], v[212:215], a[180:183], v[116:119]
  buffer_store_dwordx4 a[112:115], v233, s[16:19], s35 offen
  v_exp_f32_e64 v203, v203
  v_mfma_f32_16x16x32_bf16 v[120:123], v[212:215], a[184:187], v[120:123]
  s_add_u32 s35, s35, 2048
  v_mul_f32 v205, s29, v197
  v_add_u32 v216, s30, v218
  v_mfma_f32_16x16x32_bf16 v[124:127], v[212:215], a[188:191], v[124:127]
  s_add_u32 s36, s36, 2048
  v_exp_f32_e64 v205, v205
  v_mfma_f32_16x16x32_bf16 v[192:195], a[128:131], a[80:83], v[228:231]
  v_mul_f32_e64 v206, s29, v198
  v_cvt_pk_bf16_f32 v210, v204, v205
  v_mfma_f32_16x16x32_bf16 v[192:195], a[132:135], a[84:87], v[192:195]
  v_exp_f32_e64 v206, v206
  v_mfma_f32_16x16x32_bf16 v[192:195], a[136:139], a[88:91], v[192:195]
  ds_read_b128 a[132:135], v216 offset:64
  v_cvt_pk_bf16_f32 v211, v206, v207
  v_mfma_f32_16x16x32_bf16 v[192:195], a[140:143], a[92:95], v[192:195]
  v_exp_f32_e64 v201, v201
  v_mfma_f32_16x16x32_bf16 v[196:199], a[144:147], a[92:95], v[228:231]
  ds_read_b128 a[140:143], v216 offset:192
  v_cvt_pk_bf16_f32 v208, v200, v201
  v_mfma_f32_16x16x32_bf16 v[196:199], a[148:151], a[88:91], v[196:199]
  v_exp_f32_e64 v202, v202
  v_mfma_f32_16x16x32_bf16 v[196:199], a[152:155], a[84:87], v[196:199]
  ds_read_b128 a[128:131], v216 offset:0
  v_cvt_pk_bf16_f32 v209, v202, v203
  v_mfma_f32_16x16x32_bf16 v[196:199], a[156:159], a[80:83], v[196:199]
  ds_read_b128 a[136:139], v216 offset:128
  v_mul_f32_e64 v200, s29, v192
  v_mfma_f32_16x16x32_bf16 v[128:131], v[208:211], a[160:163], v[128:131]
  ds_read_b128 a[152:155], v216 offset:576
  v_mul_f32_e64 v203, s29, v195
  v_mfma_f32_16x16x32_bf16 v[132:135], v[208:211], a[164:167], v[132:135]
  v_exp_f32_e64 v200, v200
  v_mfma_f32_16x16x32_bf16 v[136:139], v[208:211], a[168:171], v[136:139]
  v_mul_f32 v202, s29, v194
  v_mul_f32 v205, s29, v197
  v_mfma_f32_16x16x32_bf16 v[140:143], v[208:211], a[172:175], v[140:143]
  ds_read_b128 a[144:147], v216 offset:704
  ds_read_b128 a[156:159], v216 offset:512
  v_mfma_f32_16x16x32_bf16 v[144:147], v[208:211], a[176:179], v[144:147]
  s_sub_u32 s37, s37, 1
  v_exp_f32 v202, v202
  v_mfma_f32_16x16x32_bf16 v[148:151], v[208:211], a[180:183], v[148:151]
  s_waitcnt lgkmcnt(4)
  v_mul_f32 v201, s29, v193
  v_add_u32_e64 v217, s30, v219
  v_mfma_f32_16x16x32_bf16 v[152:155], v[208:211], a[184:187], v[152:155]
  ds_read_b128 a[148:151], v216 offset:640
  v_exp_f32 v201, v201
  v_mul_f32 v204, s29, v196
  v_exp_f32_e64 v203, v203
  v_mfma_f32_16x16x32_bf16 v[156:159], v[208:211], a[188:191], v[156:159]
  s_cbranch_scc1 L_exitB
  v_mul_f32 v207, s29, v199
  v_cvt_pk_bf16_f32 v212, v200, v201
  v_mfma_f32_16x16x32_bf16 v[192:195], a[128:131], a[0:3], v[228:231]
  v_mul_f32_e64 v206, s29, v198
  v_cvt_pk_bf16_f32 v213, v202, v203
  v_mfma_f32_16x16x32_bf16 v[192:195], a[132:135], a[4:7], v[192:195]
  s_waitcnt lgkmcnt(3)
  v_exp_f32 v206, v206
  v_mfma_f32_16x16x32_bf16 v[192:195], a[136:139], a[8:11], v[192:195]
  v_exp_f32_e64 v205, v205
  v_mfma_f32_16x16x32_bf16 v[192:195], a[140:143], a[12:15], v[192:195]
  s_waitcnt lgkmcnt(1)
  v_exp_f32 v204, v204
  v_mfma_f32_16x16x32_bf16 v[196:199], a[144:147], a[12:15], v[228:231]
  s_waitcnt lgkmcnt(0)
  v_exp_f32 v207, v207
  v_mfma_f32_16x16x32_bf16 v[196:199], a[148:151], a[8:11], v[196:199]
  v_cvt_pk_bf16_f32 v214, v204, v205
  v_cvt_pk_bf16_f32 v215, v206, v207
  v_mfma_f32_16x16x32_bf16 v[196:199], a[152:155], a[4:7], v[196:199]
  v_mul_f32 v201, s29, v193
  v_mul_f32 v203, s29, v195
  v_mfma_f32_16x16x32_bf16 v[196:199], a[156:159], a[0:3], v[196:199]
  v_mul_f32 v200, s29, v192
  v_mul_f32 v202, s29, v194
  v_mfma_f32_16x16x32_bf16 v[160:163], v[212:215], a[160:163], v[160:163]
  v_exp_f32_e64 v200, v200
  v_mfma_f32_16x16x32_bf16 v[164:167], v[212:215], a[164:167], v[164:167]
  ds_read_b64_tr_b16 a[160:161], v217 offset:8448
  ds_read_b64_tr_b16 a[166:167], v217 offset:8976
  v_mfma_f32_16x16x32_bf16 v[168:171], v[212:215], a[168:171], v[168:171]
  v_exp_f32_e64 v202, v202
  v_mfma_f32_16x16x32_bf16 v[172:175], v[212:215], a[172:175], v[172:175]
  ds_read_b64_tr_b16 a[170:171], v217 offset:8992
  ds_read_b64_tr_b16 a[174:175], v217 offset:9008
  v_mfma_f32_16x16x32_bf16 v[176:179], v[212:215], a[176:179], v[176:179]
  ds_read_b64_tr_b16 a[168:169], v217 offset:8480
  v_mul_f32_e64 v207, s29, v199
  v_mfma_f32_16x16x32_bf16 v[180:183], v[212:215], a[180:183], v[180:183]
  ds_read_b64_tr_b16 a[164:165], v217 offset:8464
  v_mul_f32_e64 v205, s29, v197
  v_mfma_f32_16x16x32_bf16 v[184:187], v[212:215], a[184:187], v[184:187]
  ds_read_b64_tr_b16 a[162:163], v217 offset:8960
  v_mul_f32_e64 v204, s29, v196
  v_mfma_f32_16x16x32_bf16 v[188:191], v[212:215], a[188:191], v[188:191]
  v_exp_f32_e64 v201, v201
  v_smfmac_f32_16x16x64_bf16 a[200:203], a[220:223], v[208:215], v254
  ds_read_b64_tr_b16 a[172:173], v217 offset:8496
  v_exp_f32 v203, v203
  v_mul_f32 v206, s29, v198
L_pB0:
  v_mfma_f32_16x16x32_bf16 v[192:195], a[128:131], a[16:19], v[228:231]
  v_exp_f32_e64 v204, v204
  v_mfma_f32_16x16x32_bf16 v[192:195], a[132:135], a[20:23], v[192:195]
  ds_read_b64_tr_b16 a[176:177], v217 offset:8512
  ds_read_b64_tr_b16 a[178:179], v217 offset:9024
  v_mfma_f32_16x16x32_bf16 v[192:195], a[136:139], a[24:27], v[192:195]
  v_exp_f32_e64 v206, v206
  v_mfma_f32_16x16x32_bf16 v[192:195], a[140:143], a[28:31], v[192:195]
  v_exp_f32_e64 v207, v207
  v_mfma_f32_16x16x32_bf16 v[196:199], a[144:147], a[28:31], v[228:231]
  s_waitcnt lgkmcnt(2)
  v_exp_f32 v205, v205
  v_mfma_f32_16x16x32_bf16 v[196:199], a[148:151], a[24:27], v[196:199]
  ds_read_b64_tr_b16 a[182:183], v217 offset:9040
  v_cvt_pk_bf16_f32 v210, v204, v205
  v_mfma_f32_16x16x32_bf16 v[196:199], a[152:155], a[20:23], v[196:199]
  ds_read_b64_tr_b16 a[180:181], v217 offset:8528
  v_cvt_pk_bf16_f32 v208, v200, v201
  v_cvt_pk_bf16_f32 v209, v202, v203
  v_cvt_pk_bf16_f32 v211, v206, v207
  v_mfma_f32_16x16x32_bf16 v[196:199], a[156:159], a[16:19], v[196:199]
  ds_read_b64_tr_b16 a[184:185], v217 offset:8544
  ds_read_b64_tr_b16 a[186:187], v217 offset:9056
  v_mfma_f32_16x16x32_bf16 v[0:3], v[208:211], a[160:163], v[0:3]
  ds_read_b64_tr_b16 a[188:189], v217 offset:8560
  ds_read_b64_tr_b16 a[190:191], v217 offset:9072
  v_mfma_f32_16x16x32_bf16 v[4:7], v[208:211], a[164:167], v[4:7]
  v_mul_f32 v200, s29, v192
  v_mul_f32 v201, s29, v193
  v_mfma_f32_16x16x32_bf16 v[8:11], v[208:211], a[168:171], v[8:11]
  v_mul_f32 v202, s29, v194
  v_mul_f32 v203, s29, v195
  v_mfma_f32_16x16x32_bf16 v[12:15], v[208:211], a[172:175], v[12:15]
  s_waitcnt lgkmcnt(6)
  v_mul_f32 v206, s29, v198
  v_mul_f32_e64 v207, s29, v199
  v_mfma_f32_16x16x32_bf16 v[16:19], v[208:211], a[176:179], v[16:19]
  s_waitcnt lgkmcnt(4)
  v_mul_f32 v204, s29, v196
  v_mul_f32_e64 v205, s29, v197
  v_mfma_f32_16x16x32_bf16 v[20:23], v[208:211], a[180:183], v[20:23]
  s_waitcnt lgkmcnt(2)
  v_exp_f32 v202, v202
  v_mfma_f32_16x16x32_bf16 v[24:27], v[208:211], a[184:187], v[24:27]
  s_waitcnt lgkmcnt(0)
  v_exp_f32 v206, v206
  v_mfma_f32_16x16x32_bf16 v[28:31], v[208:211], a[188:191], v[28:31]
  v_exp_f32_e64 v201, v201
  v_mfma_f32_16x16x32_bf16 v[192:195], a[128:131], a[32:35], v[228:231]
  v_exp_f32_e64 v200, v200
  v_mfma_f32_16x16x32_bf16 v[192:195], a[132:135], a[36:39], v[192:195]
  v_exp_f32_e64 v205, v205
  v_mfma_f32_16x16x32_bf16 v[192:195], a[136:139], a[40:43], v[192:195]
  v_exp_f32_e64 v203, v203
  v_mfma_f32_16x16x32_bf16 v[192:195], a[140:143], a[44:47], v[192:195]
  v_exp_f32_e64 v204, v204
  v_mfma_f32_16x16x32_bf16 v[196:199], a[144:147], a[44:47], v[228:231]
  v_exp_f32_e64 v207, v207
  v_mfma_f32_16x16x32_bf16 v[196:199], a[148:151], a[40:43], v[196:199]
  v_cvt_pk_bf16_f32 v212, v200, v201
  v_cvt_pk_bf16_f32 v214, v204, v205
  v_mfma_f32_16x16x32_bf16 v[196:199], a[152:155], a[36:39], v[196:199]
  v_cvt_pk_bf16_f32 v213, v202, v203
  v_cvt_pk_bf16_f32 v215, v206, v207
  v_mfma_f32_16x16x32_bf16 v[196:199], a[156:159], a[32:35], v[196:199]
  v_mul_f32 v201, s29, v193
  v_mul_f32 v203, s29, v195
  v_smfmac_f32_16x16x64_bf16 a[192:195], a[220:223], v[208:215], v254
  v_mul_f32_e64 v202, s29, v194
  v_mfma_f32_16x16x32_bf16 v[32:35], v[212:215], a[160:163], v[32:35]
  v_mul_f32_e64 v200, s29, v192
  v_add_u32 v220, 6144, v220
  v_mfma_f32_16x16x32_bf16 v[36:39], v[212:215], a[164:167], v[36:39]
  v_mul_f32 v206, s29, v198
  v_mul_f32 v207, s29, v199
  v_mfma_f32_16x16x32_bf16 v[40:43], v[212:215], a[168:171], v[40:43]
  v_mul_f32 v204, s29, v196
  v_mul_f32 v205, s29, v197
  v_mfma_f32_16x16x32_bf16 v[44:47], v[212:215], a[172:175], v[44:47]
  v_exp_f32_e64 v204, v204
  v_mfma_f32_16x16x32_bf16 v[48:51], v[212:215], a[176:179], v[48:51]
  v_exp_f32_e64 v201, v201
  v_mfma_f32_16x16x32_bf16 v[52:55], v[212:215], a[180:183], v[52:55]
  s_waitcnt vmcnt(11)
  v_exp_f32 v206, v206
  v_mfma_f32_16x16x32_bf16 v[56:59], v[212:215], a[184:187], v[56:59]
  s_barrier
  v_mfma_f32_16x16x32_bf16 v[60:63], v[212:215], a[188:191], v[60:63]
  v_exp_f32 v203, v203
  v_mfma_f32_16x16x32_bf16 v[192:195], a[128:131], a[48:51], v[228:231]
  v_exp_f32_e64 v207, v207
  v_mfma_f32_16x16x32_bf16 v[192:195], a[132:135], a[52:55], v[192:195]
  v_exp_f32_e64 v202, v202
  v_mfma_f32_16x16x32_bf16 v[192:195], a[136:139], a[56:59], v[192:195]
  v_exp_f32_e64 v205, v205
  v_mfma_f32_16x16x32_bf16 v[192:195], a[140:143], a[60:63], v[192:195]
  v_exp_f32_e64 v200, v200
  v_mfma_f32_16x16x32_bf16 v[196:199], a[144:147], a[60:63], v[228:231]
  v_cvt_pk_bf16_f32 v208, v200, v201
  v_cvt_pk_bf16_f32 v211, v206, v207
  v_mfma_f32_16x16x32_bf16 v[196:199], a[148:151], a[56:59], v[196:199]
  s_mov_b32 m0, s30
  v_cvt_pk_bf16_f32 v209, v202, v203
  v_cvt_pk_bf16_f32 v210, v204, v205
  v_mfma_f32_16x16x32_bf16 v[196:199], a[152:155], a[52:55], v[196:199]
  buffer_load_dwordx4 v221, s[4:7], s33 offen lds
  v_mfma_f32_16x16x32_bf16 v[196:199], a[156:159], a[48:51], v[196:199]
  v_mul_f32 v200, s29, v192
  v_mul_f32_e64 v202, s29, v194
  v_mfma_f32_16x16x32_bf16 v[64:67], v[208:211], a[160:163], v[64:67]
  s_add_u32 m0, s30, 32
  v_mul_f32 v201, s29, v193
  v_mul_f32_e64 v203, s29, v195
  v_mfma_f32_16x16x32_bf16 v[68:71], v[208:211], a[164:167], v[68:71]
  buffer_load_dwordx4 v221, s[4:7], s33 offen offset:1024 lds
  v_mfma_f32_16x16x32_bf16 v[72:75], v[208:211], a[168:171], v[72:75]
  v_mul_f32 v205, s29, v197
  v_mul_f32 v207, s29, v199
  v_mfma_f32_16x16x32_bf16 v[76:79], v[208:211], a[172:175], v[76:79]
  v_mul_f32 v204, s29, v196
  v_mul_f32 v206, s29, v198
  v_mfma_f32_16x16x32_bf16 v[80:83], v[208:211], a[176:179], v[80:83]
  v_exp_f32_e64 v207, v207
  v_mfma_f32_16x16x32_bf16 v[84:87], v[208:211], a[180:183], v[84:87]
  v_exp_f32_e64 v204, v204
  v_mfma_f32_16x16x32_bf16 v[88:91], v[208:211], a[184:187], v[88:91]
  v_exp_f32_e64 v205, v205
  v_mfma_f32_16x16x32_bf16 v[92:95], v[208:211], a[188:191], v[92:95]
  v_exp_f32_e64 v206, v206
  v_mfma_f32_16x16x32_bf16 v[192:195], a[128:131], a[96:99], v[228:231]
  v_exp_f32_e64 v202, v202
  v_mfma_f32_16x16x32_bf16 v[192:195], a[132:135], a[100:103], v[192:195]
  v_exp_f32_e64 v203, v203
  v_mfma_f32_16x16x32_bf16 v[192:195], a[136:139], a[104:107], v[192:195]
  v_exp_f32_e64 v201, v201
  v_mfma_f32_16x16x32_bf16 v[192:195], a[140:143], a[108:111], v[192:195]
  v_exp_f32_e64 v200, v200
  v_mfma_f32_16x16x32_bf16 v[196:199], a[144:147], a[108:111], v[228:231]
  s_add_u32 m0, s30, s96
  v_cvt_pk_bf16_f32 v212, v200, v201
  v_cvt_pk_bf16_f32 v214, v204, v205
  v_mfma_f32_16x16x32_bf16 v[196:199], a[148:151], a[104:107], v[196:199]
  buffer_load_dwordx4 v221, s[8:11], s33 offen lds
  v_mfma_f32_16x16x32_bf16 v[196:199], a[152:155], a[100:103], v[196:199]
  v_cvt_pk_bf16_f32 v213, v202, v203
  v_cvt_pk_bf16_f32 v215, v206, v207
  v_mfma_f32_16x16x32_bf16 v[196:199], a[156:159], a[96:99], v[196:199]
  s_add_u32 m0, s30, s97
  v_mul_f32 v200, s29, v192
  v_mul_f32 v202, s29, v194
  v_smfmac_f32_16x16x64_bf16 a[196:199], a[220:223], v[208:215], v254
  buffer_load_dwordx4 v221, s[8:11], s33 offen offset:1024 lds
  v_mfma_f32_16x16x32_bf16 v[96:99], v[212:215], a[160:163], v[96:99]
  s_sub_u32 s30, s30, 16896
  v_mul_f32 v201, s29, v193
  v_mul_f32 v203, s29, v195
  v_mfma_f32_16x16x32_bf16 v[100:103], v[212:215], a[164:167], v[100:103]
  s_cselect_b32 s30, s31, s30
  v_mul_f32 v205, s29, v197
  v_mul_f32_e64 v207, s29, v199
  v_mfma_f32_16x16x32_bf16 v[104:107], v[212:215], a[168:171], v[104:107]
  s_add_u32 s59, s59, 8192
  v_mul_f32 v204, s29, v196
  v_mul_f32 v206, s29, v198
  v_mfma_f32_16x16x32_bf16 v[108:111], v[212:215], a[172:175], v[108:111]
  s_xor_b32 s33, s59, s3
  v_exp_f32 v200, v200
  v_mfma_f32_16x16x32_bf16 v[112:115], v[212:215], a[176:179], v[112:115]
  v_exp_f32_e64 v204, v204
  v_mfma_f32_16x16x32_bf16 v[116:119], v[212:215], a[180:183], v[116:119]
  v_exp_f32_e64 v201, v201
  v_mfma_f32_16x16x32_bf16 v[120:123], v[212:215], a[184:187], v[120:123]
  v_exp_f32_e64 v203, v203
  v_mfma_f32_16x16x32_bf16 v[124:127], v[212:215], a[188:191], v[124:127]
  v_exp_f32_e64 v202, v202
  v_mfma_f32_16x16x32_bf16 v[192:195], a[128:131], a[64:67], v[228:231]
  v_exp_f32_e64 v205, v205
  v_mfma_f32_16x16x32_bf16 v[192:195], a[132:135], a[68:71], v[192:195]
  v_exp_f32_e64 v206, v206
  v_mfma_f32_16x16x32_bf16 v[192:195], a[136:139], a[72:75], v[192:195]
  v_exp_f32_e64 v207, v207
  v_mfma_f32_16x16x32_bf16 v[192:195], a[140:143], a[76:79], v[192:195]
  v_cvt_pk_bf16_f32 v208, v200, v201
  v_cvt_pk_bf16_f32 v209, v202, v203
  v_mfma_f32_16x16x32_bf16 v[196:199], a[144:147], a[76:79], v[228:231]
  v_cvt_pk_bf16_f32 v210, v204, v205
  v_cvt_pk_bf16_f32 v211, v206, v207
  v_mfma_f32_16x16x32_bf16 v[196:199], a[148:151], a[72:75], v[196:199]
  global_load_dword a120, v[252:253], off
  v_mfma_f32_16x16x32_bf16 v[196:199], a[152:155], a[68:71], v[196:199]
  v_mul_f32 v200, s29, v192
  v_mul_f32 v203, s29, v195
  v_mfma_f32_16x16x32_bf16 v[196:199], a[156:159], a[64:67], v[196:199]
  v_mul_f32 v201, s29, v193
  v_mul_f32 v202, s29, v194
  v_mfma_f32_16x16x32_bf16 a[204:207], a[220:223], v[208:211], a[204:207]
  v_exp_f32_e64 v202, v202
  v_mfma_f32_16x16x32_bf16 a[224:227], v[208:211], a[160:163], a[224:227]
  v_exp_f32_e64 v203, v203
  v_mfma_f32_16x16x32_bf16 a[228:231], v[208:211], a[164:167], a[228:231]
  v_mul_f32 v205, s29, v197
  v_mul_f32 v206, s29, v198
  v_mfma_f32_16x16x32_bf16 a[232:235], v[208:211], a[168:171], a[232:235]
  v_mul_f32 v204, s29, v196
  v_mul_f32 v207, s29, v199
  v_mfma_f32_16x16x32_bf16 a[236:239], v[208:211], a[172:175], a[236:239]
  v_exp_f32_e64 v205, v205
  v_mfma_f32_16x16x32_bf16 a[240:243], v[208:211], a[176:179], a[240:243]
  v_exp_f32_e64 v204, v204
  v_mfma_f32_16x16x32_bf16 a[244:247], v[208:211], a[180:183], a[244:247]
  v_exp_f32_e64 v200, v200
  v_mfma_f32_16x16x32_bf16 a[248:251], v[208:211], a[184:187], a[248:251]
  v_exp_f32_e64 v206, v206
  v_mfma_f32_16x16x32_bf16 a[252:255], v[208:211], a[188:191], a[252:255]
  v_exp_f32_e64 v207, v207
  v_mfma_f32_16x16x32_bf16 v[192:195], a[128:131], a[80:83], v[228:231]
  v_exp_f32_e64 v201, v201
  v_mfma_f32_16x16x32_bf16 v[192:195], a[132:135], a[84:87], v[192:195]
  v_cvt_pk_bf16_f32 v210, v204, v205
  v_cvt_pk_bf16_f32 v211, v206, v207
  v_mfma_f32_16x16x32_bf16 v[192:195], a[136:139], a[88:91], v[192:195]
  v_cvt_pk_bf16_f32 v208, v200, v201
  v_cvt_pk_bf16_f32 v209, v202, v203
  v_mfma_f32_16x16x32_bf16 v[192:195], a[140:143], a[92:95], v[192:195]
  v_add_u32 v216, s30, v218
  v_add_u32 v217, s30, v219
  v_mfma_f32_16x16x32_bf16 v[196:199], a[144:147], a[92:95], v[228:231]
  ds_read_b128 a[128:131], v216 offset:0
  ds_read_b128 a[132:135], v216 offset:64
  v_mfma_f32_16x16x32_bf16 v[196:199], a[148:151], a[88:91], v[196:199]
  ds_read_b128 a[136:139], v216 offset:128
  ds_read_b128 a[140:143], v216 offset:192
  v_mfma_f32_16x16x32_bf16 v[196:199], a[152:155], a[84:87], v[196:199]
  v_mul_f32 v201, s29, v193
  v_mul_f32 v202, s29, v194
  v_mfma_f32_16x16x32_bf16 v[196:199], a[156:159], a[80:83], v[196:199]
  ds_read_b128 a[144:147], v216 offset:704
  v_mul_f32_e64 v203, s29, v195
  v_mfma_f32_16x16x32_bf16 v[128:131], v[208:211], a[160:163], v[128:131]
  ds_read_b128 a[152:155], v216 offset:576
  v_mul_f32_e64 v200, s29, v192
  v_mfma_f32_16x16x32_bf16 v[132:135], v[208:211], a[164:167], v[132:135]
  ds_read_b128 a[148:151], v216 offset:640
  ds_read_b128 a[156:159], v216 offset:512
  v_mfma_f32_16x16x32_bf16 v[136:139], v[208:211], a[168:171], v[136:139]
  v_exp_f32_e64 v203, v203
  v_mfma_f32_16x16x32_bf16 v[140:143], v[208:211], a[172:175], v[140:143]
  v_exp_f32_e64 v202, v202
  v_mfma_f32_16x16x32_bf16 v[144:147], v[208:211], a[176:179], v[144:147]
  v_exp_f32_e64 v201, v201
  v_mfma_f32_16x16x32_bf16 v[148:151], v[208:211], a[180:183], v[148:151]
  s_sub_u32 s37, s37, 1
  v_mul_f32 v204, s29, v196
  v_mul_f32_e64 v205, s29, v197
  v_mfma_f32_16x16x32_bf16 v[152:155], v[208:211], a[184:187], v[152:155]
  s_waitcnt lgkmcnt(3)
  v_exp_f32 v200, v200
  v_mfma_f32_16x16x32_bf16 v[156:159], v[208:211], a[188:191], v[156:159]
  s_cbranch_scc1 L_exitB
  v_mul_f32 v206, s29, v198
  v_mul_f32_e64 v207, s29, v199
  v_mfma_f32_16x16x32_bf16 v[192:195], a[128:131], a[0:3], v[228:231]
  v_exp_f32_e64 v206, v206
  v_mfma_f32_16x16x32_bf16 v[192:195], a[132:135], a[4:7], v[192:195]
  v_exp_f32_e64 v207, v207
  v_mfma_f32_16x16x32_bf16 v[192:195], a[136:139], a[8:11], v[192:195]
  v_exp_f32_e64 v204, v204
  v_mfma_f32_16x16x32_bf16 v[192:195], a[140:143], a[12:15], v[192:195]
  v_exp_f32_e64 v205, v205
  v_mfma_f32_16x16x32_bf16 v[196:199], a[144:147], a[12:15], v[228:231]
  s_waitcnt lgkmcnt(0)
  v_cvt_pk_bf16_f32 v214, v204, v205
  v_cvt_pk_bf16_f32 v215, v206, v207
  v_mfma_f32_16x16x32_bf16 v[196:199], a[148:151], a[8:11], v[196:199]
  v_cvt_pk_bf16_f32 v212, v200, v201
  v_cvt_pk_bf16_f32 v213, v202, v203
  v_mfma_f32_16x16x32_bf16 v[196:199], a[152:155], a[4:7], v[196:199]
  v_mul_f32 v200, s29, v192
  v_mul_f32_e64 v203, s29, v195
  v_mfma_f32_16x16x32_bf16 v[196:199], a[156:159], a[0:3], v[196:199]
  v_mul_f32 v201, s29, v193
  v_mul_f32 v202, s29, v194
  v_mfma_f32_16x16x32_bf16 v[160:163], v[212:215], a[160:163], v[160:163]
  ds_read_b64_tr_b16 a[160:161], v217 offset:8448
  ds_read_b64_tr_b16 a[162:163], v217 offset:8960
  v_mfma_f32_16x16x32_bf16 v[164:167], v[212:215], a[164:167], v[164:167]
  v_exp_f32_e64 v201, v201
  v_mfma_f32_16x16x32_bf16 v[168:171], v[212:215], a[168:171], v[168:171]
  ds_read_b64_tr_b16 a[168:169], v217 offset:8480
  v_mul_f32_e64 v205, s29, v197
  v_mfma_f32_16x16x32_bf16 v[172:175], v[212:215], a[172:175], v[172:175]
  v_exp_f32_e64 v200, v200
  v_mfma_f32_16x16x32_bf16 v[176:179], v[212:215], a[176:179], v[176:179]
  ds_read_b64_tr_b16 a[166:167], v217 offset:8976
  v_mul_f32_e64 v206, s29, v198
  v_mfma_f32_16x16x32_bf16 v[180:183], v[212:215], a[180:183], v[180:183]
  ds_read_b64_tr_b16 a[164:165], v217 offset:8464
  v_mul_f32_e64 v204, s29, v196
  v_mfma_f32_16x16x32_bf16 v[184:187], v[212:215], a[184:187], v[184:187]
  v_exp_f32_e64 v202, v202
  v_mfma_f32_16x16x32_bf16 v[188:191], v[212:215], a[188:191], v[188:191]
  ds_read_b64_tr_b16 a[172:173], v217 offset:8496
  ds_read_b64_tr_b16 a[174:175], v217 offset:9008
  v_smfmac_f32_16x16x64_bf16 a[200:203], a[220:223], v[208:215], v254
  ds_read_b64_tr_b16 a[170:171], v217 offset:8992
  v_exp_f32 v203, v203
  v_mul_f32_e64 v207, s29, v199
  s_branch L_pB1
L_selB:
  s_cmp_eq_u32 s28, 3
  s_cbranch_scc1 L_fB3
  s_cmp_eq_u32 s28, 2
  s_cbranch_scc1 L_fB2
L_fB1:
  v_mfma_f32_16x16x32_bf16 v[192:195], a[128:131], a[16:19], v[228:231]
  ds_read_b64_tr_b16 a[176:177], v217 offset:8512
  ds_read_b64_tr_b16 a[178:179], v217 offset:9024
  v_mfma_f32_16x16x32_bf16 v[192:195], a[132:135], a[20:23], v[192:195]
  v_exp_f32_e64 v204, v204
  v_mfma_f32_16x16x32_bf16 v[192:195], a[136:139], a[24:27], v[192:195]
  v_exp_f32_e64 v206, v206
  v_mfma_f32_16x16x32_bf16 v[192:195], a[140:143], a[28:31], v[192:195]
  v_exp_f32_e64 v207, v207
  v_mfma_f32_16x16x32_bf16 v[196:199], a[144:147], a[28:31], v[228:231]
  s_waitcnt lgkmcnt(2)
  v_exp_f32 v205, v205
  v_mfma_f32_16x16x32_bf16 v[196:199], a[148:151], a[24:27], v[196:199]
  ds_read_b64_tr_b16 a[180:181], v217 offset:8528
  v_cvt_pk_bf16_f32 v210, v204, v205
  v_mfma_f32_16x16x32_bf16 v[196:199], a[152:155], a[20:23], v[196:199]
  ds_read_b64_tr_b16 a[182:183], v217 offset:9040
  v_cvt_pk_bf16_f32 v208, v200, v201
  v_cvt_pk_bf16_f32 v209, v202, v203
  v_cvt_pk_bf16_f32 v211, v206, v207
  v_mfma_f32_16x16x32_bf16 v[196:199], a[156:159], a[16:19], v[196:199]
  ds_read_b64_tr_b16 a[184:185], v217 offset:8544
  ds_read_b64_tr_b16 a[186:187], v217 offset:9056
  v_mfma_f32_16x16x32_bf16 v[0:3], v[208:211], a[160:163], 0
  ds_read_b64_tr_b16 a[188:189], v217 offset:8560
  ds_read_b64_tr_b16 a[190:191], v217 offset:9072
  v_mfma_f32_16x16x32_bf16 v[4:7], v[208:211], a[164:167], 0
  v_mul_f32 v200, s29, v192
  v_mul_f32 v201, s29, v193
  v_mfma_f32_16x16x32_bf16 v[8:11], v[208:211], a[168:171], 0
  v_mul_f32 v202, s29, v194
  v_mul_f32 v203, s29, v195
  v_mfma_f32_16x16x32_bf16 v[12:15], v[208:211], a[172:175], 0
  s_waitcnt lgkmcnt(6)
  v_mul_f32 v206, s29, v198
  v_mul_f32_e64 v207, s29, v199
  v_mfma_f32_16x16x32_bf16 v[16:19], v[208:211], a[176:179], 0
  s_waitcnt lgkmcnt(4)
  v_mul_f32 v204, s29, v196
  v_mul_f32_e64 v205, s29, v197
  v_mfma_f32_16x16x32_bf16 v[20:23], v[208:211], a[180:183], 0
  s_waitcnt lgkmcnt(2)
  v_exp_f32 v202, v202
  v_mfma_f32_16x16x32_bf16 v[24:27], v[208:211], a[184:187], 0
  s_waitcnt lgkmcnt(0)
  v_exp_f32 v206, v206
  v_mfma_f32_16x16x32_bf16 v[28:31], v[208:211], a[188:191], 0
  v_exp_f32_e64 v201, v201
  v_mfma_f32_16x16x32_bf16 v[192:195], a[128:131], a[32:35], v[228:231]
  v_exp_f32_e64 v200, v200
  v_mfma_f32_16x16x32_bf16 v[192:195], a[132:135], a[36:39], v[192:195]
  v_exp_f32_e64 v205, v205
  v_mfma_f32_16x16x32_bf16 v[192:195], a[136:139], a[40:43], v[192:195]
  v_exp_f32_e64 v203, v203
  v_mfma_f32_16x16x32_bf16 v[192:195], a[140:143], a[44:47], v[192:195]
  v_exp_f32_e64 v204, v204
  v_mfma_f32_16x16x32_bf16 v[196:199], a[144:147], a[44:47], v[228:231]
  s_barrier
  v_cvt_pk_bf16_f32 v214, v204, v205
  v_mfma_f32_16x16x32_bf16 v[196:199], a[148:151], a[40:43], v[196:199]
  v_exp_f32 v207, v207
  v_mfma_f32_16x16x32_bf16 v[196:199], a[152:155], a[36:39], v[196:199]
  s_mov_b32 m0, s30
  v_cvt_pk_bf16_f32 v212, v200, v201
  v_cvt_pk_bf16_f32 v213, v202, v203
  v_cvt_pk_bf16_f32 v215, v206, v207
  v_mfma_f32_16x16x32_bf16 v[196:199], a[156:159], a[32:35], v[196:199]
  buffer_load_dwordx4 v221, s[4:7], s33 offen lds
  v_smfmac_f32_16x16x64_bf16 a[192:195], a[220:223], v[208:215], v254
  ds_read_b64_tr_b16 a[112:113], v220 offset:0
  v_mul_f32 v201, s29, v193
  v_mfma_f32_16x16x32_bf16 v[32:35], v[212:215], a[160:163], 0
  v_mul_f32 v202, s29, v194
  v_mul_f32 v203, s29, v195
  v_mfma_f32_16x16x32_bf16 v[36:39], v[212:215], a[164:167], 0
  ds_read_b64_tr_b16 a[114:115], v220 offset:64
  v_mul_f32_e64 v200, s29, v192
  v_mfma_f32_16x16x32_bf16 v[40:43], v[212:215], a[168:171], 0
  ds_read_b64_tr_b16 a[116:117], v220 offset:1024
  ds_read_b64_tr_b16 a[118:119], v220 offset:1088
  v_mfma_f32_16x16x32_bf16 v[44:47], v[212:215], a[172:175], 0
  v_mul_f32 v206, s29, v198
  v_mul_f32 v207, s29, v199
  v_mfma_f32_16x16x32_bf16 v[48:51], v[212:215], a[176:179], 0
  v_mul_f32 v204, s29, v196
  v_mul_f32 v205, s29, v197
  v_mfma_f32_16x16x32_bf16 v[52:55], v[212:215], a[180:183], 0
  v_exp_f32_e64 v204, v204
  v_mfma_f32_16x16x32_bf16 v[56:59], v[212:215], a[184:187], 0
  v_exp_f32_e64 v201, v201
  v_mfma_f32_16x16x32_bf16 v[60:63], v[212:215], a[188:191], 0
  v_exp_f32_e64 v206, v206
  v_mfma_f32_16x16x32_bf16 v[192:195], a[128:131], a[48:51], v[228:231]
  s_add_u32 m0, s30, 32
  v_exp_f32 v203, v203
  v_mfma_f32_16x16x32_bf16 v[192:195], a[132:135], a[52:55], v[192:195]
  buffer_load_dwordx4 v221, s[4:7], s33 offen offset:1024 lds
  v_mfma_f32_16x16x32_bf16 v[192:195], a[136:139], a[56:59], v[192:195]
  v_exp_f32_e64 v207, v207
  v_mfma_f32_16x16x32_bf16 v[192:195], a[140:143], a[60:63], v[192:195]
  v_exp_f32_e64 v202, v202
  v_mfma_f32_16x16x32_bf16 v[196:199], a[144:147], a[60:63], v[228:231]
  v_exp_f32_e64 v205, v205
  v_mfma_f32_16x16x32_bf16 v[196:199], a[148:151], a[56:59], v[196:199]
  s_add_u32 m0, s30, s96
  v_exp_f32 v200, v200
  v_mfma_f32_16x16x32_bf16 v[196:199], a[152:155], a[52:55], v[196:199]
  s_waitcnt lgkmcnt(0)
  v_cvt_pk_bf16_f32 v208, v200, v201
  v_cvt_pk_bf16_f32 v209, v202, v203
  v_cvt_pk_bf16_f32 v210, v204, v205
  v_cvt_pk_bf16_f32 v211, v206, v207
  v_mfma_f32_16x16x32_bf16 v[196:199], a[156:159], a[48:51], v[196:199]
  buffer_store_dwordx4 a[116:119], v233, s[16:19], s35 offen offset:1024
  buffer_load_dwordx4 v221, s[8:11], s33 offen lds
  v_pk_mul_f32 v[200:201], v[192:193], s[28:29] op_sel:[0,1] op_sel_hi:[1,1]
  v_pk_mul_f32 v[202:203], v[194:195], s[28:29] op_sel:[0,1] op_sel_hi:[1,1]
  v_mfma_f32_16x16x32_bf16 v[64:67], v[208:211], a[160:163], 0
  v_exp_f32 v203, v203
  v_mfma_f32_16x16x32_bf16 v[68:71], v[208:211], a[164:167], 0
  s_add_u32 m0, s30, s97
  v_exp_f32 v202, v202
  v_mfma_f32_16x16x32_bf16 v[72:75], v[208:211], a[168:171], 0
  buffer_load_dwordx4 v221, s[8:11], s33 offen offset:1024 lds
  v_mfma_f32_16x16x32_bf16 v[76:79], v[208:211], a[172:175], 0
  s_sub_u32 s30, s30, 16896
  v_mul_f32 v204, s29, v196
  v_mul_f32 v207, s29, v199
  v_mfma_f32_16x16x32_bf16 v[80:83], v[208:211], a[176:179], 0
  s_cselect_b32 s30, s31, s30
  v_mul_f32 v205, s29, v197
  v_mul_f32_e64 v206, s29, v198
  v_mfma_f32_16x16x32_bf16 v[84:87], v[208:211], a[180:183], 0
  s_add_u32 s59, s59, 8192
  v_exp_f32_e64 v207, v207
  v_mfma_f32_16x16x32_bf16 v[88:91], v[208:211], a[184:187], 0
  s_xor_b32 s33, s59, s3
  v_exp_f32 v206, v206
  v_mfma_f32_16x16x32_bf16 v[92:95], v[208:211], a[188:191], 0
  v_exp_f32_e64 v205, v205
  v_mfma_f32_16x16x32_bf16 v[192:195], a[128:131], a[64:67], v[228:231]
  v_exp_f32_e64 v204, v204
  v_mfma_f32_16x16x32_bf16 v[192:195], a[132:135], a[68:71], v[192:195]
  v_exp_f32_e64 v201, v201
  v_mfma_f32_16x16x32_bf16 v[192:195], a[136:139], a[72:75], v[192:195]
  v_exp_f32_e64 v200, v200
  v_mfma_f32_16x16x32_bf16 v[192:195], a[140:143], a[76:79], v[192:195]
  v_cvt_pk_bf16_f32 v212, v200, v201
  v_cvt_pk_bf16_f32 v213, v202, v203
  v_mfma_f32_16x16x32_bf16 v[196:199], a[144:147], a[76:79], v[228:231]
  s_mov_b32 m0, s36
  v_cvt_pk_bf16_f32 v214, v204, v205
  v_cvt_pk_bf16_f32 v215, v206, v207
  v_mfma_f32_16x16x32_bf16 v[196:199], a[148:151], a[72:75], v[196:199]
  buffer_load_dwordx4 v222, s[12:15], s34 offen nt lds
  v_mfma_f32_16x16x32_bf16 v[196:199], a[152:155], a[68:71], v[196:199]
  s_add_u32 s36, s36, 2048
  v_mul_f32 v200, s29, v192
  v_mul_f32_e64 v203, s29, v195
  v_mfma_f32_16x16x32_bf16 v[196:199], a[156:159], a[64:67], v[196:199]
  v_mul_f32 v201, s29, v193
  v_mul_f32 v202, s29, v194
  v_smfmac_f32_16x16x64_bf16 a[196:199], a[220:223], v[208:215], v254
  buffer_load_dwordx4 v223, s[12:15], s34 offen offset:1024 nt lds
  v_mfma_f32_16x16x32_bf16 v[96:99], v[212:215], a[160:163], 0
  buffer_store_dwordx4 a[112:115], v233, s[16:19], s35 offen
  v_exp_f32_e64 v202, v202
  v_mfma_f32_16x16x32_bf16 v[100:103], v[212:215], a[164:167], 0
  s_add_u32 s35, s35, 2048
  v_mul_f32 v204, s29, v196
  v_mul_f32 v207, s29, v199
  v_mfma_f32_16x16x32_bf16 v[104:107], v[212:215], a[168:171], 0
  s_add_u32 s34, s34, 2048
  v_mul_f32 v205, s29, v197
  v_mul_f32 v206, s29, v198
  v_mfma_f32_16x16x32_bf16 v[108:111], v[212:215], a[172:175], 0
  v_exp_f32_e64 v204, v204
  v_mfma_f32_16x16x32_bf16 v[112:115], v[212:215], a[176:179], 0
  v_exp_f32_e64 v203, v203
  v_mfma_f32_16x16x32_bf16 v[116:119], v[212:215], a[180:183], 0
  v_exp_f32_e64 v207, v207
  v_mfma_f32_16x16x32_bf16 v[120:123], v[212:215], a[184:187], 0
  v_exp_f32_e64 v201, v201
  v_mfma_f32_16x16x32_bf16 v[124:127], v[212:215], a[188:191], 0
  v_exp_f32_e64 v200, v200
  v_mfma_f32_16x16x32_bf16 v[192:195], a[128:131], a[80:83], v[228:231]
  v_exp_f32_e64 v206, v206
  v_mfma_f32_16x16x32_bf16 v[192:195], a[132:135], a[84:87], v[192:195]
  v_exp_f32_e64 v205, v205
  v_mfma_f32_16x16x32_bf16 v[192:195], a[136:139], a[88:91], v[192:195]
  v_cvt_pk_bf16_f32 v208, v200, v201
  v_cvt_pk_bf16_f32 v209, v202, v203
  v_mfma_f32_16x16x32_bf16 v[192:195], a[140:143], a[92:95], v[192:195]
  v_cvt_pk_bf16_f32 v210, v204, v205
  v_cvt_pk_bf16_f32 v211, v206, v207
  v_mfma_f32_16x16x32_bf16 v[196:199], a[144:147], a[92:95], v[228:231]
  v_add_u32 v216, s30, v218
  v_add_u32 v217, s30, v219
  v_mfma_f32_16x16x32_bf16 v[196:199], a[148:151], a[88:91], v[196:199]
  ds_read_b128 a[128:131], v216 offset:0
  ds_read_b128 a[132:135], v216 offset:64
  v_mfma_f32_16x16x32_bf16 v[196:199], a[152:155], a[84:87], v[196:199]
  ds_read_b128 a[136:139], v216 offset:128
  ds_read_b128 a[140:143], v216 offset:192
  v_mfma_f32_16x16x32_bf16 v[196:199], a[156:159], a[80:83], v[196:199]
  v_mul_f32 v202, s29, v194
  v_mul_f32 v203, s29, v195
  v_mfma_f32_16x16x32_bf16 v[128:131], v[208:211], a[160:163], 0
  ds_read_b128 a[144:147], v216 offset:704
  v_mul_f32_e64 v201, s29, v193
  v_mfma_f32_16x16x32_bf16 v[132:135], v[208:211], a[164:167], 0
  ds_read_b128 a[156:159], v216 offset:512
  v_mul_f32_e64 v200, s29, v192
  v_mfma_f32_16x16x32_bf16 v[136:139], v[208:211], a[168:171], 0
  v_exp_f32_e64 v203, v203
  v_mfma_f32_16x16x32_bf16 v[140:143], v[208:211], a[172:175], 0
  ds_read_b128 a[152:155], v216 offset:576
  v_mul_f32_e64 v205, s29, v197
  v_mfma_f32_16x16x32_bf16 v[144:147], v[208:211], a[176:179], 0
  v_exp_f32_e64 v201, v201
  v_mfma_f32_16x16x32_bf16 v[148:151], v[208:211], a[180:183], 0
  ds_read_b128 a[148:151], v216 offset:640
  v_mul_f32_e64 v204, s29, v196
  v_mfma_f32_16x16x32_bf16 v[152:155], v[208:211], a[184:187], 0
  v_exp_f32 v200, v200
  v_exp_f32 v202, v202
  v_mfma_f32_16x16x32_bf16 v[156:159], v[208:211], a[188:191], 0
  s_waitcnt lgkmcnt(3)
  v_mul_f32 v206, s29, v198
  v_mul_f32_e64 v207, s29, v199
  v_mfma_f32_16x16x32_bf16 v[192:195], a[128:131], a[0:3], v[228:231]
  v_exp_f32_e64 v205, v205
  v_mfma_f32_16x16x32_bf16 v[192:195], a[132:135], a[4:7], v[192:195]
  v_exp_f32_e64 v206, v206
  v_mfma_f32_16x16x32_bf16 v[192:195], a[136:139], a[8:11], v[192:195]
  v_exp_f32_e64 v204, v204
  v_mfma_f32_16x16x32_bf16 v[192:195], a[140:143], a[12:15], v[192:195]
  v_exp_f32_e64 v207, v207
  v_mfma_f32_16x16x32_bf16 v[196:199], a[144:147], a[12:15], v[228:231]
  s_waitcnt lgkmcnt(0)
  v_cvt_pk_bf16_f32 v212, v200, v201
  v_cvt_pk_bf16_f32 v213, v202, v203
  v_mfma_f32_16x16x32_bf16 v[196:199], a[148:151], a[8:11], v[196:199]
  v_cvt_pk_bf16_f32 v214, v204, v205
  v_cvt_pk_bf16_f32 v215, v206, v207
  v_mfma_f32_16x16x32_bf16 v[196:199], a[152:155], a[4:7], v[196:199]
  v_mul_f32 v200, s29, v192
  v_mul_f32_e64 v203, s29, v195
  v_mfma_f32_16x16x32_bf16 v[196:199], a[156:159], a[0:3], v[196:199]
  v_mul_f32 v201, s29, v193
  v_mul_f32 v202, s29, v194
  v_mfma_f32_16x16x32_bf16 v[160:163], v[212:215], a[160:163], 0
  v_exp_f32_e64 v201, v201
  v_mfma_f32_16x16x32_bf16 v[164:167], v[212:215], a[164:167], 0
  v_exp_f32_e64 v200, v200
  v_mfma_f32_16x16x32_bf16 v[168:171], v[212:215], a[168:171], 0
  ds_read_b64_tr_b16 a[168:169], v217 offset:8480
  v_mul_f32_e64 v205, s29, v197
  v_mfma_f32_16x16x32_bf16 v[172:175], v[212:215], a[172:175], 0
  ds_read_b64_tr_b16 a[170:171], v217 offset:8992
  ds_read_b64_tr_b16 a[172:173], v217 offset:8496
  v_mfma_f32_16x16x32_bf16 v[176:179], v[212:215], a[176:179], 0
  v_mul_f32 v204, s29, v196
  v_mul_f32 v206, s29, v198
  v_mfma_f32_16x16x32_bf16 v[180:183], v[212:215], a[180:183], 0
  ds_read_b64_tr_b16 a[162:163], v217 offset:8960
  ds_read_b64_tr_b16 a[166:167], v217 offset:8976
  v_mfma_f32_16x16x32_bf16 v[184:187], v[212:215], a[184:187], 0
  s_waitcnt vmcnt(12)
  v_exp_f32 v202, v202
  v_mfma_f32_16x16x32_bf16 v[188:191], v[212:215], a[188:191], 0
  ds_read_b64_tr_b16 a[160:161], v217 offset:8448
  ds_read_b64_tr_b16 a[174:175], v217 offset:9008
  v_smfmac_f32_16x16x64_bf16 a[200:203], a[220:223], v[208:215], v254
  ds_read_b64_tr_b16 a[164:165], v217 offset:8464
  v_exp_f32 v203, v203
  v_mul_f32 v207, s29, v199
  s_cmp_eq_u32 s38, 1
  s_cselect_b32 s37, 12, 14
  s_cbranch_scc1 L_pD2
  s_branch L_pB2
L_fB2:
  v_mfma_f32_16x16x32_bf16 v[192:195], a[128:131], a[16:19], v[228:231]
  v_exp_f32_e64 v206, v206
  v_mfma_f32_16x16x32_bf16 v[192:195], a[132:135], a[20:23], v[192:195]
  ds_read_b64_tr_b16 a[176:177], v217 offset:8512
  ds_read_b64_tr_b16 a[178:179], v217 offset:9024
  v_mfma_f32_16x16x32_bf16 v[192:195], a[136:139], a[24:27], v[192:195]
  v_exp_f32_e64 v205, v205
  v_mfma_f32_16x16x32_bf16 v[192:195], a[140:143], a[28:31], v[192:195]
  ds_read_b64_tr_b16 a[182:183], v217 offset:9040
  v_cvt_pk_bf16_f32 v209, v202, v203
  v_mfma_f32_16x16x32_bf16 v[196:199], a[144:147], a[28:31], v[228:231]
  v_exp_f32_e64 v207, v207
  v_mfma_f32_16x16x32_bf16 v[196:199], a[148:151], a[24:27], v[196:199]
  s_waitcnt lgkmcnt(3)
  v_exp_f32 v204, v204
  v_mfma_f32_16x16x32_bf16 v[196:199], a[152:155], a[20:23], v[196:199]
  ds_read_b64_tr_b16 a[180:181], v217 offset:8528
  v_cvt_pk_bf16_f32 v208, v200, v201
  v_cvt_pk_bf16_f32 v210, v204, v205
  v_cvt_pk_bf16_f32 v211, v206, v207
  v_mfma_f32_16x16x32_bf16 v[196:199], a[156:159], a[16:19], v[196:199]
  ds_read_b64_tr_b16 a[184:185], v217 offset:8544
  ds_read_b64_tr_b16 a[186:187], v217 offset:9056
  v_mfma_f32_16x16x32_bf16 v[0:3], v[208:211], a[160:163], 0
  ds_read_b64_tr_b16 a[188:189], v217 offset:8560
  ds_read_b64_tr_b16 a[190:191], v217 offset:9072
  v_mfma_f32_16x16x32_bf16 v[4:7], v[208:211], a[164:167], 0
  v_mul_f32 v201, s29, v193
  v_mul_f32 v203, s29, v195
  v_mfma_f32_16x16x32_bf16 v[8:11], v[208:211], a[168:171], 0
  v_mul_f32 v200, s29, v192
  v_mul_f32 v202, s29, v194
  v_mfma_f32_16x16x32_bf16 v[12:15], v[208:211], a[172:175], 0
  s_waitcnt lgkmcnt(5)
  v_mul_f32 v204, s29, v196
  v_mul_f32_e64 v206, s29, v198
  v_mfma_f32_16x16x32_bf16 v[16:19], v[208:211], a[176:179], 0
  s_waitcnt lgkmcnt(4)
  v_mul_f32 v205, s29, v197
  v_mul_f32_e64 v207, s29, v199
  v_mfma_f32_16x16x32_bf16 v[20:23], v[208:211], a[180:183], 0
  s_waitcnt lgkmcnt(2)
  v_exp_f32 v205, v205
  v_mfma_f32_16x16x32_bf16 v[24:27], v[208:211], a[184:187], 0
  s_waitcnt lgkmcnt(0)
  v_exp_f32 v200, v200
  v_mfma_f32_16x16x32_bf16 v[28:31], v[208:211], a[188:191], 0
  v_exp_f32_e64 v202, v202
  v_mfma_f32_16x16x32_bf16 v[192:195], a[128:131], a[32:35], v[228:231]
  v_exp_f32_e64 v206, v206
  v_mfma_f32_16x16x32_bf16 v[192:195], a[132:135], a[36:39], v[192:195]
  v_exp_f32_e64 v207, v207
  v_mfma_f32_16x16x32_bf16 v[192:195], a[136:139], a[40:43], v[192:195]
  v_exp_f32_e64 v204, v204
  v_mfma_f32_16x16x32_bf16 v[192:195], a[140:143], a[44:47], v[192:195]
  v_cvt_pk_bf16_f32 v214, v204, v205
  v_cvt_pk_bf16_f32 v215, v206, v207
  v_mfma_f32_16x16x32_bf16 v[196:199], a[144:147], a[44:47], v[228:231]
  v_exp_f32_e64 v201, v201
  v_mfma_f32_16x16x32_bf16 v[196:199], a[148:151], a[40:43], v[196:199]
  v_exp_f32_e64 v203, v203
  v_mfma_f32_16x16x32_bf16 v[196:199], a[152:155], a[36:39], v[196:199]
  v_cvt_pk_bf16_f32 v212, v200, v201
  v_cvt_pk_bf16_f32 v213, v202, v203
  v_mfma_f32_16x16x32_bf16 v[196:199], a[156:159], a[32:35], v[196:199]
  v_mul_f32 v200, s29, v192
  v_mul_f32 v203, s29, v195
  v_smfmac_f32_16x16x64_bf16 a[192:195], a[220:223], v[208:215], v254
  s_barrier
  v_mul_f32 v202, s29, v194
  v_mfma_f32_16x16x32_bf16 v[32:35], v[212:215], a[160:163], 0
  ds_read_b64_tr_b16 a[112:113], v220 offset:2048
  ds_read_b64_tr_b16 a[114:115], v220 offset:2112
  v_mfma_f32_16x16x32_bf16 v[36:39], v[212:215], a[164:167], 0
  ds_read_b64_tr_b16 a[116:117], v220 offset:3072
  ds_read_b64_tr_b16 a[118:119], v220 offset:3136
  v_mfma_f32_16x16x32_bf16 v[40:43], v[212:215], a[168:171], 0
  s_mov_b32 m0, s30
  v_mul_f32 v201, s29, v193
  v_mul_f32_e64 v205, s29, v197
  v_mfma_f32_16x16x32_bf16 v[44:47], v[212:215], a[172:175], 0
  buffer_load_dwordx4 v221, s[4:7], s33 offen lds
  v_mfma_f32_16x16x32_bf16 v[48:51], v[212:215], a[176:179], 0
  v_mul_f32 v204, s29, v196
  v_mul_f32 v206, s29, v198
  v_mfma_f32_16x16x32_bf16 v[52:55], v[212:215], a[180:183], 0
  v_exp_f32_e64 v202, v202
  v_mfma_f32_16x16x32_bf16 v[56:59], v[212:215], a[184:187], 0
  v_exp_f32_e64 v204, v204
  v_mfma_f32_16x16x32_bf16 v[60:63], v[212:215], a[188:191], 0
  v_exp_f32_e64 v200, v200
  v_mfma_f32_16x16x32_bf16 v[192:195], a[128:131], a[48:51], v[228:231]
  v_exp_f32_e64 v203, v203
  v_mfma_f32_16x16x32_bf16 v[192:195], a[132:135], a[52:55], v[192:195]
  v_mul_f32_e64 v207, s29, v199
  v_cvt_pk_bf16_f32 v209, v202, v203
  v_mfma_f32_16x16x32_bf16 v[192:195], a[136:139], a[56:59], v[192:195]
  v_exp_f32_e64 v207, v207
  v_mfma_f32_16x16x32_bf16 v[192:195], a[140:143], a[60:63], v[192:195]
  v_exp_f32_e64 v201, v201
  v_mfma_f32_16x16x32_bf16 v[196:199], a[144:147], a[60:63], v[228:231]
  v_exp_f32_e64 v205, v205
  v_mfma_f32_16x16x32_bf16 v[196:199], a[148:151], a[56:59], v[196:199]
  s_add_u32 m0, s30, 32
  v_exp_f32 v206, v206
  v_mfma_f32_16x16x32_bf16 v[196:199], a[152:155], a[52:55], v[196:199]
  s_waitcnt lgkmcnt(0)
  v_cvt_pk_bf16_f32 v208, v200, v201
  v_cvt_pk_bf16_f32 v210, v204, v205
  v_cvt_pk_bf16_f32 v211, v206, v207
  v_mfma_f32_16x16x32_bf16 v[196:199], a[156:159], a[48:51], v[196:199]
  buffer_store_dwordx4 a[116:119], v233, s[16:19], s35 offen offset:1024
  buffer_load_dwordx4 v221, s[4:7], s33 offen offset:1024 lds
  v_pk_mul_f32 v[200:201], v[192:193], s[28:29] op_sel:[0,1] op_sel_hi:[1,1]
  v_pk_mul_f32 v[202:203], v[194:195], s[28:29] op_sel:[0,1] op_sel_hi:[1,1]
  v_mfma_f32_16x16x32_bf16 v[64:67], v[208:211], a[160:163], 0
  v_exp_f32 v201, v201
  v_mfma_f32_16x16x32_bf16 v[68:71], v[208:211], a[164:167], 0
  s_add_u32 m0, s30, s96
  v_exp_f32 v202, v202
  v_mfma_f32_16x16x32_bf16 v[72:75], v[208:211], a[168:171], 0
  buffer_load_dwordx4 v221, s[8:11], s33 offen lds
  v_mfma_f32_16x16x32_bf16 v[76:79], v[208:211], a[172:175], 0
  v_mul_f32 v206, s29, v198
  v_mul_f32 v207, s29, v199
  v_mfma_f32_16x16x32_bf16 v[80:83], v[208:211], a[176:179], 0
  v_mul_f32 v204, s29, v196
  v_mul_f32 v205, s29, v197
  v_mfma_f32_16x16x32_bf16 v[84:87], v[208:211], a[180:183], 0
  v_exp_f32_e64 v205, v205
  v_mfma_f32_16x16x32_bf16 v[88:91], v[208:211], a[184:187], 0
  v_exp_f32_e64 v200, v200
  v_mfma_f32_16x16x32_bf16 v[92:95], v[208:211], a[188:191], 0
  v_exp_f32_e64 v203, v203
  v_mfma_f32_16x16x32_bf16 v[192:195], a[128:131], a[64:67], v[228:231]
  v_exp_f32_e64 v206, v206
  v_mfma_f32_16x16x32_bf16 v[192:195], a[132:135], a[68:71], v[192:195]
  v_exp_f32_e64 v204, v204
  v_mfma_f32_16x16x32_bf16 v[192:195], a[136:139], a[72:75], v[192:195]
  v_cvt_pk_bf16_f32 v213, v202, v203
  v_cvt_pk_bf16_f32 v214, v204, v205
  v_mfma_f32_16x16x32_bf16 v[192:195], a[140:143], a[76:79], v[192:195]
  v_exp_f32_e64 v207, v207
  v_mfma_f32_16x16x32_bf16 v[196:199], a[144:147], a[76:79], v[228:231]
  s_add_u32 m0, s30, s97
  v_cvt_pk_bf16_f32 v212, v200, v201
  v_cvt_pk_bf16_f32 v215, v206, v207
  v_mfma_f32_16x16x32_bf16 v[196:199], a[148:151], a[72:75], v[196:199]
  buffer_load_dwordx4 v221, s[8:11], s33 offen offset:1024 lds
  v_mfma_f32_16x16x32_bf16 v[196:199], a[152:155], a[68:71], v[196:199]
  s_sub_u32 s30, s30, 16896
  v_mul_f32 v200, s29, v192
  v_mul_f32_e64 v201, s29, v193
  v_mfma_f32_16x16x32_bf16 v[196:199], a[156:159], a[64:67], v[196:199]
  s_mov_b32 m0, s36
  v_mul_f32 v202, s29, v194
  v_mul_f32_e64 v203, s29, v195
  v_smfmac_f32_16x16x64_bf16 a[196:199], a[220:223], v[208:215], v254
  buffer_load_dwordx4 v222, s[12:15], s34 offen nt lds
  v_mfma_f32_16x16x32_bf16 v[96:99], v[212:215], a[160:163], 0
  buffer_store_dwordx4 a[112:115], v233, s[16:19], s35 offen
  v_exp_f32_e64 v201, v201
  v_mfma_f32_16x16x32_bf16 v[100:103], v[212:215], a[164:167], 0
  buffer_load_dwordx4 v223, s[12:15], s34 offen offset:1024 nt lds
  v_mfma_f32_16x16x32_bf16 v[104:107], v[212:215], a[168:171], 0
  s_cselect_b32 s30, s31, s30
  v_mul_f32 v205, s29, v197
  v_mul_f32_e64 v206, s29, v198
  v_mfma_f32_16x16x32_bf16 v[108:111], v[212:215], a[172:175], 0
  s_add_u32 s59, s59, 8192
  v_mul_f32 v204, s29, v196
  v_mul_f32 v207, s29, v199
  v_mfma_f32_16x16x32_bf16 v[112:115], v[212:215], a[176:179], 0
  s_xor_b32 s33, s59, s3
  v_exp_f32 v206, v206
  v_mfma_f32_16x16x32_bf16 v[116:119], v[212:215], a[180:183], 0
  s_add_u32 s35, s35, 2048
  v_exp_f32_e64 v202, v202
  v_mfma_f32_16x16x32_bf16 v[120:123], v[212:215], a[184:187], 0
  s_add_u32 s34, s34, 2048
  v_exp_f32_e64 v204, v204
  v_mfma_f32_16x16x32_bf16 v[124:127], v[212:215], a[188:191], 0
  s_add_u32 s36, s36, 2048
  v_exp_f32_e64 v203, v203
  v_mfma_f32_16x16x32_bf16 v[192:195], a[128:131], a[80:83], v[228:231]
  v_exp_f32_e64 v207, v207
  v_mfma_f32_16x16x32_bf16 v[192:195], a[132:135], a[84:87], v[192:195]
  v_exp_f32_e64 v205, v205
  v_mfma_f32_16x16x32_bf16 v[192:195], a[136:139], a[88:91], v[192:195]
  v_cvt_pk_bf16_f32 v210, v204, v205
  v_cvt_pk_bf16_f32 v211, v206, v207
  v_mfma_f32_16x16x32_bf16 v[192:195], a[140:143], a[92:95], v[192:195]
  v_exp_f32_e64 v200, v200
  v_mfma_f32_16x16x32_bf16 v[196:199], a[144:147], a[92:95], v[228:231]
  v_cvt_pk_bf16_f32 v208, v200, v201
  v_cvt_pk_bf16_f32 v209, v202, v203
  v_mfma_f32_16x16x32_bf16 v[196:199], a[148:151], a[88:91], v[196:199]
  v_add_u32 v216, s30, v218
  v_add_u32 v217, s30, v219
  v_mfma_f32_16x16x32_bf16 v[196:199], a[152:155], a[84:87], v[196:199]
  ds_read_b128 a[128:131], v216 offset:0
  ds_read_b128 a[132:135], v216 offset:64
  v_mfma_f32_16x16x32_bf16 v[196:199], a[156:159], a[80:83], v[196:199]
  ds_read_b128 a[136:139], v216 offset:128
  v_mul_f32_e64 v201, s29, v193
  v_mfma_f32_16x16x32_bf16 v[128:131], v[208:211], a[160:163], 0
  ds_read_b128 a[140:143], v216 offset:192
  ds_read_b128 a[156:159], v216 offset:512
  v_mfma_f32_16x16x32_bf16 v[132:135], v[208:211], a[164:167], 0
  ds_read_b128 a[144:147], v216 offset:704
  ds_read_b128 a[148:151], v216 offset:640
  v_mfma_f32_16x16x32_bf16 v[136:139], v[208:211], a[168:171], 0
  v_mul_f32 v203, s29, v195
  v_mul_f32 v204, s29, v196
  v_mfma_f32_16x16x32_bf16 v[140:143], v[208:211], a[172:175], 0
  v_mul_f32 v200, s29, v192
  v_mul_f32 v202, s29, v194
  v_mfma_f32_16x16x32_bf16 v[144:147], v[208:211], a[176:179], 0
  v_exp_f32_e64 v202, v202
  v_mfma_f32_16x16x32_bf16 v[148:151], v[208:211], a[180:183], 0
  ds_read_b128 a[152:155], v216 offset:576
  v_mul_f32_e64 v205, s29, v197
  v_mfma_f32_16x16x32_bf16 v[152:155], v[208:211], a[184:187], 0
  v_exp_f32 v200, v200
  v_exp_f32 v201, v201
  v_exp_f32_e64 v203, v203
  v_mfma_f32_16x16x32_bf16 v[156:159], v[208:211], a[188:191], 0
  s_waitcnt lgkmcnt(3)
  v_mul_f32 v206, s29, v198
  v_mul_f32_e64 v207, s29, v199
  v_mfma_f32_16x16x32_bf16 v[192:195], a[128:131], a[0:3], v[228:231]
  v_exp_f32_e64 v204, v204
  v_mfma_f32_16x16x32_bf16 v[192:195], a[132:135], a[4:7], v[192:195]
  v_exp_f32_e64 v205, v205
  v_mfma_f32_16x16x32_bf16 v[192:195], a[136:139], a[8:11], v[192:195]
  v_cvt_pk_bf16_f32 v213, v202, v203
  v_cvt_pk_bf16_f32 v214, v204, v205
  v_mfma_f32_16x16x32_bf16 v[192:195], a[140:143], a[12:15], v[192:195]
  s_waitcnt lgkmcnt(1)
  v_exp_f32 v206, v206
  v_mfma_f32_16x16x32_bf16 v[196:199], a[144:147], a[12:15], v[228:231]
  v_exp_f32_e64 v207, v207
  v_mfma_f32_16x16x32_bf16 v[196:199], a[148:151], a[8:11], v[196:199]
  s_waitcnt lgkmcnt(0)
  v_cvt_pk_bf16_f32 v212, v200, v201
  v_cvt_pk_bf16_f32 v215, v206, v207
  v_mfma_f32_16x16x32_bf16 v[196:199], a[152:155], a[4:7], v[196:199]
  v_mul_f32 v201, s29, v193
  v_mul_f32_e64 v202, s29, v194
  v_mfma_f32_16x16x32_bf16 v[196:199], a[156:159], a[0:3], v[196:199]
  v_mul_f32 v200, s29, v192
  v_mul_f32 v203, s29, v195
  v_mfma_f32_16x16x32_bf16 v[160:163], v[212:215], a[160:163], 0
  v_exp_f32_e64 v202, v202
  v_mfma_f32_16x16x32_bf16 v[164:167], v[212:215], a[164:167], 0
  v_exp_f32_e64 v203, v203
  v_mfma_f32_16x16x32_bf16 v[168:171], v[212:215], a[168:171], 0
  v_mul_f32 v205, s29, v197
  v_mul_f32 v206, s29, v198
  v_mfma_f32_16x16x32_bf16 v[172:175], v[212:215], a[172:175], 0
  v_exp_f32_e64 v201, v201
  v_mfma_f32_16x16x32_bf16 v[176:179], v[212:215], a[176:179], 0
  ds_read_b64_tr_b16 a[172:173], v217 offset:8496
  ds_read_b64_tr_b16 a[174:175], v217 offset:9008
  v_mfma_f32_16x16x32_bf16 v[180:183], v[212:215], a[180:183], 0
  ds_read_b64_tr_b16 a[162:163], v217 offset:8960
  ds_read_b64_tr_b16 a[164:165], v217 offset:8464
  v_mfma_f32_16x16x32_bf16 v[184:187], v[212:215], a[184:187], 0
  s_waitcnt vmcnt(12)
  v_exp_f32 v200, v200
  v_mfma_f32_16x16x32_bf16 v[188:191], v[212:215], a[188:191], 0
  ds_read_b64_tr_b16 a[170:171], v217 offset:8992
  v_mul_f32_e64 v204, s29, v196
  v_smfmac_f32_16x16x64_bf16 a[200:203], a[220:223], v[208:215], v254
  ds_read_b64_tr_b16 a[160:161], v217 offset:8448
  ds_read_b64_tr_b16 a[166:167], v217 offset:8976
  ds_read_b64_tr_b16 a[168:169], v217 offset:8480
  v_mul_f32_e64 v207, s29, v199
  s_cmp_eq_u32 s38, 1
  s_cselect_b32 s37, 12, 14
  s_cbranch_scc1 L_pD3
  s_branch L_pB3
L_fB3:
  v_mfma_f32_16x16x32_bf16 v[192:195], a[128:131], a[16:19], v[228:231]
  ds_read_b64_tr_b16 a[176:177], v217 offset:8512
  v_cvt_pk_bf16_f32 v208, v200, v201
  v_mfma_f32_16x16x32_bf16 v[192:195], a[132:135], a[20:23], v[192:195]
  v_exp_f32_e64 v205, v205
  v_mfma_f32_16x16x32_bf16 v[192:195], a[136:139], a[24:27], v[192:195]
  ds_read_b64_tr_b16 a[178:179], v217 offset:9024
  v_cvt_pk_bf16_f32 v209, v202, v203
  v_mfma_f32_16x16x32_bf16 v[192:195], a[140:143], a[28:31], v[192:195]
  v_exp_f32_e64 v204, v204
  v_mfma_f32_16x16x32_bf16 v[196:199], a[144:147], a[28:31], v[228:231]
  ds_read_b64_tr_b16 a[180:181], v217 offset:8528
  ds_read_b64_tr_b16 a[186:187], v217 offset:9056
  v_mfma_f32_16x16x32_bf16 v[196:199], a[148:151], a[24:27], v[196:199]
  s_waitcnt lgkmcnt(4)
  v_exp_f32 v206, v206
  v_exp_f32_e64 v207, v207
  v_mfma_f32_16x16x32_bf16 v[196:199], a[152:155], a[20:23], v[196:199]
  ds_read_b64_tr_b16 a[182:183], v217 offset:9040
  v_cvt_pk_bf16_f32 v210, v204, v205
  v_cvt_pk_bf16_f32 v211, v206, v207
  v_mfma_f32_16x16x32_bf16 v[196:199], a[156:159], a[16:19], v[196:199]
  ds_read_b64_tr_b16 a[184:185], v217 offset:8544
  ds_read_b64_tr_b16 a[190:191], v217 offset:9072
  v_mfma_f32_16x16x32_bf16 v[0:3], v[208:211], a[160:163], 0
  ds_read_b64_tr_b16 a[188:189], v217 offset:8560
  v_mul_f32_e64 v200, s29, v192
  v_mfma_f32_16x16x32_bf16 v[4:7], v[208:211], a[164:167], 0
  v_mul_f32 v202, s29, v194
  v_mul_f32 v203, s29, v195
  v_mfma_f32_16x16x32_bf16 v[8:11], v[208:211], a[168:171], 0
  v_mul_f32 v205, s29, v197
  v_mul_f32 v207, s29, v199
  v_mfma_f32_16x16x32_bf16 v[12:15], v[208:211], a[172:175], 0
  s_waitcnt lgkmcnt(4)
  v_mul_f32 v201, s29, v193
  v_mul_f32_e64 v206, s29, v198
  v_mfma_f32_16x16x32_bf16 v[16:19], v[208:211], a[176:179], 0
  s_waitcnt lgkmcnt(3)
  v_exp_f32 v200, v200
  v_mfma_f32_16x16x32_bf16 v[20:23], v[208:211], a[180:183], 0
  s_waitcnt lgkmcnt(2)
  v_exp_f32 v201, v201
  v_mfma_f32_16x16x32_bf16 v[24:27], v[208:211], a[184:187], 0
  s_waitcnt lgkmcnt(0)
  v_mul_f32 v204, s29, v196
  v_cvt_pk_bf16_f32 v212, v200, v201
  v_mfma_f32_16x16x32_bf16 v[28:31], v[208:211], a[188:191], 0
  v_exp_f32_e64 v202, v202
  v_mfma_f32_16x16x32_bf16 v[192:195], a[128:131], a[32:35], v[228:231]
  v_exp_f32_e64 v206, v206
  v_mfma_f32_16x16x32_bf16 v[192:195], a[132:135], a[36:39], v[192:195]
  v_exp_f32_e64 v204, v204
  v_mfma_f32_16x16x32_bf16 v[192:195], a[136:139], a[40:43], v[192:195]
  v_exp_f32_e64 v207, v207
  v_mfma_f32_16x16x32_bf16 v[192:195], a[140:143], a[44:47], v[192:195]
  ds_read_b64_tr_b16 a[112:113], v220 offset:4096
  v_cvt_pk_bf16_f32 v215, v206, v207
  v_mfma_f32_16x16x32_bf16 v[196:199], a[144:147], a[44:47], v[228:231]
  v_exp_f32_e64 v203, v203
  v_mfma_f32_16x16x32_bf16 v[196:199], a[148:151], a[40:43], v[196:199]
  v_exp_f32_e64 v205, v205
  v_mfma_f32_16x16x32_bf16 v[196:199], a[152:155], a[36:39], v[196:199]
  v_cvt_pk_bf16_f32 v213, v202, v203
  v_cvt_pk_bf16_f32 v214, v204, v205
  v_mfma_f32_16x16x32_bf16 v[196:199], a[156:159], a[32:35], v[196:199]
  ds_read_b64_tr_b16 a[114:115], v220 offset:4160
  v_mul_f32_e64 v203, s29, v195
  v_smfmac_f32_16x16x64_bf16 a[192:195], a[220:223], v[208:215], v254
  ds_read_b64_tr_b16 a[116:117], v220 offset:5120
  v_mul_f32_e64 v200, s29, v192
  v_mfma_f32_16x16x32_bf16 v[32:35], v[212:215], a[160:163], 0
  ds_read_b64_tr_b16 a[118:119], v220 offset:5184
  v_mul_f32_e64 v201, s29, v193
  v_mfma_f32_16x16x32_bf16 v[36:39], v[212:215], a[164:167], 0
  v_mul_f32 v202, s29, v194
  v_mul_f32 v207, s29, v199
  v_mfma_f32_16x16x32_bf16 v[40:43], v[212:215], a[168:171], 0
  v_exp_f32_e64 v201, v201
  v_mfma_f32_16x16x32_bf16 v[44:47], v[212:215], a[172:175], 0
  s_barrier
  v_mul_f32 v204, s29, v196
  v_mfma_f32_16x16x32_bf16 v[48:51], v[212:215], a[176:179], 0
  v_exp_f32_e64 v203, v203
  v_mfma_f32_16x16x32_bf16 v[52:55], v[212:215], a[180:183], 0
  v_mul_f32 v205, s29, v197
  v_mul_f32 v206, s29, v198
  v_mfma_f32_16x16x32_bf16 v[56:59], v[212:215], a[184:187], 0
  v_exp_f32_e64 v206, v206
  v_mfma_f32_16x16x32_bf16 v[60:63], v[212:215], a[188:191], 0
  s_mov_b32 m0, s30
  v_exp_f32 v205, v205
  v_mfma_f32_16x16x32_bf16 v[192:195], a[128:131], a[48:51], v[228:231]
  buffer_load_dwordx4 v221, s[4:7], s33 offen lds
  v_mfma_f32_16x16x32_bf16 v[192:195], a[132:135], a[52:55], v[192:195]
  v_exp_f32_e64 v202, v202
  v_mfma_f32_16x16x32_bf16 v[192:195], a[136:139], a[56:59], v[192:195]
  v_exp_f32_e64 v204, v204
  v_mfma_f32_16x16x32_bf16 v[192:195], a[140:143], a[60:63], v[192:195]
  v_cvt_pk_bf16_f32 v209, v202, v203
  v_cvt_pk_bf16_f32 v210, v204, v205
  v_mfma_f32_16x16x32_bf16 v[196:199], a[144:147], a[60:63], v[228:231]
  v_exp_f32_e64 v207, v207
  v_mfma_f32_16x16x32_bf16 v[196:199], a[148:151], a[56:59], v[196:199]
  s_add_u32 m0, s30, 32
  v_exp_f32 v200, v200
  v_mfma_f32_16x16x32_bf16 v[196:199], a[152:155], a[52:55], v[196:199]
  s_waitcnt lgkmcnt(0)
  v_cvt_pk_bf16_f32 v208, v200, v201
  v_cvt_pk_bf16_f32 v211, v206, v207
  v_mfma_f32_16x16x32_bf16 v[196:199], a[156:159], a[48:51], v[196:199]
  buffer_store_dwordx4 a[116:119], v233, s[16:19], s35 offen offset:1024
  buffer_load_dwordx4 v221, s[4:7], s33 offen offset:1024 lds
  v_pk_mul_f32 v[200:201], v[192:193], s[28:29] op_sel:[0,1] op_sel_hi:[1,1]
  v_pk_mul_f32 v[202:203], v[194:195], s[28:29] op_sel:[0,1] op_sel_hi:[1,1]
  v_mfma_f32_16x16x32_bf16 v[64:67], v[208:211], a[160:163], 0
  v_exp_f32 v201, v201
  v_mfma_f32_16x16x32_bf16 v[68:71], v[208:211], a[164:167], 0
  v_exp_f32_e64 v203, v203
  v_mfma_f32_16x16x32_bf16 v[72:75], v[208:211], a[168:171], 0
  v_mul_f32 v204, s29, v196
  v_mul_f32 v205, s29, v197
  v_mfma_f32_16x16x32_bf16 v[76:79], v[208:211], a[172:175], 0
  s_add_u32 m0, s30, s96
  v_mul_f32 v206, s29, v198
  v_mul_f32_e64 v207, s29, v199
  v_mfma_f32_16x16x32_bf16 v[80:83], v[208:211], a[176:179], 0
  buffer_load_dwordx4 v221, s[8:11], s33 offen lds
  v_mfma_f32_16x16x32_bf16 v[84:87], v[208:211], a[180:183], 0
  v_exp_f32_e64 v205, v205
  v_mfma_f32_16x16x32_bf16 v[88:91], v[208:211], a[184:187], 0
  v_exp_f32_e64 v204, v204
  v_mfma_f32_16x16x32_bf16 v[92:95], v[208:211], a[188:191], 0
  v_exp_f32_e64 v200, v200
  v_mfma_f32_16x16x32_bf16 v[192:195], a[128:131], a[64:67], v[228:231]
  v_cvt_pk_bf16_f32 v212, v200, v201
  v_cvt_pk_bf16_f32 v214, v204, v205
  v_mfma_f32_16x16x32_bf16 v[192:195], a[132:135], a[68:71], v[192:195]
  v_exp_f32_e64 v207, v207
  v_mfma_f32_16x16x32_bf16 v[192:195], a[136:139], a[72:75], v[192:195]
  v_exp_f32_e64 v206, v206
  v_mfma_f32_16x16x32_bf16 v[192:195], a[140:143], a[76:79], v[192:195]
  v_exp_f32_e64 v202, v202
  v_mfma_f32_16x16x32_bf16 v[196:199], a[144:147], a[76:79], v[228:231]
  s_add_u32 m0, s30, s97
  v_cvt_pk_bf16_f32 v213, v202, v203
  v_cvt_pk_bf16_f32 v215, v206, v207
  v_mfma_f32_16x16x32_bf16 v[196:199], a[148:151], a[72:75], v[196:199]
  buffer_load_dwordx4 v221, s[8:11], s33 offen offset:1024 lds
  v_mfma_f32_16x16x32_bf16 v[196:199], a[152:155], a[68:71], v[196:199]
  s_sub_u32 s30, s30, 16896
  v_mul_f32 v201, s29, v193
  v_mul_f32_e64 v202, s29, v194
  v_mfma_f32_16x16x32_bf16 v[196:199], a[156:159], a[64:67], v[196:199]
  s_mov_b32 m0, s36
  v_mul_f32 v200, s29, v192
  v_mul_f32_e64 v203, s29, v195
  v_smfmac_f32_16x16x64_bf16 a[196:199], a[220:223], v[208:215], v254
  buffer_load_dwordx4 v222, s[12:15], s34 offen nt lds
  v_mfma_f32_16x16x32_bf16 v[96:99], v[212:215], a[160:163], 0
  s_cselect_b32 s30, s31, s30
  v_exp_f32 v200, v200
  v_mfma_f32_16x16x32_bf16 v[100:103], v[212:215], a[164:167], 0
  buffer_load_dwordx4 v223, s[12:15], s34 offen offset:1024 nt lds
  v_mfma_f32_16x16x32_bf16 v[104:107], v[212:215], a[168:171], 0
  s_add_u32 s59, s59, 8192
  v_mul_f32 v204, s29, v196
  v_mul_f32 v207, s29, v199
  v_mfma_f32_16x16x32_bf16 v[108:111], v[212:215], a[172:175], 0
  s_xor_b32 s33, s59, s3
  v_exp_f32 v204, v204
  v_mfma_f32_16x16x32_bf16 v[112:115], v[212:215], a[176:179], 0
  s_add_u32 s34, s34, 2048
  v_exp_f32_e64 v207, v207
  v_mfma_f32_16x16x32_bf16 v[116:119], v[212:215], a[180:183], 0
  buffer_store_dwordx4 a[112:115], v233, s[16:19], s35 offen
  v_exp_f32_e64 v203, v203
  v_mfma_f32_16x16x32_bf16 v[120:123], v[212:215], a[184:187], 0
  s_add_u32 s35, s35, 2048
  v_mul_f32 v205, s29, v197
  v_add_u32 v216, s30, v218
  v_mfma_f32_16x16x32_bf16 v[124:127], v[212:215], a[188:191], 0
  s_add_u32 s36, s36, 2048
  v_exp_f32_e64 v205, v205
  v_mfma_f32_16x16x32_bf16 v[192:195], a[128:131], a[80:83], v[228:231]
  v_mul_f32_e64 v206, s29, v198
  v_cvt_pk_bf16_f32 v210, v204, v205
  v_mfma_f32_16x16x32_bf16 v[192:195], a[132:135], a[84:87], v[192:195]
  v_exp_f32_e64 v206, v206
  v_mfma_f32_16x16x32_bf16 v[192:195], a[136:139], a[88:91], v[192:195]
  ds_read_b128 a[132:135], v216 offset:64
  v_cvt_pk_bf16_f32 v211, v206, v207
  v_mfma_f32_16x16x32_bf16 v[192:195], a[140:143], a[92:95], v[192:195]
  v_exp_f32_e64 v201, v201
  v_mfma_f32_16x16x32_bf16 v[196:199], a[144:147], a[92:95], v[228:231]
  ds_read_b128 a[140:143], v216 offset:192
  v_cvt_pk_bf16_f32 v208, v200, v201
  v_mfma_f32_16x16x32_bf16 v[196:199], a[148:151], a[88:91], v[196:199]
  v_exp_f32_e64 v202, v202
  v_mfma_f32_16x16x32_bf16 v[196:199], a[152:155], a[84:87], v[196:199]
  ds_read_b128 a[128:131], v216 offset:0
  v_cvt_pk_bf16_f32 v209, v202, v203
  v_mfma_f32_16x16x32_bf16 v[196:199], a[156:159], a[80:83], v[196:199]
  ds_read_b128 a[136:139], v216 offset:128
  v_mul_f32_e64 v200, s29, v192
  v_mfma_f32_16x16x32_bf16 v[128:131], v[208:211], a[160:163], 0
  ds_read_b128 a[152:155], v216 offset:576
  v_mul_f32_e64 v203, s29, v195
  v_mfma_f32_16x16x32_bf16 v[132:135], v[208:211], a[164:167], 0
  v_exp_f32_e64 v200, v200
  v_mfma_f32_16x16x32_bf16 v[136:139], v[208:211], a[168:171], 0
  v_mul_f32 v202, s29, v194
  v_mul_f32 v205, s29, v197
  v_mfma_f32_16x16x32_bf16 v[140:143], v[208:211], a[172:175], 0
  ds_read_b128 a[144:147], v216 offset:704
  ds_read_b128 a[156:159], v216 offset:512
  v_mfma_f32_16x16x32_bf16 v[144:147], v[208:211], a[176:179], 0
  v_exp_f32_e64 v202, v202
  v_mfma_f32_16x16x32_bf16 v[148:151], v[208:211], a[180:183], 0
  v_mul_f32 v201, s29, v193
  v_add_u32 v217, s30, v219
  v_mfma_f32_16x16x32_bf16 v[152:155], v[208:211], a[184:187], 0
  ds_read_b128 a[148:151], v216 offset:640
  v_exp_f32 v201, v201
  v_mul_f32 v204, s29, v196
  v_exp_f32_e64 v203, v203
  v_mfma_f32_16x16x32_bf16 v[156:159], v[208:211], a[188:191], 0
  s_waitcnt lgkmcnt(3)
  v_mul_f32 v207, s29, v199
  v_cvt_pk_bf16_f32 v212, v200, v201
  v_mfma_f32_16x16x32_bf16 v[192:195], a[128:131], a[0:3], v[228:231]
  v_mul_f32_e64 v206, s29, v198
  v_cvt_pk_bf16_f32 v213, v202, v203
  v_mfma_f32_16x16x32_bf16 v[192:195], a[132:135], a[4:7], v[192:195]
  v_exp_f32_e64 v206, v206
  v_mfma_f32_16x16x32_bf16 v[192:195], a[136:139], a[8:11], v[192:195]
  v_exp_f32_e64 v205, v205
  v_mfma_f32_16x16x32_bf16 v[192:195], a[140:143], a[12:15], v[192:195]
  s_waitcnt lgkmcnt(1)
  v_exp_f32 v204, v204
  v_mfma_f32_16x16x32_bf16 v[196:199], a[144:147], a[12:15], v[228:231]
  s_waitcnt lgkmcnt(0)
  v_exp_f32 v207, v207
  v_mfma_f32_16x16x32_bf16 v[196:199], a[148:151], a[8:11], v[196:199]
  v_cvt_pk_bf16_f32 v214, v204, v205
  v_cvt_pk_bf16_f32 v215, v206, v207
  v_mfma_f32_16x16x32_bf16 v[196:199], a[152:155], a[4:7], v[196:199]
  v_mul_f32 v201, s29, v193
  v_mul_f32 v203, s29, v195
  v_mfma_f32_16x16x32_bf16 v[196:199], a[156:159], a[0:3], v[196:199]
  v_mul_f32 v200, s29, v192
  v_mul_f32 v202, s29, v194
  v_mfma_f32_16x16x32_bf16 v[160:163], v[212:215], a[160:163], 0
  v_exp_f32_e64 v200, v200
  v_mfma_f32_16x16x32_bf16 v[164:167], v[212:215], a[164:167], 0
  ds_read_b64_tr_b16 a[160:161], v217 offset:8448
  ds_read_b64_tr_b16 a[166:167], v217 offset:8976
  v_mfma_f32_16x16x32_bf16 v[168:171], v[212:215], a[168:171], 0
  v_exp_f32_e64 v202, v202
  v_mfma_f32_16x16x32_bf16 v[172:175], v[212:215], a[172:175], 0
  ds_read_b64_tr_b16 a[170:171], v217 offset:8992
  ds_read_b64_tr_b16 a[174:175], v217 offset:9008
  v_mfma_f32_16x16x32_bf16 v[176:179], v[212:215], a[176:179], 0
  ds_read_b64_tr_b16 a[168:169], v217 offset:8480
  v_mul_f32_e64 v207, s29, v199
  v_mfma_f32_16x16x32_bf16 v[180:183], v[212:215], a[180:183], 0
  ds_read_b64_tr_b16 a[164:165], v217 offset:8464
  v_mul_f32_e64 v205, s29, v197
  v_mfma_f32_16x16x32_bf16 v[184:187], v[212:215], a[184:187], 0
  ds_read_b64_tr_b16 a[162:163], v217 offset:8960
  v_mul_f32_e64 v204, s29, v196
  v_mfma_f32_16x16x32_bf16 v[188:191], v[212:215], a[188:191], 0
  s_waitcnt vmcnt(12)
  v_exp_f32 v201, v201
  v_smfmac_f32_16x16x64_bf16 a[200:203], a[220:223], v[208:215], v254
  ds_read_b64_tr_b16 a[172:173], v217 offset:8496
  v_exp_f32 v203, v203
  v_mul_f32 v206, s29, v198
  s_cmp_eq_u32 s38, 1
  s_cselect_b32 s37, 12, 14
  s_cbranch_scc1 L_pD0
  s_branch L_pB0
  .p2align 6
L_pE1:
  v_mfma_f32_16x16x32_bf16 v[192:195], a[128:131], a[16:19], v[228:231]
  s_and_b32 s57, s99, 3
  v_exp_f32 v204, v204
  v_mfma_f32_16x16x32_bf16 v[192:195], a[132:135], a[20:23], v[192:195]
  ds_read_b64_tr_b16 a[176:177], v217 offset:8512
  ds_read_b64_tr_b16 a[178:179], v217 offset:9024
  v_mfma_f32_16x16x32_bf16 v[192:195], a[136:139], a[24:27], v[192:195]
  s_cselect_b32 s100, s34, 0x40000000
  v_exp_f32 v205, v205
  v_mfma_f32_16x16x32_bf16 v[192:195], a[140:143], a[28:31], v[192:195]
  ds_read_b64_tr_b16 a[180:181], v217 offset:8528
  ds_read_b64_tr_b16 a[182:183], v217 offset:9040
  v_mfma_f32_16x16x32_bf16 v[196:199], a[144:147], a[28:31], v[228:231]
  s_cmp_ge_u32 s57, 2
  v_exp_f32 v206, v206
  v_mfma_f32_16x16x32_bf16 v[196:199], a[148:151], a[24:27], v[196:199]
  s_waitcnt lgkmcnt(4)
  v_exp_f32 v207, v207
  v_mfma_f32_16x16x32_bf16 v[196:199], a[152:155], a[20:23], v[196:199]
  ds_read_b64_tr_b16 a[184:185], v217 offset:8544
  ds_read_b64_tr_b16 a[186:187], v217 offset:9056
  v_cvt_pk_bf16_f32 v208, v200, v201
  v_cvt_pk_bf16_f32 v209, v202, v203
  v_cvt_pk_bf16_f32 v210, v204, v205
  v_cvt_pk_bf16_f32 v211, v206, v207
  v_mfma_f32_16x16x32_bf16 v[196:199], a[156:159], a[16:19], v[196:199]
  ds_read_b64_tr_b16 a[188:189], v217 offset:8560
  ds_read_b64_tr_b16 a[190:191], v217 offset:9072
  v_mfma_f32_16x16x32_bf16 v[0:3], v[208:211], a[160:163], v[0:3]
  s_cselect_b32 s101, s34, 0x40000000
  v_mul_f32 v200, s29, v192
  v_mul_f32_e64 v201, s29, v193
  v_mfma_f32_16x16x32_bf16 v[4:7], v[208:211], a[164:167], v[4:7]
  s_lshr_b32 s99, s99, 2
  v_mul_f32 v202, s29, v194
  v_mul_f32_e64 v203, s29, v195
  v_mfma_f32_16x16x32_bf16 v[8:11], v[208:211], a[168:171], v[8:11]
  s_lshl_b32 s57, s57, 11
  v_mul_f32 v204, s29, v196
  v_mul_f32_e64 v205, s29, v197
  v_mfma_f32_16x16x32_bf16 v[12:15], v[208:211], a[172:175], v[12:15]
  s_waitcnt lgkmcnt(4)
  v_mul_f32 v206, s29, v198
  v_mul_f32_e64 v207, s29, v199
  v_mfma_f32_16x16x32_bf16 v[16:19], v[208:211], a[176:179], v[16:19]
  s_add_u32 s34, s34, s57
  v_exp_f32 v200, v200
  v_mfma_f32_16x16x32_bf16 v[20:23], v[208:211], a[180:183], v[20:23]
  s_waitcnt lgkmcnt(2)
  v_exp_f32 v201, v201
  v_mfma_f32_16x16x32_bf16 v[24:27], v[208:211], a[184:187], v[24:27]
  s_waitcnt lgkmcnt(0)
  v_exp_f32 v202, v202
  v_mfma_f32_16x16x32_bf16 v[28:31], v[208:211], a[188:191], v[28:31]
  v_exp_f32_e64 v203, v203
  v_mfma_f32_16x16x32_bf16 v[192:195], a[128:131], a[32:35], v[228:231]
  v_exp_f32_e64 v204, v204
  v_mfma_f32_16x16x32_bf16 v[192:195], a[132:135], a[36:39], v[192:195]
  v_exp_f32_e64 v205, v205
  v_mfma_f32_16x16x32_bf16 v[192:195], a[136:139], a[40:43], v[192:195]
  v_exp_f32_e64 v206, v206
  v_mfma_f32_16x16x32_bf16 v[192:195], a[140:143], a[44:47], v[192:195]
  v_exp_f32_e64 v207, v207
  v_mfma_f32_16x16x32_bf16 v[196:199], a[144:147], a[44:47], v[228:231]
  s_mov_b32 m0, s30
  v_cvt_pk_bf16_f32 v212, v200, v201
  v_cvt_pk_bf16_f32 v213, v202, v203
  v_mfma_f32_16x16x32_bf16 v[196:199], a[148:151], a[40:43], v[196:199]
  s_waitcnt vmcnt(5)
  v_cvt_pk_bf16_f32 v214, v204, v205
  v_cvt_pk_bf16_f32 v215, v206, v207
  v_mfma_f32_16x16x32_bf16 v[196:199], a[152:155], a[36:39], v[196:199]
  s_barrier
  v_mul_f32 v200, s29, v192
  v_mfma_f32_16x16x32_bf16 v[196:199], a[156:159], a[32:35], v[196:199]
  buffer_load_dwordx4 v221, s[4:7], s33 offen lds
  v_smfmac_f32_16x16x64_bf16 a[192:195], a[220:223], v[208:215], v254
  v_mul_f32_e64 v201, s29, v193
  v_mfma_f32_16x16x32_bf16 v[32:35], v[212:215], a[160:163], v[32:35]
  v_mul_f32 v202, s29, v194
  v_mul_f32 v203, s29, v195
  v_mfma_f32_16x16x32_bf16 v[36:39], v[212:215], a[164:167], v[36:39]
  s_add_u32 m0, s30, 32
  v_mul_f32 v204, s29, v196
  v_mul_f32_e64 v205, s29, v197
  v_mfma_f32_16x16x32_bf16 v[40:43], v[212:215], a[168:171], v[40:43]
  buffer_load_dwordx4 v221, s[4:7], s33 offen offset:1024 lds
  v_mfma_f32_16x16x32_bf16 v[44:47], v[212:215], a[172:175], v[44:47]
  v_mul_f32 v206, s29, v198
  v_mul_f32 v207, s29, v199
  v_mfma_f32_16x16x32_bf16 v[48:51], v[212:215], a[176:179], v[48:51]
  v_exp_f32_e64 v200, v200
  v_mfma_f32_16x16x32_bf16 v[52:55], v[212:215], a[180:183], v[52:55]
  s_add_u32 m0, s30, s96
  v_exp_f32 v201, v201
  v_mfma_f32_16x16x32_bf16 v[56:59], v[212:215], a[184:187], v[56:59]
  buffer_load_dwordx4 v221, s[8:11], s33 offen lds
  v_mfma_f32_16x16x32_bf16 v[60:63], v[212:215], a[188:191], v[60:63]
  v_exp_f32_e64 v202, v202
  v_mfma_f32_16x16x32_bf16 v[192:195], a[128:131], a[48:51], v[228:231]
  v_exp_f32_e64 v203, v203
  v_mfma_f32_16x16x32_bf16 v[192:195], a[132:135], a[52:55], v[192:195]
  v_exp_f32_e64 v204, v204
  v_mfma_f32_16x16x32_bf16 v[192:195], a[136:139], a[56:59], v[192:195]
  v_exp_f32_e64 v205, v205
  v_mfma_f32_16x16x32_bf16 v[192:195], a[140:143], a[60:63], v[192:195]
  v_exp_f32_e64 v206, v206
  v_mfma_f32_16x16x32_bf16 v[196:199], a[144:147], a[60:63], v[228:231]
  v_exp_f32_e64 v207, v207
  v_mfma_f32_16x16x32_bf16 v[196:199], a[148:151], a[56:59], v[196:199]
  v_cvt_pk_bf16_f32 v208, v200, v201
  v_cvt_pk_bf16_f32 v209, v202, v203
  v_mfma_f32_16x16x32_bf16 v[196:199], a[152:155], a[52:55], v[196:199]
  v_cvt_pk_bf16_f32 v210, v204, v205
  v_cvt_pk_bf16_f32 v211, v206, v207
  v_mfma_f32_16x16x32_bf16 v[196:199], a[156:159], a[48:51], v[196:199]
  v_mul_f32 v200, s29, v192
  v_mul_f32 v201, s29, v193
  v_mfma_f32_16x16x32_bf16 v[64:67], v[208:211], a[160:163], v[64:67]
  v_mul_f32 v202, s29, v194
  v_mul_f32 v203, s29, v195
  v_mfma_f32_16x16x32_bf16 v[68:71], v[208:211], a[164:167], v[68:71]
  s_add_u32 m0, s30, s97
  v_exp_f32 v200, v200
  v_mfma_f32_16x16x32_bf16 v[72:75], v[208:211], a[168:171], v[72:75]
  buffer_load_dwordx4 v221, s[8:11], s33 offen offset:1024 lds
  v_mfma_f32_16x16x32_bf16 v[76:79], v[208:211], a[172:175], v[76:79]
  s_sub_u32 s30, s30, 16896
  v_mul_f32 v204, s29, v196
  v_mul_f32 v205, s29, v197
  v_mfma_f32_16x16x32_bf16 v[80:83], v[208:211], a[176:179], v[80:83]
  s_cselect_b32 s30, s31, s30
  v_mul_f32 v206, s29, v198
  v_mul_f32_e64 v207, s29, v199
  v_mfma_f32_16x16x32_bf16 v[84:87], v[208:211], a[180:183], v[84:87]
  s_add_u32 s59, s59, 8192
  v_exp_f32_e64 v201, v201
  v_mfma_f32_16x16x32_bf16 v[88:91], v[208:211], a[184:187], v[88:91]
  s_xor_b32 s33, s59, s3
  v_exp_f32 v202, v202
  v_mfma_f32_16x16x32_bf16 v[92:95], v[208:211], a[188:191], v[92:95]
  v_exp_f32_e64 v203, v203
  v_mfma_f32_16x16x32_bf16 v[192:195], a[128:131], a[96:99], v[228:231]
  v_exp_f32_e64 v204, v204
  v_mfma_f32_16x16x32_bf16 v[192:195], a[132:135], a[100:103], v[192:195]
  v_exp_f32_e64 v205, v205
  v_mfma_f32_16x16x32_bf16 v[192:195], a[136:139], a[104:107], v[192:195]
  v_exp_f32_e64 v206, v206
  v_mfma_f32_16x16x32_bf16 v[192:195], a[140:143], a[108:111], v[192:195]
  v_exp_f32_e64 v207, v207
  v_mfma_f32_16x16x32_bf16 v[196:199], a[144:147], a[108:111], v[228:231]
  v_cvt_pk_bf16_f32 v212, v200, v201
  v_cvt_pk_bf16_f32 v213, v202, v203
  v_mfma_f32_16x16x32_bf16 v[196:199], a[148:151], a[104:107], v[196:199]
  v_cvt_pk_bf16_f32 v214, v204, v205
  v_cvt_pk_bf16_f32 v215, v206, v207
  v_mfma_f32_16x16x32_bf16 v[196:199], a[152:155], a[100:103], v[196:199]
  v_mul_f32 v200, s29, v192
  v_mul_f32 v201, s29, v193
  v_mfma_f32_16x16x32_bf16 v[196:199], a[156:159], a[96:99], v[196:199]
  v_mul_f32 v202, s29, v194
  v_mul_f32 v203, s29, v195
  v_smfmac_f32_16x16x64_bf16 a[196:199], a[220:223], v[208:215], v254
  v_add_u32_e64 v216, s30, v218
  v_mfma_f32_16x16x32_bf16 v[96:99], v[212:215], a[160:163], v[96:99]
  s_mov_b32 m0, s36
  v_exp_f32 v200, v200
  v_mfma_f32_16x16x32_bf16 v[100:103], v[212:215], a[164:167], v[100:103]
  buffer_load_dwordx4 v222, s[12:15], s100 offen nt lds
  v_mfma_f32_16x16x32_bf16 v[104:107], v[212:215], a[168:171], v[104:107]
  s_add_u32 s36, s36, s57
  v_mul_f32 v204, s29, v196
  v_mul_f32_e64 v205, s29, v197
  v_mfma_f32_16x16x32_bf16 v[108:111], v[212:215], a[172:175], v[108:111]
  v_mul_f32 v206, s29, v198
  v_mul_f32 v207, s29, v199
  v_mfma_f32_16x16x32_bf16 v[112:115], v[212:215], a[176:179], v[112:115]
  v_exp_f32_e64 v201, v201
  v_mfma_f32_16x16x32_bf16 v[116:119], v[212:215], a[180:183], v[116:119]
  buffer_load_dwordx4 v223, s[12:15], s100 offen offset:1024 nt lds
  v_mfma_f32_16x16x32_bf16 v[120:123], v[212:215], a[184:187], v[120:123]
  v_exp_f32_e64 v202, v202
  v_mfma_f32_16x16x32_bf16 v[124:127], v[212:215], a[188:191], v[124:127]
  v_exp_f32_e64 v203, v203
  v_mfma_f32_16x16x32_bf16 v[192:195], a[128:131], a[64:67], v[228:231]
  v_exp_f32_e64 v204, v204
  v_mfma_f32_16x16x32_bf16 v[192:195], a[132:135], a[68:71], v[192:195]
  v_exp_f32_e64 v205, v205
  v_mfma_f32_16x16x32_bf16 v[192:195], a[136:139], a[72:75], v[192:195]
  v_exp_f32_e64 v206, v206
  v_mfma_f32_16x16x32_bf16 v[192:195], a[140:143], a[76:79], v[192:195]
  v_exp_f32_e64 v207, v207
  v_mfma_f32_16x16x32_bf16 v[196:199], a[144:147], a[76:79], v[228:231]
  v_cvt_pk_bf16_f32 v208, v200, v201
  v_cvt_pk_bf16_f32 v209, v202, v203
  v_mfma_f32_16x16x32_bf16 v[196:199], a[148:151], a[72:75], v[196:199]
  v_cvt_pk_bf16_f32 v210, v204, v205
  v_cvt_pk_bf16_f32 v211, v206, v207
  v_mfma_f32_16x16x32_bf16 v[196:199], a[152:155], a[68:71], v[196:199]
  v_mul_f32 v200, s29, v192
  v_mul_f32 v201, s29, v193
  v_mfma_f32_16x16x32_bf16 v[196:199], a[156:159], a[64:67], v[196:199]
  v_mul_f32 v202, s29, v194
  v_mul_f32 v203, s29, v195
  v_mfma_f32_16x16x32_bf16 a[204:207], a[220:223], v[208:211], a[204:207]
  v_exp_f32_e64 v200, v200
  v_mfma_f32_16x16x32_bf16 a[224:227], v[208:211], a[160:163], a[224:227]
  buffer_load_dwordx4 v222, s[12:15], s101 offen offset:2048 nt lds
  v_mfma_f32_16x16x32_bf16 a[228:231], v[208:211], a[164:167], a[228:231]
  v_mul_f32 v204, s29, v196
  v_mul_f32 v205, s29, v197
  v_mfma_f32_16x16x32_bf16 a[232:235], v[208:211], a[168:171], a[232:235]
  v_mul_f32 v206, s29, v198
  v_mul_f32 v207, s29, v199
  v_mfma_f32_16x16x32_bf16 a[236:239], v[208:211], a[172:175], a[236:239]
  v_exp_f32_e64 v201, v201
  v_mfma_f32_16x16x32_bf16 a[240:243], v[208:211], a[176:179], a[240:243]
  buffer_load_dwordx4 v223, s[12:15], s101 offen offset:3072 nt lds
  v_mfma_f32_16x16x32_bf16 a[244:247], v[208:211], a[180:183], a[244:247]
  v_exp_f32_e64 v202, v202
  v_mfma_f32_16x16x32_bf16 a[248:251], v[208:211], a[184:187], a[248:251]
  v_exp_f32_e64 v203, v203
  v_mfma_f32_16x16x32_bf16 a[252:255], v[208:211], a[188:191], a[252:255]
  v_exp_f32_e64 v204, v204
  v_mfma_f32_16x16x32_bf16 v[192:195], a[128:131], a[80:83], v[228:231]
  ds_read_b128 a[128:131], v216 offset:0
  v_cvt_pk_bf16_f32 v208, v200, v201
  v_mfma_f32_16x16x32_bf16 v[192:195], a[132:135], a[84:87], v[192:195]
  v_exp_f32_e64 v205, v205
  v_mfma_f32_16x16x32_bf16 v[192:195], a[136:139], a[88:91], v[192:195]
  ds_read_b128 a[132:135], v216 offset:64
  ds_read_b128 a[136:139], v216 offset:128
  v_mfma_f32_16x16x32_bf16 v[192:195], a[140:143], a[92:95], v[192:195]
  v_exp_f32_e64 v206, v206
  v_mfma_f32_16x16x32_bf16 v[196:199], a[144:147], a[92:95], v[228:231]
  ds_read_b128 a[140:143], v216 offset:192
  ds_read_b128 a[144:147], v216 offset:704
  v_mfma_f32_16x16x32_bf16 v[196:199], a[148:151], a[88:91], v[196:199]
  v_exp_f32_e64 v207, v207
  v_mfma_f32_16x16x32_bf16 v[196:199], a[152:155], a[84:87], v[196:199]
  v_cvt_pk_bf16_f32 v209, v202, v203
  v_cvt_pk_bf16_f32 v210, v204, v205
  v_cvt_pk_bf16_f32 v211, v206, v207
  v_mfma_f32_16x16x32_bf16 v[196:199], a[156:159], a[80:83], v[196:199]
  v_mul_f32 v200, s29, v192
  v_mul_f32 v201, s29, v193
  v_mfma_f32_16x16x32_bf16 v[128:131], v[208:211], a[160:163], v[128:131]
  ds_read_b128 a[148:151], v216 offset:640
  ds_read_b128 a[152:155], v216 offset:576
  v_mfma_f32_16x16x32_bf16 v[132:135], v[208:211], a[164:167], v[132:135]
  v_mul_f32 v202, s29, v194
  v_mul_f32 v203, s29, v195
  v_mfma_f32_16x16x32_bf16 v[136:139], v[208:211], a[168:171], v[136:139]
  ds_read_b128 a[156:159], v216 offset:512
  v_mul_f32_e64 v204, s29, v196
  v_mfma_f32_16x16x32_bf16 v[140:143], v[208:211], a[172:175], v[140:143]
  v_exp_f32_e64 v200, v200
  v_mfma_f32_16x16x32_bf16 v[144:147], v[208:211], a[176:179], v[144:147]
  v_exp_f32_e64 v201, v201
  v_mfma_f32_16x16x32_bf16 v[148:151], v[208:211], a[180:183], v[148:151]
  s_sub_u32 s37, s37, 1
  v_exp_f32 v202, v202
  v_mfma_f32_16x16x32_bf16 v[152:155], v[208:211], a[184:187], v[152:155]
  s_waitcnt lgkmcnt(3)
  v_mul_f32 v205, s29, v197
  v_exp_f32 v203, v203
  v_add_u32 v217, s30, v219
  v_mfma_f32_16x16x32_bf16 v[156:159], v[208:211], a[188:191], v[156:159]
  s_cbranch_scc1 L_exitA
  v_mul_f32 v206, s29, v198
  v_mul_f32_e64 v207, s29, v199
  v_mfma_f32_16x16x32_bf16 v[192:195], a[128:131], a[0:3], v[228:231]
  v_exp_f32_e64 v204, v204
  v_mfma_f32_16x16x32_bf16 v[192:195], a[132:135], a[4:7], v[192:195]
  v_exp_f32_e64 v205, v205
  v_mfma_f32_16x16x32_bf16 v[192:195], a[136:139], a[8:11], v[192:195]
  v_exp_f32_e64 v206, v206
  v_mfma_f32_16x16x32_bf16 v[192:195], a[140:143], a[12:15], v[192:195]
  v_exp_f32_e64 v207, v207
  v_mfma_f32_16x16x32_bf16 v[196:199], a[144:147], a[12:15], v[228:231]
  s_waitcnt lgkmcnt(0)
  v_cvt_pk_bf16_f32 v212, v200, v201
  v_cvt_pk_bf16_f32 v213, v202, v203
  v_mfma_f32_16x16x32_bf16 v[196:199], a[148:151], a[8:11], v[196:199]
  v_cvt_pk_bf16_f32 v214, v204, v205
  v_cvt_pk_bf16_f32 v215, v206, v207
  v_mfma_f32_16x16x32_bf16 v[196:199], a[152:155], a[4:7], v[196:199]
  v_mul_f32 v200, s29, v192
  v_mul_f32_e64 v201, s29, v193
  v_mfma_f32_16x16x32_bf16 v[196:199], a[156:159], a[0:3], v[196:199]
  v_mul_f32 v202, s29, v194
  v_mul_f32 v203, s29, v195
  v_mfma_f32_16x16x32_bf16 v[160:163], v[212:215], a[160:163], v[160:163]
  ds_read_b64_tr_b16 a[160:161], v217 offset:8448
  ds_read_b64_tr_b16 a[162:163], v217 offset:8960
  v_mfma_f32_16x16x32_bf16 v[164:167], v[212:215], a[164:167], v[164:167]
  v_exp_f32_e64 v200, v200
  v_mfma_f32_16x16x32_bf16 v[168:171], v[212:215], a[168:171], v[168:171]
  ds_read_b64_tr_b16 a[164:165], v217 offset:8464
  ds_read_b64_tr_b16 a[166:167], v217 offset:8976
  v_mfma_f32_16x16x32_bf16 v[172:175], v[212:215], a[172:175], v[172:175]
  v_exp_f32_e64 v201, v201
  v_mfma_f32_16x16x32_bf16 v[176:179], v[212:215], a[176:179], v[176:179]
  ds_read_b64_tr_b16 a[168:169], v217 offset:8480
  ds_read_b64_tr_b16 a[170:171], v217 offset:8992
  v_mfma_f32_16x16x32_bf16 v[180:183], v[212:215], a[180:183], v[180:183]
  v_exp_f32_e64 v202, v202
  v_mfma_f32_16x16x32_bf16 v[184:187], v[212:215], a[184:187], v[184:187]
  ds_read_b64_tr_b16 a[172:173], v217 offset:8496
  ds_read_b64_tr_b16 a[174:175], v217 offset:9008
  v_mfma_f32_16x16x32_bf16 v[188:191], v[212:215], a[188:191], v[188:191]
  v_mul_f32 v204, s29, v196
  v_mul_f32 v205, s29, v197
  v_smfmac_f32_16x16x64_bf16 a[200:203], a[220:223], v[208:215], v254
  v_exp_f32 v203, v203
  v_mul_f32 v206, s29, v198
  v_mul_f32_e64 v207, s29, v199
L_pE2:
  v_mfma_f32_16x16x32_bf16 v[192:195], a[128:131], a[16:19], v[228:231]
  ds_read_b64_tr_b16 a[176:177], v217 offset:8512
  ds_read_b64_tr_b16 a[178:179], v217 offset:9024
  v_mfma_f32_16x16x32_bf16 v[192:195], a[132:135], a[20:23], v[192:195]
  s_and_b32 s57, s99, 3
  v_exp_f32 v206, v206
  v_mfma_f32_16x16x32_bf16 v[192:195], a[136:139], a[24:27], v[192:195]
  ds_read_b64_tr_b16 a[180:181], v217 offset:8528
  ds_read_b64_tr_b16 a[182:183], v217 offset:9040
  v_mfma_f32_16x16x32_bf16 v[192:195], a[140:143], a[28:31], v[192:195]
  s_cselect_b32 s100, s34, 0x40000000
  v_exp_f32 v207, v207
  v_mfma_f32_16x16x32_bf16 v[196:199], a[144:147], a[28:31], v[228:231]
  ds_read_b64_tr_b16 a[184:185], v217 offset:8544
  ds_read_b64_tr_b16 a[186:187], v217 offset:9056
  v_mfma_f32_16x16x32_bf16 v[196:199], a[148:151], a[24:27], v[196:199]
  s_cmp_ge_u32 s57, 2
  v_exp_f32 v204, v204
  v_exp_f32_e64 v205, v205
  v_mfma_f32_16x16x32_bf16 v[196:199], a[152:155], a[20:23], v[196:199]
  s_waitcnt lgkmcnt(6)
  v_cvt_pk_bf16_f32 v208, v200, v201
  v_cvt_pk_bf16_f32 v209, v202, v203
  v_cvt_pk_bf16_f32 v210, v204, v205
  v_cvt_pk_bf16_f32 v211, v206, v207
  v_mfma_f32_16x16x32_bf16 v[196:199], a[156:159], a[16:19], v[196:199]
  ds_read_b64_tr_b16 a[188:189], v217 offset:8560
  ds_read_b64_tr_b16 a[190:191], v217 offset:9072
  v_mfma_f32_16x16x32_bf16 v[0:3], v[208:211], a[160:163], v[0:3]
  s_cselect_b32 s101, s34, 0x40000000
  v_mul_f32 v202, s29, v194
  v_mul_f32 v203, s29, v195
  v_mfma_f32_16x16x32_bf16 v[4:7], v[208:211], a[164:167], v[4:7]
  s_lshr_b32 s99, s99, 2
  v_mul_f32 v200, s29, v192
  v_mul_f32_e64 v201, s29, v193
  v_mfma_f32_16x16x32_bf16 v[8:11], v[208:211], a[168:171], v[8:11]
  s_lshl_b32 s57, s57, 11
  v_mul_f32 v206, s29, v198
  v_mul_f32_e64 v207, s29, v199
  v_mfma_f32_16x16x32_bf16 v[12:15], v[208:211], a[172:175], v[12:15]
  s_waitcnt lgkmcnt(4)
  v_mul_f32 v204, s29, v196
  v_mul_f32_e64 v205, s29, v197
  v_mfma_f32_16x16x32_bf16 v[16:19], v[208:211], a[176:179], v[16:19]
  s_add_u32 s34, s34, s57
  v_exp_f32 v206, v206
  v_mfma_f32_16x16x32_bf16 v[20:23], v[208:211], a[180:183], v[20:23]
  s_waitcnt lgkmcnt(2)
  v_exp_f32 v204, v204
  v_mfma_f32_16x16x32_bf16 v[24:27], v[208:211], a[184:187], v[24:27]
  s_waitcnt lgkmcnt(0)
  v_exp_f32 v207, v207
  v_mfma_f32_16x16x32_bf16 v[28:31], v[208:211], a[188:191], v[28:31]
  v_exp_f32_e64 v203, v203
  v_mfma_f32_16x16x32_bf16 v[192:195], a[128:131], a[32:35], v[228:231]
  v_exp_f32_e64 v205, v205
  v_mfma_f32_16x16x32_bf16 v[192:195], a[132:135], a[36:39], v[192:195]
  v_exp_f32_e64 v201, v201
  v_mfma_f32_16x16x32_bf16 v[192:195], a[136:139], a[40:43], v[192:195]
  v_exp_f32_e64 v202, v202
  v_mfma_f32_16x16x32_bf16 v[192:195], a[140:143], a[44:47], v[192:195]
  v_exp_f32_e64 v200, v200
  v_mfma_f32_16x16x32_bf16 v[196:199], a[144:147], a[44:47], v[228:231]
  v_cvt_pk_bf16_f32 v212, v200, v201
  v_cvt_pk_bf16_f32 v213, v202, v203
  v_mfma_f32_16x16x32_bf16 v[196:199], a[148:151], a[40:43], v[196:199]
  s_waitcnt vmcnt(8)
  v_cvt_pk_bf16_f32 v214, v204, v205
  v_cvt_pk_bf16_f32 v215, v206, v207
  v_mfma_f32_16x16x32_bf16 v[196:199], a[152:155], a[36:39], v[196:199]
  s_barrier
  v_mul_f32_e64 v203, s29, v195
  v_mfma_f32_16x16x32_bf16 v[196:199], a[156:159], a[32:35], v[196:199]
  s_mov_b32 m0, s30
  v_mul_f32 v200, s29, v192
  v_mul_f32_e64 v202, s29, v194
  v_smfmac_f32_16x16x64_bf16 a[192:195], a[220:223], v[208:215], v254
  buffer_load_dwordx4 v221, s[4:7], s33 offen lds
  v_mfma_f32_16x16x32_bf16 v[32:35], v[212:215], a[160:163], v[32:35]
  v_exp_f32_e64 v200, v200
  v_mfma_f32_16x16x32_bf16 v[36:39], v[212:215], a[164:167], v[36:39]
  v_mul_f32 v201, s29, v193
  v_mul_f32 v205, s29, v197
  v_mfma_f32_16x16x32_bf16 v[40:43], v[212:215], a[168:171], v[40:43]
  s_add_u32 m0, s30, 32
  v_mul_f32 v206, s29, v198
  v_mul_f32_e64 v207, s29, v199
  v_mfma_f32_16x16x32_bf16 v[44:47], v[212:215], a[172:175], v[44:47]
  buffer_load_dwordx4 v221, s[4:7], s33 offen offset:1024 lds
  v_mfma_f32_16x16x32_bf16 v[48:51], v[212:215], a[176:179], v[48:51]
  v_exp_f32_e64 v201, v201
  v_mfma_f32_16x16x32_bf16 v[52:55], v[212:215], a[180:183], v[52:55]
  v_mul_f32_e64 v204, s29, v196
  v_cvt_pk_bf16_f32 v208, v200, v201
  v_mfma_f32_16x16x32_bf16 v[56:59], v[212:215], a[184:187], v[56:59]
  s_add_u32 m0, s30, s96
  v_exp_f32 v202, v202
  v_mfma_f32_16x16x32_bf16 v[60:63], v[212:215], a[188:191], v[60:63]
  buffer_load_dwordx4 v221, s[8:11], s33 offen lds
  v_mfma_f32_16x16x32_bf16 v[192:195], a[128:131], a[48:51], v[228:231]
  v_exp_f32_e64 v207, v207
  v_mfma_f32_16x16x32_bf16 v[192:195], a[132:135], a[52:55], v[192:195]
  v_exp_f32_e64 v204, v204
  v_mfma_f32_16x16x32_bf16 v[192:195], a[136:139], a[56:59], v[192:195]
  v_exp_f32_e64 v206, v206
  v_mfma_f32_16x16x32_bf16 v[192:195], a[140:143], a[60:63], v[192:195]
  v_exp_f32_e64 v205, v205
  v_mfma_f32_16x16x32_bf16 v[196:199], a[144:147], a[60:63], v[228:231]
  v_exp_f32_e64 v203, v203
  v_mfma_f32_16x16x32_bf16 v[196:199], a[148:151], a[56:59], v[196:199]
  v_cvt_pk_bf16_f32 v209, v202, v203
  v_cvt_pk_bf16_f32 v210, v204, v205
  v_mfma_f32_16x16x32_bf16 v[196:199], a[152:155], a[52:55], v[196:199]
  s_add_u32 m0, s30, s97
  v_cvt_pk_bf16_f32 v211, v206, v207
  v_mul_f32 v200, s29, v192
  v_mfma_f32_16x16x32_bf16 v[196:199], a[156:159], a[48:51], v[196:199]
  buffer_load_dwordx4 v221, s[8:11], s33 offen offset:1024 lds
  v_mfma_f32_16x16x32_bf16 v[64:67], v[208:211], a[160:163], v[64:67]
  s_sub_u32 s30, s30, 16896
  v_mul_f32 v201, s29, v193
  v_mul_f32 v203, s29, v195
  v_mfma_f32_16x16x32_bf16 v[68:71], v[208:211], a[164:167], v[68:71]
  s_cselect_b32 s30, s31, s30
  v_exp_f32 v201, v201
  v_mfma_f32_16x16x32_bf16 v[72:75], v[208:211], a[168:171], v[72:75]
  s_add_u32 s59, s59, 8192
  v_mul_f32 v202, s29, v194
  v_mul_f32 v205, s29, v197
  v_mfma_f32_16x16x32_bf16 v[76:79], v[208:211], a[172:175], v[76:79]
  s_xor_b32 s33, s59, s3
  v_mul_f32 v204, s29, v196
  v_mul_f32_e64 v207, s29, v199
  v_mfma_f32_16x16x32_bf16 v[80:83], v[208:211], a[176:179], v[80:83]
  v_mul_f32 v206, s29, v198
  v_add_u32 v216, s30, v218
  v_mfma_f32_16x16x32_bf16 v[84:87], v[208:211], a[180:183], v[84:87]
  v_exp_f32_e64 v206, v206
  v_mfma_f32_16x16x32_bf16 v[88:91], v[208:211], a[184:187], v[88:91]
  v_exp_f32_e64 v205, v205
  v_mfma_f32_16x16x32_bf16 v[92:95], v[208:211], a[188:191], v[92:95]
  v_exp_f32_e64 v200, v200
  v_mfma_f32_16x16x32_bf16 v[192:195], a[128:131], a[96:99], v[228:231]
  v_exp_f32_e64 v207, v207
  v_mfma_f32_16x16x32_bf16 v[192:195], a[132:135], a[100:103], v[192:195]
  v_exp_f32_e64 v202, v202
  v_mfma_f32_16x16x32_bf16 v[192:195], a[136:139], a[104:107], v[192:195]
  v_exp_f32_e64 v204, v204
  v_mfma_f32_16x16x32_bf16 v[192:195], a[140:143], a[108:111], v[192:195]
  v_exp_f32_e64 v203, v203
  v_mfma_f32_16x16x32_bf16 v[196:199], a[144:147], a[108:111], v[228:231]
  v_cvt_pk_bf16_f32 v213, v202, v203
  v_cvt_pk_bf16_f32 v215, v206, v207
  v_mfma_f32_16x16x32_bf16 v[196:199], a[148:151], a[104:107], v[196:199]
  v_cvt_pk_bf16_f32 v212, v200, v201
  v_cvt_pk_bf16_f32 v214, v204, v205
  v_mfma_f32_16x16x32_bf16 v[196:199], a[152:155], a[100:103], v[196:199]
  v_mul_f32 v200, s29, v192
  v_mul_f32 v202, s29, v194
  v_mfma_f32_16x16x32_bf16 v[196:199], a[156:159], a[96:99], v[196:199]
  v_mul_f32 v201, s29, v193
  v_mul_f32 v203, s29, v195
  v_smfmac_f32_16x16x64_bf16 a[196:199], a[220:223], v[208:215], v254
  v_add_u32_e64 v217, s30, v219
  v_mfma_f32_16x16x32_bf16 v[96:99], v[212:215], a[160:163], v[96:99]
  v_exp_f32_e64 v202, v202
  v_mfma_f32_16x16x32_bf16 v[100:103], v[212:215], a[164:167], v[100:103]
  s_mov_b32 m0, s36
  v_mul_f32 v206, s29, v198
  v_mul_f32_e64 v207, s29, v199
  v_mfma_f32_16x16x32_bf16 v[104:107], v[212:215], a[168:171], v[104:107]
  buffer_load_dwordx4 v222, s[12:15], s100 offen nt lds
  v_mfma_f32_16x16x32_bf16 v[108:111], v[212:215], a[172:175], v[108:111]
  s_add_u32 s36, s36, s57
  v_mul_f32 v204, s29, v196
  v_mul_f32_e64 v205, s29, v197
  v_mfma_f32_16x16x32_bf16 v[112:115], v[212:215], a[176:179], v[112:115]
  v_exp_f32_e64 v205, v205
  v_mfma_f32_16x16x32_bf16 v[116:119], v[212:215], a[180:183], v[116:119]
  v_exp_f32_e64 v207, v207
  v_mfma_f32_16x16x32_bf16 v[120:123], v[212:215], a[184:187], v[120:123]
  buffer_load_dwordx4 v223, s[12:15], s100 offen offset:1024 nt lds
  v_mfma_f32_16x16x32_bf16 v[124:127], v[212:215], a[188:191], v[124:127]
  v_exp_f32_e64 v206, v206
  v_mfma_f32_16x16x32_bf16 v[192:195], a[128:131], a[64:67], v[228:231]
  v_exp_f32_e64 v204, v204
  v_mfma_f32_16x16x32_bf16 v[192:195], a[132:135], a[68:71], v[192:195]
  v_exp_f32_e64 v201, v201
  v_mfma_f32_16x16x32_bf16 v[192:195], a[136:139], a[72:75], v[192:195]
  v_exp_f32_e64 v203, v203
  v_mfma_f32_16x16x32_bf16 v[192:195], a[140:143], a[76:79], v[192:195]
  v_exp_f32_e64 v200, v200
  v_mfma_f32_16x16x32_bf16 v[196:199], a[144:147], a[76:79], v[228:231]
  v_cvt_pk_bf16_f32 v209, v202, v203
  v_cvt_pk_bf16_f32 v211, v206, v207
  v_mfma_f32_16x16x32_bf16 v[196:199], a[148:151], a[72:75], v[196:199]
  v_cvt_pk_bf16_f32 v208, v200, v201
  v_cvt_pk_bf16_f32 v210, v204, v205
  v_mfma_f32_16x16x32_bf16 v[196:199], a[152:155], a[68:71], v[196:199]
  buffer_load_dwordx4 v222, s[12:15], s101 offen offset:2048 nt lds
  v_mfma_f32_16x16x32_bf16 v[196:199], a[156:159], a[64:67], v[196:199]
  v_mul_f32 v200, s29, v192
  v_mul_f32 v203, s29, v195
  v_mfma_f32_16x16x32_bf16 a[204:207], a[220:223], v[208:211], a[204:207]
  v_mul_f32 v201, s29, v193
  v_mul_f32 v202, s29, v194
  v_mfma_f32_16x16x32_bf16 a[224:227], v[208:211], a[160:163], a[224:227]
  v_exp_f32_e64 v203, v203
  v_mfma_f32_16x16x32_bf16 a[228:231], v[208:211], a[164:167], a[228:231]
  buffer_load_dwordx4 v223, s[12:15], s101 offen offset:3072 nt lds
  v_mfma_f32_16x16x32_bf16 a[232:235], v[208:211], a[168:171], a[232:235]
  v_mul_f32 v204, s29, v196
  v_mul_f32 v205, s29, v197
  v_mfma_f32_16x16x32_bf16 a[236:239], v[208:211], a[172:175], a[236:239]
  v_mul_f32 v206, s29, v198
  v_mul_f32 v207, s29, v199
  v_mfma_f32_16x16x32_bf16 a[240:243], v[208:211], a[176:179], a[240:243]
  v_exp_f32_e64 v201, v201
  v_mfma_f32_16x16x32_bf16 a[244:247], v[208:211], a[180:183], a[244:247]
  v_exp_f32_e64 v207, v207
  v_mfma_f32_16x16x32_bf16 a[248:251], v[208:211], a[184:187], a[248:251]
  v_exp_f32_e64 v204, v204
  v_mfma_f32_16x16x32_bf16 a[252:255], v[208:211], a[188:191], a[252:255]
  v_exp_f32_e64 v206, v206
  v_mfma_f32_16x16x32_bf16 v[192:195], a[128:131], a[80:83], v[228:231]
  v_exp_f32_e64 v202, v202
  v_mfma_f32_16x16x32_bf16 v[192:195], a[132:135], a[84:87], v[192:195]
  ds_read_b128 a[128:131], v216 offset:0
  ds_read_b128 a[132:135], v216 offset:64
  v_mfma_f32_16x16x32_bf16 v[192:195], a[136:139], a[88:91], v[192:195]
  v_exp_f32_e64 v200, v200
  v_mfma_f32_16x16x32_bf16 v[192:195], a[140:143], a[92:95], v[192:195]
  ds_read_b128 a[136:139], v216 offset:128
  ds_read_b128 a[140:143], v216 offset:192
  v_mfma_f32_16x16x32_bf16 v[196:199], a[144:147], a[92:95], v[228:231]
  v_exp_f32_e64 v205, v205
  v_mfma_f32_16x16x32_bf16 v[196:199], a[148:151], a[88:91], v[196:199]
  ds_read_b128 a[144:147], v216 offset:704
  ds_read_b128 a[148:151], v216 offset:640
  v_mfma_f32_16x16x32_bf16 v[196:199], a[152:155], a[84:87], v[196:199]
  v_cvt_pk_bf16_f32 v208, v200, v201
  v_cvt_pk_bf16_f32 v209, v202, v203
  v_cvt_pk_bf16_f32 v210, v204, v205
  v_cvt_pk_bf16_f32 v211, v206, v207
  v_mfma_f32_16x16x32_bf16 v[196:199], a[156:159], a[80:83], v[196:199]
  ds_read_b128 a[152:155], v216 offset:576
  ds_read_b128 a[156:159], v216 offset:512
  v_mfma_f32_16x16x32_bf16 v[128:131], v[208:211], a[160:163], v[128:131]
  v_mul_f32 v200, s29, v192
  v_mul_f32 v202, s29, v194
  v_mfma_f32_16x16x32_bf16 v[132:135], v[208:211], a[164:167], v[132:135]
  v_mul_f32 v201, s29, v193
  v_mul_f32 v203, s29, v195
  v_mfma_f32_16x16x32_bf16 v[136:139], v[208:211], a[168:171], v[136:139]
  v_exp_f32_e64 v202, v202
  v_mfma_f32_16x16x32_bf16 v[140:143], v[208:211], a[172:175], v[140:143]
  v_exp_f32_e64 v203, v203
  v_mfma_f32_16x16x32_bf16 v[144:147], v[208:211], a[176:179], v[144:147]
  v_exp_f32_e64 v200, v200
  v_mfma_f32_16x16x32_bf16 v[148:151], v[208:211], a[180:183], v[148:151]
  s_sub_u32 s37, s37, 1
  v_exp_f32 v201, v201
  v_mfma_f32_16x16x32_bf16 v[152:155], v[208:211], a[184:187], v[152:155]
  s_waitcnt lgkmcnt(2)
  v_mul_f32 v204, s29, v196
  v_mul_f32_e64 v205, s29, v197
  v_mfma_f32_16x16x32_bf16 v[156:159], v[208:211], a[188:191], v[156:159]
  s_cbranch_scc1 L_exitA
  v_mul_f32 v206, s29, v198
  v_mul_f32_e64 v207, s29, v199
  v_mfma_f32_16x16x32_bf16 v[192:195], a[128:131], a[0:3], v[228:231]
  v_exp_f32_e64 v205, v205
  v_mfma_f32_16x16x32_bf16 v[192:195], a[132:135], a[4:7], v[192:195]
  v_exp_f32_e64 v204, v204
  v_mfma_f32_16x16x32_bf16 v[192:195], a[136:139], a[8:11], v[192:195]
  v_exp_f32_e64 v206, v206
  v_mfma_f32_16x16x32_bf16 v[192:195], a[140:143], a[12:15], v[192:195]
  v_exp_f32_e64 v207, v207
  v_mfma_f32_16x16x32_bf16 v[196:199], a[144:147], a[12:15], v[228:231]
  v_cvt_pk_bf16_f32 v212, v200, v201
  v_cvt_pk_bf16_f32 v213, v202, v203
  v_mfma_f32_16x16x32_bf16 v[196:199], a[148:151], a[8:11], v[196:199]
  s_waitcnt lgkmcnt(0)
  v_cvt_pk_bf16_f32 v214, v204, v205
  v_cvt_pk_bf16_f32 v215, v206, v207
  v_mfma_f32_16x16x32_bf16 v[196:199], a[152:155], a[4:7], v[196:199]
  v_mul_f32 v200, s29, v192
  v_mul_f32_e64 v203, s29, v195
  v_mfma_f32_16x16x32_bf16 v[196:199], a[156:159], a[0:3], v[196:199]
  v_mul_f32 v201, s29, v193
  v_mul_f32 v202, s29, v194
  v_mfma_f32_16x16x32_bf16 v[160:163], v[212:215], a[160:163], v[160:163]
  v_exp_f32_e64 v201, v201
  v_mfma_f32_16x16x32_bf16 v[164:167], v[212:215], a[164:167], v[164:167]
  ds_read_b64_tr_b16 a[164:165], v217 offset:8464
  ds_read_b64_tr_b16 a[166:167], v217 offset:8976
  v_mfma_f32_16x16x32_bf16 v[168:171], v[212:215], a[168:171], v[168:171]
  v_mul_f32 v206, s29, v198
  v_mul_f32 v207, s29, v199
  v_mfma_f32_16x16x32_bf16 v[172:175], v[212:215], a[172:175], v[172:175]
  ds_read_b64_tr_b16 a[168:169], v217 offset:8480
  ds_read_b64_tr_b16 a[174:175], v217 offset:9008
  v_mfma_f32_16x16x32_bf16 v[176:179], v[212:215], a[176:179], v[176:179]
  v_exp_f32_e64 v200, v200
  v_mfma_f32_16x16x32_bf16 v[180:183], v[212:215], a[180:183], v[180:183]
  ds_read_b64_tr_b16 a[162:163], v217 offset:8960
  ds_read_b64_tr_b16 a[172:173], v217 offset:8496
  v_mfma_f32_16x16x32_bf16 v[184:187], v[212:215], a[184:187], v[184:187]
  v_exp_f32_e64 v202, v202
  v_mfma_f32_16x16x32_bf16 v[188:191], v[212:215], a[188:191], v[188:191]
  ds_read_b64_tr_b16 a[160:161], v217 offset:8448
  ds_read_b64_tr_b16 a[170:171], v217 offset:8992
  v_smfmac_f32_16x16x64_bf16 a[200:203], a[220:223], v[208:215], v254
  v_mul_f32 v204, s29, v196
  v_mul_f32 v205, s29, v197
  v_exp_f32_e64 v203, v203
L_pE3:
  v_mfma_f32_16x16x32_bf16 v[192:195], a[128:131], a[16:19], v[228:231]
  s_and_b32 s57, s99, 3
  v_exp_f32 v206, v206
  v_mfma_f32_16x16x32_bf16 v[192:195], a[132:135], a[20:23], v[192:195]
  ds_read_b64_tr_b16 a[176:177], v217 offset:8512
  ds_read_b64_tr_b16 a[178:179], v217 offset:9024
  v_mfma_f32_16x16x32_bf16 v[192:195], a[136:139], a[24:27], v[192:195]
  s_cselect_b32 s100, s34, 0x40000000
  v_exp_f32 v207, v207
  v_mfma_f32_16x16x32_bf16 v[192:195], a[140:143], a[28:31], v[192:195]
  ds_read_b64_tr_b16 a[180:181], v217 offset:8528
  ds_read_b64_tr_b16 a[182:183], v217 offset:9040
  v_mfma_f32_16x16x32_bf16 v[196:199], a[144:147], a[28:31], v[228:231]
  s_cmp_ge_u32 s57, 2
  v_exp_f32 v204, v204
  v_mfma_f32_16x16x32_bf16 v[196:199], a[148:151], a[24:27], v[196:199]
  s_waitcnt lgkmcnt(4)
  v_exp_f32 v205, v205
  v_mfma_f32_16x16x32_bf16 v[196:199], a[152:155], a[20:23], v[196:199]
  ds_read_b64_tr_b16 a[184:185], v217 offset:8544
  ds_read_b64_tr_b16 a[186:187], v217 offset:9056
  v_cvt_pk_bf16_f32 v208, v200, v201
  v_cvt_pk_bf16_f32 v209, v202, v203
  v_cvt_pk_bf16_f32 v210, v204, v205
  v_cvt_pk_bf16_f32 v211, v206, v207
  v_mfma_f32_16x16x32_bf16 v[196:199], a[156:159], a[16:19], v[196:199]
  ds_read_b64_tr_b16 a[188:189], v217 offset:8560
  ds_read_b64_tr_b16 a[190:191], v217 offset:9072
  v_mfma_f32_16x16x32_bf16 v[0:3], v[208:211], a[160:163], v[0:3]
  s_cselect_b32 s101, s34, 0x40000000
  v_mul_f32 v202, s29, v194
  v_mul_f32_e64 v203, s29, v195
  v_mfma_f32_16x16x32_bf16 v[4:7], v[208:211], a[164:167], v[4:7]
  s_lshr_b32 s99, s99, 2
  v_mul_f32 v200, s29, v192
  v_mul_f32_e64 v201, s29, v193
  v_mfma_f32_16x16x32_bf16 v[8:11], v[208:211], a[168:171], v[8:11]
  s_lshl_b32 s57, s57, 11
  v_mul_f32 v206, s29, v198
  v_mul_f32_e64 v207, s29, v199
  v_mfma_f32_16x16x32_bf16 v[12:15], v[208:211], a[172:175], v[12:15]
  s_waitcnt lgkmcnt(4)
  v_mul_f32 v204, s29, v196
  v_mul_f32_e64 v205, s29, v197
  v_mfma_f32_16x16x32_bf16 v[16:19], v[208:211], a[176:179], v[16:19]
  s_add_u32 s34, s34, s57
  v_exp_f32 v206, v206
  v_mfma_f32_16x16x32_bf16 v[20:23], v[208:211], a[180:183], v[20:23]
  s_waitcnt lgkmcnt(2)
  v_exp_f32 v204, v204
  v_mfma_f32_16x16x32_bf16 v[24:27], v[208:211], a[184:187], v[24:27]
  s_waitcnt lgkmcnt(0)
  v_exp_f32 v207, v207
  v_mfma_f32_16x16x32_bf16 v[28:31], v[208:211], a[188:191], v[28:31]
  v_exp_f32_e64 v203, v203
  v_mfma_f32_16x16x32_bf16 v[192:195], a[128:131], a[32:35], v[228:231]
  v_exp_f32_e64 v205, v205
  v_mfma_f32_16x16x32_bf16 v[192:195], a[132:135], a[36:39], v[192:195]
  v_exp_f32_e64 v201, v201
  v_mfma_f32_16x16x32_bf16 v[192:195], a[136:139], a[40:43], v[192:195]
  v_exp_f32_e64 v202, v202
  v_mfma_f32_16x16x32_bf16 v[192:195], a[140:143], a[44:47], v[192:195]
  v_exp_f32_e64 v200, v200
  v_mfma_f32_16x16x32_bf16 v[196:199], a[144:147], a[44:47], v[228:231]
  v_cvt_pk_bf16_f32 v212, v200, v201
  v_cvt_pk_bf16_f32 v213, v202, v203
  v_mfma_f32_16x16x32_bf16 v[196:199], a[148:151], a[40:43], v[196:199]
  s_waitcnt vmcnt(8)
  v_cvt_pk_bf16_f32 v214, v204, v205
  v_cvt_pk_bf16_f32 v215, v206, v207
  v_mfma_f32_16x16x32_bf16 v[196:199], a[152:155], a[36:39], v[196:199]
  s_barrier
  v_mul_f32_e64 v203, s29, v195
  v_mfma_f32_16x16x32_bf16 v[196:199], a[156:159], a[32:35], v[196:199]
  v_mul_f32 v200, s29, v192
  v_mul_f32 v202, s29, v194
  v_smfmac_f32_16x16x64_bf16 a[192:195], a[220:223], v[208:215], v254
  s_mov_b32 m0, s30
  v_mul_f32 v201, s29, v193
  v_mfma_f32_16x16x32_bf16 v[32:35], v[212:215], a[160:163], v[32:35]
  buffer_load_dwordx4 v221, s[4:7], s33 offen lds
  v_mfma_f32_16x16x32_bf16 v[36:39], v[212:215], a[164:167], v[36:39]
  v_mul_f32 v205, s29, v197
  v_mul_f32 v207, s29, v199
  v_mfma_f32_16x16x32_bf16 v[40:43], v[212:215], a[168:171], v[40:43]
  v_mul_f32 v204, s29, v196
  v_mul_f32 v206, s29, v198
  v_mfma_f32_16x16x32_bf16 v[44:47], v[212:215], a[172:175], v[44:47]
  s_add_u32 m0, s30, 32
  v_exp_f32 v201, v201
  v_mfma_f32_16x16x32_bf16 v[48:51], v[212:215], a[176:179], v[48:51]
  buffer_load_dwordx4 v221, s[4:7], s33 offen offset:1024 lds
  v_mfma_f32_16x16x32_bf16 v[52:55], v[212:215], a[180:183], v[52:55]
  v_exp_f32_e64 v200, v200
  v_mfma_f32_16x16x32_bf16 v[56:59], v[212:215], a[184:187], v[56:59]
  v_exp_f32_e64 v202, v202
  v_mfma_f32_16x16x32_bf16 v[60:63], v[212:215], a[188:191], v[60:63]
  s_add_u32 m0, s30, s96
  v_exp_f32 v207, v207
  v_mfma_f32_16x16x32_bf16 v[192:195], a[128:131], a[48:51], v[228:231]
  buffer_load_dwordx4 v221, s[8:11], s33 offen lds
  v_mfma_f32_16x16x32_bf16 v[192:195], a[132:135], a[52:55], v[192:195]
  v_exp_f32_e64 v204, v204
  v_mfma_f32_16x16x32_bf16 v[192:195], a[136:139], a[56:59], v[192:195]
  v_exp_f32_e64 v206, v206
  v_mfma_f32_16x16x32_bf16 v[192:195], a[140:143], a[60:63], v[192:195]
  v_exp_f32_e64 v205, v205
  v_mfma_f32_16x16x32_bf16 v[196:199], a[144:147], a[60:63], v[228:231]
  v_exp_f32_e64 v203, v203
  v_mfma_f32_16x16x32_bf16 v[196:199], a[148:151], a[56:59], v[196:199]
  v_cvt_pk_bf16_f32 v208, v200, v201
  v_cvt_pk_bf16_f32 v209, v202, v203
  v_mfma_f32_16x16x32_bf16 v[196:199], a[152:155], a[52:55], v[196:199]
  v_cvt_pk_bf16_f32 v210, v204, v205
  v_cvt_pk_bf16_f32 v211, v206, v207
  v_mfma_f32_16x16x32_bf16 v[196:199], a[156:159], a[48:51], v[196:199]
  s_add_u32 m0, s30, s97
  v_mul_f32 v200, s29, v192
  v_mul_f32_e64 v201, s29, v193
  v_mfma_f32_16x16x32_bf16 v[64:67], v[208:211], a[160:163], v[64:67]
  buffer_load_dwordx4 v221, s[8:11], s33 offen offset:1024 lds
  v_mfma_f32_16x16x32_bf16 v[68:71], v[208:211], a[164:167], v[68:71]
  s_sub_u32 s30, s30, 16896
  v_mul_f32 v202, s29, v194
  v_mul_f32 v203, s29, v195
  v_mfma_f32_16x16x32_bf16 v[72:75], v[208:211], a[168:171], v[72:75]
  s_cselect_b32 s30, s31, s30
  v_mul_f32 v205, s29, v197
  v_mul_f32_e64 v207, s29, v199
  v_mfma_f32_16x16x32_bf16 v[76:79], v[208:211], a[172:175], v[76:79]
  s_add_u32 s59, s59, 8192
  v_mul_f32 v204, s29, v196
  v_mul_f32 v206, s29, v198
  v_mfma_f32_16x16x32_bf16 v[80:83], v[208:211], a[176:179], v[80:83]
  s_xor_b32 s33, s59, s3
  v_exp_f32 v206, v206
  v_mfma_f32_16x16x32_bf16 v[84:87], v[208:211], a[180:183], v[84:87]
  v_exp_f32_e64 v201, v201
  v_mfma_f32_16x16x32_bf16 v[88:91], v[208:211], a[184:187], v[88:91]
  v_exp_f32_e64 v205, v205
  v_mfma_f32_16x16x32_bf16 v[92:95], v[208:211], a[188:191], v[92:95]
  v_exp_f32_e64 v200, v200
  v_mfma_f32_16x16x32_bf16 v[192:195], a[128:131], a[96:99], v[228:231]
  v_exp_f32_e64 v207, v207
  v_mfma_f32_16x16x32_bf16 v[192:195], a[132:135], a[100:103], v[192:195]
  v_exp_f32_e64 v202, v202
  v_mfma_f32_16x16x32_bf16 v[192:195], a[136:139], a[104:107], v[192:195]
  v_exp_f32_e64 v204, v204
  v_mfma_f32_16x16x32_bf16 v[192:195], a[140:143], a[108:111], v[192:195]
  v_exp_f32_e64 v203, v203
  v_mfma_f32_16x16x32_bf16 v[196:199], a[144:147], a[108:111], v[228:231]
  v_cvt_pk_bf16_f32 v213, v202, v203
  v_cvt_pk_bf16_f32 v215, v206, v207
  v_mfma_f32_16x16x32_bf16 v[196:199], a[148:151], a[104:107], v[196:199]
  v_cvt_pk_bf16_f32 v212, v200, v201
  v_cvt_pk_bf16_f32 v214, v204, v205
  v_mfma_f32_16x16x32_bf16 v[196:199], a[152:155], a[100:103], v[196:199]
  v_mul_f32 v200, s29, v192
  v_mul_f32 v202, s29, v194
  v_mfma_f32_16x16x32_bf16 v[196:199], a[156:159], a[96:99], v[196:199]
  s_mov_b32 m0, s36
  v_mul_f32 v201, s29, v193
  v_mul_f32_e64 v203, s29, v195
  v_smfmac_f32_16x16x64_bf16 a[196:199], a[220:223], v[208:215], v254
  buffer_load_dwordx4 v222, s[12:15], s100 offen nt lds
  v_mfma_f32_16x16x32_bf16 v[96:99], v[212:215], a[160:163], v[96:99]
  s_add_u32 s36, s36, s57
  v_exp_f32 v202, v202
  v_mfma_f32_16x16x32_bf16 v[100:103], v[212:215], a[164:167], v[100:103]
  v_mul_f32 v206, s29, v198
  v_mul_f32 v207, s29, v199
  v_mfma_f32_16x16x32_bf16 v[104:107], v[212:215], a[168:171], v[104:107]
  v_mul_f32 v204, s29, v196
  v_mul_f32 v205, s29, v197
  v_mfma_f32_16x16x32_bf16 v[108:111], v[212:215], a[172:175], v[108:111]
  buffer_load_dwordx4 v223, s[12:15], s100 offen offset:1024 nt lds
  v_mfma_f32_16x16x32_bf16 v[112:115], v[212:215], a[176:179], v[112:115]
  v_exp_f32_e64 v205, v205
  v_mfma_f32_16x16x32_bf16 v[116:119], v[212:215], a[180:183], v[116:119]
  v_exp_f32_e64 v207, v207
  v_mfma_f32_16x16x32_bf16 v[120:123], v[212:215], a[184:187], v[120:123]
  v_exp_f32_e64 v206, v206
  v_mfma_f32_16x16x32_bf16 v[124:127], v[212:215], a[188:191], v[124:127]
  v_exp_f32_e64 v204, v204
  v_mfma_f32_16x16x32_bf16 v[192:195], a[128:131], a[64:67], v[228:231]
  v_exp_f32_e64 v201, v201
  v_mfma_f32_16x16x32_bf16 v[192:195], a[132:135], a[68:71], v[192:195]
  v_exp_f32_e64 v203, v203
  v_mfma_f32_16x16x32_bf16 v[192:195], a[136:139], a[72:75], v[192:195]
  v_exp_f32_e64 v200, v200
  v_mfma_f32_16x16x32_bf16 v[192:195], a[140:143], a[76:79], v[192:195]
  v_cvt_pk_bf16_f32 v209, v202, v203
  v_cvt_pk_bf16_f32 v211, v206, v207
  v_mfma_f32_16x16x32_bf16 v[196:199], a[144:147], a[76:79], v[228:231]
  v_cvt_pk_bf16_f32 v208, v200, v201
  v_cvt_pk_bf16_f32 v210, v204, v205
  v_mfma_f32_16x16x32_bf16 v[196:199], a[148:151], a[72:75], v[196:199]
  v_add_u32 v216, s30, v218
  v_add_u32 v217, s30, v219
  v_mfma_f32_16x16x32_bf16 v[196:199], a[152:155], a[68:71], v[196:199]
  v_mul_f32 v200, s29, v192
  v_mul_f32 v203, s29, v195
  v_mfma_f32_16x16x32_bf16 v[196:199], a[156:159], a[64:67], v[196:199]
  buffer_load_dwordx4 v222, s[12:15], s101 offen offset:2048 nt lds
  v_mfma_f32_16x16x32_bf16 a[204:207], a[220:223], v[208:211], a[204:207]
  v_mul_f32 v201, s29, v193
  v_mul_f32 v202, s29, v194
  v_mfma_f32_16x16x32_bf16 a[224:227], v[208:211], a[160:163], a[224:227]
  v_exp_f32_e64 v203, v203
  v_mfma_f32_16x16x32_bf16 a[228:231], v[208:211], a[164:167], a[228:231]
  v_mul_f32 v204, s29, v196
  v_mul_f32 v205, s29, v197
  v_mfma_f32_16x16x32_bf16 a[232:235], v[208:211], a[168:171], a[232:235]
  buffer_load_dwordx4 v223, s[12:15], s101 offen offset:3072 nt lds
  v_mfma_f32_16x16x32_bf16 a[236:239], v[208:211], a[172:175], a[236:239]
  v_mul_f32 v206, s29, v198
  v_mul_f32 v207, s29, v199
  v_mfma_f32_16x16x32_bf16 a[240:243], v[208:211], a[176:179], a[240:243]
  v_exp_f32_e64 v201, v201
  v_mfma_f32_16x16x32_bf16 a[244:247], v[208:211], a[180:183], a[244:247]
  v_exp_f32_e64 v207, v207
  v_mfma_f32_16x16x32_bf16 a[248:251], v[208:211], a[184:187], a[248:251]
  v_exp_f32_e64 v204, v204
  v_mfma_f32_16x16x32_bf16 a[252:255], v[208:211], a[188:191], a[252:255]
  v_exp_f32_e64 v206, v206
  v_mfma_f32_16x16x32_bf16 v[192:195], a[128:131], a[80:83], v[228:231]
  ds_read_b128 a[128:131], v216 offset:0
  v_cvt_pk_bf16_f32 v211, v206, v207
  v_mfma_f32_16x16x32_bf16 v[192:195], a[132:135], a[84:87], v[192:195]
  v_exp_f32_e64 v202, v202
  v_mfma_f32_16x16x32_bf16 v[192:195], a[136:139], a[88:91], v[192:195]
  ds_read_b128 a[132:135], v216 offset:64
  ds_read_b128 a[136:139], v216 offset:128
  v_mfma_f32_16x16x32_bf16 v[192:195], a[140:143], a[92:95], v[192:195]
  v_exp_f32_e64 v200, v200
  v_mfma_f32_16x16x32_bf16 v[196:199], a[144:147], a[92:95], v[228:231]
  ds_read_b128 a[140:143], v216 offset:192
  ds_read_b128 a[144:147], v216 offset:704
  v_mfma_f32_16x16x32_bf16 v[196:199], a[148:151], a[88:91], v[196:199]
  v_exp_f32_e64 v205, v205
  v_mfma_f32_16x16x32_bf16 v[196:199], a[152:155], a[84:87], v[196:199]
  v_cvt_pk_bf16_f32 v208, v200, v201
  v_cvt_pk_bf16_f32 v209, v202, v203
  v_cvt_pk_bf16_f32 v210, v204, v205
  v_mfma_f32_16x16x32_bf16 v[196:199], a[156:159], a[80:83], v[196:199]
  v_mul_f32 v200, s29, v192
  v_mul_f32 v202, s29, v194
  v_mfma_f32_16x16x32_bf16 v[128:131], v[208:211], a[160:163], v[128:131]
  ds_read_b128 a[148:151], v216 offset:640
  ds_read_b128 a[152:155], v216 offset:576
  v_mfma_f32_16x16x32_bf16 v[132:135], v[208:211], a[164:167], v[132:135]
  v_mul_f32 v201, s29, v193
  v_mul_f32 v203, s29, v195
  v_mfma_f32_16x16x32_bf16 v[136:139], v[208:211], a[168:171], v[136:139]
  ds_read_b128 a[156:159], v216 offset:512
  v_mul_f32_e64 v204, s29, v196
  v_mfma_f32_16x16x32_bf16 v[140:143], v[208:211], a[172:175], v[140:143]
  v_exp_f32_e64 v202, v202
  v_mfma_f32_16x16x32_bf16 v[144:147], v[208:211], a[176:179], v[144:147]
  v_exp_f32_e64 v203, v203
  v_mfma_f32_16x16x32_bf16 v[148:151], v[208:211], a[180:183], v[148:151]
  s_sub_u32 s37, s37, 1
  v_exp_f32 v200, v200
  v_mfma_f32_16x16x32_bf16 v[152:155], v[208:211], a[184:187], v[152:155]
  s_waitcnt lgkmcnt(3)
  v_exp_f32 v201, v201
  v_mul_f32_e64 v205, s29, v197
  v_mfma_f32_16x16x32_bf16 v[156:159], v[208:211], a[188:191], v[156:159]
  s_cbranch_scc1 L_exitA
  v_mul_f32 v206, s29, v198
  v_mul_f32_e64 v207, s29, v199
  v_mfma_f32_16x16x32_bf16 v[192:195], a[128:131], a[0:3], v[228:231]
  v_exp_f32_e64 v205, v205
  v_mfma_f32_16x16x32_bf16 v[192:195], a[132:135], a[4:7], v[192:195]
  v_exp_f32_e64 v204, v204
  v_mfma_f32_16x16x32_bf16 v[192:195], a[136:139], a[8:11], v[192:195]
  v_exp_f32_e64 v206, v206
  v_mfma_f32_16x16x32_bf16 v[192:195], a[140:143], a[12:15], v[192:195]
  v_exp_f32_e64 v207, v207
  v_mfma_f32_16x16x32_bf16 v[196:199], a[144:147], a[12:15], v[228:231]
  s_waitcnt lgkmcnt(0)
  v_cvt_pk_bf16_f32 v212, v200, v201
  v_cvt_pk_bf16_f32 v213, v202, v203
  v_mfma_f32_16x16x32_bf16 v[196:199], a[148:151], a[8:11], v[196:199]
  v_cvt_pk_bf16_f32 v214, v204, v205
  v_cvt_pk_bf16_f32 v215, v206, v207
  v_mfma_f32_16x16x32_bf16 v[196:199], a[152:155], a[4:7], v[196:199]
  v_mul_f32 v200, s29, v192
  v_mul_f32_e64 v203, s29, v195
  v_mfma_f32_16x16x32_bf16 v[196:199], a[156:159], a[0:3], v[196:199]
  v_mul_f32 v201, s29, v193
  v_mul_f32 v202, s29, v194
  v_mfma_f32_16x16x32_bf16 v[160:163], v[212:215], a[160:163], v[160:163]
  ds_read_b64_tr_b16 a[160:161], v217 offset:8448
  ds_read_b64_tr_b16 a[162:163], v217 offset:8960
  v_mfma_f32_16x16x32_bf16 v[164:167], v[212:215], a[164:167], v[164:167]
  v_exp_f32_e64 v201, v201
  v_mfma_f32_16x16x32_bf16 v[168:171], v[212:215], a[168:171], v[168:171]
  ds_read_b64_tr_b16 a[164:165], v217 offset:8464
  ds_read_b64_tr_b16 a[168:169], v217 offset:8480
  v_mfma_f32_16x16x32_bf16 v[172:175], v[212:215], a[172:175], v[172:175]
  v_mul_f32 v206, s29, v198
  v_mul_f32 v207, s29, v199
  v_mfma_f32_16x16x32_bf16 v[176:179], v[212:215], a[176:179], v[176:179]
  ds_read_b64_tr_b16 a[166:167], v217 offset:8976
  ds_read_b64_tr_b16 a[174:175], v217 offset:9008
  v_mfma_f32_16x16x32_bf16 v[180:183], v[212:215], a[180:183], v[180:183]
  v_exp_f32_e64 v200, v200
  v_mfma_f32_16x16x32_bf16 v[184:187], v[212:215], a[184:187], v[184:187]
  ds_read_b64_tr_b16 a[170:171], v217 offset:8992
  ds_read_b64_tr_b16 a[172:173], v217 offset:8496
  v_mfma_f32_16x16x32_bf16 v[188:191], v[212:215], a[188:191], v[188:191]
  v_exp_f32_e64 v202, v202
  v_smfmac_f32_16x16x64_bf16 a[200:203], a[220:223], v[208:215], v254
  v_mul_f32 v204, s29, v196
  v_mul_f32 v205, s29, v197
  v_exp_f32_e64 v203, v203
L_pE0:
  v_mfma_f32_16x16x32_bf16 v[192:195], a[128:131], a[16:19], v[228:231]
  ds_read_b64_tr_b16 a[176:177], v217 offset:8512
  ds_read_b64_tr_b16 a[178:179], v217 offset:9024
  v_mfma_f32_16x16x32_bf16 v[192:195], a[132:135], a[20:23], v[192:195]
  v_exp_f32_e64 v204, v204
  v_mfma_f32_16x16x32_bf16 v[192:195], a[136:139], a[24:27], v[192:195]
  ds_read_b64_tr_b16 a[182:183], v217 offset:9040
  ds_read_b64_tr_b16 a[184:185], v217 offset:8544
  v_mfma_f32_16x16x32_bf16 v[192:195], a[140:143], a[28:31], v[192:195]
  v_exp_f32_e64 v207, v207
  v_mfma_f32_16x16x32_bf16 v[196:199], a[144:147], a[28:31], v[228:231]
  ds_read_b64_tr_b16 a[180:181], v217 offset:8528
  ds_read_b64_tr_b16 a[186:187], v217 offset:9056
  v_mfma_f32_16x16x32_bf16 v[196:199], a[148:151], a[24:27], v[196:199]
  v_exp_f32 v205, v205
  v_exp_f32 v206, v206
  v_mfma_f32_16x16x32_bf16 v[196:199], a[152:155], a[20:23], v[196:199]
  s_waitcnt lgkmcnt(6)
  v_cvt_pk_bf16_f32 v208, v200, v201
  v_cvt_pk_bf16_f32 v209, v202, v203
  v_cvt_pk_bf16_f32 v210, v204, v205
  v_cvt_pk_bf16_f32 v211, v206, v207
  v_mfma_f32_16x16x32_bf16 v[196:199], a[156:159], a[16:19], v[196:199]
  ds_read_b64_tr_b16 a[188:189], v217 offset:8560
  ds_read_b64_tr_b16 a[190:191], v217 offset:9072
  v_mfma_f32_16x16x32_bf16 v[0:3], v[208:211], a[160:163], v[0:3]
  v_mul_f32 v200, s29, v192
  v_mul_f32_e64 v202, s29, v194
  v_mfma_f32_16x16x32_bf16 v[4:7], v[208:211], a[164:167], v[4:7]
  v_mul_f32 v201, s29, v193
  v_mul_f32 v203, s29, v195
  v_mfma_f32_16x16x32_bf16 v[8:11], v[208:211], a[168:171], v[8:11]
  v_mul_f32 v204, s29, v196
  v_mul_f32 v207, s29, v199
  v_mfma_f32_16x16x32_bf16 v[12:15], v[208:211], a[172:175], v[12:15]
  s_waitcnt lgkmcnt(4)
  v_exp_f32 v207, v207
  v_mfma_f32_16x16x32_bf16 v[16:19], v[208:211], a[176:179], v[16:19]
  s_waitcnt lgkmcnt(2)
  v_mul_f32 v205, s29, v197
  v_mul_f32_e64 v206, s29, v198
  v_mfma_f32_16x16x32_bf16 v[20:23], v[208:211], a[180:183], v[20:23]
  v_exp_f32_e64 v202, v202
  v_mfma_f32_16x16x32_bf16 v[24:27], v[208:211], a[184:187], v[24:27]
  s_waitcnt lgkmcnt(0)
  v_exp_f32 v206, v206
  v_mfma_f32_16x16x32_bf16 v[28:31], v[208:211], a[188:191], v[28:31]
  v_exp_f32_e64 v205, v205
  v_mfma_f32_16x16x32_bf16 v[192:195], a[128:131], a[32:35], v[228:231]
  v_exp_f32_e64 v203, v203
  v_mfma_f32_16x16x32_bf16 v[192:195], a[132:135], a[36:39], v[192:195]
  v_exp_f32_e64 v200, v200
  v_mfma_f32_16x16x32_bf16 v[192:195], a[136:139], a[40:43], v[192:195]
  v_exp_f32_e64 v201, v201
  v_mfma_f32_16x16x32_bf16 v[192:195], a[140:143], a[44:47], v[192:195]
  v_cvt_pk_bf16_f32 v212, v200, v201
  v_cvt_pk_bf16_f32 v213, v202, v203
  v_mfma_f32_16x16x32_bf16 v[196:199], a[144:147], a[44:47], v[228:231]
  v_exp_f32_e64 v204, v204
  v_mfma_f32_16x16x32_bf16 v[196:199], a[148:151], a[40:43], v[196:199]
  s_waitcnt vmcnt(8)
  v_cvt_pk_bf16_f32 v214, v204, v205
  v_cvt_pk_bf16_f32 v215, v206, v207
  v_mfma_f32_16x16x32_bf16 v[196:199], a[152:155], a[36:39], v[196:199]
  s_barrier
  v_mul_f32_e64 v203, s29, v195
  v_mfma_f32_16x16x32_bf16 v[196:199], a[156:159], a[32:35], v[196:199]
  v_mul_f32 v200, s29, v192
  v_mul_f32 v201, s29, v193
  v_smfmac_f32_16x16x64_bf16 a[192:195], a[220:223], v[208:215], v254
  v_mul_f32_e64 v202, s29, v194
  v_mfma_f32_16x16x32_bf16 v[32:35], v[212:215], a[160:163], v[32:35]
  v_exp_f32_e64 v201, v201
  v_mfma_f32_16x16x32_bf16 v[36:39], v[212:215], a[164:167], v[36:39]
  v_mul_f32 v206, s29, v198
  v_mul_f32 v207, s29, v199
  v_mfma_f32_16x16x32_bf16 v[40:43], v[212:215], a[168:171], v[40:43]
  v_mul_f32 v204, s29, v196
  v_mul_f32 v205, s29, v197
  v_mfma_f32_16x16x32_bf16 v[44:47], v[212:215], a[172:175], v[44:47]
  v_exp_f32_e64 v206, v206
  v_mfma_f32_16x16x32_bf16 v[48:51], v[212:215], a[176:179], v[48:51]
  s_mov_b32 m0, s30
  v_exp_f32 v200, v200
  v_mfma_f32_16x16x32_bf16 v[52:55], v[212:215], a[180:183], v[52:55]
  buffer_load_dwordx4 v221, s[4:7], s33 offen lds
  v_mfma_f32_16x16x32_bf16 v[56:59], v[212:215], a[184:187], v[56:59]
  v_exp_f32_e64 v207, v207
  v_mfma_f32_16x16x32_bf16 v[60:63], v[212:215], a[188:191], v[60:63]
  v_cvt_pk_bf16_f32 v208, v200, v201
  v_cvt_pk_bf16_f32 v211, v206, v207
  v_mfma_f32_16x16x32_bf16 v[192:195], a[128:131], a[48:51], v[228:231]
  v_exp_f32_e64 v202, v202
  v_mfma_f32_16x16x32_bf16 v[192:195], a[132:135], a[52:55], v[192:195]
  v_exp_f32_e64 v203, v203
  v_mfma_f32_16x16x32_bf16 v[192:195], a[136:139], a[56:59], v[192:195]
  v_exp_f32_e64 v205, v205
  v_mfma_f32_16x16x32_bf16 v[192:195], a[140:143], a[60:63], v[192:195]
  v_exp_f32_e64 v204, v204
  v_mfma_f32_16x16x32_bf16 v[196:199], a[144:147], a[60:63], v[228:231]
  s_add_u32 m0, s30, 32
  v_cvt_pk_bf16_f32 v209, v202, v203
  v_cvt_pk_bf16_f32 v210, v204, v205
  v_mfma_f32_16x16x32_bf16 v[196:199], a[148:151], a[56:59], v[196:199]
  buffer_load_dwordx4 v221, s[4:7], s33 offen offset:1024 lds
  v_mfma_f32_16x16x32_bf16 v[196:199], a[152:155], a[52:55], v[196:199]
  v_mul_f32 v201, s29, v193
  v_mul_f32_e64 v203, s29, v195
  v_mfma_f32_16x16x32_bf16 v[196:199], a[156:159], a[48:51], v[196:199]
  v_mul_f32 v200, s29, v192
  v_mul_f32 v202, s29, v194
  v_mfma_f32_16x16x32_bf16 v[64:67], v[208:211], a[160:163], v[64:67]
  s_add_u32 m0, s30, s96
  v_exp_f32 v202, v202
  v_mfma_f32_16x16x32_bf16 v[68:71], v[208:211], a[164:167], v[68:71]
  buffer_load_dwordx4 v221, s[8:11], s33 offen lds
  v_mfma_f32_16x16x32_bf16 v[72:75], v[208:211], a[168:171], v[72:75]
  v_mul_f32 v204, s29, v196
  v_mul_f32 v205, s29, v197
  v_mfma_f32_16x16x32_bf16 v[76:79], v[208:211], a[172:175], v[76:79]
  v_exp_f32_e64 v201, v201
  v_mfma_f32_16x16x32_bf16 v[80:83], v[208:211], a[176:179], v[80:83]
  s_add_u32 m0, s30, s97
  v_mul_f32 v206, s29, v198
  v_mul_f32_e64 v207, s29, v199
  v_mfma_f32_16x16x32_bf16 v[84:87], v[208:211], a[180:183], v[84:87]
  buffer_load_dwordx4 v221, s[8:11], s33 offen offset:1024 lds
  v_mfma_f32_16x16x32_bf16 v[88:91], v[208:211], a[184:187], v[88:91]
  s_sub_u32 s30, s30, 16896
  v_exp_f32_e64 v200, v200
  v_mfma_f32_16x16x32_bf16 v[92:95], v[208:211], a[188:191], v[92:95]
  s_cselect_b32 s30, s31, s30
  v_exp_f32 v204, v204
  v_mfma_f32_16x16x32_bf16 v[192:195], a[128:131], a[96:99], v[228:231]
  s_add_u32 s59, s59, 8192
  v_exp_f32_e64 v205, v205
  v_mfma_f32_16x16x32_bf16 v[192:195], a[132:135], a[100:103], v[192:195]
  s_xor_b32 s33, s59, s3
  v_cvt_pk_bf16_f32 v212, v200, v201
  v_cvt_pk_bf16_f32 v214, v204, v205
  v_mfma_f32_16x16x32_bf16 v[192:195], a[136:139], a[104:107], v[192:195]
  v_exp_f32 v207, v207
  v_mfma_f32_16x16x32_bf16 v[192:195], a[140:143], a[108:111], v[192:195]
  v_exp_f32_e64 v206, v206
  v_mfma_f32_16x16x32_bf16 v[196:199], a[144:147], a[108:111], v[228:231]
  v_exp_f32_e64 v203, v203
  v_mfma_f32_16x16x32_bf16 v[196:199], a[148:151], a[104:107], v[196:199]
  v_cvt_pk_bf16_f32 v213, v202, v203
  v_cvt_pk_bf16_f32 v215, v206, v207
  v_mfma_f32_16x16x32_bf16 v[196:199], a[152:155], a[100:103], v[196:199]
  v_mul_f32 v200, s29, v192
  v_mul_f32 v203, s29, v195
  v_mfma_f32_16x16x32_bf16 v[196:199], a[156:159], a[96:99], v[196:199]
  v_mul_f32 v201, s29, v193
  v_mul_f32 v202, s29, v194
  v_smfmac_f32_16x16x64_bf16 a[196:199], a[220:223], v[208:215], v254
  v_add_u32_e64 v216, s30, v218
  v_mfma_f32_16x16x32_bf16 v[96:99], v[212:215], a[160:163], v[96:99]
  v_exp_f32_e64 v203, v203
  v_mfma_f32_16x16x32_bf16 v[100:103], v[212:215], a[164:167], v[100:103]
  v_mul_f32 v205, s29, v197
  v_mul_f32 v207, s29, v199
  v_mfma_f32_16x16x32_bf16 v[104:107], v[212:215], a[168:171], v[104:107]
  v_exp_f32_e64 v200, v200
  v_mfma_f32_16x16x32_bf16 v[108:111], v[212:215], a[172:175], v[108:111]
  v_exp_f32_e64 v201, v201
  v_mfma_f32_16x16x32_bf16 v[112:115], v[212:215], a[176:179], v[112:115]
  v_mul_f32 v204, s29, v196
  v_mul_f32 v206, s29, v198
  v_mfma_f32_16x16x32_bf16 v[116:119], v[212:215], a[180:183], v[116:119]
  v_exp_f32_e64 v207, v207
  v_mfma_f32_16x16x32_bf16 v[120:123], v[212:215], a[184:187], v[120:123]
  v_exp_f32_e64 v204, v204
  v_mfma_f32_16x16x32_bf16 v[124:127], v[212:215], a[188:191], v[124:127]
  v_exp_f32_e64 v205, v205
  v_mfma_f32_16x16x32_bf16 v[192:195], a[128:131], a[64:67], v[228:231]
  v_exp_f32_e64 v202, v202
  v_mfma_f32_16x16x32_bf16 v[192:195], a[132:135], a[68:71], v[192:195]
  v_cvt_pk_bf16_f32 v208, v200, v201
  v_cvt_pk_bf16_f32 v210, v204, v205
  v_mfma_f32_16x16x32_bf16 v[192:195], a[136:139], a[72:75], v[192:195]
  v_exp_f32_e64 v206, v206
  v_mfma_f32_16x16x32_bf16 v[192:195], a[140:143], a[76:79], v[192:195]
  v_cvt_pk_bf16_f32 v209, v202, v203
  v_cvt_pk_bf16_f32 v211, v206, v207
  v_mfma_f32_16x16x32_bf16 v[196:199], a[144:147], a[76:79], v[228:231]
  global_load_dword a120, v[252:253], off
  v_mfma_f32_16x16x32_bf16 v[196:199], a[148:151], a[72:75], v[196:199]
  v_add_u32_e64 v217, s30, v219
  v_mfma_f32_16x16x32_bf16 v[196:199], a[152:155], a[68:71], v[196:199]
  v_mul_f32 v200, s29, v192
  v_mul_f32 v202, s29, v194
  v_mfma_f32_16x16x32_bf16 v[196:199], a[156:159], a[64:67], v[196:199]
  v_mul_f32 v201, s29, v193
  v_mul_f32 v203, s29, v195
  v_mfma_f32_16x16x32_bf16 a[204:207], a[220:223], v[208:211], a[204:207]
  v_exp_f32_e64 v203, v203
  v_mfma_f32_16x16x32_bf16 a[224:227], v[208:211], a[160:163], a[224:227]
  v_exp_f32_e64 v201, v201
  v_mfma_f32_16x16x32_bf16 a[228:231], v[208:211], a[164:167], a[228:231]
  v_mul_f32 v204, s29, v196
  v_mul_f32 v206, s29, v198
  v_mfma_f32_16x16x32_bf16 a[232:235], v[208:211], a[168:171], a[232:235]
  v_mul_f32 v205, s29, v197
  v_mul_f32 v207, s29, v199
  v_mfma_f32_16x16x32_bf16 a[236:239], v[208:211], a[172:175], a[236:239]
  v_exp_f32_e64 v204, v204
  v_mfma_f32_16x16x32_bf16 a[240:243], v[208:211], a[176:179], a[240:243]
  v_exp_f32_e64 v207, v207
  v_mfma_f32_16x16x32_bf16 a[244:247], v[208:211], a[180:183], a[244:247]
  v_exp_f32_e64 v200, v200
  v_mfma_f32_16x16x32_bf16 a[248:251], v[208:211], a[184:187], a[248:251]
  v_exp_f32_e64 v202, v202
  v_mfma_f32_16x16x32_bf16 a[252:255], v[208:211], a[188:191], a[252:255]
  v_cvt_pk_bf16_f32 v208, v200, v201
  v_cvt_pk_bf16_f32 v209, v202, v203
  v_mfma_f32_16x16x32_bf16 v[192:195], a[128:131], a[80:83], v[228:231]
  v_exp_f32_e64 v206, v206
  v_mfma_f32_16x16x32_bf16 v[192:195], a[132:135], a[84:87], v[192:195]
  ds_read_b128 a[128:131], v216 offset:0
  v_cvt_pk_bf16_f32 v211, v206, v207
  v_mfma_f32_16x16x32_bf16 v[192:195], a[136:139], a[88:91], v[192:195]
  v_exp_f32_e64 v205, v205
  v_mfma_f32_16x16x32_bf16 v[192:195], a[140:143], a[92:95], v[192:195]
  ds_read_b128 a[136:139], v216 offset:128
  v_cvt_pk_bf16_f32 v210, v204, v205
  v_mfma_f32_16x16x32_bf16 v[196:199], a[144:147], a[92:95], v[228:231]
  v_mfma_f32_16x16x32_bf16 v[196:199], a[148:151], a[88:91], v[196:199]
  ds_read_b128 a[132:135], v216 offset:64
  ds_read_b128 a[140:143], v216 offset:192
  v_mfma_f32_16x16x32_bf16 v[196:199], a[152:155], a[84:87], v[196:199]
  v_mul_f32 v200, s29, v192
  v_mul_f32 v201, s29, v193
  v_mfma_f32_16x16x32_bf16 v[196:199], a[156:159], a[80:83], v[196:199]
  ds_read_b128 a[144:147], v216 offset:704
  ds_read_b128 a[148:151], v216 offset:640
  v_mfma_f32_16x16x32_bf16 v[128:131], v[208:211], a[160:163], v[128:131]
  v_exp_f32_e64 v200, v200
  v_mfma_f32_16x16x32_bf16 v[132:135], v[208:211], a[164:167], v[132:135]
  ds_read_b128 a[156:159], v216 offset:512
  v_mul_f32_e64 v202, s29, v194
  v_mfma_f32_16x16x32_bf16 v[136:139], v[208:211], a[168:171], v[136:139]
  v_mul_f32 v204, s29, v196
  v_mul_f32 v205, s29, v197
  v_mfma_f32_16x16x32_bf16 v[140:143], v[208:211], a[172:175], v[140:143]
  v_exp_f32_e64 v202, v202
  v_mfma_f32_16x16x32_bf16 v[144:147], v[208:211], a[176:179], v[144:147]
  s_sub_u32 s37, s37, 1
  v_exp_f32 v201, v201
  v_mfma_f32_16x16x32_bf16 v[148:151], v[208:211], a[180:183], v[148:151]
  ds_read_b128 a[152:155], v216 offset:576
  v_mul_f32_e64 v203, s29, v195
  v_mfma_f32_16x16x32_bf16 v[152:155], v[208:211], a[184:187], v[152:155]
  s_waitcnt lgkmcnt(4)
  v_exp_f32 v203, v203
  v_mfma_f32_16x16x32_bf16 v[156:159], v[208:211], a[188:191], v[156:159]
  s_cbranch_scc1 L_exitA
  v_mul_f32 v206, s29, v198
  v_mul_f32_e64 v207, s29, v199
  v_mfma_f32_16x16x32_bf16 v[192:195], a[128:131], a[0:3], v[228:231]
  v_exp_f32_e64 v206, v206
  v_mfma_f32_16x16x32_bf16 v[192:195], a[132:135], a[4:7], v[192:195]
  v_exp_f32_e64 v207, v207
  v_mfma_f32_16x16x32_bf16 v[192:195], a[136:139], a[8:11], v[192:195]
  v_cvt_pk_bf16_f32 v213, v202, v203
  v_cvt_pk_bf16_f32 v215, v206, v207
  v_mfma_f32_16x16x32_bf16 v[192:195], a[140:143], a[12:15], v[192:195]
  s_waitcnt lgkmcnt(1)
  v_exp_f32 v205, v205
  v_mfma_f32_16x16x32_bf16 v[196:199], a[144:147], a[12:15], v[228:231]
  v_exp_f32_e64 v204, v204
  v_mfma_f32_16x16x32_bf16 v[196:199], a[148:151], a[8:11], v[196:199]
  s_waitcnt lgkmcnt(0)
  v_cvt_pk_bf16_f32 v212, v200, v201
  v_cvt_pk_bf16_f32 v214, v204, v205
  v_mfma_f32_16x16x32_bf16 v[196:199], a[152:155], a[4:7], v[196:199]
  v_mul_f32 v201, s29, v193
  v_mul_f32_e64 v203, s29, v195
  v_mfma_f32_16x16x32_bf16 v[196:199], a[156:159], a[0:3], v[196:199]
  v_exp_f32_e64 v203, v203
  v_mfma_f32_16x16x32_bf16 v[160:163], v[212:215], a[160:163], v[160:163]
  v_exp_f32_e64 v201, v201
  v_mfma_f32_16x16x32_bf16 v[164:167], v[212:215], a[164:167], v[164:167]
  ds_read_b64_tr_b16 a[164:165], v217 offset:8464
  ds_read_b64_tr_b16 a[166:167], v217 offset:8976
  v_mfma_f32_16x16x32_bf16 v[168:171], v[212:215], a[168:171], v[168:171]
  v_mul_f32 v202, s29, v194
  v_mul_f32 v206, s29, v198
  v_mfma_f32_16x16x32_bf16 v[172:175], v[212:215], a[172:175], v[172:175]
  ds_read_b64_tr_b16 a[172:173], v217 offset:8496
  v_mul_f32_e64 v207, s29, v199
  v_mfma_f32_16x16x32_bf16 v[176:179], v[212:215], a[176:179], v[176:179]
  v_exp_f32_e64 v202, v202
  v_mfma_f32_16x16x32_bf16 v[180:183], v[212:215], a[180:183], v[180:183]
  ds_read_b64_tr_b16 a[168:169], v217 offset:8480
  v_mul_f32_e64 v205, s29, v197
  v_mfma_f32_16x16x32_bf16 v[184:187], v[212:215], a[184:187], v[184:187]
  v_mul_f32 v200, s29, v192
  v_mul_f32 v204, s29, v196
  v_mfma_f32_16x16x32_bf16 v[188:191], v[212:215], a[188:191], v[188:191]
  v_exp_f32_e64 v200, v200
  v_smfmac_f32_16x16x64_bf16 a[200:203], a[220:223], v[208:215], v254
  ds_read_b64_tr_b16 a[160:161], v217 offset:8448
  ds_read_b64_tr_b16 a[162:163], v217 offset:8960
  ds_read_b64_tr_b16 a[170:171], v217 offset:8992
  ds_read_b64_tr_b16 a[174:175], v217 offset:9008
  s_branch L_pE1
  .p2align 6
L_pG1:
  v_mfma_f32_16x16x32_bf16 v[192:195], a[128:131], a[16:19], v[228:231]
  ds_read_b64_tr_b16 a[180:181], v217 offset:8528
  v_exp_f32_e64 v207, v207
  v_mfma_f32_16x16x32_bf16 v[192:195], a[132:135], a[20:23], v[192:195]
  ds_read_b64_tr_b16 a[184:185], v217 offset:8544
  v_cvt_pk_bf16_f32 v208, v200, v201
  v_exp_f32_e64 v206, v206
  v_mfma_f32_16x16x32_bf16 v[192:195], a[136:139], a[24:27], v[192:195]
  ds_read_b64_tr_b16 a[182:183], v217 offset:9040
  v_cvt_pk_bf16_f32 v211, v206, v207
  v_mfma_f32_16x16x32_bf16 v[192:195], a[140:143], a[28:31], v[192:195]
  ds_read_b64_tr_b16 a[178:179], v217 offset:9024
  v_exp_f32_e64 v204, v204
  v_mfma_f32_16x16x32_bf16 v[196:199], a[144:147], a[28:31], v[228:231]
  s_and_b32 s57, s99, 3
  v_exp_f32 v205, v205
  v_mfma_f32_16x16x32_bf16 v[196:199], a[148:151], a[24:27], v[196:199]
  ds_read_b64_tr_b16 a[176:177], v217 offset:8512
  ds_read_b64_tr_b16 a[190:191], v217 offset:9072
  v_mfma_f32_16x16x32_bf16 v[196:199], a[152:155], a[20:23], v[196:199]
  s_waitcnt lgkmcnt(6)
  v_cvt_pk_bf16_f32 v209, v202, v203
  v_cvt_pk_bf16_f32 v210, v204, v205
  v_mfma_f32_16x16x32_bf16 v[196:199], a[156:159], a[16:19], v[196:199]
  ds_read_b64_tr_b16 a[186:187], v217 offset:9056
  v_mul_f32 v203, s29, v195
  v_mfma_f32_16x16x32_bf16 v[0:3], v[208:211], a[160:163], v[0:3]
  ds_read_b64_tr_b16 a[188:189], v217 offset:8560
  v_mul_f32_e64 v202, s29, v194
  v_mfma_f32_16x16x32_bf16 v[4:7], v[208:211], a[164:167], v[4:7]
  s_cselect_b32 s100, s34, 0x40000000
  v_mul_f32 v200, s29, v192
  v_mul_f32_e64 v201, s29, v193
  v_mfma_f32_16x16x32_bf16 v[8:11], v[208:211], a[168:171], v[8:11]
  s_cmp_ge_u32 s57, 2
  v_mul_f32 v204, s29, v196
  v_mul_f32_e64 v205, s29, v197
  v_mfma_f32_16x16x32_bf16 v[12:15], v[208:211], a[172:175], v[12:15]
  s_waitcnt lgkmcnt(3)
  v_exp_f32 v204, v204
  v_mfma_f32_16x16x32_bf16 v[16:19], v[208:211], a[176:179], v[16:19]
  s_cselect_b32 s101, s34, 0x40000000
  v_exp_f32 v200, v200
  v_mfma_f32_16x16x32_bf16 v[20:23], v[208:211], a[180:183], v[20:23]
  s_waitcnt lgkmcnt(1)
  v_exp_f32 v202, v202
  v_mfma_f32_16x16x32_bf16 v[24:27], v[208:211], a[184:187], v[24:27]
  s_waitcnt lgkmcnt(0)
  v_exp_f32 v201, v201
  v_mfma_f32_16x16x32_bf16 v[28:31], v[208:211], a[188:191], v[28:31]
  s_lshr_b32 s99, s99, 2
  v_exp_f32 v205, v205
  v_mfma_f32_16x16x32_bf16 v[192:195], a[128:131], a[32:35], v[228:231]
  s_lshl_b32 s57, s57, 11
  v_mul_f32 v206, s29, v198
  v_mul_f32_e64 v207, s29, v199
  v_mfma_f32_16x16x32_bf16 v[192:195], a[132:135], a[36:39], v[192:195]
  s_add_u32 s34, s34, s57
  v_exp_f32 v207, v207
  v_mfma_f32_16x16x32_bf16 v[192:195], a[136:139], a[40:43], v[192:195]
  s_waitcnt vmcnt(5)
  v_exp_f32 v206, v206
  v_mfma_f32_16x16x32_bf16 v[192:195], a[140:143], a[44:47], v[192:195]
  s_barrier
  v_cvt_pk_bf16_f32 v214, v204, v205
  v_mfma_f32_16x16x32_bf16 v[196:199], a[144:147], a[44:47], v[228:231]
  v_exp_f32 v203, v203
  v_mfma_f32_16x16x32_bf16 v[196:199], a[148:151], a[40:43], v[196:199]
  v_cvt_pk_bf16_f32 v212, v200, v201
  v_cvt_pk_bf16_f32 v215, v206, v207
  v_mfma_f32_16x16x32_bf16 v[196:199], a[152:155], a[36:39], v[196:199]
  v_cvt_pk_bf16_f32 v213, v202, v203
  v_mul_f32_e64 v203, s29, v195
  v_mfma_f32_16x16x32_bf16 v[196:199], a[156:159], a[32:35], v[196:199]
  s_mov_b32 m0, s30
  v_mul_f32 v201, s29, v193
  v_mul_f32_e64 v202, s29, v194
  v_smfmac_f32_16x16x64_bf16 a[192:195], a[220:223], v[208:215], v254
  buffer_load_dwordx4 v221, s[4:7], s33 offen lds
  v_mfma_f32_16x16x32_bf16 v[32:35], v[212:215], a[160:163], v[32:35]
  v_exp_f32_e64 v201, v201
  v_mfma_f32_16x16x32_bf16 v[36:39], v[212:215], a[164:167], v[36:39]
  s_add_u32 m0, s30, 32
  v_exp_f32 v202, v202
  v_mfma_f32_16x16x32_bf16 v[40:43], v[212:215], a[168:171], v[40:43]
  buffer_load_dwordx4 v221, s[4:7], s33 offen offset:1024 lds
  v_mfma_f32_16x16x32_bf16 v[44:47], v[212:215], a[172:175], v[44:47]
  v_mul_f32 v206, s29, v198
  v_mul_f32 v207, s29, v199
  v_mfma_f32_16x16x32_bf16 v[48:51], v[212:215], a[176:179], v[48:51]
  v_exp_f32_e64 v203, v203
  v_mfma_f32_16x16x32_bf16 v[52:55], v[212:215], a[180:183], v[52:55]
  v_mul_f32 v200, s29, v192
  v_mul_f32 v204, s29, v196
  v_mfma_f32_16x16x32_bf16 v[56:59], v[212:215], a[184:187], v[56:59]
  v_exp_f32_e64 v206, v206
  v_mfma_f32_16x16x32_bf16 v[60:63], v[212:215], a[188:191], v[60:63]
  v_exp_f32_e64 v207, v207
  v_mfma_f32_16x16x32_bf16 v[192:195], a[128:131], a[48:51], v[228:231]
  v_exp_f32_e64 v200, v200
  v_mfma_f32_16x16x32_bf16 v[192:195], a[132:135], a[52:55], v[192:195]
  v_mul_f32_e64 v205, s29, v197
  v_cvt_pk_bf16_f32 v209, v202, v203
  v_mfma_f32_16x16x32_bf16 v[192:195], a[136:139], a[56:59], v[192:195]
  v_exp_f32_e64 v205, v205
  v_mfma_f32_16x16x32_bf16 v[192:195], a[140:143], a[60:63], v[192:195]
  v_cvt_pk_bf16_f32 v208, v200, v201
  v_cvt_pk_bf16_f32 v211, v206, v207
  v_mfma_f32_16x16x32_bf16 v[196:199], a[144:147], a[60:63], v[228:231]
  s_add_u32 m0, s30, s96
  v_exp_f32 v204, v204
  v_mfma_f32_16x16x32_bf16 v[196:199], a[148:151], a[56:59], v[196:199]
  buffer_load_dwordx4 v221, s[8:11], s33 offen lds
  v_mfma_f32_16x16x32_bf16 v[196:199], a[152:155], a[52:55], v[196:199]
  v_cvt_pk_bf16_f32 v210, v204, v205
  v_mul_f32_e64 v203, s29, v195
  v_mfma_f32_16x16x32_bf16 v[196:199], a[156:159], a[48:51], v[196:199]
  v_mul_f32 v201, s29, v193
  v_mul_f32 v202, s29, v194
  v_mfma_f32_16x16x32_bf16 v[64:67], v[208:211], a[160:163], v[64:67]
  s_add_u32 m0, s30, s97
  v_exp_f32 v201, v201
  v_mfma_f32_16x16x32_bf16 v[68:71], v[208:211], a[164:167], v[68:71]
  buffer_load_dwordx4 v221, s[8:11], s33 offen offset:1024 lds
  v_mfma_f32_16x16x32_bf16 v[72:75], v[208:211], a[168:171], v[72:75]
  s_sub_u32 s30, s30, 16896
  v_mul_f32 v200, s29, v192
  v_mul_f32 v206, s29, v198
  v_mfma_f32_16x16x32_bf16 v[76:79], v[208:211], a[172:175], v[76:79]
  s_cselect_b32 s30, s31, s30
  v_exp_f32 v203, v203
  v_mfma_f32_16x16x32_bf16 v[80:83], v[208:211], a[176:179], v[80:83]
  s_add_u32 s59, s59, 8192
  v_mul_f32 v205, s29, v197
  v_mul_f32 v207, s29, v199
  v_mfma_f32_16x16x32_bf16 v[84:87], v[208:211], a[180:183], v[84:87]
  s_xor_b32 s33, s59, s3
  v_exp_f32 v200, v200
  v_mfma_f32_16x16x32_bf16 v[88:91], v[208:211], a[184:187], v[88:91]
  v_exp_f32_e64 v202, v202
  v_mfma_f32_16x16x32_bf16 v[92:95], v[208:211], a[188:191], v[92:95]
  s_mov_b32 m0, s36
  v_exp_f32 v206, v206
  v_mfma_f32_16x16x32_bf16 v[192:195], a[128:131], a[64:67], v[228:231]
  buffer_load_dwordx4 v222, s[12:15], s100 offen nt lds
  v_mfma_f32_16x16x32_bf16 v[192:195], a[132:135], a[68:71], v[192:195]
  s_add_u32 s36, s36, s57
  v_mul_f32 v204, s29, v196
  v_exp_f32_e64 v207, v207
  v_mfma_f32_16x16x32_bf16 v[192:195], a[136:139], a[72:75], v[192:195]
  v_exp_f32_e64 v205, v205
  v_mfma_f32_16x16x32_bf16 v[192:195], a[140:143], a[76:79], v[192:195]
  v_cvt_pk_bf16_f32 v212, v200, v201
  v_cvt_pk_bf16_f32 v215, v206, v207
  v_mfma_f32_16x16x32_bf16 v[196:199], a[144:147], a[76:79], v[228:231]
  v_exp_f32_e64 v204, v204
  v_mfma_f32_16x16x32_bf16 v[196:199], a[148:151], a[72:75], v[196:199]
  buffer_load_dwordx4 v223, s[12:15], s100 offen offset:1024 nt lds
  v_mfma_f32_16x16x32_bf16 v[196:199], a[152:155], a[68:71], v[196:199]
  v_cvt_pk_bf16_f32 v213, v202, v203
  v_cvt_pk_bf16_f32 v214, v204, v205
  v_mfma_f32_16x16x32_bf16 v[196:199], a[156:159], a[64:67], v[196:199]
  v_mul_f32 v203, s29, v195
  v_add_u32 v217, s30, v219
  v_smfmac_f32_16x16x64_bf16 a[196:199], a[220:223], v[208:215], v254
  buffer_load_dwordx4 v222, s[12:15], s101 offen offset:2048 nt lds
  v_mfma_f32_16x16x32_bf16 v[96:99], v[212:215], a[160:163], v[96:99]
  v_exp_f32_e64 v203, v203
  v_mfma_f32_16x16x32_bf16 v[100:103], v[212:215], a[164:167], v[100:103]
  v_mul_f32 v202, s29, v194
  v_add_u32 v216, s30, v218
  v_mfma_f32_16x16x32_bf16 v[104:107], v[212:215], a[168:171], v[104:107]
  v_exp_f32_e64 v202, v202
  v_mfma_f32_16x16x32_bf16 v[108:111], v[212:215], a[172:175], v[108:111]
  buffer_load_dwordx4 v223, s[12:15], s101 offen offset:3072 nt lds
  v_mul_f32 v200, s29, v192
  v_mul_f32 v201, s29, v193
  v_pk_mul_f32 v[204:205], v[196:197], s[28:29] op_sel:[0,1] op_sel_hi:[1,1]
  v_pk_mul_f32 v[206:207], v[198:199], s[28:29] op_sel:[0,1] op_sel_hi:[1,1]
  v_mfma_f32_16x16x32_bf16 v[112:115], v[212:215], a[176:179], v[112:115]
  v_exp_f32_e64 v206, v206
  v_mfma_f32_16x16x32_bf16 v[116:119], v[212:215], a[180:183], v[116:119]
  v_exp_f32_e64 v204, v204
  v_mfma_f32_16x16x32_bf16 v[120:123], v[212:215], a[184:187], v[120:123]
  v_exp_f32_e64 v207, v207
  v_mfma_f32_16x16x32_bf16 v[124:127], v[212:215], a[188:191], v[124:127]
  v_exp_f32_e64 v201, v201
  v_mfma_f32_16x16x32_bf16 v[192:195], a[128:131], a[80:83], v[228:231]
  v_cvt_pk_bf16_f32 v209, v202, v203
  v_cvt_pk_bf16_f32 v211, v206, v207
  v_mfma_f32_16x16x32_bf16 v[192:195], a[132:135], a[84:87], v[192:195]
  ds_read_b128 a[128:131], v216 offset:0
  ds_read_b128 a[132:135], v216 offset:64
  v_mfma_f32_16x16x32_bf16 v[192:195], a[136:139], a[88:91], v[192:195]
  v_exp_f32_e64 v205, v205
  v_mfma_f32_16x16x32_bf16 v[192:195], a[140:143], a[92:95], v[192:195]
  v_exp_f32_e64 v200, v200
  v_mfma_f32_16x16x32_bf16 v[196:199], a[144:147], a[92:95], v[228:231]
  ds_read_b128 a[140:143], v216 offset:192
  v_cvt_pk_bf16_f32 v208, v200, v201
  v_mfma_f32_16x16x32_bf16 v[196:199], a[148:151], a[88:91], v[196:199]
  ds_read_b128 a[136:139], v216 offset:128
  ds_read_b128 a[144:147], v216 offset:704
  v_mfma_f32_16x16x32_bf16 v[196:199], a[152:155], a[84:87], v[196:199]
  v_cvt_pk_bf16_f32 v210, v204, v205
  v_mul_f32_e64 v203, s29, v195
  v_mfma_f32_16x16x32_bf16 v[196:199], a[156:159], a[80:83], v[196:199]
  ds_read_b128 a[152:155], v216 offset:576
  v_mul_f32_e64 v202, s29, v194
  v_mfma_f32_16x16x32_bf16 v[128:131], v[208:211], a[160:163], v[128:131]
  v_exp_f32_e64 v202, v202
  v_mfma_f32_16x16x32_bf16 v[132:135], v[208:211], a[164:167], v[132:135]
  ds_read_b128 a[156:159], v216 offset:512
  v_mul_f32_e64 v200, s29, v192
  v_mfma_f32_16x16x32_bf16 v[136:139], v[208:211], a[168:171], v[136:139]
  v_mul_f32 v204, s29, v196
  v_mul_f32 v205, s29, v197
  v_mfma_f32_16x16x32_bf16 v[140:143], v[208:211], a[172:175], v[140:143]
  ds_read_b128 a[148:151], v216 offset:640
  v_mul_f32_e64 v201, s29, v193
  v_mfma_f32_16x16x32_bf16 v[144:147], v[208:211], a[176:179], v[144:147]
  v_exp_f32_e64 v203, v203
  v_mfma_f32_16x16x32_bf16 v[148:151], v[208:211], a[180:183], v[148:151]
  s_sub_u32 s37, s37, 1
  v_exp_f32 v201, v201
  v_mfma_f32_16x16x32_bf16 v[152:155], v[208:211], a[184:187], v[152:155]
  s_waitcnt lgkmcnt(2)
  v_exp_f32 v200, v200
  v_mfma_f32_16x16x32_bf16 v[156:159], v[208:211], a[188:191], v[156:159]
  s_cbranch_scc1 L_exitB
  v_mul_f32 v206, s29, v198
  v_mul_f32_e64 v207, s29, v199
  v_mfma_f32_16x16x32_bf16 v[192:195], a[128:131], a[0:3], v[228:231]
  v_exp_f32_e64 v206, v206
  v_mfma_f32_16x16x32_bf16 v[192:195], a[132:135], a[4:7], v[192:195]
  v_exp_f32_e64 v204, v204
  v_mfma_f32_16x16x32_bf16 v[192:195], a[136:139], a[8:11], v[192:195]
  v_exp_f32_e64 v205, v205
  v_mfma_f32_16x16x32_bf16 v[192:195], a[140:143], a[12:15], v[192:195]
  v_exp_f32_e64 v207, v207
  v_mfma_f32_16x16x32_bf16 v[196:199], a[144:147], a[12:15], v[228:231]
  s_waitcnt lgkmcnt(0)
  v_cvt_pk_bf16_f32 v212, v200, v201
  v_cvt_pk_bf16_f32 v215, v206, v207
  v_mfma_f32_16x16x32_bf16 v[196:199], a[148:151], a[8:11], v[196:199]
  v_cvt_pk_bf16_f32 v213, v202, v203
  v_cvt_pk_bf16_f32 v214, v204, v205
  v_mfma_f32_16x16x32_bf16 v[196:199], a[152:155], a[4:7], v[196:199]
  v_mul_f32 v200, s29, v192
  v_mul_f32_e64 v202, s29, v194
  v_mfma_f32_16x16x32_bf16 v[196:199], a[156:159], a[0:3], v[196:199]
  v_exp_f32_e64 v200, v200
  v_mfma_f32_16x16x32_bf16 v[160:163], v[212:215], a[160:163], v[160:163]
  ds_read_b64_tr_b16 a[162:163], v217 offset:8960
  v_mul_f32_e64 v201, s29, v193
  v_mfma_f32_16x16x32_bf16 v[164:167], v[212:215], a[164:167], v[164:167]
  ds_read_b64_tr_b16 a[166:167], v217 offset:8976
  v_mul_f32_e64 v203, s29, v195
  v_mfma_f32_16x16x32_bf16 v[168:171], v[212:215], a[168:171], v[168:171]
  v_exp_f32_e64 v203, v203
  v_mfma_f32_16x16x32_bf16 v[172:175], v[212:215], a[172:175], v[172:175]
  v_exp_f32_e64 v201, v201
  v_mfma_f32_16x16x32_bf16 v[176:179], v[212:215], a[176:179], v[176:179]
  ds_read_b64_tr_b16 a[164:165], v217 offset:8464
  v_mul_f32 v206, s29, v198
  v_mul_f32 v207, s29, v199
  v_mfma_f32_16x16x32_bf16 v[180:183], v[212:215], a[180:183], v[180:183]
  ds_read_b64_tr_b16 a[168:169], v217 offset:8480
  v_exp_f32_e64 v202, v202
  v_mfma_f32_16x16x32_bf16 v[184:187], v[212:215], a[184:187], v[184:187]
  ds_read_b64_tr_b16 a[160:161], v217 offset:8448
  ds_read_b64_tr_b16 a[170:171], v217 offset:8992
  v_mfma_f32_16x16x32_bf16 v[188:191], v[212:215], a[188:191], v[188:191]
  ds_read_b64_tr_b16 a[174:175], v217 offset:9008
  v_mul_f32_e64 v205, s29, v197
  v_smfmac_f32_16x16x64_bf16 a[200:203], a[220:223], v[208:215], v254
  ds_read_b64_tr_b16 a[172:173], v217 offset:8496
  v_mul_f32_e64 v204, s29, v196
L_pG2:
  v_mfma_f32_16x16x32_bf16 v[192:195], a[128:131], a[16:19], v[228:231]
  s_and_b32 s57, s99, 3
  v_exp_f32 v205, v205
  v_mfma_f32_16x16x32_bf16 v[192:195], a[132:135], a[20:23], v[192:195]
  ds_read_b64_tr_b16 a[176:177], v217 offset:8512
  ds_read_b64_tr_b16 a[178:179], v217 offset:9024
  v_mfma_f32_16x16x32_bf16 v[192:195], a[136:139], a[24:27], v[192:195]
  s_cselect_b32 s100, s34, 0x40000000
  v_exp_f32 v206, v206
  v_mfma_f32_16x16x32_bf16 v[192:195], a[140:143], a[28:31], v[192:195]
  s_cmp_ge_u32 s57, 2
  v_exp_f32 v207, v207
  v_mfma_f32_16x16x32_bf16 v[196:199], a[144:147], a[28:31], v[228:231]
  s_cselect_b32 s101, s34, 0x40000000
  v_exp_f32 v204, v204
  v_mfma_f32_16x16x32_bf16 v[196:199], a[148:151], a[24:27], v[196:199]
  s_waitcnt lgkmcnt(2)
  v_cvt_pk_bf16_f32 v208, v200, v201
  v_cvt_pk_bf16_f32 v211, v206, v207
  v_mfma_f32_16x16x32_bf16 v[196:199], a[152:155], a[20:23], v[196:199]
  ds_read_b64_tr_b16 a[180:181], v217 offset:8528
  ds_read_b64_tr_b16 a[182:183], v217 offset:9040
  v_cvt_pk_bf16_f32 v209, v202, v203
  v_cvt_pk_bf16_f32 v210, v204, v205
  v_mfma_f32_16x16x32_bf16 v[196:199], a[156:159], a[16:19], v[196:199]
  ds_read_b64_tr_b16 a[184:185], v217 offset:8544
  ds_read_b64_tr_b16 a[186:187], v217 offset:9056
  v_mfma_f32_16x16x32_bf16 v[0:3], v[208:211], a[160:163], v[0:3]
  ds_read_b64_tr_b16 a[188:189], v217 offset:8560
  ds_read_b64_tr_b16 a[190:191], v217 offset:9072
  v_mfma_f32_16x16x32_bf16 v[4:7], v[208:211], a[164:167], v[4:7]
  s_lshr_b32 s99, s99, 2
  v_mul_f32 v202, s29, v194
  v_mul_f32 v203, s29, v195
  v_mfma_f32_16x16x32_bf16 v[8:11], v[208:211], a[168:171], v[8:11]
  s_lshl_b32 s57, s57, 11
  v_mul_f32 v200, s29, v192
  v_mul_f32_e64 v201, s29, v193
  v_mfma_f32_16x16x32_bf16 v[12:15], v[208:211], a[172:175], v[12:15]
  s_waitcnt lgkmcnt(6)
  v_mul_f32 v204, s29, v196
  v_mul_f32_e64 v206, s29, v198
  v_mfma_f32_16x16x32_bf16 v[16:19], v[208:211], a[176:179], v[16:19]
  s_waitcnt lgkmcnt(4)
  v_mul_f32 v205, s29, v197
  v_mul_f32_e64 v207, s29, v199
  v_mfma_f32_16x16x32_bf16 v[20:23], v[208:211], a[180:183], v[20:23]
  s_waitcnt lgkmcnt(2)
  v_exp_f32 v206, v206
  v_mfma_f32_16x16x32_bf16 v[24:27], v[208:211], a[184:187], v[24:27]
  s_waitcnt lgkmcnt(0)
  v_exp_f32 v204, v204
  v_mfma_f32_16x16x32_bf16 v[28:31], v[208:211], a[188:191], v[28:31]
  s_add_u32 s34, s34, s57
  v_exp_f32 v203, v203
  v_mfma_f32_16x16x32_bf16 v[192:195], a[128:131], a[32:35], v[228:231]
  v_exp_f32_e64 v205, v205
  v_mfma_f32_16x16x32_bf16 v[192:195], a[132:135], a[36:39], v[192:195]
  v_exp_f32_e64 v202, v202
  v_mfma_f32_16x16x32_bf16 v[192:195], a[136:139], a[40:43], v[192:195]
  v_exp_f32_e64 v200, v200
  v_mfma_f32_16x16x32_bf16 v[192:195], a[140:143], a[44:47], v[192:195]
  v_exp_f32_e64 v207, v207
  v_mfma_f32_16x16x32_bf16 v[196:199], a[144:147], a[44:47], v[228:231]
  v_exp_f32_e64 v201, v201
  v_mfma_f32_16x16x32_bf16 v[196:199], a[148:151], a[40:43], v[196:199]
  v_cvt_pk_bf16_f32 v213, v202, v203
  v_cvt_pk_bf16_f32 v215, v206, v207
  v_mfma_f32_16x16x32_bf16 v[196:199], a[152:155], a[36:39], v[196:199]
  s_mov_b32 m0, s30
  v_cvt_pk_bf16_f32 v212, v200, v201
  v_cvt_pk_bf16_f32 v214, v204, v205
  v_mfma_f32_16x16x32_bf16 v[196:199], a[156:159], a[32:35], v[196:199]
  s_waitcnt vmcnt(8)
  v_mul_f32 v200, s29, v192
  v_mul_f32 v203, s29, v195
  v_smfmac_f32_16x16x64_bf16 a[192:195], a[220:223], v[208:215], v254
  s_barrier
  v_mul_f32 v202, s29, v194
  v_mfma_f32_16x16x32_bf16 v[32:35], v[212:215], a[160:163], v[32:35]
  buffer_load_dwordx4 v221, s[4:7], s33 offen lds
  v_mfma_f32_16x16x32_bf16 v[36:39], v[212:215], a[164:167], v[36:39]
  v_mul_f32 v201, s29, v193
  v_mul_f32 v205, s29, v197
  v_mfma_f32_16x16x32_bf16 v[40:43], v[212:215], a[168:171], v[40:43]
  v_mul_f32 v206, s29, v198
  v_mul_f32 v207, s29, v199
  v_mfma_f32_16x16x32_bf16 v[44:47], v[212:215], a[172:175], v[44:47]
  v_exp_f32_e64 v207, v207
  v_mfma_f32_16x16x32_bf16 v[48:51], v[212:215], a[176:179], v[48:51]
  v_exp_f32_e64 v203, v203
  v_mfma_f32_16x16x32_bf16 v[52:55], v[212:215], a[180:183], v[52:55]
  v_exp_f32_e64 v205, v205
  v_mfma_f32_16x16x32_bf16 v[56:59], v[212:215], a[184:187], v[56:59]
  v_exp_f32_e64 v201, v201
  v_mfma_f32_16x16x32_bf16 v[60:63], v[212:215], a[188:191], v[60:63]
  v_exp_f32_e64 v202, v202
  v_mfma_f32_16x16x32_bf16 v[192:195], a[128:131], a[48:51], v[228:231]
  v_mul_f32_e64 v204, s29, v196
  v_cvt_pk_bf16_f32 v209, v202, v203
  v_mfma_f32_16x16x32_bf16 v[192:195], a[132:135], a[52:55], v[192:195]
  v_exp_f32_e64 v204, v204
  v_mfma_f32_16x16x32_bf16 v[192:195], a[136:139], a[56:59], v[192:195]
  v_exp_f32_e64 v206, v206
  v_mfma_f32_16x16x32_bf16 v[192:195], a[140:143], a[60:63], v[192:195]
  v_exp_f32_e64 v200, v200
  v_mfma_f32_16x16x32_bf16 v[196:199], a[144:147], a[60:63], v[228:231]
  s_add_u32 m0, s30, 32
  v_cvt_pk_bf16_f32 v210, v204, v205
  v_cvt_pk_bf16_f32 v211, v206, v207
  v_mfma_f32_16x16x32_bf16 v[196:199], a[148:151], a[56:59], v[196:199]
  buffer_load_dwordx4 v221, s[4:7], s33 offen offset:1024 lds
  v_mfma_f32_16x16x32_bf16 v[196:199], a[152:155], a[52:55], v[196:199]
  v_cvt_pk_bf16_f32 v208, v200, v201
  v_mul_f32 v200, s29, v192
  v_mfma_f32_16x16x32_bf16 v[196:199], a[156:159], a[48:51], v[196:199]
  s_add_u32 m0, s30, s96
  v_mul_f32 v201, s29, v193
  v_mul_f32_e64 v202, s29, v194
  v_mfma_f32_16x16x32_bf16 v[64:67], v[208:211], a[160:163], v[64:67]
  buffer_load_dwordx4 v221, s[8:11], s33 offen lds
  v_mfma_f32_16x16x32_bf16 v[68:71], v[208:211], a[164:167], v[68:71]
  v_exp_f32_e64 v201, v201
  v_mfma_f32_16x16x32_bf16 v[72:75], v[208:211], a[168:171], v[72:75]
  v_mul_f32 v203, s29, v195
  v_mul_f32 v205, s29, v197
  v_mfma_f32_16x16x32_bf16 v[76:79], v[208:211], a[172:175], v[76:79]
  v_mul_f32 v206, s29, v198
  v_mul_f32 v207, s29, v199
  v_mfma_f32_16x16x32_bf16 v[80:83], v[208:211], a[176:179], v[80:83]
  s_add_u32 m0, s30, s97
  v_exp_f32 v203, v203
  v_mfma_f32_16x16x32_bf16 v[84:87], v[208:211], a[180:183], v[84:87]
  buffer_load_dwordx4 v221, s[8:11], s33 offen offset:1024 lds
  v_mfma_f32_16x16x32_bf16 v[88:91], v[208:211], a[184:187], v[88:91]
  s_sub_u32 s30, s30, 16896
  v_exp_f32_e64 v206, v206
  v_mfma_f32_16x16x32_bf16 v[92:95], v[208:211], a[188:191], v[92:95]
  s_cselect_b32 s30, s31, s30
  v_exp_f32 v202, v202
  v_mfma_f32_16x16x32_bf16 v[192:195], a[128:131], a[64:67], v[228:231]
  s_add_u32 s59, s59, 8192
  v_mul_f32_e64 v204, s29, v196
  v_cvt_pk_bf16_f32 v213, v202, v203
  v_mfma_f32_16x16x32_bf16 v[192:195], a[132:135], a[68:71], v[192:195]
  s_xor_b32 s33, s59, s3
  v_exp_f32 v204, v204
  v_mfma_f32_16x16x32_bf16 v[192:195], a[136:139], a[72:75], v[192:195]
  v_exp_f32_e64 v207, v207
  v_mfma_f32_16x16x32_bf16 v[192:195], a[140:143], a[76:79], v[192:195]
  v_exp_f32_e64 v200, v200
  v_mfma_f32_16x16x32_bf16 v[196:199], a[144:147], a[76:79], v[228:231]
  v_exp_f32_e64 v205, v205
  v_mfma_f32_16x16x32_bf16 v[196:199], a[148:151], a[72:75], v[196:199]
  v_cvt_pk_bf16_f32 v214, v204, v205
  v_cvt_pk_bf16_f32 v215, v206, v207
  v_mfma_f32_16x16x32_bf16 v[196:199], a[152:155], a[68:71], v[196:199]
  s_mov_b32 m0, s36
  v_cvt_pk_bf16_f32 v212, v200, v201
  v_mul_f32 v203, s29, v195
  v_mfma_f32_16x16x32_bf16 v[196:199], a[156:159], a[64:67], v[196:199]
  buffer_load_dwordx4 v222, s[12:15], s100 offen nt lds
  v_smfmac_f32_16x16x64_bf16 a[196:199], a[220:223], v[208:215], v254
  s_add_u32 s36, s36, s57
  v_mul_f32 v200, s29, v192
  v_mfma_f32_16x16x32_bf16 v[96:99], v[212:215], a[160:163], v[96:99]
  buffer_load_dwordx4 v223, s[12:15], s100 offen offset:1024 nt lds
  v_mfma_f32_16x16x32_bf16 v[100:103], v[212:215], a[164:167], v[100:103]
  v_mul_f32 v201, s29, v193
  v_mul_f32 v202, s29, v194
  v_mfma_f32_16x16x32_bf16 v[104:107], v[212:215], a[168:171], v[104:107]
  buffer_load_dwordx4 v222, s[12:15], s101 offen offset:2048 nt lds
  v_mfma_f32_16x16x32_bf16 v[108:111], v[212:215], a[172:175], v[108:111]
  v_exp_f32 v201, v201
  v_exp_f32 v202, v202
  v_add_u32_e64 v216, s30, v218
  v_pk_mul_f32 v[206:207], v[198:199], s[28:29] op_sel:[0,1] op_sel_hi:[1,1]
  v_mfma_f32_16x16x32_bf16 v[112:115], v[212:215], a[176:179], v[112:115]
  buffer_load_dwordx4 v223, s[12:15], s101 offen offset:3072 nt lds
  v_mfma_f32_16x16x32_bf16 v[116:119], v[212:215], a[180:183], v[116:119]
  v_exp_f32 v206, v206
  v_exp_f32 v207, v207
  v_add_u32_e64 v217, s30, v219
  v_pk_mul_f32 v[204:205], v[196:197], s[28:29] op_sel:[0,1] op_sel_hi:[1,1]
  v_mfma_f32_16x16x32_bf16 v[120:123], v[212:215], a[184:187], v[120:123]
  v_exp_f32_e64 v204, v204
  v_mfma_f32_16x16x32_bf16 v[124:127], v[212:215], a[188:191], v[124:127]
  v_exp_f32_e64 v203, v203
  v_mfma_f32_16x16x32_bf16 v[192:195], a[128:131], a[80:83], v[228:231]
  v_exp_f32_e64 v205, v205
  v_mfma_f32_16x16x32_bf16 v[192:195], a[132:135], a[84:87], v[192:195]
  v_exp_f32_e64 v200, v200
  v_mfma_f32_16x16x32_bf16 v[192:195], a[136:139], a[88:91], v[192:195]
  v_cvt_pk_bf16_f32 v209, v202, v203
  v_cvt_pk_bf16_f32 v210, v204, v205
  v_mfma_f32_16x16x32_bf16 v[192:195], a[140:143], a[92:95], v[192:195]
  v_cvt_pk_bf16_f32 v208, v200, v201
  v_cvt_pk_bf16_f32 v211, v206, v207
  v_mfma_f32_16x16x32_bf16 v[196:199], a[144:147], a[92:95], v[228:231]
  ds_read_b128 a[128:131], v216 offset:0
  ds_read_b128 a[132:135], v216 offset:64
  v_mfma_f32_16x16x32_bf16 v[196:199], a[148:151], a[88:91], v[196:199]
  ds_read_b128 a[136:139], v216 offset:128
  ds_read_b128 a[140:143], v216 offset:192
  v_mfma_f32_16x16x32_bf16 v[196:199], a[152:155], a[84:87], v[196:199]
  v_mul_f32 v201, s29, v193
  v_mul_f32 v202, s29, v194
  v_mfma_f32_16x16x32_bf16 v[196:199], a[156:159], a[80:83], v[196:199]
  ds_read_b128 a[144:147], v216 offset:704
  v_mul_f32_e64 v203, s29, v195
  v_mfma_f32_16x16x32_bf16 v[128:131], v[208:211], a[160:163], v[128:131]
  ds_read_b128 a[156:159], v216 offset:512
  v_mul_f32_e64 v200, s29, v192
  v_mfma_f32_16x16x32_bf16 v[132:135], v[208:211], a[164:167], v[132:135]
  v_exp_f32_e64 v202, v202
  v_mfma_f32_16x16x32_bf16 v[136:139], v[208:211], a[168:171], v[136:139]
  ds_read_b128 a[152:155], v216 offset:576
  v_mul_f32_e64 v204, s29, v196
  v_mfma_f32_16x16x32_bf16 v[140:143], v[208:211], a[172:175], v[140:143]
  v_exp_f32_e64 v201, v201
  v_mfma_f32_16x16x32_bf16 v[144:147], v[208:211], a[176:179], v[144:147]
  s_sub_u32 s37, s37, 1
  v_exp_f32 v203, v203
  v_mfma_f32_16x16x32_bf16 v[148:151], v[208:211], a[180:183], v[148:151]
  ds_read_b128 a[148:151], v216 offset:640
  v_mul_f32_e64 v205, s29, v197
  v_mfma_f32_16x16x32_bf16 v[152:155], v[208:211], a[184:187], v[152:155]
  s_waitcnt lgkmcnt(3)
  v_exp_f32 v200, v200
  v_mfma_f32_16x16x32_bf16 v[156:159], v[208:211], a[188:191], v[156:159]
  s_cbranch_scc1 L_exitB
  v_mul_f32 v206, s29, v198
  v_mul_f32_e64 v207, s29, v199
  v_mfma_f32_16x16x32_bf16 v[192:195], a[128:131], a[0:3], v[228:231]
  v_exp_f32_e64 v205, v205
  v_mfma_f32_16x16x32_bf16 v[192:195], a[132:135], a[4:7], v[192:195]
  v_exp_f32_e64 v206, v206
  v_mfma_f32_16x16x32_bf16 v[192:195], a[136:139], a[8:11], v[192:195]
  v_exp_f32_e64 v207, v207
  v_mfma_f32_16x16x32_bf16 v[192:195], a[140:143], a[12:15], v[192:195]
  v_exp_f32_e64 v204, v204
  v_mfma_f32_16x16x32_bf16 v[196:199], a[144:147], a[12:15], v[228:231]
  s_waitcnt lgkmcnt(0)
  v_cvt_pk_bf16_f32 v214, v204, v205
  v_cvt_pk_bf16_f32 v215, v206, v207
  v_mfma_f32_16x16x32_bf16 v[196:199], a[148:151], a[8:11], v[196:199]
  v_cvt_pk_bf16_f32 v212, v200, v201
  v_cvt_pk_bf16_f32 v213, v202, v203
  v_mfma_f32_16x16x32_bf16 v[196:199], a[152:155], a[4:7], v[196:199]
  v_mul_f32 v200, s29, v192
  v_mul_f32_e64 v203, s29, v195
  v_mfma_f32_16x16x32_bf16 v[196:199], a[156:159], a[0:3], v[196:199]
  v_mul_f32 v201, s29, v193
  v_mul_f32 v202, s29, v194
  v_mfma_f32_16x16x32_bf16 v[160:163], v[212:215], a[160:163], v[160:163]
  v_exp_f32_e64 v200, v200
  v_mfma_f32_16x16x32_bf16 v[164:167], v[212:215], a[164:167], v[164:167]
  ds_read_b64_tr_b16 a[162:163], v217 offset:8960
  ds_read_b64_tr_b16 a[166:167], v217 offset:8976
  v_mfma_f32_16x16x32_bf16 v[168:171], v[212:215], a[168:171], v[168:171]
  v_exp_f32_e64 v203, v203
  v_mfma_f32_16x16x32_bf16 v[172:175], v[212:215], a[172:175], v[172:175]
  ds_read_b64_tr_b16 a[174:175], v217 offset:9008
  v_mul_f32_e64 v205, s29, v197
  v_mfma_f32_16x16x32_bf16 v[176:179], v[212:215], a[176:179], v[176:179]
  v_mul_f32 v204, s29, v196
  v_mul_f32 v206, s29, v198
  v_mfma_f32_16x16x32_bf16 v[180:183], v[212:215], a[180:183], v[180:183]
  v_exp_f32_e64 v201, v201
  v_mfma_f32_16x16x32_bf16 v[184:187], v[212:215], a[184:187], v[184:187]
  v_exp_f32_e64 v202, v202
  v_mfma_f32_16x16x32_bf16 v[188:191], v[212:215], a[188:191], v[188:191]
  ds_read_b64_tr_b16 a[164:165], v217 offset:8464
  v_mul_f32_e64 v207, s29, v199
  v_smfmac_f32_16x16x64_bf16 a[200:203], a[220:223], v[208:215], v254
  ds_read_b64_tr_b16 a[160:161], v217 offset:8448
  ds_read_b64_tr_b16 a[168:169], v217 offset:8480
  ds_read_b64_tr_b16 a[170:171], v217 offset:8992
  ds_read_b64_tr_b16 a[172:173], v217 offset:8496
L_pG3:
  v_mfma_f32_16x16x32_bf16 v[192:195], a[128:131], a[16:19], v[228:231]
  ds_read_b64_tr_b16 a[178:179], v217 offset:9024
  ds_read_b64_tr_b16 a[182:183], v217 offset:9040
  v_mfma_f32_16x16x32_bf16 v[192:195], a[132:135], a[20:23], v[192:195]
  s_and_b32 s57, s99, 3
  v_exp_f32 v205, v205
  v_mfma_f32_16x16x32_bf16 v[192:195], a[136:139], a[24:27], v[192:195]
  s_cselect_b32 s100, s34, 0x40000000
  v_exp_f32 v206, v206
  v_mfma_f32_16x16x32_bf16 v[192:195], a[140:143], a[28:31], v[192:195]
  ds_read_b64_tr_b16 a[176:177], v217 offset:8512
  v_cvt_pk_bf16_f32 v209, v202, v203
  v_mfma_f32_16x16x32_bf16 v[196:199], a[144:147], a[28:31], v[228:231]
  s_cmp_ge_u32 s57, 2
  v_exp_f32 v207, v207
  v_mfma_f32_16x16x32_bf16 v[196:199], a[148:151], a[24:27], v[196:199]
  s_waitcnt lgkmcnt(3)
  v_exp_f32 v204, v204
  v_mfma_f32_16x16x32_bf16 v[196:199], a[152:155], a[20:23], v[196:199]
  ds_read_b64_tr_b16 a[180:181], v217 offset:8528
  v_cvt_pk_bf16_f32 v208, v200, v201
  v_cvt_pk_bf16_f32 v210, v204, v205
  v_cvt_pk_bf16_f32 v211, v206, v207
  v_mfma_f32_16x16x32_bf16 v[196:199], a[156:159], a[16:19], v[196:199]
  ds_read_b64_tr_b16 a[184:185], v217 offset:8544
  ds_read_b64_tr_b16 a[186:187], v217 offset:9056
  v_mfma_f32_16x16x32_bf16 v[0:3], v[208:211], a[160:163], v[0:3]
  ds_read_b64_tr_b16 a[188:189], v217 offset:8560
  ds_read_b64_tr_b16 a[190:191], v217 offset:9072
  v_mfma_f32_16x16x32_bf16 v[4:7], v[208:211], a[164:167], v[4:7]
  s_cselect_b32 s101, s34, 0x40000000
  v_mul_f32 v200, s29, v192
  v_mul_f32_e64 v202, s29, v194
  v_mfma_f32_16x16x32_bf16 v[8:11], v[208:211], a[168:171], v[8:11]
  s_lshr_b32 s99, s99, 2
  v_mul_f32 v201, s29, v193
  v_mul_f32_e64 v207, s29, v199
  v_mfma_f32_16x16x32_bf16 v[12:15], v[208:211], a[172:175], v[12:15]
  s_waitcnt lgkmcnt(5)
  v_mul_f32 v205, s29, v197
  v_mul_f32_e64 v206, s29, v198
  v_mfma_f32_16x16x32_bf16 v[16:19], v[208:211], a[176:179], v[16:19]
  s_waitcnt lgkmcnt(4)
  v_exp_f32 v206, v206
  v_mfma_f32_16x16x32_bf16 v[20:23], v[208:211], a[180:183], v[20:23]
  s_waitcnt lgkmcnt(2)
  v_mul_f32 v203, s29, v195
  v_mul_f32_e64 v204, s29, v196
  v_mfma_f32_16x16x32_bf16 v[24:27], v[208:211], a[184:187], v[24:27]
  s_waitcnt lgkmcnt(0)
  v_exp_f32 v201, v201
  v_mfma_f32_16x16x32_bf16 v[28:31], v[208:211], a[188:191], v[28:31]
  s_lshl_b32 s57, s57, 11
  v_exp_f32 v200, v200
  v_mfma_f32_16x16x32_bf16 v[192:195], a[128:131], a[32:35], v[228:231]
  s_add_u32 s34, s34, s57
  v_exp_f32 v205, v205
  v_mfma_f32_16x16x32_bf16 v[192:195], a[132:135], a[36:39], v[192:195]
  v_exp_f32_e64 v203, v203
  v_mfma_f32_16x16x32_bf16 v[192:195], a[136:139], a[40:43], v[192:195]
  v_exp_f32_e64 v207, v207
  v_mfma_f32_16x16x32_bf16 v[192:195], a[140:143], a[44:47], v[192:195]
  v_cvt_pk_bf16_f32 v212, v200, v201
  v_cvt_pk_bf16_f32 v215, v206, v207
  v_mfma_f32_16x16x32_bf16 v[196:199], a[144:147], a[44:47], v[228:231]
  v_exp_f32_e64 v202, v202
  v_mfma_f32_16x16x32_bf16 v[196:199], a[148:151], a[40:43], v[196:199]
  v_exp_f32_e64 v204, v204
  v_mfma_f32_16x16x32_bf16 v[196:199], a[152:155], a[36:39], v[196:199]
  v_cvt_pk_bf16_f32 v213, v202, v203
  v_cvt_pk_bf16_f32 v214, v204, v205
  v_mfma_f32_16x16x32_bf16 v[196:199], a[156:159], a[32:35], v[196:199]
  v_mul_f32 v201, s29, v193
  v_mul_f32 v203, s29, v195
  v_smfmac_f32_16x16x64_bf16 a[192:195], a[220:223], v[208:215], v254
  v_mul_f32_e64 v202, s29, v194
  v_mfma_f32_16x16x32_bf16 v[32:35], v[212:215], a[160:163], v[32:35]
  v_exp_f32_e64 v202, v202
  v_mfma_f32_16x16x32_bf16 v[36:39], v[212:215], a[164:167], v[36:39]
  v_mul_f32 v205, s29, v197
  v_mul_f32 v206, s29, v198
  v_mfma_f32_16x16x32_bf16 v[40:43], v[212:215], a[168:171], v[40:43]
  s_waitcnt vmcnt(8)
  v_exp_f32 v203, v203
  v_mfma_f32_16x16x32_bf16 v[44:47], v[212:215], a[172:175], v[44:47]
  s_barrier
  v_mul_f32 v200, s29, v192
  v_mfma_f32_16x16x32_bf16 v[48:51], v[212:215], a[176:179], v[48:51]
  s_mov_b32 m0, s30
  v_mul_f32 v204, s29, v196
  v_mul_f32_e64 v207, s29, v199
  v_mfma_f32_16x16x32_bf16 v[52:55], v[212:215], a[180:183], v[52:55]
  buffer_load_dwordx4 v221, s[4:7], s33 offen lds
  v_mfma_f32_16x16x32_bf16 v[56:59], v[212:215], a[184:187], v[56:59]
  v_exp_f32_e64 v201, v201
  v_mfma_f32_16x16x32_bf16 v[60:63], v[212:215], a[188:191], v[60:63]
  v_exp_f32_e64 v207, v207
  v_mfma_f32_16x16x32_bf16 v[192:195], a[128:131], a[48:51], v[228:231]
  v_exp_f32_e64 v204, v204
  v_mfma_f32_16x16x32_bf16 v[192:195], a[132:135], a[52:55], v[192:195]
  v_exp_f32_e64 v206, v206
  v_mfma_f32_16x16x32_bf16 v[192:195], a[136:139], a[56:59], v[192:195]
  v_cvt_pk_bf16_f32 v209, v202, v203
  v_cvt_pk_bf16_f32 v211, v206, v207
  v_mfma_f32_16x16x32_bf16 v[192:195], a[140:143], a[60:63], v[192:195]
  v_exp_f32_e64 v205, v205
  v_mfma_f32_16x16x32_bf16 v[196:199], a[144:147], a[60:63], v[228:231]
  v_exp_f32_e64 v200, v200
  v_mfma_f32_16x16x32_bf16 v[196:199], a[148:151], a[56:59], v[196:199]
  v_cvt_pk_bf16_f32 v208, v200, v201
  v_cvt_pk_bf16_f32 v210, v204, v205
  v_mfma_f32_16x16x32_bf16 v[196:199], a[152:155], a[52:55], v[196:199]
  s_add_u32 m0, s30, 32
  v_mul_f32 v200, s29, v192
  v_mul_f32_e64 v202, s29, v194
  v_mfma_f32_16x16x32_bf16 v[196:199], a[156:159], a[48:51], v[196:199]
  buffer_load_dwordx4 v221, s[4:7], s33 offen offset:1024 lds
  v_mfma_f32_16x16x32_bf16 v[64:67], v[208:211], a[160:163], v[64:67]
  v_mul_f32 v201, s29, v193
  v_mul_f32 v203, s29, v195
  v_mfma_f32_16x16x32_bf16 v[68:71], v[208:211], a[164:167], v[68:71]
  s_add_u32 m0, s30, s96
  v_exp_f32 v203, v203
  v_mfma_f32_16x16x32_bf16 v[72:75], v[208:211], a[168:171], v[72:75]
  buffer_load_dwordx4 v221, s[8:11], s33 offen lds
  v_mfma_f32_16x16x32_bf16 v[76:79], v[208:211], a[172:175], v[76:79]
  v_mul_f32 v204, s29, v196
  v_mul_f32 v206, s29, v198
  v_mfma_f32_16x16x32_bf16 v[80:83], v[208:211], a[176:179], v[80:83]
  v_exp_f32_e64 v206, v206
  v_mfma_f32_16x16x32_bf16 v[84:87], v[208:211], a[180:183], v[84:87]
  v_exp_f32_e64 v202, v202
  v_mfma_f32_16x16x32_bf16 v[88:91], v[208:211], a[184:187], v[88:91]
  v_mul_f32 v205, s29, v197
  v_mul_f32 v207, s29, v199
  v_mfma_f32_16x16x32_bf16 v[92:95], v[208:211], a[188:191], v[92:95]
  v_exp_f32_e64 v205, v205
  v_mfma_f32_16x16x32_bf16 v[192:195], a[128:131], a[64:67], v[228:231]
  v_exp_f32_e64 v200, v200
  v_mfma_f32_16x16x32_bf16 v[192:195], a[132:135], a[68:71], v[192:195]
  v_exp_f32_e64 v204, v204
  v_mfma_f32_16x16x32_bf16 v[192:195], a[136:139], a[72:75], v[192:195]
  s_add_u32 m0, s30, s97
  v_cvt_pk_bf16_f32 v213, v202, v203
  v_cvt_pk_bf16_f32 v214, v204, v205
  v_mfma_f32_16x16x32_bf16 v[192:195], a[140:143], a[76:79], v[192:195]
  buffer_load_dwordx4 v221, s[8:11], s33 offen offset:1024 lds
  v_mfma_f32_16x16x32_bf16 v[196:199], a[144:147], a[76:79], v[228:231]
  s_sub_u32 s30, s30, 16896
  v_exp_f32 v201, v201
  v_mfma_f32_16x16x32_bf16 v[196:199], a[148:151], a[72:75], v[196:199]
  s_cselect_b32 s30, s31, s30
  v_exp_f32 v207, v207
  v_mfma_f32_16x16x32_bf16 v[196:199], a[152:155], a[68:71], v[196:199]
  s_add_u32 s59, s59, 8192
  v_cvt_pk_bf16_f32 v212, v200, v201
  v_cvt_pk_bf16_f32 v215, v206, v207
  v_mfma_f32_16x16x32_bf16 v[196:199], a[156:159], a[64:67], v[196:199]
  s_mov_b32 m0, s36
  v_mul_f32 v200, s29, v192
  v_mul_f32_e64 v201, s29, v193
  v_smfmac_f32_16x16x64_bf16 a[196:199], a[220:223], v[208:215], v254
  buffer_load_dwordx4 v222, s[12:15], s100 offen nt lds
  v_mfma_f32_16x16x32_bf16 v[96:99], v[212:215], a[160:163], v[96:99]
  s_xor_b32 s33, s59, s3
  v_mul_f32 v202, s29, v194
  v_mul_f32_e64 v203, s29, v195
  v_mfma_f32_16x16x32_bf16 v[100:103], v[212:215], a[164:167], v[100:103]
  buffer_load_dwordx4 v223, s[12:15], s100 offen offset:1024 nt lds
  v_mfma_f32_16x16x32_bf16 v[104:107], v[212:215], a[168:171], v[104:107]
  s_add_u32 s36, s36, s57
  v_exp_f32 v202, v202
  v_exp_f32 v203, v203
  v_add_u32 v217, s30, v219
  v_pk_mul_f32 v[206:207], v[198:199], s[28:29] op_sel:[0,1] op_sel_hi:[1,1]
  v_mfma_f32_16x16x32_bf16 v[108:111], v[212:215], a[172:175], v[108:111]
  buffer_load_dwordx4 v222, s[12:15], s101 offen offset:2048 nt lds
  v_mfma_f32_16x16x32_bf16 v[112:115], v[212:215], a[176:179], v[112:115]
  v_exp_f32_e64 v206, v206
  v_mfma_f32_16x16x32_bf16 v[116:119], v[212:215], a[180:183], v[116:119]
  buffer_load_dwordx4 v223, s[12:15], s101 offen offset:3072 nt lds
  v_exp_f32_e64 v201, v201
  v_cvt_pk_bf16_f32 v209, v202, v203
  v_pk_mul_f32 v[204:205], v[196:197], s[28:29] op_sel:[0,1] op_sel_hi:[1,1]
  v_mfma_f32_16x16x32_bf16 v[120:123], v[212:215], a[184:187], v[120:123]
  v_exp_f32_e64 v200, v200
  v_mfma_f32_16x16x32_bf16 v[124:127], v[212:215], a[188:191], v[124:127]
  v_cvt_pk_bf16_f32 v208, v200, v201
  v_add_u32_e64 v216, s30, v218
  v_mfma_f32_16x16x32_bf16 v[192:195], a[128:131], a[80:83], v[228:231]
  v_exp_f32_e64 v204, v204
  v_mfma_f32_16x16x32_bf16 v[192:195], a[132:135], a[84:87], v[192:195]
  v_exp_f32_e64 v207, v207
  v_mfma_f32_16x16x32_bf16 v[192:195], a[136:139], a[88:91], v[192:195]
  ds_read_b128 a[132:135], v216 offset:64
  v_cvt_pk_bf16_f32 v211, v206, v207
  v_mfma_f32_16x16x32_bf16 v[192:195], a[140:143], a[92:95], v[192:195]
  v_exp_f32_e64 v205, v205
  v_mfma_f32_16x16x32_bf16 v[196:199], a[144:147], a[92:95], v[228:231]
  ds_read_b128 a[128:131], v216 offset:0
  v_cvt_pk_bf16_f32 v210, v204, v205
  v_mfma_f32_16x16x32_bf16 v[196:199], a[148:151], a[88:91], v[196:199]
  ds_read_b128 a[144:147], v216 offset:704
  ds_read_b128 a[148:151], v216 offset:640
  v_mfma_f32_16x16x32_bf16 v[196:199], a[152:155], a[84:87], v[196:199]
  ds_read_b128 a[152:155], v216 offset:576
  v_mul_f32_e64 v200, s29, v192
  v_mfma_f32_16x16x32_bf16 v[196:199], a[156:159], a[80:83], v[196:199]
  v_exp_f32_e64 v200, v200
  v_mfma_f32_16x16x32_bf16 v[128:131], v[208:211], a[160:163], v[128:131]
  ds_read_b128 a[136:139], v216 offset:128
  ds_read_b128 a[156:159], v216 offset:512
  v_mfma_f32_16x16x32_bf16 v[132:135], v[208:211], a[164:167], v[132:135]
  ds_read_b128 a[140:143], v216 offset:192
  v_mul_f32_e64 v203, s29, v195
  v_mfma_f32_16x16x32_bf16 v[136:139], v[208:211], a[168:171], v[136:139]
  v_mul_f32 v202, s29, v194
  v_mul_f32 v204, s29, v196
  v_mfma_f32_16x16x32_bf16 v[140:143], v[208:211], a[172:175], v[140:143]
  v_exp_f32_e64 v202, v202
  v_mfma_f32_16x16x32_bf16 v[144:147], v[208:211], a[176:179], v[144:147]
  v_mul_f32 v201, s29, v193
  v_mul_f32 v205, s29, v197
  v_mfma_f32_16x16x32_bf16 v[148:151], v[208:211], a[180:183], v[148:151]
  s_sub_u32 s37, s37, 1
  v_exp_f32 v201, v201
  v_mfma_f32_16x16x32_bf16 v[152:155], v[208:211], a[184:187], v[152:155]
  s_waitcnt lgkmcnt(3)
  v_exp_f32 v203, v203
  v_mfma_f32_16x16x32_bf16 v[156:159], v[208:211], a[188:191], v[156:159]
  s_cbranch_scc1 L_exitB
  v_mul_f32 v206, s29, v198
  v_mul_f32_e64 v207, s29, v199
  v_mfma_f32_16x16x32_bf16 v[192:195], a[128:131], a[0:3], v[228:231]
  v_exp_f32_e64 v204, v204
  v_mfma_f32_16x16x32_bf16 v[192:195], a[132:135], a[4:7], v[192:195]
  s_waitcnt lgkmcnt(0)
  v_exp_f32 v206, v206
  v_mfma_f32_16x16x32_bf16 v[192:195], a[136:139], a[8:11], v[192:195]
  v_exp_f32_e64 v207, v207
  v_mfma_f32_16x16x32_bf16 v[192:195], a[140:143], a[12:15], v[192:195]
  v_cvt_pk_bf16_f32 v212, v200, v201
  v_cvt_pk_bf16_f32 v215, v206, v207
  v_mfma_f32_16x16x32_bf16 v[196:199], a[144:147], a[12:15], v[228:231]
  v_exp_f32_e64 v205, v205
  v_mfma_f32_16x16x32_bf16 v[196:199], a[148:151], a[8:11], v[196:199]
  v_cvt_pk_bf16_f32 v213, v202, v203
  v_cvt_pk_bf16_f32 v214, v204, v205
  v_mfma_f32_16x16x32_bf16 v[196:199], a[152:155], a[4:7], v[196:199]
  v_mul_f32 v201, s29, v193
  v_mul_f32 v203, s29, v195
  v_mfma_f32_16x16x32_bf16 v[196:199], a[156:159], a[0:3], v[196:199]
  v_exp_f32_e64 v201, v201
  v_mfma_f32_16x16x32_bf16 v[160:163], v[212:215], a[160:163], v[160:163]
  ds_read_b64_tr_b16 a[160:161], v217 offset:8448
  v_mul_f32_e64 v202, s29, v194
  v_mfma_f32_16x16x32_bf16 v[164:167], v[212:215], a[164:167], v[164:167]
  v_exp_f32_e64 v202, v202
  v_mfma_f32_16x16x32_bf16 v[168:171], v[212:215], a[168:171], v[168:171]
  ds_read_b64_tr_b16 a[170:171], v217 offset:8992
  v_mul_f32_e64 v207, s29, v199
  v_mfma_f32_16x16x32_bf16 v[172:175], v[212:215], a[172:175], v[172:175]
  ds_read_b64_tr_b16 a[174:175], v217 offset:9008
  v_mul_f32_e64 v205, s29, v197
  v_mfma_f32_16x16x32_bf16 v[176:179], v[212:215], a[176:179], v[176:179]
  ds_read_b64_tr_b16 a[166:167], v217 offset:8976
  ds_read_b64_tr_b16 a[168:169], v217 offset:8480
  v_mfma_f32_16x16x32_bf16 v[180:183], v[212:215], a[180:183], v[180:183]
  v_exp_f32_e64 v203, v203
  v_mfma_f32_16x16x32_bf16 v[184:187], v[212:215], a[184:187], v[184:187]
  ds_read_b64_tr_b16 a[162:163], v217 offset:8960
  v_mul_f32_e64 v200, s29, v192
  v_mfma_f32_16x16x32_bf16 v[188:191], v[212:215], a[188:191], v[188:191]
  v_exp_f32_e64 v200, v200
  v_smfmac_f32_16x16x64_bf16 a[200:203], a[220:223], v[208:215], v254
  ds_read_b64_tr_b16 a[164:165], v217 offset:8464
  ds_read_b64_tr_b16 a[172:173], v217 offset:8496
  v_mul_f32 v204, s29, v196
  v_mul_f32 v206, s29, v198
L_pG0:
  v_mfma_f32_16x16x32_bf16 v[192:195], a[128:131], a[16:19], v[228:231]
  v_exp_f32_e64 v204, v204
  v_mfma_f32_16x16x32_bf16 v[192:195], a[132:135], a[20:23], v[192:195]
  v_exp_f32_e64 v205, v205
  v_mfma_f32_16x16x32_bf16 v[192:195], a[136:139], a[24:27], v[192:195]
  v_exp_f32_e64 v206, v206
  v_mfma_f32_16x16x32_bf16 v[192:195], a[140:143], a[28:31], v[192:195]
  v_exp_f32_e64 v207, v207
  v_mfma_f32_16x16x32_bf16 v[196:199], a[144:147], a[28:31], v[228:231]
  ds_read_b64_tr_b16 a[176:177], v217 offset:8512
  ds_read_b64_tr_b16 a[178:179], v217 offset:9024
  v_mfma_f32_16x16x32_bf16 v[196:199], a[148:151], a[24:27], v[196:199]
  s_waitcnt lgkmcnt(2)
  v_cvt_pk_bf16_f32 v208, v200, v201
  v_cvt_pk_bf16_f32 v209, v202, v203
  v_mfma_f32_16x16x32_bf16 v[196:199], a[152:155], a[20:23], v[196:199]
  ds_read_b64_tr_b16 a[180:181], v217 offset:8528
  ds_read_b64_tr_b16 a[182:183], v217 offset:9040
  v_cvt_pk_bf16_f32 v210, v204, v205
  v_cvt_pk_bf16_f32 v211, v206, v207
  v_mfma_f32_16x16x32_bf16 v[196:199], a[156:159], a[16:19], v[196:199]
  ds_read_b64_tr_b16 a[184:185], v217 offset:8544
  ds_read_b64_tr_b16 a[186:187], v217 offset:9056
  v_mfma_f32_16x16x32_bf16 v[0:3], v[208:211], a[160:163], v[0:3]
  ds_read_b64_tr_b16 a[188:189], v217 offset:8560
  ds_read_b64_tr_b16 a[190:191], v217 offset:9072
  v_mfma_f32_16x16x32_bf16 v[4:7], v[208:211], a[164:167], v[4:7]
  v_mul_f32 v200, s29, v192
  v_mul_f32_e64 v201, s29, v193
  v_mfma_f32_16x16x32_bf16 v[8:11], v[208:211], a[168:171], v[8:11]
  v_mul_f32 v202, s29, v194
  v_mul_f32 v203, s29, v195
  v_mfma_f32_16x16x32_bf16 v[12:15], v[208:211], a[172:175], v[12:15]
  s_waitcnt lgkmcnt(6)
  v_mul_f32 v204, s29, v196
  v_mul_f32_e64 v205, s29, v197
  v_mfma_f32_16x16x32_bf16 v[16:19], v[208:211], a[176:179], v[16:19]
  s_waitcnt lgkmcnt(4)
  v_mul_f32 v206, s29, v198
  v_mul_f32_e64 v207, s29, v199
  v_mfma_f32_16x16x32_bf16 v[20:23], v[208:211], a[180:183], v[20:23]
  s_waitcnt lgkmcnt(2)
  v_exp_f32 v200, v200
  v_mfma_f32_16x16x32_bf16 v[24:27], v[208:211], a[184:187], v[24:27]
  s_waitcnt lgkmcnt(0)
  v_exp_f32 v201, v201
  v_mfma_f32_16x16x32_bf16 v[28:31], v[208:211], a[188:191], v[28:31]
  v_exp_f32_e64 v202, v202
  v_mfma_f32_16x16x32_bf16 v[192:195], a[128:131], a[32:35], v[228:231]
  v_exp_f32_e64 v203, v203
  v_mfma_f32_16x16x32_bf16 v[192:195], a[132:135], a[36:39], v[192:195]
  v_exp_f32_e64 v204, v204
  v_mfma_f32_16x16x32_bf16 v[192:195], a[136:139], a[40:43], v[192:195]
  v_exp_f32_e64 v205, v205
  v_mfma_f32_16x16x32_bf16 v[192:195], a[140:143], a[44:47], v[192:195]
  v_exp_f32_e64 v206, v206
  v_mfma_f32_16x16x32_bf16 v[196:199], a[144:147], a[44:47], v[228:231]
  v_exp_f32_e64 v207, v207
  v_mfma_f32_16x16x32_bf16 v[196:199], a[148:151], a[40:43], v[196:199]
  v_cvt_pk_bf16_f32 v212, v200, v201
  v_cvt_pk_bf16_f32 v213, v202, v203
  v_mfma_f32_16x16x32_bf16 v[196:199], a[152:155], a[36:39], v[196:199]
  v_cvt_pk_bf16_f32 v214, v204, v205
  v_cvt_pk_bf16_f32 v215, v206, v207
  v_mfma_f32_16x16x32_bf16 v[196:199], a[156:159], a[32:35], v[196:199]
  v_mul_f32 v200, s29, v192
  v_mul_f32 v201, s29, v193
  v_smfmac_f32_16x16x64_bf16 a[192:195], a[220:223], v[208:215], v254
  v_mul_f32_e64 v202, s29, v194
  v_mfma_f32_16x16x32_bf16 v[32:35], v[212:215], a[160:163], v[32:35]
  v_exp_f32_e64 v200, v200
  v_mfma_f32_16x16x32_bf16 v[36:39], v[212:215], a[164:167], v[36:39]
  v_mul_f32 v203, s29, v195
  v_mul_f32 v204, s29, v196
  v_mfma_f32_16x16x32_bf16 v[40:43], v[212:215], a[168:171], v[40:43]
  v_mul_f32 v205, s29, v197
  v_mul_f32 v206, s29, v198
  v_mfma_f32_16x16x32_bf16 v[44:47], v[212:215], a[172:175], v[44:47]
  v_exp_f32_e64 v201, v201
  v_mfma_f32_16x16x32_bf16 v[48:51], v[212:215], a[176:179], v[48:51]
  v_mul_f32_e64 v207, s29, v199
  v_cvt_pk_bf16_f32 v208, v200, v201
  v_mfma_f32_16x16x32_bf16 v[52:55], v[212:215], a[180:183], v[52:55]
  v_exp_f32_e64 v202, v202
  v_mfma_f32_16x16x32_bf16 v[56:59], v[212:215], a[184:187], v[56:59]
  s_waitcnt vmcnt(8)
  v_exp_f32 v203, v203
  v_mfma_f32_16x16x32_bf16 v[60:63], v[212:215], a[188:191], v[60:63]
  s_barrier
  v_cvt_pk_bf16_f32 v209, v202, v203
  v_mfma_f32_16x16x32_bf16 v[192:195], a[128:131], a[48:51], v[228:231]
  v_exp_f32 v204, v204
  v_mfma_f32_16x16x32_bf16 v[192:195], a[132:135], a[52:55], v[192:195]
  v_exp_f32_e64 v205, v205
  v_mfma_f32_16x16x32_bf16 v[192:195], a[136:139], a[56:59], v[192:195]
  v_exp_f32_e64 v206, v206
  v_mfma_f32_16x16x32_bf16 v[192:195], a[140:143], a[60:63], v[192:195]
  v_exp_f32_e64 v207, v207
  v_mfma_f32_16x16x32_bf16 v[196:199], a[144:147], a[60:63], v[228:231]
  s_mov_b32 m0, s30
  v_cvt_pk_bf16_f32 v210, v204, v205
  v_cvt_pk_bf16_f32 v211, v206, v207
  v_mfma_f32_16x16x32_bf16 v[196:199], a[148:151], a[56:59], v[196:199]
  buffer_load_dwordx4 v221, s[4:7], s33 offen lds
  v_mfma_f32_16x16x32_bf16 v[196:199], a[152:155], a[52:55], v[196:199]
  v_mul_f32 v200, s29, v192
  v_mul_f32_e64 v201, s29, v193
  v_mfma_f32_16x16x32_bf16 v[196:199], a[156:159], a[48:51], v[196:199]
  s_add_u32 m0, s30, 32
  v_mul_f32 v202, s29, v194
  v_mul_f32_e64 v203, s29, v195
  v_mfma_f32_16x16x32_bf16 v[64:67], v[208:211], a[160:163], v[64:67]
  buffer_load_dwordx4 v221, s[4:7], s33 offen offset:1024 lds
  v_mfma_f32_16x16x32_bf16 v[68:71], v[208:211], a[164:167], v[68:71]
  v_exp_f32_e64 v200, v200
  v_mfma_f32_16x16x32_bf16 v[72:75], v[208:211], a[168:171], v[72:75]
  v_mul_f32 v204, s29, v196
  v_mul_f32 v205, s29, v197
  v_mfma_f32_16x16x32_bf16 v[76:79], v[208:211], a[172:175], v[76:79]
  v_mul_f32 v206, s29, v198
  v_mul_f32 v207, s29, v199
  v_mfma_f32_16x16x32_bf16 v[80:83], v[208:211], a[176:179], v[80:83]
  v_exp_f32_e64 v201, v201
  v_mfma_f32_16x16x32_bf16 v[84:87], v[208:211], a[180:183], v[84:87]
  v_exp_f32_e64 v202, v202
  v_mfma_f32_16x16x32_bf16 v[88:91], v[208:211], a[184:187], v[88:91]
  v_exp_f32_e64 v203, v203
  v_mfma_f32_16x16x32_bf16 v[92:95], v[208:211], a[188:191], v[92:95]
  v_exp_f32_e64 v204, v204
  v_mfma_f32_16x16x32_bf16 v[192:195], a[128:131], a[96:99], v[228:231]
  v_exp_f32_e64 v205, v205
  v_mfma_f32_16x16x32_bf16 v[192:195], a[132:135], a[100:103], v[192:195]
  v_exp_f32_e64 v206, v206
  v_mfma_f32_16x16x32_bf16 v[192:195], a[136:139], a[104:107], v[192:195]
  v_exp_f32_e64 v207, v207
  v_mfma_f32_16x16x32_bf16 v[192:195], a[140:143], a[108:111], v[192:195]
  v_cvt_pk_bf16_f32 v212, v200, v201
  v_cvt_pk_bf16_f32 v213, v202, v203
  v_mfma_f32_16x16x32_bf16 v[196:199], a[144:147], a[108:111], v[228:231]
  s_add_u32 m0, s30, s96
  v_cvt_pk_bf16_f32 v214, v204, v205
  v_cvt_pk_bf16_f32 v215, v206, v207
  v_mfma_f32_16x16x32_bf16 v[196:199], a[148:151], a[104:107], v[196:199]
  buffer_load_dwordx4 v221, s[8:11], s33 offen lds
  v_mfma_f32_16x16x32_bf16 v[196:199], a[152:155], a[100:103], v[196:199]
  v_mul_f32 v200, s29, v192
  v_mul_f32_e64 v201, s29, v193
  v_mfma_f32_16x16x32_bf16 v[196:199], a[156:159], a[96:99], v[196:199]
  s_add_u32 m0, s30, s97
  v_mul_f32 v202, s29, v194
  v_mul_f32_e64 v203, s29, v195
  v_smfmac_f32_16x16x64_bf16 a[196:199], a[220:223], v[208:215], v254
  buffer_load_dwordx4 v221, s[8:11], s33 offen offset:1024 lds
  v_mfma_f32_16x16x32_bf16 v[96:99], v[212:215], a[160:163], v[96:99]
  s_sub_u32 s30, s30, 16896
  v_exp_f32_e64 v200, v200
  v_mfma_f32_16x16x32_bf16 v[100:103], v[212:215], a[164:167], v[100:103]
  s_cselect_b32 s30, s31, s30
  v_mul_f32 v204, s29, v196
  v_mul_f32_e64 v205, s29, v197
  v_mfma_f32_16x16x32_bf16 v[104:107], v[212:215], a[168:171], v[104:107]
  s_add_u32 s59, s59, 8192
  v_mul_f32 v206, s29, v198
  v_mul_f32 v207, s29, v199
  v_mfma_f32_16x16x32_bf16 v[108:111], v[212:215], a[172:175], v[108:111]
  s_xor_b32 s33, s59, s3
  v_exp_f32 v201, v201
  v_mfma_f32_16x16x32_bf16 v[112:115], v[212:215], a[176:179], v[112:115]
  v_exp_f32_e64 v202, v202
  v_mfma_f32_16x16x32_bf16 v[116:119], v[212:215], a[180:183], v[116:119]
  v_exp_f32_e64 v203, v203
  v_mfma_f32_16x16x32_bf16 v[120:123], v[212:215], a[184:187], v[120:123]
  v_exp_f32_e64 v204, v204
  v_mfma_f32_16x16x32_bf16 v[124:127], v[212:215], a[188:191], v[124:127]
  v_exp_f32_e64 v205, v205
  v_mfma_f32_16x16x32_bf16 v[192:195], a[128:131], a[64:67], v[228:231]
  v_exp_f32_e64 v206, v206
  v_mfma_f32_16x16x32_bf16 v[192:195], a[132:135], a[68:71], v[192:195]
  v_exp_f32_e64 v207, v207
  v_mfma_f32_16x16x32_bf16 v[192:195], a[136:139], a[72:75], v[192:195]
  v_cvt_pk_bf16_f32 v208, v200, v201
  v_cvt_pk_bf16_f32 v209, v202, v203
  v_mfma_f32_16x16x32_bf16 v[192:195], a[140:143], a[76:79], v[192:195]
  v_cvt_pk_bf16_f32 v210, v204, v205
  v_cvt_pk_bf16_f32 v211, v206, v207
  v_mfma_f32_16x16x32_bf16 v[196:199], a[144:147], a[76:79], v[228:231]
  global_load_dword a120, v[252:253], off
  v_mfma_f32_16x16x32_bf16 v[196:199], a[148:151], a[72:75], v[196:199]
  v_add_u32 v216, s30, v218
  v_add_u32 v217, s30, v219
  v_mfma_f32_16x16x32_bf16 v[196:199], a[152:155], a[68:71], v[196:199]
  v_mul_f32 v200, s29, v192
  v_mul_f32 v201, s29, v193
  v_mfma_f32_16x16x32_bf16 v[196:199], a[156:159], a[64:67], v[196:199]
  v_mul_f32 v202, s29, v194
  v_mul_f32 v203, s29, v195
  v_mfma_f32_16x16x32_bf16 a[204:207], a[220:223], v[208:211], a[204:207]
  v_exp_f32_e64 v200, v200
  v_mfma_f32_16x16x32_bf16 a[224:227], v[208:211], a[160:163], a[224:227]
  v_exp_f32_e64 v201, v201
  v_mfma_f32_16x16x32_bf16 a[228:231], v[208:211], a[164:167], a[228:231]
  v_mul_f32 v204, s29, v196
  v_mul_f32 v205, s29, v197
  v_mfma_f32_16x16x32_bf16 a[232:235], v[208:211], a[168:171], a[232:235]
  v_mul_f32 v206, s29, v198
  v_mul_f32 v207, s29, v199
  v_mfma_f32_16x16x32_bf16 a[236:239], v[208:211], a[172:175], a[236:239]
  v_exp_f32_e64 v202, v202
  v_mfma_f32_16x16x32_bf16 a[240:243], v[208:211], a[176:179], a[240:243]
  v_exp_f32_e64 v203, v203
  v_mfma_f32_16x16x32_bf16 a[244:247], v[208:211], a[180:183], a[244:247]
  v_exp_f32_e64 v204, v204
  v_mfma_f32_16x16x32_bf16 a[248:251], v[208:211], a[184:187], a[248:251]
  v_exp_f32_e64 v205, v205
  v_mfma_f32_16x16x32_bf16 a[252:255], v[208:211], a[188:191], a[252:255]
  v_exp_f32_e64 v206, v206
  v_mfma_f32_16x16x32_bf16 v[192:195], a[128:131], a[80:83], v[228:231]
  v_exp_f32_e64 v207, v207
  v_mfma_f32_16x16x32_bf16 v[192:195], a[132:135], a[84:87], v[192:195]
  v_cvt_pk_bf16_f32 v208, v200, v201
  v_cvt_pk_bf16_f32 v209, v202, v203
  v_mfma_f32_16x16x32_bf16 v[192:195], a[136:139], a[88:91], v[192:195]
  v_cvt_pk_bf16_f32 v210, v204, v205
  v_cvt_pk_bf16_f32 v211, v206, v207
  v_mfma_f32_16x16x32_bf16 v[192:195], a[140:143], a[92:95], v[192:195]
  ds_read_b128 a[128:131], v216 offset:0
  ds_read_b128 a[132:135], v216 offset:64
  v_mfma_f32_16x16x32_bf16 v[196:199], a[144:147], a[92:95], v[228:231]
  ds_read_b128 a[136:139], v216 offset:128
  ds_read_b128 a[140:143], v216 offset:192
  v_mfma_f32_16x16x32_bf16 v[196:199], a[148:151], a[88:91], v[196:199]
  ds_read_b128 a[144:147], v216 offset:704
  ds_read_b128 a[148:151], v216 offset:640
  v_mfma_f32_16x16x32_bf16 v[196:199], a[152:155], a[84:87], v[196:199]
  v_mul_f32 v200, s29, v192
  v_mul_f32 v201, s29, v193
  v_mfma_f32_16x16x32_bf16 v[196:199], a[156:159], a[80:83], v[196:199]
  v_mul_f32 v202, s29, v194
  v_mul_f32 v203, s29, v195
  v_mfma_f32_16x16x32_bf16 v[128:131], v[208:211], a[160:163], v[128:131]
  v_exp_f32_e64 v200, v200
  v_mfma_f32_16x16x32_bf16 v[132:135], v[208:211], a[164:167], v[132:135]
  v_exp_f32_e64 v201, v201
  v_mfma_f32_16x16x32_bf16 v[136:139], v[208:211], a[168:171], v[136:139]
  v_exp_f32_e64 v202, v202
  v_mfma_f32_16x16x32_bf16 v[140:143], v[208:211], a[172:175], v[140:143]
  v_mul_f32 v204, s29, v196
  v_mul_f32 v205, s29, v197
  v_mfma_f32_16x16x32_bf16 v[144:147], v[208:211], a[176:179], v[144:147]
  s_sub_u32 s37, s37, 1
  v_exp_f32 v203, v203
  v_mfma_f32_16x16x32_bf16 v[148:151], v[208:211], a[180:183], v[148:151]
  ds_read_b128 a[152:155], v216 offset:576
  ds_read_b128 a[156:159], v216 offset:512
  v_mfma_f32_16x16x32_bf16 v[152:155], v[208:211], a[184:187], v[152:155]
  s_waitcnt lgkmcnt(2)
  v_mfma_f32_16x16x32_bf16 v[156:159], v[208:211], a[188:191], v[156:159]
  s_cbranch_scc1 L_exitB
  v_mul_f32 v206, s29, v198
  v_mul_f32 v207, s29, v199
  v_mfma_f32_16x16x32_bf16 v[192:195], a[128:131], a[0:3], v[228:231]
  v_exp_f32_e64 v204, v204
  v_mfma_f32_16x16x32_bf16 v[192:195], a[132:135], a[4:7], v[192:195]
  v_exp_f32_e64 v205, v205
  v_mfma_f32_16x16x32_bf16 v[192:195], a[136:139], a[8:11], v[192:195]
  v_exp_f32_e64 v206, v206
  v_mfma_f32_16x16x32_bf16 v[192:195], a[140:143], a[12:15], v[192:195]
  v_exp_f32_e64 v207, v207
  v_mfma_f32_16x16x32_bf16 v[196:199], a[144:147], a[12:15], v[228:231]
  v_cvt_pk_bf16_f32 v212, v200, v201
  v_cvt_pk_bf16_f32 v213, v202, v203
  v_mfma_f32_16x16x32_bf16 v[196:199], a[148:151], a[8:11], v[196:199]
  s_waitcnt lgkmcnt(0)
  v_cvt_pk_bf16_f32 v214, v204, v205
  v_cvt_pk_bf16_f32 v215, v206, v207
  v_mfma_f32_16x16x32_bf16 v[196:199], a[152:155], a[4:7], v[196:199]
  v_mul_f32 v200, s29, v192
  v_mul_f32_e64 v201, s29, v193
  v_mfma_f32_16x16x32_bf16 v[196:199], a[156:159], a[0:3], v[196:199]
  v_mul_f32 v202, s29, v194
  v_mul_f32 v203, s29, v195
  v_mfma_f32_16x16x32_bf16 v[160:163], v[212:215], a[160:163], v[160:163]
  v_exp_f32_e64 v200, v200
  v_mfma_f32_16x16x32_bf16 v[164:167], v[212:215], a[164:167], v[164:167]
  v_exp_f32_e64 v201, v201
  v_mfma_f32_16x16x32_bf16 v[168:171], v[212:215], a[168:171], v[168:171]
  v_exp_f32_e64 v202, v202
  v_mfma_f32_16x16x32_bf16 v[172:175], v[212:215], a[172:175], v[172:175]
  v_mul_f32 v204, s29, v196
  v_mul_f32 v205, s29, v197
  v_mfma_f32_16x16x32_bf16 v[176:179], v[212:215], a[176:179], v[176:179]
  v_exp_f32_e64 v203, v203
  v_mfma_f32_16x16x32_bf16 v[180:183], v[212:215], a[180:183], v[180:183]
  v_mul_f32 v206, s29, v198
  v_mul_f32 v207, s29, v199
  v_mfma_f32_16x16x32_bf16 v[184:187], v[212:215], a[184:187], v[184:187]
  ds_read_b64_tr_b16 a[160:161], v217 offset:8448
  ds_read_b64_tr_b16 a[162:163], v217 offset:8960
  v_mfma_f32_16x16x32_bf16 v[188:191], v[212:215], a[188:191], v[188:191]
  ds_read_b64_tr_b16 a[164:165], v217 offset:8464
  ds_read_b64_tr_b16 a[166:167], v217 offset:8976
  v_smfmac_f32_16x16x64_bf16 a[200:203], a[220:223], v[208:215], v254
  ds_read_b64_tr_b16 a[168:169], v217 offset:8480
  ds_read_b64_tr_b16 a[170:171], v217 offset:8992
  ds_read_b64_tr_b16 a[172:173], v217 offset:8496
  ds_read_b64_tr_b16 a[174:175], v217 offset:9008
  s_branch L_pG1
  .p2align 6
L_pC1:
  v_mfma_f32_16x16x32_bf16 v[192:195], a[128:131], a[16:19], v[228:231]
  v_exp_f32_e64 v204, v204
  v_mfma_f32_16x16x32_bf16 v[192:195], a[132:135], a[20:23], v[192:195]
  ds_read_b64_tr_b16 a[176:177], v217 offset:8512
  ds_read_b64_tr_b16 a[178:179], v217 offset:9024
  v_mfma_f32_16x16x32_bf16 v[192:195], a[136:139], a[24:27], v[192:195]
  v_exp_f32_e64 v205, v205
  v_mfma_f32_16x16x32_bf16 v[192:195], a[140:143], a[28:31], v[192:195]
  ds_read_b64_tr_b16 a[180:181], v217 offset:8528
  ds_read_b64_tr_b16 a[182:183], v217 offset:9040
  v_mfma_f32_16x16x32_bf16 v[196:199], a[144:147], a[28:31], v[228:231]
  v_exp_f32_e64 v206, v206
  v_mfma_f32_16x16x32_bf16 v[196:199], a[148:151], a[24:27], v[196:199]
  s_waitcnt lgkmcnt(4)
  v_exp_f32 v207, v207
  v_mfma_f32_16x16x32_bf16 v[196:199], a[152:155], a[20:23], v[196:199]
  ds_read_b64_tr_b16 a[184:185], v217 offset:8544
  ds_read_b64_tr_b16 a[186:187], v217 offset:9056
  v_cvt_pk_bf16_f32 v208, v200, v201
  v_cvt_pk_bf16_f32 v209, v202, v203
  v_cvt_pk_bf16_f32 v210, v204, v205
  v_cvt_pk_bf16_f32 v211, v206, v207
  v_mfma_f32_16x16x32_bf16 v[196:199], a[156:159], a[16:19], v[196:199]
  ds_read_b64_tr_b16 a[188:189], v217 offset:8560
  ds_read_b64_tr_b16 a[190:191], v217 offset:9072
  v_mfma_f32_16x16x32_bf16 v[0:3], v[208:211], a[160:163], v[0:3]
  v_mul_f32 v200, s29, v192
  v_mul_f32 v201, s29, v193
  v_mfma_f32_16x16x32_bf16 v[4:7], v[208:211], a[164:167], v[4:7]
  v_mul_f32 v202, s29, v194
  v_mul_f32 v203, s29, v195
  v_mfma_f32_16x16x32_bf16 v[8:11], v[208:211], a[168:171], v[8:11]
  v_mul_f32 v204, s29, v196
  v_mul_f32 v205, s29, v197
  v_mfma_f32_16x16x32_bf16 v[12:15], v[208:211], a[172:175], v[12:15]
  s_waitcnt lgkmcnt(4)
  v_mul_f32 v206, s29, v198
  v_mul_f32_e64 v207, s29, v199
  v_mfma_f32_16x16x32_bf16 v[16:19], v[208:211], a[176:179], v[16:19]
  v_exp_f32_e64 v200, v200
  v_mfma_f32_16x16x32_bf16 v[20:23], v[208:211], a[180:183], v[20:23]
  s_waitcnt lgkmcnt(2)
  v_exp_f32 v201, v201
  v_mfma_f32_16x16x32_bf16 v[24:27], v[208:211], a[184:187], v[24:27]
  s_waitcnt lgkmcnt(0)
  v_exp_f32 v202, v202
  v_mfma_f32_16x16x32_bf16 v[28:31], v[208:211], a[188:191], v[28:31]
  v_exp_f32_e64 v203, v203
  v_mfma_f32_16x16x32_bf16 v[192:195], a[128:131], a[32:35], v[228:231]
  v_exp_f32_e64 v204, v204
  v_mfma_f32_16x16x32_bf16 v[192:195], a[132:135], a[36:39], v[192:195]
  v_exp_f32_e64 v205, v205
  v_mfma_f32_16x16x32_bf16 v[192:195], a[136:139], a[40:43], v[192:195]
  v_exp_f32_e64 v206, v206
  v_mfma_f32_16x16x32_bf16 v[192:195], a[140:143], a[44:47], v[192:195]
  s_waitcnt vmcnt(7)
  v_exp_f32 v207, v207
  v_mfma_f32_16x16x32_bf16 v[196:199], a[144:147], a[44:47], v[228:231]
  s_barrier
  v_cvt_pk_bf16_f32 v212, v200, v201
  v_mfma_f32_16x16x32_bf16 v[196:199], a[148:151], a[40:43], v[196:199]
  v_cvt_pk_bf16_f32 v213, v202, v203
  v_cvt_pk_bf16_f32 v214, v204, v205
  v_mfma_f32_16x16x32_bf16 v[196:199], a[152:155], a[36:39], v[196:199]
  v_cvt_pk_bf16_f32 v215, v206, v207
  v_mul_f32 v200, s29, v192
  v_mfma_f32_16x16x32_bf16 v[196:199], a[156:159], a[32:35], v[196:199]
  v_mul_f32 v201, s29, v193
  v_mul_f32 v202, s29, v194
  v_smfmac_f32_16x16x64_bf16 a[192:195], a[220:223], v[208:215], v254
  s_mov_b32 m0, s30
  v_mul_f32 v203, s29, v195
  v_mfma_f32_16x16x32_bf16 v[32:35], v[212:215], a[160:163], v[32:35]
  buffer_load_dwordx4 v221, s[4:7], s33 offen lds
  v_mfma_f32_16x16x32_bf16 v[36:39], v[212:215], a[164:167], v[36:39]
  v_mul_f32 v204, s29, v196
  v_mul_f32 v205, s29, v197
  v_mfma_f32_16x16x32_bf16 v[40:43], v[212:215], a[168:171], v[40:43]
  v_mul_f32 v206, s29, v198
  v_mul_f32 v207, s29, v199
  v_mfma_f32_16x16x32_bf16 v[44:47], v[212:215], a[172:175], v[44:47]
  s_add_u32 m0, s30, 32
  v_exp_f32 v200, v200
  v_mfma_f32_16x16x32_bf16 v[48:51], v[212:215], a[176:179], v[48:51]
  buffer_load_dwordx4 v221, s[4:7], s33 offen offset:1024 lds
  v_mfma_f32_16x16x32_bf16 v[52:55], v[212:215], a[180:183], v[52:55]
  v_exp_f32_e64 v201, v201
  v_mfma_f32_16x16x32_bf16 v[56:59], v[212:215], a[184:187], v[56:59]
  v_exp_f32_e64 v202, v202
  v_mfma_f32_16x16x32_bf16 v[60:63], v[212:215], a[188:191], v[60:63]
  s_add_u32 m0, s30, s96
  v_exp_f32 v203, v203
  v_mfma_f32_16x16x32_bf16 v[192:195], a[128:131], a[48:51], v[228:231]
  buffer_load_dwordx4 v221, s[8:11], s33 offen lds
  v_mfma_f32_16x16x32_bf16 v[192:195], a[132:135], a[52:55], v[192:195]
  v_exp_f32_e64 v204, v204
  v_mfma_f32_16x16x32_bf16 v[192:195], a[136:139], a[56:59], v[192:195]
  v_exp_f32_e64 v205, v205
  v_mfma_f32_16x16x32_bf16 v[192:195], a[140:143], a[60:63], v[192:195]
  v_exp_f32_e64 v206, v206
  v_mfma_f32_16x16x32_bf16 v[196:199], a[144:147], a[60:63], v[228:231]
  v_exp_f32_e64 v207, v207
  v_mfma_f32_16x16x32_bf16 v[196:199], a[148:151], a[56:59], v[196:199]
  v_cvt_pk_bf16_f32 v208, v200, v201
  v_cvt_pk_bf16_f32 v209, v202, v203
  v_mfma_f32_16x16x32_bf16 v[196:199], a[152:155], a[52:55], v[196:199]
  v_cvt_pk_bf16_f32 v210, v204, v205
  v_cvt_pk_bf16_f32 v211, v206, v207
  v_mfma_f32_16x16x32_bf16 v[196:199], a[156:159], a[48:51], v[196:199]
  s_add_u32 m0, s30, s97
  v_mul_f32 v200, s29, v192
  v_mul_f32_e64 v201, s29, v193
  v_mfma_f32_16x16x32_bf16 v[64:67], v[208:211], a[160:163], v[64:67]
  buffer_load_dwordx4 v221, s[8:11], s33 offen offset:1024 lds
  v_mfma_f32_16x16x32_bf16 v[68:71], v[208:211], a[164:167], v[68:71]
  s_sub_u32 s30, s30, 16896
  v_mul_f32 v202, s29, v194
  v_mul_f32 v203, s29, v195
  v_mfma_f32_16x16x32_bf16 v[72:75], v[208:211], a[168:171], v[72:75]
  s_cselect_b32 s30, s31, s30
  v_mul_f32 v204, s29, v196
  v_mul_f32_e64 v205, s29, v197
  v_mfma_f32_16x16x32_bf16 v[76:79], v[208:211], a[172:175], v[76:79]
  s_add_u32 s59, s59, 8192
  v_mul_f32 v206, s29, v198
  v_mul_f32 v207, s29, v199
  v_mfma_f32_16x16x32_bf16 v[80:83], v[208:211], a[176:179], v[80:83]
  s_xor_b32 s33, s59, s3
  v_exp_f32 v200, v200
  v_mfma_f32_16x16x32_bf16 v[84:87], v[208:211], a[180:183], v[84:87]
  v_exp_f32_e64 v201, v201
  v_mfma_f32_16x16x32_bf16 v[88:91], v[208:211], a[184:187], v[88:91]
  v_exp_f32_e64 v202, v202
  v_mfma_f32_16x16x32_bf16 v[92:95], v[208:211], a[188:191], v[92:95]
  v_exp_f32_e64 v203, v203
  v_mfma_f32_16x16x32_bf16 v[192:195], a[128:131], a[96:99], v[228:231]
  v_exp_f32_e64 v204, v204
  v_mfma_f32_16x16x32_bf16 v[192:195], a[132:135], a[100:103], v[192:195]
  v_exp_f32_e64 v205, v205
  v_mfma_f32_16x16x32_bf16 v[192:195], a[136:139], a[104:107], v[192:195]
  v_exp_f32_e64 v206, v206
  v_mfma_f32_16x16x32_bf16 v[192:195], a[140:143], a[108:111], v[192:195]
  v_exp_f32_e64 v207, v207
  v_mfma_f32_16x16x32_bf16 v[196:199], a[144:147], a[108:111], v[228:231]
  v_cvt_pk_bf16_f32 v212, v200, v201
  v_cvt_pk_bf16_f32 v213, v202, v203
  v_mfma_f32_16x16x32_bf16 v[196:199], a[148:151], a[104:107], v[196:199]
  v_cvt_pk_bf16_f32 v214, v204, v205
  v_cvt_pk_bf16_f32 v215, v206, v207
  v_mfma_f32_16x16x32_bf16 v[196:199], a[152:155], a[100:103], v[196:199]
  ds_read_b64_tr_b16 a[112:113], v220 offset:0
  ds_read_b64_tr_b16 a[114:115], v220 offset:64
  v_mfma_f32_16x16x32_bf16 v[196:199], a[156:159], a[96:99], v[196:199]
  v_mul_f32 v200, s29, v192
  v_mul_f32 v201, s29, v193
  v_smfmac_f32_16x16x64_bf16 a[196:199], a[220:223], v[208:215], v254
  ds_read_b64_tr_b16 a[116:117], v220 offset:1024
  ds_read_b64_tr_b16 a[118:119], v220 offset:1088
  v_mfma_f32_16x16x32_bf16 v[96:99], v[212:215], a[160:163], v[96:99]
  v_mul_f32 v202, s29, v194
  v_mul_f32 v203, s29, v195
  v_mfma_f32_16x16x32_bf16 v[100:103], v[212:215], a[164:167], v[100:103]
  v_mul_f32 v204, s29, v196
  v_mul_f32 v205, s29, v197
  v_mfma_f32_16x16x32_bf16 v[104:107], v[212:215], a[168:171], v[104:107]
  v_mul_f32 v206, s29, v198
  v_mul_f32 v207, s29, v199
  v_mfma_f32_16x16x32_bf16 v[108:111], v[212:215], a[172:175], v[108:111]
  v_exp_f32_e64 v200, v200
  v_mfma_f32_16x16x32_bf16 v[112:115], v[212:215], a[176:179], v[112:115]
  v_exp_f32_e64 v201, v201
  v_mfma_f32_16x16x32_bf16 v[116:119], v[212:215], a[180:183], v[116:119]
  v_exp_f32_e64 v202, v202
  v_mfma_f32_16x16x32_bf16 v[120:123], v[212:215], a[184:187], v[120:123]
  v_exp_f32_e64 v203, v203
  v_mfma_f32_16x16x32_bf16 v[124:127], v[212:215], a[188:191], v[124:127]
  v_exp_f32_e64 v204, v204
  v_mfma_f32_16x16x32_bf16 v[192:195], a[128:131], a[64:67], v[228:231]
  v_exp_f32_e64 v205, v205
  v_mfma_f32_16x16x32_bf16 v[192:195], a[132:135], a[68:71], v[192:195]
  v_exp_f32_e64 v206, v206
  v_mfma_f32_16x16x32_bf16 v[192:195], a[136:139], a[72:75], v[192:195]
  v_exp_f32_e64 v207, v207
  v_mfma_f32_16x16x32_bf16 v[192:195], a[140:143], a[76:79], v[192:195]
  v_cvt_pk_bf16_f32 v208, v200, v201
  v_cvt_pk_bf16_f32 v209, v202, v203
  v_mfma_f32_16x16x32_bf16 v[196:199], a[144:147], a[76:79], v[228:231]
  v_cvt_pk_bf16_f32 v210, v204, v205
  v_cvt_pk_bf16_f32 v211, v206, v207
  v_mfma_f32_16x16x32_bf16 v[196:199], a[148:151], a[72:75], v[196:199]
  v_add_u32 v216, s30, v218
  v_add_u32 v217, s30, v219
  v_mfma_f32_16x16x32_bf16 v[196:199], a[152:155], a[68:71], v[196:199]
  s_waitcnt lgkmcnt(0)
  v_mul_f32 v200, s29, v192
  v_mul_f32_e64 v201, s29, v193
  v_mfma_f32_16x16x32_bf16 v[196:199], a[156:159], a[64:67], v[196:199]
  buffer_store_dwordx4 a[116:119], v233, s[16:19], s35 offen offset:1024 sc1
  v_mul_f32 v202, s29, v194
  v_mul_f32 v203, s29, v195
  v_mfma_f32_16x16x32_bf16 a[204:207], a[220:223], v[208:211], a[204:207]
  v_exp_f32_e64 v200, v200
  v_mfma_f32_16x16x32_bf16 a[224:227], v[208:211], a[160:163], a[224:227]
  v_exp_f32_e64 v201, v201
  v_mfma_f32_16x16x32_bf16 a[228:231], v[208:211], a[164:167], a[228:231]
  v_mul_f32 v204, s29, v196
  v_mul_f32 v205, s29, v197
  v_mfma_f32_16x16x32_bf16 a[232:235], v[208:211], a[168:171], a[232:235]
  buffer_store_dwordx4 a[112:115], v233, s[16:19], s35 offen sc1
  v_mul_f32 v206, s29, v198
  v_mul_f32 v207, s29, v199
  v_mfma_f32_16x16x32_bf16 a[236:239], v[208:211], a[172:175], a[236:239]
  s_add_u32 s35, s35, 2048
  v_exp_f32_e64 v202, v202
  v_mfma_f32_16x16x32_bf16 a[240:243], v[208:211], a[176:179], a[240:243]
  v_exp_f32_e64 v203, v203
  v_mfma_f32_16x16x32_bf16 a[244:247], v[208:211], a[180:183], a[244:247]
  v_exp_f32_e64 v204, v204
  v_mfma_f32_16x16x32_bf16 a[248:251], v[208:211], a[184:187], a[248:251]
  v_exp_f32_e64 v205, v205
  v_mfma_f32_16x16x32_bf16 a[252:255], v[208:211], a[188:191], a[252:255]
  v_exp_f32_e64 v206, v206
  v_mfma_f32_16x16x32_bf16 v[192:195], a[128:131], a[80:83], v[228:231]
  ds_read_b128 a[128:131], v216 offset:0
  v_cvt_pk_bf16_f32 v208, v200, v201
  v_mfma_f32_16x16x32_bf16 v[192:195], a[132:135], a[84:87], v[192:195]
  v_exp_f32_e64 v207, v207
  v_mfma_f32_16x16x32_bf16 v[192:195], a[136:139], a[88:91], v[192:195]
  ds_read_b128 a[132:135], v216 offset:64
  ds_read_b128 a[136:139], v216 offset:128
  v_mfma_f32_16x16x32_bf16 v[192:195], a[140:143], a[92:95], v[192:195]
  v_cvt_pk_bf16_f32 v209, v202, v203
  v_cvt_pk_bf16_f32 v210, v204, v205
  v_mfma_f32_16x16x32_bf16 v[196:199], a[144:147], a[92:95], v[228:231]
  ds_read_b128 a[140:143], v216 offset:192
  ds_read_b128 a[144:147], v216 offset:704
  v_mfma_f32_16x16x32_bf16 v[196:199], a[148:151], a[88:91], v[196:199]
  v_cvt_pk_bf16_f32 v211, v206, v207
  v_mfma_f32_16x16x32_bf16 v[196:199], a[152:155], a[84:87], v[196:199]
  ds_read_b128 a[148:151], v216 offset:640
  ds_read_b128 a[152:155], v216 offset:576
  v_mfma_f32_16x16x32_bf16 v[196:199], a[156:159], a[80:83], v[196:199]
  v_mul_f32 v200, s29, v192
  v_mul_f32 v201, s29, v193
  v_mfma_f32_16x16x32_bf16 v[128:131], v[208:211], a[160:163], v[128:131]
  ds_read_b128 a[156:159], v216 offset:512
  v_mul_f32_e64 v202, s29, v194
  v_mfma_f32_16x16x32_bf16 v[132:135], v[208:211], a[164:167], v[132:135]
  v_exp_f32_e64 v200, v200
  v_mfma_f32_16x16x32_bf16 v[136:139], v[208:211], a[168:171], v[136:139]
  v_mul_f32 v203, s29, v195
  v_mul_f32 v204, s29, v196
  v_mfma_f32_16x16x32_bf16 v[140:143], v[208:211], a[172:175], v[140:143]
  v_exp_f32_e64 v201, v201
  v_mfma_f32_16x16x32_bf16 v[144:147], v[208:211], a[176:179], v[144:147]
  v_exp_f32_e64 v202, v202
  v_mfma_f32_16x16x32_bf16 v[148:151], v[208:211], a[180:183], v[148:151]
  s_sub_u32 s37, s37, 1
  v_exp_f32 v203, v203
  v_mfma_f32_16x16x32_bf16 v[152:155], v[208:211], a[184:187], v[152:155]
  s_waitcnt lgkmcnt(1)
  v_mul_f32 v205, s29, v197
  v_mfma_f32_16x16x32_bf16 v[156:159], v[208:211], a[188:191], v[156:159]
  s_cbranch_scc1 L_exitC
  v_mul_f32 v206, s29, v198
  v_mul_f32_e64 v207, s29, v199
  v_mfma_f32_16x16x32_bf16 v[192:195], a[128:131], a[0:3], v[228:231]
  v_exp_f32_e64 v204, v204
  v_mfma_f32_16x16x32_bf16 v[192:195], a[132:135], a[4:7], v[192:195]
  v_exp_f32_e64 v205, v205
  v_mfma_f32_16x16x32_bf16 v[192:195], a[136:139], a[8:11], v[192:195]
  v_exp_f32_e64 v206, v206
  v_mfma_f32_16x16x32_bf16 v[192:195], a[140:143], a[12:15], v[192:195]
  v_exp_f32_e64 v207, v207
  v_mfma_f32_16x16x32_bf16 v[196:199], a[144:147], a[12:15], v[228:231]
  v_cvt_pk_bf16_f32 v212, v200, v201
  v_cvt_pk_bf16_f32 v213, v202, v203
  v_mfma_f32_16x16x32_bf16 v[196:199], a[148:151], a[8:11], v[196:199]
  v_cvt_pk_bf16_f32 v214, v204, v205
  v_cvt_pk_bf16_f32 v215, v206, v207
  v_mfma_f32_16x16x32_bf16 v[196:199], a[152:155], a[4:7], v[196:199]
  s_waitcnt lgkmcnt(0)
  v_mul_f32 v200, s29, v192
  v_mul_f32_e64 v201, s29, v193
  v_mfma_f32_16x16x32_bf16 v[196:199], a[156:159], a[0:3], v[196:199]
  v_mul_f32 v202, s29, v194
  v_mul_f32 v203, s29, v195
  v_mfma_f32_16x16x32_bf16 v[160:163], v[212:215], a[160:163], v[160:163]
  ds_read_b64_tr_b16 a[160:161], v217 offset:8448
  ds_read_b64_tr_b16 a[162:163], v217 offset:8960
  v_mfma_f32_16x16x32_bf16 v[164:167], v[212:215], a[164:167], v[164:167]
  v_exp_f32_e64 v200, v200
  v_mfma_f32_16x16x32_bf16 v[168:171], v[212:215], a[168:171], v[168:171]
  ds_read_b64_tr_b16 a[164:165], v217 offset:8464
  ds_read_b64_tr_b16 a[166:167], v217 offset:8976
  v_mfma_f32_16x16x32_bf16 v[172:175], v[212:215], a[172:175], v[172:175]
  v_exp_f32_e64 v201, v201
  v_mfma_f32_16x16x32_bf16 v[176:179], v[212:215], a[176:179], v[176:179]
  ds_read_b64_tr_b16 a[168:169], v217 offset:8480
  ds_read_b64_tr_b16 a[170:171], v217 offset:8992
  v_mfma_f32_16x16x32_bf16 v[180:183], v[212:215], a[180:183], v[180:183]
  v_exp_f32_e64 v202, v202
  v_mfma_f32_16x16x32_bf16 v[184:187], v[212:215], a[184:187], v[184:187]
  ds_read_b64_tr_b16 a[172:173], v217 offset:8496
  ds_read_b64_tr_b16 a[174:175], v217 offset:9008
  v_mfma_f32_16x16x32_bf16 v[188:191], v[212:215], a[188:191], v[188:191]
  v_mul_f32 v204, s29, v196
  v_mul_f32 v205, s29, v197
  v_smfmac_f32_16x16x64_bf16 a[200:203], a[220:223], v[208:215], v254
  v_exp_f32 v203, v203
  v_mul_f32 v206, s29, v198
  v_mul_f32_e64 v207, s29, v199
L_pC2:
  v_mfma_f32_16x16x32_bf16 v[192:195], a[128:131], a[16:19], v[228:231]
  ds_read_b64_tr_b16 a[176:177], v217 offset:8512
  ds_read_b64_tr_b16 a[178:179], v217 offset:9024
  v_mfma_f32_16x16x32_bf16 v[192:195], a[132:135], a[20:23], v[192:195]
  v_exp_f32_e64 v206, v206
  v_mfma_f32_16x16x32_bf16 v[192:195], a[136:139], a[24:27], v[192:195]
  ds_read_b64_tr_b16 a[180:181], v217 offset:8528
  ds_read_b64_tr_b16 a[182:183], v217 offset:9040
  v_mfma_f32_16x16x32_bf16 v[192:195], a[140:143], a[28:31], v[192:195]
  v_exp_f32_e64 v207, v207
  v_mfma_f32_16x16x32_bf16 v[196:199], a[144:147], a[28:31], v[228:231]
  v_cvt_pk_bf16_f32 v209, v202, v203
  v_cvt_pk_bf16_f32 v211, v206, v207
  v_mfma_f32_16x16x32_bf16 v[196:199], a[148:151], a[24:27], v[196:199]
  s_waitcnt lgkmcnt(4)
  v_exp_f32 v204, v204
  v_exp_f32_e64 v205, v205
  v_mfma_f32_16x16x32_bf16 v[196:199], a[152:155], a[20:23], v[196:199]
  ds_read_b64_tr_b16 a[184:185], v217 offset:8544
  ds_read_b64_tr_b16 a[186:187], v217 offset:9056
  v_cvt_pk_bf16_f32 v208, v200, v201
  v_cvt_pk_bf16_f32 v210, v204, v205
  v_mfma_f32_16x16x32_bf16 v[196:199], a[156:159], a[16:19], v[196:199]
  ds_read_b64_tr_b16 a[188:189], v217 offset:8560
  ds_read_b64_tr_b16 a[190:191], v217 offset:9072
  v_mfma_f32_16x16x32_bf16 v[0:3], v[208:211], a[160:163], v[0:3]
  v_mul_f32 v201, s29, v193
  v_mul_f32 v203, s29, v195
  v_mfma_f32_16x16x32_bf16 v[4:7], v[208:211], a[164:167], v[4:7]
  v_mul_f32 v200, s29, v192
  v_mul_f32 v202, s29, v194
  v_mfma_f32_16x16x32_bf16 v[8:11], v[208:211], a[168:171], v[8:11]
  v_mul_f32 v204, s29, v196
  v_mul_f32 v206, s29, v198
  v_mfma_f32_16x16x32_bf16 v[12:15], v[208:211], a[172:175], v[12:15]
  s_waitcnt lgkmcnt(4)
  v_mul_f32 v205, s29, v197
  v_mul_f32_e64 v207, s29, v199
  v_mfma_f32_16x16x32_bf16 v[16:19], v[208:211], a[176:179], v[16:19]
  v_exp_f32_e64 v202, v202
  v_mfma_f32_16x16x32_bf16 v[20:23], v[208:211], a[180:183], v[20:23]
  s_waitcnt lgkmcnt(2)
  v_exp_f32 v201, v201
  v_mfma_f32_16x16x32_bf16 v[24:27], v[208:211], a[184:187], v[24:27]
  s_waitcnt lgkmcnt(0)
  v_exp_f32 v200, v200
  v_mfma_f32_16x16x32_bf16 v[28:31], v[208:211], a[188:191], v[28:31]
  v_exp_f32_e64 v203, v203
  v_mfma_f32_16x16x32_bf16 v[192:195], a[128:131], a[32:35], v[228:231]
  v_exp_f32_e64 v207, v207
  v_mfma_f32_16x16x32_bf16 v[192:195], a[132:135], a[36:39], v[192:195]
  v_exp_f32_e64 v205, v205
  v_mfma_f32_16x16x32_bf16 v[192:195], a[136:139], a[40:43], v[192:195]
  v_exp_f32_e64 v206, v206
  v_mfma_f32_16x16x32_bf16 v[192:195], a[140:143], a[44:47], v[192:195]
  s_waitcnt vmcnt(7)
  v_cvt_pk_bf16_f32 v213, v202, v203
  v_cvt_pk_bf16_f32 v215, v206, v207
  v_mfma_f32_16x16x32_bf16 v[196:199], a[144:147], a[44:47], v[228:231]
  s_barrier
  v_cvt_pk_bf16_f32 v212, v200, v201
  v_mfma_f32_16x16x32_bf16 v[196:199], a[148:151], a[40:43], v[196:199]
  v_exp_f32_e64 v204, v204
  v_mfma_f32_16x16x32_bf16 v[196:199], a[152:155], a[36:39], v[196:199]
  v_cvt_pk_bf16_f32 v214, v204, v205
  v_mul_f32_e64 v202, s29, v194
  v_mfma_f32_16x16x32_bf16 v[196:199], a[156:159], a[32:35], v[196:199]
  v_mul_f32 v200, s29, v192
  v_mul_f32 v201, s29, v193
  v_smfmac_f32_16x16x64_bf16 a[192:195], a[220:223], v[208:215], v254
  ds_read_b64_tr_b16 a[112:113], v220 offset:2048
  v_mul_f32_e64 v203, s29, v195
  v_mfma_f32_16x16x32_bf16 v[32:35], v[212:215], a[160:163], v[32:35]
  s_mov_b32 m0, s30
  v_exp_f32 v201, v201
  v_mfma_f32_16x16x32_bf16 v[36:39], v[212:215], a[164:167], v[36:39]
  buffer_load_dwordx4 v221, s[4:7], s33 offen lds
  v_mfma_f32_16x16x32_bf16 v[40:43], v[212:215], a[168:171], v[40:43]
  v_mul_f32 v204, s29, v196
  v_mul_f32 v207, s29, v199
  v_mfma_f32_16x16x32_bf16 v[44:47], v[212:215], a[172:175], v[44:47]
  v_mul_f32 v205, s29, v197
  v_mul_f32 v206, s29, v198
  v_mfma_f32_16x16x32_bf16 v[48:51], v[212:215], a[176:179], v[48:51]
  s_add_u32 m0, s30, 32
  v_exp_f32 v206, v206
  v_mfma_f32_16x16x32_bf16 v[52:55], v[212:215], a[180:183], v[52:55]
  buffer_load_dwordx4 v221, s[4:7], s33 offen offset:1024 lds
  v_mfma_f32_16x16x32_bf16 v[56:59], v[212:215], a[184:187], v[56:59]
  v_exp_f32_e64 v200, v200
  v_mfma_f32_16x16x32_bf16 v[60:63], v[212:215], a[188:191], v[60:63]
  v_exp_f32_e64 v204, v204
  v_mfma_f32_16x16x32_bf16 v[192:195], a[128:131], a[48:51], v[228:231]
  v_exp_f32_e64 v207, v207
  v_mfma_f32_16x16x32_bf16 v[192:195], a[132:135], a[52:55], v[192:195]
  v_exp_f32_e64 v205, v205
  v_mfma_f32_16x16x32_bf16 v[192:195], a[136:139], a[56:59], v[192:195]
  v_exp_f32_e64 v202, v202
  v_mfma_f32_16x16x32_bf16 v[192:195], a[140:143], a[60:63], v[192:195]
  v_exp_f32_e64 v203, v203
  v_mfma_f32_16x16x32_bf16 v[196:199], a[144:147], a[60:63], v[228:231]
  v_cvt_pk_bf16_f32 v208, v200, v201
  v_cvt_pk_bf16_f32 v210, v204, v205
  v_mfma_f32_16x16x32_bf16 v[196:199], a[148:151], a[56:59], v[196:199]
  v_cvt_pk_bf16_f32 v209, v202, v203
  v_cvt_pk_bf16_f32 v211, v206, v207
  v_mfma_f32_16x16x32_bf16 v[196:199], a[152:155], a[52:55], v[196:199]
  v_mul_f32 v202, s29, v194
  v_mul_f32 v203, s29, v195
  v_mfma_f32_16x16x32_bf16 v[196:199], a[156:159], a[48:51], v[196:199]
  v_mul_f32 v200, s29, v192
  v_mul_f32 v201, s29, v193
  v_mfma_f32_16x16x32_bf16 v[64:67], v[208:211], a[160:163], v[64:67]
  s_add_u32 m0, s30, s96
  v_exp_f32 v203, v203
  v_mfma_f32_16x16x32_bf16 v[68:71], v[208:211], a[164:167], v[68:71]
  buffer_load_dwordx4 v221, s[8:11], s33 offen lds
  v_mfma_f32_16x16x32_bf16 v[72:75], v[208:211], a[168:171], v[72:75]
  v_mul_f32 v204, s29, v196
  v_mul_f32 v207, s29, v199
  v_mfma_f32_16x16x32_bf16 v[76:79], v[208:211], a[172:175], v[76:79]
  v_mul_f32 v205, s29, v197
  v_mul_f32 v206, s29, v198
  v_mfma_f32_16x16x32_bf16 v[80:83], v[208:211], a[176:179], v[80:83]
  s_add_u32 m0, s30, s97
  v_exp_f32 v204, v204
  v_mfma_f32_16x16x32_bf16 v[84:87], v[208:211], a[180:183], v[84:87]
  buffer_load_dwordx4 v221, s[8:11], s33 offen offset:1024 lds
  v_mfma_f32_16x16x32_bf16 v[88:91], v[208:211], a[184:187], v[88:91]
  s_sub_u32 s30, s30, 16896
  v_exp_f32_e64 v200, v200
  v_mfma_f32_16x16x32_bf16 v[92:95], v[208:211], a[188:191], v[92:95]
  s_cselect_b32 s30, s31, s30
  v_exp_f32 v206, v206
  v_mfma_f32_16x16x32_bf16 v[192:195], a[128:131], a[96:99], v[228:231]
  s_add_u32 s59, s59, 8192
  v_exp_f32_e64 v207, v207
  v_mfma_f32_16x16x32_bf16 v[192:195], a[132:135], a[100:103], v[192:195]
  s_xor_b32 s33, s59, s3
  v_exp_f32 v202, v202
  v_mfma_f32_16x16x32_bf16 v[192:195], a[136:139], a[104:107], v[192:195]
  v_exp_f32_e64 v201, v201
  v_mfma_f32_16x16x32_bf16 v[192:195], a[140:143], a[108:111], v[192:195]
  v_cvt_pk_bf16_f32 v212, v200, v201
  v_cvt_pk_bf16_f32 v215, v206, v207
  v_mfma_f32_16x16x32_bf16 v[196:199], a[144:147], a[108:111], v[228:231]
  v_exp_f32_e64 v205, v205
  v_mfma_f32_16x16x32_bf16 v[196:199], a[148:151], a[104:107], v[196:199]
  v_cvt_pk_bf16_f32 v213, v202, v203
  v_cvt_pk_bf16_f32 v214, v204, v205
  v_mfma_f32_16x16x32_bf16 v[196:199], a[152:155], a[100:103], v[196:199]
  v_mul_f32 v200, s29, v192
  v_mul_f32 v203, s29, v195
  v_mfma_f32_16x16x32_bf16 v[196:199], a[156:159], a[96:99], v[196:199]
  v_mul_f32 v201, s29, v193
  v_mul_f32 v202, s29, v194
  v_smfmac_f32_16x16x64_bf16 a[196:199], a[220:223], v[208:215], v254
  v_add_u32_e64 v216, s30, v218
  v_mfma_f32_16x16x32_bf16 v[96:99], v[212:215], a[160:163], v[96:99]
  v_exp_f32_e64 v202, v202
  v_mfma_f32_16x16x32_bf16 v[100:103], v[212:215], a[164:167], v[100:103]
  v_mul_f32 v204, s29, v196
  v_mul_f32 v205, s29, v197
  v_mfma_f32_16x16x32_bf16 v[104:107], v[212:215], a[168:171], v[104:107]
  v_mul_f32 v206, s29, v198
  v_mul_f32 v207, s29, v199
  v_mfma_f32_16x16x32_bf16 v[108:111], v[212:215], a[172:175], v[108:111]
  v_exp_f32_e64 v200, v200
  v_mfma_f32_16x16x32_bf16 v[112:115], v[212:215], a[176:179], v[112:115]
  v_exp_f32_e64 v207, v207
  v_mfma_f32_16x16x32_bf16 v[116:119], v[212:215], a[180:183], v[116:119]
  v_exp_f32_e64 v204, v204
  v_mfma_f32_16x16x32_bf16 v[120:123], v[212:215], a[184:187], v[120:123]
  v_exp_f32_e64 v203, v203
  v_mfma_f32_16x16x32_bf16 v[124:127], v[212:215], a[188:191], v[124:127]
  v_exp_f32_e64 v206, v206
  v_mfma_f32_16x16x32_bf16 v[192:195], a[128:131], a[64:67], v[228:231]
  v_exp_f32_e64 v201, v201
  v_mfma_f32_16x16x32_bf16 v[192:195], a[132:135], a[68:71], v[192:195]
  v_exp_f32_e64 v205, v205
  v_mfma_f32_16x16x32_bf16 v[192:195], a[136:139], a[72:75], v[192:195]
  v_cvt_pk_bf16_f32 v210, v204, v205
  v_cvt_pk_bf16_f32 v211, v206, v207
  v_mfma_f32_16x16x32_bf16 v[192:195], a[140:143], a[76:79], v[192:195]
  v_cvt_pk_bf16_f32 v208, v200, v201
  v_cvt_pk_bf16_f32 v209, v202, v203
  v_mfma_f32_16x16x32_bf16 v[196:199], a[144:147], a[76:79], v[228:231]
  ds_read_b64_tr_b16 a[114:115], v220 offset:2112
  ds_read_b64_tr_b16 a[116:117], v220 offset:3072
  v_mfma_f32_16x16x32_bf16 v[196:199], a[148:151], a[72:75], v[196:199]
  v_add_u32_e64 v217, s30, v219
  v_mfma_f32_16x16x32_bf16 v[196:199], a[152:155], a[68:71], v[196:199]
  ds_read_b64_tr_b16 a[118:119], v220 offset:3136
  v_mul_f32_e64 v202, s29, v194
  v_mfma_f32_16x16x32_bf16 v[196:199], a[156:159], a[64:67], v[196:199]
  v_mul_f32 v201, s29, v193
  v_mul_f32 v203, s29, v195
  v_mfma_f32_16x16x32_bf16 a[204:207], a[220:223], v[208:211], a[204:207]
  v_exp_f32_e64 v201, v201
  v_mfma_f32_16x16x32_bf16 a[224:227], v[208:211], a[160:163], a[224:227]
  v_exp_f32_e64 v203, v203
  v_mfma_f32_16x16x32_bf16 a[228:231], v[208:211], a[164:167], a[228:231]
  v_mul_f32 v200, s29, v192
  v_mul_f32 v204, s29, v196
  v_mfma_f32_16x16x32_bf16 a[232:235], v[208:211], a[168:171], a[232:235]
  v_mul_f32 v205, s29, v197
  v_mul_f32 v207, s29, v199
  v_mfma_f32_16x16x32_bf16 a[236:239], v[208:211], a[172:175], a[236:239]
  v_exp_f32_e64 v204, v204
  v_mfma_f32_16x16x32_bf16 a[240:243], v[208:211], a[176:179], a[240:243]
  v_exp_f32_e64 v207, v207
  v_mfma_f32_16x16x32_bf16 a[244:247], v[208:211], a[180:183], a[244:247]
  v_exp_f32_e64 v200, v200
  v_mfma_f32_16x16x32_bf16 a[248:251], v[208:211], a[184:187], a[248:251]
  s_waitcnt lgkmcnt(0)
  v_exp_f32 v202, v202
  v_mfma_f32_16x16x32_bf16 a[252:255], v[208:211], a[188:191], a[252:255]
  buffer_store_dwordx4 a[116:119], v233, s[16:19], s35 offen offset:1024 sc1
  v_mul_f32_e64 v206, s29, v198
  v_cvt_pk_bf16_f32 v208, v200, v201
  v_mfma_f32_16x16x32_bf16 v[192:195], a[128:131], a[80:83], v[228:231]
  v_exp_f32_e64 v206, v206
  v_mfma_f32_16x16x32_bf16 v[192:195], a[132:135], a[84:87], v[192:195]
  buffer_store_dwordx4 a[112:115], v233, s[16:19], s35 offen sc1
  v_cvt_pk_bf16_f32 v209, v202, v203
  v_cvt_pk_bf16_f32 v211, v206, v207
  v_mfma_f32_16x16x32_bf16 v[192:195], a[136:139], a[88:91], v[192:195]
  s_add_u32 s35, s35, 2048
  v_exp_f32_e64 v205, v205
  v_mfma_f32_16x16x32_bf16 v[192:195], a[140:143], a[92:95], v[192:195]
  ds_read_b128 a[128:131], v216 offset:0
  v_cvt_pk_bf16_f32 v210, v204, v205
  v_mfma_f32_16x16x32_bf16 v[196:199], a[144:147], a[92:95], v[228:231]
  v_mfma_f32_16x16x32_bf16 v[196:199], a[148:151], a[88:91], v[196:199]
  ds_read_b128 a[132:135], v216 offset:64
  ds_read_b128 a[136:139], v216 offset:128
  v_mfma_f32_16x16x32_bf16 v[196:199], a[152:155], a[84:87], v[196:199]
  v_mul_f32 v200, s29, v192
  v_mul_f32 v201, s29, v193
  v_mfma_f32_16x16x32_bf16 v[196:199], a[156:159], a[80:83], v[196:199]
  ds_read_b128 a[140:143], v216 offset:192
  ds_read_b128 a[144:147], v216 offset:704
  v_mfma_f32_16x16x32_bf16 v[128:131], v[208:211], a[160:163], v[128:131]
  v_mul_f32 v202, s29, v194
  v_mul_f32 v203, s29, v195
  v_mfma_f32_16x16x32_bf16 v[132:135], v[208:211], a[164:167], v[132:135]
  ds_read_b128 a[148:151], v216 offset:640
  ds_read_b128 a[152:155], v216 offset:576
  v_mfma_f32_16x16x32_bf16 v[136:139], v[208:211], a[168:171], v[136:139]
  v_mul_f32 v204, s29, v196
  v_mul_f32 v205, s29, v197
  v_mfma_f32_16x16x32_bf16 v[140:143], v[208:211], a[172:175], v[140:143]
  v_exp_f32_e64 v202, v202
  v_mfma_f32_16x16x32_bf16 v[144:147], v[208:211], a[176:179], v[144:147]
  s_sub_u32 s37, s37, 1
  v_exp_f32 v201, v201
  v_mfma_f32_16x16x32_bf16 v[148:151], v[208:211], a[180:183], v[148:151]
  s_waitcnt lgkmcnt(4)
  v_exp_f32 v203, v203
  v_mfma_f32_16x16x32_bf16 v[152:155], v[208:211], a[184:187], v[152:155]
  ds_read_b128 a[156:159], v216 offset:512
  v_exp_f32_e64 v200, v200
  v_mfma_f32_16x16x32_bf16 v[156:159], v[208:211], a[188:191], v[156:159]
  s_cbranch_scc1 L_exitC
  v_mul_f32 v206, s29, v198
  v_mul_f32_e64 v207, s29, v199
  v_mfma_f32_16x16x32_bf16 v[192:195], a[128:131], a[0:3], v[228:231]
  v_exp_f32_e64 v205, v205
  v_mfma_f32_16x16x32_bf16 v[192:195], a[132:135], a[4:7], v[192:195]
  v_exp_f32_e64 v204, v204
  v_mfma_f32_16x16x32_bf16 v[192:195], a[136:139], a[8:11], v[192:195]
  s_waitcnt lgkmcnt(1)
  v_exp_f32 v207, v207
  v_mfma_f32_16x16x32_bf16 v[192:195], a[140:143], a[12:15], v[192:195]
  v_cvt_pk_bf16_f32 v213, v202, v203
  v_cvt_pk_bf16_f32 v214, v204, v205
  v_mfma_f32_16x16x32_bf16 v[196:199], a[144:147], a[12:15], v[228:231]
  v_exp_f32_e64 v206, v206
  v_mfma_f32_16x16x32_bf16 v[196:199], a[148:151], a[8:11], v[196:199]
  v_cvt_pk_bf16_f32 v212, v200, v201
  v_cvt_pk_bf16_f32 v215, v206, v207
  v_mfma_f32_16x16x32_bf16 v[196:199], a[152:155], a[4:7], v[196:199]
  s_waitcnt lgkmcnt(0)
  v_mul_f32 v201, s29, v193
  v_mul_f32_e64 v203, s29, v195
  v_mfma_f32_16x16x32_bf16 v[196:199], a[156:159], a[0:3], v[196:199]
  v_mul_f32 v200, s29, v192
  v_mul_f32 v202, s29, v194
  v_mfma_f32_16x16x32_bf16 v[160:163], v[212:215], a[160:163], v[160:163]
  v_exp_f32_e64 v202, v202
  v_mfma_f32_16x16x32_bf16 v[164:167], v[212:215], a[164:167], v[164:167]
  ds_read_b64_tr_b16 a[162:163], v217 offset:8960
  ds_read_b64_tr_b16 a[166:167], v217 offset:8976
  v_mfma_f32_16x16x32_bf16 v[168:171], v[212:215], a[168:171], v[168:171]
  v_mul_f32 v205, s29, v197
  v_mul_f32 v206, s29, v198
  v_mfma_f32_16x16x32_bf16 v[172:175], v[212:215], a[172:175], v[172:175]
  ds_read_b64_tr_b16 a[168:169], v217 offset:8480
  ds_read_b64_tr_b16 a[174:175], v217 offset:9008
  v_mfma_f32_16x16x32_bf16 v[176:179], v[212:215], a[176:179], v[176:179]
  v_exp_f32_e64 v200, v200
  v_mfma_f32_16x16x32_bf16 v[180:183], v[212:215], a[180:183], v[180:183]
  v_exp_f32_e64 v203, v203
  v_mfma_f32_16x16x32_bf16 v[184:187], v[212:215], a[184:187], v[184:187]
  v_mul_f32 v204, s29, v196
  v_mul_f32 v207, s29, v199
  v_mfma_f32_16x16x32_bf16 v[188:191], v[212:215], a[188:191], v[188:191]
  ds_read_b64_tr_b16 a[160:161], v217 offset:8448
  ds_read_b64_tr_b16 a[170:171], v217 offset:8992
  v_smfmac_f32_16x16x64_bf16 a[200:203], a[220:223], v[208:215], v254
  ds_read_b64_tr_b16 a[164:165], v217 offset:8464
  ds_read_b64_tr_b16 a[172:173], v217 offset:8496
  v_exp_f32_e64 v201, v201
L_pC3:
  v_mfma_f32_16x16x32_bf16 v[192:195], a[128:131], a[16:19], v[228:231]
  v_exp_f32_e64 v205, v205
  v_mfma_f32_16x16x32_bf16 v[192:195], a[132:135], a[20:23], v[192:195]
  ds_read_b64_tr_b16 a[176:177], v217 offset:8512
  ds_read_b64_tr_b16 a[178:179], v217 offset:9024
  v_mfma_f32_16x16x32_bf16 v[192:195], a[136:139], a[24:27], v[192:195]
  v_cvt_pk_bf16_f32 v208, v200, v201
  v_cvt_pk_bf16_f32 v209, v202, v203
  v_mfma_f32_16x16x32_bf16 v[192:195], a[140:143], a[28:31], v[192:195]
  ds_read_b64_tr_b16 a[180:181], v217 offset:8528
  ds_read_b64_tr_b16 a[182:183], v217 offset:9040
  v_mfma_f32_16x16x32_bf16 v[196:199], a[144:147], a[28:31], v[228:231]
  v_exp_f32_e64 v206, v206
  v_mfma_f32_16x16x32_bf16 v[196:199], a[148:151], a[24:27], v[196:199]
  s_waitcnt lgkmcnt(4)
  v_exp_f32 v204, v204
  v_exp_f32_e64 v207, v207
  v_mfma_f32_16x16x32_bf16 v[196:199], a[152:155], a[20:23], v[196:199]
  ds_read_b64_tr_b16 a[184:185], v217 offset:8544
  ds_read_b64_tr_b16 a[186:187], v217 offset:9056
  v_cvt_pk_bf16_f32 v210, v204, v205
  v_cvt_pk_bf16_f32 v211, v206, v207
  v_mfma_f32_16x16x32_bf16 v[196:199], a[156:159], a[16:19], v[196:199]
  ds_read_b64_tr_b16 a[188:189], v217 offset:8560
  ds_read_b64_tr_b16 a[190:191], v217 offset:9072
  v_mfma_f32_16x16x32_bf16 v[0:3], v[208:211], a[160:163], v[0:3]
  v_mul_f32 v200, s29, v192
  v_mul_f32 v202, s29, v194
  v_mfma_f32_16x16x32_bf16 v[4:7], v[208:211], a[164:167], v[4:7]
  v_mul_f32 v201, s29, v193
  v_mul_f32 v203, s29, v195
  v_mfma_f32_16x16x32_bf16 v[8:11], v[208:211], a[168:171], v[8:11]
  v_mul_f32 v204, s29, v196
  v_mul_f32 v207, s29, v199
  v_mfma_f32_16x16x32_bf16 v[12:15], v[208:211], a[172:175], v[12:15]
  s_waitcnt lgkmcnt(4)
  v_mul_f32 v205, s29, v197
  v_mul_f32_e64 v206, s29, v198
  v_mfma_f32_16x16x32_bf16 v[16:19], v[208:211], a[176:179], v[16:19]
  v_exp_f32_e64 v204, v204
  v_mfma_f32_16x16x32_bf16 v[20:23], v[208:211], a[180:183], v[20:23]
  s_waitcnt lgkmcnt(2)
  v_exp_f32 v205, v205
  v_mfma_f32_16x16x32_bf16 v[24:27], v[208:211], a[184:187], v[24:27]
  s_waitcnt lgkmcnt(0)
  v_exp_f32 v203, v203
  v_mfma_f32_16x16x32_bf16 v[28:31], v[208:211], a[188:191], v[28:31]
  v_exp_f32_e64 v202, v202
  v_mfma_f32_16x16x32_bf16 v[192:195], a[128:131], a[32:35], v[228:231]
  v_cvt_pk_bf16_f32 v213, v202, v203
  v_cvt_pk_bf16_f32 v214, v204, v205
  v_mfma_f32_16x16x32_bf16 v[192:195], a[132:135], a[36:39], v[192:195]
  v_exp_f32_e64 v207, v207
  v_mfma_f32_16x16x32_bf16 v[192:195], a[136:139], a[40:43], v[192:195]
  v_exp_f32_e64 v201, v201
  v_mfma_f32_16x16x32_bf16 v[192:195], a[140:143], a[44:47], v[192:195]
  s_waitcnt vmcnt(8)
  v_exp_f32 v200, v200
  v_mfma_f32_16x16x32_bf16 v[196:199], a[144:147], a[44:47], v[228:231]
  s_barrier
  v_cvt_pk_bf16_f32 v212, v200, v201
  v_mfma_f32_16x16x32_bf16 v[196:199], a[148:151], a[40:43], v[196:199]
  v_exp_f32 v206, v206
  v_mfma_f32_16x16x32_bf16 v[196:199], a[152:155], a[36:39], v[196:199]
  s_mov_b32 m0, s30
  v_cvt_pk_bf16_f32 v215, v206, v207
  v_mul_f32 v202, s29, v194
  v_mfma_f32_16x16x32_bf16 v[196:199], a[156:159], a[32:35], v[196:199]
  buffer_load_dwordx4 v221, s[4:7], s33 offen lds
  v_smfmac_f32_16x16x64_bf16 a[192:195], a[220:223], v[208:215], v254
  v_mul_f32_e64 v201, s29, v193
  v_mfma_f32_16x16x32_bf16 v[32:35], v[212:215], a[160:163], v[32:35]
  v_mul_f32 v200, s29, v192
  v_mul_f32 v203, s29, v195
  v_mfma_f32_16x16x32_bf16 v[36:39], v[212:215], a[164:167], v[36:39]
  s_add_u32 m0, s30, 32
  v_mul_f32 v206, s29, v198
  v_mul_f32_e64 v207, s29, v199
  v_mfma_f32_16x16x32_bf16 v[40:43], v[212:215], a[168:171], v[40:43]
  buffer_load_dwordx4 v221, s[4:7], s33 offen offset:1024 lds
  v_mfma_f32_16x16x32_bf16 v[44:47], v[212:215], a[172:175], v[44:47]
  v_exp_f32_e64 v202, v202
  v_mfma_f32_16x16x32_bf16 v[48:51], v[212:215], a[176:179], v[48:51]
  v_mul_f32 v204, s29, v196
  v_mul_f32 v205, s29, v197
  v_mfma_f32_16x16x32_bf16 v[52:55], v[212:215], a[180:183], v[52:55]
  s_add_u32 m0, s30, s96
  v_exp_f32 v205, v205
  v_mfma_f32_16x16x32_bf16 v[56:59], v[212:215], a[184:187], v[56:59]
  buffer_load_dwordx4 v221, s[8:11], s33 offen lds
  v_mfma_f32_16x16x32_bf16 v[60:63], v[212:215], a[188:191], v[60:63]
  v_exp_f32_e64 v206, v206
  v_mfma_f32_16x16x32_bf16 v[192:195], a[128:131], a[48:51], v[228:231]
  v_exp_f32_e64 v204, v204
  v_mfma_f32_16x16x32_bf16 v[192:195], a[132:135], a[52:55], v[192:195]
  v_exp_f32_e64 v201, v201
  v_mfma_f32_16x16x32_bf16 v[192:195], a[136:139], a[56:59], v[192:195]
  v_exp_f32_e64 v203, v203
  v_mfma_f32_16x16x32_bf16 v[192:195], a[140:143], a[60:63], v[192:195]
  v_cvt_pk_bf16_f32 v209, v202, v203
  v_cvt_pk_bf16_f32 v210, v204, v205
  v_mfma_f32_16x16x32_bf16 v[196:199], a[144:147], a[60:63], v[228:231]
  v_exp_f32_e64 v200, v200
  v_mfma_f32_16x16x32_bf16 v[196:199], a[148:151], a[56:59], v[196:199]
  v_exp_f32_e64 v207, v207
  v_mfma_f32_16x16x32_bf16 v[196:199], a[152:155], a[52:55], v[196:199]
  v_cvt_pk_bf16_f32 v208, v200, v201
  v_cvt_pk_bf16_f32 v211, v206, v207
  v_mfma_f32_16x16x32_bf16 v[196:199], a[156:159], a[48:51], v[196:199]
  v_mul_f32 v200, s29, v192
  v_mul_f32 v201, s29, v193
  v_mfma_f32_16x16x32_bf16 v[64:67], v[208:211], a[160:163], v[64:67]
  v_mul_f32 v202, s29, v194
  v_mul_f32 v203, s29, v195
  v_mfma_f32_16x16x32_bf16 v[68:71], v[208:211], a[164:167], v[68:71]
  s_add_u32 m0, s30, s97
  v_exp_f32 v200, v200
  v_mfma_f32_16x16x32_bf16 v[72:75], v[208:211], a[168:171], v[72:75]
  buffer_load_dwordx4 v221, s[8:11], s33 offen offset:1024 lds
  v_mfma_f32_16x16x32_bf16 v[76:79], v[208:211], a[172:175], v[76:79]
  s_sub_u32 s30, s30, 16896
  v_mul_f32 v205, s29, v197
  v_mul_f32 v207, s29, v199
  v_mfma_f32_16x16x32_bf16 v[80:83], v[208:211], a[176:179], v[80:83]
  s_cselect_b32 s30, s31, s30
  v_mul_f32 v204, s29, v196
  v_mul_f32_e64 v206, s29, v198
  v_mfma_f32_16x16x32_bf16 v[84:87], v[208:211], a[180:183], v[84:87]
  s_add_u32 s59, s59, 8192
  v_exp_f32_e64 v206, v206
  v_mfma_f32_16x16x32_bf16 v[88:91], v[208:211], a[184:187], v[88:91]
  s_xor_b32 s33, s59, s3
  v_exp_f32 v203, v203
  v_mfma_f32_16x16x32_bf16 v[92:95], v[208:211], a[188:191], v[92:95]
  v_exp_f32_e64 v201, v201
  v_mfma_f32_16x16x32_bf16 v[192:195], a[128:131], a[96:99], v[228:231]
  ds_read_b64_tr_b16 a[112:113], v220 offset:4096
  v_cvt_pk_bf16_f32 v212, v200, v201
  v_mfma_f32_16x16x32_bf16 v[192:195], a[132:135], a[100:103], v[192:195]
  v_exp_f32_e64 v204, v204
  v_mfma_f32_16x16x32_bf16 v[192:195], a[136:139], a[104:107], v[192:195]
  v_exp_f32_e64 v205, v205
  v_mfma_f32_16x16x32_bf16 v[192:195], a[140:143], a[108:111], v[192:195]
  v_exp_f32_e64 v202, v202
  v_mfma_f32_16x16x32_bf16 v[196:199], a[144:147], a[108:111], v[228:231]
  v_cvt_pk_bf16_f32 v213, v202, v203
  v_cvt_pk_bf16_f32 v214, v204, v205
  v_mfma_f32_16x16x32_bf16 v[196:199], a[148:151], a[104:107], v[196:199]
  v_exp_f32_e64 v207, v207
  v_mfma_f32_16x16x32_bf16 v[196:199], a[152:155], a[100:103], v[196:199]
  v_cvt_pk_bf16_f32 v215, v206, v207
  v_mul_f32_e64 v203, s29, v195
  v_mfma_f32_16x16x32_bf16 v[196:199], a[156:159], a[96:99], v[196:199]
  v_mul_f32 v201, s29, v193
  v_mul_f32 v202, s29, v194
  v_smfmac_f32_16x16x64_bf16 a[196:199], a[220:223], v[208:215], v254
  ds_read_b64_tr_b16 a[114:115], v220 offset:4160
  ds_read_b64_tr_b16 a[116:117], v220 offset:5120
  v_mfma_f32_16x16x32_bf16 v[96:99], v[212:215], a[160:163], v[96:99]
  v_mul_f32 v200, s29, v192
  v_add_u32 v216, s30, v218
  v_mfma_f32_16x16x32_bf16 v[100:103], v[212:215], a[164:167], v[100:103]
  ds_read_b64_tr_b16 a[118:119], v220 offset:5184
  v_mul_f32_e64 v207, s29, v199
  v_mfma_f32_16x16x32_bf16 v[104:107], v[212:215], a[168:171], v[104:107]
  v_mul_f32 v204, s29, v196
  v_mul_f32 v206, s29, v198
  v_mfma_f32_16x16x32_bf16 v[108:111], v[212:215], a[172:175], v[108:111]
  v_exp_f32_e64 v206, v206
  v_mfma_f32_16x16x32_bf16 v[112:115], v[212:215], a[176:179], v[112:115]
  v_mul_f32 v205, s29, v197
  v_add_u32 v217, s30, v219
  v_mfma_f32_16x16x32_bf16 v[116:119], v[212:215], a[180:183], v[116:119]
  v_exp_f32_e64 v204, v204
  v_mfma_f32_16x16x32_bf16 v[120:123], v[212:215], a[184:187], v[120:123]
  v_exp_f32_e64 v203, v203
  v_mfma_f32_16x16x32_bf16 v[124:127], v[212:215], a[188:191], v[124:127]
  v_exp_f32_e64 v201, v201
  v_mfma_f32_16x16x32_bf16 v[192:195], a[128:131], a[64:67], v[228:231]
  v_exp_f32_e64 v207, v207
  v_mfma_f32_16x16x32_bf16 v[192:195], a[132:135], a[68:71], v[192:195]
  v_cvt_pk_bf16_f32 v211, v206, v207
  v_mfma_f32_16x16x32_bf16 v[192:195], a[136:139], a[72:75], v[192:195]
  v_exp_f32_e64 v200, v200
  v_mfma_f32_16x16x32_bf16 v[192:195], a[140:143], a[76:79], v[192:195]
  v_exp_f32_e64 v202, v202
  v_mfma_f32_16x16x32_bf16 v[196:199], a[144:147], a[76:79], v[228:231]
  v_cvt_pk_bf16_f32 v208, v200, v201
  v_cvt_pk_bf16_f32 v209, v202, v203
  v_mfma_f32_16x16x32_bf16 v[196:199], a[148:151], a[72:75], v[196:199]
  v_exp_f32_e64 v205, v205
  v_mfma_f32_16x16x32_bf16 v[196:199], a[152:155], a[68:71], v[196:199]
  v_cvt_pk_bf16_f32 v210, v204, v205
  v_mul_f32_e64 v202, s29, v194
  v_mfma_f32_16x16x32_bf16 v[196:199], a[156:159], a[64:67], v[196:199]
  v_mul_f32 v201, s29, v193
  v_mul_f32 v203, s29, v195
  v_mfma_f32_16x16x32_bf16 a[204:207], a[220:223], v[208:211], a[204:207]
  s_waitcnt lgkmcnt(0)
  v_mul_f32 v200, s29, v192
  v_mfma_f32_16x16x32_bf16 a[224:227], v[208:211], a[160:163], a[224:227]
  buffer_store_dwordx4 a[116:119], v233, s[16:19], s35 offen offset:1024 sc1
  v_exp_f32_e64 v202, v202
  v_mfma_f32_16x16x32_bf16 a[228:231], v[208:211], a[164:167], a[228:231]
  v_mul_f32 v204, s29, v196
  v_mul_f32 v206, s29, v198
  v_mfma_f32_16x16x32_bf16 a[232:235], v[208:211], a[168:171], a[232:235]
  v_mul_f32 v205, s29, v197
  v_mul_f32 v207, s29, v199
  v_mfma_f32_16x16x32_bf16 a[236:239], v[208:211], a[172:175], a[236:239]
  v_exp_f32_e64 v201, v201
  v_mfma_f32_16x16x32_bf16 a[240:243], v[208:211], a[176:179], a[240:243]
  buffer_store_dwordx4 a[112:115], v233, s[16:19], s35 offen sc1
  v_exp_f32_e64 v200, v200
  v_mfma_f32_16x16x32_bf16 a[244:247], v[208:211], a[180:183], a[244:247]
  s_add_u32 s35, s35, 2048
  v_exp_f32_e64 v206, v206
  v_mfma_f32_16x16x32_bf16 a[248:251], v[208:211], a[184:187], a[248:251]
  v_exp_f32_e64 v203, v203
  v_mfma_f32_16x16x32_bf16 a[252:255], v[208:211], a[188:191], a[252:255]
  v_exp_f32_e64 v205, v205
  v_mfma_f32_16x16x32_bf16 v[192:195], a[128:131], a[80:83], v[228:231]
  ds_read_b128 a[128:131], v216 offset:0
  v_cvt_pk_bf16_f32 v209, v202, v203
  v_mfma_f32_16x16x32_bf16 v[192:195], a[132:135], a[84:87], v[192:195]
  v_exp_f32_e64 v204, v204
  v_mfma_f32_16x16x32_bf16 v[192:195], a[136:139], a[88:91], v[192:195]
  ds_read_b128 a[132:135], v216 offset:64
  ds_read_b128 a[136:139], v216 offset:128
  v_mfma_f32_16x16x32_bf16 v[192:195], a[140:143], a[92:95], v[192:195]
  v_cvt_pk_bf16_f32 v208, v200, v201
  v_cvt_pk_bf16_f32 v210, v204, v205
  v_mfma_f32_16x16x32_bf16 v[196:199], a[144:147], a[92:95], v[228:231]
  ds_read_b128 a[140:143], v216 offset:192
  ds_read_b128 a[144:147], v216 offset:704
  v_mfma_f32_16x16x32_bf16 v[196:199], a[148:151], a[88:91], v[196:199]
  v_exp_f32_e64 v207, v207
  v_mfma_f32_16x16x32_bf16 v[196:199], a[152:155], a[84:87], v[196:199]
  ds_read_b128 a[148:151], v216 offset:640
  v_cvt_pk_bf16_f32 v211, v206, v207
  v_mfma_f32_16x16x32_bf16 v[196:199], a[156:159], a[80:83], v[196:199]
  v_mul_f32 v201, s29, v193
  v_mul_f32 v203, s29, v195
  v_mfma_f32_16x16x32_bf16 v[128:131], v[208:211], a[160:163], v[128:131]
  ds_read_b128 a[152:155], v216 offset:576
  ds_read_b128 a[156:159], v216 offset:512
  v_mfma_f32_16x16x32_bf16 v[132:135], v[208:211], a[164:167], v[132:135]
  v_mul_f32 v200, s29, v192
  v_mul_f32 v202, s29, v194
  v_mfma_f32_16x16x32_bf16 v[136:139], v[208:211], a[168:171], v[136:139]
  v_exp_f32_e64 v200, v200
  v_mfma_f32_16x16x32_bf16 v[140:143], v[208:211], a[172:175], v[140:143]
  v_exp_f32_e64 v202, v202
  v_mfma_f32_16x16x32_bf16 v[144:147], v[208:211], a[176:179], v[144:147]
  v_exp_f32_e64 v201, v201
  v_mfma_f32_16x16x32_bf16 v[148:151], v[208:211], a[180:183], v[148:151]
  s_sub_u32 s37, s37, 1
  v_mul_f32 v204, s29, v196
  v_mul_f32_e64 v205, s29, v197
  v_mfma_f32_16x16x32_bf16 v[152:155], v[208:211], a[184:187], v[152:155]
  s_waitcnt lgkmcnt(2)
  v_exp_f32 v203, v203
  v_mfma_f32_16x16x32_bf16 v[156:159], v[208:211], a[188:191], v[156:159]
  s_cbranch_scc1 L_exitC
  v_mul_f32 v206, s29, v198
  v_mul_f32_e64 v207, s29, v199
  v_mfma_f32_16x16x32_bf16 v[192:195], a[128:131], a[0:3], v[228:231]
  v_exp_f32_e64 v207, v207
  v_mfma_f32_16x16x32_bf16 v[192:195], a[132:135], a[4:7], v[192:195]
  v_exp_f32_e64 v204, v204
  v_mfma_f32_16x16x32_bf16 v[192:195], a[136:139], a[8:11], v[192:195]
  v_exp_f32_e64 v205, v205
  v_mfma_f32_16x16x32_bf16 v[192:195], a[140:143], a[12:15], v[192:195]
  v_cvt_pk_bf16_f32 v212, v200, v201
  v_cvt_pk_bf16_f32 v214, v204, v205
  v_mfma_f32_16x16x32_bf16 v[196:199], a[144:147], a[12:15], v[228:231]
  v_exp_f32_e64 v206, v206
  v_mfma_f32_16x16x32_bf16 v[196:199], a[148:151], a[8:11], v[196:199]
  s_waitcnt lgkmcnt(0)
  v_cvt_pk_bf16_f32 v213, v202, v203
  v_cvt_pk_bf16_f32 v215, v206, v207
  v_mfma_f32_16x16x32_bf16 v[196:199], a[152:155], a[4:7], v[196:199]
  v_mul_f32 v200, s29, v192
  v_mul_f32_e64 v202, s29, v194
  v_mfma_f32_16x16x32_bf16 v[196:199], a[156:159], a[0:3], v[196:199]
  v_mul_f32 v201, s29, v193
  v_mul_f32 v203, s29, v195
  v_mfma_f32_16x16x32_bf16 v[160:163], v[212:215], a[160:163], v[160:163]
  ds_read_b64_tr_b16 a[160:161], v217 offset:8448
  ds_read_b64_tr_b16 a[162:163], v217 offset:8960
  v_mfma_f32_16x16x32_bf16 v[164:167], v[212:215], a[164:167], v[164:167]
  v_exp_f32_e64 v203, v203
  v_mfma_f32_16x16x32_bf16 v[168:171], v[212:215], a[168:171], v[168:171]
  ds_read_b64_tr_b16 a[164:165], v217 offset:8464
  ds_read_b64_tr_b16 a[166:167], v217 offset:8976
  v_mfma_f32_16x16x32_bf16 v[172:175], v[212:215], a[172:175], v[172:175]
  v_exp_f32_e64 v201, v201
  v_mfma_f32_16x16x32_bf16 v[176:179], v[212:215], a[176:179], v[176:179]
  ds_read_b64_tr_b16 a[168:169], v217 offset:8480
  ds_read_b64_tr_b16 a[174:175], v217 offset:9008
  v_mfma_f32_16x16x32_bf16 v[180:183], v[212:215], a[180:183], v[180:183]
  v_mul_f32 v206, s29, v198
  v_mul_f32 v207, s29, v199
  v_mfma_f32_16x16x32_bf16 v[184:187], v[212:215], a[184:187], v[184:187]
  ds_read_b64_tr_b16 a[170:171], v217 offset:8992
  ds_read_b64_tr_b16 a[172:173], v217 offset:8496
  v_mfma_f32_16x16x32_bf16 v[188:191], v[212:215], a[188:191], v[188:191]
  v_exp_f32_e64 v202, v202
  v_smfmac_f32_16x16x64_bf16 a[200:203], a[220:223], v[208:215], v254
  v_exp_f32 v200, v200
  v_mul_f32 v204, s29, v196
  v_mul_f32_e64 v205, s29, v197
L_pC0:
  v_mfma_f32_16x16x32_bf16 v[192:195], a[128:131], a[16:19], v[228:231]
  ds_read_b64_tr_b16 a[176:177], v217 offset:8512
  ds_read_b64_tr_b16 a[178:179], v217 offset:9024
  v_mfma_f32_16x16x32_bf16 v[192:195], a[132:135], a[20:23], v[192:195]
  v_exp_f32_e64 v206, v206
  v_mfma_f32_16x16x32_bf16 v[192:195], a[136:139], a[24:27], v[192:195]
  ds_read_b64_tr_b16 a[180:181], v217 offset:8528
  ds_read_b64_tr_b16 a[182:183], v217 offset:9040
  v_mfma_f32_16x16x32_bf16 v[192:195], a[140:143], a[28:31], v[192:195]
  v_exp_f32_e64 v205, v205
  v_mfma_f32_16x16x32_bf16 v[196:199], a[144:147], a[28:31], v[228:231]
  ds_read_b64_tr_b16 a[184:185], v217 offset:8544
  ds_read_b64_tr_b16 a[186:187], v217 offset:9056
  v_mfma_f32_16x16x32_bf16 v[196:199], a[148:151], a[24:27], v[196:199]
  v_exp_f32 v204, v204
  v_exp_f32 v207, v207
  v_mfma_f32_16x16x32_bf16 v[196:199], a[152:155], a[20:23], v[196:199]
  s_waitcnt lgkmcnt(6)
  v_cvt_pk_bf16_f32 v208, v200, v201
  v_cvt_pk_bf16_f32 v209, v202, v203
  v_cvt_pk_bf16_f32 v210, v204, v205
  v_cvt_pk_bf16_f32 v211, v206, v207
  v_mfma_f32_16x16x32_bf16 v[196:199], a[156:159], a[16:19], v[196:199]
  ds_read_b64_tr_b16 a[188:189], v217 offset:8560
  ds_read_b64_tr_b16 a[190:191], v217 offset:9072
  v_mfma_f32_16x16x32_bf16 v[0:3], v[208:211], a[160:163], v[0:3]
  v_mul_f32 v201, s29, v193
  v_mul_f32_e64 v203, s29, v195
  v_mfma_f32_16x16x32_bf16 v[4:7], v[208:211], a[164:167], v[4:7]
  v_mul_f32 v200, s29, v192
  v_mul_f32 v202, s29, v194
  v_mfma_f32_16x16x32_bf16 v[8:11], v[208:211], a[168:171], v[8:11]
  v_mul_f32 v204, s29, v196
  v_mul_f32 v206, s29, v198
  v_mfma_f32_16x16x32_bf16 v[12:15], v[208:211], a[172:175], v[12:15]
  s_waitcnt lgkmcnt(4)
  v_mul_f32 v205, s29, v197
  v_mul_f32_e64 v207, s29, v199
  v_mfma_f32_16x16x32_bf16 v[16:19], v[208:211], a[176:179], v[16:19]
  v_exp_f32_e64 v202, v202
  v_mfma_f32_16x16x32_bf16 v[20:23], v[208:211], a[180:183], v[20:23]
  s_waitcnt lgkmcnt(2)
  v_exp_f32 v204, v204
  v_mfma_f32_16x16x32_bf16 v[24:27], v[208:211], a[184:187], v[24:27]
  s_waitcnt lgkmcnt(0)
  v_exp_f32 v201, v201
  v_mfma_f32_16x16x32_bf16 v[28:31], v[208:211], a[188:191], v[28:31]
  v_exp_f32_e64 v206, v206
  v_mfma_f32_16x16x32_bf16 v[192:195], a[128:131], a[32:35], v[228:231]
  v_exp_f32_e64 v207, v207
  v_mfma_f32_16x16x32_bf16 v[192:195], a[132:135], a[36:39], v[192:195]
  v_exp_f32_e64 v203, v203
  v_mfma_f32_16x16x32_bf16 v[192:195], a[136:139], a[40:43], v[192:195]
  v_exp_f32_e64 v205, v205
  v_mfma_f32_16x16x32_bf16 v[192:195], a[140:143], a[44:47], v[192:195]
  s_waitcnt vmcnt(8)
  v_exp_f32 v200, v200
  v_mfma_f32_16x16x32_bf16 v[196:199], a[144:147], a[44:47], v[228:231]
  s_barrier
  v_cvt_pk_bf16_f32 v213, v202, v203
  v_mfma_f32_16x16x32_bf16 v[196:199], a[148:151], a[40:43], v[196:199]
  v_cvt_pk_bf16_f32 v214, v204, v205
  v_cvt_pk_bf16_f32 v215, v206, v207
  v_mfma_f32_16x16x32_bf16 v[196:199], a[152:155], a[36:39], v[196:199]
  v_cvt_pk_bf16_f32 v212, v200, v201
  v_mul_f32 v200, s29, v192
  v_mfma_f32_16x16x32_bf16 v[196:199], a[156:159], a[32:35], v[196:199]
  s_mov_b32 m0, s30
  v_mul_f32 v201, s29, v193
  v_mul_f32_e64 v202, s29, v194
  v_smfmac_f32_16x16x64_bf16 a[192:195], a[220:223], v[208:215], v254
  buffer_load_dwordx4 v221, s[4:7], s33 offen lds
  v_mfma_f32_16x16x32_bf16 v[32:35], v[212:215], a[160:163], v[32:35]
  v_mul_f32_e64 v203, s29, v195
  v_add_u32 v220, 6144, v220
  v_mfma_f32_16x16x32_bf16 v[36:39], v[212:215], a[164:167], v[36:39]
  v_mul_f32 v206, s29, v198
  v_mul_f32 v207, s29, v199
  v_mfma_f32_16x16x32_bf16 v[40:43], v[212:215], a[168:171], v[40:43]
  s_add_u32 m0, s30, 32
  v_mul_f32 v204, s29, v196
  v_mul_f32_e64 v205, s29, v197
  v_mfma_f32_16x16x32_bf16 v[44:47], v[212:215], a[172:175], v[44:47]
  buffer_load_dwordx4 v221, s[4:7], s33 offen offset:1024 lds
  v_mfma_f32_16x16x32_bf16 v[48:51], v[212:215], a[176:179], v[48:51]
  v_exp_f32_e64 v200, v200
  v_mfma_f32_16x16x32_bf16 v[52:55], v[212:215], a[180:183], v[52:55]
  v_exp_f32_e64 v201, v201
  v_mfma_f32_16x16x32_bf16 v[56:59], v[212:215], a[184:187], v[56:59]
  s_add_u32 m0, s30, s96
  v_exp_f32 v206, v206
  v_mfma_f32_16x16x32_bf16 v[60:63], v[212:215], a[188:191], v[60:63]
  buffer_load_dwordx4 v221, s[8:11], s33 offen lds
  v_mfma_f32_16x16x32_bf16 v[192:195], a[128:131], a[48:51], v[228:231]
  v_exp_f32_e64 v202, v202
  v_mfma_f32_16x16x32_bf16 v[192:195], a[132:135], a[52:55], v[192:195]
  v_exp_f32_e64 v205, v205
  v_mfma_f32_16x16x32_bf16 v[192:195], a[136:139], a[56:59], v[192:195]
  v_exp_f32_e64 v203, v203
  v_mfma_f32_16x16x32_bf16 v[192:195], a[140:143], a[60:63], v[192:195]
  v_exp_f32_e64 v204, v204
  v_mfma_f32_16x16x32_bf16 v[196:199], a[144:147], a[60:63], v[228:231]
  v_exp_f32_e64 v207, v207
  v_mfma_f32_16x16x32_bf16 v[196:199], a[148:151], a[56:59], v[196:199]
  v_cvt_pk_bf16_f32 v210, v204, v205
  v_cvt_pk_bf16_f32 v211, v206, v207
  v_mfma_f32_16x16x32_bf16 v[196:199], a[152:155], a[52:55], v[196:199]
  s_add_u32 m0, s30, s97
  v_cvt_pk_bf16_f32 v208, v200, v201
  v_cvt_pk_bf16_f32 v209, v202, v203
  v_mfma_f32_16x16x32_bf16 v[196:199], a[156:159], a[48:51], v[196:199]
  buffer_load_dwordx4 v221, s[8:11], s33 offen offset:1024 lds
  v_mfma_f32_16x16x32_bf16 v[64:67], v[208:211], a[160:163], v[64:67]
  s_sub_u32 s30, s30, 16896
  v_mul_f32 v201, s29, v193
  v_mul_f32_e64 v203, s29, v195
  v_mfma_f32_16x16x32_bf16 v[68:71], v[208:211], a[164:167], v[68:71]
  s_cselect_b32 s30, s31, s30
  v_mul_f32 v200, s29, v192
  v_mul_f32_e64 v202, s29, v194
  v_mfma_f32_16x16x32_bf16 v[72:75], v[208:211], a[168:171], v[72:75]
  s_add_u32 s59, s59, 8192
  v_mul_f32 v206, s29, v198
  v_mul_f32 v207, s29, v199
  v_mfma_f32_16x16x32_bf16 v[76:79], v[208:211], a[172:175], v[76:79]
  s_xor_b32 s33, s59, s3
  v_mul_f32 v204, s29, v196
  v_mul_f32_e64 v205, s29, v197
  v_mfma_f32_16x16x32_bf16 v[80:83], v[208:211], a[176:179], v[80:83]
  v_exp_f32_e64 v201, v201
  v_mfma_f32_16x16x32_bf16 v[84:87], v[208:211], a[180:183], v[84:87]
  v_exp_f32_e64 v205, v205
  v_mfma_f32_16x16x32_bf16 v[88:91], v[208:211], a[184:187], v[88:91]
  v_exp_f32_e64 v207, v207
  v_mfma_f32_16x16x32_bf16 v[92:95], v[208:211], a[188:191], v[92:95]
  v_exp_f32_e64 v206, v206
  v_mfma_f32_16x16x32_bf16 v[192:195], a[128:131], a[96:99], v[228:231]
  v_exp_f32_e64 v203, v203
  v_mfma_f32_16x16x32_bf16 v[192:195], a[132:135], a[100:103], v[192:195]
  v_exp_f32_e64 v202, v202
  v_mfma_f32_16x16x32_bf16 v[192:195], a[136:139], a[104:107], v[192:195]
  v_exp_f32_e64 v204, v204
  v_mfma_f32_16x16x32_bf16 v[192:195], a[140:143], a[108:111], v[192:195]
  v_exp_f32_e64 v200, v200
  v_mfma_f32_16x16x32_bf16 v[196:199], a[144:147], a[108:111], v[228:231]
  v_cvt_pk_bf16_f32 v213, v202, v203
  v_cvt_pk_bf16_f32 v215, v206, v207
  v_mfma_f32_16x16x32_bf16 v[196:199], a[148:151], a[104:107], v[196:199]
  v_cvt_pk_bf16_f32 v212, v200, v201
  v_cvt_pk_bf16_f32 v214, v204, v205
  v_mfma_f32_16x16x32_bf16 v[196:199], a[152:155], a[100:103], v[196:199]
  v_mul_f32 v200, s29, v192
  v_mul_f32 v201, s29, v193
  v_mfma_f32_16x16x32_bf16 v[196:199], a[156:159], a[96:99], v[196:199]
  v_mul_f32 v202, s29, v194
  v_mul_f32 v203, s29, v195
  v_smfmac_f32_16x16x64_bf16 a[196:199], a[220:223], v[208:215], v254
  v_add_u32_e64 v216, s30, v218
  v_mfma_f32_16x16x32_bf16 v[96:99], v[212:215], a[160:163], v[96:99]
  v_exp_f32_e64 v201, v201
  v_mfma_f32_16x16x32_bf16 v[100:103], v[212:215], a[164:167], v[100:103]
  v_mul_f32 v206, s29, v198
  v_mul_f32 v207, s29, v199
  v_mfma_f32_16x16x32_bf16 v[104:107], v[212:215], a[168:171], v[104:107]
  v_mul_f32 v204, s29, v196
  v_mul_f32 v205, s29, v197
  v_mfma_f32_16x16x32_bf16 v[108:111], v[212:215], a[172:175], v[108:111]
  v_exp_f32_e64 v204, v204
  v_mfma_f32_16x16x32_bf16 v[112:115], v[212:215], a[176:179], v[112:115]
  v_exp_f32_e64 v206, v206
  v_mfma_f32_16x16x32_bf16 v[116:119], v[212:215], a[180:183], v[116:119]
  v_exp_f32_e64 v200, v200
  v_mfma_f32_16x16x32_bf16 v[120:123], v[212:215], a[184:187], v[120:123]
  v_exp_f32_e64 v205, v205
  v_mfma_f32_16x16x32_bf16 v[124:127], v[212:215], a[188:191], v[124:127]
  v_exp_f32_e64 v202, v202
  v_mfma_f32_16x16x32_bf16 v[192:195], a[128:131], a[64:67], v[228:231]
  v_exp_f32_e64 v207, v207
  v_mfma_f32_16x16x32_bf16 v[192:195], a[132:135], a[68:71], v[192:195]
  v_exp_f32_e64 v203, v203
  v_mfma_f32_16x16x32_bf16 v[192:195], a[136:139], a[72:75], v[192:195]
  v_cvt_pk_bf16_f32 v209, v202, v203
  v_cvt_pk_bf16_f32 v210, v204, v205
  v_mfma_f32_16x16x32_bf16 v[192:195], a[140:143], a[76:79], v[192:195]
  v_cvt_pk_bf16_f32 v208, v200, v201
  v_cvt_pk_bf16_f32 v211, v206, v207
  v_mfma_f32_16x16x32_bf16 v[196:199], a[144:147], a[76:79], v[228:231]
  v_add_u32_e64 v217, s30, v219
  v_mfma_f32_16x16x32_bf16 v[196:199], a[148:151], a[72:75], v[196:199]
  v_mfma_f32_16x16x32_bf16 v[196:199], a[152:155], a[68:71], v[196:199]
  global_load_dword a120, v[252:253], off
  v_mfma_f32_16x16x32_bf16 v[196:199], a[156:159], a[64:67], v[196:199]
  v_mul_f32 v200, s29, v192
  v_mul_f32 v202, s29, v194
  v_mfma_f32_16x16x32_bf16 a[204:207], a[220:223], v[208:211], a[204:207]
  v_mul_f32 v201, s29, v193
  v_mul_f32 v203, s29, v195
  v_mfma_f32_16x16x32_bf16 a[224:227], v[208:211], a[160:163], a[224:227]
  v_exp_f32_e64 v203, v203
  v_mfma_f32_16x16x32_bf16 a[228:231], v[208:211], a[164:167], a[228:231]
  v_mul_f32 v206, s29, v198
  v_mul_f32 v207, s29, v199
  v_mfma_f32_16x16x32_bf16 a[232:235], v[208:211], a[168:171], a[232:235]
  v_mul_f32 v204, s29, v196
  v_mul_f32 v205, s29, v197
  v_mfma_f32_16x16x32_bf16 a[236:239], v[208:211], a[172:175], a[236:239]
  v_exp_f32_e64 v201, v201
  v_mfma_f32_16x16x32_bf16 a[240:243], v[208:211], a[176:179], a[240:243]
  v_exp_f32_e64 v205, v205
  v_mfma_f32_16x16x32_bf16 a[244:247], v[208:211], a[180:183], a[244:247]
  v_exp_f32_e64 v204, v204
  v_mfma_f32_16x16x32_bf16 a[248:251], v[208:211], a[184:187], a[248:251]
  v_exp_f32_e64 v202, v202
  v_mfma_f32_16x16x32_bf16 a[252:255], v[208:211], a[188:191], a[252:255]
  v_exp_f32_e64 v206, v206
  v_mfma_f32_16x16x32_bf16 v[192:195], a[128:131], a[80:83], v[228:231]
  v_exp_f32_e64 v200, v200
  v_mfma_f32_16x16x32_bf16 v[192:195], a[132:135], a[84:87], v[192:195]
  ds_read_b128 a[128:131], v216 offset:0
  ds_read_b128 a[132:135], v216 offset:64
  v_mfma_f32_16x16x32_bf16 v[192:195], a[136:139], a[88:91], v[192:195]
  v_exp_f32_e64 v207, v207
  v_mfma_f32_16x16x32_bf16 v[192:195], a[140:143], a[92:95], v[192:195]
  ds_read_b128 a[136:139], v216 offset:128
  ds_read_b128 a[140:143], v216 offset:192
  v_mfma_f32_16x16x32_bf16 v[196:199], a[144:147], a[92:95], v[228:231]
  v_cvt_pk_bf16_f32 v208, v200, v201
  v_cvt_pk_bf16_f32 v209, v202, v203
  v_mfma_f32_16x16x32_bf16 v[196:199], a[148:151], a[88:91], v[196:199]
  ds_read_b128 a[144:147], v216 offset:704
  ds_read_b128 a[148:151], v216 offset:640
  v_mfma_f32_16x16x32_bf16 v[196:199], a[152:155], a[84:87], v[196:199]
  v_cvt_pk_bf16_f32 v210, v204, v205
  v_cvt_pk_bf16_f32 v211, v206, v207
  v_mfma_f32_16x16x32_bf16 v[196:199], a[156:159], a[80:83], v[196:199]
  ds_read_b128 a[152:155], v216 offset:576
  ds_read_b128 a[156:159], v216 offset:512
  v_mfma_f32_16x16x32_bf16 v[128:131], v[208:211], a[160:163], v[128:131]
  v_mul_f32 v202, s29, v194
  v_mul_f32 v203, s29, v195
  v_mfma_f32_16x16x32_bf16 v[132:135], v[208:211], a[164:167], v[132:135]
  v_mul_f32 v200, s29, v192
  v_mul_f32 v201, s29, v193
  v_mfma_f32_16x16x32_bf16 v[136:139], v[208:211], a[168:171], v[136:139]
  v_exp_f32_e64 v200, v200
  v_mfma_f32_16x16x32_bf16 v[140:143], v[208:211], a[172:175], v[140:143]
  v_exp_f32_e64 v201, v201
  v_mfma_f32_16x16x32_bf16 v[144:147], v[208:211], a[176:179], v[144:147]
  v_mul_f32 v204, s29, v196
  v_mul_f32 v205, s29, v197
  v_mfma_f32_16x16x32_bf16 v[148:151], v[208:211], a[180:183], v[148:151]
  s_sub_u32 s37, s37, 1
  v_exp_f32 v203, v203
  v_mfma_f32_16x16x32_bf16 v[152:155], v[208:211], a[184:187], v[152:155]
  s_waitcnt lgkmcnt(2)
  v_exp_f32 v202, v202
  v_mfma_f32_16x16x32_bf16 v[156:159], v[208:211], a[188:191], v[156:159]
  s_cbranch_scc1 L_exitC
  v_mul_f32 v206, s29, v198
  v_mul_f32_e64 v207, s29, v199
  v_mfma_f32_16x16x32_bf16 v[192:195], a[128:131], a[0:3], v[228:231]
  v_exp_f32_e64 v204, v204
  v_mfma_f32_16x16x32_bf16 v[192:195], a[132:135], a[4:7], v[192:195]
  v_exp_f32_e64 v206, v206
  v_mfma_f32_16x16x32_bf16 v[192:195], a[136:139], a[8:11], v[192:195]
  v_exp_f32_e64 v207, v207
  v_mfma_f32_16x16x32_bf16 v[192:195], a[140:143], a[12:15], v[192:195]
  v_exp_f32_e64 v205, v205
  v_mfma_f32_16x16x32_bf16 v[196:199], a[144:147], a[12:15], v[228:231]
  v_cvt_pk_bf16_f32 v212, v200, v201
  v_cvt_pk_bf16_f32 v215, v206, v207
  v_mfma_f32_16x16x32_bf16 v[196:199], a[148:151], a[8:11], v[196:199]
  s_waitcnt lgkmcnt(0)
  v_cvt_pk_bf16_f32 v213, v202, v203
  v_cvt_pk_bf16_f32 v214, v204, v205
  v_mfma_f32_16x16x32_bf16 v[196:199], a[152:155], a[4:7], v[196:199]
  v_mul_f32 v200, s29, v192
  v_mul_f32_e64 v201, s29, v193
  v_mfma_f32_16x16x32_bf16 v[196:199], a[156:159], a[0:3], v[196:199]
  v_mul_f32 v202, s29, v194
  v_mul_f32 v203, s29, v195
  v_mfma_f32_16x16x32_bf16 v[160:163], v[212:215], a[160:163], v[160:163]
  v_exp_f32_e64 v203, v203
  v_mfma_f32_16x16x32_bf16 v[164:167], v[212:215], a[164:167], v[164:167]
  ds_read_b64_tr_b16 a[160:161], v217 offset:8448
  ds_read_b64_tr_b16 a[162:163], v217 offset:8960
  v_mfma_f32_16x16x32_bf16 v[168:171], v[212:215], a[168:171], v[168:171]
  v_mul_f32 v204, s29, v196
  v_mul_f32 v206, s29, v198
  v_mfma_f32_16x16x32_bf16 v[172:175], v[212:215], a[172:175], v[172:175]
  ds_read_b64_tr_b16 a[168:169], v217 offset:8480
  ds_read_b64_tr_b16 a[174:175], v217 offset:9008
  v_mfma_f32_16x16x32_bf16 v[176:179], v[212:215], a[176:179], v[176:179]
  v_exp_f32_e64 v201, v201
  v_mfma_f32_16x16x32_bf16 v[180:183], v[212:215], a[180:183], v[180:183]
  ds_read_b64_tr_b16 a[166:167], v217 offset:8976
  ds_read_b64_tr_b16 a[170:171], v217 offset:8992
  v_mfma_f32_16x16x32_bf16 v[184:187], v[212:215], a[184:187], v[184:187]
  v_mul_f32 v205, s29, v197
  v_mul_f32 v207, s29, v199
  v_mfma_f32_16x16x32_bf16 v[188:191], v[212:215], a[188:191], v[188:191]
  ds_read_b64_tr_b16 a[164:165], v217 offset:8464
  ds_read_b64_tr_b16 a[172:173], v217 offset:8496
  v_smfmac_f32_16x16x64_bf16 a[200:203], a[220:223], v[208:215], v254
  v_exp_f32 v200, v200
  v_exp_f32 v202, v202
  s_branch L_pC1
  .p2align 6
L_pD1:
  v_mfma_f32_16x16x32_bf16 v[192:195], a[128:131], a[16:19], v[228:231]
  ds_read_b64_tr_b16 a[176:177], v217 offset:8512
  ds_read_b64_tr_b16 a[178:179], v217 offset:9024
  v_mfma_f32_16x16x32_bf16 v[192:195], a[132:135], a[20:23], v[192:195]
  v_exp_f32_e64 v207, v207
  v_mfma_f32_16x16x32_bf16 v[192:195], a[136:139], a[24:27], v[192:195]
  v_exp_f32_e64 v204, v204
  v_mfma_f32_16x16x32_bf16 v[192:195], a[140:143], a[28:31], v[192:195]
  v_exp_f32_e64 v205, v205
  v_mfma_f32_16x16x32_bf16 v[196:199], a[144:147], a[28:31], v[228:231]
  s_waitcnt lgkmcnt(2)
  v_exp_f32 v206, v206
  v_mfma_f32_16x16x32_bf16 v[196:199], a[148:151], a[24:27], v[196:199]
  ds_read_b64_tr_b16 a[182:183], v217 offset:9040
  v_cvt_pk_bf16_f32 v208, v200, v201
  v_mfma_f32_16x16x32_bf16 v[196:199], a[152:155], a[20:23], v[196:199]
  ds_read_b64_tr_b16 a[180:181], v217 offset:8528
  v_cvt_pk_bf16_f32 v209, v202, v203
  v_cvt_pk_bf16_f32 v210, v204, v205
  v_cvt_pk_bf16_f32 v211, v206, v207
  v_mfma_f32_16x16x32_bf16 v[196:199], a[156:159], a[16:19], v[196:199]
  ds_read_b64_tr_b16 a[184:185], v217 offset:8544
  ds_read_b64_tr_b16 a[186:187], v217 offset:9056
  v_mfma_f32_16x16x32_bf16 v[0:3], v[208:211], a[160:163], v[0:3]
  ds_read_b64_tr_b16 a[188:189], v217 offset:8560
  ds_read_b64_tr_b16 a[190:191], v217 offset:9072
  v_mfma_f32_16x16x32_bf16 v[4:7], v[208:211], a[164:167], v[4:7]
  v_mul_f32 v202, s29, v194
  v_mul_f32 v203, s29, v195
  v_mfma_f32_16x16x32_bf16 v[8:11], v[208:211], a[168:171], v[8:11]
  v_mul_f32 v200, s29, v192
  v_mul_f32 v201, s29, v193
  v_mfma_f32_16x16x32_bf16 v[12:15], v[208:211], a[172:175], v[12:15]
  s_waitcnt lgkmcnt(6)
  v_mul_f32 v206, s29, v198
  v_mul_f32_e64 v207, s29, v199
  v_mfma_f32_16x16x32_bf16 v[16:19], v[208:211], a[176:179], v[16:19]
  s_waitcnt lgkmcnt(4)
  v_mul_f32 v204, s29, v196
  v_mul_f32_e64 v205, s29, v197
  v_mfma_f32_16x16x32_bf16 v[20:23], v[208:211], a[180:183], v[20:23]
  s_waitcnt lgkmcnt(2)
  v_exp_f32 v205, v205
  v_mfma_f32_16x16x32_bf16 v[24:27], v[208:211], a[184:187], v[24:27]
  s_waitcnt lgkmcnt(0)
  v_exp_f32 v207, v207
  v_mfma_f32_16x16x32_bf16 v[28:31], v[208:211], a[188:191], v[28:31]
  v_exp_f32_e64 v201, v201
  v_mfma_f32_16x16x32_bf16 v[192:195], a[128:131], a[32:35], v[228:231]
  v_exp_f32_e64 v203, v203
  v_mfma_f32_16x16x32_bf16 v[192:195], a[132:135], a[36:39], v[192:195]
  v_exp_f32_e64 v206, v206
  v_mfma_f32_16x16x32_bf16 v[192:195], a[136:139], a[40:43], v[192:195]
  s_waitcnt vmcnt(6)
  v_exp_f32 v204, v204
  v_mfma_f32_16x16x32_bf16 v[192:195], a[140:143], a[44:47], v[192:195]
  s_barrier
  v_cvt_pk_bf16_f32 v215, v206, v207
  v_mfma_f32_16x16x32_bf16 v[196:199], a[144:147], a[44:47], v[228:231]
  v_exp_f32 v200, v200
  v_mfma_f32_16x16x32_bf16 v[196:199], a[148:151], a[40:43], v[196:199]
  v_exp_f32_e64 v202, v202
  v_mfma_f32_16x16x32_bf16 v[196:199], a[152:155], a[36:39], v[196:199]
  s_mov_b32 m0, s30
  v_cvt_pk_bf16_f32 v212, v200, v201
  v_cvt_pk_bf16_f32 v213, v202, v203
  v_cvt_pk_bf16_f32 v214, v204, v205
  v_mfma_f32_16x16x32_bf16 v[196:199], a[156:159], a[32:35], v[196:199]
  buffer_load_dwordx4 v221, s[4:7], s33 offen lds
  v_smfmac_f32_16x16x64_bf16 a[192:195], a[220:223], v[208:215], v254
  ds_read_b64_tr_b16 a[112:113], v220 offset:0
  v_mul_f32 v202, s29, v194
  v_mfma_f32_16x16x32_bf16 v[32:35], v[212:215], a[160:163], v[32:35]
  ds_read_b64_tr_b16 a[114:115], v220 offset:64
  v_mul_f32_e64 v201, s29, v193
  v_mfma_f32_16x16x32_bf16 v[36:39], v[212:215], a[164:167], v[36:39]
  ds_read_b64_tr_b16 a[116:117], v220 offset:1024
  ds_read_b64_tr_b16 a[118:119], v220 offset:1088
  v_mfma_f32_16x16x32_bf16 v[40:43], v[212:215], a[168:171], v[40:43]
  v_mul_f32 v200, s29, v192
  v_mul_f32 v203, s29, v195
  v_mfma_f32_16x16x32_bf16 v[44:47], v[212:215], a[172:175], v[44:47]
  v_mul_f32 v206, s29, v198
  v_mul_f32 v207, s29, v199
  v_mfma_f32_16x16x32_bf16 v[48:51], v[212:215], a[176:179], v[48:51]
  s_add_u32 m0, s30, 32
  v_mul_f32 v204, s29, v196
  v_mul_f32_e64 v205, s29, v197
  v_mfma_f32_16x16x32_bf16 v[52:55], v[212:215], a[180:183], v[52:55]
  buffer_load_dwordx4 v221, s[4:7], s33 offen offset:1024 lds
  v_mfma_f32_16x16x32_bf16 v[56:59], v[212:215], a[184:187], v[56:59]
  v_exp_f32_e64 v205, v205
  v_mfma_f32_16x16x32_bf16 v[60:63], v[212:215], a[188:191], v[60:63]
  v_exp_f32_e64 v203, v203
  v_mfma_f32_16x16x32_bf16 v[192:195], a[128:131], a[48:51], v[228:231]
  v_exp_f32_e64 v202, v202
  v_mfma_f32_16x16x32_bf16 v[192:195], a[132:135], a[52:55], v[192:195]
  v_exp_f32_e64 v201, v201
  v_mfma_f32_16x16x32_bf16 v[192:195], a[136:139], a[56:59], v[192:195]
  v_exp_f32_e64 v204, v204
  v_mfma_f32_16x16x32_bf16 v[192:195], a[140:143], a[60:63], v[192:195]
  v_exp_f32_e64 v200, v200
  v_mfma_f32_16x16x32_bf16 v[196:199], a[144:147], a[60:63], v[228:231]
  v_exp_f32_e64 v207, v207
  v_mfma_f32_16x16x32_bf16 v[196:199], a[148:151], a[56:59], v[196:199]
  s_add_u32 m0, s30, s96
  v_exp_f32 v206, v206
  v_mfma_f32_16x16x32_bf16 v[196:199], a[152:155], a[52:55], v[196:199]
  s_waitcnt lgkmcnt(0)
  v_cvt_pk_bf16_f32 v208, v200, v201
  v_cvt_pk_bf16_f32 v209, v202, v203
  v_cvt_pk_bf16_f32 v210, v204, v205
  v_cvt_pk_bf16_f32 v211, v206, v207
  v_mfma_f32_16x16x32_bf16 v[196:199], a[156:159], a[48:51], v[196:199]
  buffer_store_dwordx4 a[116:119], v233, s[16:19], s35 offen offset:1024 sc1
  buffer_load_dwordx4 v221, s[8:11], s33 offen lds
  v_pk_mul_f32 v[200:201], v[192:193], s[28:29] op_sel:[0,1] op_sel_hi:[1,1]
  v_pk_mul_f32 v[202:203], v[194:195], s[28:29] op_sel:[0,1] op_sel_hi:[1,1]
  v_mfma_f32_16x16x32_bf16 v[64:67], v[208:211], a[160:163], v[64:67]
  v_exp_f32 v202, v202
  v_mfma_f32_16x16x32_bf16 v[68:71], v[208:211], a[164:167], v[68:71]
  s_add_u32 m0, s30, s97
  v_exp_f32 v200, v200
  v_mfma_f32_16x16x32_bf16 v[72:75], v[208:211], a[168:171], v[72:75]
  buffer_load_dwordx4 v221, s[8:11], s33 offen offset:1024 lds
  v_mfma_f32_16x16x32_bf16 v[76:79], v[208:211], a[172:175], v[76:79]
  s_sub_u32 s30, s30, 16896
  v_mul_f32 v204, s29, v196
  v_mul_f32 v207, s29, v199
  v_mfma_f32_16x16x32_bf16 v[80:83], v[208:211], a[176:179], v[80:83]
  s_cselect_b32 s30, s31, s30
  v_mul_f32 v205, s29, v197
  v_mul_f32_e64 v206, s29, v198
  v_mfma_f32_16x16x32_bf16 v[84:87], v[208:211], a[180:183], v[84:87]
  s_add_u32 s59, s59, 8192
  v_exp_f32_e64 v207, v207
  v_mfma_f32_16x16x32_bf16 v[88:91], v[208:211], a[184:187], v[88:91]
  s_xor_b32 s33, s59, s3
  v_exp_f32 v204, v204
  v_mfma_f32_16x16x32_bf16 v[92:95], v[208:211], a[188:191], v[92:95]
  v_exp_f32_e64 v206, v206
  v_mfma_f32_16x16x32_bf16 v[192:195], a[128:131], a[64:67], v[228:231]
  v_exp_f32_e64 v201, v201
  v_mfma_f32_16x16x32_bf16 v[192:195], a[132:135], a[68:71], v[192:195]
  v_exp_f32_e64 v205, v205
  v_mfma_f32_16x16x32_bf16 v[192:195], a[136:139], a[72:75], v[192:195]
  v_exp_f32_e64 v203, v203
  v_mfma_f32_16x16x32_bf16 v[192:195], a[140:143], a[76:79], v[192:195]
  v_cvt_pk_bf16_f32 v214, v204, v205
  v_cvt_pk_bf16_f32 v215, v206, v207
  v_mfma_f32_16x16x32_bf16 v[196:199], a[144:147], a[76:79], v[228:231]
  v_cvt_pk_bf16_f32 v212, v200, v201
  v_cvt_pk_bf16_f32 v213, v202, v203
  v_mfma_f32_16x16x32_bf16 v[196:199], a[148:151], a[72:75], v[196:199]
  buffer_store_dwordx4 a[112:115], v233, s[16:19], s35 offen sc1
  v_add_u32 v216, s30, v218
  v_add_u32 v217, s30, v219
  v_mfma_f32_16x16x32_bf16 v[196:199], a[152:155], a[68:71], v[196:199]
  s_add_u32 s35, s35, 2048
  v_mul_f32 v200, s29, v192
  v_mul_f32 v203, s29, v195
  v_mfma_f32_16x16x32_bf16 v[196:199], a[156:159], a[64:67], v[196:199]
  v_mul_f32 v201, s29, v193
  v_mul_f32 v202, s29, v194
  v_smfmac_f32_16x16x64_bf16 a[196:199], a[220:223], v[208:215], v254
  v_mfma_f32_16x16x32_bf16 v[96:99], v[212:215], a[160:163], v[96:99]
  v_exp_f32_e64 v200, v200
  v_mfma_f32_16x16x32_bf16 v[100:103], v[212:215], a[164:167], v[100:103]
  v_mul_f32 v205, s29, v197
  v_mul_f32 v207, s29, v199
  v_mfma_f32_16x16x32_bf16 v[104:107], v[212:215], a[168:171], v[104:107]
  v_mul_f32 v204, s29, v196
  v_mul_f32 v206, s29, v198
  v_mfma_f32_16x16x32_bf16 v[108:111], v[212:215], a[172:175], v[108:111]
  v_exp_f32_e64 v204, v204
  v_mfma_f32_16x16x32_bf16 v[112:115], v[212:215], a[176:179], v[112:115]
  v_exp_f32_e64 v206, v206
  v_mfma_f32_16x16x32_bf16 v[116:119], v[212:215], a[180:183], v[116:119]
  v_exp_f32_e64 v201, v201
  v_mfma_f32_16x16x32_bf16 v[120:123], v[212:215], a[184:187], v[120:123]
  v_exp_f32_e64 v203, v203
  v_mfma_f32_16x16x32_bf16 v[124:127], v[212:215], a[188:191], v[124:127]
  v_exp_f32_e64 v202, v202
  v_mfma_f32_16x16x32_bf16 v[192:195], a[128:131], a[80:83], v[228:231]
  v_exp_f32_e64 v205, v205
  v_mfma_f32_16x16x32_bf16 v[192:195], a[132:135], a[84:87], v[192:195]
  v_exp_f32_e64 v207, v207
  v_mfma_f32_16x16x32_bf16 v[192:195], a[136:139], a[88:91], v[192:195]
  v_cvt_pk_bf16_f32 v208, v200, v201
  v_cvt_pk_bf16_f32 v209, v202, v203
  v_mfma_f32_16x16x32_bf16 v[192:195], a[140:143], a[92:95], v[192:195]
  v_cvt_pk_bf16_f32 v210, v204, v205
  v_cvt_pk_bf16_f32 v211, v206, v207
  v_mfma_f32_16x16x32_bf16 v[196:199], a[144:147], a[92:95], v[228:231]
  ds_read_b128 a[128:131], v216 offset:0
  ds_read_b128 a[132:135], v216 offset:64
  v_mfma_f32_16x16x32_bf16 v[196:199], a[148:151], a[88:91], v[196:199]
  ds_read_b128 a[136:139], v216 offset:128
  ds_read_b128 a[140:143], v216 offset:192
  v_mfma_f32_16x16x32_bf16 v[196:199], a[152:155], a[84:87], v[196:199]
  v_mul_f32 v201, s29, v193
  v_mul_f32 v202, s29, v194
  v_mfma_f32_16x16x32_bf16 v[196:199], a[156:159], a[80:83], v[196:199]
  v_mul_f32 v200, s29, v192
  v_mul_f32 v203, s29, v195
  v_mfma_f32_16x16x32_bf16 v[128:131], v[208:211], a[160:163], v[128:131]
  ds_read_b128 a[144:147], v216 offset:704
  ds_read_b128 a[156:159], v216 offset:512
  v_mfma_f32_16x16x32_bf16 v[132:135], v[208:211], a[164:167], v[132:135]
  v_exp_f32_e64 v202, v202
  v_mfma_f32_16x16x32_bf16 v[136:139], v[208:211], a[168:171], v[136:139]
  ds_read_b128 a[148:151], v216 offset:640
  v_mul_f32_e64 v204, s29, v196
  v_mfma_f32_16x16x32_bf16 v[140:143], v[208:211], a[172:175], v[140:143]
  v_exp_f32_e64 v201, v201
  v_mfma_f32_16x16x32_bf16 v[144:147], v[208:211], a[176:179], v[144:147]
  ds_read_b128 a[152:155], v216 offset:576
  v_mul_f32_e64 v205, s29, v197
  v_mfma_f32_16x16x32_bf16 v[148:151], v[208:211], a[180:183], v[148:151]
  s_sub_u32 s37, s37, 1
  v_exp_f32 v200, v200
  v_mfma_f32_16x16x32_bf16 v[152:155], v[208:211], a[184:187], v[152:155]
  s_waitcnt lgkmcnt(4)
  v_exp_f32 v203, v203
  v_mfma_f32_16x16x32_bf16 v[156:159], v[208:211], a[188:191], v[156:159]
  s_cbranch_scc1 L_exitD
  v_mul_f32 v206, s29, v198
  v_mul_f32_e64 v207, s29, v199
  v_mfma_f32_16x16x32_bf16 v[192:195], a[128:131], a[0:3], v[228:231]
  v_exp_f32_e64 v204, v204
  v_mfma_f32_16x16x32_bf16 v[192:195], a[132:135], a[4:7], v[192:195]
  v_exp_f32_e64 v206, v206
  v_mfma_f32_16x16x32_bf16 v[192:195], a[136:139], a[8:11], v[192:195]
  v_exp_f32_e64 v205, v205
  v_mfma_f32_16x16x32_bf16 v[192:195], a[140:143], a[12:15], v[192:195]
  s_waitcnt lgkmcnt(0)
  v_exp_f32 v207, v207
  v_mfma_f32_16x16x32_bf16 v[196:199], a[144:147], a[12:15], v[228:231]
  v_cvt_pk_bf16_f32 v212, v200, v201
  v_cvt_pk_bf16_f32 v215, v206, v207
  v_mfma_f32_16x16x32_bf16 v[196:199], a[148:151], a[8:11], v[196:199]
  v_cvt_pk_bf16_f32 v213, v202, v203
  v_cvt_pk_bf16_f32 v214, v204, v205
  v_mfma_f32_16x16x32_bf16 v[196:199], a[152:155], a[4:7], v[196:199]
  v_mul_f32 v200, s29, v192
  v_mul_f32 v203, s29, v195
  v_mfma_f32_16x16x32_bf16 v[196:199], a[156:159], a[0:3], v[196:199]
  v_mul_f32 v201, s29, v193
  v_mul_f32 v202, s29, v194
  v_mfma_f32_16x16x32_bf16 v[160:163], v[212:215], a[160:163], v[160:163]
  v_exp_f32_e64 v200, v200
  v_mfma_f32_16x16x32_bf16 v[164:167], v[212:215], a[164:167], v[164:167]
  ds_read_b64_tr_b16 a[164:165], v217 offset:8464
  ds_read_b64_tr_b16 a[166:167], v217 offset:8976
  v_mfma_f32_16x16x32_bf16 v[168:171], v[212:215], a[168:171], v[168:171]
  v_mul_f32 v206, s29, v198
  v_mul_f32 v207, s29, v199
  v_mfma_f32_16x16x32_bf16 v[172:175], v[212:215], a[172:175], v[172:175]
  ds_read_b64_tr_b16 a[168:169], v217 offset:8480
  v_mul_f32_e64 v204, s29, v196
  v_mfma_f32_16x16x32_bf16 v[176:179], v[212:215], a[176:179], v[176:179]
  v_exp_f32_e64 v201, v201
  v_mfma_f32_16x16x32_bf16 v[180:183], v[212:215], a[180:183], v[180:183]
  ds_read_b64_tr_b16 a[160:161], v217 offset:8448
  ds_read_b64_tr_b16 a[172:173], v217 offset:8496
  v_mfma_f32_16x16x32_bf16 v[184:187], v[212:215], a[184:187], v[184:187]
  ds_read_b64_tr_b16 a[174:175], v217 offset:9008
  v_mul_f32_e64 v205, s29, v197
  v_mfma_f32_16x16x32_bf16 v[188:191], v[212:215], a[188:191], v[188:191]
  v_exp_f32_e64 v203, v203
  v_smfmac_f32_16x16x64_bf16 a[200:203], a[220:223], v[208:215], v254
  ds_read_b64_tr_b16 a[162:163], v217 offset:8960
  ds_read_b64_tr_b16 a[170:171], v217 offset:8992
  v_exp_f32_e64 v202, v202
L_pD2:
  v_mfma_f32_16x16x32_bf16 v[192:195], a[128:131], a[16:19], v[228:231]
  v_exp_f32_e64 v204, v204
  v_mfma_f32_16x16x32_bf16 v[192:195], a[132:135], a[20:23], v[192:195]
  v_exp_f32_e64 v205, v205
  v_mfma_f32_16x16x32_bf16 v[192:195], a[136:139], a[24:27], v[192:195]
  v_exp_f32_e64 v206, v206
  v_mfma_f32_16x16x32_bf16 v[192:195], a[140:143], a[28:31], v[192:195]
  v_exp_f32_e64 v207, v207
  v_mfma_f32_16x16x32_bf16 v[196:199], a[144:147], a[28:31], v[228:231]
  ds_read_b64_tr_b16 a[176:177], v217 offset:8512
  ds_read_b64_tr_b16 a[178:179], v217 offset:9024
  v_mfma_f32_16x16x32_bf16 v[196:199], a[148:151], a[24:27], v[196:199]
  s_waitcnt lgkmcnt(2)
  v_cvt_pk_bf16_f32 v208, v200, v201
  v_cvt_pk_bf16_f32 v209, v202, v203
  v_mfma_f32_16x16x32_bf16 v[196:199], a[152:155], a[20:23], v[196:199]
  ds_read_b64_tr_b16 a[180:181], v217 offset:8528
  ds_read_b64_tr_b16 a[182:183], v217 offset:9040
  v_cvt_pk_bf16_f32 v210, v204, v205
  v_cvt_pk_bf16_f32 v211, v206, v207
  v_mfma_f32_16x16x32_bf16 v[196:199], a[156:159], a[16:19], v[196:199]
  ds_read_b64_tr_b16 a[184:185], v217 offset:8544
  ds_read_b64_tr_b16 a[186:187], v217 offset:9056
  v_mfma_f32_16x16x32_bf16 v[0:3], v[208:211], a[160:163], v[0:3]
  ds_read_b64_tr_b16 a[188:189], v217 offset:8560
  ds_read_b64_tr_b16 a[190:191], v217 offset:9072
  v_mfma_f32_16x16x32_bf16 v[4:7], v[208:211], a[164:167], v[4:7]
  v_mul_f32 v200, s29, v192
  v_mul_f32_e64 v201, s29, v193
  v_mfma_f32_16x16x32_bf16 v[8:11], v[208:211], a[168:171], v[8:11]
  v_mul_f32 v202, s29, v194
  v_mul_f32 v203, s29, v195
  v_mfma_f32_16x16x32_bf16 v[12:15], v[208:211], a[172:175], v[12:15]
  s_waitcnt lgkmcnt(6)
  v_mul_f32 v204, s29, v196
  v_mul_f32_e64 v205, s29, v197
  v_mfma_f32_16x16x32_bf16 v[16:19], v[208:211], a[176:179], v[16:19]
  s_waitcnt lgkmcnt(4)
  v_mul_f32 v206, s29, v198
  v_mul_f32_e64 v207, s29, v199
  v_mfma_f32_16x16x32_bf16 v[20:23], v[208:211], a[180:183], v[20:23]
  s_waitcnt lgkmcnt(2)
  v_exp_f32 v200, v200
  v_mfma_f32_16x16x32_bf16 v[24:27], v[208:211], a[184:187], v[24:27]
  s_waitcnt lgkmcnt(0)
  v_exp_f32 v201, v201
  v_mfma_f32_16x16x32_bf16 v[28:31], v[208:211], a[188:191], v[28:31]
  v_exp_f32_e64 v202, v202
  v_mfma_f32_16x16x32_bf16 v[192:195], a[128:131], a[32:35], v[228:231]
  v_exp_f32_e64 v203, v203
  v_mfma_f32_16x16x32_bf16 v[192:195], a[132:135], a[36:39], v[192:195]
  v_exp_f32_e64 v204, v204
  v_mfma_f32_16x16x32_bf16 v[192:195], a[136:139], a[40:43], v[192:195]
  v_exp_f32_e64 v205, v205
  v_mfma_f32_16x16x32_bf16 v[192:195], a[140:143], a[44:47], v[192:195]
  v_exp_f32_e64 v206, v206
  v_mfma_f32_16x16x32_bf16 v[196:199], a[144:147], a[44:47], v[228:231]
  v_exp_f32_e64 v207, v207
  v_mfma_f32_16x16x32_bf16 v[196:199], a[148:151], a[40:43], v[196:199]
  v_cvt_pk_bf16_f32 v212, v200, v201
  v_cvt_pk_bf16_f32 v213, v202, v203
  v_mfma_f32_16x16x32_bf16 v[196:199], a[152:155], a[36:39], v[196:199]
  s_waitcnt vmcnt(7)
  v_cvt_pk_bf16_f32 v214, v204, v205
  v_cvt_pk_bf16_f32 v215, v206, v207
  v_mfma_f32_16x16x32_bf16 v[196:199], a[156:159], a[32:35], v[196:199]
  s_barrier
  v_mul_f32_e64 v200, s29, v192
  v_smfmac_f32_16x16x64_bf16 a[192:195], a[220:223], v[208:215], v254
  ds_read_b64_tr_b16 a[112:113], v220 offset:2048
  v_mul_f32_e64 v201, s29, v193
  v_mfma_f32_16x16x32_bf16 v[32:35], v[212:215], a[160:163], v[32:35]
  s_mov_b32 m0, s30
  v_mul_f32 v202, s29, v194
  v_mul_f32_e64 v203, s29, v195
  v_mfma_f32_16x16x32_bf16 v[36:39], v[212:215], a[164:167], v[36:39]
  ds_read_b64_tr_b16 a[114:115], v220 offset:2112
  ds_read_b64_tr_b16 a[116:117], v220 offset:3072
  v_mfma_f32_16x16x32_bf16 v[40:43], v[212:215], a[168:171], v[40:43]
  ds_read_b64_tr_b16 a[118:119], v220 offset:3136
  v_mul_f32_e64 v204, s29, v196
  v_mfma_f32_16x16x32_bf16 v[44:47], v[212:215], a[172:175], v[44:47]
  buffer_load_dwordx4 v221, s[4:7], s33 offen lds
  v_mfma_f32_16x16x32_bf16 v[48:51], v[212:215], a[176:179], v[48:51]
  v_mul_f32 v205, s29, v197
  v_mul_f32 v206, s29, v198
  v_mfma_f32_16x16x32_bf16 v[52:55], v[212:215], a[180:183], v[52:55]
  v_exp_f32_e64 v200, v200
  v_mfma_f32_16x16x32_bf16 v[56:59], v[212:215], a[184:187], v[56:59]
  v_exp_f32_e64 v201, v201
  v_mfma_f32_16x16x32_bf16 v[60:63], v[212:215], a[188:191], v[60:63]
  v_mul_f32_e64 v207, s29, v199
  v_cvt_pk_bf16_f32 v208, v200, v201
  v_mfma_f32_16x16x32_bf16 v[192:195], a[128:131], a[48:51], v[228:231]
  v_exp_f32_e64 v202, v202
  v_mfma_f32_16x16x32_bf16 v[192:195], a[132:135], a[52:55], v[192:195]
  v_exp_f32_e64 v203, v203
  v_mfma_f32_16x16x32_bf16 v[192:195], a[136:139], a[56:59], v[192:195]
  v_exp_f32_e64 v204, v204
  v_mfma_f32_16x16x32_bf16 v[192:195], a[140:143], a[60:63], v[192:195]
  v_exp_f32_e64 v205, v205
  v_mfma_f32_16x16x32_bf16 v[196:199], a[144:147], a[60:63], v[228:231]
  v_exp_f32_e64 v206, v206
  v_mfma_f32_16x16x32_bf16 v[196:199], a[148:151], a[56:59], v[196:199]
  s_add_u32 m0, s30, 32
  v_exp_f32 v207, v207
  v_mfma_f32_16x16x32_bf16 v[196:199], a[152:155], a[52:55], v[196:199]
  s_waitcnt lgkmcnt(0)
  v_cvt_pk_bf16_f32 v209, v202, v203
  v_cvt_pk_bf16_f32 v210, v204, v205
  v_cvt_pk_bf16_f32 v211, v206, v207
  v_mfma_f32_16x16x32_bf16 v[196:199], a[156:159], a[48:51], v[196:199]
  buffer_store_dwordx4 a[116:119], v233, s[16:19], s35 offen offset:1024 sc1
  buffer_load_dwordx4 v221, s[4:7], s33 offen offset:1024 lds
  v_pk_mul_f32 v[200:201], v[192:193], s[28:29] op_sel:[0,1] op_sel_hi:[1,1]
  v_pk_mul_f32 v[202:203], v[194:195], s[28:29] op_sel:[0,1] op_sel_hi:[1,1]
  v_mfma_f32_16x16x32_bf16 v[64:67], v[208:211], a[160:163], v[64:67]
  v_exp_f32 v200, v200
  v_mfma_f32_16x16x32_bf16 v[68:71], v[208:211], a[164:167], v[68:71]
  s_add_u32 m0, s30, s96
  v_exp_f32 v201, v201
  v_mfma_f32_16x16x32_bf16 v[72:75], v[208:211], a[168:171], v[72:75]
  buffer_load_dwordx4 v221, s[8:11], s33 offen lds
  v_mfma_f32_16x16x32_bf16 v[76:79], v[208:211], a[172:175], v[76:79]
  v_mul_f32 v204, s29, v196
  v_mul_f32 v205, s29, v197
  v_mfma_f32_16x16x32_bf16 v[80:83], v[208:211], a[176:179], v[80:83]
  s_add_u32 m0, s30, s97
  v_mul_f32 v206, s29, v198
  v_mul_f32_e64 v207, s29, v199
  v_mfma_f32_16x16x32_bf16 v[84:87], v[208:211], a[180:183], v[84:87]
  buffer_load_dwordx4 v221, s[8:11], s33 offen offset:1024 lds
  v_mfma_f32_16x16x32_bf16 v[88:91], v[208:211], a[184:187], v[88:91]
  s_sub_u32 s30, s30, 16896
  v_exp_f32_e64 v202, v202
  v_mfma_f32_16x16x32_bf16 v[92:95], v[208:211], a[188:191], v[92:95]
  s_cselect_b32 s30, s31, s30
  v_exp_f32 v203, v203
  v_mfma_f32_16x16x32_bf16 v[192:195], a[128:131], a[64:67], v[228:231]
  s_add_u32 s59, s59, 8192
  v_exp_f32_e64 v204, v204
  v_mfma_f32_16x16x32_bf16 v[192:195], a[132:135], a[68:71], v[192:195]
  s_xor_b32 s33, s59, s3
  v_exp_f32 v205, v205
  v_mfma_f32_16x16x32_bf16 v[192:195], a[136:139], a[72:75], v[192:195]
  v_exp_f32_e64 v206, v206
  v_mfma_f32_16x16x32_bf16 v[192:195], a[140:143], a[76:79], v[192:195]
  v_exp_f32_e64 v207, v207
  v_mfma_f32_16x16x32_bf16 v[196:199], a[144:147], a[76:79], v[228:231]
  v_cvt_pk_bf16_f32 v212, v200, v201
  v_cvt_pk_bf16_f32 v213, v202, v203
  v_mfma_f32_16x16x32_bf16 v[196:199], a[148:151], a[72:75], v[196:199]
  v_cvt_pk_bf16_f32 v214, v204, v205
  v_cvt_pk_bf16_f32 v215, v206, v207
  v_mfma_f32_16x16x32_bf16 v[196:199], a[152:155], a[68:71], v[196:199]
  v_mul_f32 v200, s29, v192
  v_mul_f32 v201, s29, v193
  v_mfma_f32_16x16x32_bf16 v[196:199], a[156:159], a[64:67], v[196:199]
  v_mul_f32 v202, s29, v194
  v_mul_f32 v203, s29, v195
  v_smfmac_f32_16x16x64_bf16 a[196:199], a[220:223], v[208:215], v254
  buffer_store_dwordx4 a[112:115], v233, s[16:19], s35 offen sc1
  v_exp_f32_e64 v200, v200
  v_mfma_f32_16x16x32_bf16 v[96:99], v[212:215], a[160:163], v[96:99]
  s_add_u32 s35, s35, 2048
  v_exp_f32_e64 v201, v201
  v_mfma_f32_16x16x32_bf16 v[100:103], v[212:215], a[164:167], v[100:103]
  v_mul_f32 v204, s29, v196
  v_mul_f32 v205, s29, v197
  v_mfma_f32_16x16x32_bf16 v[104:107], v[212:215], a[168:171], v[104:107]
  v_mul_f32 v206, s29, v198
  v_mul_f32 v207, s29, v199
  v_mfma_f32_16x16x32_bf16 v[108:111], v[212:215], a[172:175], v[108:111]
  v_exp_f32_e64 v202, v202
  v_mfma_f32_16x16x32_bf16 v[112:115], v[212:215], a[176:179], v[112:115]
  v_exp_f32_e64 v203, v203
  v_mfma_f32_16x16x32_bf16 v[116:119], v[212:215], a[180:183], v[116:119]
  v_exp_f32_e64 v204, v204
  v_mfma_f32_16x16x32_bf16 v[120:123], v[212:215], a[184:187], v[120:123]
  v_exp_f32_e64 v205, v205
  v_mfma_f32_16x16x32_bf16 v[124:127], v[212:215], a[188:191], v[124:127]
  v_exp_f32_e64 v206, v206
  v_mfma_f32_16x16x32_bf16 v[192:195], a[128:131], a[80:83], v[228:231]
  v_exp_f32_e64 v207, v207
  v_mfma_f32_16x16x32_bf16 v[192:195], a[132:135], a[84:87], v[192:195]
  v_cvt_pk_bf16_f32 v208, v200, v201
  v_cvt_pk_bf16_f32 v209, v202, v203
  v_mfma_f32_16x16x32_bf16 v[192:195], a[136:139], a[88:91], v[192:195]
  v_cvt_pk_bf16_f32 v210, v204, v205
  v_cvt_pk_bf16_f32 v211, v206, v207
  v_mfma_f32_16x16x32_bf16 v[192:195], a[140:143], a[92:95], v[192:195]
  v_add_u32 v216, s30, v218
  v_add_u32 v217, s30, v219
  v_mfma_f32_16x16x32_bf16 v[196:199], a[144:147], a[92:95], v[228:231]
  ds_read_b128 a[128:131], v216 offset:0
  ds_read_b128 a[132:135], v216 offset:64
  v_mfma_f32_16x16x32_bf16 v[196:199], a[148:151], a[88:91], v[196:199]
  ds_read_b128 a[136:139], v216 offset:128
  ds_read_b128 a[140:143], v216 offset:192
  v_mfma_f32_16x16x32_bf16 v[196:199], a[152:155], a[84:87], v[196:199]
  v_mul_f32 v200, s29, v192
  v_mul_f32 v201, s29, v193
  v_mfma_f32_16x16x32_bf16 v[196:199], a[156:159], a[80:83], v[196:199]
  v_mul_f32 v202, s29, v194
  v_mul_f32 v203, s29, v195
  v_mfma_f32_16x16x32_bf16 v[128:131], v[208:211], a[160:163], v[128:131]
  ds_read_b128 a[144:147], v216 offset:704
  ds_read_b128 a[148:151], v216 offset:640
  v_mfma_f32_16x16x32_bf16 v[132:135], v[208:211], a[164:167], v[132:135]
  v_exp_f32_e64 v200, v200
  v_mfma_f32_16x16x32_bf16 v[136:139], v[208:211], a[168:171], v[136:139]
  v_exp_f32_e64 v201, v201
  v_mfma_f32_16x16x32_bf16 v[140:143], v[208:211], a[172:175], v[140:143]
  v_exp_f32_e64 v202, v202
  v_mfma_f32_16x16x32_bf16 v[144:147], v[208:211], a[176:179], v[144:147]
  s_sub_u32 s37, s37, 1
  v_mul_f32 v204, s29, v196
  v_mul_f32_e64 v205, s29, v197
  v_mfma_f32_16x16x32_bf16 v[148:151], v[208:211], a[180:183], v[148:151]
  s_waitcnt lgkmcnt(2)
  v_exp_f32 v203, v203
  v_mfma_f32_16x16x32_bf16 v[152:155], v[208:211], a[184:187], v[152:155]
  ds_read_b128 a[152:155], v216 offset:576
  ds_read_b128 a[156:159], v216 offset:512
  v_mfma_f32_16x16x32_bf16 v[156:159], v[208:211], a[188:191], v[156:159]
  s_cbranch_scc1 L_exitD
  v_mul_f32 v206, s29, v198
  v_mul_f32_e64 v207, s29, v199
  v_mfma_f32_16x16x32_bf16 v[192:195], a[128:131], a[0:3], v[228:231]
  v_exp_f32_e64 v204, v204
  v_mfma_f32_16x16x32_bf16 v[192:195], a[132:135], a[4:7], v[192:195]
  v_exp_f32_e64 v205, v205
  v_mfma_f32_16x16x32_bf16 v[192:195], a[136:139], a[8:11], v[192:195]
  v_exp_f32_e64 v206, v206
  v_mfma_f32_16x16x32_bf16 v[192:195], a[140:143], a[12:15], v[192:195]
  s_waitcnt lgkmcnt(2)
  v_exp_f32 v207, v207
  v_mfma_f32_16x16x32_bf16 v[196:199], a[144:147], a[12:15], v[228:231]
  v_cvt_pk_bf16_f32 v212, v200, v201
  v_cvt_pk_bf16_f32 v213, v202, v203
  v_mfma_f32_16x16x32_bf16 v[196:199], a[148:151], a[8:11], v[196:199]
  s_waitcnt lgkmcnt(0)
  v_cvt_pk_bf16_f32 v214, v204, v205
  v_cvt_pk_bf16_f32 v215, v206, v207
  v_mfma_f32_16x16x32_bf16 v[196:199], a[152:155], a[4:7], v[196:199]
  v_mul_f32 v200, s29, v192
  v_mul_f32_e64 v201, s29, v193
  v_mfma_f32_16x16x32_bf16 v[196:199], a[156:159], a[0:3], v[196:199]
  v_mul_f32 v202, s29, v194
  v_mul_f32 v203, s29, v195
  v_mfma_f32_16x16x32_bf16 v[160:163], v[212:215], a[160:163], v[160:163]
  v_exp_f32_e64 v200, v200
  v_mfma_f32_16x16x32_bf16 v[164:167], v[212:215], a[164:167], v[164:167]
  v_exp_f32_e64 v201, v201
  v_mfma_f32_16x16x32_bf16 v[168:171], v[212:215], a[168:171], v[168:171]
  v_exp_f32_e64 v202, v202
  v_mfma_f32_16x16x32_bf16 v[172:175], v[212:215], a[172:175], v[172:175]
  v_mul_f32 v204, s29, v196
  v_mul_f32 v205, s29, v197
  v_mfma_f32_16x16x32_bf16 v[176:179], v[212:215], a[176:179], v[176:179]
  v_exp_f32_e64 v203, v203
  v_mfma_f32_16x16x32_bf16 v[180:183], v[212:215], a[180:183], v[180:183]
  v_mul_f32 v206, s29, v198
  v_mul_f32 v207, s29, v199
  v_mfma_f32_16x16x32_bf16 v[184:187], v[212:215], a[184:187], v[184:187]
  ds_read_b64_tr_b16 a[160:161], v217 offset:8448
  ds_read_b64_tr_b16 a[162:163], v217 offset:8960
  v_mfma_f32_16x16x32_bf16 v[188:191], v[212:215], a[188:191], v[188:191]
  ds_read_b64_tr_b16 a[164:165], v217 offset:8464
  ds_read_b64_tr_b16 a[166:167], v217 offset:8976
  v_smfmac_f32_16x16x64_bf16 a[200:203], a[220:223], v[208:215], v254
  ds_read_b64_tr_b16 a[168:169], v217 offset:8480
  ds_read_b64_tr_b16 a[170:171], v217 offset:8992
  ds_read_b64_tr_b16 a[172:173], v217 offset:8496
  ds_read_b64_tr_b16 a[174:175], v217 offset:9008
L_pD3:
  v_mfma_f32_16x16x32_bf16 v[192:195], a[128:131], a[16:19], v[228:231]
  ds_read_b64_tr_b16 a[176:177], v217 offset:8512
  v_cvt_pk_bf16_f32 v209, v202, v203
  v_mfma_f32_16x16x32_bf16 v[192:195], a[132:135], a[20:23], v[192:195]
  v_exp_f32_e64 v207, v207
  v_mfma_f32_16x16x32_bf16 v[192:195], a[136:139], a[24:27], v[192:195]
  v_exp_f32_e64 v205, v205
  v_mfma_f32_16x16x32_bf16 v[192:195], a[140:143], a[28:31], v[192:195]
  ds_read_b64_tr_b16 a[178:179], v217 offset:9024
  v_cvt_pk_bf16_f32 v208, v200, v201
  v_mfma_f32_16x16x32_bf16 v[196:199], a[144:147], a[28:31], v[228:231]
  v_exp_f32_e64 v204, v204
  v_mfma_f32_16x16x32_bf16 v[196:199], a[148:151], a[24:27], v[196:199]
  s_waitcnt lgkmcnt(2)
  v_exp_f32 v206, v206
  v_mfma_f32_16x16x32_bf16 v[196:199], a[152:155], a[20:23], v[196:199]
  ds_read_b64_tr_b16 a[180:181], v217 offset:8528
  ds_read_b64_tr_b16 a[182:183], v217 offset:9040
  v_cvt_pk_bf16_f32 v210, v204, v205
  v_cvt_pk_bf16_f32 v211, v206, v207
  v_mfma_f32_16x16x32_bf16 v[196:199], a[156:159], a[16:19], v[196:199]
  ds_read_b64_tr_b16 a[184:185], v217 offset:8544
  ds_read_b64_tr_b16 a[186:187], v217 offset:9056
  v_mfma_f32_16x16x32_bf16 v[0:3], v[208:211], a[160:163], v[0:3]
  ds_read_b64_tr_b16 a[188:189], v217 offset:8560
  ds_read_b64_tr_b16 a[190:191], v217 offset:9072
  v_mfma_f32_16x16x32_bf16 v[4:7], v[208:211], a[164:167], v[4:7]
  v_mul_f32 v202, s29, v194
  v_mul_f32 v203, s29, v195
  v_mfma_f32_16x16x32_bf16 v[8:11], v[208:211], a[168:171], v[8:11]
  v_mul_f32 v200, s29, v192
  v_mul_f32 v201, s29, v193
  v_mfma_f32_16x16x32_bf16 v[12:15], v[208:211], a[172:175], v[12:15]
  s_waitcnt lgkmcnt(6)
  v_mul_f32 v206, s29, v198
  v_mul_f32_e64 v207, s29, v199
  v_mfma_f32_16x16x32_bf16 v[16:19], v[208:211], a[176:179], v[16:19]
  s_waitcnt lgkmcnt(4)
  v_exp_f32 v207, v207
  v_mfma_f32_16x16x32_bf16 v[20:23], v[208:211], a[180:183], v[20:23]
  s_waitcnt lgkmcnt(2)
  v_exp_f32 v201, v201
  v_mfma_f32_16x16x32_bf16 v[24:27], v[208:211], a[184:187], v[24:27]
  s_waitcnt lgkmcnt(0)
  v_mul_f32 v204, s29, v196
  v_mul_f32_e64 v205, s29, v197
  v_mfma_f32_16x16x32_bf16 v[28:31], v[208:211], a[188:191], v[28:31]
  v_exp_f32_e64 v205, v205
  v_mfma_f32_16x16x32_bf16 v[192:195], a[128:131], a[32:35], v[228:231]
  v_exp_f32_e64 v202, v202
  v_mfma_f32_16x16x32_bf16 v[192:195], a[132:135], a[36:39], v[192:195]
  v_exp_f32_e64 v200, v200
  v_mfma_f32_16x16x32_bf16 v[192:195], a[136:139], a[40:43], v[192:195]
  v_exp_f32_e64 v206, v206
  v_mfma_f32_16x16x32_bf16 v[192:195], a[140:143], a[44:47], v[192:195]
  v_cvt_pk_bf16_f32 v212, v200, v201
  v_cvt_pk_bf16_f32 v215, v206, v207
  v_mfma_f32_16x16x32_bf16 v[196:199], a[144:147], a[44:47], v[228:231]
  v_exp_f32_e64 v204, v204
  v_mfma_f32_16x16x32_bf16 v[196:199], a[148:151], a[40:43], v[196:199]
  v_exp_f32_e64 v203, v203
  v_mfma_f32_16x16x32_bf16 v[196:199], a[152:155], a[36:39], v[196:199]
  v_cvt_pk_bf16_f32 v213, v202, v203
  v_cvt_pk_bf16_f32 v214, v204, v205
  v_mfma_f32_16x16x32_bf16 v[196:199], a[156:159], a[32:35], v[196:199]
  s_waitcnt vmcnt(7)
  v_mul_f32 v200, s29, v192
  v_mul_f32_e64 v201, s29, v193
  v_smfmac_f32_16x16x64_bf16 a[192:195], a[220:223], v[208:215], v254
  ds_read_b64_tr_b16 a[112:113], v220 offset:4096
  v_mul_f32_e64 v202, s29, v194
  v_mfma_f32_16x16x32_bf16 v[32:35], v[212:215], a[160:163], v[32:35]
  ds_read_b64_tr_b16 a[114:115], v220 offset:4160
  ds_read_b64_tr_b16 a[116:117], v220 offset:5120
  v_mfma_f32_16x16x32_bf16 v[36:39], v[212:215], a[164:167], v[36:39]
  ds_read_b64_tr_b16 a[118:119], v220 offset:5184
  v_mul_f32_e64 v206, s29, v198
  v_mfma_f32_16x16x32_bf16 v[40:43], v[212:215], a[168:171], v[40:43]
  s_barrier
  v_mul_f32 v203, s29, v195
  v_mfma_f32_16x16x32_bf16 v[44:47], v[212:215], a[172:175], v[44:47]
  v_exp_f32_e64 v201, v201
  v_mfma_f32_16x16x32_bf16 v[48:51], v[212:215], a[176:179], v[48:51]
  v_mul_f32 v205, s29, v197
  v_mul_f32 v207, s29, v199
  v_mfma_f32_16x16x32_bf16 v[52:55], v[212:215], a[180:183], v[52:55]
  v_exp_f32_e64 v205, v205
  v_mfma_f32_16x16x32_bf16 v[56:59], v[212:215], a[184:187], v[56:59]
  v_exp_f32_e64 v207, v207
  v_mfma_f32_16x16x32_bf16 v[60:63], v[212:215], a[188:191], v[60:63]
  s_mov_b32 m0, s30
  v_exp_f32 v202, v202
  v_mfma_f32_16x16x32_bf16 v[192:195], a[128:131], a[48:51], v[228:231]
  buffer_load_dwordx4 v221, s[4:7], s33 offen lds
  v_mfma_f32_16x16x32_bf16 v[192:195], a[132:135], a[52:55], v[192:195]
  v_exp_f32_e64 v200, v200
  v_mfma_f32_16x16x32_bf16 v[192:195], a[136:139], a[56:59], v[192:195]
  v_mul_f32_e64 v204, s29, v196
  v_cvt_pk_bf16_f32 v208, v200, v201
  v_mfma_f32_16x16x32_bf16 v[192:195], a[140:143], a[60:63], v[192:195]
  v_exp_f32_e64 v204, v204
  v_mfma_f32_16x16x32_bf16 v[196:199], a[144:147], a[60:63], v[228:231]
  v_exp_f32_e64 v203, v203
  v_mfma_f32_16x16x32_bf16 v[196:199], a[148:151], a[56:59], v[196:199]
  s_add_u32 m0, s30, 32
  v_exp_f32 v206, v206
  v_mfma_f32_16x16x32_bf16 v[196:199], a[152:155], a[52:55], v[196:199]
  s_waitcnt lgkmcnt(0)
  v_cvt_pk_bf16_f32 v209, v202, v203
  v_cvt_pk_bf16_f32 v210, v204, v205
  v_cvt_pk_bf16_f32 v211, v206, v207
  v_mfma_f32_16x16x32_bf16 v[196:199], a[156:159], a[48:51], v[196:199]
  buffer_store_dwordx4 a[116:119], v233, s[16:19], s35 offen offset:1024 sc1
  buffer_load_dwordx4 v221, s[4:7], s33 offen offset:1024 lds
  v_pk_mul_f32 v[200:201], v[192:193], s[28:29] op_sel:[0,1] op_sel_hi:[1,1]
  v_pk_mul_f32 v[202:203], v[194:195], s[28:29] op_sel:[0,1] op_sel_hi:[1,1]
  v_mfma_f32_16x16x32_bf16 v[64:67], v[208:211], a[160:163], v[64:67]
  v_exp_f32 v200, v200
  v_mfma_f32_16x16x32_bf16 v[68:71], v[208:211], a[164:167], v[68:71]
  v_exp_f32_e64 v201, v201
  v_mfma_f32_16x16x32_bf16 v[72:75], v[208:211], a[168:171], v[72:75]
  s_add_u32 m0, s30, s96
  v_mul_f32 v206, s29, v198
  v_mul_f32_e64 v207, s29, v199
  v_mfma_f32_16x16x32_bf16 v[76:79], v[208:211], a[172:175], v[76:79]
  buffer_load_dwordx4 v221, s[8:11], s33 offen lds
  v_mfma_f32_16x16x32_bf16 v[80:83], v[208:211], a[176:179], v[80:83]
  v_exp_f32_e64 v206, v206
  v_mfma_f32_16x16x32_bf16 v[84:87], v[208:211], a[180:183], v[84:87]
  v_mul_f32 v204, s29, v196
  v_mul_f32 v205, s29, v197
  v_mfma_f32_16x16x32_bf16 v[88:91], v[208:211], a[184:187], v[88:91]
  v_exp_f32_e64 v207, v207
  v_mfma_f32_16x16x32_bf16 v[92:95], v[208:211], a[188:191], v[92:95]
  s_add_u32 m0, s30, s97
  v_exp_f32 v205, v205
  v_mfma_f32_16x16x32_bf16 v[192:195], a[128:131], a[64:67], v[228:231]
  buffer_load_dwordx4 v221, s[8:11], s33 offen offset:1024 lds
  v_mfma_f32_16x16x32_bf16 v[192:195], a[132:135], a[68:71], v[192:195]
  s_sub_u32 s30, s30, 16896
  v_exp_f32_e64 v204, v204
  v_mfma_f32_16x16x32_bf16 v[192:195], a[136:139], a[72:75], v[192:195]
  s_cselect_b32 s30, s31, s30
  v_cvt_pk_bf16_f32 v214, v204, v205
  v_cvt_pk_bf16_f32 v215, v206, v207
  v_mfma_f32_16x16x32_bf16 v[192:195], a[140:143], a[76:79], v[192:195]
  s_add_u32 s59, s59, 8192
  v_exp_f32 v202, v202
  v_mfma_f32_16x16x32_bf16 v[196:199], a[144:147], a[76:79], v[228:231]
  s_xor_b32 s33, s59, s3
  v_exp_f32 v203, v203
  v_mfma_f32_16x16x32_bf16 v[196:199], a[148:151], a[72:75], v[196:199]
  v_cvt_pk_bf16_f32 v212, v200, v201
  v_cvt_pk_bf16_f32 v213, v202, v203
  v_mfma_f32_16x16x32_bf16 v[196:199], a[152:155], a[68:71], v[196:199]
  v_mul_f32 v201, s29, v193
  v_mul_f32 v202, s29, v194
  v_mfma_f32_16x16x32_bf16 v[196:199], a[156:159], a[64:67], v[196:199]
  v_mul_f32 v200, s29, v192
  v_mul_f32 v203, s29, v195
  v_smfmac_f32_16x16x64_bf16 a[196:199], a[220:223], v[208:215], v254
  buffer_store_dwordx4 a[112:115], v233, s[16:19], s35 offen sc1
  v_exp_f32_e64 v200, v200
  v_mfma_f32_16x16x32_bf16 v[96:99], v[212:215], a[160:163], v[96:99]
  s_add_u32 s35, s35, 2048
  v_exp_f32_e64 v203, v203
  v_mfma_f32_16x16x32_bf16 v[100:103], v[212:215], a[164:167], v[100:103]
  v_mul_f32 v205, s29, v197
  v_mul_f32 v206, s29, v198
  v_mfma_f32_16x16x32_bf16 v[104:107], v[212:215], a[168:171], v[104:107]
  v_mul_f32 v204, s29, v196
  v_mul_f32 v207, s29, v199
  v_mfma_f32_16x16x32_bf16 v[108:111], v[212:215], a[172:175], v[108:111]
  v_exp_f32_e64 v204, v204
  v_mfma_f32_16x16x32_bf16 v[112:115], v[212:215], a[176:179], v[112:115]
  v_exp_f32_e64 v206, v206
  v_mfma_f32_16x16x32_bf16 v[116:119], v[212:215], a[180:183], v[116:119]
  v_exp_f32_e64 v205, v205
  v_mfma_f32_16x16x32_bf16 v[120:123], v[212:215], a[184:187], v[120:123]
  v_cvt_pk_bf16_f32 v210, v204, v205
  v_add_u32_e64 v216, s30, v218
  v_mfma_f32_16x16x32_bf16 v[124:127], v[212:215], a[188:191], v[124:127]
  v_exp_f32_e64 v202, v202
  v_mfma_f32_16x16x32_bf16 v[192:195], a[128:131], a[80:83], v[228:231]
  ds_read_b128 a[128:131], v216 offset:0
  v_cvt_pk_bf16_f32 v209, v202, v203
  v_mfma_f32_16x16x32_bf16 v[192:195], a[132:135], a[84:87], v[192:195]
  v_exp_f32_e64 v201, v201
  v_mfma_f32_16x16x32_bf16 v[192:195], a[136:139], a[88:91], v[192:195]
  v_exp_f32_e64 v207, v207
  v_mfma_f32_16x16x32_bf16 v[192:195], a[140:143], a[92:95], v[192:195]
  ds_read_b128 a[132:135], v216 offset:64
  v_cvt_pk_bf16_f32 v211, v206, v207
  v_mfma_f32_16x16x32_bf16 v[196:199], a[144:147], a[92:95], v[228:231]
  ds_read_b128 a[144:147], v216 offset:704
  v_cvt_pk_bf16_f32 v208, v200, v201
  v_mfma_f32_16x16x32_bf16 v[196:199], a[148:151], a[88:91], v[196:199]
  ds_read_b128 a[136:139], v216 offset:128
  ds_read_b128 a[148:151], v216 offset:640
  v_mfma_f32_16x16x32_bf16 v[196:199], a[152:155], a[84:87], v[196:199]
  v_mul_f32 v201, s29, v193
  v_mul_f32 v203, s29, v195
  v_mfma_f32_16x16x32_bf16 v[196:199], a[156:159], a[80:83], v[196:199]
  v_exp_f32_e64 v203, v203
  v_mfma_f32_16x16x32_bf16 v[128:131], v[208:211], a[160:163], v[128:131]
  ds_read_b128 a[140:143], v216 offset:192
  v_mul_f32_e64 v200, s29, v192
  v_mfma_f32_16x16x32_bf16 v[132:135], v[208:211], a[164:167], v[132:135]
  ds_read_b128 a[156:159], v216 offset:512
  v_mul_f32_e64 v202, s29, v194
  v_mfma_f32_16x16x32_bf16 v[136:139], v[208:211], a[168:171], v[136:139]
  v_exp_f32_e64 v201, v201
  v_mfma_f32_16x16x32_bf16 v[140:143], v[208:211], a[172:175], v[140:143]
  ds_read_b128 a[152:155], v216 offset:576
  v_mul_f32_e64 v205, s29, v197
  v_mfma_f32_16x16x32_bf16 v[144:147], v[208:211], a[176:179], v[144:147]
  v_mul_f32 v204, s29, v196
  v_add_u32 v217, s30, v219
  v_mfma_f32_16x16x32_bf16 v[148:151], v[208:211], a[180:183], v[148:151]
  s_sub_u32 s37, s37, 1
  v_exp_f32 v200, v200
  v_mfma_f32_16x16x32_bf16 v[152:155], v[208:211], a[184:187], v[152:155]
  s_waitcnt lgkmcnt(3)
  v_exp_f32 v202, v202
  v_mfma_f32_16x16x32_bf16 v[156:159], v[208:211], a[188:191], v[156:159]
  s_cbranch_scc1 L_exitD
  v_mul_f32 v206, s29, v198
  v_mul_f32_e64 v207, s29, v199
  v_mfma_f32_16x16x32_bf16 v[192:195], a[128:131], a[0:3], v[228:231]
  v_exp_f32_e64 v204, v204
  v_mfma_f32_16x16x32_bf16 v[192:195], a[132:135], a[4:7], v[192:195]
  v_exp_f32_e64 v205, v205
  v_mfma_f32_16x16x32_bf16 v[192:195], a[136:139], a[8:11], v[192:195]
  s_waitcnt lgkmcnt(0)
  v_cvt_pk_bf16_f32 v212, v200, v201
  v_cvt_pk_bf16_f32 v214, v204, v205
  v_mfma_f32_16x16x32_bf16 v[192:195], a[140:143], a[12:15], v[192:195]
  v_exp_f32 v206, v206
  v_mfma_f32_16x16x32_bf16 v[196:199], a[144:147], a[12:15], v[228:231]
  v_exp_f32_e64 v207, v207
  v_mfma_f32_16x16x32_bf16 v[196:199], a[148:151], a[8:11], v[196:199]
  v_cvt_pk_bf16_f32 v213, v202, v203
  v_cvt_pk_bf16_f32 v215, v206, v207
  v_mfma_f32_16x16x32_bf16 v[196:199], a[152:155], a[4:7], v[196:199]
  v_mul_f32 v201, s29, v193
  v_mul_f32 v202, s29, v194
  v_mfma_f32_16x16x32_bf16 v[196:199], a[156:159], a[0:3], v[196:199]
  v_exp_f32_e64 v202, v202
  v_mfma_f32_16x16x32_bf16 v[160:163], v[212:215], a[160:163], v[160:163]
  ds_read_b64_tr_b16 a[160:161], v217 offset:8448
  v_mul_f32_e64 v200, s29, v192
  v_mfma_f32_16x16x32_bf16 v[164:167], v[212:215], a[164:167], v[164:167]
  ds_read_b64_tr_b16 a[164:165], v217 offset:8464
  ds_read_b64_tr_b16 a[166:167], v217 offset:8976
  v_mfma_f32_16x16x32_bf16 v[168:171], v[212:215], a[168:171], v[168:171]
  ds_read_b64_tr_b16 a[170:171], v217 offset:8992
  v_mul_f32_e64 v207, s29, v199
  v_mfma_f32_16x16x32_bf16 v[172:175], v[212:215], a[172:175], v[172:175]
  v_exp_f32_e64 v200, v200
  v_mfma_f32_16x16x32_bf16 v[176:179], v[212:215], a[176:179], v[176:179]
  ds_read_b64_tr_b16 a[162:163], v217 offset:8960
  v_mul_f32_e64 v205, s29, v197
  v_mfma_f32_16x16x32_bf16 v[180:183], v[212:215], a[180:183], v[180:183]
  ds_read_b64_tr_b16 a[168:169], v217 offset:8480
  v_mul_f32_e64 v203, s29, v195
  v_mfma_f32_16x16x32_bf16 v[184:187], v[212:215], a[184:187], v[184:187]
  v_exp_f32_e64 v203, v203
  v_mfma_f32_16x16x32_bf16 v[188:191], v[212:215], a[188:191], v[188:191]
  ds_read_b64_tr_b16 a[174:175], v217 offset:9008
  v_mul_f32_e64 v204, s29, v196
  v_smfmac_f32_16x16x64_bf16 a[200:203], a[220:223], v[208:215], v254
  ds_read_b64_tr_b16 a[172:173], v217 offset:8496
  v_exp_f32 v201, v201
  v_mul_f32 v206, s29, v198
L_pD0:
  v_mfma_f32_16x16x32_bf16 v[192:195], a[128:131], a[16:19], v[228:231]
  v_exp_f32_e64 v207, v207
  v_mfma_f32_16x16x32_bf16 v[192:195], a[132:135], a[20:23], v[192:195]
  ds_read_b64_tr_b16 a[182:183], v217 offset:9040
  v_cvt_pk_bf16_f32 v209, v202, v203
  v_mfma_f32_16x16x32_bf16 v[192:195], a[136:139], a[24:27], v[192:195]
  v_exp_f32_e64 v204, v204
  v_mfma_f32_16x16x32_bf16 v[192:195], a[140:143], a[28:31], v[192:195]
  ds_read_b64_tr_b16 a[178:179], v217 offset:9024
  ds_read_b64_tr_b16 a[180:181], v217 offset:8528
  v_mfma_f32_16x16x32_bf16 v[196:199], a[144:147], a[28:31], v[228:231]
  v_exp_f32_e64 v206, v206
  v_mfma_f32_16x16x32_bf16 v[196:199], a[148:151], a[24:27], v[196:199]
  ds_read_b64_tr_b16 a[176:177], v217 offset:8512
  v_exp_f32_e64 v205, v205
  v_mfma_f32_16x16x32_bf16 v[196:199], a[152:155], a[20:23], v[196:199]
  s_waitcnt lgkmcnt(4)
  v_cvt_pk_bf16_f32 v208, v200, v201
  v_cvt_pk_bf16_f32 v210, v204, v205
  v_cvt_pk_bf16_f32 v211, v206, v207
  v_mfma_f32_16x16x32_bf16 v[196:199], a[156:159], a[16:19], v[196:199]
  ds_read_b64_tr_b16 a[184:185], v217 offset:8544
  ds_read_b64_tr_b16 a[186:187], v217 offset:9056
  v_mfma_f32_16x16x32_bf16 v[0:3], v[208:211], a[160:163], v[0:3]
  ds_read_b64_tr_b16 a[188:189], v217 offset:8560
  ds_read_b64_tr_b16 a[190:191], v217 offset:9072
  v_mfma_f32_16x16x32_bf16 v[4:7], v[208:211], a[164:167], v[4:7]
  v_mul_f32 v202, s29, v194
  v_mul_f32_e64 v203, s29, v195
  v_mfma_f32_16x16x32_bf16 v[8:11], v[208:211], a[168:171], v[8:11]
  v_mul_f32 v200, s29, v192
  v_mul_f32 v205, s29, v197
  v_mfma_f32_16x16x32_bf16 v[12:15], v[208:211], a[172:175], v[12:15]
  s_waitcnt lgkmcnt(4)
  v_exp_f32 v203, v203
  v_mfma_f32_16x16x32_bf16 v[16:19], v[208:211], a[176:179], v[16:19]
  v_exp_f32_e64 v202, v202
  v_mfma_f32_16x16x32_bf16 v[20:23], v[208:211], a[180:183], v[20:23]
  s_waitcnt lgkmcnt(2)
  v_mul_f32 v201, s29, v193
  v_mul_f32_e64 v207, s29, v199
  v_mfma_f32_16x16x32_bf16 v[24:27], v[208:211], a[184:187], v[24:27]
  s_waitcnt lgkmcnt(0)
  v_exp_f32 v201, v201
  v_mfma_f32_16x16x32_bf16 v[28:31], v[208:211], a[188:191], v[28:31]
  v_exp_f32_e64 v207, v207
  v_mfma_f32_16x16x32_bf16 v[192:195], a[128:131], a[32:35], v[228:231]
  v_mul_f32 v204, s29, v196
  v_mul_f32 v206, s29, v198
  v_mfma_f32_16x16x32_bf16 v[192:195], a[132:135], a[36:39], v[192:195]
  v_exp_f32_e64 v206, v206
  v_mfma_f32_16x16x32_bf16 v[192:195], a[136:139], a[40:43], v[192:195]
  v_exp_f32_e64 v200, v200
  v_mfma_f32_16x16x32_bf16 v[192:195], a[140:143], a[44:47], v[192:195]
  v_exp_f32_e64 v205, v205
  v_mfma_f32_16x16x32_bf16 v[196:199], a[144:147], a[44:47], v[228:231]
  v_cvt_pk_bf16_f32 v213, v202, v203
  v_cvt_pk_bf16_f32 v215, v206, v207
  v_mfma_f32_16x16x32_bf16 v[196:199], a[148:151], a[40:43], v[196:199]
  v_exp_f32_e64 v204, v204
  v_mfma_f32_16x16x32_bf16 v[196:199], a[152:155], a[36:39], v[196:199]
  v_cvt_pk_bf16_f32 v212, v200, v201
  v_cvt_pk_bf16_f32 v214, v204, v205
  v_mfma_f32_16x16x32_bf16 v[196:199], a[156:159], a[32:35], v[196:199]
  v_mul_f32 v200, s29, v192
  v_mul_f32 v203, s29, v195
  v_smfmac_f32_16x16x64_bf16 a[192:195], a[220:223], v[208:215], v254
  v_mul_f32_e64 v201, s29, v193
  v_mfma_f32_16x16x32_bf16 v[32:35], v[212:215], a[160:163], v[32:35]
  v_mul_f32_e64 v202, s29, v194
  v_add_u32 v220, 6144, v220
  v_mfma_f32_16x16x32_bf16 v[36:39], v[212:215], a[164:167], v[36:39]
  v_mul_f32 v205, s29, v197
  v_mul_f32 v206, s29, v198
  v_mfma_f32_16x16x32_bf16 v[40:43], v[212:215], a[168:171], v[40:43]
  v_exp_f32_e64 v206, v206
  v_mfma_f32_16x16x32_bf16 v[44:47], v[212:215], a[172:175], v[44:47]
  v_exp_f32_e64 v201, v201
  v_mfma_f32_16x16x32_bf16 v[48:51], v[212:215], a[176:179], v[48:51]
  v_exp_f32_e64 v202, v202
  v_mfma_f32_16x16x32_bf16 v[52:55], v[212:215], a[180:183], v[52:55]
  s_waitcnt vmcnt(7)
  v_exp_f32 v205, v205
  v_mfma_f32_16x16x32_bf16 v[56:59], v[212:215], a[184:187], v[56:59]
  s_barrier
  v_mul_f32 v207, s29, v199
  v_mfma_f32_16x16x32_bf16 v[60:63], v[212:215], a[188:191], v[60:63]
  v_exp_f32_e64 v207, v207
  v_mfma_f32_16x16x32_bf16 v[192:195], a[128:131], a[48:51], v[228:231]
  v_mul_f32_e64 v204, s29, v196
  v_cvt_pk_bf16_f32 v211, v206, v207
  v_mfma_f32_16x16x32_bf16 v[192:195], a[132:135], a[52:55], v[192:195]
  v_exp_f32_e64 v204, v204
  v_mfma_f32_16x16x32_bf16 v[192:195], a[136:139], a[56:59], v[192:195]
  v_exp_f32_e64 v200, v200
  v_mfma_f32_16x16x32_bf16 v[192:195], a[140:143], a[60:63], v[192:195]
  v_cvt_pk_bf16_f32 v208, v200, v201
  v_cvt_pk_bf16_f32 v210, v204, v205
  v_mfma_f32_16x16x32_bf16 v[196:199], a[144:147], a[60:63], v[228:231]
  s_mov_b32 m0, s30
  v_exp_f32 v203, v203
  v_mfma_f32_16x16x32_bf16 v[196:199], a[148:151], a[56:59], v[196:199]
  buffer_load_dwordx4 v221, s[4:7], s33 offen lds
  v_mfma_f32_16x16x32_bf16 v[196:199], a[152:155], a[52:55], v[196:199]
  v_cvt_pk_bf16_f32 v209, v202, v203
  v_mul_f32_e64 v203, s29, v195
  v_mfma_f32_16x16x32_bf16 v[196:199], a[156:159], a[48:51], v[196:199]
  s_add_u32 m0, s30, 32
  v_mul_f32 v200, s29, v192
  v_mul_f32_e64 v202, s29, v194
  v_mfma_f32_16x16x32_bf16 v[64:67], v[208:211], a[160:163], v[64:67]
  buffer_load_dwordx4 v221, s[4:7], s33 offen offset:1024 lds
  v_mfma_f32_16x16x32_bf16 v[68:71], v[208:211], a[164:167], v[68:71]
  v_exp_f32_e64 v200, v200
  v_mfma_f32_16x16x32_bf16 v[72:75], v[208:211], a[168:171], v[72:75]
  v_mul_f32 v201, s29, v193
  v_mul_f32 v204, s29, v196
  v_mfma_f32_16x16x32_bf16 v[76:79], v[208:211], a[172:175], v[76:79]
  v_exp_f32_e64 v204, v204
  v_mfma_f32_16x16x32_bf16 v[80:83], v[208:211], a[176:179], v[80:83]
  s_add_u32 m0, s30, s96
  v_mul_f32 v205, s29, v197
  v_mul_f32_e64 v206, s29, v198
  v_mfma_f32_16x16x32_bf16 v[84:87], v[208:211], a[180:183], v[84:87]
  buffer_load_dwordx4 v221, s[8:11], s33 offen lds
  v_mfma_f32_16x16x32_bf16 v[88:91], v[208:211], a[184:187], v[88:91]
  v_exp_f32_e64 v205, v205
  v_mfma_f32_16x16x32_bf16 v[92:95], v[208:211], a[188:191], v[92:95]
  v_mul_f32_e64 v207, s29, v199
  v_cvt_pk_bf16_f32 v214, v204, v205
  v_mfma_f32_16x16x32_bf16 v[192:195], a[128:131], a[96:99], v[228:231]
  v_exp_f32_e64 v207, v207
  v_mfma_f32_16x16x32_bf16 v[192:195], a[132:135], a[100:103], v[192:195]
  v_exp_f32_e64 v201, v201
  v_mfma_f32_16x16x32_bf16 v[192:195], a[136:139], a[104:107], v[192:195]
  v_exp_f32_e64 v206, v206
  v_mfma_f32_16x16x32_bf16 v[192:195], a[140:143], a[108:111], v[192:195]
  v_cvt_pk_bf16_f32 v212, v200, v201
  v_cvt_pk_bf16_f32 v215, v206, v207
  v_mfma_f32_16x16x32_bf16 v[196:199], a[144:147], a[108:111], v[228:231]
  v_exp_f32_e64 v202, v202
  v_mfma_f32_16x16x32_bf16 v[196:199], a[148:151], a[104:107], v[196:199]
  v_exp_f32_e64 v203, v203
  v_mfma_f32_16x16x32_bf16 v[196:199], a[152:155], a[100:103], v[196:199]
  v_cvt_pk_bf16_f32 v213, v202, v203
  v_mul_f32_e64 v201, s29, v193
  v_mfma_f32_16x16x32_bf16 v[196:199], a[156:159], a[96:99], v[196:199]
  s_add_u32 m0, s30, s97
  v_mul_f32 v200, s29, v192
  v_mul_f32_e64 v202, s29, v194
  v_smfmac_f32_16x16x64_bf16 a[196:199], a[220:223], v[208:215], v254
  buffer_load_dwordx4 v221, s[8:11], s33 offen offset:1024 lds
  v_mfma_f32_16x16x32_bf16 v[96:99], v[212:215], a[160:163], v[96:99]
  s_sub_u32 s30, s30, 16896
  v_exp_f32_e64 v201, v201
  v_mfma_f32_16x16x32_bf16 v[100:103], v[212:215], a[164:167], v[100:103]
  s_cselect_b32 s30, s31, s30
  v_mul_f32 v203, s29, v195
  v_mul_f32_e64 v204, s29, v196
  v_mfma_f32_16x16x32_bf16 v[104:107], v[212:215], a[168:171], v[104:107]
  s_add_u32 s59, s59, 8192
  v_mul_f32 v206, s29, v198
  v_mul_f32 v207, s29, v199
  v_mfma_f32_16x16x32_bf16 v[108:111], v[212:215], a[172:175], v[108:111]
  s_xor_b32 s33, s59, s3
  v_exp_f32 v204, v204
  v_mfma_f32_16x16x32_bf16 v[112:115], v[212:215], a[176:179], v[112:115]
  v_exp_f32_e64 v207, v207
  v_mfma_f32_16x16x32_bf16 v[116:119], v[212:215], a[180:183], v[116:119]
  v_exp_f32_e64 v202, v202
  v_mfma_f32_16x16x32_bf16 v[120:123], v[212:215], a[184:187], v[120:123]
  v_mul_f32 v205, s29, v197
  v_add_u32 v216, s30, v218
  v_mfma_f32_16x16x32_bf16 v[124:127], v[212:215], a[188:191], v[124:127]
  v_exp_f32_e64 v205, v205
  v_mfma_f32_16x16x32_bf16 v[192:195], a[128:131], a[64:67], v[228:231]
  v_exp_f32_e64 v200, v200
  v_mfma_f32_16x16x32_bf16 v[192:195], a[132:135], a[68:71], v[192:195]
  v_cvt_pk_bf16_f32 v208, v200, v201
  v_cvt_pk_bf16_f32 v210, v204, v205
  v_mfma_f32_16x16x32_bf16 v[192:195], a[136:139], a[72:75], v[192:195]
  v_exp_f32_e64 v206, v206
  v_mfma_f32_16x16x32_bf16 v[192:195], a[140:143], a[76:79], v[192:195]
  v_cvt_pk_bf16_f32 v211, v206, v207
  v_add_u32_e64 v217, s30, v219
  v_mfma_f32_16x16x32_bf16 v[196:199], a[144:147], a[76:79], v[228:231]
  v_exp_f32_e64 v203, v203
  v_mfma_f32_16x16x32_bf16 v[196:199], a[148:151], a[72:75], v[196:199]
  global_load_dword a120, v[252:253], off
  v_mfma_f32_16x16x32_bf16 v[196:199], a[152:155], a[68:71], v[196:199]
  v_cvt_pk_bf16_f32 v209, v202, v203
  v_mul_f32_e64 v203, s29, v195
  v_mfma_f32_16x16x32_bf16 v[196:199], a[156:159], a[64:67], v[196:199]
  v_mul_f32 v200, s29, v192
  v_mul_f32 v201, s29, v193
  v_mfma_f32_16x16x32_bf16 a[204:207], a[220:223], v[208:211], a[204:207]
  v_exp_f32_e64 v201, v201
  v_mfma_f32_16x16x32_bf16 a[224:227], v[208:211], a[160:163], a[224:227]
  v_exp_f32_e64 v203, v203
  v_mfma_f32_16x16x32_bf16 a[228:231], v[208:211], a[164:167], a[228:231]
  v_mul_f32 v202, s29, v194
  v_mul_f32 v206, s29, v198
  v_mfma_f32_16x16x32_bf16 a[232:235], v[208:211], a[168:171], a[232:235]
  v_exp_f32_e64 v202, v202
  v_mfma_f32_16x16x32_bf16 a[236:239], v[208:211], a[172:175], a[236:239]
  v_exp_f32_e64 v206, v206
  v_mfma_f32_16x16x32_bf16 a[240:243], v[208:211], a[176:179], a[240:243]
  v_mul_f32 v205, s29, v197
  v_mul_f32 v207, s29, v199
  v_mfma_f32_16x16x32_bf16 a[244:247], v[208:211], a[180:183], a[244:247]
  v_exp_f32_e64 v207, v207
  v_mfma_f32_16x16x32_bf16 a[248:251], v[208:211], a[184:187], a[248:251]
  v_exp_f32_e64 v200, v200
  v_mfma_f32_16x16x32_bf16 a[252:255], v[208:211], a[188:191], a[252:255]
  v_cvt_pk_bf16_f32 v208, v200, v201
  v_cvt_pk_bf16_f32 v209, v202, v203
  v_mfma_f32_16x16x32_bf16 v[192:195], a[128:131], a[80:83], v[228:231]
  v_exp_f32_e64 v205, v205
  v_mfma_f32_16x16x32_bf16 v[192:195], a[132:135], a[84:87], v[192:195]
  ds_read_b128 a[128:131], v216 offset:0
  v_mul_f32_e64 v204, s29, v196
  v_mfma_f32_16x16x32_bf16 v[192:195], a[136:139], a[88:91], v[192:195]
  v_exp_f32_e64 v204, v204
  v_mfma_f32_16x16x32_bf16 v[192:195], a[140:143], a[92:95], v[192:195]
  ds_read_b128 a[140:143], v216 offset:192
  v_cvt_pk_bf16_f32 v210, v204, v205
  v_mfma_f32_16x16x32_bf16 v[196:199], a[144:147], a[92:95], v[228:231]
  ds_read_b128 a[132:135], v216 offset:64
  ds_read_b128 a[136:139], v216 offset:128
  v_mfma_f32_16x16x32_bf16 v[196:199], a[148:151], a[88:91], v[196:199]
  ds_read_b128 a[148:151], v216 offset:640
  v_cvt_pk_bf16_f32 v211, v206, v207
  v_mfma_f32_16x16x32_bf16 v[196:199], a[152:155], a[84:87], v[196:199]
  ds_read_b128 a[152:155], v216 offset:576
  v_mul_f32_e64 v201, s29, v193
  v_mfma_f32_16x16x32_bf16 v[196:199], a[156:159], a[80:83], v[196:199]
  ds_read_b128 a[156:159], v216 offset:512
  v_mul_f32_e64 v200, s29, v192
  v_mfma_f32_16x16x32_bf16 v[128:131], v[208:211], a[160:163], v[128:131]
  v_exp_f32_e64 v201, v201
  v_mfma_f32_16x16x32_bf16 v[132:135], v[208:211], a[164:167], v[132:135]
  v_mul_f32 v202, s29, v194
  v_mul_f32 v203, s29, v195
  v_mfma_f32_16x16x32_bf16 v[136:139], v[208:211], a[168:171], v[136:139]
  ds_read_b128 a[144:147], v216 offset:704
  v_mul_f32_e64 v205, s29, v197
  v_mfma_f32_16x16x32_bf16 v[140:143], v[208:211], a[172:175], v[140:143]
  v_exp_f32_e64 v203, v203
  v_mfma_f32_16x16x32_bf16 v[144:147], v[208:211], a[176:179], v[144:147]
  v_exp_f32_e64 v202, v202
  v_mfma_f32_16x16x32_bf16 v[148:151], v[208:211], a[180:183], v[148:151]
  s_sub_u32 s37, s37, 1
  v_exp_f32 v200, v200
  v_mfma_f32_16x16x32_bf16 v[152:155], v[208:211], a[184:187], v[152:155]
  s_waitcnt lgkmcnt(1)
  v_mul_f32 v204, s29, v196
  v_mfma_f32_16x16x32_bf16 v[156:159], v[208:211], a[188:191], v[156:159]
  s_cbranch_scc1 L_exitD
  v_mul_f32 v206, s29, v198
  v_mul_f32_e64 v207, s29, v199
  v_mfma_f32_16x16x32_bf16 v[192:195], a[128:131], a[0:3], v[228:231]
  v_exp_f32_e64 v206, v206
  v_mfma_f32_16x16x32_bf16 v[192:195], a[132:135], a[4:7], v[192:195]
  v_exp_f32_e64 v204, v204
  v_mfma_f32_16x16x32_bf16 v[192:195], a[136:139], a[8:11], v[192:195]
  v_exp_f32_e64 v205, v205
  v_mfma_f32_16x16x32_bf16 v[192:195], a[140:143], a[12:15], v[192:195]
  s_waitcnt lgkmcnt(0)
  v_exp_f32 v207, v207
  v_mfma_f32_16x16x32_bf16 v[196:199], a[144:147], a[12:15], v[228:231]
  v_cvt_pk_bf16_f32 v214, v204, v205
  v_cvt_pk_bf16_f32 v215, v206, v207
  v_mfma_f32_16x16x32_bf16 v[196:199], a[148:151], a[8:11], v[196:199]
  v_cvt_pk_bf16_f32 v212, v200, v201
  v_cvt_pk_bf16_f32 v213, v202, v203
  v_mfma_f32_16x16x32_bf16 v[196:199], a[152:155], a[4:7], v[196:199]
  v_mul_f32 v200, s29, v192
  v_mul_f32 v201, s29, v193
  v_mfma_f32_16x16x32_bf16 v[196:199], a[156:159], a[0:3], v[196:199]
  v_exp_f32_e64 v200, v200
  v_mfma_f32_16x16x32_bf16 v[160:163], v[212:215], a[160:163], v[160:163]
  ds_read_b64_tr_b16 a[162:163], v217 offset:8960
  v_mul_f32_e64 v203, s29, v195
  v_mfma_f32_16x16x32_bf16 v[164:167], v[212:215], a[164:167], v[164:167]
  ds_read_b64_tr_b16 a[166:167], v217 offset:8976
  v_mul_f32_e64 v202, s29, v194
  v_mfma_f32_16x16x32_bf16 v[168:171], v[212:215], a[168:171], v[168:171]
  v_mul_f32 v204, s29, v196
  v_mul_f32 v205, s29, v197
  v_mfma_f32_16x16x32_bf16 v[172:175], v[212:215], a[172:175], v[172:175]
  ds_read_b64_tr_b16 a[174:175], v217 offset:9008
  v_mul_f32_e64 v206, s29, v198
  v_mfma_f32_16x16x32_bf16 v[176:179], v[212:215], a[176:179], v[176:179]
  ds_read_b64_tr_b16 a[170:171], v217 offset:8992
  ds_read_b64_tr_b16 a[172:173], v217 offset:8496
  v_mfma_f32_16x16x32_bf16 v[180:183], v[212:215], a[180:183], v[180:183]
  ds_read_b64_tr_b16 a[168:169], v217 offset:8480
  v_mul_f32_e64 v207, s29, v199
  v_mfma_f32_16x16x32_bf16 v[184:187], v[212:215], a[184:187], v[184:187]
  v_exp_f32_e64 v202, v202
  v_mfma_f32_16x16x32_bf16 v[188:191], v[212:215], a[188:191], v[188:191]
  v_exp_f32_e64 v201, v201
  v_smfmac_f32_16x16x64_bf16 a[200:203], a[220:223], v[208:215], v254
  ds_read_b64_tr_b16 a[160:161], v217 offset:8448
  ds_read_b64_tr_b16 a[164:165], v217 offset:8464
  v_exp_f32 v203, v203
  s_branch L_pD1
L_lastB1:
  s_add_u32 s50, s28, 1
  s_bitcmp1_b32 s50, 1
  s_cselect_b32 s50, 2048, 0
  s_sub_u32 s35, s35, s50
  v_mov_b32 v249, v216
  v_mov_b32 v255, v217
  s_waitcnt lgkmcnt(0)
  v_mfma_f32_16x16x32_bf16 v[192:195], a[128:131], a[0:3], v[228:231]
  s_add_u32 s33, s39, 4096
  v_mul_f32_e64 v207, s29, v199
  v_cvt_pk_bf16_f32 v212, v200, v201
  v_mfma_f32_16x16x32_bf16 v[192:195], a[132:135], a[4:7], v[192:195]
  s_add_u32 s34, s39, 8192
  v_exp_f32_e64 v205, v205
  v_mfma_f32_16x16x32_bf16 v[192:195], a[136:139], a[8:11], v[192:195]
  s_add_u32 s36, s39, 12288
  v_mul_f32_e64 v206, s29, v198
  v_cvt_pk_bf16_f32 v213, v202, v203
  v_mfma_f32_16x16x32_bf16 v[192:195], a[140:143], a[12:15], v[192:195]
  s_add_u32 s30, s39, 16384
  v_exp_f32_e64 v207, v207
  v_mfma_f32_16x16x32_bf16 v[196:199], a[144:147], a[12:15], v[228:231]
  s_add_u32 s31, s39, 20480
  v_exp_f32_e64 v206, v206
  v_mfma_f32_16x16x32_bf16 v[196:199], a[148:151], a[8:11], v[196:199]
  v_exp_f32_e64 v204, v204
  v_mfma_f32_16x16x32_bf16 v[196:199], a[152:155], a[4:7], v[196:199]
  v_cvt_pk_bf16_f32 v214, v204, v205
  v_cvt_pk_bf16_f32 v215, v206, v207
  v_mfma_f32_16x16x32_bf16 v[196:199], a[156:159], a[0:3], v[196:199]
  v_mul_f32 v200, s29, v192
  v_mul_f32 v203, s29, v195
  v_mfma_f32_16x16x32_bf16 v[160:163], v[212:215], a[160:163], v[160:163]
  ds_read_b64_tr_b16 a[162:163], v255 offset:8960
  v_mul_f32_e64 v201, s29, v193
  v_mfma_f32_16x16x32_bf16 v[164:167], v[212:215], a[164:167], v[164:167]
  v_exp_f32_e64 v200, v200
  v_mfma_f32_16x16x32_bf16 v[168:171], v[212:215], a[168:171], v[168:171]
  v_mul_f32 v205, s29, v197
  v_mul_f32 v207, s29, v199
  v_mfma_f32_16x16x32_bf16 v[172:175], v[212:215], a[172:175], v[172:175]
  ds_read_b64_tr_b16 a[174:175], v255 offset:9008
  v_mul_f32_e64 v202, s29, v194
  v_mfma_f32_16x16x32_bf16 v[176:179], v[212:215], a[176:179], v[176:179]
  ds_read_b64_tr_b16 a[160:161], v255 offset:8448
  v_mul_f32_e64 v204, s29, v196
  v_mfma_f32_16x16x32_bf16 v[180:183], v[212:215], a[180:183], v[180:183]
  ds_read_b64_tr_b16 a[164:165], v255 offset:8464
  v_mul_f32_e64 v206, s29, v198
  v_mfma_f32_16x16x32_bf16 v[184:187], v[212:215], a[184:187], v[184:187]
  ds_read_b64_tr_b16 a[166:167], v255 offset:8976
  ds_read_b64_tr_b16 a[168:169], v255 offset:8480
  v_mfma_f32_16x16x32_bf16 v[188:191], v[212:215], a[188:191], v[188:191]
  v_exp_f32_e64 v206, v206
  v_smfmac_f32_16x16x64_bf16 a[200:203], a[220:223], v[208:215], v254
  ds_read_b64_tr_b16 a[172:173], v255 offset:8496
  ds_read_b64_tr_b16 a[180:181], v255 offset:8528
  s_waitcnt vmcnt(7)
  s_barrier
  v_mfma_f32_16x16x32_bf16 v[192:195], a[128:131], a[16:19], v[228:231]
  v_exp_f32_e64 v207, v207
  v_mfma_f32_16x16x32_bf16 v[192:195], a[132:135], a[20:23], v[192:195]
  v_exp_f32_e64 v201, v201
  v_mfma_f32_16x16x32_bf16 v[192:195], a[136:139], a[24:27], v[192:195]
  v_exp_f32_e64 v204, v204
  v_mfma_f32_16x16x32_bf16 v[192:195], a[140:143], a[28:31], v[192:195]
  ds_read_b64_tr_b16 a[170:171], v255 offset:8992
  v_cvt_pk_bf16_f32 v211, v206, v207
  v_mfma_f32_16x16x32_bf16 v[196:199], a[144:147], a[28:31], v[228:231]
  v_exp_f32_e64 v203, v203
  v_mfma_f32_16x16x32_bf16 v[196:199], a[148:151], a[24:27], v[196:199]
  ds_read_b64_tr_b16 a[176:177], v255 offset:8512
  ds_read_b64_tr_b16 a[178:179], v255 offset:9024
  v_exp_f32 v202, v202
  v_exp_f32 v205, v205
  v_mfma_f32_16x16x32_bf16 v[196:199], a[152:155], a[20:23], v[196:199]
  ds_read_b64_tr_b16 a[182:183], v255 offset:9040
  v_cvt_pk_bf16_f32 v208, v200, v201
  v_cvt_pk_bf16_f32 v209, v202, v203
  v_cvt_pk_bf16_f32 v210, v204, v205
  v_mfma_f32_16x16x32_bf16 v[196:199], a[156:159], a[16:19], v[196:199]
  ds_read_b64_tr_b16 a[184:185], v255 offset:8544
  ds_read_b64_tr_b16 a[186:187], v255 offset:9056
  s_waitcnt lgkmcnt(11)
  v_mfma_f32_16x16x32_bf16 v[0:3], v[208:211], a[160:163], v[0:3]
  ds_read_b64_tr_b16 a[188:189], v255 offset:8560
  ds_read_b64_tr_b16 a[190:191], v255 offset:9072
  s_waitcnt lgkmcnt(11)
  v_mfma_f32_16x16x32_bf16 v[4:7], v[208:211], a[164:167], v[4:7]
  ds_read_b128 a[128:131], v249 offset:33792
  v_mul_f32 v200, s29, v192
  s_waitcnt lgkmcnt(8)
  v_mfma_f32_16x16x32_bf16 v[8:11], v[208:211], a[168:171], v[8:11]
  ds_read_b128 a[132:135], v249 offset:33856
  ds_read_b128 a[144:147], v249 offset:34496
  v_mfma_f32_16x16x32_bf16 v[12:15], v[208:211], a[172:175], v[12:15]
  ds_read_b128 a[136:139], v249 offset:33920
  v_mul_f32 v201, s29, v193
  s_waitcnt lgkmcnt(9)
  v_mfma_f32_16x16x32_bf16 v[16:19], v[208:211], a[176:179], v[16:19]
  ds_read_b128 a[140:143], v249 offset:33984
  ds_read_b128 a[152:155], v249 offset:34368
  s_waitcnt lgkmcnt(10)
  v_mfma_f32_16x16x32_bf16 v[20:23], v[208:211], a[180:183], v[20:23]
  ds_read_b128 a[156:159], v249 offset:34304
  v_mul_f32_e64 v203, s29, v195
  s_waitcnt lgkmcnt(9)
  v_mfma_f32_16x16x32_bf16 v[24:27], v[208:211], a[184:187], v[24:27]
  ds_read_b128 a[148:151], v249 offset:34432
  v_mul_f32 v205, s29, v197
  s_waitcnt lgkmcnt(8)
  v_mfma_f32_16x16x32_bf16 v[28:31], v[208:211], a[188:191], v[28:31]
  s_waitcnt lgkmcnt(7)
  v_mul_f32 v202, s29, v194
  v_mul_f32_e64 v207, s29, v199
  v_mfma_f32_16x16x32_bf16 v[192:195], a[128:131], a[0:3], v[228:231]
  s_waitcnt lgkmcnt(6)
  v_exp_f32 v202, v202
  v_mfma_f32_16x16x32_bf16 v[192:195], a[132:135], a[4:7], v[192:195]
  s_waitcnt lgkmcnt(4)
  v_exp_f32 v205, v205
  v_mfma_f32_16x16x32_bf16 v[192:195], a[136:139], a[8:11], v[192:195]
  s_waitcnt lgkmcnt(3)
  v_exp_f32 v203, v203
  v_mfma_f32_16x16x32_bf16 v[192:195], a[140:143], a[12:15], v[192:195]
  s_waitcnt lgkmcnt(0)
  v_mul_f32 v204, s29, v196
  v_mul_f32_e64 v206, s29, v198
  v_mfma_f32_16x16x32_bf16 v[196:199], a[144:147], a[12:15], v[228:231]
  ds_read_b64_tr_b16 a[112:113], v235 offset:20480
  v_cvt_pk_bf16_f32 v213, v202, v203
  v_mfma_f32_16x16x32_bf16 v[196:199], a[148:151], a[8:11], v[196:199]
  v_exp_f32 v200, v200
  v_exp_f32 v201, v201
  v_exp_f32 v204, v204
  v_exp_f32 v206, v206
  v_exp_f32_e64 v207, v207
  v_mfma_f32_16x16x32_bf16 v[196:199], a[152:155], a[4:7], v[196:199]
  v_cvt_pk_bf16_f32 v212, v200, v201
  v_cvt_pk_bf16_f32 v214, v204, v205
  v_cvt_pk_bf16_f32 v215, v206, v207
  v_mfma_f32_16x16x32_bf16 v[196:199], a[156:159], a[0:3], v[196:199]
  v_mul_f32 v200, s29, v192
  v_mul_f32 v203, s29, v195
  v_mfma_f32_16x16x32_bf16 v[32:35], v[212:215], a[160:163], v[32:35]
  ds_read_b64_tr_b16 a[160:161], v255 offset:42240
  v_mul_f32_e64 v201, s29, v193
  v_mfma_f32_16x16x32_bf16 v[36:39], v[212:215], a[164:167], v[36:39]
  ds_read_b64_tr_b16 a[162:163], v255 offset:42752
  v_mul_f32_e64 v202, s29, v194
  v_mfma_f32_16x16x32_bf16 v[40:43], v[212:215], a[168:171], v[40:43]
  ds_read_b64_tr_b16 a[166:167], v255 offset:42768
  v_mul_f32_e64 v205, s29, v197
  v_mfma_f32_16x16x32_bf16 v[44:47], v[212:215], a[172:175], v[44:47]
  ds_read_b64_tr_b16 a[164:165], v255 offset:42256
  ds_read_b64_tr_b16 a[168:169], v255 offset:42272
  v_mfma_f32_16x16x32_bf16 v[48:51], v[212:215], a[176:179], v[48:51]
  v_exp_f32_e64 v202, v202
  v_mfma_f32_16x16x32_bf16 v[52:55], v[212:215], a[180:183], v[52:55]
  ds_read_b64_tr_b16 a[172:173], v255 offset:42288
  ds_read_b64_tr_b16 a[176:177], v255 offset:42304
  v_mfma_f32_16x16x32_bf16 v[56:59], v[212:215], a[184:187], v[56:59]
  ds_read_b64_tr_b16 a[178:179], v255 offset:42816
  v_mul_f32_e64 v204, s29, v196
  v_mfma_f32_16x16x32_bf16 v[60:63], v[212:215], a[188:191], v[60:63]
  v_exp_f32_e64 v205, v205
  v_smfmac_f32_16x16x64_bf16 a[192:195], a[220:223], v[208:215], v254
  ds_read_b64_tr_b16 a[170:171], v255 offset:42784
  ds_read_b64_tr_b16 a[182:183], v255 offset:42832
  v_mfma_f32_16x16x32_bf16 v[192:195], a[128:131], a[16:19], v[228:231]
  v_exp_f32_e64 v200, v200
  v_mfma_f32_16x16x32_bf16 v[192:195], a[132:135], a[20:23], v[192:195]
  ds_read_b64_tr_b16 a[188:189], v255 offset:42352
  v_mul_f32_e64 v206, s29, v198
  v_mfma_f32_16x16x32_bf16 v[192:195], a[136:139], a[24:27], v[192:195]
  v_exp_f32_e64 v206, v206
  v_mfma_f32_16x16x32_bf16 v[192:195], a[140:143], a[28:31], v[192:195]
  ds_read_b64_tr_b16 a[180:181], v255 offset:42320
  v_mul_f32_e64 v207, s29, v199
  v_mfma_f32_16x16x32_bf16 v[196:199], a[144:147], a[28:31], v[228:231]
  ds_read_b64_tr_b16 a[174:175], v255 offset:42800
  ds_read_b64_tr_b16 a[190:191], v255 offset:42864
  v_mfma_f32_16x16x32_bf16 v[196:199], a[148:151], a[24:27], v[196:199]
  v_exp_f32 v201, v201
  v_exp_f32 v203, v203
  v_exp_f32 v204, v204
  v_exp_f32 v207, v207
  v_mfma_f32_16x16x32_bf16 v[196:199], a[152:155], a[20:23], v[196:199]
  s_waitcnt lgkmcnt(12)
  v_cvt_pk_bf16_f32 v208, v200, v201
  v_cvt_pk_bf16_f32 v209, v202, v203
  v_cvt_pk_bf16_f32 v210, v204, v205
  v_cvt_pk_bf16_f32 v211, v206, v207
  v_mfma_f32_16x16x32_bf16 v[196:199], a[156:159], a[16:19], v[196:199]
  ds_read_b64_tr_b16 a[184:185], v255 offset:42336
  ds_read_b64_tr_b16 a[186:187], v255 offset:42848
  v_mfma_f32_16x16x32_bf16 v[0:3], v[208:211], a[160:163], v[0:3]
  s_waitcnt lgkmcnt(12)
  v_mul_f32 v200, s29, v192
  v_mul_f32 v201, s29, v193
  v_mfma_f32_16x16x32_bf16 v[4:7], v[208:211], a[164:167], v[4:7]
  s_waitcnt lgkmcnt(7)
  v_mul_f32 v202, s29, v194
  v_mul_f32_e64 v203, s29, v195
  v_mfma_f32_16x16x32_bf16 v[8:11], v[208:211], a[168:171], v[8:11]
  s_waitcnt lgkmcnt(3)
  v_mul_f32 v205, s29, v197
  v_mul_f32_e64 v207, s29, v199
  v_mfma_f32_16x16x32_bf16 v[12:15], v[208:211], a[172:175], v[12:15]
  v_exp_f32_e64 v203, v203
  v_mfma_f32_16x16x32_bf16 v[16:19], v[208:211], a[176:179], v[16:19]
  v_mul_f32 v204, s29, v196
  v_mul_f32 v206, s29, v198
  v_mfma_f32_16x16x32_bf16 v[20:23], v[208:211], a[180:183], v[20:23]
  s_waitcnt lgkmcnt(0)
  v_exp_f32 v206, v206
  v_mfma_f32_16x16x32_bf16 v[24:27], v[208:211], a[184:187], v[24:27]
  v_exp_f32_e64 v202, v202
  v_mfma_f32_16x16x32_bf16 v[28:31], v[208:211], a[188:191], v[28:31]
  v_exp_f32_e64 v200, v200
  v_mfma_f32_16x16x32_bf16 v[192:195], a[128:131], a[32:35], v[228:231]
  v_exp_f32_e64 v205, v205
  v_mfma_f32_16x16x32_bf16 v[192:195], a[132:135], a[36:39], v[192:195]
  v_exp_f32_e64 v201, v201
  v_mfma_f32_16x16x32_bf16 v[192:195], a[136:139], a[40:43], v[192:195]
  v_cvt_pk_bf16_f32 v212, v200, v201
  v_cvt_pk_bf16_f32 v213, v202, v203
  v_mfma_f32_16x16x32_bf16 v[192:195], a[140:143], a[44:47], v[192:195]
  v_exp_f32_e64 v204, v204
  v_mfma_f32_16x16x32_bf16 v[196:199], a[144:147], a[44:47], v[228:231]
  v_exp_f32_e64 v207, v207
  v_mfma_f32_16x16x32_bf16 v[196:199], a[148:151], a[40:43], v[196:199]
  ds_read_b64_tr_b16 a[114:115], v235 offset:20544
  v_cvt_pk_bf16_f32 v215, v206, v207
  v_mfma_f32_16x16x32_bf16 v[196:199], a[152:155], a[36:39], v[196:199]
  ds_read_b64_tr_b16 a[116:117], v235 offset:21504
  ds_read_b64_tr_b16 a[118:119], v235 offset:21568
  v_cvt_pk_bf16_f32 v214, v204, v205
  v_mfma_f32_16x16x32_bf16 v[196:199], a[156:159], a[32:35], v[196:199]
  v_mul_f32 v200, s29, v192
  v_mul_f32 v203, s29, v195
  v_smfmac_f32_16x16x64_bf16 a[192:195], a[220:223], v[208:215], v254
  v_mul_f32_e64 v201, s29, v193
  v_mfma_f32_16x16x32_bf16 v[32:35], v[212:215], a[160:163], v[32:35]
  s_waitcnt lgkmcnt(0)
  v_exp_f32 v201, v201
  v_mfma_f32_16x16x32_bf16 v[36:39], v[212:215], a[164:167], v[36:39]
  s_waitcnt lgkmcnt(2)
  v_mul_f32 v202, s29, v194
  v_mul_f32_e64 v204, s29, v196
  v_mfma_f32_16x16x32_bf16 v[40:43], v[212:215], a[168:171], v[40:43]
  buffer_store_dwordx4 a[112:115], v233, s[16:19], s35 offen nt
  v_accvgpr_read_b32 v242, a192
  v_accvgpr_read_b32 v250, a193
  v_mfma_f32_16x16x32_bf16 v[44:47], v[212:215], a[172:175], v[44:47]
  buffer_store_dwordx4 a[116:119], v233, s[16:19], s35 offen offset:1024 nt
  v_add_f32 v242, v242, v250
  v_mul_f32 v207, s29, v199
  v_mfma_f32_16x16x32_bf16 v[48:51], v[212:215], a[176:179], v[48:51]
  ds_read_b64_tr_b16 a[112:113], v235 offset:22528
  ds_read_b64_tr_b16 a[114:115], v235 offset:22592
  ds_read_b64_tr_b16 a[116:117], v235 offset:23552
  ds_read_b64_tr_b16 a[118:119], v235 offset:23616
  v_mfma_f32_16x16x32_bf16 v[52:55], v[212:215], a[180:183], v[52:55]
  v_rcp_f32_e64 v242, v242
  v_mfma_f32_16x16x32_bf16 v[56:59], v[212:215], a[184:187], v[56:59]
  v_accvgpr_read_b32 v243, a194
  v_accvgpr_read_b32 v251, a195
  v_add_f32 v243, v243, v251
  v_rcp_f32 v243, v243
  v_mfma_f32_16x16x32_bf16 v[60:63], v[212:215], a[188:191], v[60:63]
  s_waitcnt lgkmcnt(0)
  v_exp_f32 v207, v207
  v_mfma_f32_16x16x4_f32 v[224:227], v242, a121, 0
  s_waitcnt lgkmcnt(2)
  v_exp_f32 v202, v202
  v_mfma_f32_16x16x4_f32 v[250:253], v243, a121, 0
  buffer_store_dwordx4 a[112:115], v233, s[16:19], s35 offen offset:2048 nt
  v_exp_f32_e64 v204, v204
  v_mfma_f32_16x16x32_bf16 v[192:195], a[128:131], a[48:51], v[228:231]
  buffer_store_dwordx4 a[116:119], v233, s[16:19], s35 offen offset:3072 nt
  v_mul_f32 v205, s29, v197
  v_mul_f32 v206, s29, v198
  v_mfma_f32_16x16x32_bf16 v[192:195], a[132:135], a[52:55], v[192:195]
  v_exp_f32_e64 v205, v205
  v_mfma_f32_16x16x32_bf16 v[192:195], a[136:139], a[56:59], v[192:195]
  v_exp_f32_e64 v206, v206
  v_mfma_f32_16x16x32_bf16 v[192:195], a[140:143], a[60:63], v[192:195]
  v_cvt_pk_bf16_f32 v210, v204, v205
  v_cvt_pk_bf16_f32 v211, v206, v207
  v_pk_mul_f32 v[0:1], v[0:1], v[224:225]
  v_pk_mul_f32 v[4:5], v[4:5], v[224:225]
  v_pk_mul_f32 v[8:9], v[8:9], v[224:225]
  v_pk_mul_f32 v[12:13], v[12:13], v[224:225]
  v_pk_mul_f32 v[16:17], v[16:17], v[224:225]
  v_pk_mul_f32 v[20:21], v[20:21], v[224:225]
  v_pk_mul_f32 v[24:25], v[24:25], v[224:225]
  v_pk_mul_f32 v[28:29], v[28:29], v[224:225]
  v_cvt_pk_bf16_f32 v216, v0, v4
  v_cvt_pk_bf16_f32 v217, v8, v12
  v_cvt_pk_bf16_f32 v218, v16, v20
  v_cvt_pk_bf16_f32 v219, v24, v28
  v_cvt_pk_bf16_f32 v220, v1, v5
  v_cvt_pk_bf16_f32 v221, v9, v13
  v_cvt_pk_bf16_f32 v222, v17, v21
  v_cvt_pk_bf16_f32 v223, v25, v29
  ds_write_b128 v232, v[216:219] offset:0
  ds_write_b128 v232, v[220:223] offset:256
  v_pk_mul_f32 v[2:3], v[2:3], v[226:227]
  v_pk_mul_f32 v[6:7], v[6:7], v[226:227]
  v_pk_mul_f32 v[10:11], v[10:11], v[226:227]
  v_pk_mul_f32 v[14:15], v[14:15], v[226:227]
  v_pk_mul_f32 v[18:19], v[18:19], v[226:227]
  v_pk_mul_f32 v[22:23], v[22:23], v[226:227]
  v_pk_mul_f32 v[26:27], v[26:27], v[226:227]
  v_pk_mul_f32 v[30:31], v[30:31], v[226:227]
  v_cvt_pk_bf16_f32 v216, v2, v6
  v_cvt_pk_bf16_f32 v217, v10, v14
  v_cvt_pk_bf16_f32 v218, v18, v22
  v_cvt_pk_bf16_f32 v219, v26, v30
  v_cvt_pk_bf16_f32 v220, v3, v7
  v_cvt_pk_bf16_f32 v221, v11, v15
  v_cvt_pk_bf16_f32 v222, v19, v23
  v_cvt_pk_bf16_f32 v223, v27, v31
  ds_write_b128 v232, v[216:219] offset:512
  ds_write_b128 v232, v[220:223] offset:768
  v_pk_mul_f32 v[32:33], v[32:33], v[250:251]
  v_pk_mul_f32 v[36:37], v[36:37], v[250:251]
  v_pk_mul_f32 v[40:41], v[40:41], v[250:251]
  v_pk_mul_f32 v[44:45], v[44:45], v[250:251]
  v_pk_mul_f32 v[48:49], v[48:49], v[250:251]
  v_pk_mul_f32 v[52:53], v[52:53], v[250:251]
  v_pk_mul_f32 v[56:57], v[56:57], v[250:251]
  v_pk_mul_f32 v[60:61], v[60:61], v[250:251]
  v_cvt_pk_bf16_f32 v216, v32, v36
  v_cvt_pk_bf16_f32 v217, v40, v44
  v_cvt_pk_bf16_f32 v218, v48, v52
  v_cvt_pk_bf16_f32 v219, v56, v60
  v_cvt_pk_bf16_f32 v220, v33, v37
  v_cvt_pk_bf16_f32 v221, v41, v45
  v_cvt_pk_bf16_f32 v222, v49, v53
  v_cvt_pk_bf16_f32 v223, v57, v61
  ds_read_b64_tr_b16 v[0:1], v235 offset:0
  ds_read_b64_tr_b16 v[2:3], v235 offset:64
  ds_read_b64_tr_b16 v[4:5], v235 offset:1024
  ds_read_b64_tr_b16 v[6:7], v235 offset:1088
  ds_write_b128 v232, v[216:219] offset:4096
  ds_write_b128 v232, v[220:223] offset:4352
  v_pk_mul_f32 v[34:35], v[34:35], v[252:253]
  v_pk_mul_f32 v[38:39], v[38:39], v[252:253]
  v_pk_mul_f32 v[42:43], v[42:43], v[252:253]
  v_pk_mul_f32 v[46:47], v[46:47], v[252:253]
  v_pk_mul_f32 v[50:51], v[50:51], v[252:253]
  v_pk_mul_f32 v[54:55], v[54:55], v[252:253]
  v_pk_mul_f32 v[58:59], v[58:59], v[252:253]
  v_pk_mul_f32 v[62:63], v[62:63], v[252:253]
  v_cvt_pk_bf16_f32 v216, v34, v38
  v_cvt_pk_bf16_f32 v217, v42, v46
  v_cvt_pk_bf16_f32 v218, v50, v54
  v_cvt_pk_bf16_f32 v219, v58, v62
  v_cvt_pk_bf16_f32 v220, v35, v39
  v_cvt_pk_bf16_f32 v221, v43, v47
  v_cvt_pk_bf16_f32 v222, v51, v55
  v_cvt_pk_bf16_f32 v223, v59, v63
  ds_read_b64_tr_b16 v[8:9], v235 offset:2048
  ds_read_b64_tr_b16 v[10:11], v235 offset:2112
  ds_read_b64_tr_b16 v[12:13], v235 offset:3072
  ds_read_b64_tr_b16 v[14:15], v235 offset:3136
  ds_write_b128 v232, v[216:219] offset:4608
  ds_write_b128 v232, v[220:223] offset:4864
  s_waitcnt lgkmcnt(10)
  buffer_store_dwordx4 v[0:3], v233, s[16:19], s39 offen nt
  s_waitcnt lgkmcnt(8)
  buffer_store_dwordx4 v[4:7], v233, s[16:19], s39 offen offset:1024 nt
  v_mfma_f32_16x16x32_bf16 v[196:199], a[144:147], a[60:63], v[228:231]
  v_exp_f32_e64 v200, v200
  v_mfma_f32_16x16x32_bf16 v[196:199], a[148:151], a[56:59], v[196:199]
  v_exp_f32_e64 v203, v203
  v_mfma_f32_16x16x32_bf16 v[196:199], a[152:155], a[52:55], v[196:199]
  v_cvt_pk_bf16_f32 v208, v200, v201
  v_cvt_pk_bf16_f32 v209, v202, v203
  v_mfma_f32_16x16x32_bf16 v[196:199], a[156:159], a[48:51], v[196:199]
  ds_read_b128 a[132:135], v249 offset:64
  ds_read_b64_tr_b16 v[32:33], v235 offset:4096
  v_mfma_f32_16x16x32_bf16 v[64:67], v[208:211], a[160:163], v[64:67]
  ds_read_b128 a[136:139], v249 offset:128
  ds_read_b128 a[144:147], v249 offset:704
  v_mfma_f32_16x16x32_bf16 v[68:71], v[208:211], a[164:167], v[68:71]
  ds_read_b128 a[128:131], v249 offset:0
  ds_read_b128 a[140:143], v249 offset:192
  v_mfma_f32_16x16x32_bf16 v[72:75], v[208:211], a[168:171], v[72:75]
  v_mul_f32 v201, s29, v193
  v_mul_f32 v202, s29, v194
  v_mfma_f32_16x16x32_bf16 v[76:79], v[208:211], a[172:175], v[76:79]
  ds_read_b64_tr_b16 v[34:35], v235 offset:4160
  ds_read_b64_tr_b16 v[36:37], v235 offset:5120
  ds_read_b64_tr_b16 v[38:39], v235 offset:5184
  v_mfma_f32_16x16x32_bf16 v[80:83], v[208:211], a[176:179], v[80:83]
  ds_read_b128 a[152:155], v249 offset:576
  ds_read_b128 a[156:159], v249 offset:512
  v_mfma_f32_16x16x32_bf16 v[84:87], v[208:211], a[180:183], v[84:87]
  ds_read_b64_tr_b16 v[40:41], v235 offset:6144
  ds_read_b64_tr_b16 v[42:43], v235 offset:6208
  ds_read_b64_tr_b16 v[44:45], v235 offset:7168
  ds_read_b64_tr_b16 v[46:47], v235 offset:7232
  v_mfma_f32_16x16x32_bf16 v[88:91], v[208:211], a[184:187], v[88:91]
  s_waitcnt lgkmcnt(14)
  buffer_store_dwordx4 v[8:11], v233, s[16:19], s39 offen offset:2048 nt
  ds_read_b128 a[148:151], v249 offset:640
  v_mul_f32 v200, s29, v192
  v_mfma_f32_16x16x32_bf16 v[92:95], v[208:211], a[188:191], v[92:95]
  s_waitcnt lgkmcnt(14)
  buffer_store_dwordx4 v[12:15], v233, s[16:19], s39 offen offset:3072 nt
  v_mul_f32 v203, s29, v195
  v_mul_f32 v206, s29, v198
  s_waitcnt lgkmcnt(11)
  v_mfma_f32_16x16x32_bf16 v[192:195], a[128:131], a[32:35], v[228:231]
  s_waitcnt lgkmcnt(9)
  buffer_store_dwordx4 v[32:35], v233, s[16:19], s33 offen nt
  v_exp_f32 v202, v202
  v_mfma_f32_16x16x32_bf16 v[192:195], a[132:135], a[36:39], v[192:195]
  s_waitcnt lgkmcnt(7)
  buffer_store_dwordx4 v[36:39], v233, s[16:19], s33 offen offset:1024 nt
  v_exp_f32 v201, v201
  v_mfma_f32_16x16x32_bf16 v[192:195], a[136:139], a[40:43], v[192:195]
  s_waitcnt lgkmcnt(3)
  buffer_store_dwordx4 v[40:43], v233, s[16:19], s33 offen offset:2048 nt
  v_exp_f32 v200, v200
  v_mfma_f32_16x16x32_bf16 v[192:195], a[140:143], a[44:47], v[192:195]
  s_waitcnt lgkmcnt(1)
  buffer_store_dwordx4 v[44:47], v233, s[16:19], s33 offen offset:3072 nt
  v_mul_f32 v204, s29, v196
  v_mul_f32 v205, s29, v197
  v_mul_f32 v207, s29, v199
  v_mfma_f32_16x16x32_bf16 v[196:199], a[144:147], a[44:47], v[228:231]
  s_waitcnt lgkmcnt(0)
  v_exp_f32 v204, v204
  v_mfma_f32_16x16x32_bf16 v[196:199], a[148:151], a[40:43], v[196:199]
  v_exp_f32 v203, v203
  v_exp_f32 v205, v205
  v_exp_f32 v206, v206
  v_exp_f32 v207, v207
  v_mfma_f32_16x16x32_bf16 v[196:199], a[152:155], a[36:39], v[196:199]
  v_cvt_pk_bf16_f32 v212, v200, v201
  v_cvt_pk_bf16_f32 v213, v202, v203
  v_cvt_pk_bf16_f32 v214, v204, v205
  v_cvt_pk_bf16_f32 v215, v206, v207
  v_mfma_f32_16x16x32_bf16 v[196:199], a[156:159], a[32:35], v[196:199]
  v_mul_f32 v200, s29, v192
  v_mul_f32 v203, s29, v195
  v_mfma_f32_16x16x32_bf16 v[96:99], v[212:215], a[160:163], v[96:99]
  ds_read_b64_tr_b16 a[160:161], v255 offset:8448
  v_mul_f32_e64 v202, s29, v194
  v_mfma_f32_16x16x32_bf16 v[100:103], v[212:215], a[164:167], v[100:103]
  ds_read_b64_tr_b16 a[162:163], v255 offset:8960
  v_mul_f32_e64 v201, s29, v193
  v_mfma_f32_16x16x32_bf16 v[104:107], v[212:215], a[168:171], v[104:107]
  ds_read_b64_tr_b16 a[170:171], v255 offset:8992
  v_mul_f32_e64 v206, s29, v198
  v_mfma_f32_16x16x32_bf16 v[108:111], v[212:215], a[172:175], v[108:111]
  v_mul_f32 v204, s29, v196
  v_mul_f32 v207, s29, v199
  v_mfma_f32_16x16x32_bf16 v[112:115], v[212:215], a[176:179], v[112:115]
  v_exp_f32_e64 v207, v207
  v_mfma_f32_16x16x32_bf16 v[116:119], v[212:215], a[180:183], v[116:119]
  ds_read_b64_tr_b16 a[164:165], v255 offset:8464
  ds_read_b64_tr_b16 a[174:175], v255 offset:9008
  v_mfma_f32_16x16x32_bf16 v[120:123], v[212:215], a[184:187], v[120:123]
  ds_read_b64_tr_b16 a[172:173], v255 offset:8496
  ds_read_b64_tr_b16 a[178:179], v255 offset:9024
  v_mfma_f32_16x16x32_bf16 v[124:127], v[212:215], a[188:191], v[124:127]
  ds_read_b64_tr_b16 a[176:177], v255 offset:8512
  ds_read_b64_tr_b16 a[190:191], v255 offset:9072
  v_smfmac_f32_16x16x64_bf16 a[196:199], a[220:223], v[208:215], v254
  ds_read_b64_tr_b16 a[166:167], v255 offset:8976
  v_mul_f32_e64 v205, s29, v197
  v_mfma_f32_16x16x32_bf16 v[192:195], a[128:131], a[48:51], v[228:231]
  v_exp_f32_e64 v205, v205
  v_mfma_f32_16x16x32_bf16 v[192:195], a[132:135], a[52:55], v[192:195]
  v_exp_f32_e64 v200, v200
  v_mfma_f32_16x16x32_bf16 v[192:195], a[136:139], a[56:59], v[192:195]
  v_exp_f32_e64 v201, v201
  v_mfma_f32_16x16x32_bf16 v[192:195], a[140:143], a[60:63], v[192:195]
  ds_read_b64_tr_b16 a[168:169], v255 offset:8480
  v_cvt_pk_bf16_f32 v208, v200, v201
  v_mfma_f32_16x16x32_bf16 v[196:199], a[144:147], a[60:63], v[228:231]
  v_exp_f32_e64 v202, v202
  v_mfma_f32_16x16x32_bf16 v[196:199], a[148:151], a[56:59], v[196:199]
  v_exp_f32 v203, v203
  v_exp_f32 v204, v204
  v_exp_f32_e64 v206, v206
  v_mfma_f32_16x16x32_bf16 v[196:199], a[152:155], a[52:55], v[196:199]
  ds_read_b64_tr_b16 a[180:181], v255 offset:8528
  ds_read_b64_tr_b16 a[182:183], v255 offset:9040
  v_cvt_pk_bf16_f32 v209, v202, v203
  v_cvt_pk_bf16_f32 v210, v204, v205
  v_cvt_pk_bf16_f32 v211, v206, v207
  v_mfma_f32_16x16x32_bf16 v[196:199], a[156:159], a[48:51], v[196:199]
  ds_read_b64_tr_b16 a[184:185], v255 offset:8544
  ds_read_b64_tr_b16 a[186:187], v255 offset:9056
  s_waitcnt lgkmcnt(13)
  v_mfma_f32_16x16x32_bf16 v[64:67], v[208:211], a[160:163], v[64:67]
  ds_read_b64_tr_b16 a[188:189], v255 offset:8560
  v_mul_f32_e64 v203, s29, v195
  s_waitcnt lgkmcnt(6)
  v_mfma_f32_16x16x32_bf16 v[68:71], v[208:211], a[164:167], v[68:71]
  s_waitcnt lgkmcnt(5)
  v_mul_f32 v201, s29, v193
  v_mul_f32_e64 v202, s29, v194
  v_mfma_f32_16x16x32_bf16 v[72:75], v[208:211], a[168:171], v[72:75]
  v_mul_f32 v200, s29, v192
  v_mul_f32 v204, s29, v196
  v_mfma_f32_16x16x32_bf16 v[76:79], v[208:211], a[172:175], v[76:79]
  v_mul_f32 v205, s29, v197
  v_mul_f32 v207, s29, v199
  v_mfma_f32_16x16x32_bf16 v[80:83], v[208:211], a[176:179], v[80:83]
  s_waitcnt lgkmcnt(3)
  v_exp_f32 v203, v203
  v_mfma_f32_16x16x32_bf16 v[84:87], v[208:211], a[180:183], v[84:87]
  s_waitcnt lgkmcnt(1)
  v_exp_f32 v202, v202
  v_mfma_f32_16x16x32_bf16 v[88:91], v[208:211], a[184:187], v[88:91]
  s_waitcnt lgkmcnt(0)
  v_exp_f32 v200, v200
  v_mfma_f32_16x16x32_bf16 v[92:95], v[208:211], a[188:191], v[92:95]
  v_exp_f32_e64 v205, v205
  v_mfma_f32_16x16x32_bf16 v[192:195], a[128:131], a[64:67], v[228:231]
  v_exp_f32_e64 v204, v204
  v_mfma_f32_16x16x32_bf16 v[192:195], a[132:135], a[68:71], v[192:195]
  v_mul_f32_e64 v206, s29, v198
  v_cvt_pk_bf16_f32 v213, v202, v203
  v_mfma_f32_16x16x32_bf16 v[192:195], a[136:139], a[72:75], v[192:195]
  v_exp_f32_e64 v206, v206
  v_mfma_f32_16x16x32_bf16 v[192:195], a[140:143], a[76:79], v[192:195]
  v_exp_f32_e64 v201, v201
  v_mfma_f32_16x16x32_bf16 v[196:199], a[144:147], a[76:79], v[228:231]
  v_cvt_pk_bf16_f32 v212, v200, v201
  v_cvt_pk_bf16_f32 v214, v204, v205
  v_mfma_f32_16x16x32_bf16 v[196:199], a[148:151], a[72:75], v[196:199]
  v_exp_f32_e64 v207, v207
  v_mfma_f32_16x16x32_bf16 v[196:199], a[152:155], a[68:71], v[196:199]
  v_cvt_pk_bf16_f32 v215, v206, v207
  v_mul_f32_e64 v203, s29, v195
  v_mfma_f32_16x16x32_bf16 v[196:199], a[156:159], a[64:67], v[196:199]
  v_mul_f32 v200, s29, v192
  v_mul_f32 v202, s29, v194
  v_smfmac_f32_16x16x64_bf16 a[196:199], a[220:223], v[208:215], v254
  v_mul_f32_e64 v201, s29, v193
  v_mfma_f32_16x16x32_bf16 v[96:99], v[212:215], a[160:163], v[96:99]
  v_exp_f32_e64 v203, v203
  v_mfma_f32_16x16x32_bf16 v[100:103], v[212:215], a[164:167], v[100:103]
  v_mul_f32 v205, s29, v197
  v_mul_f32 v207, s29, v199
  v_mfma_f32_16x16x32_bf16 v[104:107], v[212:215], a[168:171], v[104:107]
  v_accvgpr_read_b32 v244, a196
  v_accvgpr_read_b32 v250, a197
  v_mfma_f32_16x16x32_bf16 v[108:111], v[212:215], a[172:175], v[108:111]
  v_add_f32 v244, v244, v250
  v_mul_f32 v206, s29, v198
  v_mfma_f32_16x16x32_bf16 v[112:115], v[212:215], a[176:179], v[112:115]
  v_rcp_f32_e64 v244, v244
  v_mfma_f32_16x16x32_bf16 v[116:119], v[212:215], a[180:183], v[116:119]
  v_accvgpr_read_b32 v245, a198
  v_accvgpr_read_b32 v251, a199
  v_mfma_f32_16x16x32_bf16 v[120:123], v[212:215], a[184:187], v[120:123]
  v_add_f32 v245, v245, v251
  v_rcp_f32 v245, v245
  v_mfma_f32_16x16x32_bf16 v[124:127], v[212:215], a[188:191], v[124:127]
  v_exp_f32_e64 v207, v207
  v_mfma_f32_16x16x4_f32 v[224:227], v244, a121, 0
  v_exp_f32_e64 v205, v205
  v_mfma_f32_16x16x4_f32 v[250:253], v245, a121, 0
  v_exp_f32_e64 v202, v202
  v_mfma_f32_16x16x32_bf16 v[192:195], a[128:131], a[80:83], v[228:231]
  v_mul_f32_e64 v204, s29, v196
  v_cvt_pk_bf16_f32 v209, v202, v203
  v_mfma_f32_16x16x32_bf16 v[192:195], a[132:135], a[84:87], v[192:195]
  v_exp_f32_e64 v204, v204
  v_mfma_f32_16x16x32_bf16 v[192:195], a[136:139], a[88:91], v[192:195]
  v_exp_f32_e64 v200, v200
  v_mfma_f32_16x16x32_bf16 v[192:195], a[140:143], a[92:95], v[192:195]
  ds_read_b128 a[140:143], v249 offset:33984
  v_cvt_pk_bf16_f32 v210, v204, v205
  v_pk_mul_f32 v[64:65], v[64:65], v[224:225]
  v_pk_mul_f32 v[68:69], v[68:69], v[224:225]
  v_pk_mul_f32 v[72:73], v[72:73], v[224:225]
  v_pk_mul_f32 v[76:77], v[76:77], v[224:225]
  v_pk_mul_f32 v[80:81], v[80:81], v[224:225]
  v_pk_mul_f32 v[84:85], v[84:85], v[224:225]
  v_pk_mul_f32 v[88:89], v[88:89], v[224:225]
  v_pk_mul_f32 v[92:93], v[92:93], v[224:225]
  v_cvt_pk_bf16_f32 v216, v64, v68
  v_cvt_pk_bf16_f32 v217, v72, v76
  v_cvt_pk_bf16_f32 v218, v80, v84
  v_cvt_pk_bf16_f32 v219, v88, v92
  v_cvt_pk_bf16_f32 v220, v65, v69
  v_cvt_pk_bf16_f32 v221, v73, v77
  v_cvt_pk_bf16_f32 v222, v81, v85
  v_cvt_pk_bf16_f32 v223, v89, v93
  ds_write_b128 v232, v[216:219] offset:8192
  ds_write_b128 v232, v[220:223] offset:8448
  v_pk_mul_f32 v[66:67], v[66:67], v[226:227]
  v_pk_mul_f32 v[70:71], v[70:71], v[226:227]
  v_pk_mul_f32 v[74:75], v[74:75], v[226:227]
  v_pk_mul_f32 v[78:79], v[78:79], v[226:227]
  v_pk_mul_f32 v[82:83], v[82:83], v[226:227]
  v_pk_mul_f32 v[86:87], v[86:87], v[226:227]
  v_pk_mul_f32 v[90:91], v[90:91], v[226:227]
  v_pk_mul_f32 v[94:95], v[94:95], v[226:227]
  v_cvt_pk_bf16_f32 v216, v66, v70
  v_cvt_pk_bf16_f32 v217, v74, v78
  v_cvt_pk_bf16_f32 v218, v82, v86
  v_cvt_pk_bf16_f32 v219, v90, v94
  v_cvt_pk_bf16_f32 v220, v67, v71
  v_cvt_pk_bf16_f32 v221, v75, v79
  v_cvt_pk_bf16_f32 v222, v83, v87
  v_cvt_pk_bf16_f32 v223, v91, v95
  ds_write_b128 v232, v[216:219] offset:8704
  ds_write_b128 v232, v[220:223] offset:8960
  v_pk_mul_f32 v[96:97], v[96:97], v[250:251]
  v_pk_mul_f32 v[100:101], v[100:101], v[250:251]
  v_pk_mul_f32 v[104:105], v[104:105], v[250:251]
  v_pk_mul_f32 v[108:109], v[108:109], v[250:251]
  v_pk_mul_f32 v[112:113], v[112:113], v[250:251]
  v_pk_mul_f32 v[116:117], v[116:117], v[250:251]
  v_pk_mul_f32 v[120:121], v[120:121], v[250:251]
  v_pk_mul_f32 v[124:125], v[124:125], v[250:251]
  v_cvt_pk_bf16_f32 v216, v96, v100
  v_cvt_pk_bf16_f32 v217, v104, v108
  v_cvt_pk_bf16_f32 v218, v112, v116
  v_cvt_pk_bf16_f32 v219, v120, v124
  v_cvt_pk_bf16_f32 v220, v97, v101
  v_cvt_pk_bf16_f32 v221, v105, v109
  v_cvt_pk_bf16_f32 v222, v113, v117
  v_cvt_pk_bf16_f32 v223, v121, v125
  ds_read_b64_tr_b16 v[64:65], v235 offset:8192
  ds_read_b64_tr_b16 v[66:67], v235 offset:8256
  ds_read_b64_tr_b16 v[68:69], v235 offset:9216
  ds_read_b64_tr_b16 v[70:71], v235 offset:9280
  ds_write_b128 v232, v[216:219] offset:12288
  ds_write_b128 v232, v[220:223] offset:12544
  v_pk_mul_f32 v[98:99], v[98:99], v[252:253]
  v_pk_mul_f32 v[102:103], v[102:103], v[252:253]
  v_pk_mul_f32 v[106:107], v[106:107], v[252:253]
  v_pk_mul_f32 v[110:111], v[110:111], v[252:253]
  v_pk_mul_f32 v[114:115], v[114:115], v[252:253]
  v_pk_mul_f32 v[118:119], v[118:119], v[252:253]
  v_pk_mul_f32 v[122:123], v[122:123], v[252:253]
  v_pk_mul_f32 v[126:127], v[126:127], v[252:253]
  v_cvt_pk_bf16_f32 v216, v98, v102
  v_cvt_pk_bf16_f32 v217, v106, v110
  v_cvt_pk_bf16_f32 v218, v114, v118
  v_cvt_pk_bf16_f32 v219, v122, v126
  v_cvt_pk_bf16_f32 v220, v99, v103
  v_cvt_pk_bf16_f32 v221, v107, v111
  v_cvt_pk_bf16_f32 v222, v115, v119
  v_cvt_pk_bf16_f32 v223, v123, v127
  ds_read_b64_tr_b16 v[72:73], v235 offset:10240
  ds_read_b64_tr_b16 v[74:75], v235 offset:10304
  ds_read_b64_tr_b16 v[76:77], v235 offset:11264
  ds_read_b64_tr_b16 v[78:79], v235 offset:11328
  ds_write_b128 v232, v[216:219] offset:12800
  ds_write_b128 v232, v[220:223] offset:13056
  s_waitcnt lgkmcnt(10)
  buffer_store_dwordx4 v[64:67], v233, s[16:19], s34 offen nt
  s_waitcnt lgkmcnt(8)
  buffer_store_dwordx4 v[68:71], v233, s[16:19], s34 offen offset:1024 nt
  v_mfma_f32_16x16x32_bf16 v[196:199], a[144:147], a[92:95], v[228:231]
  v_exp_f32_e64 v201, v201
  v_mfma_f32_16x16x32_bf16 v[196:199], a[148:151], a[88:91], v[196:199]
  v_exp_f32_e64 v206, v206
  v_mfma_f32_16x16x32_bf16 v[196:199], a[152:155], a[84:87], v[196:199]
  s_waitcnt lgkmcnt(4)
  v_cvt_pk_bf16_f32 v208, v200, v201
  v_cvt_pk_bf16_f32 v211, v206, v207
  v_mfma_f32_16x16x32_bf16 v[196:199], a[156:159], a[80:83], v[196:199]
  ds_read_b128 a[128:131], v249 offset:33792
  ds_read_b64_tr_b16 v[96:97], v235 offset:12288
  v_mfma_f32_16x16x32_bf16 v[128:131], v[208:211], a[160:163], v[128:131]
  ds_read_b128 a[136:139], v249 offset:33920
  ds_read_b128 a[148:151], v249 offset:34432
  v_mfma_f32_16x16x32_bf16 v[132:135], v[208:211], a[164:167], v[132:135]
  buffer_store_dwordx4 v[72:75], v233, s[16:19], s34 offen offset:2048 nt
  ds_read_b128 a[132:135], v249 offset:33856
  ds_read_b128 a[156:159], v249 offset:34304
  v_mfma_f32_16x16x32_bf16 v[136:139], v[208:211], a[168:171], v[136:139]
  s_waitcnt lgkmcnt(8)
  buffer_store_dwordx4 v[76:79], v233, s[16:19], s34 offen offset:3072 nt
  ds_read_b64_tr_b16 v[98:99], v235 offset:12352
  v_mul_f32_e64 v203, s29, v195
  v_mfma_f32_16x16x32_bf16 v[140:143], v[208:211], a[172:175], v[140:143]
  ds_read_b64_tr_b16 v[100:101], v235 offset:13312
  ds_read_b64_tr_b16 v[102:103], v235 offset:13376
  v_mfma_f32_16x16x32_bf16 v[144:147], v[208:211], a[176:179], v[144:147]
  ds_read_b128 a[144:147], v249 offset:34496
  v_mul_f32_e64 v201, s29, v193
  v_mfma_f32_16x16x32_bf16 v[148:151], v[208:211], a[180:183], v[148:151]
  ds_read_b64_tr_b16 v[104:105], v235 offset:14336
  ds_read_b64_tr_b16 v[106:107], v235 offset:14400
  ds_read_b64_tr_b16 v[108:109], v235 offset:15360
  ds_read_b64_tr_b16 v[110:111], v235 offset:15424
  v_mfma_f32_16x16x32_bf16 v[152:155], v[208:211], a[184:187], v[152:155]
  ds_read_b128 a[152:155], v249 offset:34368
  v_mul_f32_e64 v200, s29, v192
  v_mfma_f32_16x16x32_bf16 v[156:159], v[208:211], a[188:191], v[156:159]
  s_waitcnt lgkmcnt(14)
  v_mul_f32 v202, s29, v194
  v_mul_f32_e64 v207, s29, v199
  v_mfma_f32_16x16x32_bf16 v[192:195], a[128:131], a[96:99], v[228:231]
  s_waitcnt lgkmcnt(8)
  buffer_store_dwordx4 v[96:99], v233, s[16:19], s36 offen nt
  v_mul_f32 v205, s29, v197
  v_mul_f32_e64 v206, s29, v198
  v_mfma_f32_16x16x32_bf16 v[192:195], a[132:135], a[100:103], v[192:195]
  s_waitcnt lgkmcnt(6)
  buffer_store_dwordx4 v[100:103], v233, s[16:19], s36 offen offset:1024 nt
  v_exp_f32 v205, v205
  v_mfma_f32_16x16x32_bf16 v[192:195], a[136:139], a[104:107], v[192:195]
  s_waitcnt lgkmcnt(3)
  buffer_store_dwordx4 v[104:107], v233, s[16:19], s36 offen offset:2048 nt
  v_exp_f32 v203, v203
  v_mfma_f32_16x16x32_bf16 v[192:195], a[140:143], a[108:111], v[192:195]
  s_waitcnt lgkmcnt(1)
  buffer_store_dwordx4 v[108:111], v233, s[16:19], s36 offen offset:3072 nt
  v_mul_f32 v204, s29, v196
  v_mfma_f32_16x16x32_bf16 v[196:199], a[144:147], a[108:111], v[228:231]
  v_exp_f32_e64 v202, v202
  v_mfma_f32_16x16x32_bf16 v[196:199], a[148:151], a[104:107], v[196:199]
  s_waitcnt lgkmcnt(0)
  v_exp_f32 v200, v200
  v_exp_f32 v201, v201
  v_exp_f32 v204, v204
  v_exp_f32 v206, v206
  v_exp_f32 v207, v207
  v_mfma_f32_16x16x32_bf16 v[196:199], a[152:155], a[100:103], v[196:199]
  v_cvt_pk_bf16_f32 v212, v200, v201
  v_cvt_pk_bf16_f32 v213, v202, v203
  v_cvt_pk_bf16_f32 v214, v204, v205
  v_cvt_pk_bf16_f32 v215, v206, v207
  v_mfma_f32_16x16x32_bf16 v[196:199], a[156:159], a[96:99], v[196:199]
  v_mul_f32 v201, s29, v193
  v_mul_f32 v202, s29, v194
  v_mfma_f32_16x16x32_bf16 v[160:163], v[212:215], a[160:163], v[160:163]
  ds_read_b64_tr_b16 a[162:163], v255 offset:42752
  v_mul_f32_e64 v203, s29, v195
  v_mfma_f32_16x16x32_bf16 v[164:167], v[212:215], a[164:167], v[164:167]
  ds_read_b64_tr_b16 a[164:165], v255 offset:42256
  ds_read_b64_tr_b16 a[166:167], v255 offset:42768
  v_mfma_f32_16x16x32_bf16 v[168:171], v[212:215], a[168:171], v[168:171]
  v_mul_f32 v205, s29, v197
  v_mul_f32 v206, s29, v198
  v_mfma_f32_16x16x32_bf16 v[172:175], v[212:215], a[172:175], v[172:175]
  ds_read_b64_tr_b16 a[174:175], v255 offset:42800
  v_mul_f32_e64 v200, s29, v192
  v_mfma_f32_16x16x32_bf16 v[176:179], v[212:215], a[176:179], v[176:179]
  v_exp_f32_e64 v203, v203
  v_mfma_f32_16x16x32_bf16 v[180:183], v[212:215], a[180:183], v[180:183]
  v_exp_f32_e64 v201, v201
  v_mfma_f32_16x16x32_bf16 v[184:187], v[212:215], a[184:187], v[184:187]
  ds_read_b64_tr_b16 a[182:183], v255 offset:42832
  v_mul_f32_e64 v207, s29, v199
  v_mfma_f32_16x16x32_bf16 v[188:191], v[212:215], a[188:191], v[188:191]
  v_exp_f32_e64 v207, v207
  v_smfmac_f32_16x16x64_bf16 a[200:203], a[220:223], v[208:215], v254
  ds_read_b64_tr_b16 a[168:169], v255 offset:42272
  v_mul_f32_e64 v204, s29, v196
  v_mfma_f32_16x16x32_bf16 v[192:195], a[128:131], a[64:67], v[228:231]
  v_exp_f32_e64 v202, v202
  v_mfma_f32_16x16x32_bf16 v[192:195], a[132:135], a[68:71], v[192:195]
  ds_read_b64_tr_b16 a[160:161], v255 offset:42240
  ds_read_b64_tr_b16 a[172:173], v255 offset:42288
  v_mfma_f32_16x16x32_bf16 v[192:195], a[136:139], a[72:75], v[192:195]
  v_exp_f32_e64 v206, v206
  v_mfma_f32_16x16x32_bf16 v[192:195], a[140:143], a[76:79], v[192:195]
  ds_read_b64_tr_b16 a[170:171], v255 offset:42784
  ds_read_b64_tr_b16 a[180:181], v255 offset:42320
  v_mfma_f32_16x16x32_bf16 v[196:199], a[144:147], a[76:79], v[228:231]
  v_exp_f32_e64 v200, v200
  v_mfma_f32_16x16x32_bf16 v[196:199], a[148:151], a[72:75], v[196:199]
  v_exp_f32 v204, v204
  v_exp_f32 v205, v205
  v_mfma_f32_16x16x32_bf16 v[196:199], a[152:155], a[68:71], v[196:199]
  ds_read_b64_tr_b16 a[176:177], v255 offset:42304
  ds_read_b64_tr_b16 a[178:179], v255 offset:42816
  v_cvt_pk_bf16_f32 v208, v200, v201
  v_cvt_pk_bf16_f32 v209, v202, v203
  v_cvt_pk_bf16_f32 v210, v204, v205
  v_cvt_pk_bf16_f32 v211, v206, v207
  v_mfma_f32_16x16x32_bf16 v[196:199], a[156:159], a[64:67], v[196:199]
  ds_read_b64_tr_b16 a[184:185], v255 offset:42336
  ds_read_b64_tr_b16 a[190:191], v255 offset:42864
  v_mfma_f32_16x16x32_bf16 a[204:207], a[220:223], v[208:211], a[204:207]
  ds_read_b64_tr_b16 a[186:187], v255 offset:42848
  v_mul_f32 v202, s29, v194
  s_waitcnt lgkmcnt(8)
  v_mfma_f32_16x16x32_bf16 a[224:227], v[208:211], a[160:163], a[224:227]
  ds_read_b64_tr_b16 a[188:189], v255 offset:42352
  v_mul_f32_e64 v201, s29, v193
  v_mfma_f32_16x16x32_bf16 a[228:231], v[208:211], a[164:167], a[228:231]
  s_waitcnt lgkmcnt(7)
  v_mul_f32 v203, s29, v195
  v_mul_f32_e64 v204, s29, v196
  v_mfma_f32_16x16x32_bf16 a[232:235], v[208:211], a[168:171], a[232:235]
  v_mul_f32 v200, s29, v192
  v_mul_f32 v206, s29, v198
  v_mfma_f32_16x16x32_bf16 a[236:239], v[208:211], a[172:175], a[236:239]
  s_waitcnt lgkmcnt(4)
  v_mul_f32 v205, s29, v197
  v_mul_f32_e64 v207, s29, v199
  v_mfma_f32_16x16x32_bf16 a[240:243], v[208:211], a[176:179], a[240:243]
  v_exp_f32_e64 v206, v206
  v_mfma_f32_16x16x32_bf16 a[244:247], v[208:211], a[180:183], a[244:247]
  s_waitcnt lgkmcnt(1)
  v_exp_f32 v205, v205
  v_mfma_f32_16x16x32_bf16 a[248:251], v[208:211], a[184:187], a[248:251]
  s_waitcnt lgkmcnt(0)
  v_exp_f32 v201, v201
  v_mfma_f32_16x16x32_bf16 a[252:255], v[208:211], a[188:191], a[252:255]
  v_exp_f32_e64 v204, v204
  v_mfma_f32_16x16x32_bf16 v[192:195], a[128:131], a[80:83], v[228:231]
  v_exp_f32_e64 v203, v203
  v_mfma_f32_16x16x32_bf16 v[192:195], a[132:135], a[84:87], v[192:195]
  v_exp_f32_e64 v207, v207
  v_mfma_f32_16x16x32_bf16 v[192:195], a[136:139], a[88:91], v[192:195]
  v_cvt_pk_bf16_f32 v210, v204, v205
  v_cvt_pk_bf16_f32 v211, v206, v207
  v_mfma_f32_16x16x32_bf16 v[192:195], a[140:143], a[92:95], v[192:195]
  v_exp_f32_e64 v202, v202
  v_mfma_f32_16x16x32_bf16 v[196:199], a[144:147], a[92:95], v[228:231]
  v_exp_f32_e64 v200, v200
  v_mfma_f32_16x16x32_bf16 v[196:199], a[148:151], a[88:91], v[196:199]
  v_cvt_pk_bf16_f32 v208, v200, v201
  v_cvt_pk_bf16_f32 v209, v202, v203
  v_mfma_f32_16x16x32_bf16 v[196:199], a[152:155], a[84:87], v[196:199]
  v_mul_f32 v200, s29, v192
  v_mul_f32 v203, s29, v195
  v_mfma_f32_16x16x32_bf16 v[196:199], a[156:159], a[80:83], v[196:199]
  v_exp_f32_e64 v200, v200
  v_mfma_f32_16x16x32_bf16 v[128:131], v[208:211], a[160:163], v[128:131]
  ds_write_b128 v234, a[224:227] offset:0
  v_mul_f32 v201, s29, v193
  v_mul_f32 v202, s29, v194
  v_mfma_f32_16x16x32_bf16 v[132:135], v[208:211], a[164:167], v[132:135]
  v_exp_f32_e64 v201, v201
  v_mfma_f32_16x16x32_bf16 v[136:139], v[208:211], a[168:171], v[136:139]
  ds_write_b128 v234, a[228:231] offset:1024
  v_mul_f32 v204, s29, v196
  v_mul_f32 v205, s29, v197
  v_mfma_f32_16x16x32_bf16 v[140:143], v[208:211], a[172:175], v[140:143]
  v_mul_f32 v206, s29, v198
  v_mul_f32 v207, s29, v199
  v_mfma_f32_16x16x32_bf16 v[144:147], v[208:211], a[176:179], v[144:147]
  v_exp_f32_e64 v207, v207
  v_mfma_f32_16x16x32_bf16 v[148:151], v[208:211], a[180:183], v[148:151]
  v_exp_f32 v202, v202
  v_exp_f32 v203, v203
  v_exp_f32 v204, v204
  v_exp_f32 v205, v205
  v_exp_f32_e64 v206, v206
  v_mfma_f32_16x16x32_bf16 v[152:155], v[208:211], a[184:187], v[152:155]
  ds_write_b128 v234, a[232:235] offset:2048
  v_cvt_pk_bf16_f32 v212, v200, v201
  v_cvt_pk_bf16_f32 v213, v202, v203
  v_cvt_pk_bf16_f32 v214, v204, v205
  v_cvt_pk_bf16_f32 v215, v206, v207
  v_mfma_f32_16x16x32_bf16 v[156:159], v[208:211], a[188:191], v[156:159]
  v_accvgpr_read_b32 v248, a204
  v_accvgpr_read_b32 v250, a206
  v_add_f32_e64 v248, v248, v250
  ds_write_b32 v238, v248 offset:0
  v_smfmac_f32_16x16x64_bf16 a[200:203], a[220:223], v[208:215], v254
  ds_write_b128 v234, a[236:239] offset:3072
  v_mfma_f32_16x16x32_bf16 v[160:163], v[212:215], a[160:163], v[160:163]
  v_mfma_f32_16x16x32_bf16 v[164:167], v[212:215], a[164:167], v[164:167]
  ds_write_b128 v234, a[240:243] offset:4096
  v_mfma_f32_16x16x32_bf16 v[168:171], v[212:215], a[168:171], v[168:171]
  v_accvgpr_read_b32 v246, a200
  v_accvgpr_read_b32 v250, a201
  v_mfma_f32_16x16x32_bf16 v[172:175], v[212:215], a[172:175], v[172:175]
  ds_write_b128 v234, a[244:247] offset:5120
  v_add_f32_e64 v246, v246, v250
  v_mfma_f32_16x16x32_bf16 v[176:179], v[212:215], a[176:179], v[176:179]
  v_rcp_f32_e64 v246, v246
  v_mfma_f32_16x16x32_bf16 v[180:183], v[212:215], a[180:183], v[180:183]
  ds_write_b128 v234, a[248:251] offset:6144
  v_accvgpr_read_b32 v247, a202
  v_accvgpr_read_b32 v251, a203
  v_mfma_f32_16x16x32_bf16 v[184:187], v[212:215], a[184:187], v[184:187]
  v_add_f32 v247, v247, v251
  v_rcp_f32 v247, v247
  v_mfma_f32_16x16x32_bf16 v[188:191], v[212:215], a[188:191], v[188:191]
  ds_write_b128 v234, a[252:255] offset:7168
  v_mfma_f32_16x16x4_f32 v[224:227], v246, a121, 0
  v_mfma_f32_16x16x4_f32 v[250:253], v247, a121, 0
  s_waitcnt lgkmcnt(0)
  s_barrier
  ds_read_b32 v112, v239 offset:0
  ds_read_b32 v113, v239 offset:256
  ds_read_b32 v114, v239 offset:512
  ds_read_b32 v115, v239 offset:768
  ds_read_b128 v[64:67], v236 offset:0
  ds_read_b128 v[68:71], v236 offset:1024
  ds_read_b128 v[72:75], v236 offset:24576
  ds_read_b128 v[76:79], v236 offset:25600
  ds_read_b128 v[80:83], v237 offset:0
  ds_read_b128 v[84:87], v237 offset:1024
  ds_read_b128 v[88:91], v237 offset:24576
  ds_read_b128 v[92:95], v237 offset:25600
  v_pk_mul_f32 v[128:129], v[128:129], v[224:225]
  v_pk_mul_f32 v[132:133], v[132:133], v[224:225]
  v_pk_mul_f32 v[136:137], v[136:137], v[224:225]
  v_pk_mul_f32 v[140:141], v[140:141], v[224:225]
  v_pk_mul_f32 v[144:145], v[144:145], v[224:225]
  v_pk_mul_f32 v[148:149], v[148:149], v[224:225]
  v_pk_mul_f32 v[152:153], v[152:153], v[224:225]
  v_pk_mul_f32 v[156:157], v[156:157], v[224:225]
  v_cvt_pk_bf16_f32 v216, v128, v132
  v_cvt_pk_bf16_f32 v217, v136, v140
  v_cvt_pk_bf16_f32 v218, v144, v148
  v_cvt_pk_bf16_f32 v219, v152, v156
  v_cvt_pk_bf16_f32 v220, v129, v133
  v_cvt_pk_bf16_f32 v221, v137, v141
  v_cvt_pk_bf16_f32 v222, v145, v149
  v_cvt_pk_bf16_f32 v223, v153, v157
  ds_write_b128 v232, v[216:219] offset:16384
  ds_write_b128 v232, v[220:223] offset:16640
  v_pk_mul_f32 v[130:131], v[130:131], v[226:227]
  v_pk_mul_f32 v[134:135], v[134:135], v[226:227]
  v_pk_mul_f32 v[138:139], v[138:139], v[226:227]
  v_pk_mul_f32 v[142:143], v[142:143], v[226:227]
  v_pk_mul_f32 v[146:147], v[146:147], v[226:227]
  v_pk_mul_f32 v[150:151], v[150:151], v[226:227]
  v_pk_mul_f32 v[154:155], v[154:155], v[226:227]
  v_pk_mul_f32 v[158:159], v[158:159], v[226:227]
  v_cvt_pk_bf16_f32 v216, v130, v134
  v_cvt_pk_bf16_f32 v217, v138, v142
  v_cvt_pk_bf16_f32 v218, v146, v150
  v_cvt_pk_bf16_f32 v219, v154, v158
  v_cvt_pk_bf16_f32 v220, v131, v135
  v_cvt_pk_bf16_f32 v221, v139, v143
  v_cvt_pk_bf16_f32 v222, v147, v151
  v_cvt_pk_bf16_f32 v223, v155, v159
  ds_write_b128 v232, v[216:219] offset:16896
  ds_write_b128 v232, v[220:223] offset:17152
  s_waitcnt lgkmcnt(14)
  v_add_f32 v112, v112, v113
  s_waitcnt lgkmcnt(12)
  v_add_f32 v114, v114, v115
  v_add_f32 v248, v112, v114
  v_rcp_f32 v248, v248
  s_lshl_b32 s24, s28, 2
  s_add_u32 s25, s24, 1
  s_add_u32 s26, s24, 2
  s_add_u32 s27, s24, 3
  v_readlane_b32 s20, v248, s24
  v_readlane_b32 s21, v248, s25
  v_readlane_b32 s22, v248, s26
  v_readlane_b32 s23, v248, s27
  s_waitcnt lgkmcnt(9)
  v_pk_add_f32 v[64:65], v[64:65], v[72:73]
  v_pk_add_f32 v[66:67], v[66:67], v[74:75]
  s_waitcnt lgkmcnt(8)
  v_pk_add_f32 v[68:69], v[68:69], v[76:77]
  v_pk_add_f32 v[70:71], v[70:71], v[78:79]
  s_waitcnt lgkmcnt(5)
  v_pk_add_f32 v[80:81], v[80:81], v[88:89]
  v_pk_add_f32 v[82:83], v[82:83], v[90:91]
  s_waitcnt lgkmcnt(4)
  v_pk_add_f32 v[84:85], v[84:85], v[92:93]
  v_pk_add_f32 v[86:87], v[86:87], v[94:95]
  v_pk_add_f32 v[64:65], v[64:65], v[80:81]
  v_pk_add_f32 v[66:67], v[66:67], v[82:83]
  v_pk_add_f32 v[68:69], v[68:69], v[84:85]
  v_pk_add_f32 v[70:71], v[70:71], v[86:87]
  v_pk_mul_f32 v[64:65], v[64:65], s[20:21]
  v_pk_mul_f32 v[66:67], v[66:67], s[22:23]
  v_pk_mul_f32 v[68:69], v[68:69], s[20:21]
  v_pk_mul_f32 v[70:71], v[70:71], s[22:23]
  v_cvt_pk_bf16_f32 v64, v64, v68
  v_cvt_pk_bf16_f32 v65, v65, v69
  v_cvt_pk_bf16_f32 v66, v66, v70
  v_cvt_pk_bf16_f32 v67, v67, v71
  ds_write2st64_b32 v240, v64, v65 offset0:0 offset1:1
  ds_write2st64_b32 v240, v66, v67 offset0:2 offset1:3
  v_pk_mul_f32 v[160:161], v[160:161], v[250:251]
  v_pk_mul_f32 v[164:165], v[164:165], v[250:251]
  v_pk_mul_f32 v[168:169], v[168:169], v[250:251]
  v_pk_mul_f32 v[172:173], v[172:173], v[250:251]
  v_pk_mul_f32 v[176:177], v[176:177], v[250:251]
  v_pk_mul_f32 v[180:181], v[180:181], v[250:251]
  v_pk_mul_f32 v[184:185], v[184:185], v[250:251]
  v_pk_mul_f32 v[188:189], v[188:189], v[250:251]
  v_cvt_pk_bf16_f32 v216, v160, v164
  v_cvt_pk_bf16_f32 v217, v168, v172
  v_cvt_pk_bf16_f32 v218, v176, v180
  v_cvt_pk_bf16_f32 v219, v184, v188
  v_cvt_pk_bf16_f32 v220, v161, v165
  v_cvt_pk_bf16_f32 v221, v169, v173
  v_cvt_pk_bf16_f32 v222, v177, v181
  v_cvt_pk_bf16_f32 v223, v185, v189
  ds_read_b64_tr_b16 v[128:129], v235 offset:16384
  ds_read_b64_tr_b16 v[130:131], v235 offset:16448
  ds_read_b64_tr_b16 v[132:133], v235 offset:17408
  ds_read_b64_tr_b16 v[134:135], v235 offset:17472
  ds_write_b128 v232, v[216:219] offset:20480
  ds_write_b128 v232, v[220:223] offset:20736
  v_pk_mul_f32 v[162:163], v[162:163], v[252:253]
  v_pk_mul_f32 v[166:167], v[166:167], v[252:253]
  v_pk_mul_f32 v[170:171], v[170:171], v[252:253]
  v_pk_mul_f32 v[174:175], v[174:175], v[252:253]
  v_pk_mul_f32 v[178:179], v[178:179], v[252:253]
  v_pk_mul_f32 v[182:183], v[182:183], v[252:253]
  v_pk_mul_f32 v[186:187], v[186:187], v[252:253]
  v_pk_mul_f32 v[190:191], v[190:191], v[252:253]
  v_cvt_pk_bf16_f32 v216, v162, v166
  v_cvt_pk_bf16_f32 v217, v170, v174
  v_cvt_pk_bf16_f32 v218, v178, v182
  v_cvt_pk_bf16_f32 v219, v186, v190
  v_cvt_pk_bf16_f32 v220, v163, v167
  v_cvt_pk_bf16_f32 v221, v171, v175
  v_cvt_pk_bf16_f32 v222, v179, v183
  v_cvt_pk_bf16_f32 v223, v187, v191
  ds_read_b64_tr_b16 v[136:137], v235 offset:18432
  ds_read_b64_tr_b16 v[138:139], v235 offset:18496
  ds_read_b64_tr_b16 v[140:141], v235 offset:19456
  ds_read_b64_tr_b16 v[142:143], v235 offset:19520
  ds_read_b64_tr_b16 v[72:73], v241 offset:0
  ds_read_b64_tr_b16 v[74:75], v241 offset:64
  ds_write_b128 v232, v[216:219] offset:20992
  ds_write_b128 v232, v[220:223] offset:21248
  s_waitcnt lgkmcnt(12)
  buffer_store_dwordx4 v[128:131], v233, s[16:19], s30 offen nt
  s_waitcnt lgkmcnt(10)
  buffer_store_dwordx4 v[132:135], v233, s[16:19], s30 offen offset:1024 nt
  ds_read_b64_tr_b16 v[160:161], v235 offset:20480
  ds_read_b64_tr_b16 v[162:163], v235 offset:20544
  ds_read_b64_tr_b16 v[164:165], v235 offset:21504
  ds_read_b64_tr_b16 v[166:167], v235 offset:21568
  s_waitcnt lgkmcnt(10)
  buffer_store_dwordx4 v[136:139], v233, s[16:19], s30 offen offset:2048 nt
  s_waitcnt lgkmcnt(8)
  buffer_store_dwordx4 v[140:143], v233, s[16:19], s30 offen offset:3072 nt
  ds_read_b64_tr_b16 v[168:169], v235 offset:22528
  ds_read_b64_tr_b16 v[170:171], v235 offset:22592
  ds_read_b64_tr_b16 v[172:173], v235 offset:23552
  ds_read_b64_tr_b16 v[174:175], v235 offset:23616
  s_waitcnt lgkmcnt(6)
  buffer_store_dwordx4 v[160:163], v233, s[16:19], s31 offen nt
  s_waitcnt lgkmcnt(4)
  buffer_store_dwordx4 v[164:167], v233, s[16:19], s31 offen offset:1024 nt
  s_waitcnt lgkmcnt(2)
  buffer_store_dwordx4 v[168:171], v233, s[16:19], s31 offen offset:2048 nt
  s_waitcnt lgkmcnt(0)
  buffer_store_dwordx4 v[172:175], v233, s[16:19], s31 offen offset:3072 nt
  s_lshl_b32 s52, s28, 10
  s_add_u32 s52, s52, s40
  buffer_store_dwordx4 v[72:75], v233, s[16:19], s52 offen nt
  v_max3_u32 v250, v242, v243, v244
  v_min3_u32 v251, v242, v243, v244
  v_max3_u32 v250, v250, v245, v246
  v_min3_u32 v251, v251, v245, v246
  v_max_u32 v250, v250, v247
  v_min_u32 v251, v251, v247
  v_cmp_lt_u32 s[20:21], s54, v250
  v_cmp_gt_u32 s[22:23], s53, v251
  v_cmp_lt_u32 s[24:25], s54, v248
  v_cmp_gt_u32 s[26:27], s53, v248
  s_nop 2
  s_or_b64 s[20:21], s[20:21], s[22:23]
  s_addc_u32 s48, s48, s48
  s_or_b64 s[24:25], s[24:25], s[26:27]
  s_addc_u32 s48, s48, s48
  s_barrier
  s_branch L_fin
L_lastB2:
  s_add_u32 s50, s28, 1
  s_bitcmp1_b32 s50, 1
  s_cselect_b32 s50, 2048, 0
  s_sub_u32 s35, s35, s50
  v_mov_b32 v249, v216
  v_mov_b32_e64 v255, v217
  s_waitcnt lgkmcnt(0)
  v_mfma_f32_16x16x32_bf16 v[192:195], a[128:131], a[0:3], v[228:231]
  s_add_u32 s33, s39, 4096
  v_mul_f32_e64 v207, s29, v199
  v_cvt_pk_bf16_f32 v212, v200, v201
  v_mfma_f32_16x16x32_bf16 v[192:195], a[132:135], a[4:7], v[192:195]
  s_add_u32 s34, s39, 8192
  v_exp_f32_e64 v205, v205
  v_mfma_f32_16x16x32_bf16 v[192:195], a[136:139], a[8:11], v[192:195]
  s_add_u32 s36, s39, 12288
  v_mul_f32_e64 v206, s29, v198
  v_cvt_pk_bf16_f32 v213, v202, v203
  v_mfma_f32_16x16x32_bf16 v[192:195], a[140:143], a[12:15], v[192:195]
  s_add_u32 s30, s39, 16384
  v_exp_f32_e64 v207, v207
  v_mfma_f32_16x16x32_bf16 v[196:199], a[144:147], a[12:15], v[228:231]
  s_add_u32 s31, s39, 20480
  v_exp_f32_e64 v206, v206
  v_mfma_f32_16x16x32_bf16 v[196:199], a[148:151], a[8:11], v[196:199]
  v_exp_f32_e64 v204, v204
  v_mfma_f32_16x16x32_bf16 v[196:199], a[152:155], a[4:7], v[196:199]
  v_cvt_pk_bf16_f32 v214, v204, v205
  v_cvt_pk_bf16_f32 v215, v206, v207
  v_mfma_f32_16x16x32_bf16 v[196:199], a[156:159], a[0:3], v[196:199]
  v_mul_f32 v200, s29, v192
  v_mul_f32 v203, s29, v195
  v_mfma_f32_16x16x32_bf16 v[160:163], v[212:215], a[160:163], v[160:163]
  ds_read_b64_tr_b16 a[162:163], v255 offset:8960
  v_mul_f32_e64 v201, s29, v193
  v_mfma_f32_16x16x32_bf16 v[164:167], v[212:215], a[164:167], v[164:167]
  v_exp_f32_e64 v200, v200
  v_mfma_f32_16x16x32_bf16 v[168:171], v[212:215], a[168:171], v[168:171]
  v_mul_f32 v205, s29, v197
  v_mul_f32 v207, s29, v199
  v_mfma_f32_16x16x32_bf16 v[172:175], v[212:215], a[172:175], v[172:175]
  ds_read_b64_tr_b16 a[174:175], v255 offset:9008
  v_mul_f32_e64 v202, s29, v194
  v_mfma_f32_16x16x32_bf16 v[176:179], v[212:215], a[176:179], v[176:179]
  ds_read_b64_tr_b16 a[160:161], v255 offset:8448
  v_mul_f32_e64 v204, s29, v196
  v_mfma_f32_16x16x32_bf16 v[180:183], v[212:215], a[180:183], v[180:183]
  ds_read_b64_tr_b16 a[164:165], v255 offset:8464
  v_mul_f32_e64 v206, s29, v198
  v_mfma_f32_16x16x32_bf16 v[184:187], v[212:215], a[184:187], v[184:187]
  ds_read_b64_tr_b16 a[166:167], v255 offset:8976
  ds_read_b64_tr_b16 a[168:169], v255 offset:8480
  v_mfma_f32_16x16x32_bf16 v[188:191], v[212:215], a[188:191], v[188:191]
  v_exp_f32_e64 v206, v206
  v_smfmac_f32_16x16x64_bf16 a[200:203], a[220:223], v[208:215], v254
  ds_read_b64_tr_b16 a[172:173], v255 offset:8496
  ds_read_b64_tr_b16 a[180:181], v255 offset:8528
  s_waitcnt vmcnt(7)
  s_barrier
  v_mfma_f32_16x16x32_bf16 v[192:195], a[128:131], a[16:19], v[228:231]
  v_exp_f32_e64 v207, v207
  v_mfma_f32_16x16x32_bf16 v[192:195], a[132:135], a[20:23], v[192:195]
  v_exp_f32_e64 v201, v201
  v_mfma_f32_16x16x32_bf16 v[192:195], a[136:139], a[24:27], v[192:195]
  v_exp_f32_e64 v204, v204
  v_mfma_f32_16x16x32_bf16 v[192:195], a[140:143], a[28:31], v[192:195]
  ds_read_b64_tr_b16 a[170:171], v255 offset:8992
  v_cvt_pk_bf16_f32 v211, v206, v207
  v_mfma_f32_16x16x32_bf16 v[196:199], a[144:147], a[28:31], v[228:231]
  v_exp_f32_e64 v203, v203
  v_mfma_f32_16x16x32_bf16 v[196:199], a[148:151], a[24:27], v[196:199]
  ds_read_b64_tr_b16 a[176:177], v255 offset:8512
  ds_read_b64_tr_b16 a[178:179], v255 offset:9024
  v_exp_f32 v202, v202
  v_exp_f32 v205, v205
  v_mfma_f32_16x16x32_bf16 v[196:199], a[152:155], a[20:23], v[196:199]
  ds_read_b64_tr_b16 a[182:183], v255 offset:9040
  v_cvt_pk_bf16_f32 v208, v200, v201
  v_cvt_pk_bf16_f32 v209, v202, v203
  v_cvt_pk_bf16_f32 v210, v204, v205
  v_mfma_f32_16x16x32_bf16 v[196:199], a[156:159], a[16:19], v[196:199]
  ds_read_b64_tr_b16 a[184:185], v255 offset:8544
  ds_read_b64_tr_b16 a[186:187], v255 offset:9056
  s_waitcnt lgkmcnt(11)
  v_mfma_f32_16x16x32_bf16 v[0:3], v[208:211], a[160:163], v[0:3]
  ds_read_b64_tr_b16 a[188:189], v255 offset:8560
  ds_read_b64_tr_b16 a[190:191], v255 offset:9072
  s_waitcnt lgkmcnt(11)
  v_mfma_f32_16x16x32_bf16 v[4:7], v[208:211], a[164:167], v[4:7]
  ds_read_b128 a[128:131], v249 offset:33792
  v_mul_f32 v200, s29, v192
  s_waitcnt lgkmcnt(8)
  v_mfma_f32_16x16x32_bf16 v[8:11], v[208:211], a[168:171], v[8:11]
  ds_read_b128 a[132:135], v249 offset:33856
  ds_read_b128 a[144:147], v249 offset:34496
  v_mfma_f32_16x16x32_bf16 v[12:15], v[208:211], a[172:175], v[12:15]
  ds_read_b128 a[136:139], v249 offset:33920
  v_mul_f32 v201, s29, v193
  s_waitcnt lgkmcnt(9)
  v_mfma_f32_16x16x32_bf16 v[16:19], v[208:211], a[176:179], v[16:19]
  ds_read_b128 a[140:143], v249 offset:33984
  ds_read_b128 a[152:155], v249 offset:34368
  s_waitcnt lgkmcnt(10)
  v_mfma_f32_16x16x32_bf16 v[20:23], v[208:211], a[180:183], v[20:23]
  ds_read_b128 a[156:159], v249 offset:34304
  v_mul_f32_e64 v203, s29, v195
  s_waitcnt lgkmcnt(9)
  v_mfma_f32_16x16x32_bf16 v[24:27], v[208:211], a[184:187], v[24:27]
  ds_read_b128 a[148:151], v249 offset:34432
  v_mul_f32 v205, s29, v197
  s_waitcnt lgkmcnt(8)
  v_mfma_f32_16x16x32_bf16 v[28:31], v[208:211], a[188:191], v[28:31]
  s_waitcnt lgkmcnt(7)
  v_mul_f32 v202, s29, v194
  v_mul_f32_e64 v207, s29, v199
  v_mfma_f32_16x16x32_bf16 v[192:195], a[128:131], a[0:3], v[228:231]
  s_waitcnt lgkmcnt(6)
  v_exp_f32 v202, v202
  v_mfma_f32_16x16x32_bf16 v[192:195], a[132:135], a[4:7], v[192:195]
  s_waitcnt lgkmcnt(4)
  v_exp_f32 v205, v205
  v_mfma_f32_16x16x32_bf16 v[192:195], a[136:139], a[8:11], v[192:195]
  s_waitcnt lgkmcnt(3)
  v_exp_f32 v203, v203
  v_mfma_f32_16x16x32_bf16 v[192:195], a[140:143], a[12:15], v[192:195]
  s_waitcnt lgkmcnt(0)
  v_mul_f32 v204, s29, v196
  v_mul_f32_e64 v206, s29, v198
  v_mfma_f32_16x16x32_bf16 v[196:199], a[144:147], a[12:15], v[228:231]
  ds_read_b64_tr_b16 a[112:113], v235 offset:20480
  v_cvt_pk_bf16_f32 v213, v202, v203
  v_mfma_f32_16x16x32_bf16 v[196:199], a[148:151], a[8:11], v[196:199]
  v_exp_f32 v200, v200
  v_exp_f32 v201, v201
  v_exp_f32 v204, v204
  v_exp_f32 v206, v206
  v_exp_f32_e64 v207, v207
  v_mfma_f32_16x16x32_bf16 v[196:199], a[152:155], a[4:7], v[196:199]
  v_cvt_pk_bf16_f32 v212, v200, v201
  v_cvt_pk_bf16_f32 v214, v204, v205
  v_cvt_pk_bf16_f32 v215, v206, v207
  v_mfma_f32_16x16x32_bf16 v[196:199], a[156:159], a[0:3], v[196:199]
  v_mul_f32 v200, s29, v192
  v_mul_f32 v203, s29, v195
  v_mfma_f32_16x16x32_bf16 v[32:35], v[212:215], a[160:163], v[32:35]
  ds_read_b64_tr_b16 a[160:161], v255 offset:42240
  v_mul_f32_e64 v201, s29, v193
  v_mfma_f32_16x16x32_bf16 v[36:39], v[212:215], a[164:167], v[36:39]
  ds_read_b64_tr_b16 a[162:163], v255 offset:42752
  v_mul_f32_e64 v202, s29, v194
  v_mfma_f32_16x16x32_bf16 v[40:43], v[212:215], a[168:171], v[40:43]
  ds_read_b64_tr_b16 a[166:167], v255 offset:42768
  v_mul_f32_e64 v205, s29, v197
  v_mfma_f32_16x16x32_bf16 v[44:47], v[212:215], a[172:175], v[44:47]
  ds_read_b64_tr_b16 a[164:165], v255 offset:42256
  ds_read_b64_tr_b16 a[168:169], v255 offset:42272
  v_mfma_f32_16x16x32_bf16 v[48:51], v[212:215], a[176:179], v[48:51]
  v_exp_f32_e64 v202, v202
  v_mfma_f32_16x16x32_bf16 v[52:55], v[212:215], a[180:183], v[52:55]
  ds_read_b64_tr_b16 a[172:173], v255 offset:42288
  ds_read_b64_tr_b16 a[176:177], v255 offset:42304
  v_mfma_f32_16x16x32_bf16 v[56:59], v[212:215], a[184:187], v[56:59]
  ds_read_b64_tr_b16 a[178:179], v255 offset:42816
  v_mul_f32_e64 v204, s29, v196
  v_mfma_f32_16x16x32_bf16 v[60:63], v[212:215], a[188:191], v[60:63]
  v_exp_f32_e64 v205, v205
  v_smfmac_f32_16x16x64_bf16 a[192:195], a[220:223], v[208:215], v254
  ds_read_b64_tr_b16 a[170:171], v255 offset:42784
  ds_read_b64_tr_b16 a[182:183], v255 offset:42832
  v_mfma_f32_16x16x32_bf16 v[192:195], a[128:131], a[16:19], v[228:231]
  v_exp_f32_e64 v200, v200
  v_mfma_f32_16x16x32_bf16 v[192:195], a[132:135], a[20:23], v[192:195]
  ds_read_b64_tr_b16 a[188:189], v255 offset:42352
  v_mul_f32_e64 v206, s29, v198
  v_mfma_f32_16x16x32_bf16 v[192:195], a[136:139], a[24:27], v[192:195]
  v_exp_f32_e64 v206, v206
  v_mfma_f32_16x16x32_bf16 v[192:195], a[140:143], a[28:31], v[192:195]
  ds_read_b64_tr_b16 a[180:181], v255 offset:42320
  v_mul_f32_e64 v207, s29, v199
  v_mfma_f32_16x16x32_bf16 v[196:199], a[144:147], a[28:31], v[228:231]
  ds_read_b64_tr_b16 a[174:175], v255 offset:42800
  ds_read_b64_tr_b16 a[190:191], v255 offset:42864
  v_mfma_f32_16x16x32_bf16 v[196:199], a[148:151], a[24:27], v[196:199]
  v_exp_f32 v201, v201
  v_exp_f32 v203, v203
  v_exp_f32 v204, v204
  v_exp_f32 v207, v207
  v_mfma_f32_16x16x32_bf16 v[196:199], a[152:155], a[20:23], v[196:199]
  s_waitcnt lgkmcnt(12)
  v_cvt_pk_bf16_f32 v208, v200, v201
  v_cvt_pk_bf16_f32 v209, v202, v203
  v_cvt_pk_bf16_f32 v210, v204, v205
  v_cvt_pk_bf16_f32 v211, v206, v207
  v_mfma_f32_16x16x32_bf16 v[196:199], a[156:159], a[16:19], v[196:199]
  ds_read_b64_tr_b16 a[184:185], v255 offset:42336
  ds_read_b64_tr_b16 a[186:187], v255 offset:42848
  v_mfma_f32_16x16x32_bf16 v[0:3], v[208:211], a[160:163], v[0:3]
  s_waitcnt lgkmcnt(12)
  v_mul_f32 v200, s29, v192
  v_mul_f32 v201, s29, v193
  v_mfma_f32_16x16x32_bf16 v[4:7], v[208:211], a[164:167], v[4:7]
  s_waitcnt lgkmcnt(7)
  v_mul_f32 v202, s29, v194
  v_mul_f32_e64 v203, s29, v195
  v_mfma_f32_16x16x32_bf16 v[8:11], v[208:211], a[168:171], v[8:11]
  s_waitcnt lgkmcnt(3)
  v_mul_f32 v205, s29, v197
  v_mul_f32_e64 v207, s29, v199
  v_mfma_f32_16x16x32_bf16 v[12:15], v[208:211], a[172:175], v[12:15]
  v_exp_f32_e64 v203, v203
  v_mfma_f32_16x16x32_bf16 v[16:19], v[208:211], a[176:179], v[16:19]
  v_mul_f32 v204, s29, v196
  v_mul_f32 v206, s29, v198
  v_mfma_f32_16x16x32_bf16 v[20:23], v[208:211], a[180:183], v[20:23]
  s_waitcnt lgkmcnt(0)
  v_exp_f32 v206, v206
  v_mfma_f32_16x16x32_bf16 v[24:27], v[208:211], a[184:187], v[24:27]
  v_exp_f32_e64 v202, v202
  v_mfma_f32_16x16x32_bf16 v[28:31], v[208:211], a[188:191], v[28:31]
  v_exp_f32_e64 v200, v200
  v_mfma_f32_16x16x32_bf16 v[192:195], a[128:131], a[32:35], v[228:231]
  v_exp_f32_e64 v205, v205
  v_mfma_f32_16x16x32_bf16 v[192:195], a[132:135], a[36:39], v[192:195]
  v_exp_f32_e64 v201, v201
  v_mfma_f32_16x16x32_bf16 v[192:195], a[136:139], a[40:43], v[192:195]
  v_cvt_pk_bf16_f32 v212, v200, v201
  v_cvt_pk_bf16_f32 v213, v202, v203
  v_mfma_f32_16x16x32_bf16 v[192:195], a[140:143], a[44:47], v[192:195]
  v_exp_f32_e64 v204, v204
  v_mfma_f32_16x16x32_bf16 v[196:199], a[144:147], a[44:47], v[228:231]
  v_exp_f32_e64 v207, v207
  v_mfma_f32_16x16x32_bf16 v[196:199], a[148:151], a[40:43], v[196:199]
  ds_read_b64_tr_b16 a[114:115], v235 offset:20544
  v_cvt_pk_bf16_f32 v215, v206, v207
  v_mfma_f32_16x16x32_bf16 v[196:199], a[152:155], a[36:39], v[196:199]
  ds_read_b64_tr_b16 a[116:117], v235 offset:21504
  ds_read_b64_tr_b16 a[118:119], v235 offset:21568
  v_cvt_pk_bf16_f32 v214, v204, v205
  v_mfma_f32_16x16x32_bf16 v[196:199], a[156:159], a[32:35], v[196:199]
  v_mul_f32 v200, s29, v192
  v_mul_f32 v203, s29, v195
  v_smfmac_f32_16x16x64_bf16 a[192:195], a[220:223], v[208:215], v254
  v_mul_f32_e64 v201, s29, v193
  v_mfma_f32_16x16x32_bf16 v[32:35], v[212:215], a[160:163], v[32:35]
  s_waitcnt lgkmcnt(0)
  v_exp_f32 v201, v201
  v_mfma_f32_16x16x32_bf16 v[36:39], v[212:215], a[164:167], v[36:39]
  s_waitcnt lgkmcnt(2)
  v_mul_f32 v202, s29, v194
  v_mul_f32_e64 v204, s29, v196
  v_mfma_f32_16x16x32_bf16 v[40:43], v[212:215], a[168:171], v[40:43]
  buffer_store_dwordx4 a[112:115], v233, s[16:19], s35 offen nt
  v_accvgpr_read_b32 v242, a192
  v_accvgpr_read_b32 v250, a193
  v_mfma_f32_16x16x32_bf16 v[44:47], v[212:215], a[172:175], v[44:47]
  buffer_store_dwordx4 a[116:119], v233, s[16:19], s35 offen offset:1024 nt
  v_add_f32 v242, v242, v250
  v_mul_f32 v207, s29, v199
  v_mfma_f32_16x16x32_bf16 v[48:51], v[212:215], a[176:179], v[48:51]
  ds_read_b64_tr_b16 a[112:113], v235 offset:22528
  ds_read_b64_tr_b16 a[114:115], v235 offset:22592
  ds_read_b64_tr_b16 a[116:117], v235 offset:23552
  ds_read_b64_tr_b16 a[118:119], v235 offset:23616
  v_mfma_f32_16x16x32_bf16 v[52:55], v[212:215], a[180:183], v[52:55]
  v_rcp_f32_e64 v242, v242
  v_mfma_f32_16x16x32_bf16 v[56:59], v[212:215], a[184:187], v[56:59]
  v_accvgpr_read_b32 v243, a194
  v_accvgpr_read_b32 v251, a195
  v_add_f32 v243, v243, v251
  v_rcp_f32 v243, v243
  v_mfma_f32_16x16x32_bf16 v[60:63], v[212:215], a[188:191], v[60:63]
  s_waitcnt lgkmcnt(0)
  v_exp_f32 v207, v207
  v_mfma_f32_16x16x4_f32 v[224:227], v242, a121, 0
  s_waitcnt lgkmcnt(2)
  v_exp_f32 v202, v202
  v_mfma_f32_16x16x4_f32 v[250:253], v243, a121, 0
  buffer_store_dwordx4 a[112:115], v233, s[16:19], s35 offen offset:2048 nt
  v_exp_f32_e64 v204, v204
  v_mfma_f32_16x16x32_bf16 v[192:195], a[128:131], a[48:51], v[228:231]
  buffer_store_dwordx4 a[116:119], v233, s[16:19], s35 offen offset:3072 nt
  v_mul_f32 v205, s29, v197
  v_mul_f32 v206, s29, v198
  v_mfma_f32_16x16x32_bf16 v[192:195], a[132:135], a[52:55], v[192:195]
  v_exp_f32_e64 v205, v205
  v_mfma_f32_16x16x32_bf16 v[192:195], a[136:139], a[56:59], v[192:195]
  v_exp_f32_e64 v206, v206
  v_mfma_f32_16x16x32_bf16 v[192:195], a[140:143], a[60:63], v[192:195]
  v_cvt_pk_bf16_f32 v210, v204, v205
  v_cvt_pk_bf16_f32 v211, v206, v207
  v_pk_mul_f32 v[0:1], v[0:1], v[224:225]
  v_pk_mul_f32 v[4:5], v[4:5], v[224:225]
  v_pk_mul_f32 v[8:9], v[8:9], v[224:225]
  v_pk_mul_f32 v[12:13], v[12:13], v[224:225]
  v_pk_mul_f32 v[16:17], v[16:17], v[224:225]
  v_pk_mul_f32 v[20:21], v[20:21], v[224:225]
  v_pk_mul_f32 v[24:25], v[24:25], v[224:225]
  v_pk_mul_f32 v[28:29], v[28:29], v[224:225]
  v_cvt_pk_bf16_f32 v216, v0, v4
  v_cvt_pk_bf16_f32 v217, v8, v12
  v_cvt_pk_bf16_f32 v218, v16, v20
  v_cvt_pk_bf16_f32 v219, v24, v28
  v_cvt_pk_bf16_f32 v220, v1, v5
  v_cvt_pk_bf16_f32 v221, v9, v13
  v_cvt_pk_bf16_f32 v222, v17, v21
  v_cvt_pk_bf16_f32 v223, v25, v29
  ds_write_b128 v232, v[216:219] offset:0
  ds_write_b128 v232, v[220:223] offset:256
  v_pk_mul_f32 v[2:3], v[2:3], v[226:227]
  v_pk_mul_f32 v[6:7], v[6:7], v[226:227]
  v_pk_mul_f32 v[10:11], v[10:11], v[226:227]
  v_pk_mul_f32 v[14:15], v[14:15], v[226:227]
  v_pk_mul_f32 v[18:19], v[18:19], v[226:227]
  v_pk_mul_f32 v[22:23], v[22:23], v[226:227]
  v_pk_mul_f32 v[26:27], v[26:27], v[226:227]
  v_pk_mul_f32 v[30:31], v[30:31], v[226:227]
  v_cvt_pk_bf16_f32 v216, v2, v6
  v_cvt_pk_bf16_f32 v217, v10, v14
  v_cvt_pk_bf16_f32 v218, v18, v22
  v_cvt_pk_bf16_f32 v219, v26, v30
  v_cvt_pk_bf16_f32 v220, v3, v7
  v_cvt_pk_bf16_f32 v221, v11, v15
  v_cvt_pk_bf16_f32 v222, v19, v23
  v_cvt_pk_bf16_f32 v223, v27, v31
  ds_write_b128 v232, v[216:219] offset:512
  ds_write_b128 v232, v[220:223] offset:768
  v_pk_mul_f32 v[32:33], v[32:33], v[250:251]
  v_pk_mul_f32 v[36:37], v[36:37], v[250:251]
  v_pk_mul_f32 v[40:41], v[40:41], v[250:251]
  v_pk_mul_f32 v[44:45], v[44:45], v[250:251]
  v_pk_mul_f32 v[48:49], v[48:49], v[250:251]
  v_pk_mul_f32 v[52:53], v[52:53], v[250:251]
  v_pk_mul_f32 v[56:57], v[56:57], v[250:251]
  v_pk_mul_f32 v[60:61], v[60:61], v[250:251]
  v_cvt_pk_bf16_f32 v216, v32, v36
  v_cvt_pk_bf16_f32 v217, v40, v44
  v_cvt_pk_bf16_f32 v218, v48, v52
  v_cvt_pk_bf16_f32 v219, v56, v60
  v_cvt_pk_bf16_f32 v220, v33, v37
  v_cvt_pk_bf16_f32 v221, v41, v45
  v_cvt_pk_bf16_f32 v222, v49, v53
  v_cvt_pk_bf16_f32 v223, v57, v61
  ds_read_b64_tr_b16 v[0:1], v235 offset:0
  ds_read_b64_tr_b16 v[2:3], v235 offset:64
  ds_read_b64_tr_b16 v[4:5], v235 offset:1024
  ds_read_b64_tr_b16 v[6:7], v235 offset:1088
  ds_write_b128 v232, v[216:219] offset:4096
  ds_write_b128 v232, v[220:223] offset:4352
  v_pk_mul_f32 v[34:35], v[34:35], v[252:253]
  v_pk_mul_f32 v[38:39], v[38:39], v[252:253]
  v_pk_mul_f32 v[42:43], v[42:43], v[252:253]
  v_pk_mul_f32 v[46:47], v[46:47], v[252:253]
  v_pk_mul_f32 v[50:51], v[50:51], v[252:253]
  v_pk_mul_f32 v[54:55], v[54:55], v[252:253]
  v_pk_mul_f32 v[58:59], v[58:59], v[252:253]
  v_pk_mul_f32 v[62:63], v[62:63], v[252:253]
  v_cvt_pk_bf16_f32 v216, v34, v38
  v_cvt_pk_bf16_f32 v217, v42, v46
  v_cvt_pk_bf16_f32 v218, v50, v54
  v_cvt_pk_bf16_f32 v219, v58, v62
  v_cvt_pk_bf16_f32 v220, v35, v39
  v_cvt_pk_bf16_f32 v221, v43, v47
  v_cvt_pk_bf16_f32 v222, v51, v55
  v_cvt_pk_bf16_f32 v223, v59, v63
  ds_read_b64_tr_b16 v[8:9], v235 offset:2048
  ds_read_b64_tr_b16 v[10:11], v235 offset:2112
  ds_read_b64_tr_b16 v[12:13], v235 offset:3072
  ds_read_b64_tr_b16 v[14:15], v235 offset:3136
  ds_write_b128 v232, v[216:219] offset:4608
  ds_write_b128 v232, v[220:223] offset:4864
  s_waitcnt lgkmcnt(10)
  buffer_store_dwordx4 v[0:3], v233, s[16:19], s39 offen nt
  s_waitcnt lgkmcnt(8)
  buffer_store_dwordx4 v[4:7], v233, s[16:19], s39 offen offset:1024 nt
  v_mfma_f32_16x16x32_bf16 v[196:199], a[144:147], a[60:63], v[228:231]
  v_exp_f32_e64 v200, v200
  v_mfma_f32_16x16x32_bf16 v[196:199], a[148:151], a[56:59], v[196:199]
  v_exp_f32_e64 v203, v203
  v_mfma_f32_16x16x32_bf16 v[196:199], a[152:155], a[52:55], v[196:199]
  v_cvt_pk_bf16_f32 v208, v200, v201
  v_cvt_pk_bf16_f32 v209, v202, v203
  v_mfma_f32_16x16x32_bf16 v[196:199], a[156:159], a[48:51], v[196:199]
  ds_read_b128 a[132:135], v249 offset:64
  ds_read_b64_tr_b16 v[32:33], v235 offset:4096
  v_mfma_f32_16x16x32_bf16 v[64:67], v[208:211], a[160:163], v[64:67]
  ds_read_b128 a[136:139], v249 offset:128
  ds_read_b128 a[144:147], v249 offset:704
  v_mfma_f32_16x16x32_bf16 v[68:71], v[208:211], a[164:167], v[68:71]
  ds_read_b128 a[128:131], v249 offset:0
  ds_read_b128 a[140:143], v249 offset:192
  v_mfma_f32_16x16x32_bf16 v[72:75], v[208:211], a[168:171], v[72:75]
  v_mul_f32 v201, s29, v193
  v_mul_f32 v202, s29, v194
  v_mfma_f32_16x16x32_bf16 v[76:79], v[208:211], a[172:175], v[76:79]
  ds_read_b64_tr_b16 v[34:35], v235 offset:4160
  ds_read_b64_tr_b16 v[36:37], v235 offset:5120
  ds_read_b64_tr_b16 v[38:39], v235 offset:5184
  v_mfma_f32_16x16x32_bf16 v[80:83], v[208:211], a[176:179], v[80:83]
  ds_read_b128 a[152:155], v249 offset:576
  ds_read_b128 a[156:159], v249 offset:512
  v_mfma_f32_16x16x32_bf16 v[84:87], v[208:211], a[180:183], v[84:87]
  ds_read_b64_tr_b16 v[40:41], v235 offset:6144
  ds_read_b64_tr_b16 v[42:43], v235 offset:6208
  ds_read_b64_tr_b16 v[44:45], v235 offset:7168
  ds_read_b64_tr_b16 v[46:47], v235 offset:7232
  v_mfma_f32_16x16x32_bf16 v[88:91], v[208:211], a[184:187], v[88:91]
  s_waitcnt lgkmcnt(14)
  buffer_store_dwordx4 v[8:11], v233, s[16:19], s39 offen offset:2048 nt
  ds_read_b128 a[148:151], v249 offset:640
  v_mul_f32 v200, s29, v192
  v_mfma_f32_16x16x32_bf16 v[92:95], v[208:211], a[188:191], v[92:95]
  s_waitcnt lgkmcnt(14)
  buffer_store_dwordx4 v[12:15], v233, s[16:19], s39 offen offset:3072 nt
  v_mul_f32 v203, s29, v195
  v_mul_f32 v206, s29, v198
  s_waitcnt lgkmcnt(11)
  v_mfma_f32_16x16x32_bf16 v[192:195], a[128:131], a[32:35], v[228:231]
  s_waitcnt lgkmcnt(9)
  buffer_store_dwordx4 v[32:35], v233, s[16:19], s33 offen nt
  v_exp_f32 v202, v202
  v_mfma_f32_16x16x32_bf16 v[192:195], a[132:135], a[36:39], v[192:195]
  s_waitcnt lgkmcnt(7)
  buffer_store_dwordx4 v[36:39], v233, s[16:19], s33 offen offset:1024 nt
  v_exp_f32 v201, v201
  v_mfma_f32_16x16x32_bf16 v[192:195], a[136:139], a[40:43], v[192:195]
  s_waitcnt lgkmcnt(3)
  buffer_store_dwordx4 v[40:43], v233, s[16:19], s33 offen offset:2048 nt
  v_exp_f32 v200, v200
  v_mfma_f32_16x16x32_bf16 v[192:195], a[140:143], a[44:47], v[192:195]
  s_waitcnt lgkmcnt(1)
  buffer_store_dwordx4 v[44:47], v233, s[16:19], s33 offen offset:3072 nt
  v_mul_f32 v204, s29, v196
  v_mul_f32 v205, s29, v197
  v_mul_f32 v207, s29, v199
  v_mfma_f32_16x16x32_bf16 v[196:199], a[144:147], a[44:47], v[228:231]
  s_waitcnt lgkmcnt(0)
  v_exp_f32 v204, v204
  v_mfma_f32_16x16x32_bf16 v[196:199], a[148:151], a[40:43], v[196:199]
  v_exp_f32 v203, v203
  v_exp_f32 v205, v205
  v_exp_f32 v206, v206
  v_exp_f32 v207, v207
  v_mfma_f32_16x16x32_bf16 v[196:199], a[152:155], a[36:39], v[196:199]
  v_cvt_pk_bf16_f32 v212, v200, v201
  v_cvt_pk_bf16_f32 v213, v202, v203
  v_cvt_pk_bf16_f32 v214, v204, v205
  v_cvt_pk_bf16_f32 v215, v206, v207
  v_mfma_f32_16x16x32_bf16 v[196:199], a[156:159], a[32:35], v[196:199]
  v_mul_f32 v200, s29, v192
  v_mul_f32 v203, s29, v195
  v_mfma_f32_16x16x32_bf16 v[96:99], v[212:215], a[160:163], v[96:99]
  ds_read_b64_tr_b16 a[160:161], v255 offset:8448
  v_mul_f32_e64 v202, s29, v194
  v_mfma_f32_16x16x32_bf16 v[100:103], v[212:215], a[164:167], v[100:103]
  ds_read_b64_tr_b16 a[162:163], v255 offset:8960
  v_mul_f32_e64 v201, s29, v193
  v_mfma_f32_16x16x32_bf16 v[104:107], v[212:215], a[168:171], v[104:107]
  ds_read_b64_tr_b16 a[170:171], v255 offset:8992
  v_mul_f32_e64 v206, s29, v198
  v_mfma_f32_16x16x32_bf16 v[108:111], v[212:215], a[172:175], v[108:111]
  v_mul_f32 v204, s29, v196
  v_mul_f32 v207, s29, v199
  v_mfma_f32_16x16x32_bf16 v[112:115], v[212:215], a[176:179], v[112:115]
  v_exp_f32_e64 v207, v207
  v_mfma_f32_16x16x32_bf16 v[116:119], v[212:215], a[180:183], v[116:119]
  ds_read_b64_tr_b16 a[164:165], v255 offset:8464
  ds_read_b64_tr_b16 a[174:175], v255 offset:9008
  v_mfma_f32_16x16x32_bf16 v[120:123], v[212:215], a[184:187], v[120:123]
  ds_read_b64_tr_b16 a[172:173], v255 offset:8496
  ds_read_b64_tr_b16 a[178:179], v255 offset:9024
  v_mfma_f32_16x16x32_bf16 v[124:127], v[212:215], a[188:191], v[124:127]
  ds_read_b64_tr_b16 a[176:177], v255 offset:8512
  ds_read_b64_tr_b16 a[190:191], v255 offset:9072
  v_smfmac_f32_16x16x64_bf16 a[196:199], a[220:223], v[208:215], v254
  ds_read_b64_tr_b16 a[166:167], v255 offset:8976
  v_mul_f32_e64 v205, s29, v197
  v_mfma_f32_16x16x32_bf16 v[192:195], a[128:131], a[48:51], v[228:231]
  v_exp_f32_e64 v205, v205
  v_mfma_f32_16x16x32_bf16 v[192:195], a[132:135], a[52:55], v[192:195]
  v_exp_f32_e64 v200, v200
  v_mfma_f32_16x16x32_bf16 v[192:195], a[136:139], a[56:59], v[192:195]
  v_exp_f32_e64 v201, v201
  v_mfma_f32_16x16x32_bf16 v[192:195], a[140:143], a[60:63], v[192:195]
  ds_read_b64_tr_b16 a[168:169], v255 offset:8480
  v_cvt_pk_bf16_f32 v208, v200, v201
  v_mfma_f32_16x16x32_bf16 v[196:199], a[144:147], a[60:63], v[228:231]
  v_exp_f32_e64 v202, v202
  v_mfma_f32_16x16x32_bf16 v[196:199], a[148:151], a[56:59], v[196:199]
  v_exp_f32 v203, v203
  v_exp_f32 v204, v204
  v_exp_f32_e64 v206, v206
  v_mfma_f32_16x16x32_bf16 v[196:199], a[152:155], a[52:55], v[196:199]
  ds_read_b64_tr_b16 a[180:181], v255 offset:8528
  ds_read_b64_tr_b16 a[182:183], v255 offset:9040
  v_cvt_pk_bf16_f32 v209, v202, v203
  v_cvt_pk_bf16_f32 v210, v204, v205
  v_cvt_pk_bf16_f32 v211, v206, v207
  v_mfma_f32_16x16x32_bf16 v[196:199], a[156:159], a[48:51], v[196:199]
  ds_read_b64_tr_b16 a[184:185], v255 offset:8544
  ds_read_b64_tr_b16 a[186:187], v255 offset:9056
  s_waitcnt lgkmcnt(13)
  v_mfma_f32_16x16x32_bf16 v[64:67], v[208:211], a[160:163], v[64:67]
  ds_read_b64_tr_b16 a[188:189], v255 offset:8560
  v_mul_f32_e64 v203, s29, v195
  s_waitcnt lgkmcnt(6)
  v_mfma_f32_16x16x32_bf16 v[68:71], v[208:211], a[164:167], v[68:71]
  s_waitcnt lgkmcnt(5)
  v_mul_f32 v201, s29, v193
  v_mul_f32_e64 v202, s29, v194
  v_mfma_f32_16x16x32_bf16 v[72:75], v[208:211], a[168:171], v[72:75]
  v_mul_f32 v200, s29, v192
  v_mul_f32 v204, s29, v196
  v_mfma_f32_16x16x32_bf16 v[76:79], v[208:211], a[172:175], v[76:79]
  v_mul_f32 v205, s29, v197
  v_mul_f32 v207, s29, v199
  v_mfma_f32_16x16x32_bf16 v[80:83], v[208:211], a[176:179], v[80:83]
  s_waitcnt lgkmcnt(3)
  v_exp_f32 v203, v203
  v_mfma_f32_16x16x32_bf16 v[84:87], v[208:211], a[180:183], v[84:87]
  s_waitcnt lgkmcnt(1)
  v_exp_f32 v202, v202
  v_mfma_f32_16x16x32_bf16 v[88:91], v[208:211], a[184:187], v[88:91]
  s_waitcnt lgkmcnt(0)
  v_exp_f32 v200, v200
  v_mfma_f32_16x16x32_bf16 v[92:95], v[208:211], a[188:191], v[92:95]
  v_exp_f32_e64 v205, v205
  v_mfma_f32_16x16x32_bf16 v[192:195], a[128:131], a[96:99], v[228:231]
  v_exp_f32_e64 v204, v204
  v_mfma_f32_16x16x32_bf16 v[192:195], a[132:135], a[100:103], v[192:195]
  v_mul_f32_e64 v206, s29, v198
  v_cvt_pk_bf16_f32 v213, v202, v203
  v_mfma_f32_16x16x32_bf16 v[192:195], a[136:139], a[104:107], v[192:195]
  v_exp_f32_e64 v206, v206
  v_mfma_f32_16x16x32_bf16 v[192:195], a[140:143], a[108:111], v[192:195]
  v_exp_f32_e64 v201, v201
  v_mfma_f32_16x16x32_bf16 v[196:199], a[144:147], a[108:111], v[228:231]
  v_cvt_pk_bf16_f32 v212, v200, v201
  v_cvt_pk_bf16_f32 v214, v204, v205
  v_mfma_f32_16x16x32_bf16 v[196:199], a[148:151], a[104:107], v[196:199]
  v_exp_f32_e64 v207, v207
  v_mfma_f32_16x16x32_bf16 v[196:199], a[152:155], a[100:103], v[196:199]
  v_cvt_pk_bf16_f32 v215, v206, v207
  v_mul_f32_e64 v203, s29, v195
  v_mfma_f32_16x16x32_bf16 v[196:199], a[156:159], a[96:99], v[196:199]
  v_mul_f32 v200, s29, v192
  v_mul_f32 v202, s29, v194
  v_smfmac_f32_16x16x64_bf16 a[196:199], a[220:223], v[208:215], v254
  v_mul_f32_e64 v201, s29, v193
  v_mfma_f32_16x16x32_bf16 v[96:99], v[212:215], a[160:163], v[96:99]
  v_exp_f32_e64 v203, v203
  v_mfma_f32_16x16x32_bf16 v[100:103], v[212:215], a[164:167], v[100:103]
  v_mul_f32 v205, s29, v197
  v_mul_f32 v207, s29, v199
  v_mfma_f32_16x16x32_bf16 v[104:107], v[212:215], a[168:171], v[104:107]
  v_accvgpr_read_b32 v244, a196
  v_accvgpr_read_b32 v250, a197
  v_mfma_f32_16x16x32_bf16 v[108:111], v[212:215], a[172:175], v[108:111]
  v_add_f32 v244, v244, v250
  v_mul_f32 v206, s29, v198
  v_mfma_f32_16x16x32_bf16 v[112:115], v[212:215], a[176:179], v[112:115]
  v_rcp_f32_e64 v244, v244
  v_mfma_f32_16x16x32_bf16 v[116:119], v[212:215], a[180:183], v[116:119]
  v_accvgpr_read_b32 v245, a198
  v_accvgpr_read_b32 v251, a199
  v_mfma_f32_16x16x32_bf16 v[120:123], v[212:215], a[184:187], v[120:123]
  v_add_f32 v245, v245, v251
  v_rcp_f32 v245, v245
  v_mfma_f32_16x16x32_bf16 v[124:127], v[212:215], a[188:191], v[124:127]
  v_exp_f32_e64 v207, v207
  v_mfma_f32_16x16x4_f32 v[224:227], v244, a121, 0
  v_exp_f32_e64 v205, v205
  v_mfma_f32_16x16x4_f32 v[250:253], v245, a121, 0
  v_exp_f32_e64 v202, v202
  v_mfma_f32_16x16x32_bf16 v[192:195], a[128:131], a[64:67], v[228:231]
  v_mul_f32_e64 v204, s29, v196
  v_cvt_pk_bf16_f32 v209, v202, v203
  v_mfma_f32_16x16x32_bf16 v[192:195], a[132:135], a[68:71], v[192:195]
  v_exp_f32_e64 v204, v204
  v_mfma_f32_16x16x32_bf16 v[192:195], a[136:139], a[72:75], v[192:195]
  v_exp_f32_e64 v200, v200
  v_mfma_f32_16x16x32_bf16 v[192:195], a[140:143], a[76:79], v[192:195]
  v_exp_f32_e64 v201, v201
  v_pk_mul_f32 v[64:65], v[64:65], v[224:225]
  v_pk_mul_f32 v[68:69], v[68:69], v[224:225]
  v_pk_mul_f32 v[72:73], v[72:73], v[224:225]
  v_pk_mul_f32 v[76:77], v[76:77], v[224:225]
  v_pk_mul_f32 v[80:81], v[80:81], v[224:225]
  v_pk_mul_f32 v[84:85], v[84:85], v[224:225]
  v_pk_mul_f32 v[88:89], v[88:89], v[224:225]
  v_pk_mul_f32 v[92:93], v[92:93], v[224:225]
  v_cvt_pk_bf16_f32 v216, v64, v68
  v_cvt_pk_bf16_f32 v217, v72, v76
  v_cvt_pk_bf16_f32 v218, v80, v84
  v_cvt_pk_bf16_f32 v219, v88, v92
  v_cvt_pk_bf16_f32 v220, v65, v69
  v_cvt_pk_bf16_f32 v221, v73, v77
  v_cvt_pk_bf16_f32 v222, v81, v85
  v_cvt_pk_bf16_f32 v223, v89, v93
  ds_write_b128 v232, v[216:219] offset:8192
  ds_write_b128 v232, v[220:223] offset:8448
  v_pk_mul_f32 v[66:67], v[66:67], v[226:227]
  v_pk_mul_f32 v[70:71], v[70:71], v[226:227]
  v_pk_mul_f32 v[74:75], v[74:75], v[226:227]
  v_pk_mul_f32 v[78:79], v[78:79], v[226:227]
  v_pk_mul_f32 v[82:83], v[82:83], v[226:227]
  v_pk_mul_f32 v[86:87], v[86:87], v[226:227]
  v_pk_mul_f32 v[90:91], v[90:91], v[226:227]
  v_pk_mul_f32 v[94:95], v[94:95], v[226:227]
  v_cvt_pk_bf16_f32 v216, v66, v70
  v_cvt_pk_bf16_f32 v217, v74, v78
  v_cvt_pk_bf16_f32 v218, v82, v86
  v_cvt_pk_bf16_f32 v219, v90, v94
  v_cvt_pk_bf16_f32 v220, v67, v71
  v_cvt_pk_bf16_f32 v221, v75, v79
  v_cvt_pk_bf16_f32 v222, v83, v87
  v_cvt_pk_bf16_f32 v223, v91, v95
  ds_write_b128 v232, v[216:219] offset:8704
  ds_write_b128 v232, v[220:223] offset:8960
  v_pk_mul_f32 v[96:97], v[96:97], v[250:251]
  v_pk_mul_f32 v[100:101], v[100:101], v[250:251]
  v_pk_mul_f32 v[104:105], v[104:105], v[250:251]
  v_pk_mul_f32 v[108:109], v[108:109], v[250:251]
  v_pk_mul_f32 v[112:113], v[112:113], v[250:251]
  v_pk_mul_f32 v[116:117], v[116:117], v[250:251]
  v_pk_mul_f32 v[120:121], v[120:121], v[250:251]
  v_pk_mul_f32 v[124:125], v[124:125], v[250:251]
  v_cvt_pk_bf16_f32 v216, v96, v100
  v_cvt_pk_bf16_f32 v217, v104, v108
  v_cvt_pk_bf16_f32 v218, v112, v116
  v_cvt_pk_bf16_f32 v219, v120, v124
  v_cvt_pk_bf16_f32 v220, v97, v101
  v_cvt_pk_bf16_f32 v221, v105, v109
  v_cvt_pk_bf16_f32 v222, v113, v117
  v_cvt_pk_bf16_f32 v223, v121, v125
  ds_read_b64_tr_b16 v[64:65], v235 offset:8192
  ds_read_b64_tr_b16 v[66:67], v235 offset:8256
  ds_read_b64_tr_b16 v[68:69], v235 offset:9216
  ds_read_b64_tr_b16 v[70:71], v235 offset:9280
  ds_write_b128 v232, v[216:219] offset:12288
  ds_write_b128 v232, v[220:223] offset:12544
  v_pk_mul_f32 v[98:99], v[98:99], v[252:253]
  v_pk_mul_f32 v[102:103], v[102:103], v[252:253]
  v_pk_mul_f32 v[106:107], v[106:107], v[252:253]
  v_pk_mul_f32 v[110:111], v[110:111], v[252:253]
  v_pk_mul_f32 v[114:115], v[114:115], v[252:253]
  v_pk_mul_f32 v[118:119], v[118:119], v[252:253]
  v_pk_mul_f32 v[122:123], v[122:123], v[252:253]
  v_pk_mul_f32 v[126:127], v[126:127], v[252:253]
  v_cvt_pk_bf16_f32 v216, v98, v102
  v_cvt_pk_bf16_f32 v217, v106, v110
  v_cvt_pk_bf16_f32 v218, v114, v118
  v_cvt_pk_bf16_f32 v219, v122, v126
  v_cvt_pk_bf16_f32 v220, v99, v103
  v_cvt_pk_bf16_f32 v221, v107, v111
  v_cvt_pk_bf16_f32 v222, v115, v119
  v_cvt_pk_bf16_f32 v223, v123, v127
  ds_read_b64_tr_b16 v[72:73], v235 offset:10240
  ds_read_b64_tr_b16 v[74:75], v235 offset:10304
  ds_read_b64_tr_b16 v[76:77], v235 offset:11264
  ds_read_b64_tr_b16 v[78:79], v235 offset:11328
  ds_write_b128 v232, v[216:219] offset:12800
  ds_write_b128 v232, v[220:223] offset:13056
  s_waitcnt lgkmcnt(10)
  buffer_store_dwordx4 v[64:67], v233, s[16:19], s34 offen nt
  s_waitcnt lgkmcnt(8)
  buffer_store_dwordx4 v[68:71], v233, s[16:19], s34 offen offset:1024 nt
  v_mfma_f32_16x16x32_bf16 v[196:199], a[144:147], a[76:79], v[228:231]
  ds_read_b64_tr_b16 v[96:97], v235 offset:12288
  v_cvt_pk_bf16_f32 v210, v204, v205
  v_mfma_f32_16x16x32_bf16 v[196:199], a[148:151], a[72:75], v[196:199]
  v_exp_f32_e64 v206, v206
  v_mfma_f32_16x16x32_bf16 v[196:199], a[152:155], a[68:71], v[196:199]
  s_waitcnt lgkmcnt(5)
  v_cvt_pk_bf16_f32 v208, v200, v201
  v_cvt_pk_bf16_f32 v211, v206, v207
  v_mfma_f32_16x16x32_bf16 v[196:199], a[156:159], a[64:67], v[196:199]
  buffer_store_dwordx4 v[72:75], v233, s[16:19], s34 offen offset:2048 nt
  ds_read_b64_tr_b16 v[98:99], v235 offset:12352
  ds_read_b64_tr_b16 v[100:101], v235 offset:13312
  v_mfma_f32_16x16x32_bf16 a[204:207], a[220:223], v[208:211], a[204:207]
  ds_read_b64_tr_b16 v[102:103], v235 offset:13376
  v_mul_f32 v203, s29, v195
  v_mfma_f32_16x16x32_bf16 a[224:227], v[208:211], a[160:163], a[224:227]
  s_waitcnt lgkmcnt(6)
  buffer_store_dwordx4 v[76:79], v233, s[16:19], s34 offen offset:3072 nt
  ds_read_b64_tr_b16 v[104:105], v235 offset:14336
  ds_read_b64_tr_b16 v[106:107], v235 offset:14400
  v_mfma_f32_16x16x32_bf16 a[228:231], v[208:211], a[164:167], a[228:231]
  ds_read_b64_tr_b16 v[108:109], v235 offset:15360
  ds_read_b64_tr_b16 v[110:111], v235 offset:15424
  v_mfma_f32_16x16x32_bf16 a[232:235], v[208:211], a[168:171], a[232:235]
  s_waitcnt lgkmcnt(4)
  v_mul_f32 v200, s29, v192
  v_mul_f32 v201, s29, v193
  v_mfma_f32_16x16x32_bf16 a[236:239], v[208:211], a[172:175], a[236:239]
  s_waitcnt lgkmcnt(6)
  v_mul_f32 v202, s29, v194
  v_mul_f32_e64 v207, s29, v199
  v_mfma_f32_16x16x32_bf16 a[240:243], v[208:211], a[176:179], a[240:243]
  buffer_store_dwordx4 v[96:99], v233, s[16:19], s36 offen nt
  v_mul_f32 v205, s29, v197
  v_mul_f32 v206, s29, v198
  v_mfma_f32_16x16x32_bf16 a[244:247], v[208:211], a[180:183], a[244:247]
  buffer_store_dwordx4 v[100:103], v233, s[16:19], s36 offen offset:1024 nt
  v_exp_f32_e64 v205, v205
  v_mfma_f32_16x16x32_bf16 a[248:251], v[208:211], a[184:187], a[248:251]
  s_waitcnt lgkmcnt(2)
  buffer_store_dwordx4 v[104:107], v233, s[16:19], s36 offen offset:2048 nt
  v_exp_f32 v203, v203
  v_mfma_f32_16x16x32_bf16 a[252:255], v[208:211], a[188:191], a[252:255]
  v_exp_f32_e64 v202, v202
  v_mfma_f32_16x16x32_bf16 v[192:195], a[128:131], a[80:83], v[228:231]
  s_waitcnt lgkmcnt(0)
  v_mul_f32 v204, s29, v196
  v_cvt_pk_bf16_f32 v209, v202, v203
  v_mfma_f32_16x16x32_bf16 v[192:195], a[132:135], a[84:87], v[192:195]
  buffer_store_dwordx4 v[108:111], v233, s[16:19], s36 offen offset:3072 nt
  v_exp_f32_e64 v207, v207
  v_mfma_f32_16x16x32_bf16 v[192:195], a[136:139], a[88:91], v[192:195]
  v_exp_f32_e64 v200, v200
  v_mfma_f32_16x16x32_bf16 v[192:195], a[140:143], a[92:95], v[192:195]
  v_exp_f32_e64 v201, v201
  v_mfma_f32_16x16x32_bf16 v[196:199], a[144:147], a[92:95], v[228:231]
  ds_read_b128 a[140:143], v249 offset:33984
  v_cvt_pk_bf16_f32 v208, v200, v201
  v_mfma_f32_16x16x32_bf16 v[196:199], a[148:151], a[88:91], v[196:199]
  v_exp_f32 v204, v204
  v_exp_f32 v206, v206
  v_mfma_f32_16x16x32_bf16 v[196:199], a[152:155], a[84:87], v[196:199]
  v_cvt_pk_bf16_f32 v210, v204, v205
  v_cvt_pk_bf16_f32 v211, v206, v207
  v_mfma_f32_16x16x32_bf16 v[196:199], a[156:159], a[80:83], v[196:199]
  ds_read_b128 a[128:131], v249 offset:33792
  ds_read_b128 a[148:151], v249 offset:34432
  v_mfma_f32_16x16x32_bf16 v[128:131], v[208:211], a[160:163], v[128:131]
  ds_read_b128 a[136:139], v249 offset:33920
  v_mul_f32_e64 v201, s29, v193
  v_mfma_f32_16x16x32_bf16 v[132:135], v[208:211], a[164:167], v[132:135]
  ds_read_b128 a[156:159], v249 offset:34304
  v_mul_f32_e64 v202, s29, v194
  v_mfma_f32_16x16x32_bf16 v[136:139], v[208:211], a[168:171], v[136:139]
  ds_read_b128 a[132:135], v249 offset:33856
  ds_read_b128 a[144:147], v249 offset:34496
  v_mfma_f32_16x16x32_bf16 v[140:143], v[208:211], a[172:175], v[140:143]
  v_mul_f32 v203, s29, v195
  v_mul_f32 v205, s29, v197
  v_mfma_f32_16x16x32_bf16 v[144:147], v[208:211], a[176:179], v[144:147]
  v_exp_f32_e64 v203, v203
  v_mfma_f32_16x16x32_bf16 v[148:151], v[208:211], a[180:183], v[148:151]
  ds_read_b128 a[152:155], v249 offset:34368
  v_mul_f32_e64 v206, s29, v198
  v_mfma_f32_16x16x32_bf16 v[152:155], v[208:211], a[184:187], v[152:155]
  v_exp_f32_e64 v201, v201
  v_mfma_f32_16x16x32_bf16 v[156:159], v[208:211], a[188:191], v[156:159]
  s_waitcnt lgkmcnt(6)
  v_mul_f32 v200, s29, v192
  v_mul_f32_e64 v207, s29, v199
  v_mfma_f32_16x16x32_bf16 v[192:195], a[128:131], a[64:67], v[228:231]
  s_waitcnt lgkmcnt(2)
  v_exp_f32 v207, v207
  v_mfma_f32_16x16x32_bf16 v[192:195], a[132:135], a[68:71], v[192:195]
  v_exp_f32_e64 v202, v202
  v_mfma_f32_16x16x32_bf16 v[192:195], a[136:139], a[72:75], v[192:195]
  v_mul_f32_e64 v204, s29, v196
  v_cvt_pk_bf16_f32 v213, v202, v203
  v_mfma_f32_16x16x32_bf16 v[192:195], a[140:143], a[76:79], v[192:195]
  s_waitcnt lgkmcnt(1)
  v_exp_f32 v206, v206
  v_mfma_f32_16x16x32_bf16 v[196:199], a[144:147], a[76:79], v[228:231]
  v_exp_f32_e64 v200, v200
  v_mfma_f32_16x16x32_bf16 v[196:199], a[148:151], a[72:75], v[196:199]
  s_waitcnt lgkmcnt(0)
  v_exp_f32 v204, v204
  v_exp_f32_e64 v205, v205
  v_mfma_f32_16x16x32_bf16 v[196:199], a[152:155], a[68:71], v[196:199]
  v_cvt_pk_bf16_f32 v212, v200, v201
  v_cvt_pk_bf16_f32 v214, v204, v205
  v_cvt_pk_bf16_f32 v215, v206, v207
  v_mfma_f32_16x16x32_bf16 v[196:199], a[156:159], a[64:67], v[196:199]
  v_mul_f32 v201, s29, v193
  v_mul_f32 v202, s29, v194
  v_mfma_f32_16x16x32_bf16 v[160:163], v[212:215], a[160:163], v[160:163]
  ds_read_b64_tr_b16 a[162:163], v255 offset:42752
  v_mul_f32_e64 v203, s29, v195
  v_mfma_f32_16x16x32_bf16 v[164:167], v[212:215], a[164:167], v[164:167]
  ds_read_b64_tr_b16 a[164:165], v255 offset:42256
  ds_read_b64_tr_b16 a[166:167], v255 offset:42768
  v_mfma_f32_16x16x32_bf16 v[168:171], v[212:215], a[168:171], v[168:171]
  v_mul_f32 v204, s29, v196
  v_mul_f32 v206, s29, v198
  v_mfma_f32_16x16x32_bf16 v[172:175], v[212:215], a[172:175], v[172:175]
  ds_read_b64_tr_b16 a[174:175], v255 offset:42800
  v_mul_f32_e64 v200, s29, v192
  v_mfma_f32_16x16x32_bf16 v[176:179], v[212:215], a[176:179], v[176:179]
  ds_read_b64_tr_b16 a[168:169], v255 offset:42272
  v_mul_f32_e64 v205, s29, v197
  v_mfma_f32_16x16x32_bf16 v[180:183], v[212:215], a[180:183], v[180:183]
  ds_read_b64_tr_b16 a[160:161], v255 offset:42240
  ds_read_b64_tr_b16 a[182:183], v255 offset:42832
  v_mfma_f32_16x16x32_bf16 v[184:187], v[212:215], a[184:187], v[184:187]
  v_exp_f32_e64 v206, v206
  v_mfma_f32_16x16x32_bf16 v[188:191], v[212:215], a[188:191], v[188:191]
  v_exp_f32_e64 v205, v205
  v_smfmac_f32_16x16x64_bf16 a[200:203], a[220:223], v[208:215], v254
  ds_read_b64_tr_b16 a[170:171], v255 offset:42784
  ds_read_b64_tr_b16 a[172:173], v255 offset:42288
  v_mfma_f32_16x16x32_bf16 v[192:195], a[128:131], a[80:83], v[228:231]
  ds_read_b64_tr_b16 a[180:181], v255 offset:42320
  v_mul_f32_e64 v207, s29, v199
  v_mfma_f32_16x16x32_bf16 v[192:195], a[132:135], a[84:87], v[192:195]
  ds_read_b64_tr_b16 a[184:185], v255 offset:42336
  ds_read_b64_tr_b16 a[190:191], v255 offset:42864
  v_mfma_f32_16x16x32_bf16 v[192:195], a[136:139], a[88:91], v[192:195]
  v_exp_f32_e64 v201, v201
  v_mfma_f32_16x16x32_bf16 v[192:195], a[140:143], a[92:95], v[192:195]
  v_exp_f32_e64 v204, v204
  v_mfma_f32_16x16x32_bf16 v[196:199], a[144:147], a[92:95], v[228:231]
  v_exp_f32_e64 v203, v203
  v_mfma_f32_16x16x32_bf16 v[196:199], a[148:151], a[88:91], v[196:199]
  ds_read_b64_tr_b16 a[176:177], v255 offset:42304
  ds_read_b64_tr_b16 a[178:179], v255 offset:42816
  v_exp_f32 v200, v200
  v_exp_f32 v202, v202
  v_exp_f32_e64 v207, v207
  v_mfma_f32_16x16x32_bf16 v[196:199], a[152:155], a[84:87], v[196:199]
  s_waitcnt lgkmcnt(8)
  v_cvt_pk_bf16_f32 v208, v200, v201
  v_cvt_pk_bf16_f32 v209, v202, v203
  v_cvt_pk_bf16_f32 v210, v204, v205
  v_cvt_pk_bf16_f32 v211, v206, v207
  v_mfma_f32_16x16x32_bf16 v[196:199], a[156:159], a[80:83], v[196:199]
  ds_read_b64_tr_b16 a[186:187], v255 offset:42848
  v_mul_f32 v203, s29, v195
  v_mfma_f32_16x16x32_bf16 v[128:131], v[208:211], a[160:163], v[128:131]
  ds_read_b64_tr_b16 a[188:189], v255 offset:42352
  v_mul_f32_e64 v200, s29, v192
  v_mfma_f32_16x16x32_bf16 v[132:135], v[208:211], a[164:167], v[132:135]
  s_waitcnt lgkmcnt(8)
  v_exp_f32 v200, v200
  v_mfma_f32_16x16x32_bf16 v[136:139], v[208:211], a[168:171], v[136:139]
  ds_write_b128 v234, a[224:227] offset:0
  v_mul_f32 v204, s29, v196
  v_mul_f32_e64 v205, s29, v197
  s_waitcnt lgkmcnt(8)
  v_mfma_f32_16x16x32_bf16 v[140:143], v[208:211], a[172:175], v[140:143]
  s_waitcnt lgkmcnt(3)
  v_mul_f32 v202, s29, v194
  v_mul_f32_e64 v207, s29, v199
  v_mfma_f32_16x16x32_bf16 v[144:147], v[208:211], a[176:179], v[144:147]
  ds_write_b128 v234, a[228:231] offset:1024
  v_mul_f32 v201, s29, v193
  v_mul_f32 v206, s29, v198
  v_mfma_f32_16x16x32_bf16 v[148:151], v[208:211], a[180:183], v[148:151]
  s_waitcnt lgkmcnt(3)
  v_exp_f32 v201, v201
  v_exp_f32 v202, v202
  v_exp_f32 v203, v203
  v_exp_f32 v204, v204
  v_exp_f32 v205, v205
  v_exp_f32 v206, v206
  v_exp_f32 v207, v207
  v_mfma_f32_16x16x32_bf16 v[152:155], v[208:211], a[184:187], v[152:155]
  ds_write_b128 v234, a[232:235] offset:2048
  v_cvt_pk_bf16_f32 v212, v200, v201
  v_cvt_pk_bf16_f32 v213, v202, v203
  v_cvt_pk_bf16_f32 v214, v204, v205
  v_cvt_pk_bf16_f32 v215, v206, v207
  s_waitcnt lgkmcnt(3)
  v_mfma_f32_16x16x32_bf16 v[156:159], v[208:211], a[188:191], v[156:159]
  v_accvgpr_read_b32 v248, a204
  v_accvgpr_read_b32 v250, a206
  v_add_f32 v248, v248, v250
  ds_write_b32 v238, v248 offset:0
  v_smfmac_f32_16x16x64_bf16 a[200:203], a[220:223], v[208:215], v254
  ds_write_b128 v234, a[236:239] offset:3072
  v_mfma_f32_16x16x32_bf16 v[160:163], v[212:215], a[160:163], v[160:163]
  v_mfma_f32_16x16x32_bf16 v[164:167], v[212:215], a[164:167], v[164:167]
  ds_write_b128 v234, a[240:243] offset:4096
  v_mfma_f32_16x16x32_bf16 v[168:171], v[212:215], a[168:171], v[168:171]
  v_accvgpr_read_b32 v246, a200
  v_accvgpr_read_b32 v250, a201
  v_mfma_f32_16x16x32_bf16 v[172:175], v[212:215], a[172:175], v[172:175]
  ds_write_b128 v234, a[244:247] offset:5120
  v_add_f32_e64 v246, v246, v250
  v_mfma_f32_16x16x32_bf16 v[176:179], v[212:215], a[176:179], v[176:179]
  v_rcp_f32_e64 v246, v246
  v_mfma_f32_16x16x32_bf16 v[180:183], v[212:215], a[180:183], v[180:183]
  ds_write_b128 v234, a[248:251] offset:6144
  v_accvgpr_read_b32 v247, a202
  v_accvgpr_read_b32 v251, a203
  v_mfma_f32_16x16x32_bf16 v[184:187], v[212:215], a[184:187], v[184:187]
  v_add_f32 v247, v247, v251
  v_rcp_f32 v247, v247
  v_mfma_f32_16x16x32_bf16 v[188:191], v[212:215], a[188:191], v[188:191]
  ds_write_b128 v234, a[252:255] offset:7168
  v_mfma_f32_16x16x4_f32 v[224:227], v246, a121, 0
  v_mfma_f32_16x16x4_f32 v[250:253], v247, a121, 0
  s_waitcnt lgkmcnt(0)
  s_barrier
  ds_read_b32 v112, v239 offset:0
  ds_read_b32 v113, v239 offset:256
  ds_read_b32 v114, v239 offset:512
  ds_read_b32 v115, v239 offset:768
  ds_read_b128 v[64:67], v236 offset:0
  ds_read_b128 v[68:71], v236 offset:1024
  ds_read_b128 v[72:75], v236 offset:24576
  ds_read_b128 v[76:79], v236 offset:25600
  ds_read_b128 v[80:83], v237 offset:0
  ds_read_b128 v[84:87], v237 offset:1024
  ds_read_b128 v[88:91], v237 offset:24576
  ds_read_b128 v[92:95], v237 offset:25600
  v_pk_mul_f32 v[128:129], v[128:129], v[224:225]
  v_pk_mul_f32 v[132:133], v[132:133], v[224:225]
  v_pk_mul_f32 v[136:137], v[136:137], v[224:225]
  v_pk_mul_f32 v[140:141], v[140:141], v[224:225]
  v_pk_mul_f32 v[144:145], v[144:145], v[224:225]
  v_pk_mul_f32 v[148:149], v[148:149], v[224:225]
  v_pk_mul_f32 v[152:153], v[152:153], v[224:225]
  v_pk_mul_f32 v[156:157], v[156:157], v[224:225]
  v_cvt_pk_bf16_f32 v216, v128, v132
  v_cvt_pk_bf16_f32 v217, v136, v140
  v_cvt_pk_bf16_f32 v218, v144, v148
  v_cvt_pk_bf16_f32 v219, v152, v156
  v_cvt_pk_bf16_f32 v220, v129, v133
  v_cvt_pk_bf16_f32 v221, v137, v141
  v_cvt_pk_bf16_f32 v222, v145, v149
  v_cvt_pk_bf16_f32 v223, v153, v157
  ds_write_b128 v232, v[216:219] offset:16384
  ds_write_b128 v232, v[220:223] offset:16640
  v_pk_mul_f32 v[130:131], v[130:131], v[226:227]
  v_pk_mul_f32 v[134:135], v[134:135], v[226:227]
  v_pk_mul_f32 v[138:139], v[138:139], v[226:227]
  v_pk_mul_f32 v[142:143], v[142:143], v[226:227]
  v_pk_mul_f32 v[146:147], v[146:147], v[226:227]
  v_pk_mul_f32 v[150:151], v[150:151], v[226:227]
  v_pk_mul_f32 v[154:155], v[154:155], v[226:227]
  v_pk_mul_f32 v[158:159], v[158:159], v[226:227]
  v_cvt_pk_bf16_f32 v216, v130, v134
  v_cvt_pk_bf16_f32 v217, v138, v142
  v_cvt_pk_bf16_f32 v218, v146, v150
  v_cvt_pk_bf16_f32 v219, v154, v158
  v_cvt_pk_bf16_f32 v220, v131, v135
  v_cvt_pk_bf16_f32 v221, v139, v143
  v_cvt_pk_bf16_f32 v222, v147, v151
  v_cvt_pk_bf16_f32 v223, v155, v159
  ds_write_b128 v232, v[216:219] offset:16896
  ds_write_b128 v232, v[220:223] offset:17152
  s_waitcnt lgkmcnt(14)
  v_add_f32 v112, v112, v113
  s_waitcnt lgkmcnt(12)
  v_add_f32 v114, v114, v115
  v_add_f32 v248, v112, v114
  v_rcp_f32 v248, v248
  s_lshl_b32 s24, s28, 2
  s_add_u32 s25, s24, 1
  s_add_u32 s26, s24, 2
  s_add_u32 s27, s24, 3
  v_readlane_b32 s20, v248, s24
  v_readlane_b32 s21, v248, s25
  v_readlane_b32 s22, v248, s26
  v_readlane_b32 s23, v248, s27
  s_waitcnt lgkmcnt(9)
  v_pk_add_f32 v[64:65], v[64:65], v[72:73]
  v_pk_add_f32 v[66:67], v[66:67], v[74:75]
  s_waitcnt lgkmcnt(8)
  v_pk_add_f32 v[68:69], v[68:69], v[76:77]
  v_pk_add_f32 v[70:71], v[70:71], v[78:79]
  s_waitcnt lgkmcnt(5)
  v_pk_add_f32 v[80:81], v[80:81], v[88:89]
  v_pk_add_f32 v[82:83], v[82:83], v[90:91]
  s_waitcnt lgkmcnt(4)
  v_pk_add_f32 v[84:85], v[84:85], v[92:93]
  v_pk_add_f32 v[86:87], v[86:87], v[94:95]
  v_pk_add_f32 v[64:65], v[64:65], v[80:81]
  v_pk_add_f32 v[66:67], v[66:67], v[82:83]
  v_pk_add_f32 v[68:69], v[68:69], v[84:85]
  v_pk_add_f32 v[70:71], v[70:71], v[86:87]
  v_pk_mul_f32 v[64:65], v[64:65], s[20:21]
  v_pk_mul_f32 v[66:67], v[66:67], s[22:23]
  v_pk_mul_f32 v[68:69], v[68:69], s[20:21]
  v_pk_mul_f32 v[70:71], v[70:71], s[22:23]
  v_cvt_pk_bf16_f32 v64, v64, v68
  v_cvt_pk_bf16_f32 v65, v65, v69
  v_cvt_pk_bf16_f32 v66, v66, v70
  v_cvt_pk_bf16_f32 v67, v67, v71
  ds_write2st64_b32 v240, v64, v65 offset0:0 offset1:1
  ds_write2st64_b32 v240, v66, v67 offset0:2 offset1:3
  v_pk_mul_f32 v[160:161], v[160:161], v[250:251]
  v_pk_mul_f32 v[164:165], v[164:165], v[250:251]
  v_pk_mul_f32 v[168:169], v[168:169], v[250:251]
  v_pk_mul_f32 v[172:173], v[172:173], v[250:251]
  v_pk_mul_f32 v[176:177], v[176:177], v[250:251]
  v_pk_mul_f32 v[180:181], v[180:181], v[250:251]
  v_pk_mul_f32 v[184:185], v[184:185], v[250:251]
  v_pk_mul_f32 v[188:189], v[188:189], v[250:251]
  v_cvt_pk_bf16_f32 v216, v160, v164
  v_cvt_pk_bf16_f32 v217, v168, v172
  v_cvt_pk_bf16_f32 v218, v176, v180
  v_cvt_pk_bf16_f32 v219, v184, v188
  v_cvt_pk_bf16_f32 v220, v161, v165
  v_cvt_pk_bf16_f32 v221, v169, v173
  v_cvt_pk_bf16_f32 v222, v177, v181
  v_cvt_pk_bf16_f32 v223, v185, v189
  ds_read_b64_tr_b16 v[128:129], v235 offset:16384
  ds_read_b64_tr_b16 v[130:131], v235 offset:16448
  ds_read_b64_tr_b16 v[132:133], v235 offset:17408
  ds_read_b64_tr_b16 v[134:135], v235 offset:17472
  ds_write_b128 v232, v[216:219] offset:20480
  ds_write_b128 v232, v[220:223] offset:20736
  v_pk_mul_f32 v[162:163], v[162:163], v[252:253]
  v_pk_mul_f32 v[166:167], v[166:167], v[252:253]
  v_pk_mul_f32 v[170:171], v[170:171], v[252:253]
  v_pk_mul_f32 v[174:175], v[174:175], v[252:253]
  v_pk_mul_f32 v[178:179], v[178:179], v[252:253]
  v_pk_mul_f32 v[182:183], v[182:183], v[252:253]
  v_pk_mul_f32 v[186:187], v[186:187], v[252:253]
  v_pk_mul_f32 v[190:191], v[190:191], v[252:253]
  v_cvt_pk_bf16_f32 v216, v162, v166
  v_cvt_pk_bf16_f32 v217, v170, v174
  v_cvt_pk_bf16_f32 v218, v178, v182
  v_cvt_pk_bf16_f32 v219, v186, v190
  v_cvt_pk_bf16_f32 v220, v163, v167
  v_cvt_pk_bf16_f32 v221, v171, v175
  v_cvt_pk_bf16_f32 v222, v179, v183
  v_cvt_pk_bf16_f32 v223, v187, v191
  ds_read_b64_tr_b16 v[136:137], v235 offset:18432
  ds_read_b64_tr_b16 v[138:139], v235 offset:18496
  ds_read_b64_tr_b16 v[140:141], v235 offset:19456
  ds_read_b64_tr_b16 v[142:143], v235 offset:19520
  ds_read_b64_tr_b16 v[72:73], v241 offset:0
  ds_read_b64_tr_b16 v[74:75], v241 offset:64
  ds_write_b128 v232, v[216:219] offset:20992
  ds_write_b128 v232, v[220:223] offset:21248
  s_waitcnt lgkmcnt(12)
  buffer_store_dwordx4 v[128:131], v233, s[16:19], s30 offen nt
  s_waitcnt lgkmcnt(10)
  buffer_store_dwordx4 v[132:135], v233, s[16:19], s30 offen offset:1024 nt
  ds_read_b64_tr_b16 v[160:161], v235 offset:20480
  ds_read_b64_tr_b16 v[162:163], v235 offset:20544
  ds_read_b64_tr_b16 v[164:165], v235 offset:21504
  ds_read_b64_tr_b16 v[166:167], v235 offset:21568
  s_waitcnt lgkmcnt(10)
  buffer_store_dwordx4 v[136:139], v233, s[16:19], s30 offen offset:2048 nt
  s_waitcnt lgkmcnt(8)
  buffer_store_dwordx4 v[140:143], v233, s[16:19], s30 offen offset:3072 nt
  ds_read_b64_tr_b16 v[168:169], v235 offset:22528
  ds_read_b64_tr_b16 v[170:171], v235 offset:22592
  ds_read_b64_tr_b16 v[172:173], v235 offset:23552
  ds_read_b64_tr_b16 v[174:175], v235 offset:23616
  s_waitcnt lgkmcnt(6)
  buffer_store_dwordx4 v[160:163], v233, s[16:19], s31 offen nt
  s_waitcnt lgkmcnt(4)
  buffer_store_dwordx4 v[164:167], v233, s[16:19], s31 offen offset:1024 nt
  s_waitcnt lgkmcnt(2)
  buffer_store_dwordx4 v[168:171], v233, s[16:19], s31 offen offset:2048 nt
  s_waitcnt lgkmcnt(0)
  buffer_store_dwordx4 v[172:175], v233, s[16:19], s31 offen offset:3072 nt
  s_lshl_b32 s52, s28, 10
  s_add_u32 s52, s52, s40
  buffer_store_dwordx4 v[72:75], v233, s[16:19], s52 offen nt
  v_max3_u32 v250, v242, v243, v244
  v_min3_u32 v251, v242, v243, v244
  v_max3_u32 v250, v250, v245, v246
  v_min3_u32 v251, v251, v245, v246
  v_max_u32 v250, v250, v247
  v_min_u32 v251, v251, v247
  v_cmp_lt_u32 s[20:21], s54, v250
  v_cmp_gt_u32 s[22:23], s53, v251
  v_cmp_lt_u32 s[24:25], s54, v248
  v_cmp_gt_u32 s[26:27], s53, v248
  s_nop 2
  s_or_b64 s[20:21], s[20:21], s[22:23]
  s_addc_u32 s48, s48, s48
  s_or_b64 s[24:25], s[24:25], s[26:27]
  s_addc_u32 s48, s48, s48
  s_barrier
  s_branch L_fin
L_exitD:
  s_cmp_eq_u32 s28, 1
  s_cbranch_scc1 L_lastB1
  s_cmp_eq_u32 s28, 2
  s_cbranch_scc1 L_lastB2
  s_add_u32 s50, s28, 1
  s_bitcmp1_b32 s50, 1
  s_cselect_b32 s50, 2048, 0
  s_sub_u32 s35, s35, s50
  v_mov_b32 v249, v216
  v_mov_b32_e64 v255, v217
  s_waitcnt lgkmcnt(0)
  v_mfma_f32_16x16x32_bf16 v[192:195], a[128:131], a[0:3], v[228:231]
  s_add_u32 s33, s39, 4096
  v_mul_f32 v206, s29, v198
  v_mul_f32 v207, s29, v199
  v_mfma_f32_16x16x32_bf16 v[192:195], a[132:135], a[4:7], v[192:195]
  s_add_u32 s34, s39, 8192
  v_exp_f32_e64 v205, v205
  v_mfma_f32_16x16x32_bf16 v[192:195], a[136:139], a[8:11], v[192:195]
  s_add_u32 s36, s39, 12288
  v_exp_f32_e64 v204, v204
  v_mfma_f32_16x16x32_bf16 v[192:195], a[140:143], a[12:15], v[192:195]
  s_add_u32 s30, s39, 16384
  v_cvt_pk_bf16_f32 v213, v202, v203
  v_cvt_pk_bf16_f32 v214, v204, v205
  v_mfma_f32_16x16x32_bf16 v[196:199], a[144:147], a[12:15], v[228:231]
  s_add_u32 s31, s39, 20480
  v_exp_f32_e64 v207, v207
  v_mfma_f32_16x16x32_bf16 v[196:199], a[148:151], a[8:11], v[196:199]
  v_exp_f32_e64 v206, v206
  v_mfma_f32_16x16x32_bf16 v[196:199], a[152:155], a[4:7], v[196:199]
  v_cvt_pk_bf16_f32 v212, v200, v201
  v_cvt_pk_bf16_f32 v215, v206, v207
  v_mfma_f32_16x16x32_bf16 v[196:199], a[156:159], a[0:3], v[196:199]
  v_mul_f32 v200, s29, v192
  v_mul_f32 v202, s29, v194
  v_mfma_f32_16x16x32_bf16 v[160:163], v[212:215], a[160:163], v[160:163]
  ds_read_b64_tr_b16 a[160:161], v255 offset:8448
  v_mul_f32_e64 v203, s29, v195
  v_mfma_f32_16x16x32_bf16 v[164:167], v[212:215], a[164:167], v[164:167]
  ds_read_b64_tr_b16 a[162:163], v255 offset:8960
  ds_read_b64_tr_b16 a[164:165], v255 offset:8464
  v_mfma_f32_16x16x32_bf16 v[168:171], v[212:215], a[168:171], v[168:171]
  v_mul_f32 v205, s29, v197
  v_mul_f32 v206, s29, v198
  v_mfma_f32_16x16x32_bf16 v[172:175], v[212:215], a[172:175], v[172:175]
  ds_read_b64_tr_b16 a[168:169], v255 offset:8480
  ds_read_b64_tr_b16 a[174:175], v255 offset:9008
  v_mfma_f32_16x16x32_bf16 v[176:179], v[212:215], a[176:179], v[176:179]
  ds_read_b64_tr_b16 a[166:167], v255 offset:8976
  ds_read_b64_tr_b16 a[178:179], v255 offset:9024
  v_mfma_f32_16x16x32_bf16 v[180:183], v[212:215], a[180:183], v[180:183]
  ds_read_b64_tr_b16 a[172:173], v255 offset:8496
  v_mul_f32_e64 v201, s29, v193
  v_mfma_f32_16x16x32_bf16 v[184:187], v[212:215], a[184:187], v[184:187]
  ds_read_b64_tr_b16 a[180:181], v255 offset:8528
  v_mul_f32_e64 v204, s29, v196
  v_mfma_f32_16x16x32_bf16 v[188:191], v[212:215], a[188:191], v[188:191]
  v_exp_f32_e64 v201, v201
  v_smfmac_f32_16x16x64_bf16 a[200:203], a[220:223], v[208:215], v254
  ds_read_b64_tr_b16 a[190:191], v255 offset:9072
  v_mul_f32_e64 v207, s29, v199
  s_waitcnt vmcnt(6)
  s_barrier
  v_mfma_f32_16x16x32_bf16 v[192:195], a[128:131], a[16:19], v[228:231]
  v_exp_f32_e64 v207, v207
  v_mfma_f32_16x16x32_bf16 v[192:195], a[132:135], a[20:23], v[192:195]
  v_exp_f32_e64 v206, v206
  v_mfma_f32_16x16x32_bf16 v[192:195], a[136:139], a[24:27], v[192:195]
  ds_read_b64_tr_b16 a[170:171], v255 offset:8992
  ds_read_b64_tr_b16 a[176:177], v255 offset:8512
  v_mfma_f32_16x16x32_bf16 v[192:195], a[140:143], a[28:31], v[192:195]
  v_exp_f32_e64 v203, v203
  v_mfma_f32_16x16x32_bf16 v[196:199], a[144:147], a[28:31], v[228:231]
  ds_read_b64_tr_b16 a[182:183], v255 offset:9040
  ds_read_b64_tr_b16 a[186:187], v255 offset:9056
  v_mfma_f32_16x16x32_bf16 v[196:199], a[148:151], a[24:27], v[196:199]
  v_exp_f32 v200, v200
  v_exp_f32 v202, v202
  v_exp_f32 v204, v204
  v_exp_f32 v205, v205
  v_mfma_f32_16x16x32_bf16 v[196:199], a[152:155], a[20:23], v[196:199]
  s_waitcnt lgkmcnt(12)
  v_cvt_pk_bf16_f32 v208, v200, v201
  v_cvt_pk_bf16_f32 v209, v202, v203
  v_cvt_pk_bf16_f32 v210, v204, v205
  v_cvt_pk_bf16_f32 v211, v206, v207
  v_mfma_f32_16x16x32_bf16 v[196:199], a[156:159], a[16:19], v[196:199]
  ds_read_b64_tr_b16 a[184:185], v255 offset:8544
  ds_read_b64_tr_b16 a[188:189], v255 offset:8560
  v_mfma_f32_16x16x32_bf16 v[0:3], v[208:211], a[160:163], v[0:3]
  ds_read_b128 a[132:135], v249 offset:33856
  ds_read_b128 a[140:143], v249 offset:33984
  s_waitcnt lgkmcnt(12)
  v_mfma_f32_16x16x32_bf16 v[4:7], v[208:211], a[164:167], v[4:7]
  ds_read_b128 a[128:131], v249 offset:33792
  ds_read_b128 a[136:139], v249 offset:33920
  s_waitcnt lgkmcnt(9)
  v_mfma_f32_16x16x32_bf16 v[8:11], v[208:211], a[168:171], v[8:11]
  ds_read_b128 a[156:159], v249 offset:34304
  v_mul_f32 v202, s29, v194
  v_mfma_f32_16x16x32_bf16 v[12:15], v[208:211], a[172:175], v[12:15]
  ds_read_b128 a[144:147], v249 offset:34496
  v_mul_f32 v203, s29, v195
  s_waitcnt lgkmcnt(10)
  v_mfma_f32_16x16x32_bf16 v[16:19], v[208:211], a[176:179], v[16:19]
  s_waitcnt lgkmcnt(9)
  v_mul_f32 v200, s29, v192
  v_mul_f32_e64 v201, s29, v193
  v_mfma_f32_16x16x32_bf16 v[20:23], v[208:211], a[180:183], v[20:23]
  ds_read_b128 a[148:151], v249 offset:34432
  v_mul_f32 v206, s29, v198
  s_waitcnt lgkmcnt(8)
  v_mfma_f32_16x16x32_bf16 v[24:27], v[208:211], a[184:187], v[24:27]
  ds_read_b128 a[152:155], v249 offset:34368
  v_mul_f32 v205, s29, v197
  s_waitcnt lgkmcnt(8)
  v_mfma_f32_16x16x32_bf16 v[28:31], v[208:211], a[188:191], v[28:31]
  s_waitcnt lgkmcnt(5)
  v_exp_f32 v205, v205
  v_mfma_f32_16x16x32_bf16 v[192:195], a[128:131], a[0:3], v[228:231]
  v_mul_f32 v204, s29, v196
  v_mul_f32 v207, s29, v199
  v_mfma_f32_16x16x32_bf16 v[192:195], a[132:135], a[4:7], v[192:195]
  s_waitcnt lgkmcnt(4)
  v_exp_f32 v200, v200
  v_mfma_f32_16x16x32_bf16 v[192:195], a[136:139], a[8:11], v[192:195]
  s_waitcnt lgkmcnt(1)
  v_exp_f32 v203, v203
  v_mfma_f32_16x16x32_bf16 v[192:195], a[140:143], a[12:15], v[192:195]
  s_waitcnt lgkmcnt(2)
  v_exp_f32 v204, v204
  v_mfma_f32_16x16x32_bf16 v[196:199], a[144:147], a[12:15], v[228:231]
  ds_read_b64_tr_b16 a[112:113], v235 offset:20480
  v_cvt_pk_bf16_f32 v214, v204, v205
  v_mfma_f32_16x16x32_bf16 v[196:199], a[148:151], a[8:11], v[196:199]
  s_waitcnt lgkmcnt(1)
  v_exp_f32 v201, v201
  v_exp_f32 v202, v202
  v_exp_f32 v206, v206
  v_exp_f32_e64 v207, v207
  v_mfma_f32_16x16x32_bf16 v[196:199], a[152:155], a[4:7], v[196:199]
  v_cvt_pk_bf16_f32 v212, v200, v201
  v_cvt_pk_bf16_f32 v213, v202, v203
  v_cvt_pk_bf16_f32 v215, v206, v207
  v_mfma_f32_16x16x32_bf16 v[196:199], a[156:159], a[0:3], v[196:199]
  v_mul_f32 v200, s29, v192
  v_mul_f32 v202, s29, v194
  v_mfma_f32_16x16x32_bf16 v[32:35], v[212:215], a[160:163], v[32:35]
  v_exp_f32_e64 v202, v202
  v_mfma_f32_16x16x32_bf16 v[36:39], v[212:215], a[164:167], v[36:39]
  ds_read_b64_tr_b16 a[166:167], v255 offset:42768
  v_mul_f32_e64 v201, s29, v193
  v_mfma_f32_16x16x32_bf16 v[40:43], v[212:215], a[168:171], v[40:43]
  ds_read_b64_tr_b16 a[168:169], v255 offset:42272
  v_mul_f32_e64 v207, s29, v199
  v_mfma_f32_16x16x32_bf16 v[44:47], v[212:215], a[172:175], v[44:47]
  v_mul_f32 v203, s29, v195
  v_mul_f32 v206, s29, v198
  v_mfma_f32_16x16x32_bf16 v[48:51], v[212:215], a[176:179], v[48:51]
  ds_read_b64_tr_b16 a[174:175], v255 offset:42800
  v_mul_f32_e64 v205, s29, v197
  v_mfma_f32_16x16x32_bf16 v[52:55], v[212:215], a[180:183], v[52:55]
  ds_read_b64_tr_b16 a[160:161], v255 offset:42240
  ds_read_b64_tr_b16 a[178:179], v255 offset:42816
  v_mfma_f32_16x16x32_bf16 v[56:59], v[212:215], a[184:187], v[56:59]
  ds_read_b64_tr_b16 a[162:163], v255 offset:42752
  ds_read_b64_tr_b16 a[164:165], v255 offset:42256
  v_mfma_f32_16x16x32_bf16 v[60:63], v[212:215], a[188:191], v[60:63]
  v_exp_f32_e64 v207, v207
  v_smfmac_f32_16x16x64_bf16 a[192:195], a[220:223], v[208:215], v254
  ds_read_b64_tr_b16 a[170:171], v255 offset:42784
  ds_read_b64_tr_b16 a[182:183], v255 offset:42832
  v_mfma_f32_16x16x32_bf16 v[192:195], a[128:131], a[16:19], v[228:231]
  v_exp_f32_e64 v200, v200
  v_mfma_f32_16x16x32_bf16 v[192:195], a[132:135], a[20:23], v[192:195]
  ds_read_b64_tr_b16 a[172:173], v255 offset:42288
  v_mul_f32_e64 v204, s29, v196
  v_mfma_f32_16x16x32_bf16 v[192:195], a[136:139], a[24:27], v[192:195]
  v_exp_f32_e64 v205, v205
  v_mfma_f32_16x16x32_bf16 v[192:195], a[140:143], a[28:31], v[192:195]
  v_exp_f32_e64 v201, v201
  v_mfma_f32_16x16x32_bf16 v[196:199], a[144:147], a[28:31], v[228:231]
  ds_read_b64_tr_b16 a[180:181], v255 offset:42320
  v_cvt_pk_bf16_f32 v208, v200, v201
  v_mfma_f32_16x16x32_bf16 v[196:199], a[148:151], a[24:27], v[196:199]
  ds_read_b64_tr_b16 a[176:177], v255 offset:42304
  v_exp_f32 v203, v203
  v_exp_f32 v204, v204
  v_exp_f32_e64 v206, v206
  v_mfma_f32_16x16x32_bf16 v[196:199], a[152:155], a[20:23], v[196:199]
  s_waitcnt lgkmcnt(6)
  v_cvt_pk_bf16_f32 v209, v202, v203
  v_cvt_pk_bf16_f32 v210, v204, v205
  v_cvt_pk_bf16_f32 v211, v206, v207
  v_mfma_f32_16x16x32_bf16 v[196:199], a[156:159], a[16:19], v[196:199]
  ds_read_b64_tr_b16 a[184:185], v255 offset:42336
  ds_read_b64_tr_b16 a[186:187], v255 offset:42848
  v_mfma_f32_16x16x32_bf16 v[0:3], v[208:211], a[160:163], v[0:3]
  ds_read_b64_tr_b16 a[188:189], v255 offset:42352
  ds_read_b64_tr_b16 a[190:191], v255 offset:42864
  s_waitcnt lgkmcnt(9)
  v_mfma_f32_16x16x32_bf16 v[4:7], v[208:211], a[164:167], v[4:7]
  s_waitcnt lgkmcnt(8)
  v_mul_f32 v201, s29, v193
  v_mul_f32_e64 v202, s29, v194
  v_mfma_f32_16x16x32_bf16 v[8:11], v[208:211], a[168:171], v[8:11]
  s_waitcnt lgkmcnt(6)
  v_mul_f32 v203, s29, v195
  v_mul_f32_e64 v206, s29, v198
  v_mfma_f32_16x16x32_bf16 v[12:15], v[208:211], a[172:175], v[12:15]
  s_waitcnt lgkmcnt(4)
  v_mul_f32 v200, s29, v192
  v_mul_f32_e64 v207, s29, v199
  v_mfma_f32_16x16x32_bf16 v[16:19], v[208:211], a[176:179], v[16:19]
  v_exp_f32_e64 v201, v201
  v_mfma_f32_16x16x32_bf16 v[20:23], v[208:211], a[180:183], v[20:23]
  s_waitcnt lgkmcnt(2)
  v_exp_f32 v207, v207
  v_mfma_f32_16x16x32_bf16 v[24:27], v[208:211], a[184:187], v[24:27]
  s_waitcnt lgkmcnt(0)
  v_mul_f32 v204, s29, v196
  v_mul_f32_e64 v205, s29, v197
  v_mfma_f32_16x16x32_bf16 v[28:31], v[208:211], a[188:191], v[28:31]
  v_exp_f32_e64 v205, v205
  v_mfma_f32_16x16x32_bf16 v[192:195], a[128:131], a[32:35], v[228:231]
  v_exp_f32_e64 v200, v200
  v_mfma_f32_16x16x32_bf16 v[192:195], a[132:135], a[36:39], v[192:195]
  v_exp_f32_e64 v204, v204
  v_mfma_f32_16x16x32_bf16 v[192:195], a[136:139], a[40:43], v[192:195]
  v_cvt_pk_bf16_f32 v212, v200, v201
  v_cvt_pk_bf16_f32 v214, v204, v205
  v_mfma_f32_16x16x32_bf16 v[192:195], a[140:143], a[44:47], v[192:195]
  v_exp_f32_e64 v202, v202
  v_mfma_f32_16x16x32_bf16 v[196:199], a[144:147], a[44:47], v[228:231]
  v_exp_f32_e64 v203, v203
  v_mfma_f32_16x16x32_bf16 v[196:199], a[148:151], a[40:43], v[196:199]
  v_exp_f32_e64 v206, v206
  v_mfma_f32_16x16x32_bf16 v[196:199], a[152:155], a[36:39], v[196:199]
  ds_read_b64_tr_b16 a[114:115], v235 offset:20544
  ds_read_b64_tr_b16 a[116:117], v235 offset:21504
  ds_read_b64_tr_b16 a[118:119], v235 offset:21568
  v_cvt_pk_bf16_f32 v213, v202, v203
  v_cvt_pk_bf16_f32 v215, v206, v207
  v_mfma_f32_16x16x32_bf16 v[196:199], a[156:159], a[32:35], v[196:199]
  v_mul_f32 v202, s29, v194
  v_mul_f32 v203, s29, v195
  v_smfmac_f32_16x16x64_bf16 a[192:195], a[220:223], v[208:215], v254
  v_mul_f32_e64 v201, s29, v193
  v_mfma_f32_16x16x32_bf16 v[32:35], v[212:215], a[160:163], v[32:35]
  s_waitcnt lgkmcnt(0)
  v_exp_f32 v203, v203
  v_mfma_f32_16x16x32_bf16 v[36:39], v[212:215], a[164:167], v[36:39]
  s_waitcnt lgkmcnt(2)
  v_mul_f32 v200, s29, v192
  v_mul_f32_e64 v205, s29, v197
  v_mfma_f32_16x16x32_bf16 v[40:43], v[212:215], a[168:171], v[40:43]
  buffer_store_dwordx4 a[112:115], v233, s[16:19], s35 offen nt
  v_accvgpr_read_b32 v242, a192
  v_accvgpr_read_b32 v250, a193
  v_mfma_f32_16x16x32_bf16 v[44:47], v[212:215], a[172:175], v[44:47]
  buffer_store_dwordx4 a[116:119], v233, s[16:19], s35 offen offset:1024 nt
  v_add_f32 v242, v242, v250
  v_mul_f32 v204, s29, v196
  v_mfma_f32_16x16x32_bf16 v[48:51], v[212:215], a[176:179], v[48:51]
  ds_read_b64_tr_b16 a[112:113], v235 offset:22528
  ds_read_b64_tr_b16 a[114:115], v235 offset:22592
  ds_read_b64_tr_b16 a[116:117], v235 offset:23552
  ds_read_b64_tr_b16 a[118:119], v235 offset:23616
  v_mfma_f32_16x16x32_bf16 v[52:55], v[212:215], a[180:183], v[52:55]
  v_rcp_f32_e64 v242, v242
  v_mfma_f32_16x16x32_bf16 v[56:59], v[212:215], a[184:187], v[56:59]
  v_accvgpr_read_b32 v243, a194
  v_accvgpr_read_b32 v251, a195
  v_add_f32 v243, v243, v251
  v_rcp_f32 v243, v243
  v_mfma_f32_16x16x32_bf16 v[60:63], v[212:215], a[188:191], v[60:63]
  s_waitcnt lgkmcnt(0)
  v_exp_f32 v204, v204
  v_mfma_f32_16x16x4_f32 v[224:227], v242, a121, 0
  s_waitcnt lgkmcnt(2)
  v_exp_f32 v205, v205
  v_mfma_f32_16x16x4_f32 v[250:253], v243, a121, 0
  buffer_store_dwordx4 a[112:115], v233, s[16:19], s35 offen offset:2048 nt
  v_exp_f32_e64 v200, v200
  v_mfma_f32_16x16x32_bf16 v[192:195], a[128:131], a[48:51], v[228:231]
  buffer_store_dwordx4 a[116:119], v233, s[16:19], s35 offen offset:3072 nt
  v_exp_f32_e64 v202, v202
  v_mfma_f32_16x16x32_bf16 v[192:195], a[132:135], a[52:55], v[192:195]
  v_mul_f32_e64 v207, s29, v199
  v_cvt_pk_bf16_f32 v209, v202, v203
  v_mfma_f32_16x16x32_bf16 v[192:195], a[136:139], a[56:59], v[192:195]
  v_exp_f32_e64 v207, v207
  v_mfma_f32_16x16x32_bf16 v[192:195], a[140:143], a[60:63], v[192:195]
  ds_read_b128 a[136:139], v249 offset:128
  v_mul_f32_e64 v206, s29, v198
  v_pk_mul_f32 v[0:1], v[0:1], v[224:225]
  v_pk_mul_f32 v[4:5], v[4:5], v[224:225]
  v_pk_mul_f32 v[8:9], v[8:9], v[224:225]
  v_pk_mul_f32 v[12:13], v[12:13], v[224:225]
  v_pk_mul_f32 v[16:17], v[16:17], v[224:225]
  v_pk_mul_f32 v[20:21], v[20:21], v[224:225]
  v_pk_mul_f32 v[24:25], v[24:25], v[224:225]
  v_pk_mul_f32 v[28:29], v[28:29], v[224:225]
  v_cvt_pk_bf16_f32 v216, v0, v4
  v_cvt_pk_bf16_f32 v217, v8, v12
  v_cvt_pk_bf16_f32 v218, v16, v20
  v_cvt_pk_bf16_f32 v219, v24, v28
  v_cvt_pk_bf16_f32 v220, v1, v5
  v_cvt_pk_bf16_f32 v221, v9, v13
  v_cvt_pk_bf16_f32 v222, v17, v21
  v_cvt_pk_bf16_f32 v223, v25, v29
  ds_write_b128 v232, v[216:219] offset:0
  ds_write_b128 v232, v[220:223] offset:256
  v_pk_mul_f32 v[2:3], v[2:3], v[226:227]
  v_pk_mul_f32 v[6:7], v[6:7], v[226:227]
  v_pk_mul_f32 v[10:11], v[10:11], v[226:227]
  v_pk_mul_f32 v[14:15], v[14:15], v[226:227]
  v_pk_mul_f32 v[18:19], v[18:19], v[226:227]
  v_pk_mul_f32 v[22:23], v[22:23], v[226:227]
  v_pk_mul_f32 v[26:27], v[26:27], v[226:227]
  v_pk_mul_f32 v[30:31], v[30:31], v[226:227]
  v_cvt_pk_bf16_f32 v216, v2, v6
  v_cvt_pk_bf16_f32 v217, v10, v14
  v_cvt_pk_bf16_f32 v218, v18, v22
  v_cvt_pk_bf16_f32 v219, v26, v30
  v_cvt_pk_bf16_f32 v220, v3, v7
  v_cvt_pk_bf16_f32 v221, v11, v15
  v_cvt_pk_bf16_f32 v222, v19, v23
  v_cvt_pk_bf16_f32 v223, v27, v31
  ds_write_b128 v232, v[216:219] offset:512
  ds_write_b128 v232, v[220:223] offset:768
  v_pk_mul_f32 v[32:33], v[32:33], v[250:251]
  v_pk_mul_f32 v[36:37], v[36:37], v[250:251]
  v_pk_mul_f32 v[40:41], v[40:41], v[250:251]
  v_pk_mul_f32 v[44:45], v[44:45], v[250:251]
  v_pk_mul_f32 v[48:49], v[48:49], v[250:251]
  v_pk_mul_f32 v[52:53], v[52:53], v[250:251]
  v_pk_mul_f32 v[56:57], v[56:57], v[250:251]
  v_pk_mul_f32 v[60:61], v[60:61], v[250:251]
  v_cvt_pk_bf16_f32 v216, v32, v36
  v_cvt_pk_bf16_f32 v217, v40, v44
  v_cvt_pk_bf16_f32 v218, v48, v52
  v_cvt_pk_bf16_f32 v219, v56, v60
  v_cvt_pk_bf16_f32 v220, v33, v37
  v_cvt_pk_bf16_f32 v221, v41, v45
  v_cvt_pk_bf16_f32 v222, v49, v53
  v_cvt_pk_bf16_f32 v223, v57, v61
  ds_read_b64_tr_b16 v[0:1], v235 offset:0
  ds_read_b64_tr_b16 v[2:3], v235 offset:64
  ds_read_b64_tr_b16 v[4:5], v235 offset:1024
  ds_read_b64_tr_b16 v[6:7], v235 offset:1088
  ds_write_b128 v232, v[216:219] offset:4096
  ds_write_b128 v232, v[220:223] offset:4352
  v_pk_mul_f32 v[34:35], v[34:35], v[252:253]
  v_pk_mul_f32 v[38:39], v[38:39], v[252:253]
  v_pk_mul_f32 v[42:43], v[42:43], v[252:253]
  v_pk_mul_f32 v[46:47], v[46:47], v[252:253]
  v_pk_mul_f32 v[50:51], v[50:51], v[252:253]
  v_pk_mul_f32 v[54:55], v[54:55], v[252:253]
  v_pk_mul_f32 v[58:59], v[58:59], v[252:253]
  v_pk_mul_f32 v[62:63], v[62:63], v[252:253]
  v_cvt_pk_bf16_f32 v216, v34, v38
  v_cvt_pk_bf16_f32 v217, v42, v46
  v_cvt_pk_bf16_f32 v218, v50, v54
  v_cvt_pk_bf16_f32 v219, v58, v62
  v_cvt_pk_bf16_f32 v220, v35, v39
  v_cvt_pk_bf16_f32 v221, v43, v47
  v_cvt_pk_bf16_f32 v222, v51, v55
  v_cvt_pk_bf16_f32 v223, v59, v63
  ds_read_b64_tr_b16 v[8:9], v235 offset:2048
  ds_read_b64_tr_b16 v[10:11], v235 offset:2112
  ds_read_b64_tr_b16 v[12:13], v235 offset:3072
  ds_read_b64_tr_b16 v[14:15], v235 offset:3136
  ds_write_b128 v232, v[216:219] offset:4608
  ds_write_b128 v232, v[220:223] offset:4864
  s_waitcnt lgkmcnt(10)
  buffer_store_dwordx4 v[0:3], v233, s[16:19], s39 offen nt
  s_waitcnt lgkmcnt(8)
  buffer_store_dwordx4 v[4:7], v233, s[16:19], s39 offen offset:1024 nt
  v_mfma_f32_16x16x32_bf16 v[196:199], a[144:147], a[60:63], v[228:231]
  v_exp_f32_e64 v206, v206
  v_mfma_f32_16x16x32_bf16 v[196:199], a[148:151], a[56:59], v[196:199]
  v_exp_f32_e64 v201, v201
  v_mfma_f32_16x16x32_bf16 v[196:199], a[152:155], a[52:55], v[196:199]
  v_cvt_pk_bf16_f32 v208, v200, v201
  v_cvt_pk_bf16_f32 v210, v204, v205
  v_cvt_pk_bf16_f32 v211, v206, v207
  v_mfma_f32_16x16x32_bf16 v[196:199], a[156:159], a[48:51], v[196:199]
  ds_read_b64_tr_b16 v[32:33], v235 offset:4096
  ds_read_b64_tr_b16 v[34:35], v235 offset:4160
  v_mfma_f32_16x16x32_bf16 v[64:67], v[208:211], a[160:163], v[64:67]
  ds_read_b128 a[128:131], v249 offset:0
  ds_read_b64_tr_b16 v[36:37], v235 offset:5120
  v_mfma_f32_16x16x32_bf16 v[68:71], v[208:211], a[164:167], v[68:71]
  ds_read_b128 a[132:135], v249 offset:64
  ds_read_b128 a[144:147], v249 offset:704
  v_mfma_f32_16x16x32_bf16 v[72:75], v[208:211], a[168:171], v[72:75]
  ds_read_b128 a[140:143], v249 offset:192
  v_mul_f32_e64 v201, s29, v193
  v_mfma_f32_16x16x32_bf16 v[76:79], v[208:211], a[172:175], v[76:79]
  ds_read_b64_tr_b16 v[38:39], v235 offset:5184
  ds_read_b64_tr_b16 v[40:41], v235 offset:6144
  v_mfma_f32_16x16x32_bf16 v[80:83], v[208:211], a[176:179], v[80:83]
  ds_read_b64_tr_b16 v[42:43], v235 offset:6208
  ds_read_b64_tr_b16 v[44:45], v235 offset:7168
  v_mfma_f32_16x16x32_bf16 v[84:87], v[208:211], a[180:183], v[84:87]
  ds_read_b128 a[156:159], v249 offset:512
  ds_read_b64_tr_b16 v[46:47], v235 offset:7232
  v_mfma_f32_16x16x32_bf16 v[88:91], v[208:211], a[184:187], v[88:91]
  s_waitcnt lgkmcnt(14)
  buffer_store_dwordx4 v[8:11], v233, s[16:19], s39 offen offset:2048 nt
  ds_read_b128 a[148:151], v249 offset:640
  v_mul_f32 v202, s29, v194
  v_mfma_f32_16x16x32_bf16 v[92:95], v[208:211], a[188:191], v[92:95]
  s_waitcnt lgkmcnt(14)
  buffer_store_dwordx4 v[12:15], v233, s[16:19], s39 offen offset:3072 nt
  ds_read_b128 a[152:155], v249 offset:576
  v_mul_f32 v200, s29, v192
  v_mul_f32 v203, s29, v195
  s_waitcnt lgkmcnt(12)
  v_mfma_f32_16x16x32_bf16 v[192:195], a[128:131], a[32:35], v[228:231]
  buffer_store_dwordx4 v[32:35], v233, s[16:19], s33 offen nt
  v_exp_f32 v200, v200
  s_waitcnt lgkmcnt(10)
  v_mfma_f32_16x16x32_bf16 v[192:195], a[132:135], a[36:39], v[192:195]
  s_waitcnt lgkmcnt(7)
  buffer_store_dwordx4 v[36:39], v233, s[16:19], s33 offen offset:1024 nt
  v_mul_f32 v206, s29, v198
  v_mul_f32_e64 v207, s29, v199
  v_mfma_f32_16x16x32_bf16 v[192:195], a[136:139], a[40:43], v[192:195]
  s_waitcnt lgkmcnt(5)
  buffer_store_dwordx4 v[40:43], v233, s[16:19], s33 offen offset:2048 nt
  v_exp_f32 v203, v203
  v_mfma_f32_16x16x32_bf16 v[192:195], a[140:143], a[44:47], v[192:195]
  s_waitcnt lgkmcnt(2)
  buffer_store_dwordx4 v[44:47], v233, s[16:19], s33 offen offset:3072 nt
  v_mul_f32 v204, s29, v196
  v_mul_f32_e64 v205, s29, v197
  v_mfma_f32_16x16x32_bf16 v[196:199], a[144:147], a[44:47], v[228:231]
  s_waitcnt lgkmcnt(1)
  v_exp_f32 v201, v201
  v_mfma_f32_16x16x32_bf16 v[196:199], a[148:151], a[40:43], v[196:199]
  s_waitcnt lgkmcnt(0)
  v_exp_f32 v202, v202
  v_exp_f32 v204, v204
  v_exp_f32 v205, v205
  v_exp_f32 v206, v206
  v_exp_f32 v207, v207
  v_mfma_f32_16x16x32_bf16 v[196:199], a[152:155], a[36:39], v[196:199]
  v_cvt_pk_bf16_f32 v212, v200, v201
  v_cvt_pk_bf16_f32 v213, v202, v203
  v_cvt_pk_bf16_f32 v214, v204, v205
  v_cvt_pk_bf16_f32 v215, v206, v207
  v_mfma_f32_16x16x32_bf16 v[196:199], a[156:159], a[32:35], v[196:199]
  v_mul_f32 v201, s29, v193
  v_mul_f32 v203, s29, v195
  v_mfma_f32_16x16x32_bf16 v[96:99], v[212:215], a[160:163], v[96:99]
  ds_read_b64_tr_b16 a[162:163], v255 offset:8960
  v_mul_f32_e64 v202, s29, v194
  v_mfma_f32_16x16x32_bf16 v[100:103], v[212:215], a[164:167], v[100:103]
  ds_read_b64_tr_b16 a[164:165], v255 offset:8464
  v_mul_f32_e64 v200, s29, v192
  v_mfma_f32_16x16x32_bf16 v[104:107], v[212:215], a[168:171], v[104:107]
  ds_read_b64_tr_b16 a[168:169], v255 offset:8480
  v_mul_f32_e64 v206, s29, v198
  v_mfma_f32_16x16x32_bf16 v[108:111], v[212:215], a[172:175], v[108:111]
  ds_read_b64_tr_b16 a[172:173], v255 offset:8496
  v_mul_f32_e64 v205, s29, v197
  v_mfma_f32_16x16x32_bf16 v[112:115], v[212:215], a[176:179], v[112:115]
  v_exp_f32_e64 v201, v201
  v_mfma_f32_16x16x32_bf16 v[116:119], v[212:215], a[180:183], v[116:119]
  ds_read_b64_tr_b16 a[174:175], v255 offset:9008
  v_mul_f32_e64 v207, s29, v199
  v_mfma_f32_16x16x32_bf16 v[120:123], v[212:215], a[184:187], v[120:123]
  v_exp_f32_e64 v207, v207
  v_mfma_f32_16x16x32_bf16 v[124:127], v[212:215], a[188:191], v[124:127]
  ds_read_b64_tr_b16 a[160:161], v255 offset:8448
  ds_read_b64_tr_b16 a[182:183], v255 offset:9040
  v_smfmac_f32_16x16x64_bf16 a[196:199], a[220:223], v[208:215], v254
  ds_read_b64_tr_b16 a[178:179], v255 offset:9024
  v_mul_f32_e64 v204, s29, v196
  v_mfma_f32_16x16x32_bf16 v[192:195], a[128:131], a[48:51], v[228:231]
  v_exp_f32_e64 v205, v205
  v_mfma_f32_16x16x32_bf16 v[192:195], a[132:135], a[52:55], v[192:195]
  ds_read_b64_tr_b16 a[176:177], v255 offset:8512
  ds_read_b64_tr_b16 a[184:185], v255 offset:8544
  v_mfma_f32_16x16x32_bf16 v[192:195], a[136:139], a[56:59], v[192:195]
  ds_read_b64_tr_b16 a[166:167], v255 offset:8976
  ds_read_b64_tr_b16 a[180:181], v255 offset:8528
  v_mfma_f32_16x16x32_bf16 v[192:195], a[140:143], a[60:63], v[192:195]
  ds_read_b64_tr_b16 a[170:171], v255 offset:8992
  ds_read_b64_tr_b16 a[186:187], v255 offset:9056
  v_mfma_f32_16x16x32_bf16 v[196:199], a[144:147], a[60:63], v[228:231]
  v_exp_f32_e64 v206, v206
  v_mfma_f32_16x16x32_bf16 v[196:199], a[148:151], a[56:59], v[196:199]
  v_exp_f32 v200, v200
  v_exp_f32 v202, v202
  v_exp_f32 v203, v203
  v_exp_f32 v204, v204
  v_mfma_f32_16x16x32_bf16 v[196:199], a[152:155], a[52:55], v[196:199]
  s_waitcnt lgkmcnt(8)
  v_cvt_pk_bf16_f32 v208, v200, v201
  v_cvt_pk_bf16_f32 v209, v202, v203
  v_cvt_pk_bf16_f32 v210, v204, v205
  v_cvt_pk_bf16_f32 v211, v206, v207
  v_mfma_f32_16x16x32_bf16 v[196:199], a[156:159], a[48:51], v[196:199]
  ds_read_b64_tr_b16 a[188:189], v255 offset:8560
  ds_read_b64_tr_b16 a[190:191], v255 offset:9072
  v_mfma_f32_16x16x32_bf16 v[64:67], v[208:211], a[160:163], v[64:67]
  s_waitcnt lgkmcnt(5)
  v_mul_f32 v200, s29, v192
  v_mul_f32 v201, s29, v193
  v_mfma_f32_16x16x32_bf16 v[68:71], v[208:211], a[164:167], v[68:71]
  s_waitcnt lgkmcnt(3)
  v_mul_f32 v202, s29, v194
  v_mul_f32_e64 v203, s29, v195
  v_mfma_f32_16x16x32_bf16 v[72:75], v[208:211], a[168:171], v[72:75]
  v_mul_f32 v204, s29, v196
  v_mul_f32 v205, s29, v197
  v_mfma_f32_16x16x32_bf16 v[76:79], v[208:211], a[172:175], v[76:79]
  v_mul_f32 v206, s29, v198
  v_mul_f32 v207, s29, v199
  v_mfma_f32_16x16x32_bf16 v[80:83], v[208:211], a[176:179], v[80:83]
  v_exp_f32_e64 v204, v204
  v_mfma_f32_16x16x32_bf16 v[84:87], v[208:211], a[180:183], v[84:87]
  s_waitcnt lgkmcnt(2)
  v_exp_f32 v200, v200
  v_mfma_f32_16x16x32_bf16 v[88:91], v[208:211], a[184:187], v[88:91]
  s_waitcnt lgkmcnt(0)
  v_exp_f32 v206, v206
  v_mfma_f32_16x16x32_bf16 v[92:95], v[208:211], a[188:191], v[92:95]
  v_exp_f32_e64 v205, v205
  v_mfma_f32_16x16x32_bf16 v[192:195], a[128:131], a[64:67], v[228:231]
  v_exp_f32_e64 v201, v201
  v_mfma_f32_16x16x32_bf16 v[192:195], a[132:135], a[68:71], v[192:195]
  v_cvt_pk_bf16_f32 v212, v200, v201
  v_cvt_pk_bf16_f32 v214, v204, v205
  v_mfma_f32_16x16x32_bf16 v[192:195], a[136:139], a[72:75], v[192:195]
  v_exp_f32_e64 v203, v203
  v_mfma_f32_16x16x32_bf16 v[192:195], a[140:143], a[76:79], v[192:195]
  v_exp_f32_e64 v202, v202
  v_mfma_f32_16x16x32_bf16 v[196:199], a[144:147], a[76:79], v[228:231]
  v_exp_f32_e64 v207, v207
  v_mfma_f32_16x16x32_bf16 v[196:199], a[148:151], a[72:75], v[196:199]
  v_cvt_pk_bf16_f32 v213, v202, v203
  v_cvt_pk_bf16_f32 v215, v206, v207
  v_mfma_f32_16x16x32_bf16 v[196:199], a[152:155], a[68:71], v[196:199]
  v_mul_f32 v200, s29, v192
  v_mul_f32 v202, s29, v194
  v_mfma_f32_16x16x32_bf16 v[196:199], a[156:159], a[64:67], v[196:199]
  v_mul_f32 v201, s29, v193
  v_mul_f32 v203, s29, v195
  v_smfmac_f32_16x16x64_bf16 a[196:199], a[220:223], v[208:215], v254
  ds_write_b128 v234, a[224:227] offset:0
  v_exp_f32_e64 v202, v202
  v_mfma_f32_16x16x32_bf16 v[96:99], v[212:215], a[160:163], v[96:99]
  v_exp_f32_e64 v203, v203
  v_mfma_f32_16x16x32_bf16 v[100:103], v[212:215], a[164:167], v[100:103]
  v_mul_f32_e64 v207, s29, v199
  v_cvt_pk_bf16_f32 v209, v202, v203
  v_mfma_f32_16x16x32_bf16 v[104:107], v[212:215], a[168:171], v[104:107]
  v_accvgpr_read_b32 v244, a196
  v_accvgpr_read_b32 v250, a197
  v_mfma_f32_16x16x32_bf16 v[108:111], v[212:215], a[172:175], v[108:111]
  v_add_f32 v244, v244, v250
  v_mul_f32 v204, s29, v196
  v_mfma_f32_16x16x32_bf16 v[112:115], v[212:215], a[176:179], v[112:115]
  v_rcp_f32_e64 v244, v244
  v_mfma_f32_16x16x32_bf16 v[116:119], v[212:215], a[180:183], v[116:119]
  v_accvgpr_read_b32 v245, a198
  v_accvgpr_read_b32 v251, a199
  v_mfma_f32_16x16x32_bf16 v[120:123], v[212:215], a[184:187], v[120:123]
  v_add_f32 v245, v245, v251
  v_rcp_f32 v245, v245
  v_mfma_f32_16x16x32_bf16 v[124:127], v[212:215], a[188:191], v[124:127]
  v_exp_f32_e64 v207, v207
  v_mfma_f32_16x16x4_f32 v[224:227], v244, a121, 0
  v_exp_f32_e64 v204, v204
  v_mfma_f32_16x16x4_f32 v[250:253], v245, a121, 0
  v_mul_f32 v205, s29, v197
  v_mul_f32 v206, s29, v198
  v_mfma_f32_16x16x32_bf16 v[192:195], a[128:131], a[80:83], v[228:231]
  v_exp_f32_e64 v205, v205
  v_mfma_f32_16x16x32_bf16 v[192:195], a[132:135], a[84:87], v[192:195]
  v_exp_f32_e64 v206, v206
  v_mfma_f32_16x16x32_bf16 v[192:195], a[136:139], a[88:91], v[192:195]
  v_exp_f32_e64 v200, v200
  v_mfma_f32_16x16x32_bf16 v[192:195], a[140:143], a[92:95], v[192:195]
  ds_read_b128 a[132:135], v249 offset:33856
  v_cvt_pk_bf16_f32 v210, v204, v205
  v_pk_mul_f32 v[64:65], v[64:65], v[224:225]
  v_pk_mul_f32 v[68:69], v[68:69], v[224:225]
  v_pk_mul_f32 v[72:73], v[72:73], v[224:225]
  v_pk_mul_f32 v[76:77], v[76:77], v[224:225]
  v_pk_mul_f32 v[80:81], v[80:81], v[224:225]
  v_pk_mul_f32 v[84:85], v[84:85], v[224:225]
  v_pk_mul_f32 v[88:89], v[88:89], v[224:225]
  v_pk_mul_f32 v[92:93], v[92:93], v[224:225]
  v_cvt_pk_bf16_f32 v216, v64, v68
  v_cvt_pk_bf16_f32 v217, v72, v76
  v_cvt_pk_bf16_f32 v218, v80, v84
  v_cvt_pk_bf16_f32 v219, v88, v92
  v_cvt_pk_bf16_f32 v220, v65, v69
  v_cvt_pk_bf16_f32 v221, v73, v77
  v_cvt_pk_bf16_f32 v222, v81, v85
  v_cvt_pk_bf16_f32 v223, v89, v93
  ds_write_b128 v232, v[216:219] offset:8192
  ds_write_b128 v232, v[220:223] offset:8448
  v_pk_mul_f32 v[66:67], v[66:67], v[226:227]
  v_pk_mul_f32 v[70:71], v[70:71], v[226:227]
  v_pk_mul_f32 v[74:75], v[74:75], v[226:227]
  v_pk_mul_f32 v[78:79], v[78:79], v[226:227]
  v_pk_mul_f32 v[82:83], v[82:83], v[226:227]
  v_pk_mul_f32 v[86:87], v[86:87], v[226:227]
  v_pk_mul_f32 v[90:91], v[90:91], v[226:227]
  v_pk_mul_f32 v[94:95], v[94:95], v[226:227]
  v_cvt_pk_bf16_f32 v216, v66, v70
  v_cvt_pk_bf16_f32 v217, v74, v78
  v_cvt_pk_bf16_f32 v218, v82, v86
  v_cvt_pk_bf16_f32 v219, v90, v94
  v_cvt_pk_bf16_f32 v220, v67, v71
  v_cvt_pk_bf16_f32 v221, v75, v79
  v_cvt_pk_bf16_f32 v222, v83, v87
  v_cvt_pk_bf16_f32 v223, v91, v95
  ds_write_b128 v232, v[216:219] offset:8704
  ds_write_b128 v232, v[220:223] offset:8960
  v_pk_mul_f32 v[96:97], v[96:97], v[250:251]
  v_pk_mul_f32 v[100:101], v[100:101], v[250:251]
  v_pk_mul_f32 v[104:105], v[104:105], v[250:251]
  v_pk_mul_f32 v[108:109], v[108:109], v[250:251]
  v_pk_mul_f32 v[112:113], v[112:113], v[250:251]
  v_pk_mul_f32 v[116:117], v[116:117], v[250:251]
  v_pk_mul_f32 v[120:121], v[120:121], v[250:251]
  v_pk_mul_f32 v[124:125], v[124:125], v[250:251]
  v_cvt_pk_bf16_f32 v216, v96, v100
  v_cvt_pk_bf16_f32 v217, v104, v108
  v_cvt_pk_bf16_f32 v218, v112, v116
  v_cvt_pk_bf16_f32 v219, v120, v124
  v_cvt_pk_bf16_f32 v220, v97, v101
  v_cvt_pk_bf16_f32 v221, v105, v109
  v_cvt_pk_bf16_f32 v222, v113, v117
  v_cvt_pk_bf16_f32 v223, v121, v125
  ds_read_b64_tr_b16 v[64:65], v235 offset:8192
  ds_read_b64_tr_b16 v[66:67], v235 offset:8256
  ds_read_b64_tr_b16 v[68:69], v235 offset:9216
  ds_read_b64_tr_b16 v[70:71], v235 offset:9280
  ds_write_b128 v232, v[216:219] offset:12288
  ds_write_b128 v232, v[220:223] offset:12544
  v_pk_mul_f32 v[98:99], v[98:99], v[252:253]
  v_pk_mul_f32 v[102:103], v[102:103], v[252:253]
  v_pk_mul_f32 v[106:107], v[106:107], v[252:253]
  v_pk_mul_f32 v[110:111], v[110:111], v[252:253]
  v_pk_mul_f32 v[114:115], v[114:115], v[252:253]
  v_pk_mul_f32 v[118:119], v[118:119], v[252:253]
  v_pk_mul_f32 v[122:123], v[122:123], v[252:253]
  v_pk_mul_f32 v[126:127], v[126:127], v[252:253]
  v_cvt_pk_bf16_f32 v216, v98, v102
  v_cvt_pk_bf16_f32 v217, v106, v110
  v_cvt_pk_bf16_f32 v218, v114, v118
  v_cvt_pk_bf16_f32 v219, v122, v126
  v_cvt_pk_bf16_f32 v220, v99, v103
  v_cvt_pk_bf16_f32 v221, v107, v111
  v_cvt_pk_bf16_f32 v222, v115, v119
  v_cvt_pk_bf16_f32 v223, v123, v127
  ds_read_b64_tr_b16 v[72:73], v235 offset:10240
  ds_read_b64_tr_b16 v[74:75], v235 offset:10304
  ds_read_b64_tr_b16 v[76:77], v235 offset:11264
  ds_read_b64_tr_b16 v[78:79], v235 offset:11328
  ds_write_b128 v232, v[216:219] offset:12800
  ds_write_b128 v232, v[220:223] offset:13056
  s_waitcnt lgkmcnt(10)
  buffer_store_dwordx4 v[64:67], v233, s[16:19], s34 offen nt
  s_waitcnt lgkmcnt(8)
  buffer_store_dwordx4 v[68:71], v233, s[16:19], s34 offen offset:1024 nt
  v_mfma_f32_16x16x32_bf16 v[196:199], a[144:147], a[92:95], v[228:231]
  s_waitcnt lgkmcnt(4)
  v_exp_f32 v201, v201
  v_mfma_f32_16x16x32_bf16 v[196:199], a[148:151], a[88:91], v[196:199]
  ds_read_b64_tr_b16 v[96:97], v235 offset:12288
  v_cvt_pk_bf16_f32 v208, v200, v201
  v_mfma_f32_16x16x32_bf16 v[196:199], a[152:155], a[84:87], v[196:199]
  ds_read_b64_tr_b16 v[98:99], v235 offset:12352
  v_cvt_pk_bf16_f32 v211, v206, v207
  v_mfma_f32_16x16x32_bf16 v[196:199], a[156:159], a[80:83], v[196:199]
  ds_read_b128 a[140:143], v249 offset:33984
  ds_read_b128 a[144:147], v249 offset:34496
  v_mfma_f32_16x16x32_bf16 v[128:131], v[208:211], a[160:163], v[128:131]
  buffer_store_dwordx4 v[72:75], v233, s[16:19], s34 offen offset:2048 nt
  ds_read_b128 a[128:131], v249 offset:33792
  ds_read_b64_tr_b16 v[100:101], v235 offset:13312
  v_mfma_f32_16x16x32_bf16 v[132:135], v[208:211], a[164:167], v[132:135]
  ds_read_b128 a[136:139], v249 offset:33920
  ds_read_b64_tr_b16 v[102:103], v235 offset:13376
  v_mfma_f32_16x16x32_bf16 v[136:139], v[208:211], a[168:171], v[136:139]
  s_waitcnt lgkmcnt(10)
  buffer_store_dwordx4 v[76:79], v233, s[16:19], s34 offen offset:3072 nt
  ds_read_b64_tr_b16 v[104:105], v235 offset:14336
  v_mul_f32 v201, s29, v193
  v_mfma_f32_16x16x32_bf16 v[140:143], v[208:211], a[172:175], v[140:143]
  ds_read_b128 a[156:159], v249 offset:34304
  ds_read_b64_tr_b16 v[106:107], v235 offset:14400
  v_mfma_f32_16x16x32_bf16 v[144:147], v[208:211], a[176:179], v[144:147]
  v_mul_f32 v203, s29, v195
  v_mul_f32 v207, s29, v199
  v_mfma_f32_16x16x32_bf16 v[148:151], v[208:211], a[180:183], v[148:151]
  ds_read_b64_tr_b16 v[108:109], v235 offset:15360
  ds_read_b64_tr_b16 v[110:111], v235 offset:15424
  v_mfma_f32_16x16x32_bf16 v[152:155], v[208:211], a[184:187], v[152:155]
  ds_read_b128 a[148:151], v249 offset:34432
  v_mul_f32_e64 v205, s29, v197
  v_mfma_f32_16x16x32_bf16 v[156:159], v[208:211], a[188:191], v[156:159]
  ds_read_b128 a[152:155], v249 offset:34368
  v_mul_f32 v200, s29, v192
  v_mul_f32_e64 v202, s29, v194
  s_waitcnt lgkmcnt(10)
  v_mfma_f32_16x16x32_bf16 v[192:195], a[128:131], a[64:67], v[228:231]
  buffer_store_dwordx4 v[96:99], v233, s[16:19], s36 offen nt
  v_mul_f32 v204, s29, v196
  v_mul_f32 v206, s29, v198
  v_mfma_f32_16x16x32_bf16 v[192:195], a[132:135], a[68:71], v[192:195]
  s_waitcnt lgkmcnt(7)
  buffer_store_dwordx4 v[100:103], v233, s[16:19], s36 offen offset:1024 nt
  v_exp_f32 v203, v203
  v_mfma_f32_16x16x32_bf16 v[192:195], a[136:139], a[72:75], v[192:195]
  s_waitcnt lgkmcnt(4)
  buffer_store_dwordx4 v[104:107], v233, s[16:19], s36 offen offset:2048 nt
  v_exp_f32 v201, v201
  v_mfma_f32_16x16x32_bf16 v[192:195], a[140:143], a[76:79], v[192:195]
  s_waitcnt lgkmcnt(2)
  buffer_store_dwordx4 v[108:111], v233, s[16:19], s36 offen offset:3072 nt
  v_exp_f32 v206, v206
  v_mfma_f32_16x16x32_bf16 v[196:199], a[144:147], a[76:79], v[228:231]
  s_waitcnt lgkmcnt(1)
  v_exp_f32 v207, v207
  v_mfma_f32_16x16x32_bf16 v[196:199], a[148:151], a[72:75], v[196:199]
  s_waitcnt lgkmcnt(0)
  v_exp_f32 v200, v200
  v_exp_f32 v202, v202
  v_exp_f32 v204, v204
  v_exp_f32_e64 v205, v205
  v_mfma_f32_16x16x32_bf16 v[196:199], a[152:155], a[68:71], v[196:199]
  v_cvt_pk_bf16_f32 v212, v200, v201
  v_cvt_pk_bf16_f32 v213, v202, v203
  v_cvt_pk_bf16_f32 v214, v204, v205
  v_cvt_pk_bf16_f32 v215, v206, v207
  v_mfma_f32_16x16x32_bf16 v[196:199], a[156:159], a[64:67], v[196:199]
  v_mul_f32 v200, s29, v192
  v_mul_f32 v203, s29, v195
  v_mfma_f32_16x16x32_bf16 v[160:163], v[212:215], a[160:163], v[160:163]
  ds_read_b64_tr_b16 a[160:161], v255 offset:42240
  v_mul_f32_e64 v201, s29, v193
  v_mfma_f32_16x16x32_bf16 v[164:167], v[212:215], a[164:167], v[164:167]
  ds_read_b64_tr_b16 a[164:165], v255 offset:42256
  ds_read_b64_tr_b16 a[166:167], v255 offset:42768
  v_mfma_f32_16x16x32_bf16 v[168:171], v[212:215], a[168:171], v[168:171]
  ds_read_b64_tr_b16 a[168:169], v255 offset:42272
  v_mul_f32_e64 v205, s29, v197
  v_mfma_f32_16x16x32_bf16 v[172:175], v[212:215], a[172:175], v[172:175]
  ds_read_b64_tr_b16 a[170:171], v255 offset:42784
  v_mul_f32_e64 v202, s29, v194
  v_mfma_f32_16x16x32_bf16 v[176:179], v[212:215], a[176:179], v[176:179]
  ds_read_b64_tr_b16 a[178:179], v255 offset:42816
  v_mul_f32_e64 v206, s29, v198
  v_mfma_f32_16x16x32_bf16 v[180:183], v[212:215], a[180:183], v[180:183]
  v_exp_f32_e64 v203, v203
  v_mfma_f32_16x16x32_bf16 v[184:187], v[212:215], a[184:187], v[184:187]
  ds_read_b64_tr_b16 a[162:163], v255 offset:42752
  ds_read_b64_tr_b16 a[176:177], v255 offset:42304
  v_mfma_f32_16x16x32_bf16 v[188:191], v[212:215], a[188:191], v[188:191]
  v_exp_f32_e64 v202, v202
  v_smfmac_f32_16x16x64_bf16 a[200:203], a[220:223], v[208:215], v254
  ds_read_b64_tr_b16 a[174:175], v255 offset:42800
  v_mul_f32_e64 v207, s29, v199
  v_mfma_f32_16x16x32_bf16 v[192:195], a[128:131], a[80:83], v[228:231]
  ds_read_b64_tr_b16 a[172:173], v255 offset:42288
  v_cvt_pk_bf16_f32 v209, v202, v203
  v_mfma_f32_16x16x32_bf16 v[192:195], a[132:135], a[84:87], v[192:195]
  v_exp_f32_e64 v201, v201
  v_mfma_f32_16x16x32_bf16 v[192:195], a[136:139], a[88:91], v[192:195]
  v_exp_f32_e64 v205, v205
  v_mfma_f32_16x16x32_bf16 v[192:195], a[140:143], a[92:95], v[192:195]
  ds_read_b64_tr_b16 a[186:187], v255 offset:42848
  v_mul_f32_e64 v204, s29, v196
  v_mfma_f32_16x16x32_bf16 v[196:199], a[144:147], a[92:95], v[228:231]
  v_exp_f32_e64 v204, v204
  v_mfma_f32_16x16x32_bf16 v[196:199], a[148:151], a[88:91], v[196:199]
  v_exp_f32 v200, v200
  v_exp_f32 v206, v206
  v_exp_f32_e64 v207, v207
  v_mfma_f32_16x16x32_bf16 v[196:199], a[152:155], a[84:87], v[196:199]
  ds_read_b64_tr_b16 a[180:181], v255 offset:42320
  ds_read_b64_tr_b16 a[182:183], v255 offset:42832
  v_cvt_pk_bf16_f32 v208, v200, v201
  v_cvt_pk_bf16_f32 v210, v204, v205
  v_cvt_pk_bf16_f32 v211, v206, v207
  v_mfma_f32_16x16x32_bf16 v[196:199], a[156:159], a[80:83], v[196:199]
  ds_read_b64_tr_b16 a[184:185], v255 offset:42336
  ds_read_b64_tr_b16 a[188:189], v255 offset:42352
  s_waitcnt lgkmcnt(8)
  v_mfma_f32_16x16x32_bf16 v[128:131], v[208:211], a[160:163], v[128:131]
  ds_read_b64_tr_b16 a[190:191], v255 offset:42864
  v_mul_f32 v203, s29, v195
  v_mfma_f32_16x16x32_bf16 v[132:135], v[208:211], a[164:167], v[132:135]
  v_exp_f32_e64 v203, v203
  v_mfma_f32_16x16x32_bf16 v[136:139], v[208:211], a[168:171], v[136:139]
  s_waitcnt lgkmcnt(6)
  v_mul_f32 v205, s29, v197
  v_mul_f32_e64 v207, s29, v199
  v_mfma_f32_16x16x32_bf16 v[140:143], v[208:211], a[172:175], v[140:143]
  s_waitcnt lgkmcnt(3)
  v_mul_f32 v200, s29, v192
  v_mul_f32_e64 v204, s29, v196
  v_mfma_f32_16x16x32_bf16 v[144:147], v[208:211], a[176:179], v[144:147]
  ds_write_b128 v234, a[228:231] offset:1024
  v_mul_f32 v201, s29, v193
  v_mul_f32 v202, s29, v194
  v_mul_f32_e64 v206, s29, v198
  v_mfma_f32_16x16x32_bf16 v[148:151], v[208:211], a[180:183], v[148:151]
  s_waitcnt lgkmcnt(3)
  v_exp_f32 v200, v200
  v_exp_f32 v201, v201
  v_exp_f32 v202, v202
  v_exp_f32 v204, v204
  v_exp_f32 v205, v205
  v_exp_f32 v206, v206
  v_exp_f32 v207, v207
  v_mfma_f32_16x16x32_bf16 v[152:155], v[208:211], a[184:187], v[152:155]
  ds_write_b128 v234, a[232:235] offset:2048
  v_cvt_pk_bf16_f32 v212, v200, v201
  v_cvt_pk_bf16_f32 v213, v202, v203
  v_cvt_pk_bf16_f32 v214, v204, v205
  v_cvt_pk_bf16_f32 v215, v206, v207
  s_waitcnt lgkmcnt(2)
  v_mfma_f32_16x16x32_bf16 v[156:159], v[208:211], a[188:191], v[156:159]
  v_accvgpr_read_b32 v248, a204
  v_accvgpr_read_b32 v250, a206
  v_add_f32 v248, v248, v250
  ds_write_b32 v238, v248 offset:0
  v_smfmac_f32_16x16x64_bf16 a[200:203], a[220:223], v[208:215], v254
  ds_write_b128 v234, a[236:239] offset:3072
  v_mfma_f32_16x16x32_bf16 v[160:163], v[212:215], a[160:163], v[160:163]
  v_mfma_f32_16x16x32_bf16 v[164:167], v[212:215], a[164:167], v[164:167]
  ds_write_b128 v234, a[240:243] offset:4096
  v_mfma_f32_16x16x32_bf16 v[168:171], v[212:215], a[168:171], v[168:171]
  v_accvgpr_read_b32 v246, a200
  v_accvgpr_read_b32 v250, a201
  v_mfma_f32_16x16x32_bf16 v[172:175], v[212:215], a[172:175], v[172:175]
  ds_write_b128 v234, a[244:247] offset:5120
  v_add_f32_e64 v246, v246, v250
  v_mfma_f32_16x16x32_bf16 v[176:179], v[212:215], a[176:179], v[176:179]
  v_rcp_f32_e64 v246, v246
  v_mfma_f32_16x16x32_bf16 v[180:183], v[212:215], a[180:183], v[180:183]
  ds_write_b128 v234, a[248:251] offset:6144
  v_accvgpr_read_b32 v247, a202
  v_accvgpr_read_b32 v251, a203
  v_mfma_f32_16x16x32_bf16 v[184:187], v[212:215], a[184:187], v[184:187]
  v_add_f32 v247, v247, v251
  v_rcp_f32 v247, v247
  v_mfma_f32_16x16x32_bf16 v[188:191], v[212:215], a[188:191], v[188:191]
  ds_write_b128 v234, a[252:255] offset:7168
  v_mfma_f32_16x16x4_f32 v[224:227], v246, a121, 0
  v_mfma_f32_16x16x4_f32 v[250:253], v247, a121, 0
  s_waitcnt lgkmcnt(0)
  s_barrier
  ds_read_b32 v112, v239 offset:0
  ds_read_b32 v113, v239 offset:256
  ds_read_b32 v114, v239 offset:512
  ds_read_b32 v115, v239 offset:768
  ds_read_b128 v[64:67], v236 offset:0
  ds_read_b128 v[68:71], v236 offset:1024
  ds_read_b128 v[72:75], v236 offset:24576
  ds_read_b128 v[76:79], v236 offset:25600
  ds_read_b128 v[80:83], v237 offset:0
  ds_read_b128 v[84:87], v237 offset:1024
  ds_read_b128 v[88:91], v237 offset:24576
  ds_read_b128 v[92:95], v237 offset:25600
  v_pk_mul_f32 v[128:129], v[128:129], v[224:225]
  v_pk_mul_f32 v[132:133], v[132:133], v[224:225]
  v_pk_mul_f32 v[136:137], v[136:137], v[224:225]
  v_pk_mul_f32 v[140:141], v[140:141], v[224:225]
  v_pk_mul_f32 v[144:145], v[144:145], v[224:225]
  v_pk_mul_f32 v[148:149], v[148:149], v[224:225]
  v_pk_mul_f32 v[152:153], v[152:153], v[224:225]
  v_pk_mul_f32 v[156:157], v[156:157], v[224:225]
  v_cvt_pk_bf16_f32 v216, v128, v132
  v_cvt_pk_bf16_f32 v217, v136, v140
  v_cvt_pk_bf16_f32 v218, v144, v148
  v_cvt_pk_bf16_f32 v219, v152, v156
  v_cvt_pk_bf16_f32 v220, v129, v133
  v_cvt_pk_bf16_f32 v221, v137, v141
  v_cvt_pk_bf16_f32 v222, v145, v149
  v_cvt_pk_bf16_f32 v223, v153, v157
  ds_write_b128 v232, v[216:219] offset:16384
  ds_write_b128 v232, v[220:223] offset:16640
  v_pk_mul_f32 v[130:131], v[130:131], v[226:227]
  v_pk_mul_f32 v[134:135], v[134:135], v[226:227]
  v_pk_mul_f32 v[138:139], v[138:139], v[226:227]
  v_pk_mul_f32 v[142:143], v[142:143], v[226:227]
  v_pk_mul_f32 v[146:147], v[146:147], v[226:227]
  v_pk_mul_f32 v[150:151], v[150:151], v[226:227]
  v_pk_mul_f32 v[154:155], v[154:155], v[226:227]
  v_pk_mul_f32 v[158:159], v[158:159], v[226:227]
  v_cvt_pk_bf16_f32 v216, v130, v134
  v_cvt_pk_bf16_f32 v217, v138, v142
  v_cvt_pk_bf16_f32 v218, v146, v150
  v_cvt_pk_bf16_f32 v219, v154, v158
  v_cvt_pk_bf16_f32 v220, v131, v135
  v_cvt_pk_bf16_f32 v221, v139, v143
  v_cvt_pk_bf16_f32 v222, v147, v151
  v_cvt_pk_bf16_f32 v223, v155, v159
  ds_write_b128 v232, v[216:219] offset:16896
  ds_write_b128 v232, v[220:223] offset:17152
  s_waitcnt lgkmcnt(14)
  v_add_f32 v112, v112, v113
  s_waitcnt lgkmcnt(12)
  v_add_f32 v114, v114, v115
  v_add_f32 v248, v112, v114
  v_rcp_f32 v248, v248
  s_lshl_b32 s24, s28, 2
  s_add_u32 s25, s24, 1
  s_add_u32 s26, s24, 2
  s_add_u32 s27, s24, 3
  v_readlane_b32 s20, v248, s24
  v_readlane_b32 s21, v248, s25
  v_readlane_b32 s22, v248, s26
  v_readlane_b32 s23, v248, s27
  s_waitcnt lgkmcnt(9)
  v_pk_add_f32 v[64:65], v[64:65], v[72:73]
  v_pk_add_f32 v[66:67], v[66:67], v[74:75]
  s_waitcnt lgkmcnt(8)
  v_pk_add_f32 v[68:69], v[68:69], v[76:77]
  v_pk_add_f32 v[70:71], v[70:71], v[78:79]
  s_waitcnt lgkmcnt(5)
  v_pk_add_f32 v[80:81], v[80:81], v[88:89]
  v_pk_add_f32 v[82:83], v[82:83], v[90:91]
  s_waitcnt lgkmcnt(4)
  v_pk_add_f32 v[84:85], v[84:85], v[92:93]
  v_pk_add_f32 v[86:87], v[86:87], v[94:95]
  v_pk_add_f32 v[64:65], v[64:65], v[80:81]
  v_pk_add_f32 v[66:67], v[66:67], v[82:83]
  v_pk_add_f32 v[68:69], v[68:69], v[84:85]
  v_pk_add_f32 v[70:71], v[70:71], v[86:87]
  v_pk_mul_f32 v[64:65], v[64:65], s[20:21]
  v_pk_mul_f32 v[66:67], v[66:67], s[22:23]
  v_pk_mul_f32 v[68:69], v[68:69], s[20:21]
  v_pk_mul_f32 v[70:71], v[70:71], s[22:23]
  v_cvt_pk_bf16_f32 v64, v64, v68
  v_cvt_pk_bf16_f32 v65, v65, v69
  v_cvt_pk_bf16_f32 v66, v66, v70
  v_cvt_pk_bf16_f32 v67, v67, v71
  ds_write2st64_b32 v240, v64, v65 offset0:0 offset1:1
  ds_write2st64_b32 v240, v66, v67 offset0:2 offset1:3
  v_pk_mul_f32 v[160:161], v[160:161], v[250:251]
  v_pk_mul_f32 v[164:165], v[164:165], v[250:251]
  v_pk_mul_f32 v[168:169], v[168:169], v[250:251]
  v_pk_mul_f32 v[172:173], v[172:173], v[250:251]
  v_pk_mul_f32 v[176:177], v[176:177], v[250:251]
  v_pk_mul_f32 v[180:181], v[180:181], v[250:251]
  v_pk_mul_f32 v[184:185], v[184:185], v[250:251]
  v_pk_mul_f32 v[188:189], v[188:189], v[250:251]
  v_cvt_pk_bf16_f32 v216, v160, v164
  v_cvt_pk_bf16_f32 v217, v168, v172
  v_cvt_pk_bf16_f32 v218, v176, v180
  v_cvt_pk_bf16_f32 v219, v184, v188
  v_cvt_pk_bf16_f32 v220, v161, v165
  v_cvt_pk_bf16_f32 v221, v169, v173
  v_cvt_pk_bf16_f32 v222, v177, v181
  v_cvt_pk_bf16_f32 v223, v185, v189
  ds_read_b64_tr_b16 v[128:129], v235 offset:16384
  ds_read_b64_tr_b16 v[130:131], v235 offset:16448
  ds_read_b64_tr_b16 v[132:133], v235 offset:17408
  ds_read_b64_tr_b16 v[134:135], v235 offset:17472
  ds_write_b128 v232, v[216:219] offset:20480
  ds_write_b128 v232, v[220:223] offset:20736
  v_pk_mul_f32 v[162:163], v[162:163], v[252:253]
  v_pk_mul_f32 v[166:167], v[166:167], v[252:253]
  v_pk_mul_f32 v[170:171], v[170:171], v[252:253]
  v_pk_mul_f32 v[174:175], v[174:175], v[252:253]
  v_pk_mul_f32 v[178:179], v[178:179], v[252:253]
  v_pk_mul_f32 v[182:183], v[182:183], v[252:253]
  v_pk_mul_f32 v[186:187], v[186:187], v[252:253]
  v_pk_mul_f32 v[190:191], v[190:191], v[252:253]
  v_cvt_pk_bf16_f32 v216, v162, v166
  v_cvt_pk_bf16_f32 v217, v170, v174
  v_cvt_pk_bf16_f32 v218, v178, v182
  v_cvt_pk_bf16_f32 v219, v186, v190
  v_cvt_pk_bf16_f32 v220, v163, v167
  v_cvt_pk_bf16_f32 v221, v171, v175
  v_cvt_pk_bf16_f32 v222, v179, v183
  v_cvt_pk_bf16_f32 v223, v187, v191
  ds_read_b64_tr_b16 v[136:137], v235 offset:18432
  ds_read_b64_tr_b16 v[138:139], v235 offset:18496
  ds_read_b64_tr_b16 v[140:141], v235 offset:19456
  ds_read_b64_tr_b16 v[142:143], v235 offset:19520
  ds_read_b64_tr_b16 v[72:73], v241 offset:0
  ds_read_b64_tr_b16 v[74:75], v241 offset:64
  ds_write_b128 v232, v[216:219] offset:20992
  ds_write_b128 v232, v[220:223] offset:21248
  s_waitcnt lgkmcnt(12)
  buffer_store_dwordx4 v[128:131], v233, s[16:19], s30 offen nt
  s_waitcnt lgkmcnt(10)
  buffer_store_dwordx4 v[132:135], v233, s[16:19], s30 offen offset:1024 nt
  ds_read_b64_tr_b16 v[160:161], v235 offset:20480
  ds_read_b64_tr_b16 v[162:163], v235 offset:20544
  ds_read_b64_tr_b16 v[164:165], v235 offset:21504
  ds_read_b64_tr_b16 v[166:167], v235 offset:21568
  s_waitcnt lgkmcnt(10)
  buffer_store_dwordx4 v[136:139], v233, s[16:19], s30 offen offset:2048 nt
  s_waitcnt lgkmcnt(8)
  buffer_store_dwordx4 v[140:143], v233, s[16:19], s30 offen offset:3072 nt
  ds_read_b64_tr_b16 v[168:169], v235 offset:22528
  ds_read_b64_tr_b16 v[170:171], v235 offset:22592
  ds_read_b64_tr_b16 v[172:173], v235 offset:23552
  ds_read_b64_tr_b16 v[174:175], v235 offset:23616
  s_waitcnt lgkmcnt(6)
  buffer_store_dwordx4 v[160:163], v233, s[16:19], s31 offen nt
  s_waitcnt lgkmcnt(4)
  buffer_store_dwordx4 v[164:167], v233, s[16:19], s31 offen offset:1024 nt
  s_waitcnt lgkmcnt(2)
  buffer_store_dwordx4 v[168:171], v233, s[16:19], s31 offen offset:2048 nt
  s_waitcnt lgkmcnt(0)
  buffer_store_dwordx4 v[172:175], v233, s[16:19], s31 offen offset:3072 nt
  s_lshl_b32 s52, s28, 10
  s_add_u32 s52, s52, s40
  buffer_store_dwordx4 v[72:75], v233, s[16:19], s52 offen nt
  v_max3_u32 v250, v242, v243, v244
  v_min3_u32 v251, v242, v243, v244
  v_max3_u32 v250, v250, v245, v246
  v_min3_u32 v251, v251, v245, v246
  v_max_u32 v250, v250, v247
  v_min_u32 v251, v251, v247
  v_cmp_lt_u32 s[20:21], s54, v250
  v_cmp_gt_u32 s[22:23], s53, v251
  v_cmp_lt_u32 s[24:25], s54, v248
  v_cmp_gt_u32 s[26:27], s53, v248
  s_nop 2
  s_or_b64 s[20:21], s[20:21], s[22:23]
  s_addc_u32 s48, s48, s48
  s_or_b64 s[24:25], s[24:25], s[26:27]
  s_addc_u32 s48, s48, s48
  s_barrier
  s_branch L_fin
L_exitC:
  s_add_u32 s50, s28, 1
  s_bitcmp1_b32 s50, 1
  s_cselect_b32 s50, 2048, 0
  s_sub_u32 s35, s35, s50
  v_mov_b32 v249, v216
  v_mov_b32_e64 v255, v217
  s_waitcnt lgkmcnt(0)
  v_mfma_f32_16x16x32_bf16 v[192:195], a[128:131], a[0:3], v[228:231]
  s_add_u32 s33, s39, 4096
  v_mul_f32_e64 v206, s29, v198
  v_cvt_pk_bf16_f32 v213, v202, v203
  v_mfma_f32_16x16x32_bf16 v[192:195], a[132:135], a[4:7], v[192:195]
  s_add_u32 s34, s39, 8192
  v_exp_f32_e64 v206, v206
  v_mfma_f32_16x16x32_bf16 v[192:195], a[136:139], a[8:11], v[192:195]
  s_add_u32 s36, s39, 12288
  v_mul_f32_e64 v207, s29, v199
  v_cvt_pk_bf16_f32 v212, v200, v201
  v_mfma_f32_16x16x32_bf16 v[192:195], a[140:143], a[12:15], v[192:195]
  s_add_u32 s30, s39, 16384
  v_exp_f32_e64 v207, v207
  v_mfma_f32_16x16x32_bf16 v[196:199], a[144:147], a[12:15], v[228:231]
  s_add_u32 s31, s39, 20480
  v_exp_f32_e64 v204, v204
  v_mfma_f32_16x16x32_bf16 v[196:199], a[148:151], a[8:11], v[196:199]
  v_exp_f32_e64 v205, v205
  v_mfma_f32_16x16x32_bf16 v[196:199], a[152:155], a[4:7], v[196:199]
  v_cvt_pk_bf16_f32 v214, v204, v205
  v_cvt_pk_bf16_f32 v215, v206, v207
  v_mfma_f32_16x16x32_bf16 v[196:199], a[156:159], a[0:3], v[196:199]
  v_mul_f32 v201, s29, v193
  v_mul_f32 v203, s29, v195
  v_mfma_f32_16x16x32_bf16 v[160:163], v[212:215], a[160:163], v[160:163]
  ds_read_b64_tr_b16 a[162:163], v255 offset:8960
  v_mul_f32_e64 v200, s29, v192
  v_mfma_f32_16x16x32_bf16 v[164:167], v[212:215], a[164:167], v[164:167]
  ds_read_b64_tr_b16 a[160:161], v255 offset:8448
  v_mul_f32_e64 v202, s29, v194
  v_mfma_f32_16x16x32_bf16 v[168:171], v[212:215], a[168:171], v[168:171]
  ds_read_b64_tr_b16 a[164:165], v255 offset:8464
  ds_read_b64_tr_b16 a[168:169], v255 offset:8480
  v_mfma_f32_16x16x32_bf16 v[172:175], v[212:215], a[172:175], v[172:175]
  ds_read_b64_tr_b16 a[170:171], v255 offset:8992
  v_mul_f32_e64 v204, s29, v196
  v_mfma_f32_16x16x32_bf16 v[176:179], v[212:215], a[176:179], v[176:179]
  ds_read_b64_tr_b16 a[166:167], v255 offset:8976
  v_mul_f32_e64 v206, s29, v198
  v_mfma_f32_16x16x32_bf16 v[180:183], v[212:215], a[180:183], v[180:183]
  v_exp_f32_e64 v203, v203
  v_mfma_f32_16x16x32_bf16 v[184:187], v[212:215], a[184:187], v[184:187]
  ds_read_b64_tr_b16 a[176:177], v255 offset:8512
  v_mul_f32_e64 v205, s29, v197
  v_mfma_f32_16x16x32_bf16 v[188:191], v[212:215], a[188:191], v[188:191]
  ds_read_b64_tr_b16 a[174:175], v255 offset:9008
  ds_read_b64_tr_b16 a[178:179], v255 offset:9024
  v_smfmac_f32_16x16x64_bf16 a[200:203], a[220:223], v[208:215], v254
  ds_read_b64_tr_b16 a[172:173], v255 offset:8496
  ds_read_b64_tr_b16 a[180:181], v255 offset:8528
  s_waitcnt vmcnt(7)
  s_barrier
  v_mfma_f32_16x16x32_bf16 v[192:195], a[128:131], a[16:19], v[228:231]
  ds_read_b64_tr_b16 a[182:183], v255 offset:9040
  v_mul_f32_e64 v207, s29, v199
  v_mfma_f32_16x16x32_bf16 v[192:195], a[132:135], a[20:23], v[192:195]
  v_exp_f32_e64 v207, v207
  v_mfma_f32_16x16x32_bf16 v[192:195], a[136:139], a[24:27], v[192:195]
  v_exp_f32_e64 v202, v202
  v_mfma_f32_16x16x32_bf16 v[192:195], a[140:143], a[28:31], v[192:195]
  ds_read_b64_tr_b16 a[188:189], v255 offset:8560
  v_cvt_pk_bf16_f32 v209, v202, v203
  v_mfma_f32_16x16x32_bf16 v[196:199], a[144:147], a[28:31], v[228:231]
  v_exp_f32_e64 v206, v206
  v_mfma_f32_16x16x32_bf16 v[196:199], a[148:151], a[24:27], v[196:199]
  v_exp_f32 v200, v200
  v_exp_f32 v201, v201
  v_exp_f32 v204, v204
  v_exp_f32 v205, v205
  v_mfma_f32_16x16x32_bf16 v[196:199], a[152:155], a[20:23], v[196:199]
  s_waitcnt lgkmcnt(11)
  v_cvt_pk_bf16_f32 v208, v200, v201
  v_cvt_pk_bf16_f32 v210, v204, v205
  v_cvt_pk_bf16_f32 v211, v206, v207
  v_mfma_f32_16x16x32_bf16 v[196:199], a[156:159], a[16:19], v[196:199]
  ds_read_b64_tr_b16 a[184:185], v255 offset:8544
  ds_read_b64_tr_b16 a[186:187], v255 offset:9056
  v_mfma_f32_16x16x32_bf16 v[0:3], v[208:211], a[160:163], v[0:3]
  ds_read_b64_tr_b16 a[190:191], v255 offset:9072
  ds_read_b128 a[132:135], v249 offset:33856
  s_waitcnt lgkmcnt(11)
  v_mfma_f32_16x16x32_bf16 v[4:7], v[208:211], a[164:167], v[4:7]
  ds_read_b128 a[128:131], v249 offset:33792
  ds_read_b128 a[140:143], v249 offset:33984
  v_mfma_f32_16x16x32_bf16 v[8:11], v[208:211], a[168:171], v[8:11]
  ds_read_b128 a[136:139], v249 offset:33920
  ds_read_b128 a[144:147], v249 offset:34496
  s_waitcnt lgkmcnt(11)
  v_mfma_f32_16x16x32_bf16 v[12:15], v[208:211], a[172:175], v[12:15]
  ds_read_b128 a[152:155], v249 offset:34368
  v_mul_f32 v202, s29, v194
  v_mfma_f32_16x16x32_bf16 v[16:19], v[208:211], a[176:179], v[16:19]
  s_waitcnt lgkmcnt(10)
  v_mul_f32 v200, s29, v192
  v_mul_f32_e64 v201, s29, v193
  v_mfma_f32_16x16x32_bf16 v[20:23], v[208:211], a[180:183], v[20:23]
  ds_read_b128 a[148:151], v249 offset:34432
  ds_read_b128 a[156:159], v249 offset:34304
  s_waitcnt lgkmcnt(9)
  v_mfma_f32_16x16x32_bf16 v[24:27], v[208:211], a[184:187], v[24:27]
  s_waitcnt lgkmcnt(8)
  v_mul_f32 v203, s29, v195
  v_mul_f32 v206, s29, v198
  v_mfma_f32_16x16x32_bf16 v[28:31], v[208:211], a[188:191], v[28:31]
  s_waitcnt lgkmcnt(6)
  v_mul_f32 v205, s29, v197
  v_mul_f32_e64 v207, s29, v199
  v_mfma_f32_16x16x32_bf16 v[192:195], a[128:131], a[0:3], v[228:231]
  ds_read_b64_tr_b16 a[112:113], v235 offset:20480
  v_mul_f32_e64 v204, s29, v196
  v_mfma_f32_16x16x32_bf16 v[192:195], a[132:135], a[4:7], v[192:195]
  s_waitcnt lgkmcnt(5)
  v_exp_f32 v204, v204
  v_mfma_f32_16x16x32_bf16 v[192:195], a[136:139], a[8:11], v[192:195]
  v_exp_f32_e64 v203, v203
  v_mfma_f32_16x16x32_bf16 v[192:195], a[140:143], a[12:15], v[192:195]
  s_waitcnt lgkmcnt(4)
  v_exp_f32 v207, v207
  v_mfma_f32_16x16x32_bf16 v[196:199], a[144:147], a[12:15], v[228:231]
  s_waitcnt lgkmcnt(2)
  v_exp_f32 v202, v202
  v_mfma_f32_16x16x32_bf16 v[196:199], a[148:151], a[8:11], v[196:199]
  v_exp_f32 v200, v200
  v_exp_f32 v201, v201
  v_exp_f32 v205, v205
  v_exp_f32 v206, v206
  v_mfma_f32_16x16x32_bf16 v[196:199], a[152:155], a[4:7], v[196:199]
  s_waitcnt lgkmcnt(1)
  v_cvt_pk_bf16_f32 v212, v200, v201
  v_cvt_pk_bf16_f32 v213, v202, v203
  v_cvt_pk_bf16_f32 v214, v204, v205
  v_cvt_pk_bf16_f32 v215, v206, v207
  v_mfma_f32_16x16x32_bf16 v[196:199], a[156:159], a[0:3], v[196:199]
  v_mul_f32 v200, s29, v192
  v_mul_f32_e64 v202, s29, v194
  v_mfma_f32_16x16x32_bf16 v[32:35], v[212:215], a[160:163], v[32:35]
  v_mul_f32 v201, s29, v193
  v_mul_f32 v203, s29, v195
  v_mfma_f32_16x16x32_bf16 v[36:39], v[212:215], a[164:167], v[36:39]
  ds_read_b64_tr_b16 a[162:163], v255 offset:42752
  ds_read_b64_tr_b16 a[166:167], v255 offset:42768
  v_mfma_f32_16x16x32_bf16 v[40:43], v[212:215], a[168:171], v[40:43]
  ds_read_b64_tr_b16 a[168:169], v255 offset:42272
  v_mul_f32_e64 v207, s29, v199
  v_mfma_f32_16x16x32_bf16 v[44:47], v[212:215], a[172:175], v[44:47]
  ds_read_b64_tr_b16 a[160:161], v255 offset:42240
  v_mul_f32_e64 v206, s29, v198
  v_mfma_f32_16x16x32_bf16 v[48:51], v[212:215], a[176:179], v[48:51]
  ds_read_b64_tr_b16 a[170:171], v255 offset:42784
  v_mul_f32_e64 v205, s29, v197
  v_mfma_f32_16x16x32_bf16 v[52:55], v[212:215], a[180:183], v[52:55]
  ds_read_b64_tr_b16 a[174:175], v255 offset:42800
  v_mul_f32_e64 v204, s29, v196
  v_mfma_f32_16x16x32_bf16 v[56:59], v[212:215], a[184:187], v[56:59]
  ds_read_b64_tr_b16 a[164:165], v255 offset:42256
  ds_read_b64_tr_b16 a[172:173], v255 offset:42288
  v_mfma_f32_16x16x32_bf16 v[60:63], v[212:215], a[188:191], v[60:63]
  v_exp_f32_e64 v200, v200
  v_smfmac_f32_16x16x64_bf16 a[192:195], a[220:223], v[208:215], v254
  ds_read_b64_tr_b16 a[180:181], v255 offset:42320
  ds_read_b64_tr_b16 a[182:183], v255 offset:42832
  v_mfma_f32_16x16x32_bf16 v[192:195], a[128:131], a[16:19], v[228:231]
  v_exp_f32_e64 v204, v204
  v_mfma_f32_16x16x32_bf16 v[192:195], a[132:135], a[20:23], v[192:195]
  v_exp_f32_e64 v205, v205
  v_mfma_f32_16x16x32_bf16 v[192:195], a[136:139], a[24:27], v[192:195]
  v_exp_f32_e64 v207, v207
  v_mfma_f32_16x16x32_bf16 v[192:195], a[140:143], a[28:31], v[192:195]
  v_exp_f32_e64 v206, v206
  v_mfma_f32_16x16x32_bf16 v[196:199], a[144:147], a[28:31], v[228:231]
  v_exp_f32_e64 v201, v201
  v_mfma_f32_16x16x32_bf16 v[196:199], a[148:151], a[24:27], v[196:199]
  ds_read_b64_tr_b16 a[176:177], v255 offset:42304
  ds_read_b64_tr_b16 a[178:179], v255 offset:42816
  v_exp_f32 v202, v202
  v_exp_f32 v203, v203
  v_mfma_f32_16x16x32_bf16 v[196:199], a[152:155], a[20:23], v[196:199]
  s_waitcnt lgkmcnt(8)
  v_cvt_pk_bf16_f32 v208, v200, v201
  v_cvt_pk_bf16_f32 v209, v202, v203
  v_cvt_pk_bf16_f32 v210, v204, v205
  v_cvt_pk_bf16_f32 v211, v206, v207
  v_mfma_f32_16x16x32_bf16 v[196:199], a[156:159], a[16:19], v[196:199]
  ds_read_b64_tr_b16 a[184:185], v255 offset:42336
  ds_read_b64_tr_b16 a[186:187], v255 offset:42848
  v_mfma_f32_16x16x32_bf16 v[0:3], v[208:211], a[160:163], v[0:3]
  ds_read_b64_tr_b16 a[188:189], v255 offset:42352
  ds_read_b64_tr_b16 a[190:191], v255 offset:42864
  s_waitcnt lgkmcnt(9)
  v_mfma_f32_16x16x32_bf16 v[4:7], v[208:211], a[164:167], v[4:7]
  v_mul_f32 v200, s29, v192
  v_mul_f32 v201, s29, v193
  v_mfma_f32_16x16x32_bf16 v[8:11], v[208:211], a[168:171], v[8:11]
  s_waitcnt lgkmcnt(8)
  v_mul_f32 v202, s29, v194
  v_mul_f32_e64 v203, s29, v195
  v_mfma_f32_16x16x32_bf16 v[12:15], v[208:211], a[172:175], v[12:15]
  s_waitcnt lgkmcnt(4)
  v_mul_f32 v204, s29, v196
  v_mul_f32_e64 v207, s29, v199
  v_mfma_f32_16x16x32_bf16 v[16:19], v[208:211], a[176:179], v[16:19]
  v_mul_f32 v205, s29, v197
  v_mul_f32 v206, s29, v198
  v_mfma_f32_16x16x32_bf16 v[20:23], v[208:211], a[180:183], v[20:23]
  s_waitcnt lgkmcnt(2)
  v_exp_f32 v200, v200
  v_mfma_f32_16x16x32_bf16 v[24:27], v[208:211], a[184:187], v[24:27]
  s_waitcnt lgkmcnt(0)
  v_exp_f32 v201, v201
  v_mfma_f32_16x16x32_bf16 v[28:31], v[208:211], a[188:191], v[28:31]
  v_exp_f32_e64 v205, v205
  v_mfma_f32_16x16x32_bf16 v[192:195], a[128:131], a[32:35], v[228:231]
  ds_read_b64_tr_b16 a[114:115], v235 offset:20544
  ds_read_b64_tr_b16 a[116:117], v235 offset:21504
  v_mfma_f32_16x16x32_bf16 v[192:195], a[132:135], a[36:39], v[192:195]
  ds_read_b64_tr_b16 a[118:119], v235 offset:21568
  v_cvt_pk_bf16_f32 v212, v200, v201
  v_mfma_f32_16x16x32_bf16 v[192:195], a[136:139], a[40:43], v[192:195]
  v_exp_f32_e64 v202, v202
  v_mfma_f32_16x16x32_bf16 v[192:195], a[140:143], a[44:47], v[192:195]
  v_exp_f32_e64 v207, v207
  v_mfma_f32_16x16x32_bf16 v[196:199], a[144:147], a[44:47], v[228:231]
  v_exp_f32_e64 v203, v203
  v_mfma_f32_16x16x32_bf16 v[196:199], a[148:151], a[40:43], v[196:199]
  v_exp_f32 v204, v204
  v_exp_f32 v206, v206
  v_mfma_f32_16x16x32_bf16 v[196:199], a[152:155], a[36:39], v[196:199]
  s_waitcnt lgkmcnt(2)
  v_cvt_pk_bf16_f32 v213, v202, v203
  v_cvt_pk_bf16_f32 v214, v204, v205
  v_cvt_pk_bf16_f32 v215, v206, v207
  v_mfma_f32_16x16x32_bf16 v[196:199], a[156:159], a[32:35], v[196:199]
  buffer_store_dwordx4 a[112:115], v233, s[16:19], s35 offen nt
  v_mul_f32 v200, s29, v192
  v_mul_f32_e64 v203, s29, v195
  v_smfmac_f32_16x16x64_bf16 a[192:195], a[220:223], v[208:215], v254
  s_waitcnt lgkmcnt(0)
  buffer_store_dwordx4 a[116:119], v233, s[16:19], s35 offen offset:1024 nt
  v_mul_f32 v201, s29, v193
  v_mul_f32_e64 v202, s29, v194
  v_mfma_f32_16x16x32_bf16 v[32:35], v[212:215], a[160:163], v[32:35]
  v_exp_f32_e64 v203, v203
  v_mfma_f32_16x16x32_bf16 v[36:39], v[212:215], a[164:167], v[36:39]
  ds_read_b64_tr_b16 a[112:113], v235 offset:22528
  ds_read_b64_tr_b16 a[114:115], v235 offset:22592
  v_mfma_f32_16x16x32_bf16 v[40:43], v[212:215], a[168:171], v[40:43]
  ds_read_b64_tr_b16 a[116:117], v235 offset:23552
  ds_read_b64_tr_b16 a[118:119], v235 offset:23616
  v_mfma_f32_16x16x32_bf16 v[44:47], v[212:215], a[172:175], v[44:47]
  v_accvgpr_read_b32 v242, a192
  v_accvgpr_read_b32 v250, a193
  v_mfma_f32_16x16x32_bf16 v[48:51], v[212:215], a[176:179], v[48:51]
  v_add_f32 v242, v242, v250
  v_mul_f32 v205, s29, v197
  v_mfma_f32_16x16x32_bf16 v[52:55], v[212:215], a[180:183], v[52:55]
  v_rcp_f32_e64 v242, v242
  v_mfma_f32_16x16x32_bf16 v[56:59], v[212:215], a[184:187], v[56:59]
  s_waitcnt lgkmcnt(2)
  v_accvgpr_read_b32 v243, a194
  v_accvgpr_read_b32 v251, a195
  v_add_f32 v243, v243, v251
  v_rcp_f32_e64 v243, v243
  v_mfma_f32_16x16x32_bf16 v[60:63], v[212:215], a[188:191], v[60:63]
  buffer_store_dwordx4 a[112:115], v233, s[16:19], s35 offen offset:2048 nt
  v_mul_f32 v206, s29, v198
  v_mul_f32 v207, s29, v199
  v_mfma_f32_16x16x4_f32 v[224:227], v242, a121, 0
  s_waitcnt lgkmcnt(0)
  buffer_store_dwordx4 a[116:119], v233, s[16:19], s35 offen offset:3072 nt
  v_exp_f32 v207, v207
  v_mfma_f32_16x16x4_f32 v[250:253], v243, a121, 0
  v_exp_f32_e64 v205, v205
  v_mfma_f32_16x16x32_bf16 v[192:195], a[128:131], a[48:51], v[228:231]
  ds_read_b128 a[128:131], v249 offset:0
  v_mul_f32_e64 v204, s29, v196
  v_mfma_f32_16x16x32_bf16 v[192:195], a[132:135], a[52:55], v[192:195]
  v_exp_f32_e64 v204, v204
  v_mfma_f32_16x16x32_bf16 v[192:195], a[136:139], a[56:59], v[192:195]
  v_exp_f32_e64 v200, v200
  v_mfma_f32_16x16x32_bf16 v[192:195], a[140:143], a[60:63], v[192:195]
  v_exp_f32_e64 v206, v206
  v_pk_mul_f32 v[0:1], v[0:1], v[224:225]
  v_pk_mul_f32 v[4:5], v[4:5], v[224:225]
  v_pk_mul_f32 v[8:9], v[8:9], v[224:225]
  v_pk_mul_f32 v[12:13], v[12:13], v[224:225]
  v_pk_mul_f32 v[16:17], v[16:17], v[224:225]
  v_pk_mul_f32 v[20:21], v[20:21], v[224:225]
  v_pk_mul_f32 v[24:25], v[24:25], v[224:225]
  v_pk_mul_f32 v[28:29], v[28:29], v[224:225]
  v_cvt_pk_bf16_f32 v216, v0, v4
  v_cvt_pk_bf16_f32 v217, v8, v12
  v_cvt_pk_bf16_f32 v218, v16, v20
  v_cvt_pk_bf16_f32 v219, v24, v28
  v_cvt_pk_bf16_f32 v220, v1, v5
  v_cvt_pk_bf16_f32 v221, v9, v13
  v_cvt_pk_bf16_f32 v222, v17, v21
  v_cvt_pk_bf16_f32 v223, v25, v29
  ds_write_b128 v232, v[216:219] offset:0
  ds_write_b128 v232, v[220:223] offset:256
  v_pk_mul_f32 v[2:3], v[2:3], v[226:227]
  v_pk_mul_f32 v[6:7], v[6:7], v[226:227]
  v_pk_mul_f32 v[10:11], v[10:11], v[226:227]
  v_pk_mul_f32 v[14:15], v[14:15], v[226:227]
  v_pk_mul_f32 v[18:19], v[18:19], v[226:227]
  v_pk_mul_f32 v[22:23], v[22:23], v[226:227]
  v_pk_mul_f32 v[26:27], v[26:27], v[226:227]
  v_pk_mul_f32 v[30:31], v[30:31], v[226:227]
  v_cvt_pk_bf16_f32 v216, v2, v6
  v_cvt_pk_bf16_f32 v217, v10, v14
  v_cvt_pk_bf16_f32 v218, v18, v22
  v_cvt_pk_bf16_f32 v219, v26, v30
  v_cvt_pk_bf16_f32 v220, v3, v7
  v_cvt_pk_bf16_f32 v221, v11, v15
  v_cvt_pk_bf16_f32 v222, v19, v23
  v_cvt_pk_bf16_f32 v223, v27, v31
  ds_write_b128 v232, v[216:219] offset:512
  ds_write_b128 v232, v[220:223] offset:768
  v_pk_mul_f32 v[32:33], v[32:33], v[250:251]
  v_pk_mul_f32 v[36:37], v[36:37], v[250:251]
  v_pk_mul_f32 v[40:41], v[40:41], v[250:251]
  v_pk_mul_f32 v[44:45], v[44:45], v[250:251]
  v_pk_mul_f32 v[48:49], v[48:49], v[250:251]
  v_pk_mul_f32 v[52:53], v[52:53], v[250:251]
  v_pk_mul_f32 v[56:57], v[56:57], v[250:251]
  v_pk_mul_f32 v[60:61], v[60:61], v[250:251]
  v_cvt_pk_bf16_f32 v216, v32, v36
  v_cvt_pk_bf16_f32 v217, v40, v44
  v_cvt_pk_bf16_f32 v218, v48, v52
  v_cvt_pk_bf16_f32 v219, v56, v60
  v_cvt_pk_bf16_f32 v220, v33, v37
  v_cvt_pk_bf16_f32 v221, v41, v45
  v_cvt_pk_bf16_f32 v222, v49, v53
  v_cvt_pk_bf16_f32 v223, v57, v61
  ds_read_b64_tr_b16 v[0:1], v235 offset:0
  ds_read_b64_tr_b16 v[2:3], v235 offset:64
  ds_read_b64_tr_b16 v[4:5], v235 offset:1024
  ds_read_b64_tr_b16 v[6:7], v235 offset:1088
  ds_write_b128 v232, v[216:219] offset:4096
  ds_write_b128 v232, v[220:223] offset:4352
  v_pk_mul_f32 v[34:35], v[34:35], v[252:253]
  v_pk_mul_f32 v[38:39], v[38:39], v[252:253]
  v_pk_mul_f32 v[42:43], v[42:43], v[252:253]
  v_pk_mul_f32 v[46:47], v[46:47], v[252:253]
  v_pk_mul_f32 v[50:51], v[50:51], v[252:253]
  v_pk_mul_f32 v[54:55], v[54:55], v[252:253]
  v_pk_mul_f32 v[58:59], v[58:59], v[252:253]
  v_pk_mul_f32 v[62:63], v[62:63], v[252:253]
  v_cvt_pk_bf16_f32 v216, v34, v38
  v_cvt_pk_bf16_f32 v217, v42, v46
  v_cvt_pk_bf16_f32 v218, v50, v54
  v_cvt_pk_bf16_f32 v219, v58, v62
  v_cvt_pk_bf16_f32 v220, v35, v39
  v_cvt_pk_bf16_f32 v221, v43, v47
  v_cvt_pk_bf16_f32 v222, v51, v55
  v_cvt_pk_bf16_f32 v223, v59, v63
  ds_read_b64_tr_b16 v[8:9], v235 offset:2048
  ds_read_b64_tr_b16 v[10:11], v235 offset:2112
  ds_read_b64_tr_b16 v[12:13], v235 offset:3072
  ds_read_b64_tr_b16 v[14:15], v235 offset:3136
  ds_write_b128 v232, v[216:219] offset:4608
  ds_write_b128 v232, v[220:223] offset:4864
  s_waitcnt lgkmcnt(10)
  buffer_store_dwordx4 v[0:3], v233, s[16:19], s39 offen nt
  s_waitcnt lgkmcnt(8)
  buffer_store_dwordx4 v[4:7], v233, s[16:19], s39 offen offset:1024 nt
  v_mfma_f32_16x16x32_bf16 v[196:199], a[144:147], a[60:63], v[228:231]
  v_exp_f32_e64 v201, v201
  v_mfma_f32_16x16x32_bf16 v[196:199], a[148:151], a[56:59], v[196:199]
  v_exp_f32_e64 v202, v202
  v_mfma_f32_16x16x32_bf16 v[196:199], a[152:155], a[52:55], v[196:199]
  v_cvt_pk_bf16_f32 v208, v200, v201
  v_cvt_pk_bf16_f32 v209, v202, v203
  v_cvt_pk_bf16_f32 v210, v204, v205
  v_cvt_pk_bf16_f32 v211, v206, v207
  v_mfma_f32_16x16x32_bf16 v[196:199], a[156:159], a[48:51], v[196:199]
  ds_read_b128 a[132:135], v249 offset:64
  ds_read_b64_tr_b16 v[32:33], v235 offset:4096
  v_mfma_f32_16x16x32_bf16 v[64:67], v[208:211], a[160:163], v[64:67]
  ds_read_b64_tr_b16 v[34:35], v235 offset:4160
  ds_read_b64_tr_b16 v[36:37], v235 offset:5120
  v_mfma_f32_16x16x32_bf16 v[68:71], v[208:211], a[164:167], v[68:71]
  ds_read_b128 a[136:139], v249 offset:128
  ds_read_b64_tr_b16 v[38:39], v235 offset:5184
  v_mfma_f32_16x16x32_bf16 v[72:75], v[208:211], a[168:171], v[72:75]
  ds_read_b64_tr_b16 v[40:41], v235 offset:6144
  v_mul_f32_e64 v203, s29, v195
  v_mfma_f32_16x16x32_bf16 v[76:79], v[208:211], a[172:175], v[76:79]
  s_waitcnt lgkmcnt(11)
  buffer_store_dwordx4 v[8:11], v233, s[16:19], s39 offen offset:2048 nt
  ds_read_b128 a[140:143], v249 offset:192
  v_mul_f32 v201, s29, v193
  v_mfma_f32_16x16x32_bf16 v[80:83], v[208:211], a[176:179], v[80:83]
  s_waitcnt lgkmcnt(10)
  buffer_store_dwordx4 v[12:15], v233, s[16:19], s39 offen offset:3072 nt
  ds_read_b64_tr_b16 v[42:43], v235 offset:6208
  v_mul_f32 v200, s29, v192
  v_mfma_f32_16x16x32_bf16 v[84:87], v[208:211], a[180:183], v[84:87]
  ds_read_b128 a[144:147], v249 offset:704
  ds_read_b64_tr_b16 v[44:45], v235 offset:7168
  ds_read_b64_tr_b16 v[46:47], v235 offset:7232
  v_mfma_f32_16x16x32_bf16 v[88:91], v[208:211], a[184:187], v[88:91]
  ds_read_b128 a[148:151], v249 offset:640
  v_mul_f32_e64 v202, s29, v194
  v_mfma_f32_16x16x32_bf16 v[92:95], v[208:211], a[188:191], v[92:95]
  ds_read_b128 a[152:155], v249 offset:576
  ds_read_b128 a[156:159], v249 offset:512
  v_mfma_f32_16x16x32_bf16 v[192:195], a[128:131], a[32:35], v[228:231]
  s_waitcnt lgkmcnt(12)
  buffer_store_dwordx4 v[32:35], v233, s[16:19], s33 offen nt
  v_mul_f32 v204, s29, v196
  v_mul_f32_e64 v207, s29, v199
  v_mfma_f32_16x16x32_bf16 v[192:195], a[132:135], a[36:39], v[192:195]
  s_waitcnt lgkmcnt(9)
  buffer_store_dwordx4 v[36:39], v233, s[16:19], s33 offen offset:1024 nt
  v_exp_f32 v204, v204
  v_mfma_f32_16x16x32_bf16 v[192:195], a[136:139], a[40:43], v[192:195]
  s_waitcnt lgkmcnt(6)
  buffer_store_dwordx4 v[40:43], v233, s[16:19], s33 offen offset:2048 nt
  v_exp_f32 v202, v202
  v_mfma_f32_16x16x32_bf16 v[192:195], a[140:143], a[44:47], v[192:195]
  s_waitcnt lgkmcnt(3)
  buffer_store_dwordx4 v[44:47], v233, s[16:19], s33 offen offset:3072 nt
  v_mul_f32 v205, s29, v197
  v_mul_f32_e64 v206, s29, v198
  v_mfma_f32_16x16x32_bf16 v[196:199], a[144:147], a[44:47], v[228:231]
  s_waitcnt lgkmcnt(2)
  v_exp_f32 v203, v203
  v_mfma_f32_16x16x32_bf16 v[196:199], a[148:151], a[40:43], v[196:199]
  s_waitcnt lgkmcnt(1)
  v_exp_f32 v200, v200
  v_exp_f32 v201, v201
  v_exp_f32 v205, v205
  v_exp_f32 v206, v206
  v_exp_f32 v207, v207
  v_mfma_f32_16x16x32_bf16 v[196:199], a[152:155], a[36:39], v[196:199]
  s_waitcnt lgkmcnt(0)
  v_cvt_pk_bf16_f32 v212, v200, v201
  v_cvt_pk_bf16_f32 v213, v202, v203
  v_cvt_pk_bf16_f32 v214, v204, v205
  v_cvt_pk_bf16_f32 v215, v206, v207
  v_mfma_f32_16x16x32_bf16 v[196:199], a[156:159], a[32:35], v[196:199]
  v_mul_f32 v200, s29, v192
  v_mul_f32_e64 v203, s29, v195
  v_mfma_f32_16x16x32_bf16 v[96:99], v[212:215], a[160:163], v[96:99]
  v_mul_f32 v201, s29, v193
  v_mul_f32 v202, s29, v194
  v_mfma_f32_16x16x32_bf16 v[100:103], v[212:215], a[164:167], v[100:103]
  ds_read_b64_tr_b16 a[160:161], v255 offset:8448
  ds_read_b64_tr_b16 a[166:167], v255 offset:8976
  v_mfma_f32_16x16x32_bf16 v[104:107], v[212:215], a[168:171], v[104:107]
  ds_read_b64_tr_b16 a[168:169], v255 offset:8480
  v_mul_f32_e64 v205, s29, v197
  v_mfma_f32_16x16x32_bf16 v[108:111], v[212:215], a[172:175], v[108:111]
  ds_read_b64_tr_b16 a[162:163], v255 offset:8960
  ds_read_b64_tr_b16 a[174:175], v255 offset:9008
  v_mfma_f32_16x16x32_bf16 v[112:115], v[212:215], a[176:179], v[112:115]
  ds_read_b64_tr_b16 a[164:165], v255 offset:8464
  ds_read_b64_tr_b16 a[170:171], v255 offset:8992
  v_mfma_f32_16x16x32_bf16 v[116:119], v[212:215], a[180:183], v[116:119]
  ds_read_b64_tr_b16 a[172:173], v255 offset:8496
  v_mul_f32_e64 v206, s29, v198
  v_mfma_f32_16x16x32_bf16 v[120:123], v[212:215], a[184:187], v[120:123]
  ds_read_b64_tr_b16 a[182:183], v255 offset:9040
  v_mul_f32_e64 v204, s29, v196
  v_mfma_f32_16x16x32_bf16 v[124:127], v[212:215], a[188:191], v[124:127]
  ds_read_b64_tr_b16 a[178:179], v255 offset:9024
  v_mul_f32_e64 v207, s29, v199
  v_smfmac_f32_16x16x64_bf16 a[196:199], a[220:223], v[208:215], v254
  ds_read_b64_tr_b16 a[176:177], v255 offset:8512
  ds_read_b64_tr_b16 a[180:181], v255 offset:8528
  v_mfma_f32_16x16x32_bf16 v[192:195], a[128:131], a[48:51], v[228:231]
  v_exp_f32_e64 v206, v206
  v_mfma_f32_16x16x32_bf16 v[192:195], a[132:135], a[52:55], v[192:195]
  v_exp_f32_e64 v204, v204
  v_mfma_f32_16x16x32_bf16 v[192:195], a[136:139], a[56:59], v[192:195]
  v_exp_f32_e64 v203, v203
  v_mfma_f32_16x16x32_bf16 v[192:195], a[140:143], a[60:63], v[192:195]
  v_exp_f32_e64 v202, v202
  v_mfma_f32_16x16x32_bf16 v[196:199], a[144:147], a[60:63], v[228:231]
  v_exp_f32_e64 v205, v205
  v_mfma_f32_16x16x32_bf16 v[196:199], a[148:151], a[56:59], v[196:199]
  v_exp_f32 v200, v200
  v_exp_f32 v201, v201
  v_exp_f32_e64 v207, v207
  v_mfma_f32_16x16x32_bf16 v[196:199], a[152:155], a[52:55], v[196:199]
  s_waitcnt lgkmcnt(8)
  v_cvt_pk_bf16_f32 v208, v200, v201
  v_cvt_pk_bf16_f32 v209, v202, v203
  v_cvt_pk_bf16_f32 v210, v204, v205
  v_cvt_pk_bf16_f32 v211, v206, v207
  v_mfma_f32_16x16x32_bf16 v[196:199], a[156:159], a[48:51], v[196:199]
  ds_read_b64_tr_b16 a[184:185], v255 offset:8544
  ds_read_b64_tr_b16 a[186:187], v255 offset:9056
  v_mfma_f32_16x16x32_bf16 v[64:67], v[208:211], a[160:163], v[64:67]
  ds_read_b64_tr_b16 a[188:189], v255 offset:8560
  ds_read_b64_tr_b16 a[190:191], v255 offset:9072
  s_waitcnt lgkmcnt(10)
  v_mfma_f32_16x16x32_bf16 v[68:71], v[208:211], a[164:167], v[68:71]
  s_waitcnt lgkmcnt(9)
  v_mul_f32 v201, s29, v193
  v_mul_f32_e64 v202, s29, v194
  v_mfma_f32_16x16x32_bf16 v[72:75], v[208:211], a[168:171], v[72:75]
  s_waitcnt lgkmcnt(8)
  v_mul_f32 v200, s29, v192
  v_mul_f32_e64 v203, s29, v195
  v_mfma_f32_16x16x32_bf16 v[76:79], v[208:211], a[172:175], v[76:79]
  s_waitcnt lgkmcnt(5)
  v_mul_f32 v204, s29, v196
  v_mul_f32_e64 v205, s29, v197
  v_mfma_f32_16x16x32_bf16 v[80:83], v[208:211], a[176:179], v[80:83]
  s_waitcnt lgkmcnt(4)
  v_exp_f32 v202, v202
  v_mfma_f32_16x16x32_bf16 v[84:87], v[208:211], a[180:183], v[84:87]
  s_waitcnt lgkmcnt(2)
  v_mul_f32 v206, s29, v198
  v_mul_f32_e64 v207, s29, v199
  v_mfma_f32_16x16x32_bf16 v[88:91], v[208:211], a[184:187], v[88:91]
  s_waitcnt lgkmcnt(0)
  v_exp_f32 v205, v205
  v_mfma_f32_16x16x32_bf16 v[92:95], v[208:211], a[188:191], v[92:95]
  v_exp_f32_e64 v206, v206
  v_mfma_f32_16x16x32_bf16 v[192:195], a[128:131], a[96:99], v[228:231]
  v_exp_f32_e64 v201, v201
  v_mfma_f32_16x16x32_bf16 v[192:195], a[132:135], a[100:103], v[192:195]
  v_exp_f32_e64 v204, v204
  v_mfma_f32_16x16x32_bf16 v[192:195], a[136:139], a[104:107], v[192:195]
  v_exp_f32_e64 v203, v203
  v_mfma_f32_16x16x32_bf16 v[192:195], a[140:143], a[108:111], v[192:195]
  v_exp_f32_e64 v207, v207
  v_mfma_f32_16x16x32_bf16 v[196:199], a[144:147], a[108:111], v[228:231]
  v_cvt_pk_bf16_f32 v213, v202, v203
  v_cvt_pk_bf16_f32 v215, v206, v207
  v_mfma_f32_16x16x32_bf16 v[196:199], a[148:151], a[104:107], v[196:199]
  v_exp_f32_e64 v200, v200
  v_mfma_f32_16x16x32_bf16 v[196:199], a[152:155], a[100:103], v[196:199]
  v_cvt_pk_bf16_f32 v212, v200, v201
  v_cvt_pk_bf16_f32 v214, v204, v205
  v_mfma_f32_16x16x32_bf16 v[196:199], a[156:159], a[96:99], v[196:199]
  v_mul_f32 v202, s29, v194
  v_mul_f32 v203, s29, v195
  v_smfmac_f32_16x16x64_bf16 a[196:199], a[220:223], v[208:215], v254
  v_mul_f32_e64 v201, s29, v193
  v_mfma_f32_16x16x32_bf16 v[96:99], v[212:215], a[160:163], v[96:99]
  v_exp_f32_e64 v201, v201
  v_mfma_f32_16x16x32_bf16 v[100:103], v[212:215], a[164:167], v[100:103]
  v_mul_f32 v200, s29, v192
  v_mul_f32 v204, s29, v196
  v_mfma_f32_16x16x32_bf16 v[104:107], v[212:215], a[168:171], v[104:107]
  v_accvgpr_read_b32 v244, a196
  v_accvgpr_read_b32 v250, a197
  v_mfma_f32_16x16x32_bf16 v[108:111], v[212:215], a[172:175], v[108:111]
  v_add_f32 v244, v244, v250
  v_mul_f32 v205, s29, v197
  v_mfma_f32_16x16x32_bf16 v[112:115], v[212:215], a[176:179], v[112:115]
  v_rcp_f32_e64 v244, v244
  v_mfma_f32_16x16x32_bf16 v[116:119], v[212:215], a[180:183], v[116:119]
  v_accvgpr_read_b32 v245, a198
  v_accvgpr_read_b32 v251, a199
  v_mfma_f32_16x16x32_bf16 v[120:123], v[212:215], a[184:187], v[120:123]
  v_add_f32 v245, v245, v251
  v_rcp_f32 v245, v245
  v_mfma_f32_16x16x32_bf16 v[124:127], v[212:215], a[188:191], v[124:127]
  v_mul_f32 v206, s29, v198
  v_mul_f32 v207, s29, v199
  v_mfma_f32_16x16x4_f32 v[224:227], v244, a121, 0
  v_exp_f32_e64 v207, v207
  v_mfma_f32_16x16x4_f32 v[250:253], v245, a121, 0
  v_exp_f32_e64 v205, v205
  v_mfma_f32_16x16x32_bf16 v[192:195], a[128:131], a[64:67], v[228:231]
  v_exp_f32_e64 v200, v200
  v_mfma_f32_16x16x32_bf16 v[192:195], a[132:135], a[68:71], v[192:195]
  v_exp_f32_e64 v206, v206
  v_mfma_f32_16x16x32_bf16 v[192:195], a[136:139], a[72:75], v[192:195]
  v_exp_f32_e64 v202, v202
  v_mfma_f32_16x16x32_bf16 v[192:195], a[140:143], a[76:79], v[192:195]
  v_exp_f32_e64 v204, v204
  v_pk_mul_f32 v[64:65], v[64:65], v[224:225]
  v_pk_mul_f32 v[68:69], v[68:69], v[224:225]
  v_pk_mul_f32 v[72:73], v[72:73], v[224:225]
  v_pk_mul_f32 v[76:77], v[76:77], v[224:225]
  v_pk_mul_f32 v[80:81], v[80:81], v[224:225]
  v_pk_mul_f32 v[84:85], v[84:85], v[224:225]
  v_pk_mul_f32 v[88:89], v[88:89], v[224:225]
  v_pk_mul_f32 v[92:93], v[92:93], v[224:225]
  v_cvt_pk_bf16_f32 v216, v64, v68
  v_cvt_pk_bf16_f32 v217, v72, v76
  v_cvt_pk_bf16_f32 v218, v80, v84
  v_cvt_pk_bf16_f32 v219, v88, v92
  v_cvt_pk_bf16_f32 v220, v65, v69
  v_cvt_pk_bf16_f32 v221, v73, v77
  v_cvt_pk_bf16_f32 v222, v81, v85
  v_cvt_pk_bf16_f32 v223, v89, v93
  ds_write_b128 v232, v[216:219] offset:8192
  ds_write_b128 v232, v[220:223] offset:8448
  v_pk_mul_f32 v[66:67], v[66:67], v[226:227]
  v_pk_mul_f32 v[70:71], v[70:71], v[226:227]
  v_pk_mul_f32 v[74:75], v[74:75], v[226:227]
  v_pk_mul_f32 v[78:79], v[78:79], v[226:227]
  v_pk_mul_f32 v[82:83], v[82:83], v[226:227]
  v_pk_mul_f32 v[86:87], v[86:87], v[226:227]
  v_pk_mul_f32 v[90:91], v[90:91], v[226:227]
  v_pk_mul_f32 v[94:95], v[94:95], v[226:227]
  v_cvt_pk_bf16_f32 v216, v66, v70
  v_cvt_pk_bf16_f32 v217, v74, v78
  v_cvt_pk_bf16_f32 v218, v82, v86
  v_cvt_pk_bf16_f32 v219, v90, v94
  v_cvt_pk_bf16_f32 v220, v67, v71
  v_cvt_pk_bf16_f32 v221, v75, v79
  v_cvt_pk_bf16_f32 v222, v83, v87
  v_cvt_pk_bf16_f32 v223, v91, v95
  ds_write_b128 v232, v[216:219] offset:8704
  ds_write_b128 v232, v[220:223] offset:8960
  v_pk_mul_f32 v[96:97], v[96:97], v[250:251]
  v_pk_mul_f32 v[100:101], v[100:101], v[250:251]
  v_pk_mul_f32 v[104:105], v[104:105], v[250:251]
  v_pk_mul_f32 v[108:109], v[108:109], v[250:251]
  v_pk_mul_f32 v[112:113], v[112:113], v[250:251]
  v_pk_mul_f32 v[116:117], v[116:117], v[250:251]
  v_pk_mul_f32 v[120:121], v[120:121], v[250:251]
  v_pk_mul_f32 v[124:125], v[124:125], v[250:251]
  v_cvt_pk_bf16_f32 v216, v96, v100
  v_cvt_pk_bf16_f32 v217, v104, v108
  v_cvt_pk_bf16_f32 v218, v112, v116
  v_cvt_pk_bf16_f32 v219, v120, v124
  v_cvt_pk_bf16_f32 v220, v97, v101
  v_cvt_pk_bf16_f32 v221, v105, v109
  v_cvt_pk_bf16_f32 v222, v113, v117
  v_cvt_pk_bf16_f32 v223, v121, v125
  ds_read_b64_tr_b16 v[64:65], v235 offset:8192
  ds_read_b64_tr_b16 v[66:67], v235 offset:8256
  ds_read_b64_tr_b16 v[68:69], v235 offset:9216
  ds_read_b64_tr_b16 v[70:71], v235 offset:9280
  ds_write_b128 v232, v[216:219] offset:12288
  ds_write_b128 v232, v[220:223] offset:12544
  v_pk_mul_f32 v[98:99], v[98:99], v[252:253]
  v_pk_mul_f32 v[102:103], v[102:103], v[252:253]
  v_pk_mul_f32 v[106:107], v[106:107], v[252:253]
  v_pk_mul_f32 v[110:111], v[110:111], v[252:253]
  v_pk_mul_f32 v[114:115], v[114:115], v[252:253]
  v_pk_mul_f32 v[118:119], v[118:119], v[252:253]
  v_pk_mul_f32 v[122:123], v[122:123], v[252:253]
  v_pk_mul_f32 v[126:127], v[126:127], v[252:253]
  v_cvt_pk_bf16_f32 v216, v98, v102
  v_cvt_pk_bf16_f32 v217, v106, v110
  v_cvt_pk_bf16_f32 v218, v114, v118
  v_cvt_pk_bf16_f32 v219, v122, v126
  v_cvt_pk_bf16_f32 v220, v99, v103
  v_cvt_pk_bf16_f32 v221, v107, v111
  v_cvt_pk_bf16_f32 v222, v115, v119
  v_cvt_pk_bf16_f32 v223, v123, v127
  ds_read_b64_tr_b16 v[72:73], v235 offset:10240
  ds_read_b64_tr_b16 v[74:75], v235 offset:10304
  ds_read_b64_tr_b16 v[76:77], v235 offset:11264
  ds_read_b64_tr_b16 v[78:79], v235 offset:11328
  ds_write_b128 v232, v[216:219] offset:12800
  ds_write_b128 v232, v[220:223] offset:13056
  s_waitcnt lgkmcnt(10)
  buffer_store_dwordx4 v[64:67], v233, s[16:19], s34 offen nt
  s_waitcnt lgkmcnt(8)
  buffer_store_dwordx4 v[68:71], v233, s[16:19], s34 offen offset:1024 nt
  v_mfma_f32_16x16x32_bf16 v[196:199], a[144:147], a[76:79], v[228:231]
  v_cvt_pk_bf16_f32 v210, v204, v205
  v_cvt_pk_bf16_f32 v211, v206, v207
  v_mfma_f32_16x16x32_bf16 v[196:199], a[148:151], a[72:75], v[196:199]
  v_exp_f32_e64 v203, v203
  v_mfma_f32_16x16x32_bf16 v[196:199], a[152:155], a[68:71], v[196:199]
  v_cvt_pk_bf16_f32 v208, v200, v201
  v_cvt_pk_bf16_f32 v209, v202, v203
  v_mfma_f32_16x16x32_bf16 v[196:199], a[156:159], a[64:67], v[196:199]
  ds_read_b64_tr_b16 v[96:97], v235 offset:12288
  ds_read_b64_tr_b16 v[98:99], v235 offset:12352
  v_mfma_f32_16x16x32_bf16 a[204:207], a[220:223], v[208:211], a[204:207]
  ds_read_b64_tr_b16 v[100:101], v235 offset:13312
  ds_read_b64_tr_b16 v[102:103], v235 offset:13376
  v_mfma_f32_16x16x32_bf16 a[224:227], v[208:211], a[160:163], a[224:227]
  ds_read_b64_tr_b16 v[104:105], v235 offset:14336
  ds_read_b64_tr_b16 v[106:107], v235 offset:14400
  v_mfma_f32_16x16x32_bf16 a[228:231], v[208:211], a[164:167], a[228:231]
  ds_read_b64_tr_b16 v[108:109], v235 offset:15360
  v_mul_f32_e64 v203, s29, v195
  v_mfma_f32_16x16x32_bf16 a[232:235], v[208:211], a[168:171], a[232:235]
  ds_read_b64_tr_b16 v[110:111], v235 offset:15424
  v_mul_f32_e64 v201, s29, v193
  v_mfma_f32_16x16x32_bf16 a[236:239], v[208:211], a[172:175], a[236:239]
  s_waitcnt lgkmcnt(12)
  v_mul_f32 v200, s29, v192
  v_mul_f32_e64 v202, s29, v194
  v_mfma_f32_16x16x32_bf16 a[240:243], v[208:211], a[176:179], a[240:243]
  buffer_store_dwordx4 v[72:75], v233, s[16:19], s34 offen offset:2048 nt
  v_mul_f32 v204, s29, v196
  v_mul_f32 v205, s29, v197
  v_mfma_f32_16x16x32_bf16 a[244:247], v[208:211], a[180:183], a[244:247]
  s_waitcnt lgkmcnt(10)
  buffer_store_dwordx4 v[76:79], v233, s[16:19], s34 offen offset:3072 nt
  v_mul_f32 v206, s29, v198
  v_mul_f32_e64 v207, s29, v199
  v_mfma_f32_16x16x32_bf16 a[248:251], v[208:211], a[184:187], a[248:251]
  s_waitcnt lgkmcnt(6)
  buffer_store_dwordx4 v[96:99], v233, s[16:19], s36 offen nt
  v_exp_f32 v207, v207
  v_mfma_f32_16x16x32_bf16 a[252:255], v[208:211], a[188:191], a[252:255]
  s_waitcnt lgkmcnt(4)
  buffer_store_dwordx4 v[100:103], v233, s[16:19], s36 offen offset:1024 nt
  v_exp_f32 v200, v200
  v_mfma_f32_16x16x32_bf16 v[192:195], a[128:131], a[80:83], v[228:231]
  s_waitcnt lgkmcnt(2)
  buffer_store_dwordx4 v[104:107], v233, s[16:19], s36 offen offset:2048 nt
  v_exp_f32 v201, v201
  v_mfma_f32_16x16x32_bf16 v[192:195], a[132:135], a[84:87], v[192:195]
  s_waitcnt lgkmcnt(0)
  buffer_store_dwordx4 v[108:111], v233, s[16:19], s36 offen offset:3072 nt
  ds_read_b128 a[132:135], v249 offset:33856
  v_cvt_pk_bf16_f32 v208, v200, v201
  v_mfma_f32_16x16x32_bf16 v[192:195], a[136:139], a[88:91], v[192:195]
  v_exp_f32 v204, v204
  v_mfma_f32_16x16x32_bf16 v[192:195], a[140:143], a[92:95], v[192:195]
  v_exp_f32_e64 v203, v203
  v_mfma_f32_16x16x32_bf16 v[196:199], a[144:147], a[92:95], v[228:231]
  v_exp_f32_e64 v206, v206
  v_mfma_f32_16x16x32_bf16 v[196:199], a[148:151], a[88:91], v[196:199]
  v_exp_f32 v202, v202
  v_exp_f32 v205, v205
  v_mfma_f32_16x16x32_bf16 v[196:199], a[152:155], a[84:87], v[196:199]
  v_cvt_pk_bf16_f32 v209, v202, v203
  v_cvt_pk_bf16_f32 v210, v204, v205
  v_cvt_pk_bf16_f32 v211, v206, v207
  v_mfma_f32_16x16x32_bf16 v[196:199], a[156:159], a[80:83], v[196:199]
  ds_read_b128 a[128:131], v249 offset:33792
  ds_read_b128 a[140:143], v249 offset:33984
  v_mfma_f32_16x16x32_bf16 v[128:131], v[208:211], a[160:163], v[128:131]
  ds_read_b128 a[144:147], v249 offset:34496
  ds_read_b128 a[148:151], v249 offset:34432
  v_mfma_f32_16x16x32_bf16 v[132:135], v[208:211], a[164:167], v[132:135]
  ds_read_b128 a[136:139], v249 offset:33920
  v_mul_f32_e64 v202, s29, v194
  v_mfma_f32_16x16x32_bf16 v[136:139], v[208:211], a[168:171], v[136:139]
  ds_read_b128 a[152:155], v249 offset:34368
  v_mul_f32_e64 v203, s29, v195
  v_mfma_f32_16x16x32_bf16 v[140:143], v[208:211], a[172:175], v[140:143]
  v_mul_f32 v200, s29, v192
  v_mul_f32 v201, s29, v193
  v_mfma_f32_16x16x32_bf16 v[144:147], v[208:211], a[176:179], v[144:147]
  ds_read_b128 a[156:159], v249 offset:34304
  v_mul_f32_e64 v204, s29, v196
  v_mfma_f32_16x16x32_bf16 v[148:151], v[208:211], a[180:183], v[148:151]
  v_exp_f32_e64 v203, v203
  v_mfma_f32_16x16x32_bf16 v[152:155], v[208:211], a[184:187], v[152:155]
  v_mul_f32 v205, s29, v197
  v_mul_f32 v207, s29, v199
  v_mfma_f32_16x16x32_bf16 v[156:159], v[208:211], a[188:191], v[156:159]
  s_waitcnt lgkmcnt(6)
  v_exp_f32 v207, v207
  v_mfma_f32_16x16x32_bf16 v[192:195], a[128:131], a[96:99], v[228:231]
  v_exp_f32_e64 v202, v202
  v_mfma_f32_16x16x32_bf16 v[192:195], a[132:135], a[100:103], v[192:195]
  s_waitcnt lgkmcnt(2)
  v_mul_f32 v206, s29, v198
  v_cvt_pk_bf16_f32 v213, v202, v203
  v_mfma_f32_16x16x32_bf16 v[192:195], a[136:139], a[104:107], v[192:195]
  v_exp_f32_e64 v205, v205
  v_mfma_f32_16x16x32_bf16 v[192:195], a[140:143], a[108:111], v[192:195]
  v_exp_f32_e64 v206, v206
  v_mfma_f32_16x16x32_bf16 v[196:199], a[144:147], a[108:111], v[228:231]
  v_exp_f32_e64 v201, v201
  v_mfma_f32_16x16x32_bf16 v[196:199], a[148:151], a[104:107], v[196:199]
  s_waitcnt lgkmcnt(1)
  v_exp_f32 v200, v200
  v_exp_f32_e64 v204, v204
  v_mfma_f32_16x16x32_bf16 v[196:199], a[152:155], a[100:103], v[196:199]
  s_waitcnt lgkmcnt(0)
  v_cvt_pk_bf16_f32 v212, v200, v201
  v_cvt_pk_bf16_f32 v214, v204, v205
  v_cvt_pk_bf16_f32 v215, v206, v207
  v_mfma_f32_16x16x32_bf16 v[196:199], a[156:159], a[96:99], v[196:199]
  v_mul_f32 v201, s29, v193
  v_mul_f32_e64 v203, s29, v195
  v_mfma_f32_16x16x32_bf16 v[160:163], v[212:215], a[160:163], v[160:163]
  v_mul_f32 v200, s29, v192
  v_mul_f32 v202, s29, v194
  v_mfma_f32_16x16x32_bf16 v[164:167], v[212:215], a[164:167], v[164:167]
  ds_read_b64_tr_b16 a[160:161], v255 offset:42240
  ds_read_b64_tr_b16 a[166:167], v255 offset:42768
  v_mfma_f32_16x16x32_bf16 v[168:171], v[212:215], a[168:171], v[168:171]
  ds_read_b64_tr_b16 a[164:165], v255 offset:42256
  v_mul_f32_e64 v204, s29, v196
  v_mfma_f32_16x16x32_bf16 v[172:175], v[212:215], a[172:175], v[172:175]
  ds_read_b64_tr_b16 a[162:163], v255 offset:42752
  v_mul_f32_e64 v205, s29, v197
  v_mfma_f32_16x16x32_bf16 v[176:179], v[212:215], a[176:179], v[176:179]
  v_exp_f32_e64 v201, v201
  v_mfma_f32_16x16x32_bf16 v[180:183], v[212:215], a[180:183], v[180:183]
  v_exp_f32_e64 v202, v202
  v_mfma_f32_16x16x32_bf16 v[184:187], v[212:215], a[184:187], v[184:187]
  v_exp_f32_e64 v204, v204
  v_mfma_f32_16x16x32_bf16 v[188:191], v[212:215], a[188:191], v[188:191]
  v_exp_f32_e64 v200, v200
  v_smfmac_f32_16x16x64_bf16 a[200:203], a[220:223], v[208:215], v254
  ds_read_b64_tr_b16 a[170:171], v255 offset:42784
  v_mul_f32_e64 v207, s29, v199
  v_mfma_f32_16x16x32_bf16 v[192:195], a[128:131], a[64:67], v[228:231]
  v_exp_f32_e64 v207, v207
  v_mfma_f32_16x16x32_bf16 v[192:195], a[132:135], a[68:71], v[192:195]
  ds_read_b64_tr_b16 a[176:177], v255 offset:42304
  v_mul_f32_e64 v206, s29, v198
  v_mfma_f32_16x16x32_bf16 v[192:195], a[136:139], a[72:75], v[192:195]
  v_exp_f32_e64 v205, v205
  v_mfma_f32_16x16x32_bf16 v[192:195], a[140:143], a[76:79], v[192:195]
  ds_read_b64_tr_b16 a[174:175], v255 offset:42800
  v_cvt_pk_bf16_f32 v210, v204, v205
  v_mfma_f32_16x16x32_bf16 v[196:199], a[144:147], a[76:79], v[228:231]
  ds_read_b64_tr_b16 a[168:169], v255 offset:42272
  ds_read_b64_tr_b16 a[178:179], v255 offset:42816
  v_mfma_f32_16x16x32_bf16 v[196:199], a[148:151], a[72:75], v[196:199]
  ds_read_b64_tr_b16 a[172:173], v255 offset:42288
  v_exp_f32 v203, v203
  v_exp_f32 v206, v206
  v_mfma_f32_16x16x32_bf16 v[196:199], a[152:155], a[68:71], v[196:199]
  s_waitcnt lgkmcnt(6)
  v_cvt_pk_bf16_f32 v208, v200, v201
  v_cvt_pk_bf16_f32 v209, v202, v203
  v_cvt_pk_bf16_f32 v211, v206, v207
  v_mfma_f32_16x16x32_bf16 v[196:199], a[156:159], a[64:67], v[196:199]
  ds_read_b64_tr_b16 a[180:181], v255 offset:42320
  ds_read_b64_tr_b16 a[182:183], v255 offset:42832
  v_mfma_f32_16x16x32_bf16 a[204:207], a[220:223], v[208:211], a[204:207]
  ds_read_b64_tr_b16 a[184:185], v255 offset:42336
  ds_read_b64_tr_b16 a[186:187], v255 offset:42848
  v_mfma_f32_16x16x32_bf16 a[224:227], v[208:211], a[160:163], a[224:227]
  ds_read_b64_tr_b16 a[188:189], v255 offset:42352
  ds_read_b64_tr_b16 a[190:191], v255 offset:42864
  v_mfma_f32_16x16x32_bf16 a[228:231], v[208:211], a[164:167], a[228:231]
  s_waitcnt lgkmcnt(8)
  v_mul_f32 v201, s29, v193
  v_mul_f32 v203, s29, v195
  v_mfma_f32_16x16x32_bf16 a[232:235], v[208:211], a[168:171], a[232:235]
  s_waitcnt lgkmcnt(6)
  v_accvgpr_read_b32 v248, a204
  v_accvgpr_read_b32 v250, a206
  v_mfma_f32_16x16x32_bf16 a[236:239], v[208:211], a[172:175], a[236:239]
  v_add_f32 v248, v248, v250
  v_mul_f32_e64 v200, s29, v192
  v_mfma_f32_16x16x32_bf16 a[240:243], v[208:211], a[176:179], a[240:243]
  s_waitcnt lgkmcnt(4)
  v_rcp_f32 v248, v248
  v_mfma_f32_16x16x32_bf16 a[244:247], v[208:211], a[180:183], a[244:247]
  s_waitcnt lgkmcnt(2)
  v_mul_f32 v202, s29, v194
  v_mul_f32_e64 v206, s29, v198
  v_mfma_f32_16x16x32_bf16 a[248:251], v[208:211], a[184:187], a[248:251]
  s_waitcnt lgkmcnt(0)
  v_mul_f32 v204, s29, v196
  v_mul_f32_e64 v205, s29, v197
  v_mfma_f32_16x16x32_bf16 a[252:255], v[208:211], a[188:191], a[252:255]
  v_exp_f32_e64 v204, v204
  v_mfma_f32_16x16x4_f32 v[224:227], v248, a121, 0
  v_exp_f32_e64 v203, v203
  v_mfma_f32_16x16x32_bf16 v[192:195], a[128:131], a[80:83], v[228:231]
  v_exp_f32_e64 v206, v206
  v_mfma_f32_16x16x32_bf16 v[192:195], a[132:135], a[84:87], v[192:195]
  v_exp_f32_e64 v205, v205
  v_mfma_f32_16x16x32_bf16 v[192:195], a[136:139], a[88:91], v[192:195]
  v_mul_f32_e64 v207, s29, v199
  v_cvt_pk_bf16_f32 v210, v204, v205
  v_mfma_f32_16x16x32_bf16 v[192:195], a[140:143], a[92:95], v[192:195]
  v_exp_f32_e64 v207, v207
  v_accvgpr_read_b32 v32, a224
  v_accvgpr_read_b32 v33, a225
  v_accvgpr_read_b32 v34, a228
  v_accvgpr_read_b32 v35, a229
  v_accvgpr_read_b32 v36, a232
  v_accvgpr_read_b32 v37, a233
  v_accvgpr_read_b32 v38, a236
  v_accvgpr_read_b32 v39, a237
  v_accvgpr_read_b32 v40, a240
  v_accvgpr_read_b32 v41, a241
  v_accvgpr_read_b32 v42, a244
  v_accvgpr_read_b32 v43, a245
  v_accvgpr_read_b32 v44, a248
  v_accvgpr_read_b32 v45, a249
  v_accvgpr_read_b32 v46, a252
  v_accvgpr_read_b32 v47, a253
  v_pk_mul_f32 v[32:33], v[32:33], v[224:225]
  v_pk_mul_f32 v[34:35], v[34:35], v[224:225]
  v_pk_mul_f32 v[36:37], v[36:37], v[224:225]
  v_pk_mul_f32 v[38:39], v[38:39], v[224:225]
  v_pk_mul_f32 v[40:41], v[40:41], v[224:225]
  v_pk_mul_f32 v[42:43], v[42:43], v[224:225]
  v_pk_mul_f32 v[44:45], v[44:45], v[224:225]
  v_pk_mul_f32 v[46:47], v[46:47], v[224:225]
  v_cvt_pk_bf16_f32 v216, v32, v34
  v_cvt_pk_bf16_f32 v217, v36, v38
  v_cvt_pk_bf16_f32 v218, v40, v42
  v_cvt_pk_bf16_f32 v219, v44, v46
  v_cvt_pk_bf16_f32 v220, v33, v35
  v_cvt_pk_bf16_f32 v221, v37, v39
  v_cvt_pk_bf16_f32 v222, v41, v43
  v_cvt_pk_bf16_f32 v223, v45, v47
  ds_write_b128 v232, v[216:219] offset:0
  ds_write_b128 v232, v[220:223] offset:256
  v_accvgpr_read_b32 v48, a226
  v_accvgpr_read_b32 v49, a227
  v_accvgpr_read_b32 v50, a230
  v_accvgpr_read_b32 v51, a231
  v_accvgpr_read_b32 v52, a234
  v_accvgpr_read_b32 v53, a235
  v_accvgpr_read_b32 v54, a238
  v_accvgpr_read_b32 v55, a239
  v_accvgpr_read_b32 v56, a242
  v_accvgpr_read_b32 v57, a243
  v_accvgpr_read_b32 v58, a246
  v_accvgpr_read_b32 v59, a247
  v_accvgpr_read_b32 v60, a250
  v_accvgpr_read_b32 v61, a251
  v_accvgpr_read_b32 v62, a254
  v_accvgpr_read_b32 v63, a255
  v_pk_mul_f32 v[48:49], v[48:49], v[226:227]
  v_pk_mul_f32 v[50:51], v[50:51], v[226:227]
  v_pk_mul_f32 v[52:53], v[52:53], v[226:227]
  v_pk_mul_f32 v[54:55], v[54:55], v[226:227]
  v_pk_mul_f32 v[56:57], v[56:57], v[226:227]
  v_pk_mul_f32 v[58:59], v[58:59], v[226:227]
  v_pk_mul_f32 v[60:61], v[60:61], v[226:227]
  v_pk_mul_f32 v[62:63], v[62:63], v[226:227]
  v_cvt_pk_bf16_f32 v216, v48, v50
  v_cvt_pk_bf16_f32 v217, v52, v54
  v_cvt_pk_bf16_f32 v218, v56, v58
  v_cvt_pk_bf16_f32 v219, v60, v62
  v_cvt_pk_bf16_f32 v220, v49, v51
  v_cvt_pk_bf16_f32 v221, v53, v55
  v_cvt_pk_bf16_f32 v222, v57, v59
  v_cvt_pk_bf16_f32 v223, v61, v63
  ds_write_b128 v232, v[216:219] offset:512
  ds_write_b128 v232, v[220:223] offset:768
  v_mfma_f32_16x16x32_bf16 v[196:199], a[144:147], a[92:95], v[228:231]
  v_exp_f32_e64 v202, v202
  v_mfma_f32_16x16x32_bf16 v[196:199], a[148:151], a[88:91], v[196:199]
  v_exp_f32 v200, v200
  v_exp_f32 v201, v201
  v_mfma_f32_16x16x32_bf16 v[196:199], a[152:155], a[84:87], v[196:199]
  v_cvt_pk_bf16_f32 v208, v200, v201
  v_cvt_pk_bf16_f32 v209, v202, v203
  v_cvt_pk_bf16_f32 v211, v206, v207
  v_mfma_f32_16x16x32_bf16 v[196:199], a[156:159], a[80:83], v[196:199]
  ds_read_b64_tr_b16 v[32:33], v235 offset:0
  ds_read_b64_tr_b16 v[34:35], v235 offset:64
  v_mfma_f32_16x16x32_bf16 v[128:131], v[208:211], a[160:163], v[128:131]
  ds_read_b64_tr_b16 v[36:37], v235 offset:1024
  v_mul_f32_e64 v202, s29, v194
  v_mfma_f32_16x16x32_bf16 v[132:135], v[208:211], a[164:167], v[132:135]
  ds_read_b64_tr_b16 v[38:39], v235 offset:1088
  v_mul_f32_e64 v201, s29, v193
  v_mfma_f32_16x16x32_bf16 v[136:139], v[208:211], a[168:171], v[136:139]
  v_mul_f32 v204, s29, v196
  v_mul_f32 v206, s29, v198
  v_mfma_f32_16x16x32_bf16 v[140:143], v[208:211], a[172:175], v[140:143]
  v_exp_f32_e64 v201, v201
  v_mfma_f32_16x16x32_bf16 v[144:147], v[208:211], a[176:179], v[144:147]
  v_mul_f32 v200, s29, v192
  v_mul_f32 v203, s29, v195
  v_mul_f32 v205, s29, v197
  v_mul_f32 v207, s29, v199
  v_mfma_f32_16x16x32_bf16 v[148:151], v[208:211], a[180:183], v[148:151]
  ds_read_b64_tr_b16 v[40:41], v235 offset:2048
  ds_read_b64_tr_b16 v[42:43], v235 offset:2112
  ds_read_b64_tr_b16 v[44:45], v235 offset:3072
  ds_read_b64_tr_b16 v[46:47], v235 offset:3136
  v_exp_f32 v200, v200
  v_exp_f32 v202, v202
  v_exp_f32 v203, v203
  v_exp_f32 v204, v204
  v_exp_f32 v205, v205
  v_exp_f32 v206, v206
  v_exp_f32_e64 v207, v207
  v_mfma_f32_16x16x32_bf16 v[152:155], v[208:211], a[184:187], v[152:155]
  s_waitcnt lgkmcnt(6)
  v_cvt_pk_bf16_f32 v212, v200, v201
  v_cvt_pk_bf16_f32 v213, v202, v203
  v_cvt_pk_bf16_f32 v214, v204, v205
  v_cvt_pk_bf16_f32 v215, v206, v207
  v_mfma_f32_16x16x32_bf16 v[156:159], v[208:211], a[188:191], v[156:159]
  buffer_store_dwordx4 v[32:35], v233, s[16:19], s40 offen nt
  v_smfmac_f32_16x16x64_bf16 a[200:203], a[220:223], v[208:215], v254
  s_waitcnt lgkmcnt(4)
  buffer_store_dwordx4 v[36:39], v233, s[16:19], s40 offen offset:1024 nt
  v_mfma_f32_16x16x32_bf16 v[160:163], v[212:215], a[160:163], v[160:163]
  v_mfma_f32_16x16x32_bf16 v[164:167], v[212:215], a[164:167], v[164:167]
  s_waitcnt lgkmcnt(2)
  buffer_store_dwordx4 v[40:43], v233, s[16:19], s40 offen offset:2048 nt
  v_mfma_f32_16x16x32_bf16 v[168:171], v[212:215], a[168:171], v[168:171]
  s_waitcnt lgkmcnt(0)
  buffer_store_dwordx4 v[44:47], v233, s[16:19], s40 offen offset:3072 nt
  v_accvgpr_read_b32 v246, a200
  v_accvgpr_read_b32 v250, a201
  v_mfma_f32_16x16x32_bf16 v[172:175], v[212:215], a[172:175], v[172:175]
  v_add_f32_e64 v246, v246, v250
  v_mfma_f32_16x16x32_bf16 v[176:179], v[212:215], a[176:179], v[176:179]
  v_rcp_f32_e64 v246, v246
  v_mfma_f32_16x16x32_bf16 v[180:183], v[212:215], a[180:183], v[180:183]
  v_accvgpr_read_b32 v247, a202
  v_accvgpr_read_b32 v251, a203
  v_mfma_f32_16x16x32_bf16 v[184:187], v[212:215], a[184:187], v[184:187]
  v_add_f32 v247, v247, v251
  v_rcp_f32 v247, v247
  v_mfma_f32_16x16x32_bf16 v[188:191], v[212:215], a[188:191], v[188:191]
  v_mfma_f32_16x16x4_f32 v[224:227], v246, a121, 0
  v_mfma_f32_16x16x4_f32 v[250:253], v247, a121, 0
  s_nop 8
  v_pk_mul_f32 v[128:129], v[128:129], v[224:225]
  v_pk_mul_f32 v[132:133], v[132:133], v[224:225]
  v_pk_mul_f32 v[136:137], v[136:137], v[224:225]
  v_pk_mul_f32 v[140:141], v[140:141], v[224:225]
  v_pk_mul_f32 v[144:145], v[144:145], v[224:225]
  v_pk_mul_f32 v[148:149], v[148:149], v[224:225]
  v_pk_mul_f32 v[152:153], v[152:153], v[224:225]
  v_pk_mul_f32 v[156:157], v[156:157], v[224:225]
  v_cvt_pk_bf16_f32 v216, v128, v132
  v_cvt_pk_bf16_f32 v217, v136, v140
  v_cvt_pk_bf16_f32 v218, v144, v148
  v_cvt_pk_bf16_f32 v219, v152, v156
  v_cvt_pk_bf16_f32 v220, v129, v133
  v_cvt_pk_bf16_f32 v221, v137, v141
  v_cvt_pk_bf16_f32 v222, v145, v149
  v_cvt_pk_bf16_f32 v223, v153, v157
  ds_write_b128 v232, v[216:219] offset:16384
  ds_write_b128 v232, v[220:223] offset:16640
  v_pk_mul_f32 v[130:131], v[130:131], v[226:227]
  v_pk_mul_f32 v[134:135], v[134:135], v[226:227]
  v_pk_mul_f32 v[138:139], v[138:139], v[226:227]
  v_pk_mul_f32 v[142:143], v[142:143], v[226:227]
  v_pk_mul_f32 v[146:147], v[146:147], v[226:227]
  v_pk_mul_f32 v[150:151], v[150:151], v[226:227]
  v_pk_mul_f32 v[154:155], v[154:155], v[226:227]
  v_pk_mul_f32 v[158:159], v[158:159], v[226:227]
  v_cvt_pk_bf16_f32 v216, v130, v134
  v_cvt_pk_bf16_f32 v217, v138, v142
  v_cvt_pk_bf16_f32 v218, v146, v150
  v_cvt_pk_bf16_f32 v219, v154, v158
  v_cvt_pk_bf16_f32 v220, v131, v135
  v_cvt_pk_bf16_f32 v221, v139, v143
  v_cvt_pk_bf16_f32 v222, v147, v151
  v_cvt_pk_bf16_f32 v223, v155, v159
  ds_write_b128 v232, v[216:219] offset:16896
  ds_write_b128 v232, v[220:223] offset:17152
  v_pk_mul_f32 v[160:161], v[160:161], v[250:251]
  v_pk_mul_f32 v[164:165], v[164:165], v[250:251]
  v_pk_mul_f32 v[168:169], v[168:169], v[250:251]
  v_pk_mul_f32 v[172:173], v[172:173], v[250:251]
  v_pk_mul_f32 v[176:177], v[176:177], v[250:251]
  v_pk_mul_f32 v[180:181], v[180:181], v[250:251]
  v_pk_mul_f32 v[184:185], v[184:185], v[250:251]
  v_pk_mul_f32 v[188:189], v[188:189], v[250:251]
  v_cvt_pk_bf16_f32 v216, v160, v164
  v_cvt_pk_bf16_f32 v217, v168, v172
  v_cvt_pk_bf16_f32 v218, v176, v180
  v_cvt_pk_bf16_f32 v219, v184, v188
  v_cvt_pk_bf16_f32 v220, v161, v165
  v_cvt_pk_bf16_f32 v221, v169, v173
  v_cvt_pk_bf16_f32 v222, v177, v181
  v_cvt_pk_bf16_f32 v223, v185, v189
  ds_read_b64_tr_b16 v[128:129], v235 offset:16384
  ds_read_b64_tr_b16 v[130:131], v235 offset:16448
  ds_read_b64_tr_b16 v[132:133], v235 offset:17408
  ds_read_b64_tr_b16 v[134:135], v235 offset:17472
  ds_write_b128 v232, v[216:219] offset:20480
  ds_write_b128 v232, v[220:223] offset:20736
  v_pk_mul_f32 v[162:163], v[162:163], v[252:253]
  v_pk_mul_f32 v[166:167], v[166:167], v[252:253]
  v_pk_mul_f32 v[170:171], v[170:171], v[252:253]
  v_pk_mul_f32 v[174:175], v[174:175], v[252:253]
  v_pk_mul_f32 v[178:179], v[178:179], v[252:253]
  v_pk_mul_f32 v[182:183], v[182:183], v[252:253]
  v_pk_mul_f32 v[186:187], v[186:187], v[252:253]
  v_pk_mul_f32 v[190:191], v[190:191], v[252:253]
  v_cvt_pk_bf16_f32 v216, v162, v166
  v_cvt_pk_bf16_f32 v217, v170, v174
  v_cvt_pk_bf16_f32 v218, v178, v182
  v_cvt_pk_bf16_f32 v219, v186, v190
  v_cvt_pk_bf16_f32 v220, v163, v167
  v_cvt_pk_bf16_f32 v221, v171, v175
  v_cvt_pk_bf16_f32 v222, v179, v183
  v_cvt_pk_bf16_f32 v223, v187, v191
  ds_read_b64_tr_b16 v[136:137], v235 offset:18432
  ds_read_b64_tr_b16 v[138:139], v235 offset:18496
  ds_read_b64_tr_b16 v[140:141], v235 offset:19456
  ds_read_b64_tr_b16 v[142:143], v235 offset:19520
  ds_write_b128 v232, v[216:219] offset:20992
  ds_write_b128 v232, v[220:223] offset:21248
  s_waitcnt lgkmcnt(10)
  buffer_store_dwordx4 v[128:131], v233, s[16:19], s30 offen nt
  s_waitcnt lgkmcnt(8)
  buffer_store_dwordx4 v[132:135], v233, s[16:19], s30 offen offset:1024 nt
  ds_read_b64_tr_b16 v[160:161], v235 offset:20480
  ds_read_b64_tr_b16 v[162:163], v235 offset:20544
  ds_read_b64_tr_b16 v[164:165], v235 offset:21504
  ds_read_b64_tr_b16 v[166:167], v235 offset:21568
  s_waitcnt lgkmcnt(8)
  buffer_store_dwordx4 v[136:139], v233, s[16:19], s30 offen offset:2048 nt
  s_waitcnt lgkmcnt(6)
  buffer_store_dwordx4 v[140:143], v233, s[16:19], s30 offen offset:3072 nt
  ds_read_b64_tr_b16 v[168:169], v235 offset:22528
  ds_read_b64_tr_b16 v[170:171], v235 offset:22592
  ds_read_b64_tr_b16 v[172:173], v235 offset:23552
  ds_read_b64_tr_b16 v[174:175], v235 offset:23616
  s_waitcnt lgkmcnt(6)
  buffer_store_dwordx4 v[160:163], v233, s[16:19], s31 offen nt
  s_waitcnt lgkmcnt(4)
  buffer_store_dwordx4 v[164:167], v233, s[16:19], s31 offen offset:1024 nt
  s_waitcnt lgkmcnt(2)
  buffer_store_dwordx4 v[168:171], v233, s[16:19], s31 offen offset:2048 nt
  s_waitcnt lgkmcnt(0)
  buffer_store_dwordx4 v[172:175], v233, s[16:19], s31 offen offset:3072 nt
  v_max3_u32 v250, v242, v243, v244
  v_min3_u32 v251, v242, v243, v244
  v_max3_u32 v250, v250, v245, v246
  v_min3_u32 v251, v251, v245, v246
  v_max_u32 v250, v250, v247
  v_min_u32 v251, v251, v247
  v_cmp_lt_u32 s[20:21], s54, v250
  v_cmp_gt_u32 s[22:23], s53, v251
  v_cmp_lt_u32 s[24:25], s54, v248
  v_cmp_gt_u32 s[26:27], s53, v248
  s_nop 2
  s_or_b64 s[20:21], s[20:21], s[22:23]
  s_addc_u32 s48, s48, s48
  s_or_b64 s[24:25], s[24:25], s[26:27]
  s_addc_u32 s48, s48, s48
L_fin:
  s_cmp_eq_u32 s48, 0
  s_cbranch_scc1 L_end
L_slow:
  s_waitcnt vmcnt(0) lgkmcnt(0)
  s_mov_b32 s14, 111149056
  s_sub_u32 s50, 7, s56
  s_mul_i32 s50, s50, s28
  s_mul_i32 s51, s56, 28
  s_add_u32 s50, s50, s51
  s_lshl_b32 s50, s50, 12
  s_mul_i32 s47, s55, 868352
  s_add_u32 s41, s47, s50
  s_lshl_b32 s50, s28, 12
  s_sub_u32 s43, 331776, s50
  s_add_u32 s45, 102400, s50
  s_mul_i32 s50, s50, 7
  s_sub_u32 s44, 405504, s50
  s_add_u32 s46, 28672, s50
  s_add_u32 s50, s50, 24576
  s_cmp_eq_u32 s56, 0
  s_cselect_b32 s43, s43, s45
  s_cselect_b32 s44, s44, s46
  s_cselect_b32 s50, s50, 212992
  s_add_u32 s42, s47, s50
  s_add_u32 s50, s49, s32
  v_accvgpr_read_b32 v134, a122
  v_accvgpr_read_b32 v135, a123
  v_accvgpr_read_b32 v255, a208
  v_add_u32 v134, s50, v134
  v_add_u32 v135, s50, v135
  v_and_b32 v136, 0xf00, v255
  v_bfe_u32 v132, v255, 4, 1
  v_lshl_add_u32 v136, v132, 3, v136
  v_bfe_u32 v132, v255, 5, 1
  v_lshl_add_u32 v136, v132, 7, v136
  s_mov_b32 s38, 0
L_sround:
  s_mov_b32 s57, 0
L_ssub:
  s_cmp_eq_u32 s57, 6
  s_cselect_b32 s51, 6, 7
  s_lshl_b32 s50, s38, 1
  s_sub_u32 s51, s51, s50
  s_bitcmp1_b32 s48, s51
  s_cbranch_scc0 L_snext
  s_lshl_b32 s50, s57, 12
  s_add_u32 s35, s41, s50
  s_cmp_eq_u32 s57, 6
  s_cselect_b32 s35, s42, s35
  buffer_load_dwordx4 v[0:3], v255, s[12:15], s35 offen
  buffer_load_dwordx4 v[4:7], v255, s[12:15], s35 offen offset:64
  buffer_load_dwordx4 v[8:11], v255, s[12:15], s35 offen offset:128
  buffer_load_dwordx4 v[12:15], v255, s[12:15], s35 offen offset:192
  v_mov_b32 v132, 0xff800000
  s_lshl_b32 s33, s38, 17
  s_mov_b32 s58, 0
L_smax:
  s_add_u32 m0, s49, 0
  s_add_u32 s50, s33, 0
  buffer_load_dwordx4 v233, s[4:7], s50 offen lds
  s_add_u32 m0, s49, 1056
  s_add_u32 s50, s33, 1024
  buffer_load_dwordx4 v233, s[4:7], s50 offen lds
  s_add_u32 m0, s49, 2112
  s_add_u32 s50, s33, 2048
  buffer_load_dwordx4 v233, s[4:7], s50 offen lds
  s_add_u32 m0, s49, 3168
  s_add_u32 s50, s33, 3072
  buffer_load_dwordx4 v233, s[4:7], s50 offen lds
  s_add_u32 m0, s49, 4224
  s_add_u32 s50, s33, 4096
  buffer_load_dwordx4 v233, s[4:7], s50 offen lds
  s_add_u32 m0, s49, 5280
  s_add_u32 s50, s33, 5120
  buffer_load_dwordx4 v233, s[4:7], s50 offen lds
  s_add_u32 m0, s49, 6336
  s_add_u32 s50, s33, 6144
  buffer_load_dwordx4 v233, s[4:7], s50 offen lds
  s_add_u32 m0, s49, 7392
  s_add_u32 s50, s33, 7168
  buffer_load_dwordx4 v233, s[4:7], s50 offen lds
  s_waitcnt vmcnt(0)
  ds_read_b128 v[64:67], v134 offset:0
  ds_read_b128 v[68:71], v134 offset:64
  ds_read_b128 v[72:75], v134 offset:128
  ds_read_b128 v[76:79], v134 offset:192
  ds_read_b128 v[80:83], v134 offset:512
  ds_read_b128 v[84:87], v134 offset:576
  ds_read_b128 v[88:91], v134 offset:640
  ds_read_b128 v[92:95], v134 offset:704
  s_waitcnt lgkmcnt(0)
  v_mfma_f32_16x16x32_bf16 v[16:19], v[64:67], v[0:3], 0
  v_mfma_f32_16x16x32_bf16 v[16:19], v[68:71], v[4:7], v[16:19]
  v_mfma_f32_16x16x32_bf16 v[16:19], v[72:75], v[8:11], v[16:19]
  v_mfma_f32_16x16x32_bf16 v[16:19], v[76:79], v[12:15], v[16:19]
  v_mfma_f32_16x16x32_bf16 v[20:23], v[80:83], v[0:3], 0
  v_mfma_f32_16x16x32_bf16 v[20:23], v[84:87], v[4:7], v[20:23]
  v_mfma_f32_16x16x32_bf16 v[20:23], v[88:91], v[8:11], v[20:23]
  v_mfma_f32_16x16x32_bf16 v[20:23], v[92:95], v[12:15], v[20:23]
  s_nop 8
  v_max3_f32 v132, v132, v16, v17
  v_max3_f32 v132, v132, v18, v19
  v_max3_f32 v132, v132, v20, v21
  v_max3_f32 v132, v132, v22, v23
  s_add_u32 s33, s33, 8192
  s_add_u32 s58, s58, 1
  s_cmp_lt_u32 s58, 16
  s_cbranch_scc1 L_smax
  v_mov_b32 v133, v132
  s_nop 1
  v_permlane32_swap_b32 v132, v133
  s_nop 1
  v_max_f32 v132, v132, v133
  v_mov_b32 v133, v132
  s_nop 1
  v_permlane16_swap_b32 v132, v133
  s_nop 1
  v_max_f32 v132, v132, v133
  v_mov_b32 v32, 0
  v_mov_b32 v33, 0
  v_mov_b32 v34, 0
  v_mov_b32 v35, 0
  v_mov_b32 v36, 0
  v_mov_b32 v37, 0
  v_mov_b32 v38, 0
  v_mov_b32 v39, 0
  v_mov_b32 v40, 0
  v_mov_b32 v41, 0
  v_mov_b32 v42, 0
  v_mov_b32 v43, 0
  v_mov_b32 v44, 0
  v_mov_b32 v45, 0
  v_mov_b32 v46, 0
  v_mov_b32 v47, 0
  v_mov_b32 v48, 0
  v_mov_b32 v49, 0
  v_mov_b32 v50, 0
  v_mov_b32 v51, 0
  v_mov_b32 v52, 0
  v_mov_b32 v53, 0
  v_mov_b32 v54, 0
  v_mov_b32 v55, 0
  v_mov_b32 v56, 0
  v_mov_b32 v57, 0
  v_mov_b32 v58, 0
  v_mov_b32 v59, 0
  v_mov_b32 v60, 0
  v_mov_b32 v61, 0
  v_mov_b32 v62, 0
  v_mov_b32 v63, 0
  v_mov_b32 v128, 0
  v_mov_b32 v129, 0
  v_mov_b32 v130, 0
  v_mov_b32_e64 v131, 0
  s_lshl_b32 s33, s38, 17
  s_mov_b32 s58, 0
L_spv:
  s_add_u32 m0, s49, 0
  s_add_u32 s50, s33, 0
  buffer_load_dwordx4 v233, s[4:7], s50 offen lds
  s_add_u32 m0, s49, 1056
  s_add_u32 s50, s33, 1024
  buffer_load_dwordx4 v233, s[4:7], s50 offen lds
  s_add_u32 m0, s49, 2112
  s_add_u32 s50, s33, 2048
  buffer_load_dwordx4 v233, s[4:7], s50 offen lds
  s_add_u32 m0, s49, 3168
  s_add_u32 s50, s33, 3072
  buffer_load_dwordx4 v233, s[4:7], s50 offen lds
  s_add_u32 m0, s49, 4224
  s_add_u32 s50, s33, 4096
  buffer_load_dwordx4 v233, s[4:7], s50 offen lds
  s_add_u32 m0, s49, 5280
  s_add_u32 s50, s33, 5120
  buffer_load_dwordx4 v233, s[4:7], s50 offen lds
  s_add_u32 m0, s49, 6336
  s_add_u32 s50, s33, 6144
  buffer_load_dwordx4 v233, s[4:7], s50 offen lds
  s_add_u32 m0, s49, 7392
  s_add_u32 s50, s33, 7168
  buffer_load_dwordx4 v233, s[4:7], s50 offen lds
  s_add_u32 m0, s49, 8448
  s_add_u32 s50, s33, 0
  buffer_load_dwordx4 v233, s[8:11], s50 offen lds
  s_add_u32 m0, s49, 9488
  s_add_u32 s50, s33, 1024
  buffer_load_dwordx4 v233, s[8:11], s50 offen lds
  s_add_u32 m0, s49, 10528
  s_add_u32 s50, s33, 2048
  buffer_load_dwordx4 v233, s[8:11], s50 offen lds
  s_add_u32 m0, s49, 11568
  s_add_u32 s50, s33, 3072
  buffer_load_dwordx4 v233, s[8:11], s50 offen lds
  s_add_u32 m0, s49, 12608
  s_add_u32 s50, s33, 4096
  buffer_load_dwordx4 v233, s[8:11], s50 offen lds
  s_add_u32 m0, s49, 13648
  s_add_u32 s50, s33, 5120
  buffer_load_dwordx4 v233, s[8:11], s50 offen lds
  s_add_u32 m0, s49, 14688
  s_add_u32 s50, s33, 6144
  buffer_load_dwordx4 v233, s[8:11], s50 offen lds
  s_add_u32 m0, s49, 15728
  s_add_u32 s50, s33, 7168
  buffer_load_dwordx4 v233, s[8:11], s50 offen lds
  s_waitcnt vmcnt(0)
  ds_read_b128 v[64:67], v134 offset:0
  ds_read_b128 v[68:71], v134 offset:64
  ds_read_b128 v[72:75], v134 offset:128
  ds_read_b128 v[76:79], v134 offset:192
  ds_read_b128 v[80:83], v134 offset:512
  ds_read_b128 v[84:87], v134 offset:576
  ds_read_b128 v[88:91], v134 offset:640
  ds_read_b128 v[92:95], v134 offset:704
  s_waitcnt lgkmcnt(0)
  ds_read_b64_tr_b16 v[96:97], v135 offset:8448
  ds_read_b64_tr_b16 v[98:99], v135 offset:8960
  ds_read_b64_tr_b16 v[100:101], v135 offset:8464
  ds_read_b64_tr_b16 v[102:103], v135 offset:8976
  ds_read_b64_tr_b16 v[104:105], v135 offset:8480
  ds_read_b64_tr_b16 v[106:107], v135 offset:8992
  ds_read_b64_tr_b16 v[108:109], v135 offset:8496
  ds_read_b64_tr_b16 v[110:111], v135 offset:9008
  ds_read_b64_tr_b16 v[112:113], v135 offset:8512
  ds_read_b64_tr_b16 v[114:115], v135 offset:9024
  ds_read_b64_tr_b16 v[116:117], v135 offset:8528
  ds_read_b64_tr_b16 v[118:119], v135 offset:9040
  ds_read_b64_tr_b16 v[120:121], v135 offset:8544
  ds_read_b64_tr_b16 v[122:123], v135 offset:9056
  ds_read_b64_tr_b16 v[124:125], v135 offset:8560
  ds_read_b64_tr_b16 v[126:127], v135 offset:9072
  v_mfma_f32_16x16x32_bf16 v[16:19], v[64:67], v[0:3], 0
  v_mfma_f32_16x16x32_bf16 v[16:19], v[68:71], v[4:7], v[16:19]
  v_mfma_f32_16x16x32_bf16 v[16:19], v[72:75], v[8:11], v[16:19]
  v_mfma_f32_16x16x32_bf16 v[16:19], v[76:79], v[12:15], v[16:19]
  v_mfma_f32_16x16x32_bf16 v[20:23], v[80:83], v[0:3], 0
  v_mfma_f32_16x16x32_bf16 v[20:23], v[84:87], v[4:7], v[20:23]
  v_mfma_f32_16x16x32_bf16 v[20:23], v[88:91], v[8:11], v[20:23]
  v_mfma_f32_16x16x32_bf16 v[20:23], v[92:95], v[12:15], v[20:23]
  s_nop 8
  v_sub_f32 v16, v16, v132
  v_sub_f32 v17, v17, v132
  v_sub_f32 v18, v18, v132
  v_sub_f32 v19, v19, v132
  v_sub_f32 v20, v20, v132
  v_sub_f32 v21, v21, v132
  v_sub_f32 v22, v22, v132
  v_sub_f32 v23, v23, v132
  v_mul_f32 v16, s29, v16
  v_mul_f32 v17, s29, v17
  v_mul_f32 v18, s29, v18
  v_mul_f32 v19, s29, v19
  v_mul_f32 v20, s29, v20
  v_mul_f32 v21, s29, v21
  v_mul_f32 v22, s29, v22
  v_mul_f32 v23, s29, v23
  v_exp_f32 v16, v16
  v_exp_f32 v17, v17
  v_exp_f32 v18, v18
  v_exp_f32 v19, v19
  v_exp_f32 v20, v20
  v_exp_f32 v21, v21
  v_exp_f32 v22, v22
  v_exp_f32 v23, v23
  s_nop 0
  v_cvt_pk_bf16_f32 v24, v16, v17
  v_cvt_pk_bf16_f32 v25, v18, v19
  v_cvt_pk_bf16_f32 v26, v20, v21
  v_cvt_pk_bf16_f32 v27, v22, v23
  s_waitcnt lgkmcnt(0)
  s_nop 1
  v_mfma_f32_16x16x32_bf16 v[128:131], a[220:223], v[24:27], v[128:131]
  v_mfma_f32_16x16x32_bf16 v[32:35], v[96:99], v[24:27], v[32:35]
  v_mfma_f32_16x16x32_bf16 v[36:39], v[100:103], v[24:27], v[36:39]
  v_mfma_f32_16x16x32_bf16 v[40:43], v[104:107], v[24:27], v[40:43]
  v_mfma_f32_16x16x32_bf16 v[44:47], v[108:111], v[24:27], v[44:47]
  v_mfma_f32_16x16x32_bf16 v[48:51], v[112:115], v[24:27], v[48:51]
  v_mfma_f32_16x16x32_bf16 v[52:55], v[116:119], v[24:27], v[52:55]
  v_mfma_f32_16x16x32_bf16 v[56:59], v[120:123], v[24:27], v[56:59]
  v_mfma_f32_16x16x32_bf16 v[60:63], v[124:127], v[24:27], v[60:63]
  s_add_u32 s33, s33, 8192
  s_add_u32 s58, s58, 1
  s_cmp_lt_u32 s58, 16
  s_cbranch_scc1 L_spv
  s_nop 8
  v_add_f32 v128, v128, v130
  v_rcp_f32 v128, v128
  s_nop 0
  v_mul_f32 v32, v32, v128
  v_mul_f32 v33, v33, v128
  v_mul_f32 v34, v34, v128
  v_mul_f32 v35, v35, v128
  v_mul_f32 v36, v36, v128
  v_mul_f32 v37, v37, v128
  v_mul_f32 v38, v38, v128
  v_mul_f32 v39, v39, v128
  v_mul_f32 v40, v40, v128
  v_mul_f32 v41, v41, v128
  v_mul_f32 v42, v42, v128
  v_mul_f32 v43, v43, v128
  v_mul_f32 v44, v44, v128
  v_mul_f32 v45, v45, v128
  v_mul_f32 v46, v46, v128
  v_mul_f32 v47, v47, v128
  v_mul_f32 v48, v48, v128
  v_mul_f32 v49, v49, v128
  v_mul_f32 v50, v50, v128
  v_mul_f32 v51, v51, v128
  v_mul_f32 v52, v52, v128
  v_mul_f32 v53, v53, v128
  v_mul_f32 v54, v54, v128
  v_mul_f32 v55, v55, v128
  v_mul_f32 v56, v56, v128
  v_mul_f32 v57, v57, v128
  v_mul_f32 v58, v58, v128
  v_mul_f32 v59, v59, v128
  v_mul_f32 v60, v60, v128
  v_mul_f32 v61, v61, v128
  v_mul_f32 v62, v62, v128
  v_mul_f32 v63, v63, v128
  v_cvt_pk_bf16_f32 v32, v32, v33
  v_cvt_pk_bf16_f32 v33, v34, v35
  v_cvt_pk_bf16_f32 v36, v36, v37
  v_cvt_pk_bf16_f32 v37, v38, v39
  v_cvt_pk_bf16_f32 v40, v40, v41
  v_cvt_pk_bf16_f32 v41, v42, v43
  v_cvt_pk_bf16_f32 v44, v44, v45
  v_cvt_pk_bf16_f32 v45, v46, v47
  v_cvt_pk_bf16_f32 v48, v48, v49
  v_cvt_pk_bf16_f32 v49, v50, v51
  v_cvt_pk_bf16_f32 v52, v52, v53
  v_cvt_pk_bf16_f32 v53, v54, v55
  v_cvt_pk_bf16_f32 v56, v56, v57
  v_cvt_pk_bf16_f32 v57, v58, v59
  v_cvt_pk_bf16_f32 v60, v60, v61
  v_cvt_pk_bf16_f32 v61, v62, v63
  buffer_store_dwordx2 v[32:33], v136, s[16:19], s35 offen
  buffer_store_dwordx2 v[36:37], v136, s[16:19], s35 offen offset:16
  buffer_store_dwordx2 v[40:41], v136, s[16:19], s35 offen offset:32
  buffer_store_dwordx2 v[44:45], v136, s[16:19], s35 offen offset:48
  buffer_store_dwordx2 v[48:49], v136, s[16:19], s35 offen offset:64
  buffer_store_dwordx2 v[52:53], v136, s[16:19], s35 offen offset:80
  buffer_store_dwordx2 v[56:57], v136, s[16:19], s35 offen offset:96
  buffer_store_dwordx2 v[60:61], v136, s[16:19], s35 offen offset:112
  s_waitcnt vmcnt(0)
L_snext:
  s_add_u32 s57, s57, 1
  s_cmp_lt_u32 s57, 7
  s_cbranch_scc1 L_ssub
  s_add_u32 s41, s41, s43
  s_add_u32 s42, s42, s44
  s_sub_u32 s43, 434176, s43
  s_sub_u32 s44, 434176, s44
  s_add_u32 s38, s38, 1
  s_cmp_lt_u32 s38, 4
  s_cbranch_scc1 L_sround
L_end:
  s_endpgm
.section .rodata,"a"
.p2align 6
.amdhsa_kernel standalone__gqa_softmax__near_ridge_kernel
  .amdhsa_next_free_vgpr 512
  .amdhsa_next_free_sgpr 102
  .amdhsa_accum_offset 256
  .amdhsa_group_segment_fixed_size 0
  .amdhsa_kernarg_size 48
  .amdhsa_user_sgpr_count 2
  .amdhsa_user_sgpr_kernarg_segment_ptr 1
  .amdhsa_system_sgpr_workgroup_id_x 1
  .amdhsa_float_denorm_mode_32 3
.end_amdhsa_kernel
```
